```python
import torch

def _softmax(x, axis=-1):
    return torch.softmax(x, dim=axis)
def _gelu(x):
    return torch.nn.functional.gelu(x, approximate="tanh")
def _silu(x):
    return torch.nn.functional.silu(x)
def _sigmoid(x):
    return torch.sigmoid(x)
def _layernorm(x, axis=-1, eps=1e-5):
    m = x.mean(dim=axis, keepdim=True)
    v = x.var(dim=axis, keepdim=True, unbiased=False)
    return (x - m) / torch.sqrt(v + eps)
def _scatter_add(tgt, idx, src, axis=0):
    return tgt.clone().index_add_(axis, idx, src)
def _segment_sum(src, seg, n):
    out = torch.zeros((n,) + src.shape[1:], dtype=src.dtype)
    return out.index_add_(0, seg, src)
def _pad(x, pw):
    flat = tuple(v for pair in reversed(pw) for v in pair)
    return torch.nn.functional.pad(x, flat)

kernel_name = 'recurrent_scan__sliding_local_dilated__moe_arch_mod__prompt'

def setup_inputs():

    _w = (lambda a: (lambda t: t.to(torch.bfloat16) if t.is_floating_point() else t)(torch.as_tensor(a)))
    def _A_setup():
        B, S, D = 1, 2048, 640
        return {
            "x": _w((lambda *s: torch.randn(*s, dtype=torch.bfloat16) * 0.05)(B, S, D)),
            "wqkv": _w((lambda *s: torch.randn(*s, dtype=torch.bfloat16) * 0.05)(D, 3 * D)),
            "wo": _w((lambda *s: torch.randn(*s, dtype=torch.bfloat16) * 0.05)(D, D)),
        }
    _A_in = _A_setup()

    def _B_setup():
        B, S, D, F, C = 1, 2048, 640, 1728, 2
        return {
            "x": _w((lambda *s: torch.randn(*s, dtype=torch.bfloat16) * 0.05)(B, S, D)),
            "w_r": _w((lambda *s: torch.randn(*s, dtype=torch.bfloat16) * 0.05)(D)),
            "w_gate": _w((lambda *s: torch.randn(*s, dtype=torch.bfloat16) * 0.05)(D, F)),
            "w_up": _w((lambda *s: torch.randn(*s, dtype=torch.bfloat16) * 0.05)(D, F)),
            "w_down": _w((lambda *s: torch.randn(*s, dtype=torch.bfloat16) * 0.05)(F, D)),
        }
    _B_in = _B_setup()

    return {
        "A_x": _A_in["x"],
        "A_wqkv": _A_in["wqkv"],
        "A_wo": _A_in["wo"],
        "B_x": _B_in["x"],
        "B_w_r": _B_in["w_r"],
        "B_w_gate": _B_in["w_gate"],
        "B_w_up": _B_in["w_up"],
        "B_w_down": _B_in["w_down"],
    }

def reference(A_x, A_wqkv, A_wo, B_x, B_w_r, B_w_gate, B_w_up, B_w_down):
    def _A_ref(x, wqkv, wo):
        B, S, D = x.shape
        H = 32; Dh = D // H
        W, dil = 8, 2
        qkv = (lambda x, *d: x.permute(*d))((x @ wqkv).reshape(B, S, 3, H, Dh), 2, 0, 3, 1, 4)
        q, k, v = qkv[0], qkv[1], qkv[2]
        scale = Dh ** -0.5
        pos = torch.arange(S)
        off = torch.arange(W) * dil
        idx = pos[:, None] - off[None, :]
        mask = idx >= 0
        idx_c = torch.where(mask, idx, 0).reshape(-1)
        kg = k[:, :, idx_c, :].reshape(B, H, S, W, Dh)
        vg = v[:, :, idx_c, :].reshape(B, H, S, W, Dh)
        logits = torch.einsum("bhsd,bhswd->bhsw", q, kg) * scale
        logits = torch.where(mask[None, None, :, :], logits, -1e9)
        attn = _softmax(logits, axis=-1)
        o = torch.einsum("bhsw,bhswd->bhsd", attn, vg)
        return (lambda x, *d: x.permute(*d))(o, 0, 2, 1, 3).reshape(B, S, D) @ wo

    def _B_ref(x, w_r, w_gate, w_up, w_down):
        B, S, D = x.shape
        C = 2
        r = x @ w_r
        idx = torch.argsort(-r, axis=-1)[:, :C]
        idx_e = (lambda x, n, axis: torch.repeat_interleave(x, n, dim=axis))(idx.reshape(B, C, 1), D, axis=2)
        x_sel = (lambda x, i, axis: torch.take_along_dim(x, i, dim=axis))(x, idx_e, axis=1)
        g = _silu(x_sel @ w_gate)
        u = x_sel @ w_up
        y = (g * u) @ w_down
        r_sel = _sigmoid((lambda x, i, axis: torch.take_along_dim(x, i, dim=axis))(r, idx, axis=1))
        y = y * r_sel.reshape(B, C, 1)
        b_off = (torch.arange(B) * S).reshape(B, 1)
        flat_idx = (idx + b_off).reshape(B * C)
        zero = (x * 0.0).reshape(B * S, D)
        upd = _scatter_add(zero, flat_idx, y.reshape(B * C, D), axis=0)
        return x + upd.reshape(B, S, D)

    x = A_x
    xn = _layernorm(x, axis=-1)
    s = _A_ref(xn, A_wqkv, A_wo)
    g = _silu(_B_ref(xn, B_w_r, B_w_gate, B_w_up, B_w_down))
    return x + s * g
```

```asm
; @launch grid=(256,1,1) block=(256,1,1) lds=163840
.amdgcn_target "amdgcn-amd-amdhsa--gfx950"
.text
.globl recurrent_scan__sliding_local_dilated__moe_arch_mod__prompt_kernel
.p2align 8
.type recurrent_scan__sliding_local_dilated__moe_arch_mod__prompt_kernel,@function
recurrent_scan__sliding_local_dilated__moe_arch_mod__prompt_kernel:
    s_load_dwordx16 s[4:19], s[0:1], 0
    s_load_dwordx4 s[20:23], s[0:1], 64
    s_load_dwordx2 s[24:25], s[0:1], 80
    s_mov_b32 s54, 200000
    s_cmp_ge_u32 s2, 256
    s_cbranch_scc1 Lend
    v_lshrrev_b32 v4, 6, v0
    v_and_b32 v1, 63, v0
    v_readfirstlane_b32 s3, v4
    v_lshrrev_b32 v2, 4, v1
    v_and_b32 v3, 15, v1
    v_lshlrev_b32 v12, 2, v1
    v_lshlrev_b32 v13, 4, v1
    s_and_b32 s56, s2, 7
    s_lshr_b32 s57, s2, 3
    s_and_b32 s58, s56, 1
    s_lshr_b32 s56, s56, 1
    s_add_u32 s59, s58, 4
    s_waitcnt lgkmcnt(0)
    s_mov_b32 s28, s4
    s_mov_b32 s29, s5
    s_mov_b32 s30, 2621440
    s_mov_b32 s31, 0x20000
    s_mov_b32 s44, s24
    s_mov_b32 s45, s25
    s_mov_b32 s46, 268435456
    s_mov_b32 s47, 0x20000
    s_mov_b32 s48, s22
    s_mov_b32 s49, s23
    s_mov_b32 s50, 256
    s_mov_b32 s51, 0x20000
    s_cmp_lt_u32 s57, s59
    s_cbranch_scc1 Laux
    s_mul_i32 s56, s56, 55
    s_mul_i32 s58, s58, 28
    s_add_u32 s56, s56, s58
    s_add_u32 s56, s56, s57
    s_sub_u32 s56, s56, s59
    s_mul_i32 s26, s56, 6554
    s_lshr_b32 s26, s26, 16
    s_mul_i32 s57, s26, 10
    s_sub_u32 s27, s56, s57
    s_mov_b32 s32, s6
    s_mov_b32 s33, s7
    s_mov_b32 s34, 2457600
    s_mov_b32 s35, 0x20000
    s_add_u32 s36, s6, 1280
    s_addc_u32 s37, s7, 0
    s_mov_b32 s38, 2456320
    s_mov_b32 s39, 0x20000
    s_add_u32 s40, s6, 2560
    s_addc_u32 s41, s7, 0
    s_mov_b32 s42, 2455040
    s_mov_b32 s43, 0x20000
    s_and_b32 s56, s26, 3
    s_lshl_b32 s56, s56, 2
    s_lshr_b32 s56, 0x9731, s56
    s_and_b32 s56, s56, 15
    s_mov_b32 s57, s27
    v_lshrrev_b32 v5, 3, v1
    v_and_b32 v6, 7, v1
    s_lshl_b32 s58, s3, 4
    v_add_u32 v7, s58, v5
    v_mul_u32_u24 v7, 3840, v7
    v_and_b32 v8, 1, v2
    v_lshlrev_b32 v8, 1, v8
    v_xor_b32 v8, v8, v6
    v_lshlrev_b32 v8, 4, v8
    s_lshl_b32 s59, s27, 7
    v_add3_u32 v14, v7, v8, s59
    v_xor_b32 v15, 64, v14
    v_add_u32 v15, 30720, v15
    s_mul_i32 s58, s26, 96
    s_lshl_b32 s59, s3, 5
    s_add_u32 s58, s58, s59
    s_sub_u32 s58, s58, 16
    s_cmp_eq_u32 s3, 0
    s_cselect_b32 s59, 0, 16
    s_cselect_b64 s[82:83], 1, -1
    s_cselect_b32 s80, 0, 2048
    s_sub_u32 s59, s58, s59
    v_xor_b32 v9, v6, v2
    v_lshlrev_b32 v9, 4, v9
    v_xor_b32 v10, 64, v9
    v_mov_b32 v11, 2047
    v_add_u32 v16, s59, v5
    v_med3_i32 v16, v16, 0, v11
    v_mul_u32_u24 v16, 1280, v16
    v_add_u32 v16, v16, v9
    v_add_u32 v17, s59, v5
    v_add_u32 v17, 8, v17
    v_med3_i32 v17, v17, 0, v11
    v_mul_u32_u24 v17, 1280, v17
    v_add_u32 v17, v17, v10
    v_add_u32 v18, s58, v5
    v_med3_i32 v18, v18, 0, v11
    v_mul_u32_u24 v18, 1280, v18
    v_add_u32 v18, v18, v9
    v_add_u32 v19, s58, v5
    v_add_u32 v19, 8, v19
    v_med3_i32 v19, v19, 0, v11
    v_mul_u32_u24 v19, 1280, v19
    v_add_u32 v19, v19, v10
    s_lshl_b32 s55, s3, 11
    s_lshl_b32 s81, s3, 12
    s_add_u32 s81, s81, 16384
    s_sub_u32 s80, s81, s80
    s_mul_i32 s60, s57, 245760
    s_lshl_b32 s70, s57, 7
    s_add_u32 s57, s57, s56
    s_sub_u32 s58, s57, 10
    s_cmp_ge_u32 s57, 10
    s_cselect_b32 s57, s58, s57
    s_add_u32 m0, s81, 0
    s_nop 0
    buffer_load_dwordx4 v18, s[28:31], s70 offen lds
    s_add_u32 m0, s81, 1024
    s_nop 0
    buffer_load_dwordx4 v19, s[28:31], s70 offen lds
    s_add_u32 m0, s55, 0
    s_nop 0
    buffer_load_dwordx4 v14, s[32:35], s60 offen lds
    s_add_u32 m0, s55, 1024
    s_nop 0
    buffer_load_dwordx4 v15, s[32:35], s60 offen lds
    s_add_u32 m0, s55, 8192
    s_nop 0
    buffer_load_dwordx4 v14, s[36:39], s60 offen lds
    s_add_u32 m0, s55, 9216
    s_nop 0
    buffer_load_dwordx4 v15, s[36:39], s60 offen lds
    s_mov_b64 exec, s[82:83]
    s_add_u32 m0, s80, 0
    s_nop 0
    buffer_load_dwordx4 v16, s[28:31], s70 offen lds
    s_add_u32 m0, s80, 1024
    s_nop 0
    buffer_load_dwordx4 v17, s[28:31], s70 offen lds
    s_mov_b64 exec, -1
    s_mul_i32 s61, s57, 245760
    s_lshl_b32 s71, s57, 7
    s_add_u32 s57, s57, s56
    s_sub_u32 s58, s57, 10
    s_cmp_ge_u32 s57, 10
    s_cselect_b32 s57, s58, s57
    s_add_u32 m0, s81, 30848
    s_nop 0
    buffer_load_dwordx4 v18, s[28:31], s71 offen lds
    s_add_u32 m0, s81, 31872
    s_nop 0
    buffer_load_dwordx4 v19, s[28:31], s71 offen lds
    s_add_u32 m0, s55, 30848
    s_nop 0
    buffer_load_dwordx4 v14, s[32:35], s61 offen lds
    s_add_u32 m0, s55, 31872
    s_nop 0
    buffer_load_dwordx4 v15, s[32:35], s61 offen lds
    s_add_u32 m0, s55, 39040
    s_nop 0
    buffer_load_dwordx4 v14, s[36:39], s61 offen lds
    s_add_u32 m0, s55, 40064
    s_nop 0
    buffer_load_dwordx4 v15, s[36:39], s61 offen lds
    s_mov_b64 exec, s[82:83]
    s_add_u32 m0, s80, 30848
    s_nop 0
    buffer_load_dwordx4 v16, s[28:31], s71 offen lds
    s_add_u32 m0, s80, 31872
    s_nop 0
    buffer_load_dwordx4 v17, s[28:31], s71 offen lds
    s_mov_b64 exec, -1
    s_mul_i32 s62, s57, 245760
    s_lshl_b32 s72, s57, 7
    s_add_u32 s57, s57, s56
    s_sub_u32 s58, s57, 10
    s_cmp_ge_u32 s57, 10
    s_cselect_b32 s57, s58, s57
    s_add_u32 m0, s81, 61696
    s_nop 0
    buffer_load_dwordx4 v18, s[28:31], s72 offen lds
    s_add_u32 m0, s81, 62720
    s_nop 0
    buffer_load_dwordx4 v19, s[28:31], s72 offen lds
    s_add_u32 m0, s55, 61696
    s_nop 0
    buffer_load_dwordx4 v14, s[32:35], s62 offen lds
    s_add_u32 m0, s55, 62720
    s_nop 0
    buffer_load_dwordx4 v15, s[32:35], s62 offen lds
    s_add_u32 m0, s55, 69888
    s_nop 0
    buffer_load_dwordx4 v14, s[36:39], s62 offen lds
    s_add_u32 m0, s55, 70912
    s_nop 0
    buffer_load_dwordx4 v15, s[36:39], s62 offen lds
    s_mov_b64 exec, s[82:83]
    s_add_u32 m0, s80, 61696
    s_nop 0
    buffer_load_dwordx4 v16, s[28:31], s72 offen lds
    s_add_u32 m0, s80, 62720
    s_nop 0
    buffer_load_dwordx4 v17, s[28:31], s72 offen lds
    s_mov_b64 exec, -1
    s_mul_i32 s63, s57, 245760
    s_lshl_b32 s73, s57, 7
    s_add_u32 s57, s57, s56
    s_sub_u32 s58, s57, 10
    s_cmp_ge_u32 s57, 10
    s_cselect_b32 s57, s58, s57
    s_add_u32 m0, s81, 92544
    s_nop 0
    buffer_load_dwordx4 v18, s[28:31], s73 offen lds
    s_add_u32 m0, s81, 93568
    s_nop 0
    buffer_load_dwordx4 v19, s[28:31], s73 offen lds
    s_add_u32 m0, s55, 92544
    s_nop 0
    buffer_load_dwordx4 v14, s[32:35], s63 offen lds
    s_add_u32 m0, s55, 93568
    s_nop 0
    buffer_load_dwordx4 v15, s[32:35], s63 offen lds
    s_add_u32 m0, s55, 100736
    s_nop 0
    buffer_load_dwordx4 v14, s[36:39], s63 offen lds
    s_add_u32 m0, s55, 101760
    s_nop 0
    buffer_load_dwordx4 v15, s[36:39], s63 offen lds
    s_mov_b64 exec, s[82:83]
    s_add_u32 m0, s80, 92544
    s_nop 0
    buffer_load_dwordx4 v16, s[28:31], s73 offen lds
    s_add_u32 m0, s80, 93568
    s_nop 0
    buffer_load_dwordx4 v17, s[28:31], s73 offen lds
    s_mov_b64 exec, -1
    s_mul_i32 s64, s57, 245760
    s_lshl_b32 s74, s57, 7
    s_add_u32 s57, s57, s56
    s_sub_u32 s58, s57, 10
    s_cmp_ge_u32 s57, 10
    s_cselect_b32 s57, s58, s57
    s_add_u32 m0, s81, 123392
    s_nop 0
    buffer_load_dwordx4 v18, s[28:31], s74 offen lds
    s_add_u32 m0, s81, 124416
    s_nop 0
    buffer_load_dwordx4 v19, s[28:31], s74 offen lds
    s_add_u32 m0, s55, 123392
    s_nop 0
    buffer_load_dwordx4 v14, s[32:35], s64 offen lds
    s_add_u32 m0, s55, 124416
    s_nop 0
    buffer_load_dwordx4 v15, s[32:35], s64 offen lds
    s_add_u32 m0, s55, 131584
    s_nop 0
    buffer_load_dwordx4 v14, s[36:39], s64 offen lds
    s_add_u32 m0, s55, 132608
    s_nop 0
    buffer_load_dwordx4 v15, s[36:39], s64 offen lds
    s_mov_b64 exec, s[82:83]
    s_add_u32 m0, s80, 123392
    s_nop 0
    buffer_load_dwordx4 v16, s[28:31], s74 offen lds
    s_add_u32 m0, s80, 124416
    s_nop 0
    buffer_load_dwordx4 v17, s[28:31], s74 offen lds
    s_mov_b64 exec, -1
    s_mul_i32 s65, s57, 245760
    s_lshl_b32 s75, s57, 7
    s_add_u32 s57, s57, s56
    s_sub_u32 s58, s57, 10
    s_cmp_ge_u32 s57, 10
    s_cselect_b32 s57, s58, s57
    s_mul_i32 s66, s57, 245760
    s_lshl_b32 s76, s57, 7
    s_add_u32 s57, s57, s56
    s_sub_u32 s58, s57, 10
    s_cmp_ge_u32 s57, 10
    s_cselect_b32 s57, s58, s57
    s_mul_i32 s67, s57, 245760
    s_lshl_b32 s77, s57, 7
    s_add_u32 s57, s57, s56
    s_sub_u32 s58, s57, 10
    s_cmp_ge_u32 s57, 10
    s_cselect_b32 s57, s58, s57
    s_mul_i32 s68, s57, 245760
    s_lshl_b32 s78, s57, 7
    s_add_u32 s57, s57, s56
    s_sub_u32 s58, s57, 10
    s_cmp_ge_u32 s57, 10
    s_cselect_b32 s57, s58, s57
    s_mul_i32 s69, s57, 245760
    s_lshl_b32 s79, s57, 7
    s_add_u32 s57, s57, s56
    s_sub_u32 s58, s57, 10
    s_cmp_ge_u32 s57, 10
    s_cselect_b32 s57, s58, s57
    s_mov_b32 s84, s8
    s_mov_b32 s85, s9
    s_mov_b32 s86, 819200
    s_mov_b32 s87, 0x20000
    s_mov_b32 s88, s20
    s_mov_b32 s89, s21
    s_mov_b32 s90, 2621440
    s_mov_b32 s91, 0x20000
    s_sub_u32 s56, s27, 5
    s_cmp_ge_u32 s27, 5
    s_cselect_b32 s52, s56, s27
    s_mov_b32 s4, 0xbfe10856
    s_mov_b32 s5, 0xaae00455
    s_cmp_eq_u32 s52, 1
    s_cselect_b32 s4, 0xaff80255, s4
    s_cselect_b32 s5, 0xaaf80155, s5
    s_cmp_eq_u32 s52, 2
    s_cselect_b32 s4, 0xabfe4015, s4
    s_cselect_b32 s5, 0xaafe4055, s5
    s_cmp_eq_u32 s52, 3
    s_cselect_b32 s4, 0xaa7fd005, s4
    s_cselect_b32 s5, 0xaabfd055, s5
    s_cmp_eq_u32 s52, 4
    s_cselect_b32 s4, 0x6adfb401, s4
    s_cselect_b32 s5, 0xaaeff455, s5
    v_mov_b32 v20, 0x3f803f80
    v_mov_b32 v21, 0x3f803f80
    v_mov_b32 v22, 0x3f803f80
    v_mov_b32 v23, 0x3f803f80
    v_lshlrev_b32 v4, 4, v6
    ds_write_b128 v4, v[20:23] offset:30720
    ds_write_b128 v4, v[20:23] offset:61568
    v_add_u32 v4, 61696, v4
    ds_write_b128 v4, v[20:23] offset:30720
    ds_write_b128 v4, v[20:23] offset:61568
    v_add_u32 v4, 61696, v4
    ds_write_b128 v4, v[20:23] offset:30720
    v_bfe_u32 v7, v1, 2, 2
    v_and_b32 v8, 3, v1
    v_and_b32 v9, 1, v2
    v_lshlrev_b32 v9, 1, v9
    v_lshrrev_b32 v10, 1, v7
    v_or_b32 v9, v9, v10
    v_lshl_add_u32 v24, v2, 3, v7
    v_lshlrev_b32 v24, 7, v24
    v_lshlrev_b32 v25, 5, v9
    v_lshlrev_b32 v10, 1, v8
    v_add_u32 v11, 0, v10
    v_bfe_u32 v11, s4, v11, 2
    v_lshl_add_u32 v11, v11, 2, v8
    v_lshlrev_b32 v11, 3, v11
    v_xor_b32 v11, v11, v25
    v_add_u32 v26, v11, v24
    v_add_u32 v30, 61696, v26
    v_add_u32 v34, 123392, v26
    v_add_u32 v11, 8, v10
    v_bfe_u32 v11, s4, v11, 2
    v_lshl_add_u32 v11, v11, 2, v8
    v_lshlrev_b32 v11, 3, v11
    v_xor_b32 v11, v11, v25
    v_add_u32 v27, v11, v24
    v_add_u32 v31, 61696, v27
    v_add_u32 v35, 123392, v27
    v_add_u32 v11, 16, v10
    v_bfe_u32 v11, s4, v11, 2
    v_lshl_add_u32 v11, v11, 2, v8
    v_lshlrev_b32 v11, 3, v11
    v_xor_b32 v11, v11, v25
    v_add_u32 v28, v11, v24
    v_add_u32 v32, 61696, v28
    v_add_u32 v36, 123392, v28
    v_add_u32 v11, 24, v10
    v_bfe_u32 v11, s4, v11, 2
    v_lshl_add_u32 v11, v11, 2, v8
    v_lshlrev_b32 v11, 3, v11
    v_xor_b32 v11, v11, v25
    v_add_u32 v29, v11, v24
    v_add_u32 v33, 61696, v29
    v_add_u32 v37, 123392, v29
    v_lshrrev_b32 v10, 1, v3
    v_xor_b32 v10, v10, v2
    v_lshlrev_b32 v10, 4, v10
    v_lshl_add_u32 v10, v3, 7, v10
    v_add_u32 v40, s81, v10
    v_xor_b32 v41, 64, v40
    v_add_u32 v38, s80, v10
    s_cmp_eq_u32 s3, 0
    s_cselect_b64 vcc, -1, 0
    v_mov_b32 v11, 30720
    v_cndmask_b32 v38, v38, v11, vcc
    v_xor_b32 v39, 64, v38
    v_add_u32 v42, 61696, v38
    v_add_u32 v46, 123392, v38
    v_add_u32 v43, 61696, v39
    v_add_u32 v47, 123392, v39
    v_add_u32 v44, 61696, v40
    v_add_u32 v48, 123392, v40
    v_add_u32 v45, 61696, v41
    v_add_u32 v49, 123392, v41
    s_mov_b32 s6, 20480
    s_lshr_b32 s56, s3, 1
    s_lshl_b32 s56, s56, 4
    s_and_b32 s57, s3, 1
    s_lshl_b32 s57, s57, 1
    s_lshl_b32 s58, s57, 1
    s_add_u32 s56, s56, s58
    v_lshrrev_b32 v10, 5, v1
    v_lshl_add_u32 v50, v10, 3, s56
    v_add_u32 v51, 2, v50
    v_and_b32 v10, 3, v5
    s_lshl_b32 s57, s57, 2
    v_add_u32 v10, s57, v10
    v_mul_u32_u24 v10, 1280, v10
    v_and_b32 v11, 0x70, v14
    s_lshl_b32 s59, s27, 7
    v_add3_u32 v52, v10, v11, s59
    v_xor_b32 v53, 64, v52
    v_add_u32 v53, 5120, v53
    v_lshlrev_b32 v10, 1, v2
    v_add_u32 v10, 8, v10
    v_bfe_u32 v10, s5, v10, 2
    v_cmp_eq_u32 s[10:11], 0, v10
    v_cmp_eq_u32 s[12:13], 3, v10
    v_cmp_eq_u32 s[14:15], 1, v10
    v_lshlrev_b32 v10, 1, v2
    v_add_u32 v10, 16, v10
    v_bfe_u32 v10, s5, v10, 2
    v_cmp_eq_u32 s[16:17], 0, v10
    v_cmp_eq_u32 s[18:19], 3, v10
    v_cmp_eq_u32 s[20:21], 2, v10
    s_mov_b32 s4, 0xaaaaaaaa
    s_mov_b32 s5, 0xaaaaaaaa
    s_mov_b32 s22, 0xcccccccc
    s_mov_b32 s23, 0xcccccccc
    v_lshrrev_b32 v56, 2, v3
    v_lshl_add_u32 v56, v56, 4, v3
    v_lshlrev_b32 v56, 2, v56
    s_waitcnt vmcnt(32) lgkmcnt(0)
    s_barrier
    ds_read_b128 a[0:3], v38 offset:0
    ds_read_b128 a[8:11], v40 offset:0
    ds_read_b128 a[4:7], v39 offset:0
    ds_read_b128 a[12:15], v41 offset:0
    ds_read_b64_tr_b16 a[160:161], v26 offset:0
    ds_read_b64_tr_b16 a[162:163], v26 offset:512
    ds_read_b64_tr_b16 a[164:165], v27 offset:0
    ds_read_b64_tr_b16 a[166:167], v27 offset:512
    ds_read_b64_tr_b16 a[168:169], v28 offset:0
    ds_read_b64_tr_b16 a[170:171], v28 offset:512
    ds_read_b64_tr_b16 a[172:173], v29 offset:0
    ds_read_b64_tr_b16 a[174:175], v29 offset:512
    ds_read_b64_tr_b16 a[176:177], v26 offset:8192
    ds_read_b64_tr_b16 a[178:179], v26 offset:8704
    ds_read_b64_tr_b16 a[180:181], v27 offset:8192
    ds_read_b64_tr_b16 a[182:183], v27 offset:8704
    ds_read_b64_tr_b16 a[184:185], v28 offset:8192
    ds_read_b64_tr_b16 a[186:187], v28 offset:8704
    ds_read_b64_tr_b16 a[188:189], v29 offset:8192
    ds_read_b64_tr_b16 a[190:191], v29 offset:8704
    s_waitcnt lgkmcnt(0)
    v_mfma_f32_16x16x32_bf16 v[122:125], v[20:23], a[0:3], 0
    ds_read_b64_tr_b16 a[192:193], v26 offset:4096
    ds_read_b64_tr_b16 a[194:195], v26 offset:4608
    v_mfma_f32_16x16x32_bf16 v[126:129], a[0:3], a[0:3], 0
    ds_read_b64_tr_b16 a[196:197], v27 offset:4096
    ds_read_b64_tr_b16 a[198:199], v27 offset:4608
    v_mfma_f32_16x16x32_bf16 v[130:133], v[20:23], a[8:11], 0
    ds_read_b64_tr_b16 a[200:201], v28 offset:4096
    ds_read_b64_tr_b16 a[202:203], v28 offset:4608
    v_mfma_f32_16x16x32_bf16 v[134:137], a[8:11], a[8:11], 0
    ds_read_b64_tr_b16 a[204:205], v29 offset:4096
    ds_read_b64_tr_b16 a[206:207], v29 offset:4608
    v_mfma_f32_16x16x32_bf16 v[58:61], a[160:163], a[0:3], 0
    ds_read_b64_tr_b16 a[208:209], v26 offset:12288
    ds_read_b64_tr_b16 a[210:211], v26 offset:12800
    v_mfma_f32_16x16x32_bf16 v[90:93], a[160:163], a[8:11], 0
    ds_read_b64_tr_b16 a[212:213], v27 offset:12288
    ds_read_b64_tr_b16 a[214:215], v27 offset:12800
    v_mfma_f32_16x16x32_bf16 v[62:65], a[164:167], a[0:3], 0
    ds_read_b64_tr_b16 a[216:217], v28 offset:12288
    ds_read_b64_tr_b16 a[218:219], v28 offset:12800
    v_mfma_f32_16x16x32_bf16 v[94:97], a[164:167], a[8:11], 0
    ds_read_b64_tr_b16 a[220:221], v29 offset:12288
    ds_read_b64_tr_b16 a[222:223], v29 offset:12800
    v_mfma_f32_16x16x32_bf16 v[66:69], a[168:171], a[0:3], 0
    v_mfma_f32_16x16x32_bf16 v[98:101], a[168:171], a[8:11], 0
    v_mfma_f32_16x16x32_bf16 v[70:73], a[172:175], a[0:3], 0
    v_mfma_f32_16x16x32_bf16 v[102:105], a[172:175], a[8:11], 0
    v_mfma_f32_16x16x32_bf16 v[74:77], a[176:179], a[0:3], 0
    v_mfma_f32_16x16x32_bf16 v[106:109], a[176:179], a[8:11], 0
    v_mfma_f32_16x16x32_bf16 v[78:81], a[180:183], a[0:3], 0
    v_mfma_f32_16x16x32_bf16 v[110:113], a[180:183], a[8:11], 0
    v_mfma_f32_16x16x32_bf16 v[82:85], a[184:187], a[0:3], 0
    v_mfma_f32_16x16x32_bf16 v[114:117], a[184:187], a[8:11], 0
    v_mfma_f32_16x16x32_bf16 v[86:89], a[188:191], a[0:3], 0
    v_mfma_f32_16x16x32_bf16 v[118:121], a[188:191], a[8:11], 0
    s_waitcnt vmcnt(24) lgkmcnt(0)
    s_barrier
    v_mfma_f32_16x16x32_bf16 v[122:125], v[20:23], a[4:7], v[122:125]
    ds_read_b128 a[16:19], v38 offset:30848
    ds_read_b128 a[24:27], v40 offset:30848
    v_mfma_f32_16x16x32_bf16 v[126:129], a[4:7], a[4:7], v[126:129]
    ds_read_b128 a[20:23], v39 offset:30848
    ds_read_b128 a[28:31], v41 offset:30848
    v_mfma_f32_16x16x32_bf16 v[130:133], v[20:23], a[12:15], v[130:133]
    ds_read_b64_tr_b16 a[160:161], v26 offset:30848
    ds_read_b64_tr_b16 a[162:163], v26 offset:31360
    v_mfma_f32_16x16x32_bf16 v[134:137], a[12:15], a[12:15], v[134:137]
    ds_read_b64_tr_b16 a[164:165], v27 offset:30848
    ds_read_b64_tr_b16 a[166:167], v27 offset:31360
    v_mfma_f32_16x16x32_bf16 v[58:61], a[192:195], a[4:7], v[58:61]
    ds_read_b64_tr_b16 a[168:169], v28 offset:30848
    ds_read_b64_tr_b16 a[170:171], v28 offset:31360
    v_mfma_f32_16x16x32_bf16 v[90:93], a[192:195], a[12:15], v[90:93]
    ds_read_b64_tr_b16 a[172:173], v29 offset:30848
    ds_read_b64_tr_b16 a[174:175], v29 offset:31360
    v_mfma_f32_16x16x32_bf16 v[62:65], a[196:199], a[4:7], v[62:65]
    ds_read_b64_tr_b16 a[176:177], v26 offset:39040
    ds_read_b64_tr_b16 a[178:179], v26 offset:39552
    v_mfma_f32_16x16x32_bf16 v[94:97], a[196:199], a[12:15], v[94:97]
    ds_read_b64_tr_b16 a[180:181], v27 offset:39040
    ds_read_b64_tr_b16 a[182:183], v27 offset:39552
    v_mfma_f32_16x16x32_bf16 v[66:69], a[200:203], a[4:7], v[66:69]
    ds_read_b64_tr_b16 a[184:185], v28 offset:39040
    ds_read_b64_tr_b16 a[186:187], v28 offset:39552
    v_mfma_f32_16x16x32_bf16 v[98:101], a[200:203], a[12:15], v[98:101]
    ds_read_b64_tr_b16 a[188:189], v29 offset:39040
    ds_read_b64_tr_b16 a[190:191], v29 offset:39552
    v_mfma_f32_16x16x32_bf16 v[70:73], a[204:207], a[4:7], v[70:73]
    s_add_u32 m0, s81, 0
    s_nop 0
    buffer_load_dwordx4 v18, s[28:31], s75 offen lds
    v_mfma_f32_16x16x32_bf16 v[102:105], a[204:207], a[12:15], v[102:105]
    s_add_u32 m0, s81, 1024
    s_nop 0
    buffer_load_dwordx4 v19, s[28:31], s75 offen lds
    v_mfma_f32_16x16x32_bf16 v[74:77], a[208:211], a[4:7], v[74:77]
    s_add_u32 m0, s55, 0
    s_nop 0
    buffer_load_dwordx4 v14, s[32:35], s65 offen lds
    v_mfma_f32_16x16x32_bf16 v[106:109], a[208:211], a[12:15], v[106:109]
    s_add_u32 m0, s55, 1024
    s_nop 0
    buffer_load_dwordx4 v15, s[32:35], s65 offen lds
    v_mfma_f32_16x16x32_bf16 v[78:81], a[212:215], a[4:7], v[78:81]
    s_add_u32 m0, s55, 8192
    s_nop 0
    buffer_load_dwordx4 v14, s[36:39], s65 offen lds
    v_mfma_f32_16x16x32_bf16 v[110:113], a[212:215], a[12:15], v[110:113]
    s_add_u32 m0, s55, 9216
    s_nop 0
    buffer_load_dwordx4 v15, s[36:39], s65 offen lds
    v_mfma_f32_16x16x32_bf16 v[82:85], a[216:219], a[4:7], v[82:85]
    s_mov_b64 exec, s[82:83]
    s_add_u32 m0, s80, 0
    s_nop 0
    buffer_load_dwordx4 v16, s[28:31], s75 offen lds
    s_add_u32 m0, s80, 1024
    s_nop 0
    buffer_load_dwordx4 v17, s[28:31], s75 offen lds
    s_mov_b64 exec, -1
    v_mfma_f32_16x16x32_bf16 v[114:117], a[216:219], a[12:15], v[114:117]
    v_mfma_f32_16x16x32_bf16 v[86:89], a[220:223], a[4:7], v[86:89]
    v_mfma_f32_16x16x32_bf16 v[118:121], a[220:223], a[12:15], v[118:121]
    s_waitcnt lgkmcnt(0)
    v_mfma_f32_16x16x32_bf16 v[122:125], v[20:23], a[16:19], v[122:125]
    ds_read_b64_tr_b16 a[192:193], v26 offset:34944
    ds_read_b64_tr_b16 a[194:195], v26 offset:35456
    v_mfma_f32_16x16x32_bf16 v[126:129], a[16:19], a[16:19], v[126:129]
    ds_read_b64_tr_b16 a[196:197], v27 offset:34944
    ds_read_b64_tr_b16 a[198:199], v27 offset:35456
    v_mfma_f32_16x16x32_bf16 v[130:133], v[20:23], a[24:27], v[130:133]
    ds_read_b64_tr_b16 a[200:201], v28 offset:34944
    ds_read_b64_tr_b16 a[202:203], v28 offset:35456
    v_mfma_f32_16x16x32_bf16 v[134:137], a[24:27], a[24:27], v[134:137]
    ds_read_b64_tr_b16 a[204:205], v29 offset:34944
    ds_read_b64_tr_b16 a[206:207], v29 offset:35456
    v_mfma_f32_16x16x32_bf16 v[58:61], a[160:163], a[16:19], v[58:61]
    ds_read_b64_tr_b16 a[208:209], v26 offset:43136
    ds_read_b64_tr_b16 a[210:211], v26 offset:43648
    v_mfma_f32_16x16x32_bf16 v[90:93], a[160:163], a[24:27], v[90:93]
    ds_read_b64_tr_b16 a[212:213], v27 offset:43136
    ds_read_b64_tr_b16 a[214:215], v27 offset:43648
    v_mfma_f32_16x16x32_bf16 v[62:65], a[164:167], a[16:19], v[62:65]
    ds_read_b64_tr_b16 a[216:217], v28 offset:43136
    ds_read_b64_tr_b16 a[218:219], v28 offset:43648
    v_mfma_f32_16x16x32_bf16 v[94:97], a[164:167], a[24:27], v[94:97]
    ds_read_b64_tr_b16 a[220:221], v29 offset:43136
    ds_read_b64_tr_b16 a[222:223], v29 offset:43648
    v_mfma_f32_16x16x32_bf16 v[66:69], a[168:171], a[16:19], v[66:69]
    v_mfma_f32_16x16x32_bf16 v[98:101], a[168:171], a[24:27], v[98:101]
    v_mfma_f32_16x16x32_bf16 v[70:73], a[172:175], a[16:19], v[70:73]
    v_mfma_f32_16x16x32_bf16 v[102:105], a[172:175], a[24:27], v[102:105]
    v_mfma_f32_16x16x32_bf16 v[74:77], a[176:179], a[16:19], v[74:77]
    v_mfma_f32_16x16x32_bf16 v[106:109], a[176:179], a[24:27], v[106:109]
    v_mfma_f32_16x16x32_bf16 v[78:81], a[180:183], a[16:19], v[78:81]
    v_mfma_f32_16x16x32_bf16 v[110:113], a[180:183], a[24:27], v[110:113]
    v_mfma_f32_16x16x32_bf16 v[82:85], a[184:187], a[16:19], v[82:85]
    v_mfma_f32_16x16x32_bf16 v[114:117], a[184:187], a[24:27], v[114:117]
    v_mfma_f32_16x16x32_bf16 v[86:89], a[188:191], a[16:19], v[86:89]
    v_mfma_f32_16x16x32_bf16 v[118:121], a[188:191], a[24:27], v[118:121]
    s_waitcnt vmcnt(24) lgkmcnt(0)
    s_barrier
    v_mfma_f32_16x16x32_bf16 v[122:125], v[20:23], a[20:23], v[122:125]
    ds_read_b128 a[32:35], v42 offset:0
    ds_read_b128 a[40:43], v44 offset:0
    v_mfma_f32_16x16x32_bf16 v[126:129], a[20:23], a[20:23], v[126:129]
    ds_read_b128 a[36:39], v43 offset:0
    ds_read_b128 a[44:47], v45 offset:0
    v_mfma_f32_16x16x32_bf16 v[130:133], v[20:23], a[28:31], v[130:133]
    ds_read_b64_tr_b16 a[160:161], v30 offset:0
    ds_read_b64_tr_b16 a[162:163], v30 offset:512
    v_mfma_f32_16x16x32_bf16 v[134:137], a[28:31], a[28:31], v[134:137]
    ds_read_b64_tr_b16 a[164:165], v31 offset:0
    ds_read_b64_tr_b16 a[166:167], v31 offset:512
    v_mfma_f32_16x16x32_bf16 v[58:61], a[192:195], a[20:23], v[58:61]
    ds_read_b64_tr_b16 a[168:169], v32 offset:0
    ds_read_b64_tr_b16 a[170:171], v32 offset:512
    v_mfma_f32_16x16x32_bf16 v[90:93], a[192:195], a[28:31], v[90:93]
    ds_read_b64_tr_b16 a[172:173], v33 offset:0
    ds_read_b64_tr_b16 a[174:175], v33 offset:512
    v_mfma_f32_16x16x32_bf16 v[62:65], a[196:199], a[20:23], v[62:65]
    ds_read_b64_tr_b16 a[176:177], v30 offset:8192
    ds_read_b64_tr_b16 a[178:179], v30 offset:8704
    v_mfma_f32_16x16x32_bf16 v[94:97], a[196:199], a[28:31], v[94:97]
    ds_read_b64_tr_b16 a[180:181], v31 offset:8192
    ds_read_b64_tr_b16 a[182:183], v31 offset:8704
    v_mfma_f32_16x16x32_bf16 v[66:69], a[200:203], a[20:23], v[66:69]
    ds_read_b64_tr_b16 a[184:185], v32 offset:8192
    ds_read_b64_tr_b16 a[186:187], v32 offset:8704
    v_mfma_f32_16x16x32_bf16 v[98:101], a[200:203], a[28:31], v[98:101]
    ds_read_b64_tr_b16 a[188:189], v33 offset:8192
    ds_read_b64_tr_b16 a[190:191], v33 offset:8704
    v_mfma_f32_16x16x32_bf16 v[70:73], a[204:207], a[20:23], v[70:73]
    s_add_u32 m0, s81, 30848
    s_nop 0
    buffer_load_dwordx4 v18, s[28:31], s76 offen lds
    v_mfma_f32_16x16x32_bf16 v[102:105], a[204:207], a[28:31], v[102:105]
    s_add_u32 m0, s81, 31872
    s_nop 0
    buffer_load_dwordx4 v19, s[28:31], s76 offen lds
    v_mfma_f32_16x16x32_bf16 v[74:77], a[208:211], a[20:23], v[74:77]
    s_add_u32 m0, s55, 30848
    s_nop 0
    buffer_load_dwordx4 v14, s[32:35], s66 offen lds
    v_mfma_f32_16x16x32_bf16 v[106:109], a[208:211], a[28:31], v[106:109]
    s_add_u32 m0, s55, 31872
    s_nop 0
    buffer_load_dwordx4 v15, s[32:35], s66 offen lds
    v_mfma_f32_16x16x32_bf16 v[78:81], a[212:215], a[20:23], v[78:81]
    s_add_u32 m0, s55, 39040
    s_nop 0
    buffer_load_dwordx4 v14, s[36:39], s66 offen lds
    v_mfma_f32_16x16x32_bf16 v[110:113], a[212:215], a[28:31], v[110:113]
    s_add_u32 m0, s55, 40064
    s_nop 0
    buffer_load_dwordx4 v15, s[36:39], s66 offen lds
    v_mfma_f32_16x16x32_bf16 v[82:85], a[216:219], a[20:23], v[82:85]
    s_mov_b64 exec, s[82:83]
    s_add_u32 m0, s80, 30848
    s_nop 0
    buffer_load_dwordx4 v16, s[28:31], s76 offen lds
    s_add_u32 m0, s80, 31872
    s_nop 0
    buffer_load_dwordx4 v17, s[28:31], s76 offen lds
    s_mov_b64 exec, -1
    v_mfma_f32_16x16x32_bf16 v[114:117], a[216:219], a[28:31], v[114:117]
    v_mfma_f32_16x16x32_bf16 v[86:89], a[220:223], a[20:23], v[86:89]
    v_mfma_f32_16x16x32_bf16 v[118:121], a[220:223], a[28:31], v[118:121]
    s_waitcnt lgkmcnt(0)
    v_mfma_f32_16x16x32_bf16 v[122:125], v[20:23], a[32:35], v[122:125]
    ds_read_b64_tr_b16 a[192:193], v30 offset:4096
    ds_read_b64_tr_b16 a[194:195], v30 offset:4608
    v_mfma_f32_16x16x32_bf16 v[126:129], a[32:35], a[32:35], v[126:129]
    ds_read_b64_tr_b16 a[196:197], v31 offset:4096
    ds_read_b64_tr_b16 a[198:199], v31 offset:4608
    v_mfma_f32_16x16x32_bf16 v[130:133], v[20:23], a[40:43], v[130:133]
    ds_read_b64_tr_b16 a[200:201], v32 offset:4096
    ds_read_b64_tr_b16 a[202:203], v32 offset:4608
    v_mfma_f32_16x16x32_bf16 v[134:137], a[40:43], a[40:43], v[134:137]
    ds_read_b64_tr_b16 a[204:205], v33 offset:4096
    ds_read_b64_tr_b16 a[206:207], v33 offset:4608
    v_mfma_f32_16x16x32_bf16 v[58:61], a[160:163], a[32:35], v[58:61]
    ds_read_b64_tr_b16 a[208:209], v30 offset:12288
    ds_read_b64_tr_b16 a[210:211], v30 offset:12800
    v_mfma_f32_16x16x32_bf16 v[90:93], a[160:163], a[40:43], v[90:93]
    ds_read_b64_tr_b16 a[212:213], v31 offset:12288
    ds_read_b64_tr_b16 a[214:215], v31 offset:12800
    v_mfma_f32_16x16x32_bf16 v[62:65], a[164:167], a[32:35], v[62:65]
    ds_read_b64_tr_b16 a[216:217], v32 offset:12288
    ds_read_b64_tr_b16 a[218:219], v32 offset:12800
    v_mfma_f32_16x16x32_bf16 v[94:97], a[164:167], a[40:43], v[94:97]
    ds_read_b64_tr_b16 a[220:221], v33 offset:12288
    ds_read_b64_tr_b16 a[222:223], v33 offset:12800
    v_mfma_f32_16x16x32_bf16 v[66:69], a[168:171], a[32:35], v[66:69]
    v_mfma_f32_16x16x32_bf16 v[98:101], a[168:171], a[40:43], v[98:101]
    v_mfma_f32_16x16x32_bf16 v[70:73], a[172:175], a[32:35], v[70:73]
    v_mfma_f32_16x16x32_bf16 v[102:105], a[172:175], a[40:43], v[102:105]
    v_mfma_f32_16x16x32_bf16 v[74:77], a[176:179], a[32:35], v[74:77]
    v_mfma_f32_16x16x32_bf16 v[106:109], a[176:179], a[40:43], v[106:109]
    v_mfma_f32_16x16x32_bf16 v[78:81], a[180:183], a[32:35], v[78:81]
    v_mfma_f32_16x16x32_bf16 v[110:113], a[180:183], a[40:43], v[110:113]
    v_mfma_f32_16x16x32_bf16 v[82:85], a[184:187], a[32:35], v[82:85]
    v_mfma_f32_16x16x32_bf16 v[114:117], a[184:187], a[40:43], v[114:117]
    v_mfma_f32_16x16x32_bf16 v[86:89], a[188:191], a[32:35], v[86:89]
    v_mfma_f32_16x16x32_bf16 v[118:121], a[188:191], a[40:43], v[118:121]
    s_waitcnt vmcnt(24) lgkmcnt(0)
    s_barrier
    v_mfma_f32_16x16x32_bf16 v[122:125], v[20:23], a[36:39], v[122:125]
    ds_read_b128 a[48:51], v42 offset:30848
    ds_read_b128 a[56:59], v44 offset:30848
    v_mfma_f32_16x16x32_bf16 v[126:129], a[36:39], a[36:39], v[126:129]
    ds_read_b128 a[52:55], v43 offset:30848
    ds_read_b128 a[60:63], v45 offset:30848
    v_mfma_f32_16x16x32_bf16 v[130:133], v[20:23], a[44:47], v[130:133]
    ds_read_b64_tr_b16 a[160:161], v30 offset:30848
    ds_read_b64_tr_b16 a[162:163], v30 offset:31360
    v_mfma_f32_16x16x32_bf16 v[134:137], a[44:47], a[44:47], v[134:137]
    ds_read_b64_tr_b16 a[164:165], v31 offset:30848
    ds_read_b64_tr_b16 a[166:167], v31 offset:31360
    v_mfma_f32_16x16x32_bf16 v[58:61], a[192:195], a[36:39], v[58:61]
    ds_read_b64_tr_b16 a[168:169], v32 offset:30848
    ds_read_b64_tr_b16 a[170:171], v32 offset:31360
    v_mfma_f32_16x16x32_bf16 v[90:93], a[192:195], a[44:47], v[90:93]
    ds_read_b64_tr_b16 a[172:173], v33 offset:30848
    ds_read_b64_tr_b16 a[174:175], v33 offset:31360
    v_mfma_f32_16x16x32_bf16 v[62:65], a[196:199], a[36:39], v[62:65]
    ds_read_b64_tr_b16 a[176:177], v30 offset:39040
    ds_read_b64_tr_b16 a[178:179], v30 offset:39552
    v_mfma_f32_16x16x32_bf16 v[94:97], a[196:199], a[44:47], v[94:97]
    ds_read_b64_tr_b16 a[180:181], v31 offset:39040
    ds_read_b64_tr_b16 a[182:183], v31 offset:39552
    v_mfma_f32_16x16x32_bf16 v[66:69], a[200:203], a[36:39], v[66:69]
    ds_read_b64_tr_b16 a[184:185], v32 offset:39040
    ds_read_b64_tr_b16 a[186:187], v32 offset:39552
    v_mfma_f32_16x16x32_bf16 v[98:101], a[200:203], a[44:47], v[98:101]
    ds_read_b64_tr_b16 a[188:189], v33 offset:39040
    ds_read_b64_tr_b16 a[190:191], v33 offset:39552
    v_mfma_f32_16x16x32_bf16 v[70:73], a[204:207], a[36:39], v[70:73]
    s_add_u32 m0, s81, 61696
    s_nop 0
    buffer_load_dwordx4 v18, s[28:31], s77 offen lds
    v_mfma_f32_16x16x32_bf16 v[102:105], a[204:207], a[44:47], v[102:105]
    s_add_u32 m0, s81, 62720
    s_nop 0
    buffer_load_dwordx4 v19, s[28:31], s77 offen lds
    v_mfma_f32_16x16x32_bf16 v[74:77], a[208:211], a[36:39], v[74:77]
    s_add_u32 m0, s55, 61696
    s_nop 0
    buffer_load_dwordx4 v14, s[32:35], s67 offen lds
    v_mfma_f32_16x16x32_bf16 v[106:109], a[208:211], a[44:47], v[106:109]
    s_add_u32 m0, s55, 62720
    s_nop 0
    buffer_load_dwordx4 v15, s[32:35], s67 offen lds
    v_mfma_f32_16x16x32_bf16 v[78:81], a[212:215], a[36:39], v[78:81]
    s_add_u32 m0, s55, 69888
    s_nop 0
    buffer_load_dwordx4 v14, s[36:39], s67 offen lds
    v_mfma_f32_16x16x32_bf16 v[110:113], a[212:215], a[44:47], v[110:113]
    s_add_u32 m0, s55, 70912
    s_nop 0
    buffer_load_dwordx4 v15, s[36:39], s67 offen lds
    v_mfma_f32_16x16x32_bf16 v[82:85], a[216:219], a[36:39], v[82:85]
    s_mov_b64 exec, s[82:83]
    s_add_u32 m0, s80, 61696
    s_nop 0
    buffer_load_dwordx4 v16, s[28:31], s77 offen lds
    s_add_u32 m0, s80, 62720
    s_nop 0
    buffer_load_dwordx4 v17, s[28:31], s77 offen lds
    s_mov_b64 exec, -1
    v_mfma_f32_16x16x32_bf16 v[114:117], a[216:219], a[44:47], v[114:117]
    v_mfma_f32_16x16x32_bf16 v[86:89], a[220:223], a[36:39], v[86:89]
    v_mfma_f32_16x16x32_bf16 v[118:121], a[220:223], a[44:47], v[118:121]
    s_waitcnt lgkmcnt(0)
    v_mfma_f32_16x16x32_bf16 v[122:125], v[20:23], a[48:51], v[122:125]
    ds_read_b64_tr_b16 a[192:193], v30 offset:34944
    ds_read_b64_tr_b16 a[194:195], v30 offset:35456
    v_mfma_f32_16x16x32_bf16 v[126:129], a[48:51], a[48:51], v[126:129]
    ds_read_b64_tr_b16 a[196:197], v31 offset:34944
    ds_read_b64_tr_b16 a[198:199], v31 offset:35456
    v_mfma_f32_16x16x32_bf16 v[130:133], v[20:23], a[56:59], v[130:133]
    ds_read_b64_tr_b16 a[200:201], v32 offset:34944
    ds_read_b64_tr_b16 a[202:203], v32 offset:35456
    v_mfma_f32_16x16x32_bf16 v[134:137], a[56:59], a[56:59], v[134:137]
    ds_read_b64_tr_b16 a[204:205], v33 offset:34944
    ds_read_b64_tr_b16 a[206:207], v33 offset:35456
    v_mfma_f32_16x16x32_bf16 v[58:61], a[160:163], a[48:51], v[58:61]
    ds_read_b64_tr_b16 a[208:209], v30 offset:43136
    ds_read_b64_tr_b16 a[210:211], v30 offset:43648
    v_mfma_f32_16x16x32_bf16 v[90:93], a[160:163], a[56:59], v[90:93]
    ds_read_b64_tr_b16 a[212:213], v31 offset:43136
    ds_read_b64_tr_b16 a[214:215], v31 offset:43648
    v_mfma_f32_16x16x32_bf16 v[62:65], a[164:167], a[48:51], v[62:65]
    ds_read_b64_tr_b16 a[216:217], v32 offset:43136
    ds_read_b64_tr_b16 a[218:219], v32 offset:43648
    v_mfma_f32_16x16x32_bf16 v[94:97], a[164:167], a[56:59], v[94:97]
    ds_read_b64_tr_b16 a[220:221], v33 offset:43136
    ds_read_b64_tr_b16 a[222:223], v33 offset:43648
    v_mfma_f32_16x16x32_bf16 v[66:69], a[168:171], a[48:51], v[66:69]
    v_mfma_f32_16x16x32_bf16 v[98:101], a[168:171], a[56:59], v[98:101]
    v_mfma_f32_16x16x32_bf16 v[70:73], a[172:175], a[48:51], v[70:73]
    v_mfma_f32_16x16x32_bf16 v[102:105], a[172:175], a[56:59], v[102:105]
    v_mfma_f32_16x16x32_bf16 v[74:77], a[176:179], a[48:51], v[74:77]
    v_mfma_f32_16x16x32_bf16 v[106:109], a[176:179], a[56:59], v[106:109]
    v_mfma_f32_16x16x32_bf16 v[78:81], a[180:183], a[48:51], v[78:81]
    v_mfma_f32_16x16x32_bf16 v[110:113], a[180:183], a[56:59], v[110:113]
    v_mfma_f32_16x16x32_bf16 v[82:85], a[184:187], a[48:51], v[82:85]
    v_mfma_f32_16x16x32_bf16 v[114:117], a[184:187], a[56:59], v[114:117]
    v_mfma_f32_16x16x32_bf16 v[86:89], a[188:191], a[48:51], v[86:89]
    v_mfma_f32_16x16x32_bf16 v[118:121], a[188:191], a[56:59], v[118:121]
    s_waitcnt vmcnt(24) lgkmcnt(0)
    s_barrier
    v_mfma_f32_16x16x32_bf16 v[122:125], v[20:23], a[52:55], v[122:125]
    ds_read_b128 a[64:67], v46 offset:0
    ds_read_b128 a[72:75], v48 offset:0
    v_mfma_f32_16x16x32_bf16 v[126:129], a[52:55], a[52:55], v[126:129]
    ds_read_b128 a[68:71], v47 offset:0
    ds_read_b128 a[76:79], v49 offset:0
    v_mfma_f32_16x16x32_bf16 v[130:133], v[20:23], a[60:63], v[130:133]
    ds_read_b64_tr_b16 a[160:161], v34 offset:0
    ds_read_b64_tr_b16 a[162:163], v34 offset:512
    v_mfma_f32_16x16x32_bf16 v[134:137], a[60:63], a[60:63], v[134:137]
    ds_read_b64_tr_b16 a[164:165], v35 offset:0
    ds_read_b64_tr_b16 a[166:167], v35 offset:512
    v_mfma_f32_16x16x32_bf16 v[58:61], a[192:195], a[52:55], v[58:61]
    ds_read_b64_tr_b16 a[168:169], v36 offset:0
    ds_read_b64_tr_b16 a[170:171], v36 offset:512
    v_mfma_f32_16x16x32_bf16 v[90:93], a[192:195], a[60:63], v[90:93]
    ds_read_b64_tr_b16 a[172:173], v37 offset:0
    ds_read_b64_tr_b16 a[174:175], v37 offset:512
    v_mfma_f32_16x16x32_bf16 v[62:65], a[196:199], a[52:55], v[62:65]
    ds_read_b64_tr_b16 a[176:177], v34 offset:8192
    ds_read_b64_tr_b16 a[178:179], v34 offset:8704
    v_mfma_f32_16x16x32_bf16 v[94:97], a[196:199], a[60:63], v[94:97]
    ds_read_b64_tr_b16 a[180:181], v35 offset:8192
    ds_read_b64_tr_b16 a[182:183], v35 offset:8704
    v_mfma_f32_16x16x32_bf16 v[66:69], a[200:203], a[52:55], v[66:69]
    ds_read_b64_tr_b16 a[184:185], v36 offset:8192
    ds_read_b64_tr_b16 a[186:187], v36 offset:8704
    v_mfma_f32_16x16x32_bf16 v[98:101], a[200:203], a[60:63], v[98:101]
    ds_read_b64_tr_b16 a[188:189], v37 offset:8192
    ds_read_b64_tr_b16 a[190:191], v37 offset:8704
    v_mfma_f32_16x16x32_bf16 v[70:73], a[204:207], a[52:55], v[70:73]
    s_add_u32 m0, s81, 92544
    s_nop 0
    buffer_load_dwordx4 v18, s[28:31], s78 offen lds
    v_mfma_f32_16x16x32_bf16 v[102:105], a[204:207], a[60:63], v[102:105]
    s_add_u32 m0, s81, 93568
    s_nop 0
    buffer_load_dwordx4 v19, s[28:31], s78 offen lds
    v_mfma_f32_16x16x32_bf16 v[74:77], a[208:211], a[52:55], v[74:77]
    s_add_u32 m0, s55, 92544
    s_nop 0
    buffer_load_dwordx4 v14, s[32:35], s68 offen lds
    v_mfma_f32_16x16x32_bf16 v[106:109], a[208:211], a[60:63], v[106:109]
    s_add_u32 m0, s55, 93568
    s_nop 0
    buffer_load_dwordx4 v15, s[32:35], s68 offen lds
    v_mfma_f32_16x16x32_bf16 v[78:81], a[212:215], a[52:55], v[78:81]
    s_add_u32 m0, s55, 100736
    s_nop 0
    buffer_load_dwordx4 v14, s[36:39], s68 offen lds
    v_mfma_f32_16x16x32_bf16 v[110:113], a[212:215], a[60:63], v[110:113]
    s_add_u32 m0, s55, 101760
    s_nop 0
    buffer_load_dwordx4 v15, s[36:39], s68 offen lds
    v_mfma_f32_16x16x32_bf16 v[82:85], a[216:219], a[52:55], v[82:85]
    s_mov_b64 exec, s[82:83]
    s_add_u32 m0, s80, 92544
    s_nop 0
    buffer_load_dwordx4 v16, s[28:31], s78 offen lds
    s_add_u32 m0, s80, 93568
    s_nop 0
    buffer_load_dwordx4 v17, s[28:31], s78 offen lds
    s_mov_b64 exec, -1
    v_mfma_f32_16x16x32_bf16 v[114:117], a[216:219], a[60:63], v[114:117]
    v_mfma_f32_16x16x32_bf16 v[86:89], a[220:223], a[52:55], v[86:89]
    v_mfma_f32_16x16x32_bf16 v[118:121], a[220:223], a[60:63], v[118:121]
    s_waitcnt lgkmcnt(0)
    v_mfma_f32_16x16x32_bf16 v[122:125], v[20:23], a[64:67], v[122:125]
    ds_read_b64_tr_b16 a[192:193], v34 offset:4096
    ds_read_b64_tr_b16 a[194:195], v34 offset:4608
    v_mfma_f32_16x16x32_bf16 v[126:129], a[64:67], a[64:67], v[126:129]
    ds_read_b64_tr_b16 a[196:197], v35 offset:4096
    ds_read_b64_tr_b16 a[198:199], v35 offset:4608
    v_mfma_f32_16x16x32_bf16 v[130:133], v[20:23], a[72:75], v[130:133]
    ds_read_b64_tr_b16 a[200:201], v36 offset:4096
    ds_read_b64_tr_b16 a[202:203], v36 offset:4608
    v_mfma_f32_16x16x32_bf16 v[134:137], a[72:75], a[72:75], v[134:137]
    ds_read_b64_tr_b16 a[204:205], v37 offset:4096
    ds_read_b64_tr_b16 a[206:207], v37 offset:4608
    v_mfma_f32_16x16x32_bf16 v[58:61], a[160:163], a[64:67], v[58:61]
    ds_read_b64_tr_b16 a[208:209], v34 offset:12288
    ds_read_b64_tr_b16 a[210:211], v34 offset:12800
    v_mfma_f32_16x16x32_bf16 v[90:93], a[160:163], a[72:75], v[90:93]
    ds_read_b64_tr_b16 a[212:213], v35 offset:12288
    ds_read_b64_tr_b16 a[214:215], v35 offset:12800
    v_mfma_f32_16x16x32_bf16 v[62:65], a[164:167], a[64:67], v[62:65]
    ds_read_b64_tr_b16 a[216:217], v36 offset:12288
    ds_read_b64_tr_b16 a[218:219], v36 offset:12800
    v_mfma_f32_16x16x32_bf16 v[94:97], a[164:167], a[72:75], v[94:97]
    ds_read_b64_tr_b16 a[220:221], v37 offset:12288
    ds_read_b64_tr_b16 a[222:223], v37 offset:12800
    v_mfma_f32_16x16x32_bf16 v[66:69], a[168:171], a[64:67], v[66:69]
    v_mfma_f32_16x16x32_bf16 v[98:101], a[168:171], a[72:75], v[98:101]
    v_mfma_f32_16x16x32_bf16 v[70:73], a[172:175], a[64:67], v[70:73]
    v_mfma_f32_16x16x32_bf16 v[102:105], a[172:175], a[72:75], v[102:105]
    v_mfma_f32_16x16x32_bf16 v[74:77], a[176:179], a[64:67], v[74:77]
    v_mfma_f32_16x16x32_bf16 v[106:109], a[176:179], a[72:75], v[106:109]
    v_mfma_f32_16x16x32_bf16 v[78:81], a[180:183], a[64:67], v[78:81]
    v_mfma_f32_16x16x32_bf16 v[110:113], a[180:183], a[72:75], v[110:113]
    v_mfma_f32_16x16x32_bf16 v[82:85], a[184:187], a[64:67], v[82:85]
    v_mfma_f32_16x16x32_bf16 v[114:117], a[184:187], a[72:75], v[114:117]
    v_mfma_f32_16x16x32_bf16 v[86:89], a[188:191], a[64:67], v[86:89]
    v_mfma_f32_16x16x32_bf16 v[118:121], a[188:191], a[72:75], v[118:121]
    s_waitcnt vmcnt(24) lgkmcnt(0)
    s_barrier
    v_mfma_f32_16x16x32_bf16 v[122:125], v[20:23], a[68:71], v[122:125]
    ds_read_b128 a[80:83], v38 offset:0
    ds_read_b128 a[88:91], v40 offset:0
    v_mfma_f32_16x16x32_bf16 v[126:129], a[68:71], a[68:71], v[126:129]
    ds_read_b128 a[84:87], v39 offset:0
    ds_read_b128 a[92:95], v41 offset:0
    v_mfma_f32_16x16x32_bf16 v[130:133], v[20:23], a[76:79], v[130:133]
    ds_read_b64_tr_b16 a[160:161], v26 offset:0
    ds_read_b64_tr_b16 a[162:163], v26 offset:512
    v_mfma_f32_16x16x32_bf16 v[134:137], a[76:79], a[76:79], v[134:137]
    ds_read_b64_tr_b16 a[164:165], v27 offset:0
    ds_read_b64_tr_b16 a[166:167], v27 offset:512
    v_mfma_f32_16x16x32_bf16 v[58:61], a[192:195], a[68:71], v[58:61]
    ds_read_b64_tr_b16 a[168:169], v28 offset:0
    ds_read_b64_tr_b16 a[170:171], v28 offset:512
    v_mfma_f32_16x16x32_bf16 v[90:93], a[192:195], a[76:79], v[90:93]
    ds_read_b64_tr_b16 a[172:173], v29 offset:0
    ds_read_b64_tr_b16 a[174:175], v29 offset:512
    v_mfma_f32_16x16x32_bf16 v[62:65], a[196:199], a[68:71], v[62:65]
    ds_read_b64_tr_b16 a[176:177], v26 offset:8192
    ds_read_b64_tr_b16 a[178:179], v26 offset:8704
    v_mfma_f32_16x16x32_bf16 v[94:97], a[196:199], a[76:79], v[94:97]
    ds_read_b64_tr_b16 a[180:181], v27 offset:8192
    ds_read_b64_tr_b16 a[182:183], v27 offset:8704
    v_mfma_f32_16x16x32_bf16 v[66:69], a[200:203], a[68:71], v[66:69]
    ds_read_b64_tr_b16 a[184:185], v28 offset:8192
    ds_read_b64_tr_b16 a[186:187], v28 offset:8704
    v_mfma_f32_16x16x32_bf16 v[98:101], a[200:203], a[76:79], v[98:101]
    ds_read_b64_tr_b16 a[188:189], v29 offset:8192
    ds_read_b64_tr_b16 a[190:191], v29 offset:8704
    v_mfma_f32_16x16x32_bf16 v[70:73], a[204:207], a[68:71], v[70:73]
    s_add_u32 m0, s81, 123392
    s_nop 0
    buffer_load_dwordx4 v18, s[28:31], s79 offen lds
    v_mfma_f32_16x16x32_bf16 v[102:105], a[204:207], a[76:79], v[102:105]
    s_add_u32 m0, s81, 124416
    s_nop 0
    buffer_load_dwordx4 v19, s[28:31], s79 offen lds
    v_mfma_f32_16x16x32_bf16 v[74:77], a[208:211], a[68:71], v[74:77]
    s_add_u32 m0, s55, 123392
    s_nop 0
    buffer_load_dwordx4 v14, s[32:35], s69 offen lds
    v_mfma_f32_16x16x32_bf16 v[106:109], a[208:211], a[76:79], v[106:109]
    s_add_u32 m0, s55, 124416
    s_nop 0
    buffer_load_dwordx4 v15, s[32:35], s69 offen lds
    v_mfma_f32_16x16x32_bf16 v[78:81], a[212:215], a[68:71], v[78:81]
    s_add_u32 m0, s55, 131584
    s_nop 0
    buffer_load_dwordx4 v14, s[36:39], s69 offen lds
    v_mfma_f32_16x16x32_bf16 v[110:113], a[212:215], a[76:79], v[110:113]
    s_add_u32 m0, s55, 132608
    s_nop 0
    buffer_load_dwordx4 v15, s[36:39], s69 offen lds
    v_mfma_f32_16x16x32_bf16 v[82:85], a[216:219], a[68:71], v[82:85]
    s_mov_b64 exec, s[82:83]
    s_add_u32 m0, s80, 123392
    s_nop 0
    buffer_load_dwordx4 v16, s[28:31], s79 offen lds
    s_add_u32 m0, s80, 124416
    s_nop 0
    buffer_load_dwordx4 v17, s[28:31], s79 offen lds
    s_mov_b64 exec, -1
    v_mfma_f32_16x16x32_bf16 v[114:117], a[216:219], a[76:79], v[114:117]
    v_mfma_f32_16x16x32_bf16 v[86:89], a[220:223], a[68:71], v[86:89]
    v_mfma_f32_16x16x32_bf16 v[118:121], a[220:223], a[76:79], v[118:121]
    s_waitcnt lgkmcnt(0)
    v_mfma_f32_16x16x32_bf16 v[122:125], v[20:23], a[80:83], v[122:125]
    ds_read_b64_tr_b16 a[192:193], v26 offset:4096
    ds_read_b64_tr_b16 a[194:195], v26 offset:4608
    v_mfma_f32_16x16x32_bf16 v[126:129], a[80:83], a[80:83], v[126:129]
    ds_read_b64_tr_b16 a[196:197], v27 offset:4096
    ds_read_b64_tr_b16 a[198:199], v27 offset:4608
    v_mfma_f32_16x16x32_bf16 v[130:133], v[20:23], a[88:91], v[130:133]
    ds_read_b64_tr_b16 a[200:201], v28 offset:4096
    ds_read_b64_tr_b16 a[202:203], v28 offset:4608
    v_mfma_f32_16x16x32_bf16 v[134:137], a[88:91], a[88:91], v[134:137]
    ds_read_b64_tr_b16 a[204:205], v29 offset:4096
    ds_read_b64_tr_b16 a[206:207], v29 offset:4608
    v_mfma_f32_16x16x32_bf16 v[58:61], a[160:163], a[80:83], v[58:61]
    ds_read_b64_tr_b16 a[208:209], v26 offset:12288
    ds_read_b64_tr_b16 a[210:211], v26 offset:12800
    v_mfma_f32_16x16x32_bf16 v[90:93], a[160:163], a[88:91], v[90:93]
    ds_read_b64_tr_b16 a[212:213], v27 offset:12288
    ds_read_b64_tr_b16 a[214:215], v27 offset:12800
    v_mfma_f32_16x16x32_bf16 v[62:65], a[164:167], a[80:83], v[62:65]
    ds_read_b64_tr_b16 a[216:217], v28 offset:12288
    ds_read_b64_tr_b16 a[218:219], v28 offset:12800
    v_mfma_f32_16x16x32_bf16 v[94:97], a[164:167], a[88:91], v[94:97]
    ds_read_b64_tr_b16 a[220:221], v29 offset:12288
    ds_read_b64_tr_b16 a[222:223], v29 offset:12800
    v_mfma_f32_16x16x32_bf16 v[66:69], a[168:171], a[80:83], v[66:69]
    v_mfma_f32_16x16x32_bf16 v[98:101], a[168:171], a[88:91], v[98:101]
    v_mfma_f32_16x16x32_bf16 v[70:73], a[172:175], a[80:83], v[70:73]
    v_mfma_f32_16x16x32_bf16 v[102:105], a[172:175], a[88:91], v[102:105]
    v_mfma_f32_16x16x32_bf16 v[74:77], a[176:179], a[80:83], v[74:77]
    v_mfma_f32_16x16x32_bf16 v[106:109], a[176:179], a[88:91], v[106:109]
    v_mfma_f32_16x16x32_bf16 v[78:81], a[180:183], a[80:83], v[78:81]
    v_mfma_f32_16x16x32_bf16 v[110:113], a[180:183], a[88:91], v[110:113]
    v_mfma_f32_16x16x32_bf16 v[82:85], a[184:187], a[80:83], v[82:85]
    v_mfma_f32_16x16x32_bf16 v[114:117], a[184:187], a[88:91], v[114:117]
    v_mfma_f32_16x16x32_bf16 v[86:89], a[188:191], a[80:83], v[86:89]
    v_mfma_f32_16x16x32_bf16 v[118:121], a[188:191], a[88:91], v[118:121]
    s_waitcnt vmcnt(24) lgkmcnt(0)
    s_barrier
    v_mfma_f32_16x16x32_bf16 v[122:125], v[20:23], a[84:87], v[122:125]
    ds_read_b128 a[96:99], v38 offset:30848
    ds_read_b128 a[104:107], v40 offset:30848
    v_mfma_f32_16x16x32_bf16 v[126:129], a[84:87], a[84:87], v[126:129]
    ds_read_b128 a[100:103], v39 offset:30848
    ds_read_b128 a[108:111], v41 offset:30848
    v_mfma_f32_16x16x32_bf16 v[130:133], v[20:23], a[92:95], v[130:133]
    ds_read_b64_tr_b16 a[160:161], v26 offset:30848
    ds_read_b64_tr_b16 a[162:163], v26 offset:31360
    v_mfma_f32_16x16x32_bf16 v[134:137], a[92:95], a[92:95], v[134:137]
    ds_read_b64_tr_b16 a[164:165], v27 offset:30848
    ds_read_b64_tr_b16 a[166:167], v27 offset:31360
    v_mfma_f32_16x16x32_bf16 v[58:61], a[192:195], a[84:87], v[58:61]
    ds_read_b64_tr_b16 a[168:169], v28 offset:30848
    ds_read_b64_tr_b16 a[170:171], v28 offset:31360
    v_mfma_f32_16x16x32_bf16 v[90:93], a[192:195], a[92:95], v[90:93]
    ds_read_b64_tr_b16 a[172:173], v29 offset:30848
    ds_read_b64_tr_b16 a[174:175], v29 offset:31360
    v_mfma_f32_16x16x32_bf16 v[62:65], a[196:199], a[84:87], v[62:65]
    ds_read_b64_tr_b16 a[176:177], v26 offset:39040
    ds_read_b64_tr_b16 a[178:179], v26 offset:39552
    v_mfma_f32_16x16x32_bf16 v[94:97], a[196:199], a[92:95], v[94:97]
    ds_read_b64_tr_b16 a[180:181], v27 offset:39040
    ds_read_b64_tr_b16 a[182:183], v27 offset:39552
    v_mfma_f32_16x16x32_bf16 v[66:69], a[200:203], a[84:87], v[66:69]
    ds_read_b64_tr_b16 a[184:185], v28 offset:39040
    ds_read_b64_tr_b16 a[186:187], v28 offset:39552
    v_mfma_f32_16x16x32_bf16 v[98:101], a[200:203], a[92:95], v[98:101]
    ds_read_b64_tr_b16 a[188:189], v29 offset:39040
    ds_read_b64_tr_b16 a[190:191], v29 offset:39552
    v_mfma_f32_16x16x32_bf16 v[70:73], a[204:207], a[84:87], v[70:73]
    v_mov_b32 v57, 192
    buffer_load_dword v57, v57, s[48:51], 0 offen sc1
    v_mfma_f32_16x16x32_bf16 v[102:105], a[204:207], a[92:95], v[102:105]
    s_add_u32 m0, s55, 0
    s_nop 0
    buffer_load_dwordx4 v14, s[40:43], s60 offen lds
    v_mfma_f32_16x16x32_bf16 v[74:77], a[208:211], a[84:87], v[74:77]
    s_add_u32 m0, s55, 1024
    s_nop 0
    buffer_load_dwordx4 v15, s[40:43], s60 offen lds
    v_mfma_f32_16x16x32_bf16 v[106:109], a[208:211], a[92:95], v[106:109]
    s_add_u32 m0, s55, 8192
    s_nop 0
    buffer_load_dwordx4 v14, s[40:43], s61 offen lds
    v_mfma_f32_16x16x32_bf16 v[78:81], a[212:215], a[84:87], v[78:81]
    s_add_u32 m0, s55, 9216
    s_nop 0
    buffer_load_dwordx4 v15, s[40:43], s61 offen lds
    v_mfma_f32_16x16x32_bf16 v[110:113], a[212:215], a[92:95], v[110:113]
    s_add_u32 m0, s55, 16384
    s_nop 0
    buffer_load_dwordx4 v14, s[40:43], s62 offen lds
    v_mfma_f32_16x16x32_bf16 v[82:85], a[216:219], a[84:87], v[82:85]
    s_add_u32 m0, s55, 17408
    s_nop 0
    buffer_load_dwordx4 v15, s[40:43], s62 offen lds
    v_mfma_f32_16x16x32_bf16 v[114:117], a[216:219], a[92:95], v[114:117]
    v_mfma_f32_16x16x32_bf16 v[86:89], a[220:223], a[84:87], v[86:89]
    v_mfma_f32_16x16x32_bf16 v[118:121], a[220:223], a[92:95], v[118:121]
    s_waitcnt lgkmcnt(0)
    v_mfma_f32_16x16x32_bf16 v[122:125], v[20:23], a[96:99], v[122:125]
    ds_read_b64_tr_b16 a[192:193], v26 offset:34944
    ds_read_b64_tr_b16 a[194:195], v26 offset:35456
    v_mfma_f32_16x16x32_bf16 v[126:129], a[96:99], a[96:99], v[126:129]
    ds_read_b64_tr_b16 a[196:197], v27 offset:34944
    ds_read_b64_tr_b16 a[198:199], v27 offset:35456
    v_mfma_f32_16x16x32_bf16 v[130:133], v[20:23], a[104:107], v[130:133]
    ds_read_b64_tr_b16 a[200:201], v28 offset:34944
    ds_read_b64_tr_b16 a[202:203], v28 offset:35456
    v_mfma_f32_16x16x32_bf16 v[134:137], a[104:107], a[104:107], v[134:137]
    ds_read_b64_tr_b16 a[204:205], v29 offset:34944
    ds_read_b64_tr_b16 a[206:207], v29 offset:35456
    v_mfma_f32_16x16x32_bf16 v[58:61], a[160:163], a[96:99], v[58:61]
    ds_read_b64_tr_b16 a[208:209], v26 offset:43136
    ds_read_b64_tr_b16 a[210:211], v26 offset:43648
    v_mfma_f32_16x16x32_bf16 v[90:93], a[160:163], a[104:107], v[90:93]
    ds_read_b64_tr_b16 a[212:213], v27 offset:43136
    ds_read_b64_tr_b16 a[214:215], v27 offset:43648
    v_mfma_f32_16x16x32_bf16 v[62:65], a[164:167], a[96:99], v[62:65]
    ds_read_b64_tr_b16 a[216:217], v28 offset:43136
    ds_read_b64_tr_b16 a[218:219], v28 offset:43648
    v_mfma_f32_16x16x32_bf16 v[94:97], a[164:167], a[104:107], v[94:97]
    ds_read_b64_tr_b16 a[220:221], v29 offset:43136
    ds_read_b64_tr_b16 a[222:223], v29 offset:43648
    v_mfma_f32_16x16x32_bf16 v[66:69], a[168:171], a[96:99], v[66:69]
    v_mfma_f32_16x16x32_bf16 v[98:101], a[168:171], a[104:107], v[98:101]
    v_mfma_f32_16x16x32_bf16 v[70:73], a[172:175], a[96:99], v[70:73]
    v_mfma_f32_16x16x32_bf16 v[102:105], a[172:175], a[104:107], v[102:105]
    v_mfma_f32_16x16x32_bf16 v[74:77], a[176:179], a[96:99], v[74:77]
    v_mfma_f32_16x16x32_bf16 v[106:109], a[176:179], a[104:107], v[106:109]
    v_mfma_f32_16x16x32_bf16 v[78:81], a[180:183], a[96:99], v[78:81]
    v_mfma_f32_16x16x32_bf16 v[110:113], a[180:183], a[104:107], v[110:113]
    v_mfma_f32_16x16x32_bf16 v[82:85], a[184:187], a[96:99], v[82:85]
    v_mfma_f32_16x16x32_bf16 v[114:117], a[184:187], a[104:107], v[114:117]
    v_mfma_f32_16x16x32_bf16 v[86:89], a[188:191], a[96:99], v[86:89]
    v_mfma_f32_16x16x32_bf16 v[118:121], a[188:191], a[104:107], v[118:121]
    s_waitcnt vmcnt(23) lgkmcnt(0)
    s_barrier
    v_mfma_f32_16x16x32_bf16 v[122:125], v[20:23], a[100:103], v[122:125]
    ds_read_b128 a[112:115], v42 offset:0
    ds_read_b128 a[120:123], v44 offset:0
    v_mfma_f32_16x16x32_bf16 v[126:129], a[100:103], a[100:103], v[126:129]
    ds_read_b128 a[116:119], v43 offset:0
    ds_read_b128 a[124:127], v45 offset:0
    v_mfma_f32_16x16x32_bf16 v[130:133], v[20:23], a[108:111], v[130:133]
    ds_read_b64_tr_b16 a[160:161], v30 offset:0
    ds_read_b64_tr_b16 a[162:163], v30 offset:512
    v_mfma_f32_16x16x32_bf16 v[134:137], a[108:111], a[108:111], v[134:137]
    ds_read_b64_tr_b16 a[164:165], v31 offset:0
    ds_read_b64_tr_b16 a[166:167], v31 offset:512
    v_mfma_f32_16x16x32_bf16 v[58:61], a[192:195], a[100:103], v[58:61]
    ds_read_b64_tr_b16 a[168:169], v32 offset:0
    ds_read_b64_tr_b16 a[170:171], v32 offset:512
    v_mfma_f32_16x16x32_bf16 v[90:93], a[192:195], a[108:111], v[90:93]
    ds_read_b64_tr_b16 a[172:173], v33 offset:0
    ds_read_b64_tr_b16 a[174:175], v33 offset:512
    v_mfma_f32_16x16x32_bf16 v[62:65], a[196:199], a[100:103], v[62:65]
    ds_read_b64_tr_b16 a[176:177], v30 offset:8192
    ds_read_b64_tr_b16 a[178:179], v30 offset:8704
    v_mfma_f32_16x16x32_bf16 v[94:97], a[196:199], a[108:111], v[94:97]
    ds_read_b64_tr_b16 a[180:181], v31 offset:8192
    ds_read_b64_tr_b16 a[182:183], v31 offset:8704
    v_mfma_f32_16x16x32_bf16 v[66:69], a[200:203], a[100:103], v[66:69]
    ds_read_b64_tr_b16 a[184:185], v32 offset:8192
    ds_read_b64_tr_b16 a[186:187], v32 offset:8704
    v_mfma_f32_16x16x32_bf16 v[98:101], a[200:203], a[108:111], v[98:101]
    ds_read_b64_tr_b16 a[188:189], v33 offset:8192
    ds_read_b64_tr_b16 a[190:191], v33 offset:8704
    v_mfma_f32_16x16x32_bf16 v[70:73], a[204:207], a[100:103], v[70:73]
    s_add_u32 m0, s55, 30848
    s_nop 0
    buffer_load_dwordx4 v14, s[40:43], s63 offen lds
    v_mfma_f32_16x16x32_bf16 v[102:105], a[204:207], a[108:111], v[102:105]
    s_add_u32 m0, s55, 31872
    s_nop 0
    buffer_load_dwordx4 v15, s[40:43], s63 offen lds
    v_mfma_f32_16x16x32_bf16 v[74:77], a[208:211], a[100:103], v[74:77]
    s_add_u32 m0, s55, 39040
    s_nop 0
    buffer_load_dwordx4 v14, s[40:43], s64 offen lds
    v_mfma_f32_16x16x32_bf16 v[106:109], a[208:211], a[108:111], v[106:109]
    s_add_u32 m0, s55, 40064
    s_nop 0
    buffer_load_dwordx4 v15, s[40:43], s64 offen lds
    v_mfma_f32_16x16x32_bf16 v[78:81], a[212:215], a[100:103], v[78:81]
    s_add_u32 m0, s55, 47232
    s_nop 0
    buffer_load_dwordx4 v14, s[40:43], s65 offen lds
    v_mfma_f32_16x16x32_bf16 v[110:113], a[212:215], a[108:111], v[110:113]
    s_add_u32 m0, s55, 48256
    s_nop 0
    buffer_load_dwordx4 v15, s[40:43], s65 offen lds
    v_mfma_f32_16x16x32_bf16 v[82:85], a[216:219], a[100:103], v[82:85]
    v_mfma_f32_16x16x32_bf16 v[114:117], a[216:219], a[108:111], v[114:117]
    v_mfma_f32_16x16x32_bf16 v[86:89], a[220:223], a[100:103], v[86:89]
    v_mfma_f32_16x16x32_bf16 v[118:121], a[220:223], a[108:111], v[118:121]
    s_waitcnt lgkmcnt(0)
    v_mfma_f32_16x16x32_bf16 v[122:125], v[20:23], a[112:115], v[122:125]
    ds_read_b64_tr_b16 a[192:193], v30 offset:4096
    ds_read_b64_tr_b16 a[194:195], v30 offset:4608
    v_mfma_f32_16x16x32_bf16 v[126:129], a[112:115], a[112:115], v[126:129]
    ds_read_b64_tr_b16 a[196:197], v31 offset:4096
    ds_read_b64_tr_b16 a[198:199], v31 offset:4608
    v_mfma_f32_16x16x32_bf16 v[130:133], v[20:23], a[120:123], v[130:133]
    ds_read_b64_tr_b16 a[200:201], v32 offset:4096
    ds_read_b64_tr_b16 a[202:203], v32 offset:4608
    v_mfma_f32_16x16x32_bf16 v[134:137], a[120:123], a[120:123], v[134:137]
    ds_read_b64_tr_b16 a[204:205], v33 offset:4096
    ds_read_b64_tr_b16 a[206:207], v33 offset:4608
    v_mfma_f32_16x16x32_bf16 v[58:61], a[160:163], a[112:115], v[58:61]
    ds_read_b64_tr_b16 a[208:209], v30 offset:12288
    ds_read_b64_tr_b16 a[210:211], v30 offset:12800
    v_mfma_f32_16x16x32_bf16 v[90:93], a[160:163], a[120:123], v[90:93]
    ds_read_b64_tr_b16 a[212:213], v31 offset:12288
    ds_read_b64_tr_b16 a[214:215], v31 offset:12800
    v_mfma_f32_16x16x32_bf16 v[62:65], a[164:167], a[112:115], v[62:65]
    ds_read_b64_tr_b16 a[216:217], v32 offset:12288
    ds_read_b64_tr_b16 a[218:219], v32 offset:12800
    v_mfma_f32_16x16x32_bf16 v[94:97], a[164:167], a[120:123], v[94:97]
    ds_read_b64_tr_b16 a[220:221], v33 offset:12288
    ds_read_b64_tr_b16 a[222:223], v33 offset:12800
    v_mfma_f32_16x16x32_bf16 v[66:69], a[168:171], a[112:115], v[66:69]
    v_mfma_f32_16x16x32_bf16 v[98:101], a[168:171], a[120:123], v[98:101]
    v_mfma_f32_16x16x32_bf16 v[70:73], a[172:175], a[112:115], v[70:73]
    v_mfma_f32_16x16x32_bf16 v[102:105], a[172:175], a[120:123], v[102:105]
    v_mfma_f32_16x16x32_bf16 v[74:77], a[176:179], a[112:115], v[74:77]
    v_mfma_f32_16x16x32_bf16 v[106:109], a[176:179], a[120:123], v[106:109]
    v_mfma_f32_16x16x32_bf16 v[78:81], a[180:183], a[112:115], v[78:81]
    v_mfma_f32_16x16x32_bf16 v[110:113], a[180:183], a[120:123], v[110:113]
    v_mfma_f32_16x16x32_bf16 v[82:85], a[184:187], a[112:115], v[82:85]
    v_mfma_f32_16x16x32_bf16 v[114:117], a[184:187], a[120:123], v[114:117]
    v_mfma_f32_16x16x32_bf16 v[86:89], a[188:191], a[112:115], v[86:89]
    v_mfma_f32_16x16x32_bf16 v[118:121], a[188:191], a[120:123], v[118:121]
    s_waitcnt vmcnt(21) lgkmcnt(0)
    s_barrier
    v_mfma_f32_16x16x32_bf16 v[122:125], v[20:23], a[116:119], v[122:125]
    ds_read_b128 a[128:131], v42 offset:30848
    ds_read_b128 a[136:139], v44 offset:30848
    v_mfma_f32_16x16x32_bf16 v[126:129], a[116:119], a[116:119], v[126:129]
    ds_read_b128 a[132:135], v43 offset:30848
    ds_read_b128 a[140:143], v45 offset:30848
    v_mfma_f32_16x16x32_bf16 v[130:133], v[20:23], a[124:127], v[130:133]
    ds_read_b64_tr_b16 a[160:161], v30 offset:30848
    ds_read_b64_tr_b16 a[162:163], v30 offset:31360
    v_mfma_f32_16x16x32_bf16 v[134:137], a[124:127], a[124:127], v[134:137]
    ds_read_b64_tr_b16 a[164:165], v31 offset:30848
    ds_read_b64_tr_b16 a[166:167], v31 offset:31360
    v_mfma_f32_16x16x32_bf16 v[58:61], a[192:195], a[116:119], v[58:61]
    ds_read_b64_tr_b16 a[168:169], v32 offset:30848
    ds_read_b64_tr_b16 a[170:171], v32 offset:31360
    v_mfma_f32_16x16x32_bf16 v[90:93], a[192:195], a[124:127], v[90:93]
    ds_read_b64_tr_b16 a[172:173], v33 offset:30848
    ds_read_b64_tr_b16 a[174:175], v33 offset:31360
    v_mfma_f32_16x16x32_bf16 v[62:65], a[196:199], a[116:119], v[62:65]
    ds_read_b64_tr_b16 a[176:177], v30 offset:39040
    ds_read_b64_tr_b16 a[178:179], v30 offset:39552
    v_mfma_f32_16x16x32_bf16 v[94:97], a[196:199], a[124:127], v[94:97]
    ds_read_b64_tr_b16 a[180:181], v31 offset:39040
    ds_read_b64_tr_b16 a[182:183], v31 offset:39552
    v_mfma_f32_16x16x32_bf16 v[66:69], a[200:203], a[116:119], v[66:69]
    ds_read_b64_tr_b16 a[184:185], v32 offset:39040
    ds_read_b64_tr_b16 a[186:187], v32 offset:39552
    v_mfma_f32_16x16x32_bf16 v[98:101], a[200:203], a[124:127], v[98:101]
    ds_read_b64_tr_b16 a[188:189], v33 offset:39040
    ds_read_b64_tr_b16 a[190:191], v33 offset:39552
    v_mfma_f32_16x16x32_bf16 v[70:73], a[204:207], a[116:119], v[70:73]
    s_add_u32 m0, s55, 61696
    s_nop 0
    buffer_load_dwordx4 v14, s[40:43], s66 offen lds
    v_mfma_f32_16x16x32_bf16 v[102:105], a[204:207], a[124:127], v[102:105]
    s_add_u32 m0, s55, 62720
    s_nop 0
    buffer_load_dwordx4 v15, s[40:43], s66 offen lds
    v_mfma_f32_16x16x32_bf16 v[74:77], a[208:211], a[116:119], v[74:77]
    s_add_u32 m0, s55, 69888
    s_nop 0
    buffer_load_dwordx4 v14, s[40:43], s67 offen lds
    v_mfma_f32_16x16x32_bf16 v[106:109], a[208:211], a[124:127], v[106:109]
    s_add_u32 m0, s55, 70912
    s_nop 0
    buffer_load_dwordx4 v15, s[40:43], s67 offen lds
    v_mfma_f32_16x16x32_bf16 v[78:81], a[212:215], a[116:119], v[78:81]
    s_add_u32 m0, s55, 78080
    s_nop 0
    buffer_load_dwordx4 v14, s[40:43], s68 offen lds
    v_mfma_f32_16x16x32_bf16 v[110:113], a[212:215], a[124:127], v[110:113]
    s_add_u32 m0, s55, 79104
    s_nop 0
    buffer_load_dwordx4 v15, s[40:43], s68 offen lds
    v_mfma_f32_16x16x32_bf16 v[82:85], a[216:219], a[116:119], v[82:85]
    v_mfma_f32_16x16x32_bf16 v[114:117], a[216:219], a[124:127], v[114:117]
    v_mfma_f32_16x16x32_bf16 v[86:89], a[220:223], a[116:119], v[86:89]
    v_mfma_f32_16x16x32_bf16 v[118:121], a[220:223], a[124:127], v[118:121]
    s_waitcnt lgkmcnt(0)
    v_mfma_f32_16x16x32_bf16 v[122:125], v[20:23], a[128:131], v[122:125]
    ds_read_b64_tr_b16 a[192:193], v30 offset:34944
    ds_read_b64_tr_b16 a[194:195], v30 offset:35456
    v_mfma_f32_16x16x32_bf16 v[126:129], a[128:131], a[128:131], v[126:129]
    ds_read_b64_tr_b16 a[196:197], v31 offset:34944
    ds_read_b64_tr_b16 a[198:199], v31 offset:35456
    v_mfma_f32_16x16x32_bf16 v[130:133], v[20:23], a[136:139], v[130:133]
    ds_read_b64_tr_b16 a[200:201], v32 offset:34944
    ds_read_b64_tr_b16 a[202:203], v32 offset:35456
    v_mfma_f32_16x16x32_bf16 v[134:137], a[136:139], a[136:139], v[134:137]
    ds_read_b64_tr_b16 a[204:205], v33 offset:34944
    ds_read_b64_tr_b16 a[206:207], v33 offset:35456
    v_mfma_f32_16x16x32_bf16 v[58:61], a[160:163], a[128:131], v[58:61]
    ds_read_b64_tr_b16 a[208:209], v30 offset:43136
    ds_read_b64_tr_b16 a[210:211], v30 offset:43648
    v_mfma_f32_16x16x32_bf16 v[90:93], a[160:163], a[136:139], v[90:93]
    ds_read_b64_tr_b16 a[212:213], v31 offset:43136
    ds_read_b64_tr_b16 a[214:215], v31 offset:43648
    v_mfma_f32_16x16x32_bf16 v[62:65], a[164:167], a[128:131], v[62:65]
    ds_read_b64_tr_b16 a[216:217], v32 offset:43136
    ds_read_b64_tr_b16 a[218:219], v32 offset:43648
    v_mfma_f32_16x16x32_bf16 v[94:97], a[164:167], a[136:139], v[94:97]
    ds_read_b64_tr_b16 a[220:221], v33 offset:43136
    ds_read_b64_tr_b16 a[222:223], v33 offset:43648
    v_mfma_f32_16x16x32_bf16 v[66:69], a[168:171], a[128:131], v[66:69]
    v_mfma_f32_16x16x32_bf16 v[98:101], a[168:171], a[136:139], v[98:101]
    v_mfma_f32_16x16x32_bf16 v[70:73], a[172:175], a[128:131], v[70:73]
    v_mfma_f32_16x16x32_bf16 v[102:105], a[172:175], a[136:139], v[102:105]
    v_mfma_f32_16x16x32_bf16 v[74:77], a[176:179], a[128:131], v[74:77]
    v_mfma_f32_16x16x32_bf16 v[106:109], a[176:179], a[136:139], v[106:109]
    v_mfma_f32_16x16x32_bf16 v[78:81], a[180:183], a[128:131], v[78:81]
    v_mfma_f32_16x16x32_bf16 v[110:113], a[180:183], a[136:139], v[110:113]
    v_mfma_f32_16x16x32_bf16 v[82:85], a[184:187], a[128:131], v[82:85]
    v_mfma_f32_16x16x32_bf16 v[114:117], a[184:187], a[136:139], v[114:117]
    v_mfma_f32_16x16x32_bf16 v[86:89], a[188:191], a[128:131], v[86:89]
    v_mfma_f32_16x16x32_bf16 v[118:121], a[188:191], a[136:139], v[118:121]
    s_waitcnt vmcnt(19) lgkmcnt(0)
    s_barrier
    v_mfma_f32_16x16x32_bf16 v[122:125], v[20:23], a[132:135], v[122:125]
    ds_read_b128 a[144:147], v46 offset:0
    ds_read_b128 a[152:155], v48 offset:0
    v_mfma_f32_16x16x32_bf16 v[126:129], a[132:135], a[132:135], v[126:129]
    ds_read_b128 a[148:151], v47 offset:0
    ds_read_b128 a[156:159], v49 offset:0
    v_mfma_f32_16x16x32_bf16 v[130:133], v[20:23], a[140:143], v[130:133]
    ds_read_b64_tr_b16 a[160:161], v34 offset:0
    ds_read_b64_tr_b16 a[162:163], v34 offset:512
    v_mfma_f32_16x16x32_bf16 v[134:137], a[140:143], a[140:143], v[134:137]
    ds_read_b64_tr_b16 a[164:165], v35 offset:0
    ds_read_b64_tr_b16 a[166:167], v35 offset:512
    v_mfma_f32_16x16x32_bf16 v[58:61], a[192:195], a[132:135], v[58:61]
    ds_read_b64_tr_b16 a[168:169], v36 offset:0
    ds_read_b64_tr_b16 a[170:171], v36 offset:512
    v_mfma_f32_16x16x32_bf16 v[90:93], a[192:195], a[140:143], v[90:93]
    ds_read_b64_tr_b16 a[172:173], v37 offset:0
    ds_read_b64_tr_b16 a[174:175], v37 offset:512
    v_mfma_f32_16x16x32_bf16 v[62:65], a[196:199], a[132:135], v[62:65]
    ds_read_b64_tr_b16 a[176:177], v34 offset:8192
    ds_read_b64_tr_b16 a[178:179], v34 offset:8704
    v_mfma_f32_16x16x32_bf16 v[94:97], a[196:199], a[140:143], v[94:97]
    ds_read_b64_tr_b16 a[180:181], v35 offset:8192
    ds_read_b64_tr_b16 a[182:183], v35 offset:8704
    v_mfma_f32_16x16x32_bf16 v[66:69], a[200:203], a[132:135], v[66:69]
    ds_read_b64_tr_b16 a[184:185], v36 offset:8192
    ds_read_b64_tr_b16 a[186:187], v36 offset:8704
    v_mfma_f32_16x16x32_bf16 v[98:101], a[200:203], a[140:143], v[98:101]
    ds_read_b64_tr_b16 a[188:189], v37 offset:8192
    ds_read_b64_tr_b16 a[190:191], v37 offset:8704
    v_mfma_f32_16x16x32_bf16 v[70:73], a[204:207], a[132:135], v[70:73]
    s_add_u32 m0, s55, 92544
    s_nop 0
    buffer_load_dwordx4 v14, s[40:43], s69 offen lds
    v_mfma_f32_16x16x32_bf16 v[102:105], a[204:207], a[140:143], v[102:105]
    s_add_u32 m0, s55, 93568
    s_nop 0
    buffer_load_dwordx4 v15, s[40:43], s69 offen lds
    v_mfma_f32_16x16x32_bf16 v[74:77], a[208:211], a[132:135], v[74:77]
    s_mov_b32 s7, 0xbfe10856
    s_mov_b32 s8, 0
    v_bfe_u32 v54, s7, v50, 2
    v_mad_u32_u24 v54, v54, s6, v52
    s_add_u32 m0, s55, 100736
    s_nop 0
    buffer_load_dwordx4 v54, s[84:87], s8 offen lds
    v_mfma_f32_16x16x32_bf16 v[106:109], a[208:211], a[140:143], v[106:109]
    v_bfe_u32 v55, s7, v51, 2
    v_mad_u32_u24 v55, v55, s6, v53
    s_add_u32 m0, s55, 101760
    s_nop 0
    buffer_load_dwordx4 v55, s[84:87], s8 offen lds
    v_mfma_f32_16x16x32_bf16 v[78:81], a[212:215], a[132:135], v[78:81]
    s_mov_b32 s7, 0xaff80255
    s_mov_b32 s8, 81920
    v_bfe_u32 v54, s7, v50, 2
    v_mad_u32_u24 v54, v54, s6, v52
    s_add_u32 m0, s55, 108928
    s_nop 0
    buffer_load_dwordx4 v54, s[84:87], s8 offen lds
    v_mfma_f32_16x16x32_bf16 v[110:113], a[212:215], a[140:143], v[110:113]
    v_bfe_u32 v55, s7, v51, 2
    v_mad_u32_u24 v55, v55, s6, v53
    s_add_u32 m0, s55, 109952
    s_nop 0
    buffer_load_dwordx4 v55, s[84:87], s8 offen lds
    v_mfma_f32_16x16x32_bf16 v[82:85], a[216:219], a[132:135], v[82:85]
    v_mfma_f32_16x16x32_bf16 v[114:117], a[216:219], a[140:143], v[114:117]
    v_mfma_f32_16x16x32_bf16 v[86:89], a[220:223], a[132:135], v[86:89]
    v_mfma_f32_16x16x32_bf16 v[118:121], a[220:223], a[140:143], v[118:121]
    s_waitcnt lgkmcnt(0)
    v_mfma_f32_16x16x32_bf16 v[122:125], v[20:23], a[144:147], v[122:125]
    ds_read_b64_tr_b16 a[192:193], v34 offset:4096
    ds_read_b64_tr_b16 a[194:195], v34 offset:4608
    v_mfma_f32_16x16x32_bf16 v[126:129], a[144:147], a[144:147], v[126:129]
    ds_read_b64_tr_b16 a[196:197], v35 offset:4096
    ds_read_b64_tr_b16 a[198:199], v35 offset:4608
    v_mfma_f32_16x16x32_bf16 v[130:133], v[20:23], a[152:155], v[130:133]
    ds_read_b64_tr_b16 a[200:201], v36 offset:4096
    ds_read_b64_tr_b16 a[202:203], v36 offset:4608
    v_mfma_f32_16x16x32_bf16 v[134:137], a[152:155], a[152:155], v[134:137]
    ds_read_b64_tr_b16 a[204:205], v37 offset:4096
    ds_read_b64_tr_b16 a[206:207], v37 offset:4608
    v_mfma_f32_16x16x32_bf16 v[58:61], a[160:163], a[144:147], v[58:61]
    ds_read_b64_tr_b16 a[208:209], v34 offset:12288
    ds_read_b64_tr_b16 a[210:211], v34 offset:12800
    v_mfma_f32_16x16x32_bf16 v[90:93], a[160:163], a[152:155], v[90:93]
    ds_read_b64_tr_b16 a[212:213], v35 offset:12288
    ds_read_b64_tr_b16 a[214:215], v35 offset:12800
    v_mfma_f32_16x16x32_bf16 v[62:65], a[164:167], a[144:147], v[62:65]
    ds_read_b64_tr_b16 a[216:217], v36 offset:12288
    ds_read_b64_tr_b16 a[218:219], v36 offset:12800
    v_mfma_f32_16x16x32_bf16 v[94:97], a[164:167], a[152:155], v[94:97]
    ds_read_b64_tr_b16 a[220:221], v37 offset:12288
    ds_read_b64_tr_b16 a[222:223], v37 offset:12800
    v_mfma_f32_16x16x32_bf16 v[66:69], a[168:171], a[144:147], v[66:69]
    v_mfma_f32_16x16x32_bf16 v[98:101], a[168:171], a[152:155], v[98:101]
    v_mfma_f32_16x16x32_bf16 v[70:73], a[172:175], a[144:147], v[70:73]
    v_mfma_f32_16x16x32_bf16 v[102:105], a[172:175], a[152:155], v[102:105]
    v_mfma_f32_16x16x32_bf16 v[74:77], a[176:179], a[144:147], v[74:77]
    v_mfma_f32_16x16x32_bf16 v[106:109], a[176:179], a[152:155], v[106:109]
    v_mfma_f32_16x16x32_bf16 v[78:81], a[180:183], a[144:147], v[78:81]
    v_mfma_f32_16x16x32_bf16 v[110:113], a[180:183], a[152:155], v[110:113]
    v_mfma_f32_16x16x32_bf16 v[82:85], a[184:187], a[144:147], v[82:85]
    v_mfma_f32_16x16x32_bf16 v[114:117], a[184:187], a[152:155], v[114:117]
    v_mfma_f32_16x16x32_bf16 v[86:89], a[188:191], a[144:147], v[86:89]
    v_mfma_f32_16x16x32_bf16 v[118:121], a[188:191], a[152:155], v[118:121]
    s_waitcnt lgkmcnt(0)
    v_mfma_f32_16x16x32_bf16 v[122:125], v[20:23], a[148:151], v[122:125]
    v_mfma_f32_16x16x32_bf16 v[126:129], a[148:151], a[148:151], v[126:129]
    v_mfma_f32_16x16x32_bf16 v[130:133], v[20:23], a[156:159], v[130:133]
    v_mfma_f32_16x16x32_bf16 v[134:137], a[156:159], a[156:159], v[134:137]
    v_mfma_f32_16x16x32_bf16 v[58:61], a[192:195], a[148:151], v[58:61]
    v_mfma_f32_16x16x32_bf16 v[90:93], a[192:195], a[156:159], v[90:93]
    v_mfma_f32_16x16x32_bf16 v[62:65], a[196:199], a[148:151], v[62:65]
    v_mfma_f32_16x16x32_bf16 v[94:97], a[196:199], a[156:159], v[94:97]
    v_mfma_f32_16x16x32_bf16 v[66:69], a[200:203], a[148:151], v[66:69]
    v_mfma_f32_16x16x32_bf16 v[98:101], a[200:203], a[156:159], v[98:101]
    v_mfma_f32_16x16x32_bf16 v[70:73], a[204:207], a[148:151], v[70:73]
    v_mfma_f32_16x16x32_bf16 v[102:105], a[204:207], a[156:159], v[102:105]
    v_mfma_f32_16x16x32_bf16 v[74:77], a[208:211], a[148:151], v[74:77]
    v_mfma_f32_16x16x32_bf16 v[106:109], a[208:211], a[156:159], v[106:109]
    v_mfma_f32_16x16x32_bf16 v[78:81], a[212:215], a[148:151], v[78:81]
    v_mfma_f32_16x16x32_bf16 v[110:113], a[212:215], a[156:159], v[110:113]
    v_mfma_f32_16x16x32_bf16 v[82:85], a[216:219], a[148:151], v[82:85]
    v_mfma_f32_16x16x32_bf16 v[114:117], a[216:219], a[156:159], v[114:117]
    v_mfma_f32_16x16x32_bf16 v[86:89], a[220:223], a[148:151], v[86:89]
    v_mfma_f32_16x16x32_bf16 v[118:121], a[220:223], a[156:159], v[118:121]
    v_cndmask_b32 v4, v126, v127, s[4:5]
    v_cndmask_b32 v5, v128, v129, s[4:5]
    v_cndmask_b32 v4, v4, v5, s[22:23]
    ds_bpermute_b32 v4, v56, v4
    v_mul_f32 v5, 0x3acccccd, v122
    v_cvt_pk_bf16_f32 v140, v5, v5
    v_lshlrev_b32 v140, 16, v140
    v_xor_b32 v140, 0x80000000, v140
    v_mul_f32 v5, v5, v5
    s_waitcnt lgkmcnt(0)
    v_mul_f32 v4, 0x3acccccd, v4
    v_sub_f32 v4, v4, v5
    v_max_f32 v4, 0, v4
    v_cvt_pk_bf16_f32 v4, v4, v4
    v_lshlrev_b32 v4, 16, v4
    v_add_f32 v4, 0x3727c5ac, v4
    v_cvt_pk_bf16_f32 v4, v4, v4
    v_lshlrev_b32 v4, 16, v4
    v_sqrt_f32 v4, v4
    s_nop 0
    v_cvt_pk_bf16_f32 v4, v4, v4
    v_lshlrev_b32 v4, 16, v4
    v_rcp_f32 v141, v4
    v_cndmask_b32 v4, v134, v135, s[4:5]
    v_cndmask_b32 v5, v136, v137, s[4:5]
    v_cndmask_b32 v4, v4, v5, s[22:23]
    ds_bpermute_b32 v4, v56, v4
    v_mul_f32 v5, 0x3acccccd, v130
    v_cvt_pk_bf16_f32 v142, v5, v5
    v_lshlrev_b32 v142, 16, v142
    v_xor_b32 v142, 0x80000000, v142
    v_mul_f32 v5, v5, v5
    s_waitcnt lgkmcnt(0)
    v_mul_f32 v4, 0x3acccccd, v4
    v_sub_f32 v4, v4, v5
    v_max_f32 v4, 0, v4
    v_cvt_pk_bf16_f32 v4, v4, v4
    v_lshlrev_b32 v4, 16, v4
    v_add_f32 v4, 0x3727c5ac, v4
    v_cvt_pk_bf16_f32 v4, v4, v4
    v_lshlrev_b32 v4, 16, v4
    v_sqrt_f32 v4, v4
    s_nop 0
    v_cvt_pk_bf16_f32 v4, v4, v4
    v_lshlrev_b32 v4, 16, v4
    v_rcp_f32 v143, v4
    s_lshl_b32 s56, s3, 7
    s_add_u32 s56, s56, 154240
    v_lshl_add_u32 v16, v3, 2, s56
    ds_write_b32 v16, v140 offset:0
    ds_write_b32 v16, v141 offset:512
    ds_write_b32 v16, v142 offset:64
    ds_write_b32 v16, v143 offset:576
    s_mul_i32 s56, s3, 30848
    s_add_u32 s56, s56, 24576
    v_lshl_add_u32 v17, v1, 4, s56
    ds_write_b128 v17, v[106:109] offset:0
    ds_write_b128 v17, v[110:113] offset:1024
    ds_write_b128 v17, v[114:117] offset:2048
    ds_write_b128 v17, v[118:121] offset:3072
    s_lshl_b32 s56, s3, 9
    s_add_u32 s56, s56, 155264
    v_lshl_add_u32 v18, v2, 4, s56
    s_mov_b32 exec_lo, 0x00010001
    s_mov_b32 exec_hi, 0x00010001
    ds_write_b128 v18, v[58:61] offset:0
    ds_write_b128 v18, v[62:65] offset:64
    ds_write_b128 v18, v[66:69] offset:128
    ds_write_b128 v18, v[70:73] offset:192
    ds_write_b128 v18, v[74:77] offset:256
    ds_write_b128 v18, v[78:81] offset:320
    ds_write_b128 v18, v[82:85] offset:384
    ds_write_b128 v18, v[86:89] offset:448
    s_mov_b64 exec, -1
    s_waitcnt lgkmcnt(0)
    s_barrier
    s_mov_b32 s7, 0xabfe4015
    s_mov_b32 s8, 163840
    v_bfe_u32 v54, s7, v50, 2
    v_mad_u32_u24 v54, v54, s6, v52
    s_add_u32 m0, s55, 123392
    s_nop 0
    buffer_load_dwordx4 v54, s[84:87], s8 offen lds
    v_bfe_u32 v55, s7, v51, 2
    v_mad_u32_u24 v55, v55, s6, v53
    s_add_u32 m0, s55, 124416
    s_nop 0
    buffer_load_dwordx4 v55, s[84:87], s8 offen lds
    s_mov_b32 s7, 0xaa7fd005
    s_mov_b32 s8, 245760
    v_bfe_u32 v54, s7, v50, 2
    v_mad_u32_u24 v54, v54, s6, v52
    s_add_u32 m0, s55, 131584
    s_nop 0
    buffer_load_dwordx4 v54, s[84:87], s8 offen lds
    v_bfe_u32 v55, s7, v51, 2
    v_mad_u32_u24 v55, v55, s6, v53
    s_add_u32 m0, s55, 132608
    s_nop 0
    buffer_load_dwordx4 v55, s[84:87], s8 offen lds
    s_mov_b32 s7, 0x6adfb401
    s_mov_b32 s8, 327680
    v_bfe_u32 v54, s7, v50, 2
    v_mad_u32_u24 v54, v54, s6, v52
    s_add_u32 m0, s55, 139776
    s_nop 0
    buffer_load_dwordx4 v54, s[84:87], s8 offen lds
    v_bfe_u32 v55, s7, v51, 2
    v_mad_u32_u24 v55, v55, s6, v53
    s_add_u32 m0, s55, 140800
    s_nop 0
    buffer_load_dwordx4 v55, s[84:87], s8 offen lds
    v_lshlrev_b32 v18, 4, v2
    v_add_u32 v18, 155264, v18
    ds_read_b128 v[144:147], v18 offset:0
    ds_read_b128 v[148:151], v18 offset:64
    ds_read_b128 v[152:155], v18 offset:128
    ds_read_b128 v[156:159], v18 offset:192
    ds_read_b128 v[160:163], v18 offset:256
    ds_read_b128 v[164:167], v18 offset:320
    ds_read_b128 v[168:171], v18 offset:384
    ds_read_b128 v[172:175], v18 offset:448
    s_cmp_eq_u32 s3, 0
    s_cselect_b32 s56, 0, 30848
    s_cselect_b32 s57, 0, 64
    v_subrev_u32 v19, s56, v17
    ds_read_b128 v[122:125], v19 offset:0
    ds_read_b128 v[126:129], v19 offset:1024
    ds_read_b128 v[130:133], v19 offset:2048
    ds_read_b128 v[134:137], v19 offset:3072
    v_subrev_u32 v4, s57, v16
    ds_read_b32 v138, v4
    ds_read_b32 v139, v4 offset:512
    v_lshlrev_b32 v5, 2, v2
    v_sub_u32 v5, v3, v5
    v_mov_b32 v6, 0xff800000
    s_cmp_eq_u32 s26, 0
    s_cselect_b32 s56, s3, 0
    s_cmp_eq_u32 s56, 1
    s_cselect_b64 s[58:59], 0, -1
    v_mov_b32 v176, 0
    v_mov_b32 v177, 0
    v_mov_b32 v178, 0
    v_mov_b32 v179, 0
    v_subrev_u32 v7, 0, v5
    v_and_b32 v8, 0x80000001, v7
    v_mov_b32 v9, 0x0000ffff
    v_cmp_eq_u32 vcc, 0, v8
    s_nop 1
    v_cndmask_b32 v42, v6, 0, vcc
    v_cndmask_b32 v178, v178, v9, vcc
    v_cmp_eq_u32 vcc, 0x80000000, v8
    s_nop 1
    v_cndmask_b32 v38, v6, 0, vcc
    v_cndmask_b32 v176, v176, v9, vcc
    v_cndmask_b32 v46, v6, v38, s[58:59]
    v_subrev_u32 v7, 1, v5
    v_and_b32 v8, 0x80000001, v7
    v_mov_b32 v9, 0xffff0000
    v_cmp_eq_u32 vcc, 0, v8
    s_nop 1
    v_cndmask_b32 v43, v6, 0, vcc
    v_cndmask_b32 v178, v178, v9, vcc
    v_cmp_eq_u32 vcc, 0x80000000, v8
    s_nop 1
    v_cndmask_b32 v39, v6, 0, vcc
    v_cndmask_b32 v176, v176, v9, vcc
    v_cndmask_b32 v47, v6, v39, s[58:59]
    v_subrev_u32 v7, 2, v5
    v_and_b32 v8, 0x80000001, v7
    v_mov_b32 v9, 0x0000ffff
    v_cmp_eq_u32 vcc, 0, v8
    s_nop 1
    v_cndmask_b32 v44, v6, 0, vcc
    v_cndmask_b32 v179, v179, v9, vcc
    v_cmp_eq_u32 vcc, 0x80000000, v8
    s_nop 1
    v_cndmask_b32 v40, v6, 0, vcc
    v_cndmask_b32 v177, v177, v9, vcc
    v_cndmask_b32 v48, v6, v40, s[58:59]
    v_subrev_u32 v7, 3, v5
    v_and_b32 v8, 0x80000001, v7
    v_mov_b32 v9, 0xffff0000
    v_cmp_eq_u32 vcc, 0, v8
    s_nop 1
    v_cndmask_b32 v45, v6, 0, vcc
    v_cndmask_b32 v179, v179, v9, vcc
    v_cmp_eq_u32 vcc, 0x80000000, v8
    s_nop 1
    v_cndmask_b32 v41, v6, 0, vcc
    v_cndmask_b32 v177, v177, v9, vcc
    v_cndmask_b32 v49, v6, v41, s[58:59]
    s_waitcnt lgkmcnt(0)
    v_pk_fma_f32 v[122:123], v[160:161], v[138:139], v[122:123] op_sel_hi:[1,0,1]
    v_pk_fma_f32 v[124:125], v[162:163], v[138:139], v[124:125] op_sel_hi:[1,0,1]
    v_pk_mul_f32 v[122:123], v[122:123], v[138:139] op_sel:[0,1] op_sel_hi:[1,1]
    v_pk_mul_f32 v[124:125], v[124:125], v[138:139] op_sel:[0,1] op_sel_hi:[1,1]
    v_cvt_pk_bf16_f32 v180, v122, v123
    v_cvt_pk_bf16_f32 v181, v124, v125
    v_pk_fma_f32 v[74:75], v[160:161], v[140:141], v[74:75] op_sel_hi:[1,0,1]
    v_pk_fma_f32 v[76:77], v[162:163], v[140:141], v[76:77] op_sel_hi:[1,0,1]
    v_pk_mul_f32 v[74:75], v[74:75], v[140:141] op_sel:[0,1] op_sel_hi:[1,1]
    v_pk_mul_f32 v[76:77], v[76:77], v[140:141] op_sel:[0,1] op_sel_hi:[1,1]
    v_cvt_pk_bf16_f32 v188, v74, v75
    v_cvt_pk_bf16_f32 v189, v76, v77
    v_pk_fma_f32 v[106:107], v[160:161], v[142:143], v[106:107] op_sel_hi:[1,0,1]
    v_pk_fma_f32 v[108:109], v[162:163], v[142:143], v[108:109] op_sel_hi:[1,0,1]
    v_pk_mul_f32 v[106:107], v[106:107], v[142:143] op_sel:[0,1] op_sel_hi:[1,1]
    v_pk_mul_f32 v[108:109], v[108:109], v[142:143] op_sel:[0,1] op_sel_hi:[1,1]
    v_cvt_pk_bf16_f32 v196, v106, v107
    v_cvt_pk_bf16_f32 v197, v108, v109
    v_pk_fma_f32 v[126:127], v[164:165], v[138:139], v[126:127] op_sel_hi:[1,0,1]
    v_pk_fma_f32 v[128:129], v[166:167], v[138:139], v[128:129] op_sel_hi:[1,0,1]
    v_pk_mul_f32 v[126:127], v[126:127], v[138:139] op_sel:[0,1] op_sel_hi:[1,1]
    v_pk_mul_f32 v[128:129], v[128:129], v[138:139] op_sel:[0,1] op_sel_hi:[1,1]
    v_cvt_pk_bf16_f32 v182, v126, v127
    v_cvt_pk_bf16_f32 v183, v128, v129
    v_pk_fma_f32 v[78:79], v[164:165], v[140:141], v[78:79] op_sel_hi:[1,0,1]
    v_pk_fma_f32 v[80:81], v[166:167], v[140:141], v[80:81] op_sel_hi:[1,0,1]
    v_pk_mul_f32 v[78:79], v[78:79], v[140:141] op_sel:[0,1] op_sel_hi:[1,1]
    v_pk_mul_f32 v[80:81], v[80:81], v[140:141] op_sel:[0,1] op_sel_hi:[1,1]
    v_cvt_pk_bf16_f32 v190, v78, v79
    v_cvt_pk_bf16_f32 v191, v80, v81
    v_pk_fma_f32 v[110:111], v[164:165], v[142:143], v[110:111] op_sel_hi:[1,0,1]
    v_pk_fma_f32 v[112:113], v[166:167], v[142:143], v[112:113] op_sel_hi:[1,0,1]
    v_pk_mul_f32 v[110:111], v[110:111], v[142:143] op_sel:[0,1] op_sel_hi:[1,1]
    v_pk_mul_f32 v[112:113], v[112:113], v[142:143] op_sel:[0,1] op_sel_hi:[1,1]
    v_cvt_pk_bf16_f32 v198, v110, v111
    v_cvt_pk_bf16_f32 v199, v112, v113
    v_pk_fma_f32 v[130:131], v[168:169], v[138:139], v[130:131] op_sel_hi:[1,0,1]
    v_pk_fma_f32 v[132:133], v[170:171], v[138:139], v[132:133] op_sel_hi:[1,0,1]
    v_pk_mul_f32 v[130:131], v[130:131], v[138:139] op_sel:[0,1] op_sel_hi:[1,1]
    v_pk_mul_f32 v[132:133], v[132:133], v[138:139] op_sel:[0,1] op_sel_hi:[1,1]
    v_cvt_pk_bf16_f32 v184, v130, v131
    v_cvt_pk_bf16_f32 v185, v132, v133
    v_pk_fma_f32 v[82:83], v[168:169], v[140:141], v[82:83] op_sel_hi:[1,0,1]
    v_pk_fma_f32 v[84:85], v[170:171], v[140:141], v[84:85] op_sel_hi:[1,0,1]
    v_pk_mul_f32 v[82:83], v[82:83], v[140:141] op_sel:[0,1] op_sel_hi:[1,1]
    v_pk_mul_f32 v[84:85], v[84:85], v[140:141] op_sel:[0,1] op_sel_hi:[1,1]
    v_cvt_pk_bf16_f32 v192, v82, v83
    v_cvt_pk_bf16_f32 v193, v84, v85
    v_pk_fma_f32 v[114:115], v[168:169], v[142:143], v[114:115] op_sel_hi:[1,0,1]
    v_pk_fma_f32 v[116:117], v[170:171], v[142:143], v[116:117] op_sel_hi:[1,0,1]
    v_pk_mul_f32 v[114:115], v[114:115], v[142:143] op_sel:[0,1] op_sel_hi:[1,1]
    v_pk_mul_f32 v[116:117], v[116:117], v[142:143] op_sel:[0,1] op_sel_hi:[1,1]
    v_cvt_pk_bf16_f32 v200, v114, v115
    v_cvt_pk_bf16_f32 v201, v116, v117
    v_pk_fma_f32 v[134:135], v[172:173], v[138:139], v[134:135] op_sel_hi:[1,0,1]
    v_pk_fma_f32 v[136:137], v[174:175], v[138:139], v[136:137] op_sel_hi:[1,0,1]
    v_pk_mul_f32 v[134:135], v[134:135], v[138:139] op_sel:[0,1] op_sel_hi:[1,1]
    v_pk_mul_f32 v[136:137], v[136:137], v[138:139] op_sel:[0,1] op_sel_hi:[1,1]
    v_cvt_pk_bf16_f32 v186, v134, v135
    v_cvt_pk_bf16_f32 v187, v136, v137
    v_pk_fma_f32 v[86:87], v[172:173], v[140:141], v[86:87] op_sel_hi:[1,0,1]
    v_pk_fma_f32 v[88:89], v[174:175], v[140:141], v[88:89] op_sel_hi:[1,0,1]
    v_pk_mul_f32 v[86:87], v[86:87], v[140:141] op_sel:[0,1] op_sel_hi:[1,1]
    v_pk_mul_f32 v[88:89], v[88:89], v[140:141] op_sel:[0,1] op_sel_hi:[1,1]
    v_cvt_pk_bf16_f32 v194, v86, v87
    v_cvt_pk_bf16_f32 v195, v88, v89
    v_pk_fma_f32 v[118:119], v[172:173], v[142:143], v[118:119] op_sel_hi:[1,0,1]
    v_pk_fma_f32 v[120:121], v[174:175], v[142:143], v[120:121] op_sel_hi:[1,0,1]
    v_pk_mul_f32 v[118:119], v[118:119], v[142:143] op_sel:[0,1] op_sel_hi:[1,1]
    v_pk_mul_f32 v[120:121], v[120:121], v[142:143] op_sel:[0,1] op_sel_hi:[1,1]
    v_cvt_pk_bf16_f32 v202, v118, v119
    v_cvt_pk_bf16_f32 v203, v120, v121
    v_pk_fma_f32 v[58:59], v[144:145], v[140:141], v[58:59] op_sel_hi:[1,0,1]
    v_pk_fma_f32 v[60:61], v[146:147], v[140:141], v[60:61] op_sel_hi:[1,0,1]
    v_pk_mul_f32 v[58:59], v[58:59], v[140:141] op_sel:[0,1] op_sel_hi:[1,1]
    v_pk_mul_f32 v[60:61], v[60:61], v[140:141] op_sel:[0,1] op_sel_hi:[1,1]
    v_pk_fma_f32 v[62:63], v[148:149], v[140:141], v[62:63] op_sel_hi:[1,0,1]
    v_pk_fma_f32 v[64:65], v[150:151], v[140:141], v[64:65] op_sel_hi:[1,0,1]
    v_pk_mul_f32 v[62:63], v[62:63], v[140:141] op_sel:[0,1] op_sel_hi:[1,1]
    v_pk_mul_f32 v[64:65], v[64:65], v[140:141] op_sel:[0,1] op_sel_hi:[1,1]
    v_pk_fma_f32 v[66:67], v[152:153], v[140:141], v[66:67] op_sel_hi:[1,0,1]
    v_pk_fma_f32 v[68:69], v[154:155], v[140:141], v[68:69] op_sel_hi:[1,0,1]
    v_pk_mul_f32 v[66:67], v[66:67], v[140:141] op_sel:[0,1] op_sel_hi:[1,1]
    v_pk_mul_f32 v[68:69], v[68:69], v[140:141] op_sel:[0,1] op_sel_hi:[1,1]
    v_pk_fma_f32 v[70:71], v[156:157], v[140:141], v[70:71] op_sel_hi:[1,0,1]
    v_pk_fma_f32 v[72:73], v[158:159], v[140:141], v[72:73] op_sel_hi:[1,0,1]
    v_pk_mul_f32 v[70:71], v[70:71], v[140:141] op_sel:[0,1] op_sel_hi:[1,1]
    v_pk_mul_f32 v[72:73], v[72:73], v[140:141] op_sel:[0,1] op_sel_hi:[1,1]
    v_cvt_pk_bf16_f32 v208, v58, v59
    v_cvt_pk_bf16_f32 v209, v60, v61
    v_cvt_pk_bf16_f32 v214, v70, v71
    v_cvt_pk_bf16_f32 v215, v72, v73
    v_cvt_pk_bf16_f32 v4, v62, v63
    v_cvt_pk_bf16_f32 v5, v64, v65
    v_cvt_pk_bf16_f32 v6, v66, v67
    v_cvt_pk_bf16_f32 v7, v68, v69
    v_cndmask_b32 v210, 0, v4, s[14:15]
    v_cndmask_b32 v212, 0, v6, s[20:21]
    v_cndmask_b32 v204, 0, v4, s[10:11]
    v_cndmask_b32 v206, 0, v6, s[16:17]
    v_cndmask_b32 v216, 0, v4, s[12:13]
    v_cndmask_b32 v218, 0, v6, s[18:19]
    v_cndmask_b32 v211, 0, v5, s[14:15]
    v_cndmask_b32 v213, 0, v7, s[20:21]
    v_cndmask_b32 v205, 0, v5, s[10:11]
    v_cndmask_b32 v207, 0, v7, s[16:17]
    v_cndmask_b32 v217, 0, v5, s[12:13]
    v_cndmask_b32 v219, 0, v7, s[18:19]
    v_pk_fma_f32 v[90:91], v[144:145], v[142:143], v[90:91] op_sel_hi:[1,0,1]
    v_pk_fma_f32 v[92:93], v[146:147], v[142:143], v[92:93] op_sel_hi:[1,0,1]
    v_pk_mul_f32 v[90:91], v[90:91], v[142:143] op_sel:[0,1] op_sel_hi:[1,1]
    v_pk_mul_f32 v[92:93], v[92:93], v[142:143] op_sel:[0,1] op_sel_hi:[1,1]
    v_pk_fma_f32 v[94:95], v[148:149], v[142:143], v[94:95] op_sel_hi:[1,0,1]
    v_pk_fma_f32 v[96:97], v[150:151], v[142:143], v[96:97] op_sel_hi:[1,0,1]
    v_pk_mul_f32 v[94:95], v[94:95], v[142:143] op_sel:[0,1] op_sel_hi:[1,1]
    v_pk_mul_f32 v[96:97], v[96:97], v[142:143] op_sel:[0,1] op_sel_hi:[1,1]
    v_pk_fma_f32 v[98:99], v[152:153], v[142:143], v[98:99] op_sel_hi:[1,0,1]
    v_pk_fma_f32 v[100:101], v[154:155], v[142:143], v[100:101] op_sel_hi:[1,0,1]
    v_pk_mul_f32 v[98:99], v[98:99], v[142:143] op_sel:[0,1] op_sel_hi:[1,1]
    v_pk_mul_f32 v[100:101], v[100:101], v[142:143] op_sel:[0,1] op_sel_hi:[1,1]
    v_pk_fma_f32 v[102:103], v[156:157], v[142:143], v[102:103] op_sel_hi:[1,0,1]
    v_pk_fma_f32 v[104:105], v[158:159], v[142:143], v[104:105] op_sel_hi:[1,0,1]
    v_pk_mul_f32 v[102:103], v[102:103], v[142:143] op_sel:[0,1] op_sel_hi:[1,1]
    v_pk_mul_f32 v[104:105], v[104:105], v[142:143] op_sel:[0,1] op_sel_hi:[1,1]
    v_cvt_pk_bf16_f32 v224, v90, v91
    v_cvt_pk_bf16_f32 v225, v92, v93
    v_cvt_pk_bf16_f32 v230, v102, v103
    v_cvt_pk_bf16_f32 v231, v104, v105
    v_cvt_pk_bf16_f32 v4, v94, v95
    v_cvt_pk_bf16_f32 v5, v96, v97
    v_cvt_pk_bf16_f32 v6, v98, v99
    v_cvt_pk_bf16_f32 v7, v100, v101
    v_cndmask_b32 v226, 0, v4, s[14:15]
    v_cndmask_b32 v228, 0, v6, s[20:21]
    v_cndmask_b32 v220, 0, v4, s[10:11]
    v_cndmask_b32 v222, 0, v6, s[16:17]
    v_cndmask_b32 v232, 0, v4, s[12:13]
    v_cndmask_b32 v234, 0, v6, s[18:19]
    v_cndmask_b32 v227, 0, v5, s[14:15]
    v_cndmask_b32 v229, 0, v7, s[20:21]
    v_cndmask_b32 v221, 0, v5, s[10:11]
    v_cndmask_b32 v223, 0, v7, s[16:17]
    v_cndmask_b32 v233, 0, v5, s[12:13]
    v_cndmask_b32 v235, 0, v7, s[18:19]
    v_mfma_f32_16x16x32_bf16 v[58:61], v[182:185], v[204:207], v[46:49]
    v_mfma_f32_16x16x32_bf16 v[62:65], v[190:193], v[204:207], v[42:45]
    v_mfma_f32_16x16x32_bf16 v[90:93], v[190:193], v[220:223], v[38:41]
    v_mfma_f32_16x16x32_bf16 v[94:97], v[198:201], v[220:223], v[42:45]
    v_mfma_f32_16x16x32_bf16 v[82:85], v[182:185], v[216:219], v[46:49]
    v_mfma_f32_16x16x32_bf16 v[86:89], v[190:193], v[216:219], v[42:45]
    v_mfma_f32_16x16x32_bf16 v[114:117], v[190:193], v[232:235], v[38:41]
    v_mfma_f32_16x16x32_bf16 v[118:121], v[198:201], v[232:235], v[42:45]
    v_mfma_f32_16x16x32_bf16 v[66:69], v[180:183], v[208:211], v[46:49]
    v_mfma_f32_16x16x32_bf16 v[70:73], v[188:191], v[208:211], v[42:45]
    v_mfma_f32_16x16x32_bf16 v[98:101], v[188:191], v[224:227], v[38:41]
    v_mfma_f32_16x16x32_bf16 v[102:105], v[196:199], v[224:227], v[42:45]
    v_mfma_f32_16x16x32_bf16 v[74:77], v[184:187], v[212:215], v[46:49]
    v_mfma_f32_16x16x32_bf16 v[78:81], v[192:195], v[212:215], v[42:45]
    v_mfma_f32_16x16x32_bf16 v[106:109], v[192:195], v[228:231], v[38:41]
    v_mfma_f32_16x16x32_bf16 v[110:113], v[200:203], v[228:231], v[42:45]
    s_waitcnt vmcnt(30)
    v_readfirstlane_b32 s53, v57
    s_nop 0
    s_cmp_lg_u32 s53, 0
    s_nop 2
    s_cbranch_scc1 Lnon_ok
Lnon_retry:
    s_sub_u32 s54, s54, 1
    s_cbranch_scc1 Lend
    v_mov_b32 v57, 192
    buffer_load_dword v57, v57, s[48:51], 0 offen sc1
    s_waitcnt vmcnt(0)
    v_readfirstlane_b32 s53, v57
    s_nop 0
    s_cmp_eq_u32 s53, 0
    s_nop 1
    s_cbranch_scc1 Lnon_retry
Lnon_ok:
    s_mul_i32 s5, s26, 10
    s_add_u32 s5, s5, s27
    s_mul_i32 s4, s5, 12288
    s_add_u32 s4, s4, 1048576
    s_lshl_b32 s56, s3, 11
    s_sub_u32 s56, s56, 2048
    s_cmp_eq_u32 s3, 0
    s_cselect_b32 s56, 0x40000000, s56
    v_lshl_add_u32 v38, v1, 4, s56
    s_add_u32 s57, s4, 6144
    v_max3_f32 v144, v58, v59, v62
    v_max3_f32 v146, v60, v61, v64
    v_max_f32 v144, v144, v63
    v_max_f32 v146, v146, v65
    v_mov_b32 v145, s53
    v_mov_b32 v147, s53
    buffer_store_dwordx4 v[144:147], v38, s[44:47], s4 offen offset:0 sc1
    v_max3_f32 v160, v90, v91, v94
    v_max3_f32 v162, v92, v93, v96
    v_max_f32 v160, v160, v95
    v_max_f32 v162, v162, v97
    v_mov_b32 v161, s53
    v_mov_b32 v163, s53
    buffer_store_dwordx4 v[160:163], v38, s[44:47], s4 offen offset:1024 sc1
    v_max3_f32 v156, v82, v83, v86
    v_max3_f32 v158, v84, v85, v88
    v_max_f32 v156, v156, v87
    v_max_f32 v158, v158, v89
    v_mov_b32 v157, s53
    v_mov_b32 v159, s53
    buffer_store_dwordx4 v[156:159], v38, s[44:47], s57 offen offset:0 sc1
    v_max3_f32 v172, v114, v115, v118
    v_max3_f32 v174, v116, v117, v120
    v_max_f32 v172, v172, v119
    v_max_f32 v174, v174, v121
    v_mov_b32 v173, s53
    v_mov_b32 v175, s53
    buffer_store_dwordx4 v[172:175], v38, s[44:47], s57 offen offset:1024 sc1
    s_mov_b32 s9, 0x3ea52b5c
    v_max3_f32 v148, v66, v67, v70
    v_max3_f32 v150, v68, v69, v72
    v_max_f32 v148, v148, v71
    v_max_f32 v150, v150, v73
    v_max3_f32 v164, v98, v99, v102
    v_max3_f32 v166, v100, v101, v104
    v_max_f32 v164, v164, v103
    v_max_f32 v166, v166, v105
    v_max3_f32 v152, v74, v75, v78
    v_max3_f32 v154, v76, v77, v80
    v_max_f32 v152, v152, v79
    v_max_f32 v154, v154, v81
    v_max3_f32 v168, v106, v107, v110
    v_max3_f32 v170, v108, v109, v112
    v_max_f32 v168, v168, v111
    v_max_f32 v170, v170, v113
    v_max_f32 v4, v148, v150
    v_max_f32 v5, v164, v166
    v_max_f32 v6, v152, v154
    v_max_f32 v7, v168, v170
    v_mov_b32 v8, v4
    v_mov_b32 v9, v5
    v_mov_b32 v10, v6
    v_mov_b32 v11, v7
    v_permlane32_swap_b32 v4, v8
    v_permlane32_swap_b32 v5, v9
    v_permlane32_swap_b32 v6, v10
    v_permlane32_swap_b32 v7, v11
    v_max_f32 v4, v4, v8
    v_max_f32 v5, v5, v9
    v_max_f32 v6, v6, v10
    v_max_f32 v7, v7, v11
    v_mov_b32 v8, v4
    v_mov_b32 v9, v5
    v_mov_b32 v10, v6
    v_mov_b32 v11, v7
    v_permlane16_swap_b32 v4, v8
    v_permlane16_swap_b32 v5, v9
    v_permlane16_swap_b32 v6, v10
    v_permlane16_swap_b32 v7, v11
    v_max_f32 v4, v4, v8
    v_max_f32 v5, v5, v9
    v_max_f32 v6, v6, v10
    v_max_f32 v7, v7, v11
    v_mul_f32 v4, s9, v4
    v_mul_f32 v5, s9, v5
    v_mul_f32 v6, s9, v6
    v_mul_f32 v7, s9, v7
    v_fma_f32 v148, v148, s9, -v4
    v_fma_f32 v150, v150, s9, -v4
    v_fma_f32 v164, v164, s9, -v5
    v_fma_f32 v166, v166, s9, -v5
    v_fma_f32 v152, v152, s9, -v6
    v_fma_f32 v154, v154, s9, -v6
    v_fma_f32 v168, v168, s9, -v7
    v_fma_f32 v170, v170, s9, -v7
    v_exp_f32 v148, v148
    v_exp_f32 v150, v150
    v_exp_f32 v164, v164
    v_exp_f32 v166, v166
    v_exp_f32 v152, v152
    v_exp_f32 v154, v154
    v_exp_f32 v168, v168
    v_exp_f32 v170, v170
    v_cvt_pk_bf16_f32 v148, v148, v148
    v_cvt_pk_bf16_f32 v149, v150, v150
    v_cvt_pk_bf16_f32 v164, v164, v164
    v_cvt_pk_bf16_f32 v165, v166, v166
    v_cvt_pk_bf16_f32 v152, v152, v152
    v_cvt_pk_bf16_f32 v153, v154, v154
    v_cvt_pk_bf16_f32 v168, v168, v168
    v_cvt_pk_bf16_f32 v169, v170, v170
    v_and_b32 v150, v148, v178
    v_and_b32 v151, v149, v179
    v_and_b32 v148, v148, v176
    v_and_b32 v149, v149, v177
    v_and_b32 v166, v164, v178
    v_and_b32 v167, v165, v179
    v_and_b32 v164, v164, v176
    v_and_b32 v165, v165, v177
    v_and_b32 v154, v152, v178
    v_and_b32 v155, v153, v179
    v_and_b32 v152, v152, v176
    v_and_b32 v153, v153, v177
    v_and_b32 v170, v168, v178
    v_and_b32 v171, v169, v179
    v_and_b32 v168, v168, v176
    v_and_b32 v169, v169, v177
    s_waitcnt vmcnt(28) lgkmcnt(0)
    s_barrier
    ds_read_b64_tr_b16 a[160:161], v26 offset:0
    ds_read_b64_tr_b16 a[162:163], v26 offset:512
    ds_read_b64_tr_b16 a[164:165], v27 offset:0
    ds_read_b64_tr_b16 a[166:167], v27 offset:512
    ds_read_b64_tr_b16 a[168:169], v28 offset:0
    ds_read_b64_tr_b16 a[170:171], v28 offset:512
    ds_read_b64_tr_b16 a[172:173], v29 offset:0
    ds_read_b64_tr_b16 a[174:175], v29 offset:512
    s_waitcnt lgkmcnt(0)
    v_mfma_f32_16x16x32_bf16 v[58:61], a[0:3], a[160:163], 0
    ds_read_b64_tr_b16 a[192:193], v26 offset:4096
    ds_read_b64_tr_b16 a[194:195], v26 offset:4608
    v_mfma_f32_16x16x32_bf16 v[74:77], a[8:11], a[160:163], 0
    ds_read_b64_tr_b16 a[196:197], v27 offset:4096
    ds_read_b64_tr_b16 a[198:199], v27 offset:4608
    v_mfma_f32_16x16x32_bf16 v[62:65], a[0:3], a[164:167], 0
    ds_read_b64_tr_b16 a[200:201], v28 offset:4096
    ds_read_b64_tr_b16 a[202:203], v28 offset:4608
    v_mfma_f32_16x16x32_bf16 v[78:81], a[8:11], a[164:167], 0
    ds_read_b64_tr_b16 a[204:205], v29 offset:4096
    ds_read_b64_tr_b16 a[206:207], v29 offset:4608
    v_mfma_f32_16x16x32_bf16 v[66:69], a[0:3], a[168:171], 0
    v_mfma_f32_16x16x32_bf16 v[82:85], a[8:11], a[168:171], 0
    v_mfma_f32_16x16x32_bf16 v[70:73], a[0:3], a[172:175], 0
    v_mfma_f32_16x16x32_bf16 v[86:89], a[8:11], a[172:175], 0
    s_waitcnt lgkmcnt(0)
    v_mfma_f32_16x16x32_bf16 v[58:61], a[4:7], a[192:195], v[58:61]
    ds_read_b64_tr_b16 a[160:161], v26 offset:8192
    ds_read_b64_tr_b16 a[162:163], v26 offset:8704
    v_mfma_f32_16x16x32_bf16 v[74:77], a[12:15], a[192:195], v[74:77]
    ds_read_b64_tr_b16 a[164:165], v27 offset:8192
    ds_read_b64_tr_b16 a[166:167], v27 offset:8704
    v_mfma_f32_16x16x32_bf16 v[62:65], a[4:7], a[196:199], v[62:65]
    ds_read_b64_tr_b16 a[168:169], v28 offset:8192
    ds_read_b64_tr_b16 a[170:171], v28 offset:8704
    v_mfma_f32_16x16x32_bf16 v[78:81], a[12:15], a[196:199], v[78:81]
    ds_read_b64_tr_b16 a[172:173], v29 offset:8192
    ds_read_b64_tr_b16 a[174:175], v29 offset:8704
    v_mfma_f32_16x16x32_bf16 v[66:69], a[4:7], a[200:203], v[66:69]
    v_mfma_f32_16x16x32_bf16 v[82:85], a[12:15], a[200:203], v[82:85]
    v_mfma_f32_16x16x32_bf16 v[70:73], a[4:7], a[204:207], v[70:73]
    v_mfma_f32_16x16x32_bf16 v[86:89], a[12:15], a[204:207], v[86:89]
    s_waitcnt lgkmcnt(0)
    v_mfma_f32_16x16x32_bf16 v[58:61], a[16:19], a[160:163], v[58:61]
    ds_read_b64_tr_b16 a[192:193], v26 offset:12288
    ds_read_b64_tr_b16 a[194:195], v26 offset:12800
    v_mfma_f32_16x16x32_bf16 v[74:77], a[24:27], a[160:163], v[74:77]
    ds_read_b64_tr_b16 a[196:197], v27 offset:12288
    ds_read_b64_tr_b16 a[198:199], v27 offset:12800
    v_mfma_f32_16x16x32_bf16 v[62:65], a[16:19], a[164:167], v[62:65]
    ds_read_b64_tr_b16 a[200:201], v28 offset:12288
    ds_read_b64_tr_b16 a[202:203], v28 offset:12800
    v_mfma_f32_16x16x32_bf16 v[78:81], a[24:27], a[164:167], v[78:81]
    ds_read_b64_tr_b16 a[204:205], v29 offset:12288
    ds_read_b64_tr_b16 a[206:207], v29 offset:12800
    v_mfma_f32_16x16x32_bf16 v[66:69], a[16:19], a[168:171], v[66:69]
    v_mfma_f32_16x16x32_bf16 v[82:85], a[24:27], a[168:171], v[82:85]
    v_mfma_f32_16x16x32_bf16 v[70:73], a[16:19], a[172:175], v[70:73]
    v_mfma_f32_16x16x32_bf16 v[86:89], a[24:27], a[172:175], v[86:89]
    s_waitcnt lgkmcnt(0)
    v_mfma_f32_16x16x32_bf16 v[58:61], a[20:23], a[192:195], v[58:61]
    ds_read_b64_tr_b16 a[160:161], v26 offset:16384
    ds_read_b64_tr_b16 a[162:163], v26 offset:16896
    v_mfma_f32_16x16x32_bf16 v[74:77], a[28:31], a[192:195], v[74:77]
    ds_read_b64_tr_b16 a[164:165], v27 offset:16384
    ds_read_b64_tr_b16 a[166:167], v27 offset:16896
    v_mfma_f32_16x16x32_bf16 v[62:65], a[20:23], a[196:199], v[62:65]
    ds_read_b64_tr_b16 a[168:169], v28 offset:16384
    ds_read_b64_tr_b16 a[170:171], v28 offset:16896
    v_mfma_f32_16x16x32_bf16 v[78:81], a[28:31], a[196:199], v[78:81]
    ds_read_b64_tr_b16 a[172:173], v29 offset:16384
    ds_read_b64_tr_b16 a[174:175], v29 offset:16896
    v_mfma_f32_16x16x32_bf16 v[66:69], a[20:23], a[200:203], v[66:69]
    v_mfma_f32_16x16x32_bf16 v[82:85], a[28:31], a[200:203], v[82:85]
    v_mfma_f32_16x16x32_bf16 v[70:73], a[20:23], a[204:207], v[70:73]
    v_mfma_f32_16x16x32_bf16 v[86:89], a[28:31], a[204:207], v[86:89]
    s_waitcnt lgkmcnt(0)
    v_mfma_f32_16x16x32_bf16 v[58:61], a[32:35], a[160:163], v[58:61]
    ds_read_b64_tr_b16 a[192:193], v26 offset:20480
    ds_read_b64_tr_b16 a[194:195], v26 offset:20992
    v_mfma_f32_16x16x32_bf16 v[74:77], a[40:43], a[160:163], v[74:77]
    ds_read_b64_tr_b16 a[196:197], v27 offset:20480
    ds_read_b64_tr_b16 a[198:199], v27 offset:20992
    v_mfma_f32_16x16x32_bf16 v[62:65], a[32:35], a[164:167], v[62:65]
    ds_read_b64_tr_b16 a[200:201], v28 offset:20480
    ds_read_b64_tr_b16 a[202:203], v28 offset:20992
    v_mfma_f32_16x16x32_bf16 v[78:81], a[40:43], a[164:167], v[78:81]
    ds_read_b64_tr_b16 a[204:205], v29 offset:20480
    ds_read_b64_tr_b16 a[206:207], v29 offset:20992
    v_mfma_f32_16x16x32_bf16 v[66:69], a[32:35], a[168:171], v[66:69]
    v_mfma_f32_16x16x32_bf16 v[82:85], a[40:43], a[168:171], v[82:85]
    v_mfma_f32_16x16x32_bf16 v[70:73], a[32:35], a[172:175], v[70:73]
    v_mfma_f32_16x16x32_bf16 v[86:89], a[40:43], a[172:175], v[86:89]
    s_waitcnt vmcnt(22) lgkmcnt(0)
    s_barrier
    v_mfma_f32_16x16x32_bf16 v[58:61], a[36:39], a[192:195], v[58:61]
    ds_read_b64_tr_b16 a[160:161], v26 offset:30848
    ds_read_b64_tr_b16 a[162:163], v26 offset:31360
    v_mfma_f32_16x16x32_bf16 v[74:77], a[44:47], a[192:195], v[74:77]
    ds_read_b64_tr_b16 a[164:165], v27 offset:30848
    ds_read_b64_tr_b16 a[166:167], v27 offset:31360
    v_mfma_f32_16x16x32_bf16 v[62:65], a[36:39], a[196:199], v[62:65]
    ds_read_b64_tr_b16 a[168:169], v28 offset:30848
    ds_read_b64_tr_b16 a[170:171], v28 offset:31360
    v_mfma_f32_16x16x32_bf16 v[78:81], a[44:47], a[196:199], v[78:81]
    ds_read_b64_tr_b16 a[172:173], v29 offset:30848
    ds_read_b64_tr_b16 a[174:175], v29 offset:31360
    v_mfma_f32_16x16x32_bf16 v[66:69], a[36:39], a[200:203], v[66:69]
    v_mfma_f32_16x16x32_bf16 v[82:85], a[44:47], a[200:203], v[82:85]
    v_mfma_f32_16x16x32_bf16 v[70:73], a[36:39], a[204:207], v[70:73]
    v_mfma_f32_16x16x32_bf16 v[86:89], a[44:47], a[204:207], v[86:89]
    s_waitcnt lgkmcnt(0)
    v_mfma_f32_16x16x32_bf16 v[58:61], a[48:51], a[160:163], v[58:61]
    ds_read_b64_tr_b16 a[192:193], v26 offset:34944
    ds_read_b64_tr_b16 a[194:195], v26 offset:35456
    v_mfma_f32_16x16x32_bf16 v[74:77], a[56:59], a[160:163], v[74:77]
    ds_read_b64_tr_b16 a[196:197], v27 offset:34944
    ds_read_b64_tr_b16 a[198:199], v27 offset:35456
    v_mfma_f32_16x16x32_bf16 v[62:65], a[48:51], a[164:167], v[62:65]
    ds_read_b64_tr_b16 a[200:201], v28 offset:34944
    ds_read_b64_tr_b16 a[202:203], v28 offset:35456
    v_mfma_f32_16x16x32_bf16 v[78:81], a[56:59], a[164:167], v[78:81]
    ds_read_b64_tr_b16 a[204:205], v29 offset:34944
    ds_read_b64_tr_b16 a[206:207], v29 offset:35456
    v_mfma_f32_16x16x32_bf16 v[66:69], a[48:51], a[168:171], v[66:69]
    v_mfma_f32_16x16x32_bf16 v[82:85], a[56:59], a[168:171], v[82:85]
    v_mfma_f32_16x16x32_bf16 v[70:73], a[48:51], a[172:175], v[70:73]
    v_mfma_f32_16x16x32_bf16 v[86:89], a[56:59], a[172:175], v[86:89]
    s_mov_b32 s7, 0xbfe10856
    s_mov_b32 s8, 409600
    v_bfe_u32 v54, s7, v50, 2
    v_mad_u32_u24 v54, v54, s6, v52
    s_add_u32 m0, s55, 0
    s_nop 0
    buffer_load_dwordx4 v54, s[84:87], s8 offen lds
    v_bfe_u32 v55, s7, v51, 2
    v_mad_u32_u24 v55, v55, s6, v53
    s_add_u32 m0, s55, 1024
    s_nop 0
    buffer_load_dwordx4 v55, s[84:87], s8 offen lds
    s_mov_b32 s7, 0xaff80255
    s_mov_b32 s8, 491520
    v_bfe_u32 v54, s7, v50, 2
    v_mad_u32_u24 v54, v54, s6, v52
    s_add_u32 m0, s55, 8192
    s_nop 0
    buffer_load_dwordx4 v54, s[84:87], s8 offen lds
    v_bfe_u32 v55, s7, v51, 2
    v_mad_u32_u24 v55, v55, s6, v53
    s_add_u32 m0, s55, 9216
    s_nop 0
    buffer_load_dwordx4 v55, s[84:87], s8 offen lds
    s_mov_b32 s7, 0xabfe4015
    s_mov_b32 s8, 573440
    v_bfe_u32 v54, s7, v50, 2
    v_mad_u32_u24 v54, v54, s6, v52
    s_add_u32 m0, s55, 16384
    s_nop 0
    buffer_load_dwordx4 v54, s[84:87], s8 offen lds
    v_bfe_u32 v55, s7, v51, 2
    v_mad_u32_u24 v55, v55, s6, v53
    s_add_u32 m0, s55, 17408
    s_nop 0
    buffer_load_dwordx4 v55, s[84:87], s8 offen lds
    s_waitcnt lgkmcnt(0)
    v_mfma_f32_16x16x32_bf16 v[58:61], a[52:55], a[192:195], v[58:61]
    ds_read_b64_tr_b16 a[160:161], v26 offset:39040
    ds_read_b64_tr_b16 a[162:163], v26 offset:39552
    v_mfma_f32_16x16x32_bf16 v[74:77], a[60:63], a[192:195], v[74:77]
    ds_read_b64_tr_b16 a[164:165], v27 offset:39040
    ds_read_b64_tr_b16 a[166:167], v27 offset:39552
    v_mfma_f32_16x16x32_bf16 v[62:65], a[52:55], a[196:199], v[62:65]
    ds_read_b64_tr_b16 a[168:169], v28 offset:39040
    ds_read_b64_tr_b16 a[170:171], v28 offset:39552
    v_mfma_f32_16x16x32_bf16 v[78:81], a[60:63], a[196:199], v[78:81]
    ds_read_b64_tr_b16 a[172:173], v29 offset:39040
    ds_read_b64_tr_b16 a[174:175], v29 offset:39552
    v_mfma_f32_16x16x32_bf16 v[66:69], a[52:55], a[200:203], v[66:69]
    v_mfma_f32_16x16x32_bf16 v[82:85], a[60:63], a[200:203], v[82:85]
    v_mfma_f32_16x16x32_bf16 v[70:73], a[52:55], a[204:207], v[70:73]
    v_mfma_f32_16x16x32_bf16 v[86:89], a[60:63], a[204:207], v[86:89]
    s_waitcnt lgkmcnt(0)
    v_mfma_f32_16x16x32_bf16 v[58:61], a[64:67], a[160:163], v[58:61]
    ds_read_b64_tr_b16 a[192:193], v26 offset:43136
    ds_read_b64_tr_b16 a[194:195], v26 offset:43648
    v_mfma_f32_16x16x32_bf16 v[74:77], a[72:75], a[160:163], v[74:77]
    ds_read_b64_tr_b16 a[196:197], v27 offset:43136
    ds_read_b64_tr_b16 a[198:199], v27 offset:43648
    v_mfma_f32_16x16x32_bf16 v[62:65], a[64:67], a[164:167], v[62:65]
    ds_read_b64_tr_b16 a[200:201], v28 offset:43136
    ds_read_b64_tr_b16 a[202:203], v28 offset:43648
    v_mfma_f32_16x16x32_bf16 v[78:81], a[72:75], a[164:167], v[78:81]
    ds_read_b64_tr_b16 a[204:205], v29 offset:43136
    ds_read_b64_tr_b16 a[206:207], v29 offset:43648
    v_mfma_f32_16x16x32_bf16 v[66:69], a[64:67], a[168:171], v[66:69]
    v_mfma_f32_16x16x32_bf16 v[82:85], a[72:75], a[168:171], v[82:85]
    v_mfma_f32_16x16x32_bf16 v[70:73], a[64:67], a[172:175], v[70:73]
    v_mfma_f32_16x16x32_bf16 v[86:89], a[72:75], a[172:175], v[86:89]
    s_waitcnt lgkmcnt(0)
    v_mfma_f32_16x16x32_bf16 v[58:61], a[68:71], a[192:195], v[58:61]
    ds_read_b64_tr_b16 a[160:161], v26 offset:47232
    ds_read_b64_tr_b16 a[162:163], v26 offset:47744
    v_mfma_f32_16x16x32_bf16 v[74:77], a[76:79], a[192:195], v[74:77]
    ds_read_b64_tr_b16 a[164:165], v27 offset:47232
    ds_read_b64_tr_b16 a[166:167], v27 offset:47744
    v_mfma_f32_16x16x32_bf16 v[62:65], a[68:71], a[196:199], v[62:65]
    ds_read_b64_tr_b16 a[168:169], v28 offset:47232
    ds_read_b64_tr_b16 a[170:171], v28 offset:47744
    v_mfma_f32_16x16x32_bf16 v[78:81], a[76:79], a[196:199], v[78:81]
    ds_read_b64_tr_b16 a[172:173], v29 offset:47232
    ds_read_b64_tr_b16 a[174:175], v29 offset:47744
    v_mfma_f32_16x16x32_bf16 v[66:69], a[68:71], a[200:203], v[66:69]
    v_mfma_f32_16x16x32_bf16 v[82:85], a[76:79], a[200:203], v[82:85]
    v_mfma_f32_16x16x32_bf16 v[70:73], a[68:71], a[204:207], v[70:73]
    v_mfma_f32_16x16x32_bf16 v[86:89], a[76:79], a[204:207], v[86:89]
    s_waitcnt lgkmcnt(0)
    v_mfma_f32_16x16x32_bf16 v[58:61], a[80:83], a[160:163], v[58:61]
    ds_read_b64_tr_b16 a[192:193], v26 offset:51328
    ds_read_b64_tr_b16 a[194:195], v26 offset:51840
    v_mfma_f32_16x16x32_bf16 v[74:77], a[88:91], a[160:163], v[74:77]
    ds_read_b64_tr_b16 a[196:197], v27 offset:51328
    ds_read_b64_tr_b16 a[198:199], v27 offset:51840
    v_mfma_f32_16x16x32_bf16 v[62:65], a[80:83], a[164:167], v[62:65]
    ds_read_b64_tr_b16 a[200:201], v28 offset:51328
    ds_read_b64_tr_b16 a[202:203], v28 offset:51840
    v_mfma_f32_16x16x32_bf16 v[78:81], a[88:91], a[164:167], v[78:81]
    ds_read_b64_tr_b16 a[204:205], v29 offset:51328
    ds_read_b64_tr_b16 a[206:207], v29 offset:51840
    v_mfma_f32_16x16x32_bf16 v[66:69], a[80:83], a[168:171], v[66:69]
    v_mfma_f32_16x16x32_bf16 v[82:85], a[88:91], a[168:171], v[82:85]
    v_mfma_f32_16x16x32_bf16 v[70:73], a[80:83], a[172:175], v[70:73]
    v_mfma_f32_16x16x32_bf16 v[86:89], a[88:91], a[172:175], v[86:89]
    s_waitcnt vmcnt(22) lgkmcnt(0)
    s_barrier
    v_mfma_f32_16x16x32_bf16 v[58:61], a[84:87], a[192:195], v[58:61]
    ds_read_b64_tr_b16 a[160:161], v30 offset:0
    ds_read_b64_tr_b16 a[162:163], v30 offset:512
    v_mfma_f32_16x16x32_bf16 v[74:77], a[92:95], a[192:195], v[74:77]
    ds_read_b64_tr_b16 a[164:165], v31 offset:0
    ds_read_b64_tr_b16 a[166:167], v31 offset:512
    v_mfma_f32_16x16x32_bf16 v[62:65], a[84:87], a[196:199], v[62:65]
    ds_read_b64_tr_b16 a[168:169], v32 offset:0
    ds_read_b64_tr_b16 a[170:171], v32 offset:512
    v_mfma_f32_16x16x32_bf16 v[78:81], a[92:95], a[196:199], v[78:81]
    ds_read_b64_tr_b16 a[172:173], v33 offset:0
    ds_read_b64_tr_b16 a[174:175], v33 offset:512
    v_mfma_f32_16x16x32_bf16 v[66:69], a[84:87], a[200:203], v[66:69]
    v_mfma_f32_16x16x32_bf16 v[82:85], a[92:95], a[200:203], v[82:85]
    v_mfma_f32_16x16x32_bf16 v[70:73], a[84:87], a[204:207], v[70:73]
    v_mfma_f32_16x16x32_bf16 v[86:89], a[92:95], a[204:207], v[86:89]
    s_waitcnt lgkmcnt(0)
    v_mfma_f32_16x16x32_bf16 v[58:61], a[96:99], a[160:163], v[58:61]
    ds_read_b64_tr_b16 a[192:193], v30 offset:4096
    ds_read_b64_tr_b16 a[194:195], v30 offset:4608
    v_mfma_f32_16x16x32_bf16 v[74:77], a[104:107], a[160:163], v[74:77]
    ds_read_b64_tr_b16 a[196:197], v31 offset:4096
    ds_read_b64_tr_b16 a[198:199], v31 offset:4608
    v_mfma_f32_16x16x32_bf16 v[62:65], a[96:99], a[164:167], v[62:65]
    ds_read_b64_tr_b16 a[200:201], v32 offset:4096
    ds_read_b64_tr_b16 a[202:203], v32 offset:4608
    v_mfma_f32_16x16x32_bf16 v[78:81], a[104:107], a[164:167], v[78:81]
    ds_read_b64_tr_b16 a[204:205], v33 offset:4096
    ds_read_b64_tr_b16 a[206:207], v33 offset:4608
    v_mfma_f32_16x16x32_bf16 v[66:69], a[96:99], a[168:171], v[66:69]
    v_mfma_f32_16x16x32_bf16 v[82:85], a[104:107], a[168:171], v[82:85]
    v_mfma_f32_16x16x32_bf16 v[70:73], a[96:99], a[172:175], v[70:73]
    v_mfma_f32_16x16x32_bf16 v[86:89], a[104:107], a[172:175], v[86:89]
    s_mov_b32 s7, 0xaa7fd005
    s_mov_b32 s8, 655360
    v_bfe_u32 v54, s7, v50, 2
    v_mad_u32_u24 v54, v54, s6, v52
    s_add_u32 m0, s55, 30848
    s_nop 0
    buffer_load_dwordx4 v54, s[84:87], s8 offen lds
    v_bfe_u32 v55, s7, v51, 2
    v_mad_u32_u24 v55, v55, s6, v53
    s_add_u32 m0, s55, 31872
    s_nop 0
    buffer_load_dwordx4 v55, s[84:87], s8 offen lds
    s_mov_b32 s7, 0x6adfb401
    s_mov_b32 s8, 737280
    v_bfe_u32 v54, s7, v50, 2
    v_mad_u32_u24 v54, v54, s6, v52
    s_add_u32 m0, s55, 39040
    s_nop 0
    buffer_load_dwordx4 v54, s[84:87], s8 offen lds
    v_bfe_u32 v55, s7, v51, 2
    v_mad_u32_u24 v55, v55, s6, v53
    s_add_u32 m0, s55, 40064
    s_nop 0
    buffer_load_dwordx4 v55, s[84:87], s8 offen lds
    s_waitcnt lgkmcnt(0)
    v_mfma_f32_16x16x32_bf16 v[58:61], a[100:103], a[192:195], v[58:61]
    ds_read_b64_tr_b16 a[160:161], v30 offset:8192
    ds_read_b64_tr_b16 a[162:163], v30 offset:8704
    v_mfma_f32_16x16x32_bf16 v[74:77], a[108:111], a[192:195], v[74:77]
    ds_read_b64_tr_b16 a[164:165], v31 offset:8192
    ds_read_b64_tr_b16 a[166:167], v31 offset:8704
    v_mfma_f32_16x16x32_bf16 v[62:65], a[100:103], a[196:199], v[62:65]
    ds_read_b64_tr_b16 a[168:169], v32 offset:8192
    ds_read_b64_tr_b16 a[170:171], v32 offset:8704
    v_mfma_f32_16x16x32_bf16 v[78:81], a[108:111], a[196:199], v[78:81]
    ds_read_b64_tr_b16 a[172:173], v33 offset:8192
    ds_read_b64_tr_b16 a[174:175], v33 offset:8704
    v_mfma_f32_16x16x32_bf16 v[66:69], a[100:103], a[200:203], v[66:69]
    v_mfma_f32_16x16x32_bf16 v[82:85], a[108:111], a[200:203], v[82:85]
    v_mfma_f32_16x16x32_bf16 v[70:73], a[100:103], a[204:207], v[70:73]
    v_mfma_f32_16x16x32_bf16 v[86:89], a[108:111], a[204:207], v[86:89]
    s_waitcnt lgkmcnt(0)
    v_mfma_f32_16x16x32_bf16 v[58:61], a[112:115], a[160:163], v[58:61]
    ds_read_b64_tr_b16 a[192:193], v30 offset:12288
    ds_read_b64_tr_b16 a[194:195], v30 offset:12800
    v_mfma_f32_16x16x32_bf16 v[74:77], a[120:123], a[160:163], v[74:77]
    ds_read_b64_tr_b16 a[196:197], v31 offset:12288
    ds_read_b64_tr_b16 a[198:199], v31 offset:12800
    v_mfma_f32_16x16x32_bf16 v[62:65], a[112:115], a[164:167], v[62:65]
    ds_read_b64_tr_b16 a[200:201], v32 offset:12288
    ds_read_b64_tr_b16 a[202:203], v32 offset:12800
    v_mfma_f32_16x16x32_bf16 v[78:81], a[120:123], a[164:167], v[78:81]
    ds_read_b64_tr_b16 a[204:205], v33 offset:12288
    ds_read_b64_tr_b16 a[206:207], v33 offset:12800
    v_mfma_f32_16x16x32_bf16 v[66:69], a[112:115], a[168:171], v[66:69]
    v_mfma_f32_16x16x32_bf16 v[82:85], a[120:123], a[168:171], v[82:85]
    v_mfma_f32_16x16x32_bf16 v[70:73], a[112:115], a[172:175], v[70:73]
    v_mfma_f32_16x16x32_bf16 v[86:89], a[120:123], a[172:175], v[86:89]
    s_waitcnt lgkmcnt(0)
    v_mfma_f32_16x16x32_bf16 v[58:61], a[116:119], a[192:195], v[58:61]
    ds_read_b64_tr_b16 a[160:161], v30 offset:16384
    ds_read_b64_tr_b16 a[162:163], v30 offset:16896
    v_mfma_f32_16x16x32_bf16 v[74:77], a[124:127], a[192:195], v[74:77]
    ds_read_b64_tr_b16 a[164:165], v31 offset:16384
    ds_read_b64_tr_b16 a[166:167], v31 offset:16896
    v_mfma_f32_16x16x32_bf16 v[62:65], a[116:119], a[196:199], v[62:65]
    ds_read_b64_tr_b16 a[168:169], v32 offset:16384
    ds_read_b64_tr_b16 a[170:171], v32 offset:16896
    v_mfma_f32_16x16x32_bf16 v[78:81], a[124:127], a[196:199], v[78:81]
    ds_read_b64_tr_b16 a[172:173], v33 offset:16384
    ds_read_b64_tr_b16 a[174:175], v33 offset:16896
    v_mfma_f32_16x16x32_bf16 v[66:69], a[116:119], a[200:203], v[66:69]
    v_mfma_f32_16x16x32_bf16 v[82:85], a[124:127], a[200:203], v[82:85]
    v_mfma_f32_16x16x32_bf16 v[70:73], a[116:119], a[204:207], v[70:73]
    v_mfma_f32_16x16x32_bf16 v[86:89], a[124:127], a[204:207], v[86:89]
    s_waitcnt lgkmcnt(0)
    v_mfma_f32_16x16x32_bf16 v[58:61], a[128:131], a[160:163], v[58:61]
    ds_read_b64_tr_b16 a[192:193], v30 offset:20480
    ds_read_b64_tr_b16 a[194:195], v30 offset:20992
    v_mfma_f32_16x16x32_bf16 v[74:77], a[136:139], a[160:163], v[74:77]
    ds_read_b64_tr_b16 a[196:197], v31 offset:20480
    ds_read_b64_tr_b16 a[198:199], v31 offset:20992
    v_mfma_f32_16x16x32_bf16 v[62:65], a[128:131], a[164:167], v[62:65]
    ds_read_b64_tr_b16 a[200:201], v32 offset:20480
    ds_read_b64_tr_b16 a[202:203], v32 offset:20992
    v_mfma_f32_16x16x32_bf16 v[78:81], a[136:139], a[164:167], v[78:81]
    ds_read_b64_tr_b16 a[204:205], v33 offset:20480
    ds_read_b64_tr_b16 a[206:207], v33 offset:20992
    v_mfma_f32_16x16x32_bf16 v[66:69], a[128:131], a[168:171], v[66:69]
    v_mfma_f32_16x16x32_bf16 v[82:85], a[136:139], a[168:171], v[82:85]
    v_mfma_f32_16x16x32_bf16 v[70:73], a[128:131], a[172:175], v[70:73]
    v_mfma_f32_16x16x32_bf16 v[86:89], a[136:139], a[172:175], v[86:89]
    s_waitcnt vmcnt(24) lgkmcnt(0)
    s_barrier
    v_mfma_f32_16x16x32_bf16 v[58:61], a[132:135], a[192:195], v[58:61]
    ds_read_b64_tr_b16 a[160:161], v30 offset:30848
    ds_read_b64_tr_b16 a[162:163], v30 offset:31360
    v_mfma_f32_16x16x32_bf16 v[74:77], a[140:143], a[192:195], v[74:77]
    ds_read_b64_tr_b16 a[164:165], v31 offset:30848
    ds_read_b64_tr_b16 a[166:167], v31 offset:31360
    v_mfma_f32_16x16x32_bf16 v[62:65], a[132:135], a[196:199], v[62:65]
    ds_read_b64_tr_b16 a[168:169], v32 offset:30848
    ds_read_b64_tr_b16 a[170:171], v32 offset:31360
    v_mfma_f32_16x16x32_bf16 v[78:81], a[140:143], a[196:199], v[78:81]
    ds_read_b64_tr_b16 a[172:173], v33 offset:30848
    ds_read_b64_tr_b16 a[174:175], v33 offset:31360
    v_mfma_f32_16x16x32_bf16 v[66:69], a[132:135], a[200:203], v[66:69]
    v_mfma_f32_16x16x32_bf16 v[82:85], a[140:143], a[200:203], v[82:85]
    v_mfma_f32_16x16x32_bf16 v[70:73], a[132:135], a[204:207], v[70:73]
    v_mfma_f32_16x16x32_bf16 v[86:89], a[140:143], a[204:207], v[86:89]
    s_waitcnt lgkmcnt(0)
    v_mfma_f32_16x16x32_bf16 v[58:61], a[144:147], a[160:163], v[58:61]
    ds_read_b64_tr_b16 a[192:193], v30 offset:34944
    ds_read_b64_tr_b16 a[194:195], v30 offset:35456
    v_mfma_f32_16x16x32_bf16 v[74:77], a[152:155], a[160:163], v[74:77]
    ds_read_b64_tr_b16 a[196:197], v31 offset:34944
    ds_read_b64_tr_b16 a[198:199], v31 offset:35456
    v_mfma_f32_16x16x32_bf16 v[62:65], a[144:147], a[164:167], v[62:65]
    ds_read_b64_tr_b16 a[200:201], v32 offset:34944
    ds_read_b64_tr_b16 a[202:203], v32 offset:35456
    v_mfma_f32_16x16x32_bf16 v[78:81], a[152:155], a[164:167], v[78:81]
    ds_read_b64_tr_b16 a[204:205], v33 offset:34944
    ds_read_b64_tr_b16 a[206:207], v33 offset:35456
    v_mfma_f32_16x16x32_bf16 v[66:69], a[144:147], a[168:171], v[66:69]
    v_mfma_f32_16x16x32_bf16 v[82:85], a[152:155], a[168:171], v[82:85]
    v_mfma_f32_16x16x32_bf16 v[70:73], a[144:147], a[172:175], v[70:73]
    v_mfma_f32_16x16x32_bf16 v[86:89], a[152:155], a[172:175], v[86:89]
    s_sub_u32 s56, s4, 6144
    s_add_u32 s57, s4, 12288
    s_mov_b32 s22, s56
    s_mov_b32 s23, s57
    buffer_load_dwordx4 v[90:93], v38, s[44:47], s22 offen offset:0 sc1
    buffer_load_dwordx4 v[94:97], v38, s[44:47], s22 offen offset:1024 sc1
    buffer_load_dwordx4 v[98:101], v38, s[44:47], s23 offen offset:0 sc1
    buffer_load_dwordx4 v[102:105], v38, s[44:47], s23 offen offset:1024 sc1
    s_waitcnt lgkmcnt(0)
    v_mfma_f32_16x16x32_bf16 v[58:61], a[148:151], a[192:195], v[58:61]
    v_mfma_f32_16x16x32_bf16 v[74:77], a[156:159], a[192:195], v[74:77]
    v_mfma_f32_16x16x32_bf16 v[62:65], a[148:151], a[196:199], v[62:65]
    v_mfma_f32_16x16x32_bf16 v[78:81], a[156:159], a[196:199], v[78:81]
    v_mfma_f32_16x16x32_bf16 v[66:69], a[148:151], a[200:203], v[66:69]
    v_mfma_f32_16x16x32_bf16 v[82:85], a[156:159], a[200:203], v[82:85]
    v_mfma_f32_16x16x32_bf16 v[70:73], a[148:151], a[204:207], v[70:73]
    v_mfma_f32_16x16x32_bf16 v[86:89], a[156:159], a[204:207], v[86:89]
    s_nop 1
    ds_write_b128 v17, v[74:77] offset:0
    s_nop 0
    ds_write_b128 v17, v[78:81] offset:1024
    s_nop 0
    ds_write_b128 v17, v[82:85] offset:2048
    s_nop 0
    ds_write_b128 v17, v[86:89] offset:3072
    s_lshl_b32 s56, s3, 8
    s_add_u32 s56, s56, 157312
    v_lshl_add_u32 v18, v3, 4, s56
    ds_write_b32 v18, v58 offset:0
    ds_write_b32 v18, v62 offset:4
    ds_write_b32 v18, v66 offset:8
    ds_write_b32 v18, v70 offset:12
    s_waitcnt vmcnt(0) lgkmcnt(0)
    s_barrier
    s_cmp_eq_u32 s3, 0
    s_cbranch_scc1 Lwave0
    ds_read_b128 v[106:109], v19 offset:0
    ds_read_b128 v[110:113], v19 offset:1024
    ds_read_b128 v[114:117], v19 offset:2048
    ds_read_b128 v[118:121], v19 offset:3072
    v_lshlrev_b32 v18, 4, v3
    v_add_u32 v18, 157312, v18
    ds_read_b128 v[40:43], v18
    s_lshl_b32 s56, s3, 7
    s_add_u32 s56, s56, 154176
    v_lshl_add_u32 v4, v2, 4, s56
    ds_read_b128 v[122:125], v4 offset:0
    ds_read_b128 v[180:183], v4 offset:512
    ds_read_b128 v[126:129], v4 offset:64
    ds_read_b128 v[184:187], v4 offset:576
    ds_read_b128 v[130:133], v4 offset:128
    ds_read_b128 v[188:191], v4 offset:640
Lrx_chk:
    s_mov_b64 s[56:57], -1
    s_mov_b64 s[58:59], -1
    v_cmp_eq_u32 vcc, s53, v91
    s_nop 0
    s_and_b64 s[56:57], s[56:57], vcc
    v_cmp_eq_u32 vcc, s53, v93
    s_nop 0
    s_and_b64 s[56:57], s[56:57], vcc
    v_cmp_eq_u32 vcc, s53, v95
    s_nop 0
    s_and_b64 s[56:57], s[56:57], vcc
    v_cmp_eq_u32 vcc, s53, v97
    s_nop 0
    s_and_b64 s[56:57], s[56:57], vcc
    v_cmp_eq_u32 vcc, s53, v99
    s_nop 0
    s_and_b64 s[58:59], s[58:59], vcc
    v_cmp_eq_u32 vcc, s53, v101
    s_nop 0
    s_and_b64 s[58:59], s[58:59], vcc
    v_cmp_eq_u32 vcc, s53, v103
    s_nop 0
    s_and_b64 s[58:59], s[58:59], vcc
    v_cmp_eq_u32 vcc, s53, v105
    s_nop 0
    s_and_b64 s[58:59], s[58:59], vcc
    s_cmp_eq_u32 s52, 0
    s_cselect_b64 s[56:57], -1, s[56:57]
    s_cmp_eq_u32 s52, 4
    s_cselect_b64 s[58:59], -1, s[58:59]
    s_and_b64 s[56:57], s[56:57], s[58:59]
    s_cmp_eq_u64 s[56:57], -1
    s_cbranch_scc1 Lrx_ok
    s_sub_u32 s54, s54, 1
    s_cbranch_scc1 Lend
    buffer_load_dwordx4 v[90:93], v38, s[44:47], s22 offen offset:0 sc1
    buffer_load_dwordx4 v[94:97], v38, s[44:47], s22 offen offset:1024 sc1
    buffer_load_dwordx4 v[98:101], v38, s[44:47], s23 offen offset:0 sc1
    buffer_load_dwordx4 v[102:105], v38, s[44:47], s23 offen offset:1024 sc1
    s_waitcnt vmcnt(0)
    s_branch Lrx_chk
Lrx_ok:
    s_cmp_eq_u32 s52, 0
    s_cselect_b64 vcc, -1, 0
    v_cndmask_b32 v90, v90, 0, vcc
    v_add_f32 v144, v144, v90
    v_cndmask_b32 v92, v92, 0, vcc
    v_add_f32 v146, v146, v92
    v_cndmask_b32 v94, v94, 0, vcc
    v_add_f32 v160, v160, v94
    v_cndmask_b32 v96, v96, 0, vcc
    v_add_f32 v162, v162, v96
    s_cmp_eq_u32 s52, 4
    s_cselect_b64 vcc, -1, 0
    v_cndmask_b32 v98, v98, 0, vcc
    v_add_f32 v156, v156, v98
    v_cndmask_b32 v100, v100, 0, vcc
    v_add_f32 v158, v158, v100
    v_cndmask_b32 v102, v102, 0, vcc
    v_add_f32 v172, v172, v102
    v_cndmask_b32 v104, v104, 0, vcc
    v_add_f32 v174, v174, v104
    v_max_f32 v4, v144, v146
    v_max_f32 v5, v160, v162
    v_max_f32 v6, v156, v158
    v_max_f32 v7, v172, v174
    v_mov_b32 v8, v4
    v_mov_b32 v9, v5
    v_mov_b32 v10, v6
    v_mov_b32 v11, v7
    v_permlane32_swap_b32 v4, v8
    v_permlane32_swap_b32 v5, v9
    v_permlane32_swap_b32 v6, v10
    v_permlane32_swap_b32 v7, v11
    v_max_f32 v4, v4, v8
    v_max_f32 v5, v5, v9
    v_max_f32 v6, v6, v10
    v_max_f32 v7, v7, v11
    v_mov_b32 v8, v4
    v_mov_b32 v9, v5
    v_mov_b32 v10, v6
    v_mov_b32 v11, v7
    v_permlane16_swap_b32 v4, v8
    v_permlane16_swap_b32 v5, v9
    v_permlane16_swap_b32 v6, v10
    v_permlane16_swap_b32 v7, v11
    v_max_f32 v4, v4, v8
    v_max_f32 v5, v5, v9
    v_max_f32 v6, v6, v10
    v_max_f32 v7, v7, v11
    v_mul_f32 v4, s9, v4
    v_mul_f32 v5, s9, v5
    v_mul_f32 v6, s9, v6
    v_mul_f32 v7, s9, v7
    v_fma_f32 v144, v144, s9, -v4
    v_fma_f32 v146, v146, s9, -v4
    v_fma_f32 v160, v160, s9, -v5
    v_fma_f32 v162, v162, s9, -v5
    v_fma_f32 v156, v156, s9, -v6
    v_fma_f32 v158, v158, s9, -v6
    v_fma_f32 v172, v172, s9, -v7
    v_fma_f32 v174, v174, s9, -v7
    v_exp_f32 v144, v144
    v_exp_f32 v146, v146
    v_exp_f32 v160, v160
    v_exp_f32 v162, v162
    v_exp_f32 v156, v156
    v_exp_f32 v158, v158
    v_exp_f32 v172, v172
    v_exp_f32 v174, v174
    v_cvt_pk_bf16_f32 v144, v144, v144
    v_cvt_pk_bf16_f32 v145, v146, v146
    v_cvt_pk_bf16_f32 v160, v160, v160
    v_cvt_pk_bf16_f32 v161, v162, v162
    v_cvt_pk_bf16_f32 v156, v156, v156
    v_cvt_pk_bf16_f32 v157, v158, v158
    v_cvt_pk_bf16_f32 v172, v172, v172
    v_cvt_pk_bf16_f32 v173, v174, v174
    v_and_b32 v146, v144, v178
    v_and_b32 v147, v145, v179
    v_and_b32 v144, v144, v176
    v_and_b32 v145, v145, v177
    v_and_b32 v162, v160, v178
    v_and_b32 v163, v161, v179
    v_and_b32 v160, v160, v176
    v_and_b32 v161, v161, v177
    v_and_b32 v158, v156, v178
    v_and_b32 v159, v157, v179
    v_and_b32 v156, v156, v176
    v_and_b32 v157, v157, v177
    v_and_b32 v174, v172, v178
    v_and_b32 v175, v173, v179
    v_and_b32 v172, v172, v176
    v_and_b32 v173, v173, v177
    s_waitcnt lgkmcnt(0)
    v_pk_fma_f32 v[106:107], v[122:123], v[40:41], v[106:107] op_sel_hi:[1,0,1]
    v_pk_fma_f32 v[108:109], v[124:125], v[40:41], v[108:109] op_sel_hi:[1,0,1]
    v_pk_mul_f32 v[106:107], v[106:107], v[180:181]
    v_pk_mul_f32 v[108:109], v[108:109], v[182:183]
    v_cvt_pk_bf16_f32 v192, v106, v107
    v_cvt_pk_bf16_f32 v193, v108, v109
    v_pk_fma_f32 v[58:59], v[126:127], v[40:41], v[58:59] op_sel_hi:[1,0,1]
    v_pk_fma_f32 v[60:61], v[128:129], v[40:41], v[60:61] op_sel_hi:[1,0,1]
    v_pk_mul_f32 v[58:59], v[58:59], v[184:185]
    v_pk_mul_f32 v[60:61], v[60:61], v[186:187]
    v_cvt_pk_bf16_f32 v194, v58, v59
    v_cvt_pk_bf16_f32 v195, v60, v61
    v_pk_fma_f32 v[74:75], v[130:131], v[40:41], v[74:75] op_sel_hi:[1,0,1]
    v_pk_fma_f32 v[76:77], v[132:133], v[40:41], v[76:77] op_sel_hi:[1,0,1]
    v_pk_mul_f32 v[74:75], v[74:75], v[188:189]
    v_pk_mul_f32 v[76:77], v[76:77], v[190:191]
    v_cvt_pk_bf16_f32 v196, v74, v75
    v_cvt_pk_bf16_f32 v197, v76, v77
    v_pk_fma_f32 v[110:111], v[122:123], v[40:41], v[110:111] op_sel:[0,1,0] op_sel_hi:[1,1,1]
    v_pk_fma_f32 v[112:113], v[124:125], v[40:41], v[112:113] op_sel:[0,1,0] op_sel_hi:[1,1,1]
    v_pk_mul_f32 v[110:111], v[110:111], v[180:181]
    v_pk_mul_f32 v[112:113], v[112:113], v[182:183]
    v_cvt_pk_bf16_f32 v198, v110, v111
    v_cvt_pk_bf16_f32 v199, v112, v113
    v_pk_fma_f32 v[62:63], v[126:127], v[40:41], v[62:63] op_sel:[0,1,0] op_sel_hi:[1,1,1]
    v_pk_fma_f32 v[64:65], v[128:129], v[40:41], v[64:65] op_sel:[0,1,0] op_sel_hi:[1,1,1]
    v_pk_mul_f32 v[62:63], v[62:63], v[184:185]
    v_pk_mul_f32 v[64:65], v[64:65], v[186:187]
    v_cvt_pk_bf16_f32 v200, v62, v63
    v_cvt_pk_bf16_f32 v201, v64, v65
    v_pk_fma_f32 v[78:79], v[130:131], v[40:41], v[78:79] op_sel:[0,1,0] op_sel_hi:[1,1,1]
    v_pk_fma_f32 v[80:81], v[132:133], v[40:41], v[80:81] op_sel:[0,1,0] op_sel_hi:[1,1,1]
    v_pk_mul_f32 v[78:79], v[78:79], v[188:189]
    v_pk_mul_f32 v[80:81], v[80:81], v[190:191]
    v_cvt_pk_bf16_f32 v202, v78, v79
    v_cvt_pk_bf16_f32 v203, v80, v81
    v_pk_fma_f32 v[114:115], v[122:123], v[42:43], v[114:115] op_sel_hi:[1,0,1]
    v_pk_fma_f32 v[116:117], v[124:125], v[42:43], v[116:117] op_sel_hi:[1,0,1]
    v_pk_mul_f32 v[114:115], v[114:115], v[180:181]
    v_pk_mul_f32 v[116:117], v[116:117], v[182:183]
    v_cvt_pk_bf16_f32 v204, v114, v115
    v_cvt_pk_bf16_f32 v205, v116, v117
    v_pk_fma_f32 v[66:67], v[126:127], v[42:43], v[66:67] op_sel_hi:[1,0,1]
    v_pk_fma_f32 v[68:69], v[128:129], v[42:43], v[68:69] op_sel_hi:[1,0,1]
    v_pk_mul_f32 v[66:67], v[66:67], v[184:185]
    v_pk_mul_f32 v[68:69], v[68:69], v[186:187]
    v_cvt_pk_bf16_f32 v206, v66, v67
    v_cvt_pk_bf16_f32 v207, v68, v69
    v_pk_fma_f32 v[82:83], v[130:131], v[42:43], v[82:83] op_sel_hi:[1,0,1]
    v_pk_fma_f32 v[84:85], v[132:133], v[42:43], v[84:85] op_sel_hi:[1,0,1]
    v_pk_mul_f32 v[82:83], v[82:83], v[188:189]
    v_pk_mul_f32 v[84:85], v[84:85], v[190:191]
    v_cvt_pk_bf16_f32 v208, v82, v83
    v_cvt_pk_bf16_f32 v209, v84, v85
    v_pk_fma_f32 v[118:119], v[122:123], v[42:43], v[118:119] op_sel:[0,1,0] op_sel_hi:[1,1,1]
    v_pk_fma_f32 v[120:121], v[124:125], v[42:43], v[120:121] op_sel:[0,1,0] op_sel_hi:[1,1,1]
    v_pk_mul_f32 v[118:119], v[118:119], v[180:181]
    v_pk_mul_f32 v[120:121], v[120:121], v[182:183]
    v_cvt_pk_bf16_f32 v210, v118, v119
    v_cvt_pk_bf16_f32 v211, v120, v121
    v_pk_fma_f32 v[70:71], v[126:127], v[42:43], v[70:71] op_sel:[0,1,0] op_sel_hi:[1,1,1]
    v_pk_fma_f32 v[72:73], v[128:129], v[42:43], v[72:73] op_sel:[0,1,0] op_sel_hi:[1,1,1]
    v_pk_mul_f32 v[70:71], v[70:71], v[184:185]
    v_pk_mul_f32 v[72:73], v[72:73], v[186:187]
    v_cvt_pk_bf16_f32 v212, v70, v71
    v_cvt_pk_bf16_f32 v213, v72, v73
    v_pk_fma_f32 v[86:87], v[130:131], v[42:43], v[86:87] op_sel:[0,1,0] op_sel_hi:[1,1,1]
    v_pk_fma_f32 v[88:89], v[132:133], v[42:43], v[88:89] op_sel:[0,1,0] op_sel_hi:[1,1,1]
    v_pk_mul_f32 v[86:87], v[86:87], v[188:189]
    v_pk_mul_f32 v[88:89], v[88:89], v[190:191]
    v_cvt_pk_bf16_f32 v214, v86, v87
    v_cvt_pk_bf16_f32 v215, v88, v89
    v_mfma_f32_16x16x32_bf16 v[102:105], v[20:23], v[144:147], 0
    v_mfma_f32_16x16x32_bf16 v[106:109], v[20:23], v[148:151], 0
    v_mfma_f32_16x16x32_bf16 v[110:113], v[20:23], v[152:155], 0
    v_mfma_f32_16x16x32_bf16 v[114:117], v[20:23], v[156:159], 0
    v_mfma_f32_16x16x32_bf16 v[118:121], v[20:23], v[160:163], 0
    v_mfma_f32_16x16x32_bf16 v[122:125], v[20:23], v[164:167], 0
    v_mfma_f32_16x16x32_bf16 v[126:129], v[20:23], v[168:171], 0
    v_mfma_f32_16x16x32_bf16 v[130:133], v[20:23], v[172:175], 0
    v_mfma_f32_16x16x32_bf16 v[38:41], v[192:195], v[148:151], 0
    v_mfma_f32_16x16x32_bf16 v[42:45], v[198:201], v[148:151], 0
    v_mfma_f32_16x16x32_bf16 v[46:49], v[198:201], v[144:147], 0
    v_mfma_f32_16x16x32_bf16 v[50:53], v[198:201], v[156:159], 0
    v_mfma_f32_16x16x32_bf16 v[54:57], v[204:207], v[152:155], 0
    v_mfma_f32_16x16x32_bf16 v[58:61], v[204:207], v[144:147], 0
    v_mfma_f32_16x16x32_bf16 v[62:65], v[204:207], v[156:159], 0
    v_mfma_f32_16x16x32_bf16 v[66:69], v[210:213], v[152:155], 0
    v_mfma_f32_16x16x32_bf16 v[70:73], v[194:197], v[164:167], 0
    v_mfma_f32_16x16x32_bf16 v[74:77], v[200:203], v[164:167], 0
    v_mfma_f32_16x16x32_bf16 v[78:81], v[200:203], v[160:163], 0
    v_mfma_f32_16x16x32_bf16 v[82:85], v[200:203], v[172:175], 0
    v_mfma_f32_16x16x32_bf16 v[86:89], v[206:209], v[168:171], 0
    v_mfma_f32_16x16x32_bf16 v[90:93], v[206:209], v[160:163], 0
    v_mfma_f32_16x16x32_bf16 v[94:97], v[206:209], v[172:175], 0
    v_mfma_f32_16x16x32_bf16 v[98:101], v[212:215], v[168:171], 0
    s_mul_i32 s4, s26, 6
    s_lshl_b32 s56, s3, 1
    s_add_u32 s4, s4, s56
    s_sub_u32 s4, s4, 2
    s_mul_i32 s4, s4, 20480
    s_add_u32 s4, s4, 4194304
    s_lshl_b32 s56, s27, 11
    s_add_u32 s56, s56, s4
    s_add_u32 s57, s56, 20480
    v_rcp_f32 v102, v102
    v_rcp_f32 v106, v106
    v_rcp_f32 v110, v110
    v_rcp_f32 v114, v114
    v_cndmask_b32 v108, v106, v102, s[10:11]
    v_cndmask_b32 v108, v108, v114, s[12:13]
    v_cndmask_b32 v42, v42, v46, s[10:11]
    v_cndmask_b32 v43, v43, v47, s[10:11]
    v_cndmask_b32 v44, v44, v48, s[10:11]
    v_cndmask_b32 v45, v45, v49, s[10:11]
    v_cndmask_b32 v42, v42, v50, s[12:13]
    v_cndmask_b32 v43, v43, v51, s[12:13]
    v_cndmask_b32 v44, v44, v52, s[12:13]
    v_cndmask_b32 v45, v45, v53, s[12:13]
    v_cndmask_b32 v112, v110, v102, s[16:17]
    v_cndmask_b32 v112, v112, v114, s[18:19]
    v_cndmask_b32 v54, v54, v58, s[16:17]
    v_cndmask_b32 v55, v55, v59, s[16:17]
    v_cndmask_b32 v56, v56, v60, s[16:17]
    v_cndmask_b32 v57, v57, v61, s[16:17]
    v_cndmask_b32 v54, v54, v62, s[18:19]
    v_cndmask_b32 v55, v55, v63, s[18:19]
    v_cndmask_b32 v56, v56, v64, s[18:19]
    v_cndmask_b32 v57, v57, v65, s[18:19]
    v_pk_mul_f32 v[38:39], v[38:39], v[106:107] op_sel_hi:[1,0]
    v_pk_mul_f32 v[40:41], v[40:41], v[106:107] op_sel_hi:[1,0]
    v_cvt_pk_bf16_f32 v216, v38, v39
    v_cvt_pk_bf16_f32 v217, v40, v41
    v_pk_mul_f32 v[42:43], v[42:43], v[108:109] op_sel_hi:[1,0]
    v_pk_mul_f32 v[44:45], v[44:45], v[108:109] op_sel_hi:[1,0]
    v_cvt_pk_bf16_f32 v218, v42, v43
    v_cvt_pk_bf16_f32 v219, v44, v45
    v_pk_mul_f32 v[54:55], v[54:55], v[112:113] op_sel_hi:[1,0]
    v_pk_mul_f32 v[56:57], v[56:57], v[112:113] op_sel_hi:[1,0]
    v_cvt_pk_bf16_f32 v220, v54, v55
    v_cvt_pk_bf16_f32 v221, v56, v57
    v_pk_mul_f32 v[66:67], v[66:67], v[110:111] op_sel_hi:[1,0]
    v_pk_mul_f32 v[68:69], v[68:69], v[110:111] op_sel_hi:[1,0]
    v_cvt_pk_bf16_f32 v222, v66, v67
    v_cvt_pk_bf16_f32 v223, v68, v69
    buffer_store_dwordx4 v[216:219], v13, s[44:47], s56 offen offset:0 sc1
    buffer_store_dwordx4 v[220:223], v13, s[44:47], s56 offen offset:1024 sc1
    v_rcp_f32 v118, v118
    v_rcp_f32 v122, v122
    v_rcp_f32 v126, v126
    v_rcp_f32 v130, v130
    v_cndmask_b32 v124, v122, v118, s[10:11]
    v_cndmask_b32 v124, v124, v130, s[12:13]
    v_cndmask_b32 v74, v74, v78, s[10:11]
    v_cndmask_b32 v75, v75, v79, s[10:11]
    v_cndmask_b32 v76, v76, v80, s[10:11]
    v_cndmask_b32 v77, v77, v81, s[10:11]
    v_cndmask_b32 v74, v74, v82, s[12:13]
    v_cndmask_b32 v75, v75, v83, s[12:13]
    v_cndmask_b32 v76, v76, v84, s[12:13]
    v_cndmask_b32 v77, v77, v85, s[12:13]
    v_cndmask_b32 v128, v126, v118, s[16:17]
    v_cndmask_b32 v128, v128, v130, s[18:19]
    v_cndmask_b32 v86, v86, v90, s[16:17]
    v_cndmask_b32 v87, v87, v91, s[16:17]
    v_cndmask_b32 v88, v88, v92, s[16:17]
    v_cndmask_b32 v89, v89, v93, s[16:17]
    v_cndmask_b32 v86, v86, v94, s[18:19]
    v_cndmask_b32 v87, v87, v95, s[18:19]
    v_cndmask_b32 v88, v88, v96, s[18:19]
    v_cndmask_b32 v89, v89, v97, s[18:19]
    v_pk_mul_f32 v[70:71], v[70:71], v[122:123] op_sel_hi:[1,0]
    v_pk_mul_f32 v[72:73], v[72:73], v[122:123] op_sel_hi:[1,0]
    v_cvt_pk_bf16_f32 v224, v70, v71
    v_cvt_pk_bf16_f32 v225, v72, v73
    v_pk_mul_f32 v[74:75], v[74:75], v[124:125] op_sel_hi:[1,0]
    v_pk_mul_f32 v[76:77], v[76:77], v[124:125] op_sel_hi:[1,0]
    v_cvt_pk_bf16_f32 v226, v74, v75
    v_cvt_pk_bf16_f32 v227, v76, v77
    v_pk_mul_f32 v[86:87], v[86:87], v[128:129] op_sel_hi:[1,0]
    v_pk_mul_f32 v[88:89], v[88:89], v[128:129] op_sel_hi:[1,0]
    v_cvt_pk_bf16_f32 v228, v86, v87
    v_cvt_pk_bf16_f32 v229, v88, v89
    v_pk_mul_f32 v[98:99], v[98:99], v[126:127] op_sel_hi:[1,0]
    v_pk_mul_f32 v[100:101], v[100:101], v[126:127] op_sel_hi:[1,0]
    v_cvt_pk_bf16_f32 v230, v98, v99
    v_cvt_pk_bf16_f32 v231, v100, v101
    buffer_store_dwordx4 v[224:227], v13, s[44:47], s57 offen offset:0 sc1
    buffer_store_dwordx4 v[228:231], v13, s[44:47], s57 offen offset:1024 sc1
    s_lshl_b32 s22, s26, 2
    s_add_u32 s22, s22, s3
    s_lshl_b32 s22, s22, 7
    s_add_u32 s22, s22, 7340032
    s_lshl_b32 s56, s27, 2
    v_mov_b32 v4, s56
    v_mov_b32 v5, s53
    v_accvgpr_read_b32 v39, a0
    v_accvgpr_read_b32 v41, a1
    v_accvgpr_read_b32 v43, a2
    v_accvgpr_read_b32 v45, a3
    v_accvgpr_read_b32 v47, a4
    v_accvgpr_read_b32 v49, a5
    v_accvgpr_read_b32 v51, a6
    v_accvgpr_read_b32 v53, a7
    v_accvgpr_read_b32 v55, a8
    v_accvgpr_read_b32 v57, a9
    v_accvgpr_read_b32 v59, a10
    v_accvgpr_read_b32 v61, a11
    v_accvgpr_read_b32 v63, a12
    v_accvgpr_read_b32 v65, a13
    v_accvgpr_read_b32 v67, a14
    v_accvgpr_read_b32 v69, a15
    s_waitcnt vmcnt(0)
    s_mov_b64 exec, 1
    buffer_store_dword v5, v4, s[44:47], s22 offen sc1
    s_mov_b64 exec, -1
    v_lshlrev_b32 v38, 16, v39
    v_and_b32 v39, 0xffff0000, v39
    v_lshlrev_b32 v40, 16, v41
    v_and_b32 v41, 0xffff0000, v41
    v_lshlrev_b32 v42, 16, v43
    v_and_b32 v43, 0xffff0000, v43
    v_lshlrev_b32 v44, 16, v45
    v_and_b32 v45, 0xffff0000, v45
    v_lshlrev_b32 v46, 16, v47
    v_and_b32 v47, 0xffff0000, v47
    v_lshlrev_b32 v48, 16, v49
    v_and_b32 v49, 0xffff0000, v49
    v_lshlrev_b32 v50, 16, v51
    v_and_b32 v51, 0xffff0000, v51
    v_lshlrev_b32 v52, 16, v53
    v_and_b32 v53, 0xffff0000, v53
    v_lshlrev_b32 v54, 16, v55
    v_and_b32 v55, 0xffff0000, v55
    v_lshlrev_b32 v56, 16, v57
    v_and_b32 v57, 0xffff0000, v57
    v_lshlrev_b32 v58, 16, v59
    v_and_b32 v59, 0xffff0000, v59
    v_lshlrev_b32 v60, 16, v61
    v_and_b32 v61, 0xffff0000, v61
    v_lshlrev_b32 v62, 16, v63
    v_and_b32 v63, 0xffff0000, v63
    v_lshlrev_b32 v64, 16, v65
    v_and_b32 v65, 0xffff0000, v65
    v_lshlrev_b32 v66, 16, v67
    v_and_b32 v67, 0xffff0000, v67
    v_lshlrev_b32 v68, 16, v69
    v_and_b32 v69, 0xffff0000, v69
    v_pk_add_f32 v[70:71], v[38:39], v[140:141] op_sel_hi:[1,0]
    v_pk_add_f32 v[72:73], v[40:41], v[140:141] op_sel_hi:[1,0]
    v_pk_add_f32 v[74:75], v[42:43], v[140:141] op_sel_hi:[1,0]
    v_pk_add_f32 v[76:77], v[44:45], v[140:141] op_sel_hi:[1,0]
    v_pk_add_f32 v[78:79], v[46:47], v[140:141] op_sel_hi:[1,0]
    v_pk_add_f32 v[80:81], v[48:49], v[140:141] op_sel_hi:[1,0]
    v_pk_add_f32 v[82:83], v[50:51], v[140:141] op_sel_hi:[1,0]
    v_pk_add_f32 v[84:85], v[52:53], v[140:141] op_sel_hi:[1,0]
    v_pk_add_f32 v[86:87], v[54:55], v[142:143] op_sel_hi:[1,0]
    v_pk_add_f32 v[88:89], v[56:57], v[142:143] op_sel_hi:[1,0]
    v_pk_add_f32 v[90:91], v[58:59], v[142:143] op_sel_hi:[1,0]
    v_pk_add_f32 v[92:93], v[60:61], v[142:143] op_sel_hi:[1,0]
    v_pk_add_f32 v[94:95], v[62:63], v[142:143] op_sel_hi:[1,0]
    v_pk_add_f32 v[96:97], v[64:65], v[142:143] op_sel_hi:[1,0]
    v_pk_add_f32 v[98:99], v[66:67], v[142:143] op_sel_hi:[1,0]
    v_pk_add_f32 v[100:101], v[68:69], v[142:143] op_sel_hi:[1,0]
    v_cvt_pk_bf16_f32 v71, v70, v71
    v_cvt_pk_bf16_f32 v73, v72, v73
    v_cvt_pk_bf16_f32 v75, v74, v75
    v_cvt_pk_bf16_f32 v77, v76, v77
    v_cvt_pk_bf16_f32 v79, v78, v79
    v_cvt_pk_bf16_f32 v81, v80, v81
    v_cvt_pk_bf16_f32 v83, v82, v83
    v_cvt_pk_bf16_f32 v85, v84, v85
    v_cvt_pk_bf16_f32 v87, v86, v87
    v_cvt_pk_bf16_f32 v89, v88, v89
    v_cvt_pk_bf16_f32 v91, v90, v91
    v_cvt_pk_bf16_f32 v93, v92, v93
    v_cvt_pk_bf16_f32 v95, v94, v95
    v_cvt_pk_bf16_f32 v97, v96, v97
    v_cvt_pk_bf16_f32 v99, v98, v99
    v_cvt_pk_bf16_f32 v101, v100, v101
    v_lshlrev_b32 v70, 16, v71
    v_and_b32 v71, 0xffff0000, v71
    v_lshlrev_b32 v72, 16, v73
    v_and_b32 v73, 0xffff0000, v73
    v_lshlrev_b32 v74, 16, v75
    v_and_b32 v75, 0xffff0000, v75
    v_lshlrev_b32 v76, 16, v77
    v_and_b32 v77, 0xffff0000, v77
    v_lshlrev_b32 v78, 16, v79
    v_and_b32 v79, 0xffff0000, v79
    v_lshlrev_b32 v80, 16, v81
    v_and_b32 v81, 0xffff0000, v81
    v_lshlrev_b32 v82, 16, v83
    v_and_b32 v83, 0xffff0000, v83
    v_lshlrev_b32 v84, 16, v85
    v_and_b32 v85, 0xffff0000, v85
    v_lshlrev_b32 v86, 16, v87
    v_and_b32 v87, 0xffff0000, v87
    v_lshlrev_b32 v88, 16, v89
    v_and_b32 v89, 0xffff0000, v89
    v_lshlrev_b32 v90, 16, v91
    v_and_b32 v91, 0xffff0000, v91
    v_lshlrev_b32 v92, 16, v93
    v_and_b32 v93, 0xffff0000, v93
    v_lshlrev_b32 v94, 16, v95
    v_and_b32 v95, 0xffff0000, v95
    v_lshlrev_b32 v96, 16, v97
    v_and_b32 v97, 0xffff0000, v97
    v_lshlrev_b32 v98, 16, v99
    v_and_b32 v99, 0xffff0000, v99
    v_lshlrev_b32 v100, 16, v101
    v_and_b32 v101, 0xffff0000, v101
    v_pk_mul_f32 v[70:71], v[70:71], v[140:141] op_sel:[0,1] op_sel_hi:[1,1]
    v_pk_mul_f32 v[72:73], v[72:73], v[140:141] op_sel:[0,1] op_sel_hi:[1,1]
    v_pk_mul_f32 v[74:75], v[74:75], v[140:141] op_sel:[0,1] op_sel_hi:[1,1]
    v_pk_mul_f32 v[76:77], v[76:77], v[140:141] op_sel:[0,1] op_sel_hi:[1,1]
    v_pk_mul_f32 v[78:79], v[78:79], v[140:141] op_sel:[0,1] op_sel_hi:[1,1]
    v_pk_mul_f32 v[80:81], v[80:81], v[140:141] op_sel:[0,1] op_sel_hi:[1,1]
    v_pk_mul_f32 v[82:83], v[82:83], v[140:141] op_sel:[0,1] op_sel_hi:[1,1]
    v_pk_mul_f32 v[84:85], v[84:85], v[140:141] op_sel:[0,1] op_sel_hi:[1,1]
    v_pk_mul_f32 v[86:87], v[86:87], v[142:143] op_sel:[0,1] op_sel_hi:[1,1]
    v_pk_mul_f32 v[88:89], v[88:89], v[142:143] op_sel:[0,1] op_sel_hi:[1,1]
    v_pk_mul_f32 v[90:91], v[90:91], v[142:143] op_sel:[0,1] op_sel_hi:[1,1]
    v_pk_mul_f32 v[92:93], v[92:93], v[142:143] op_sel:[0,1] op_sel_hi:[1,1]
    v_pk_mul_f32 v[94:95], v[94:95], v[142:143] op_sel:[0,1] op_sel_hi:[1,1]
    v_pk_mul_f32 v[96:97], v[96:97], v[142:143] op_sel:[0,1] op_sel_hi:[1,1]
    v_pk_mul_f32 v[98:99], v[98:99], v[142:143] op_sel:[0,1] op_sel_hi:[1,1]
    v_pk_mul_f32 v[100:101], v[100:101], v[142:143] op_sel:[0,1] op_sel_hi:[1,1]
    v_cvt_pk_bf16_f32 v71, v70, v71
    v_cvt_pk_bf16_f32 v73, v72, v73
    v_cvt_pk_bf16_f32 v75, v74, v75
    v_cvt_pk_bf16_f32 v77, v76, v77
    v_cvt_pk_bf16_f32 v79, v78, v79
    v_cvt_pk_bf16_f32 v81, v80, v81
    v_cvt_pk_bf16_f32 v83, v82, v83
    v_cvt_pk_bf16_f32 v85, v84, v85
    v_cvt_pk_bf16_f32 v87, v86, v87
    v_cvt_pk_bf16_f32 v89, v88, v89
    v_cvt_pk_bf16_f32 v91, v90, v91
    v_cvt_pk_bf16_f32 v93, v92, v93
    v_cvt_pk_bf16_f32 v95, v94, v95
    v_cvt_pk_bf16_f32 v97, v96, v97
    v_cvt_pk_bf16_f32 v99, v98, v99
    v_cvt_pk_bf16_f32 v101, v100, v101
    v_lshlrev_b32 v70, 16, v71
    v_and_b32 v71, 0xffff0000, v71
    v_lshlrev_b32 v72, 16, v73
    v_and_b32 v73, 0xffff0000, v73
    v_lshlrev_b32 v74, 16, v75
    v_and_b32 v75, 0xffff0000, v75
    v_lshlrev_b32 v76, 16, v77
    v_and_b32 v77, 0xffff0000, v77
    v_lshlrev_b32 v78, 16, v79
    v_and_b32 v79, 0xffff0000, v79
    v_lshlrev_b32 v80, 16, v81
    v_and_b32 v81, 0xffff0000, v81
    v_lshlrev_b32 v82, 16, v83
    v_and_b32 v83, 0xffff0000, v83
    v_lshlrev_b32 v84, 16, v85
    v_and_b32 v85, 0xffff0000, v85
    v_lshlrev_b32 v86, 16, v87
    v_and_b32 v87, 0xffff0000, v87
    v_lshlrev_b32 v88, 16, v89
    v_and_b32 v89, 0xffff0000, v89
    v_lshlrev_b32 v90, 16, v91
    v_and_b32 v91, 0xffff0000, v91
    v_lshlrev_b32 v92, 16, v93
    v_and_b32 v93, 0xffff0000, v93
    v_lshlrev_b32 v94, 16, v95
    v_and_b32 v95, 0xffff0000, v95
    v_lshlrev_b32 v96, 16, v97
    v_and_b32 v97, 0xffff0000, v97
    v_lshlrev_b32 v98, 16, v99
    v_and_b32 v99, 0xffff0000, v99
    v_lshlrev_b32 v100, 16, v101
    v_and_b32 v101, 0xffff0000, v101
    v_mul_f32 v102, 0xbfb8aa3b, v70
    v_mul_f32 v103, 0xbfb8aa3b, v71
    v_mul_f32 v104, 0xbfb8aa3b, v72
    v_mul_f32 v105, 0xbfb8aa3b, v73
    v_mul_f32 v106, 0xbfb8aa3b, v74
    v_mul_f32 v107, 0xbfb8aa3b, v75
    v_mul_f32 v108, 0xbfb8aa3b, v76
    v_mul_f32 v109, 0xbfb8aa3b, v77
    v_mul_f32 v110, 0xbfb8aa3b, v78
    v_mul_f32 v111, 0xbfb8aa3b, v79
    v_mul_f32 v112, 0xbfb8aa3b, v80
    v_mul_f32 v113, 0xbfb8aa3b, v81
    v_mul_f32 v114, 0xbfb8aa3b, v82
    v_mul_f32 v115, 0xbfb8aa3b, v83
    v_mul_f32 v116, 0xbfb8aa3b, v84
    v_mul_f32 v117, 0xbfb8aa3b, v85
    v_mul_f32 v118, 0xbfb8aa3b, v86
    v_mul_f32 v119, 0xbfb8aa3b, v87
    v_mul_f32 v120, 0xbfb8aa3b, v88
    v_mul_f32 v121, 0xbfb8aa3b, v89
    v_mul_f32 v122, 0xbfb8aa3b, v90
    v_mul_f32 v123, 0xbfb8aa3b, v91
    v_mul_f32 v124, 0xbfb8aa3b, v92
    v_mul_f32 v125, 0xbfb8aa3b, v93
    v_mul_f32 v126, 0xbfb8aa3b, v94
    v_mul_f32 v127, 0xbfb8aa3b, v95
    v_mul_f32 v128, 0xbfb8aa3b, v96
    v_mul_f32 v129, 0xbfb8aa3b, v97
    v_mul_f32 v130, 0xbfb8aa3b, v98
    v_mul_f32 v131, 0xbfb8aa3b, v99
    v_mul_f32 v132, 0xbfb8aa3b, v100
    v_mul_f32 v133, 0xbfb8aa3b, v101
    v_exp_f32 v102, v102
    v_exp_f32 v103, v103
    v_exp_f32 v104, v104
    v_exp_f32 v105, v105
    v_exp_f32 v106, v106
    v_exp_f32 v107, v107
    v_exp_f32 v108, v108
    v_exp_f32 v109, v109
    v_exp_f32 v110, v110
    v_exp_f32 v111, v111
    v_exp_f32 v112, v112
    v_exp_f32 v113, v113
    v_exp_f32 v114, v114
    v_exp_f32 v115, v115
    v_exp_f32 v116, v116
    v_exp_f32 v117, v117
    v_exp_f32 v118, v118
    v_exp_f32 v119, v119
    v_exp_f32 v120, v120
    v_exp_f32 v121, v121
    v_exp_f32 v122, v122
    v_exp_f32 v123, v123
    v_exp_f32 v124, v124
    v_exp_f32 v125, v125
    v_exp_f32 v126, v126
    v_exp_f32 v127, v127
    v_exp_f32 v128, v128
    v_exp_f32 v129, v129
    v_exp_f32 v130, v130
    v_exp_f32 v131, v131
    v_exp_f32 v132, v132
    v_exp_f32 v133, v133
    v_add_f32 v102, 1.0, v102
    v_add_f32 v103, 1.0, v103
    v_add_f32 v104, 1.0, v104
    v_add_f32 v105, 1.0, v105
    v_add_f32 v106, 1.0, v106
    v_add_f32 v107, 1.0, v107
    v_add_f32 v108, 1.0, v108
    v_add_f32 v109, 1.0, v109
    v_add_f32 v110, 1.0, v110
    v_add_f32 v111, 1.0, v111
    v_add_f32 v112, 1.0, v112
    v_add_f32 v113, 1.0, v113
    v_add_f32 v114, 1.0, v114
    v_add_f32 v115, 1.0, v115
    v_add_f32 v116, 1.0, v116
    v_add_f32 v117, 1.0, v117
    v_add_f32 v118, 1.0, v118
    v_add_f32 v119, 1.0, v119
    v_add_f32 v120, 1.0, v120
    v_add_f32 v121, 1.0, v121
    v_add_f32 v122, 1.0, v122
    v_add_f32 v123, 1.0, v123
    v_add_f32 v124, 1.0, v124
    v_add_f32 v125, 1.0, v125
    v_add_f32 v126, 1.0, v126
    v_add_f32 v127, 1.0, v127
    v_add_f32 v128, 1.0, v128
    v_add_f32 v129, 1.0, v129
    v_add_f32 v130, 1.0, v130
    v_add_f32 v131, 1.0, v131
    v_add_f32 v132, 1.0, v132
    v_add_f32 v133, 1.0, v133
    v_rcp_f32 v102, v102
    v_rcp_f32 v103, v103
    v_rcp_f32 v104, v104
    v_rcp_f32 v105, v105
    v_rcp_f32 v106, v106
    v_rcp_f32 v107, v107
    v_rcp_f32 v108, v108
    v_rcp_f32 v109, v109
    v_rcp_f32 v110, v110
    v_rcp_f32 v111, v111
    v_rcp_f32 v112, v112
    v_rcp_f32 v113, v113
    v_rcp_f32 v114, v114
    v_rcp_f32 v115, v115
    v_rcp_f32 v116, v116
    v_rcp_f32 v117, v117
    v_rcp_f32 v118, v118
    v_rcp_f32 v119, v119
    v_rcp_f32 v120, v120
    v_rcp_f32 v121, v121
    v_rcp_f32 v122, v122
    v_rcp_f32 v123, v123
    v_rcp_f32 v124, v124
    v_rcp_f32 v125, v125
    v_rcp_f32 v126, v126
    v_rcp_f32 v127, v127
    v_rcp_f32 v128, v128
    v_rcp_f32 v129, v129
    v_rcp_f32 v130, v130
    v_rcp_f32 v131, v131
    v_rcp_f32 v132, v132
    v_rcp_f32 v133, v133
    v_pk_mul_f32 v[102:103], v[102:103], v[70:71]
    v_pk_mul_f32 v[104:105], v[104:105], v[72:73]
    v_pk_mul_f32 v[106:107], v[106:107], v[74:75]
    v_pk_mul_f32 v[108:109], v[108:109], v[76:77]
    v_pk_mul_f32 v[110:111], v[110:111], v[78:79]
    v_pk_mul_f32 v[112:113], v[112:113], v[80:81]
    v_pk_mul_f32 v[114:115], v[114:115], v[82:83]
    v_pk_mul_f32 v[116:117], v[116:117], v[84:85]
    v_pk_mul_f32 v[118:119], v[118:119], v[86:87]
    v_pk_mul_f32 v[120:121], v[120:121], v[88:89]
    v_pk_mul_f32 v[122:123], v[122:123], v[90:91]
    v_pk_mul_f32 v[124:125], v[124:125], v[92:93]
    v_pk_mul_f32 v[126:127], v[126:127], v[94:95]
    v_pk_mul_f32 v[128:129], v[128:129], v[96:97]
    v_pk_mul_f32 v[130:131], v[130:131], v[98:99]
    v_pk_mul_f32 v[132:133], v[132:133], v[100:101]
    v_cvt_pk_bf16_f32 v103, v102, v103
    v_cvt_pk_bf16_f32 v105, v104, v105
    v_cvt_pk_bf16_f32 v107, v106, v107
    v_cvt_pk_bf16_f32 v109, v108, v109
    v_cvt_pk_bf16_f32 v111, v110, v111
    v_cvt_pk_bf16_f32 v113, v112, v113
    v_cvt_pk_bf16_f32 v115, v114, v115
    v_cvt_pk_bf16_f32 v117, v116, v117
    v_cvt_pk_bf16_f32 v119, v118, v119
    v_cvt_pk_bf16_f32 v121, v120, v121
    v_cvt_pk_bf16_f32 v123, v122, v123
    v_cvt_pk_bf16_f32 v125, v124, v125
    v_cvt_pk_bf16_f32 v127, v126, v127
    v_cvt_pk_bf16_f32 v129, v128, v129
    v_cvt_pk_bf16_f32 v131, v130, v131
    v_cvt_pk_bf16_f32 v133, v132, v133
    v_lshlrev_b32 v102, 16, v103
    v_and_b32 v103, 0xffff0000, v103
    v_lshlrev_b32 v104, 16, v105
    v_and_b32 v105, 0xffff0000, v105
    v_lshlrev_b32 v106, 16, v107
    v_and_b32 v107, 0xffff0000, v107
    v_lshlrev_b32 v108, 16, v109
    v_and_b32 v109, 0xffff0000, v109
    v_lshlrev_b32 v110, 16, v111
    v_and_b32 v111, 0xffff0000, v111
    v_lshlrev_b32 v112, 16, v113
    v_and_b32 v113, 0xffff0000, v113
    v_lshlrev_b32 v114, 16, v115
    v_and_b32 v115, 0xffff0000, v115
    v_lshlrev_b32 v116, 16, v117
    v_and_b32 v117, 0xffff0000, v117
    v_lshlrev_b32 v118, 16, v119
    v_and_b32 v119, 0xffff0000, v119
    v_lshlrev_b32 v120, 16, v121
    v_and_b32 v121, 0xffff0000, v121
    v_lshlrev_b32 v122, 16, v123
    v_and_b32 v123, 0xffff0000, v123
    v_lshlrev_b32 v124, 16, v125
    v_and_b32 v125, 0xffff0000, v125
    v_lshlrev_b32 v126, 16, v127
    v_and_b32 v127, 0xffff0000, v127
    v_lshlrev_b32 v128, 16, v129
    v_and_b32 v129, 0xffff0000, v129
    v_lshlrev_b32 v130, 16, v131
    v_and_b32 v131, 0xffff0000, v131
    v_lshlrev_b32 v132, 16, v133
    v_and_b32 v133, 0xffff0000, v133
    v_and_b32 v6, 3, v1
    v_lshlrev_b32 v6, 4, v6
    v_xor_b32 v6, v6, v25
    v_add_u32 v26, v6, v24
    v_add_u32 v27, 8, v26
    v_xor_b32 v28, 64, v26
    v_add_u32 v29, 8, v28
    v_add_u32 v30, 61696, v26
    v_add_u32 v34, 123392, v26
    v_add_u32 v31, 61696, v27
    v_add_u32 v35, 123392, v27
    v_add_u32 v32, 61696, v28
    v_add_u32 v36, 123392, v28
    v_add_u32 v33, 61696, v29
    v_add_u32 v37, 123392, v29
    ds_read_b64_tr_b16 a[160:161], v30 offset:39040
    ds_read_b64_tr_b16 a[162:163], v30 offset:39552
    ds_read_b64_tr_b16 a[164:165], v31 offset:39040
    ds_read_b64_tr_b16 a[166:167], v31 offset:39552
    ds_read_b64_tr_b16 a[168:169], v32 offset:39040
    ds_read_b64_tr_b16 a[170:171], v32 offset:39552
    ds_read_b64_tr_b16 a[172:173], v33 offset:39040
    ds_read_b64_tr_b16 a[174:175], v33 offset:39552
    ds_read_b64_tr_b16 a[176:177], v30 offset:43136
    ds_read_b64_tr_b16 a[178:179], v30 offset:43648
    ds_read_b64_tr_b16 a[180:181], v31 offset:43136
    ds_read_b64_tr_b16 a[182:183], v31 offset:43648
    ds_read_b64_tr_b16 a[184:185], v32 offset:43136
    ds_read_b64_tr_b16 a[186:187], v32 offset:43648
    ds_read_b64_tr_b16 a[188:189], v33 offset:43136
    ds_read_b64_tr_b16 a[190:191], v33 offset:43648
    ds_read_b64_tr_b16 a[192:193], v30 offset:47232
    ds_read_b64_tr_b16 a[194:195], v30 offset:47744
    ds_read_b64_tr_b16 a[196:197], v31 offset:47232
    ds_read_b64_tr_b16 a[198:199], v31 offset:47744
    ds_read_b64_tr_b16 a[200:201], v32 offset:47232
    ds_read_b64_tr_b16 a[202:203], v32 offset:47744
    ds_read_b64_tr_b16 a[204:205], v33 offset:47232
    ds_read_b64_tr_b16 a[206:207], v33 offset:47744
Lfl_poll:
    s_sub_u32 s54, s54, 1
    s_cbranch_scc1 Lend
    buffer_load_dword v4, v12, s[44:47], s22 offen sc1
    s_waitcnt vmcnt(0)
    v_cmp_eq_u32 vcc, s53, v4
    s_nop 0
    s_and_b32 s56, vcc_lo, 0x3ff
    s_cmp_lg_u32 s56, 0x3ff
    s_nop 0
    s_cbranch_scc1 Lfl_poll
    s_add_u32 s23, s4, 20480
    buffer_load_dwordx4 a[0:3], v13, s[44:47], s4 offen offset:0 sc1
    buffer_load_dwordx4 a[4:7], v13, s[44:47], s23 offen offset:0 sc1
    buffer_load_dwordx4 a[8:11], v13, s[44:47], s4 offen offset:1024 sc1
    buffer_load_dwordx4 a[12:15], v13, s[44:47], s23 offen offset:1024 sc1
    buffer_load_dwordx4 a[16:19], v13, s[44:47], s4 offen offset:2048 sc1
    buffer_load_dwordx4 a[20:23], v13, s[44:47], s23 offen offset:2048 sc1
    buffer_load_dwordx4 a[24:27], v13, s[44:47], s4 offen offset:3072 sc1
    buffer_load_dwordx4 a[28:31], v13, s[44:47], s23 offen offset:3072 sc1
    s_add_u32 s4, s4, 4096
    s_add_u32 s23, s23, 4096
    buffer_load_dwordx4 a[32:35], v13, s[44:47], s4 offen offset:0 sc1
    buffer_load_dwordx4 a[36:39], v13, s[44:47], s23 offen offset:0 sc1
    buffer_load_dwordx4 a[40:43], v13, s[44:47], s4 offen offset:1024 sc1
    buffer_load_dwordx4 a[44:47], v13, s[44:47], s23 offen offset:1024 sc1
    buffer_load_dwordx4 a[48:51], v13, s[44:47], s4 offen offset:2048 sc1
    buffer_load_dwordx4 a[52:55], v13, s[44:47], s23 offen offset:2048 sc1
    buffer_load_dwordx4 a[56:59], v13, s[44:47], s4 offen offset:3072 sc1
    buffer_load_dwordx4 a[60:63], v13, s[44:47], s23 offen offset:3072 sc1
    s_add_u32 s4, s4, 4096
    s_add_u32 s23, s23, 4096
    buffer_load_dwordx4 a[64:67], v13, s[44:47], s4 offen offset:0 sc1
    buffer_load_dwordx4 a[68:71], v13, s[44:47], s23 offen offset:0 sc1
    buffer_load_dwordx4 a[72:75], v13, s[44:47], s4 offen offset:1024 sc1
    buffer_load_dwordx4 a[76:79], v13, s[44:47], s23 offen offset:1024 sc1
    buffer_load_dwordx4 a[80:83], v13, s[44:47], s4 offen offset:2048 sc1
    buffer_load_dwordx4 a[84:87], v13, s[44:47], s23 offen offset:2048 sc1
    buffer_load_dwordx4 a[88:91], v13, s[44:47], s4 offen offset:3072 sc1
    buffer_load_dwordx4 a[92:95], v13, s[44:47], s23 offen offset:3072 sc1
    s_add_u32 s4, s4, 4096
    s_add_u32 s23, s23, 4096
    buffer_load_dwordx4 a[96:99], v13, s[44:47], s4 offen offset:0 sc1
    buffer_load_dwordx4 a[100:103], v13, s[44:47], s23 offen offset:0 sc1
    buffer_load_dwordx4 a[104:107], v13, s[44:47], s4 offen offset:1024 sc1
    buffer_load_dwordx4 a[108:111], v13, s[44:47], s23 offen offset:1024 sc1
    buffer_load_dwordx4 a[112:115], v13, s[44:47], s4 offen offset:2048 sc1
    buffer_load_dwordx4 a[116:119], v13, s[44:47], s23 offen offset:2048 sc1
    buffer_load_dwordx4 a[120:123], v13, s[44:47], s4 offen offset:3072 sc1
    buffer_load_dwordx4 a[124:127], v13, s[44:47], s23 offen offset:3072 sc1
    s_add_u32 s4, s4, 4096
    s_add_u32 s23, s23, 4096
    buffer_load_dwordx4 a[128:131], v13, s[44:47], s4 offen offset:0 sc1
    buffer_load_dwordx4 a[132:135], v13, s[44:47], s23 offen offset:0 sc1
    buffer_load_dwordx4 a[136:139], v13, s[44:47], s4 offen offset:1024 sc1
    buffer_load_dwordx4 a[140:143], v13, s[44:47], s23 offen offset:1024 sc1
    buffer_load_dwordx4 a[144:147], v13, s[44:47], s4 offen offset:2048 sc1
    buffer_load_dwordx4 a[148:151], v13, s[44:47], s23 offen offset:2048 sc1
    buffer_load_dwordx4 a[152:155], v13, s[44:47], s4 offen offset:3072 sc1
    buffer_load_dwordx4 a[156:159], v13, s[44:47], s23 offen offset:3072 sc1
    s_waitcnt vmcnt(38) lgkmcnt(8)
    v_mfma_f32_16x16x32_bf16 v[144:147], a[160:163], a[0:3], 0
    ds_read_b64_tr_b16 a[208:209], v30 offset:51328
    v_mfma_f32_16x16x32_bf16 v[160:163], a[160:163], a[4:7], 0
    ds_read_b64_tr_b16 a[210:211], v30 offset:51840
    v_mfma_f32_16x16x32_bf16 v[148:151], a[164:167], a[0:3], 0
    ds_read_b64_tr_b16 a[212:213], v31 offset:51328
    v_mfma_f32_16x16x32_bf16 v[164:167], a[164:167], a[4:7], 0
    ds_read_b64_tr_b16 a[214:215], v31 offset:51840
    v_mfma_f32_16x16x32_bf16 v[152:155], a[168:171], a[0:3], 0
    ds_read_b64_tr_b16 a[216:217], v32 offset:51328
    v_mfma_f32_16x16x32_bf16 v[168:171], a[168:171], a[4:7], 0
    ds_read_b64_tr_b16 a[218:219], v32 offset:51840
    v_mfma_f32_16x16x32_bf16 v[156:159], a[172:175], a[0:3], 0
    ds_read_b64_tr_b16 a[220:221], v33 offset:51328
    v_mfma_f32_16x16x32_bf16 v[172:175], a[172:175], a[4:7], 0
    ds_read_b64_tr_b16 a[222:223], v33 offset:51840
    s_waitcnt vmcnt(36) lgkmcnt(8)
    v_mfma_f32_16x16x32_bf16 v[144:147], a[176:179], a[8:11], v[144:147]
    ds_read_b64_tr_b16 a[160:161], v34 offset:0
    v_mfma_f32_16x16x32_bf16 v[160:163], a[176:179], a[12:15], v[160:163]
    ds_read_b64_tr_b16 a[162:163], v34 offset:512
    v_mfma_f32_16x16x32_bf16 v[148:151], a[180:183], a[8:11], v[148:151]
    ds_read_b64_tr_b16 a[164:165], v35 offset:0
    v_mfma_f32_16x16x32_bf16 v[164:167], a[180:183], a[12:15], v[164:167]
    ds_read_b64_tr_b16 a[166:167], v35 offset:512
    v_mfma_f32_16x16x32_bf16 v[152:155], a[184:187], a[8:11], v[152:155]
    ds_read_b64_tr_b16 a[168:169], v36 offset:0
    v_mfma_f32_16x16x32_bf16 v[168:171], a[184:187], a[12:15], v[168:171]
    ds_read_b64_tr_b16 a[170:171], v36 offset:512
    v_mfma_f32_16x16x32_bf16 v[156:159], a[188:191], a[8:11], v[156:159]
    ds_read_b64_tr_b16 a[172:173], v37 offset:0
    v_mfma_f32_16x16x32_bf16 v[172:175], a[188:191], a[12:15], v[172:175]
    ds_read_b64_tr_b16 a[174:175], v37 offset:512
    s_waitcnt vmcnt(34) lgkmcnt(8)
    v_mfma_f32_16x16x32_bf16 v[144:147], a[192:195], a[16:19], v[144:147]
    ds_read_b64_tr_b16 a[176:177], v34 offset:4096
    v_mfma_f32_16x16x32_bf16 v[160:163], a[192:195], a[20:23], v[160:163]
    ds_read_b64_tr_b16 a[178:179], v34 offset:4608
    v_mfma_f32_16x16x32_bf16 v[148:151], a[196:199], a[16:19], v[148:151]
    ds_read_b64_tr_b16 a[180:181], v35 offset:4096
    v_mfma_f32_16x16x32_bf16 v[164:167], a[196:199], a[20:23], v[164:167]
    ds_read_b64_tr_b16 a[182:183], v35 offset:4608
    v_mfma_f32_16x16x32_bf16 v[152:155], a[200:203], a[16:19], v[152:155]
    ds_read_b64_tr_b16 a[184:185], v36 offset:4096
    v_mfma_f32_16x16x32_bf16 v[168:171], a[200:203], a[20:23], v[168:171]
    ds_read_b64_tr_b16 a[186:187], v36 offset:4608
    v_mfma_f32_16x16x32_bf16 v[156:159], a[204:207], a[16:19], v[156:159]
    ds_read_b64_tr_b16 a[188:189], v37 offset:4096
    v_mfma_f32_16x16x32_bf16 v[172:175], a[204:207], a[20:23], v[172:175]
    ds_read_b64_tr_b16 a[190:191], v37 offset:4608
    s_waitcnt vmcnt(32) lgkmcnt(8)
    v_mfma_f32_16x16x32_bf16 v[144:147], a[208:211], a[24:27], v[144:147]
    ds_read_b64_tr_b16 a[192:193], v34 offset:8192
    v_mfma_f32_16x16x32_bf16 v[160:163], a[208:211], a[28:31], v[160:163]
    ds_read_b64_tr_b16 a[194:195], v34 offset:8704
    v_mfma_f32_16x16x32_bf16 v[148:151], a[212:215], a[24:27], v[148:151]
    ds_read_b64_tr_b16 a[196:197], v35 offset:8192
    v_mfma_f32_16x16x32_bf16 v[164:167], a[212:215], a[28:31], v[164:167]
    ds_read_b64_tr_b16 a[198:199], v35 offset:8704
    v_mfma_f32_16x16x32_bf16 v[152:155], a[216:219], a[24:27], v[152:155]
    ds_read_b64_tr_b16 a[200:201], v36 offset:8192
    v_mfma_f32_16x16x32_bf16 v[168:171], a[216:219], a[28:31], v[168:171]
    ds_read_b64_tr_b16 a[202:203], v36 offset:8704
    v_mfma_f32_16x16x32_bf16 v[156:159], a[220:223], a[24:27], v[156:159]
    ds_read_b64_tr_b16 a[204:205], v37 offset:8192
    v_mfma_f32_16x16x32_bf16 v[172:175], a[220:223], a[28:31], v[172:175]
    ds_read_b64_tr_b16 a[206:207], v37 offset:8704
    s_waitcnt vmcnt(30) lgkmcnt(8)
    v_mfma_f32_16x16x32_bf16 v[144:147], a[160:163], a[32:35], v[144:147]
    ds_read_b64_tr_b16 a[208:209], v34 offset:12288
    v_mfma_f32_16x16x32_bf16 v[160:163], a[160:163], a[36:39], v[160:163]
    ds_read_b64_tr_b16 a[210:211], v34 offset:12800
    v_mfma_f32_16x16x32_bf16 v[148:151], a[164:167], a[32:35], v[148:151]
    ds_read_b64_tr_b16 a[212:213], v35 offset:12288
    v_mfma_f32_16x16x32_bf16 v[164:167], a[164:167], a[36:39], v[164:167]
    ds_read_b64_tr_b16 a[214:215], v35 offset:12800
    v_mfma_f32_16x16x32_bf16 v[152:155], a[168:171], a[32:35], v[152:155]
    ds_read_b64_tr_b16 a[216:217], v36 offset:12288
    v_mfma_f32_16x16x32_bf16 v[168:171], a[168:171], a[36:39], v[168:171]
    ds_read_b64_tr_b16 a[218:219], v36 offset:12800
    v_mfma_f32_16x16x32_bf16 v[156:159], a[172:175], a[32:35], v[156:159]
    ds_read_b64_tr_b16 a[220:221], v37 offset:12288
    v_mfma_f32_16x16x32_bf16 v[172:175], a[172:175], a[36:39], v[172:175]
    ds_read_b64_tr_b16 a[222:223], v37 offset:12800
    s_waitcnt vmcnt(28) lgkmcnt(8)
    v_mfma_f32_16x16x32_bf16 v[144:147], a[176:179], a[40:43], v[144:147]
    ds_read_b64_tr_b16 a[160:161], v34 offset:16384
    v_mfma_f32_16x16x32_bf16 v[160:163], a[176:179], a[44:47], v[160:163]
    ds_read_b64_tr_b16 a[162:163], v34 offset:16896
    v_mfma_f32_16x16x32_bf16 v[148:151], a[180:183], a[40:43], v[148:151]
    ds_read_b64_tr_b16 a[164:165], v35 offset:16384
    v_mfma_f32_16x16x32_bf16 v[164:167], a[180:183], a[44:47], v[164:167]
    ds_read_b64_tr_b16 a[166:167], v35 offset:16896
    v_mfma_f32_16x16x32_bf16 v[152:155], a[184:187], a[40:43], v[152:155]
    ds_read_b64_tr_b16 a[168:169], v36 offset:16384
    v_mfma_f32_16x16x32_bf16 v[168:171], a[184:187], a[44:47], v[168:171]
    ds_read_b64_tr_b16 a[170:171], v36 offset:16896
    v_mfma_f32_16x16x32_bf16 v[156:159], a[188:191], a[40:43], v[156:159]
    ds_read_b64_tr_b16 a[172:173], v37 offset:16384
    v_mfma_f32_16x16x32_bf16 v[172:175], a[188:191], a[44:47], v[172:175]
    ds_read_b64_tr_b16 a[174:175], v37 offset:16896
    s_waitcnt vmcnt(26) lgkmcnt(8)
    v_mfma_f32_16x16x32_bf16 v[144:147], a[192:195], a[48:51], v[144:147]
    ds_read_b64_tr_b16 a[176:177], v34 offset:20480
    v_mfma_f32_16x16x32_bf16 v[160:163], a[192:195], a[52:55], v[160:163]
    ds_read_b64_tr_b16 a[178:179], v34 offset:20992
    v_mfma_f32_16x16x32_bf16 v[148:151], a[196:199], a[48:51], v[148:151]
    ds_read_b64_tr_b16 a[180:181], v35 offset:20480
    v_mfma_f32_16x16x32_bf16 v[164:167], a[196:199], a[52:55], v[164:167]
    ds_read_b64_tr_b16 a[182:183], v35 offset:20992
    v_mfma_f32_16x16x32_bf16 v[152:155], a[200:203], a[48:51], v[152:155]
    ds_read_b64_tr_b16 a[184:185], v36 offset:20480
    v_mfma_f32_16x16x32_bf16 v[168:171], a[200:203], a[52:55], v[168:171]
    ds_read_b64_tr_b16 a[186:187], v36 offset:20992
    v_mfma_f32_16x16x32_bf16 v[156:159], a[204:207], a[48:51], v[156:159]
    ds_read_b64_tr_b16 a[188:189], v37 offset:20480
    v_mfma_f32_16x16x32_bf16 v[172:175], a[204:207], a[52:55], v[172:175]
    ds_read_b64_tr_b16 a[190:191], v37 offset:20992
    s_waitcnt vmcnt(24) lgkmcnt(8)
    v_mfma_f32_16x16x32_bf16 v[144:147], a[208:211], a[56:59], v[144:147]
    ds_read_b64_tr_b16 a[192:193], v26 offset:0
    v_mfma_f32_16x16x32_bf16 v[160:163], a[208:211], a[60:63], v[160:163]
    ds_read_b64_tr_b16 a[194:195], v26 offset:512
    v_mfma_f32_16x16x32_bf16 v[148:151], a[212:215], a[56:59], v[148:151]
    ds_read_b64_tr_b16 a[196:197], v27 offset:0
    v_mfma_f32_16x16x32_bf16 v[164:167], a[212:215], a[60:63], v[164:167]
    ds_read_b64_tr_b16 a[198:199], v27 offset:512
    v_mfma_f32_16x16x32_bf16 v[152:155], a[216:219], a[56:59], v[152:155]
    ds_read_b64_tr_b16 a[200:201], v28 offset:0
    v_mfma_f32_16x16x32_bf16 v[168:171], a[216:219], a[60:63], v[168:171]
    ds_read_b64_tr_b16 a[202:203], v28 offset:512
    v_mfma_f32_16x16x32_bf16 v[156:159], a[220:223], a[56:59], v[156:159]
    ds_read_b64_tr_b16 a[204:205], v29 offset:0
    v_mfma_f32_16x16x32_bf16 v[172:175], a[220:223], a[60:63], v[172:175]
    ds_read_b64_tr_b16 a[206:207], v29 offset:512
    s_waitcnt vmcnt(22) lgkmcnt(8)
    v_mfma_f32_16x16x32_bf16 v[144:147], a[160:163], a[64:67], v[144:147]
    ds_read_b64_tr_b16 a[208:209], v26 offset:4096
    v_mfma_f32_16x16x32_bf16 v[160:163], a[160:163], a[68:71], v[160:163]
    ds_read_b64_tr_b16 a[210:211], v26 offset:4608
    v_mfma_f32_16x16x32_bf16 v[148:151], a[164:167], a[64:67], v[148:151]
    ds_read_b64_tr_b16 a[212:213], v27 offset:4096
    v_mfma_f32_16x16x32_bf16 v[164:167], a[164:167], a[68:71], v[164:167]
    ds_read_b64_tr_b16 a[214:215], v27 offset:4608
    v_mfma_f32_16x16x32_bf16 v[152:155], a[168:171], a[64:67], v[152:155]
    ds_read_b64_tr_b16 a[216:217], v28 offset:4096
    v_mfma_f32_16x16x32_bf16 v[168:171], a[168:171], a[68:71], v[168:171]
    ds_read_b64_tr_b16 a[218:219], v28 offset:4608
    v_mfma_f32_16x16x32_bf16 v[156:159], a[172:175], a[64:67], v[156:159]
    ds_read_b64_tr_b16 a[220:221], v29 offset:4096
    v_mfma_f32_16x16x32_bf16 v[172:175], a[172:175], a[68:71], v[172:175]
    ds_read_b64_tr_b16 a[222:223], v29 offset:4608
    s_waitcnt vmcnt(20) lgkmcnt(8)
    v_mfma_f32_16x16x32_bf16 v[144:147], a[176:179], a[72:75], v[144:147]
    ds_read_b64_tr_b16 a[160:161], v26 offset:8192
    v_mfma_f32_16x16x32_bf16 v[160:163], a[176:179], a[76:79], v[160:163]
    ds_read_b64_tr_b16 a[162:163], v26 offset:8704
    v_mfma_f32_16x16x32_bf16 v[148:151], a[180:183], a[72:75], v[148:151]
    ds_read_b64_tr_b16 a[164:165], v27 offset:8192
    v_mfma_f32_16x16x32_bf16 v[164:167], a[180:183], a[76:79], v[164:167]
    ds_read_b64_tr_b16 a[166:167], v27 offset:8704
    v_mfma_f32_16x16x32_bf16 v[152:155], a[184:187], a[72:75], v[152:155]
    ds_read_b64_tr_b16 a[168:169], v28 offset:8192
    v_mfma_f32_16x16x32_bf16 v[168:171], a[184:187], a[76:79], v[168:171]
    ds_read_b64_tr_b16 a[170:171], v28 offset:8704
    v_mfma_f32_16x16x32_bf16 v[156:159], a[188:191], a[72:75], v[156:159]
    ds_read_b64_tr_b16 a[172:173], v29 offset:8192
    v_mfma_f32_16x16x32_bf16 v[172:175], a[188:191], a[76:79], v[172:175]
    ds_read_b64_tr_b16 a[174:175], v29 offset:8704
    s_waitcnt vmcnt(18) lgkmcnt(8)
    v_mfma_f32_16x16x32_bf16 v[144:147], a[192:195], a[80:83], v[144:147]
    ds_read_b64_tr_b16 a[176:177], v26 offset:12288
    v_mfma_f32_16x16x32_bf16 v[160:163], a[192:195], a[84:87], v[160:163]
    ds_read_b64_tr_b16 a[178:179], v26 offset:12800
    v_mfma_f32_16x16x32_bf16 v[148:151], a[196:199], a[80:83], v[148:151]
    ds_read_b64_tr_b16 a[180:181], v27 offset:12288
    v_mfma_f32_16x16x32_bf16 v[164:167], a[196:199], a[84:87], v[164:167]
    ds_read_b64_tr_b16 a[182:183], v27 offset:12800
    v_mfma_f32_16x16x32_bf16 v[152:155], a[200:203], a[80:83], v[152:155]
    ds_read_b64_tr_b16 a[184:185], v28 offset:12288
    v_mfma_f32_16x16x32_bf16 v[168:171], a[200:203], a[84:87], v[168:171]
    ds_read_b64_tr_b16 a[186:187], v28 offset:12800
    v_mfma_f32_16x16x32_bf16 v[156:159], a[204:207], a[80:83], v[156:159]
    ds_read_b64_tr_b16 a[188:189], v29 offset:12288
    v_mfma_f32_16x16x32_bf16 v[172:175], a[204:207], a[84:87], v[172:175]
    ds_read_b64_tr_b16 a[190:191], v29 offset:12800
    s_waitcnt vmcnt(16) lgkmcnt(8)
    v_mfma_f32_16x16x32_bf16 v[144:147], a[208:211], a[88:91], v[144:147]
    ds_read_b64_tr_b16 a[192:193], v26 offset:16384
    v_mfma_f32_16x16x32_bf16 v[160:163], a[208:211], a[92:95], v[160:163]
    ds_read_b64_tr_b16 a[194:195], v26 offset:16896
    v_mfma_f32_16x16x32_bf16 v[148:151], a[212:215], a[88:91], v[148:151]
    ds_read_b64_tr_b16 a[196:197], v27 offset:16384
    v_mfma_f32_16x16x32_bf16 v[164:167], a[212:215], a[92:95], v[164:167]
    ds_read_b64_tr_b16 a[198:199], v27 offset:16896
    v_mfma_f32_16x16x32_bf16 v[152:155], a[216:219], a[88:91], v[152:155]
    ds_read_b64_tr_b16 a[200:201], v28 offset:16384
    v_mfma_f32_16x16x32_bf16 v[168:171], a[216:219], a[92:95], v[168:171]
    ds_read_b64_tr_b16 a[202:203], v28 offset:16896
    v_mfma_f32_16x16x32_bf16 v[156:159], a[220:223], a[88:91], v[156:159]
    ds_read_b64_tr_b16 a[204:205], v29 offset:16384
    v_mfma_f32_16x16x32_bf16 v[172:175], a[220:223], a[92:95], v[172:175]
    ds_read_b64_tr_b16 a[206:207], v29 offset:16896
    s_waitcnt vmcnt(14) lgkmcnt(8)
    v_mfma_f32_16x16x32_bf16 v[144:147], a[160:163], a[96:99], v[144:147]
    ds_read_b64_tr_b16 a[208:209], v26 offset:20480
    v_mfma_f32_16x16x32_bf16 v[160:163], a[160:163], a[100:103], v[160:163]
    ds_read_b64_tr_b16 a[210:211], v26 offset:20992
    v_mfma_f32_16x16x32_bf16 v[148:151], a[164:167], a[96:99], v[148:151]
    ds_read_b64_tr_b16 a[212:213], v27 offset:20480
    v_mfma_f32_16x16x32_bf16 v[164:167], a[164:167], a[100:103], v[164:167]
    ds_read_b64_tr_b16 a[214:215], v27 offset:20992
    v_mfma_f32_16x16x32_bf16 v[152:155], a[168:171], a[96:99], v[152:155]
    ds_read_b64_tr_b16 a[216:217], v28 offset:20480
    v_mfma_f32_16x16x32_bf16 v[168:171], a[168:171], a[100:103], v[168:171]
    ds_read_b64_tr_b16 a[218:219], v28 offset:20992
    v_mfma_f32_16x16x32_bf16 v[156:159], a[172:175], a[96:99], v[156:159]
    ds_read_b64_tr_b16 a[220:221], v29 offset:20480
    v_mfma_f32_16x16x32_bf16 v[172:175], a[172:175], a[100:103], v[172:175]
    ds_read_b64_tr_b16 a[222:223], v29 offset:20992
    s_waitcnt vmcnt(12) lgkmcnt(8)
    v_mfma_f32_16x16x32_bf16 v[144:147], a[176:179], a[104:107], v[144:147]
    ds_read_b64_tr_b16 a[160:161], v26 offset:30848
    v_mfma_f32_16x16x32_bf16 v[160:163], a[176:179], a[108:111], v[160:163]
    ds_read_b64_tr_b16 a[162:163], v26 offset:31360
    v_mfma_f32_16x16x32_bf16 v[148:151], a[180:183], a[104:107], v[148:151]
    ds_read_b64_tr_b16 a[164:165], v27 offset:30848
    v_mfma_f32_16x16x32_bf16 v[164:167], a[180:183], a[108:111], v[164:167]
    ds_read_b64_tr_b16 a[166:167], v27 offset:31360
    v_mfma_f32_16x16x32_bf16 v[152:155], a[184:187], a[104:107], v[152:155]
    ds_read_b64_tr_b16 a[168:169], v28 offset:30848
    v_mfma_f32_16x16x32_bf16 v[168:171], a[184:187], a[108:111], v[168:171]
    ds_read_b64_tr_b16 a[170:171], v28 offset:31360
    v_mfma_f32_16x16x32_bf16 v[156:159], a[188:191], a[104:107], v[156:159]
    ds_read_b64_tr_b16 a[172:173], v29 offset:30848
    v_mfma_f32_16x16x32_bf16 v[172:175], a[188:191], a[108:111], v[172:175]
    ds_read_b64_tr_b16 a[174:175], v29 offset:31360
    s_waitcnt vmcnt(10) lgkmcnt(8)
    v_mfma_f32_16x16x32_bf16 v[144:147], a[192:195], a[112:115], v[144:147]
    ds_read_b64_tr_b16 a[176:177], v26 offset:34944
    v_mfma_f32_16x16x32_bf16 v[160:163], a[192:195], a[116:119], v[160:163]
    ds_read_b64_tr_b16 a[178:179], v26 offset:35456
    v_mfma_f32_16x16x32_bf16 v[148:151], a[196:199], a[112:115], v[148:151]
    ds_read_b64_tr_b16 a[180:181], v27 offset:34944
    v_mfma_f32_16x16x32_bf16 v[164:167], a[196:199], a[116:119], v[164:167]
    ds_read_b64_tr_b16 a[182:183], v27 offset:35456
    v_mfma_f32_16x16x32_bf16 v[152:155], a[200:203], a[112:115], v[152:155]
    ds_read_b64_tr_b16 a[184:185], v28 offset:34944
    v_mfma_f32_16x16x32_bf16 v[168:171], a[200:203], a[116:119], v[168:171]
    ds_read_b64_tr_b16 a[186:187], v28 offset:35456
    v_mfma_f32_16x16x32_bf16 v[156:159], a[204:207], a[112:115], v[156:159]
    ds_read_b64_tr_b16 a[188:189], v29 offset:34944
    v_mfma_f32_16x16x32_bf16 v[172:175], a[204:207], a[116:119], v[172:175]
    ds_read_b64_tr_b16 a[190:191], v29 offset:35456
    s_waitcnt vmcnt(8) lgkmcnt(8)
    v_mfma_f32_16x16x32_bf16 v[144:147], a[208:211], a[120:123], v[144:147]
    ds_read_b64_tr_b16 a[192:193], v26 offset:39040
    v_mfma_f32_16x16x32_bf16 v[160:163], a[208:211], a[124:127], v[160:163]
    ds_read_b64_tr_b16 a[194:195], v26 offset:39552
    v_mfma_f32_16x16x32_bf16 v[148:151], a[212:215], a[120:123], v[148:151]
    ds_read_b64_tr_b16 a[196:197], v27 offset:39040
    v_mfma_f32_16x16x32_bf16 v[164:167], a[212:215], a[124:127], v[164:167]
    ds_read_b64_tr_b16 a[198:199], v27 offset:39552
    v_mfma_f32_16x16x32_bf16 v[152:155], a[216:219], a[120:123], v[152:155]
    ds_read_b64_tr_b16 a[200:201], v28 offset:39040
    v_mfma_f32_16x16x32_bf16 v[168:171], a[216:219], a[124:127], v[168:171]
    ds_read_b64_tr_b16 a[202:203], v28 offset:39552
    v_mfma_f32_16x16x32_bf16 v[156:159], a[220:223], a[120:123], v[156:159]
    ds_read_b64_tr_b16 a[204:205], v29 offset:39040
    v_mfma_f32_16x16x32_bf16 v[172:175], a[220:223], a[124:127], v[172:175]
    ds_read_b64_tr_b16 a[206:207], v29 offset:39552
    s_waitcnt vmcnt(6) lgkmcnt(8)
    v_mfma_f32_16x16x32_bf16 v[144:147], a[160:163], a[128:131], v[144:147]
    ds_read_b64_tr_b16 a[208:209], v26 offset:43136
    v_mfma_f32_16x16x32_bf16 v[160:163], a[160:163], a[132:135], v[160:163]
    ds_read_b64_tr_b16 a[210:211], v26 offset:43648
    v_mfma_f32_16x16x32_bf16 v[148:151], a[164:167], a[128:131], v[148:151]
    ds_read_b64_tr_b16 a[212:213], v27 offset:43136
    v_mfma_f32_16x16x32_bf16 v[164:167], a[164:167], a[132:135], v[164:167]
    ds_read_b64_tr_b16 a[214:215], v27 offset:43648
    v_mfma_f32_16x16x32_bf16 v[152:155], a[168:171], a[128:131], v[152:155]
    ds_read_b64_tr_b16 a[216:217], v28 offset:43136
    v_mfma_f32_16x16x32_bf16 v[168:171], a[168:171], a[132:135], v[168:171]
    ds_read_b64_tr_b16 a[218:219], v28 offset:43648
    v_mfma_f32_16x16x32_bf16 v[156:159], a[172:175], a[128:131], v[156:159]
    ds_read_b64_tr_b16 a[220:221], v29 offset:43136
    v_mfma_f32_16x16x32_bf16 v[172:175], a[172:175], a[132:135], v[172:175]
    ds_read_b64_tr_b16 a[222:223], v29 offset:43648
    s_waitcnt vmcnt(4) lgkmcnt(8)
    v_mfma_f32_16x16x32_bf16 v[144:147], a[176:179], a[136:139], v[144:147]
    v_mfma_f32_16x16x32_bf16 v[160:163], a[176:179], a[140:143], v[160:163]
    v_mfma_f32_16x16x32_bf16 v[148:151], a[180:183], a[136:139], v[148:151]
    v_mfma_f32_16x16x32_bf16 v[164:167], a[180:183], a[140:143], v[164:167]
    v_mfma_f32_16x16x32_bf16 v[152:155], a[184:187], a[136:139], v[152:155]
    v_mfma_f32_16x16x32_bf16 v[168:171], a[184:187], a[140:143], v[168:171]
    v_mfma_f32_16x16x32_bf16 v[156:159], a[188:191], a[136:139], v[156:159]
    v_mfma_f32_16x16x32_bf16 v[172:175], a[188:191], a[140:143], v[172:175]
    s_waitcnt vmcnt(2) lgkmcnt(0)
    v_mfma_f32_16x16x32_bf16 v[144:147], a[192:195], a[144:147], v[144:147]
    v_mfma_f32_16x16x32_bf16 v[160:163], a[192:195], a[148:151], v[160:163]
    v_mfma_f32_16x16x32_bf16 v[148:151], a[196:199], a[144:147], v[148:151]
    v_mfma_f32_16x16x32_bf16 v[164:167], a[196:199], a[148:151], v[164:167]
    v_mfma_f32_16x16x32_bf16 v[152:155], a[200:203], a[144:147], v[152:155]
    v_mfma_f32_16x16x32_bf16 v[168:171], a[200:203], a[148:151], v[168:171]
    v_mfma_f32_16x16x32_bf16 v[156:159], a[204:207], a[144:147], v[156:159]
    v_mfma_f32_16x16x32_bf16 v[172:175], a[204:207], a[148:151], v[172:175]
    s_waitcnt vmcnt(0) lgkmcnt(0)
    v_mfma_f32_16x16x32_bf16 v[144:147], a[208:211], a[152:155], v[144:147]
    v_mfma_f32_16x16x32_bf16 v[160:163], a[208:211], a[156:159], v[160:163]
    v_mfma_f32_16x16x32_bf16 v[148:151], a[212:215], a[152:155], v[148:151]
    v_mfma_f32_16x16x32_bf16 v[164:167], a[212:215], a[156:159], v[164:167]
    v_mfma_f32_16x16x32_bf16 v[152:155], a[216:219], a[152:155], v[152:155]
    v_mfma_f32_16x16x32_bf16 v[168:171], a[216:219], a[156:159], v[168:171]
    v_mfma_f32_16x16x32_bf16 v[156:159], a[220:223], a[152:155], v[156:159]
    v_mfma_f32_16x16x32_bf16 v[172:175], a[220:223], a[156:159], v[172:175]
    s_barrier
    v_mov_b32 v4, 159104
    ds_read_b64 v[4:5], v4
    s_mul_i32 s56, s26, 96
    s_lshl_b32 s57, s3, 5
    s_sub_u32 s57, s57, 32
    s_add_u32 s56, s56, s57
    v_add_u32 v6, s56, v3
    v_mul_u32_u24 v7, 1280, v6
    v_lshl_add_u32 v7, v2, 4, v7
    v_add_u32 v8, 20480, v7
    s_lshl_b32 s58, s27, 7
    s_waitcnt lgkmcnt(0)
    v_and_b32 v9, v4, v5
    s_nop 0
    v_readfirstlane_b32 s59, v9
    s_nop 0
    s_cmp_eq_u32 s59, -1
    s_nop 1
    s_cbranch_scc1 Lnofix
    v_mov_b32 v9, 158848
    v_mov_b32 v10, 158336
    v_mov_b32 v11, 158592
    v_cmp_eq_u32 vcc, v4, v6
    s_nop 1
    v_cndmask_b32 v9, v9, v10, vcc
    v_cmp_eq_u32 vcc, v5, v6
    s_nop 1
    v_cndmask_b32 v9, v9, v11, vcc
    v_lshl_add_u32 v9, v2, 5, v9
    ds_read_b128 v[102:105], v9 offset:0
    ds_read_b128 v[106:109], v9 offset:16
    ds_read_b128 v[110:113], v9 offset:128
    ds_read_b128 v[114:117], v9 offset:144
    v_add_u32 v6, 16, v6
    v_mov_b32 v9, 158848
    v_mov_b32 v10, 158336
    v_mov_b32 v11, 158592
    v_cmp_eq_u32 vcc, v4, v6
    s_nop 1
    v_cndmask_b32 v9, v9, v10, vcc
    v_cmp_eq_u32 vcc, v5, v6
    s_nop 1
    v_cndmask_b32 v9, v9, v11, vcc
    v_lshl_add_u32 v9, v2, 5, v9
    ds_read_b128 v[118:121], v9 offset:0
    ds_read_b128 v[122:125], v9 offset:16
    ds_read_b128 v[126:129], v9 offset:128
    ds_read_b128 v[130:133], v9 offset:144
    s_waitcnt lgkmcnt(0)
    v_pk_add_f32 v[70:71], v[70:71], v[102:103]
    v_pk_add_f32 v[72:73], v[72:73], v[104:105]
    v_pk_add_f32 v[74:75], v[74:75], v[106:107]
    v_pk_add_f32 v[76:77], v[76:77], v[108:109]
    v_pk_add_f32 v[78:79], v[78:79], v[110:111]
    v_pk_add_f32 v[80:81], v[80:81], v[112:113]
    v_pk_add_f32 v[82:83], v[82:83], v[114:115]
    v_pk_add_f32 v[84:85], v[84:85], v[116:117]
    v_pk_add_f32 v[86:87], v[86:87], v[118:119]
    v_pk_add_f32 v[88:89], v[88:89], v[120:121]
    v_pk_add_f32 v[90:91], v[90:91], v[122:123]
    v_pk_add_f32 v[92:93], v[92:93], v[124:125]
    v_pk_add_f32 v[94:95], v[94:95], v[126:127]
    v_pk_add_f32 v[96:97], v[96:97], v[128:129]
    v_pk_add_f32 v[98:99], v[98:99], v[130:131]
    v_pk_add_f32 v[100:101], v[100:101], v[132:133]
    v_cvt_pk_bf16_f32 v71, v70, v71
    v_cvt_pk_bf16_f32 v73, v72, v73
    v_cvt_pk_bf16_f32 v75, v74, v75
    v_cvt_pk_bf16_f32 v77, v76, v77
    v_cvt_pk_bf16_f32 v79, v78, v79
    v_cvt_pk_bf16_f32 v81, v80, v81
    v_cvt_pk_bf16_f32 v83, v82, v83
    v_cvt_pk_bf16_f32 v85, v84, v85
    v_cvt_pk_bf16_f32 v87, v86, v87
    v_cvt_pk_bf16_f32 v89, v88, v89
    v_cvt_pk_bf16_f32 v91, v90, v91
    v_cvt_pk_bf16_f32 v93, v92, v93
    v_cvt_pk_bf16_f32 v95, v94, v95
    v_cvt_pk_bf16_f32 v97, v96, v97
    v_cvt_pk_bf16_f32 v99, v98, v99
    v_cvt_pk_bf16_f32 v101, v100, v101
    v_lshlrev_b32 v70, 16, v71
    v_and_b32 v71, 0xffff0000, v71
    v_lshlrev_b32 v72, 16, v73
    v_and_b32 v73, 0xffff0000, v73
    v_lshlrev_b32 v74, 16, v75
    v_and_b32 v75, 0xffff0000, v75
    v_lshlrev_b32 v76, 16, v77
    v_and_b32 v77, 0xffff0000, v77
    v_lshlrev_b32 v78, 16, v79
    v_and_b32 v79, 0xffff0000, v79
    v_lshlrev_b32 v80, 16, v81
    v_and_b32 v81, 0xffff0000, v81
    v_lshlrev_b32 v82, 16, v83
    v_and_b32 v83, 0xffff0000, v83
    v_lshlrev_b32 v84, 16, v85
    v_and_b32 v85, 0xffff0000, v85
    v_lshlrev_b32 v86, 16, v87
    v_and_b32 v87, 0xffff0000, v87
    v_lshlrev_b32 v88, 16, v89
    v_and_b32 v89, 0xffff0000, v89
    v_lshlrev_b32 v90, 16, v91
    v_and_b32 v91, 0xffff0000, v91
    v_lshlrev_b32 v92, 16, v93
    v_and_b32 v93, 0xffff0000, v93
    v_lshlrev_b32 v94, 16, v95
    v_and_b32 v95, 0xffff0000, v95
    v_lshlrev_b32 v96, 16, v97
    v_and_b32 v97, 0xffff0000, v97
    v_lshlrev_b32 v98, 16, v99
    v_and_b32 v99, 0xffff0000, v99
    v_lshlrev_b32 v100, 16, v101
    v_and_b32 v101, 0xffff0000, v101
    v_mul_f32 v102, 0xbfb8aa3b, v70
    v_mul_f32 v103, 0xbfb8aa3b, v71
    v_mul_f32 v104, 0xbfb8aa3b, v72
    v_mul_f32 v105, 0xbfb8aa3b, v73
    v_mul_f32 v106, 0xbfb8aa3b, v74
    v_mul_f32 v107, 0xbfb8aa3b, v75
    v_mul_f32 v108, 0xbfb8aa3b, v76
    v_mul_f32 v109, 0xbfb8aa3b, v77
    v_mul_f32 v110, 0xbfb8aa3b, v78
    v_mul_f32 v111, 0xbfb8aa3b, v79
    v_mul_f32 v112, 0xbfb8aa3b, v80
    v_mul_f32 v113, 0xbfb8aa3b, v81
    v_mul_f32 v114, 0xbfb8aa3b, v82
    v_mul_f32 v115, 0xbfb8aa3b, v83
    v_mul_f32 v116, 0xbfb8aa3b, v84
    v_mul_f32 v117, 0xbfb8aa3b, v85
    v_mul_f32 v118, 0xbfb8aa3b, v86
    v_mul_f32 v119, 0xbfb8aa3b, v87
    v_mul_f32 v120, 0xbfb8aa3b, v88
    v_mul_f32 v121, 0xbfb8aa3b, v89
    v_mul_f32 v122, 0xbfb8aa3b, v90
    v_mul_f32 v123, 0xbfb8aa3b, v91
    v_mul_f32 v124, 0xbfb8aa3b, v92
    v_mul_f32 v125, 0xbfb8aa3b, v93
    v_mul_f32 v126, 0xbfb8aa3b, v94
    v_mul_f32 v127, 0xbfb8aa3b, v95
    v_mul_f32 v128, 0xbfb8aa3b, v96
    v_mul_f32 v129, 0xbfb8aa3b, v97
    v_mul_f32 v130, 0xbfb8aa3b, v98
    v_mul_f32 v131, 0xbfb8aa3b, v99
    v_mul_f32 v132, 0xbfb8aa3b, v100
    v_mul_f32 v133, 0xbfb8aa3b, v101
    v_exp_f32 v102, v102
    v_exp_f32 v103, v103
    v_exp_f32 v104, v104
    v_exp_f32 v105, v105
    v_exp_f32 v106, v106
    v_exp_f32 v107, v107
    v_exp_f32 v108, v108
    v_exp_f32 v109, v109
    v_exp_f32 v110, v110
    v_exp_f32 v111, v111
    v_exp_f32 v112, v112
    v_exp_f32 v113, v113
    v_exp_f32 v114, v114
    v_exp_f32 v115, v115
    v_exp_f32 v116, v116
    v_exp_f32 v117, v117
    v_exp_f32 v118, v118
    v_exp_f32 v119, v119
    v_exp_f32 v120, v120
    v_exp_f32 v121, v121
    v_exp_f32 v122, v122
    v_exp_f32 v123, v123
    v_exp_f32 v124, v124
    v_exp_f32 v125, v125
    v_exp_f32 v126, v126
    v_exp_f32 v127, v127
    v_exp_f32 v128, v128
    v_exp_f32 v129, v129
    v_exp_f32 v130, v130
    v_exp_f32 v131, v131
    v_exp_f32 v132, v132
    v_exp_f32 v133, v133
    v_add_f32 v102, 1.0, v102
    v_add_f32 v103, 1.0, v103
    v_add_f32 v104, 1.0, v104
    v_add_f32 v105, 1.0, v105
    v_add_f32 v106, 1.0, v106
    v_add_f32 v107, 1.0, v107
    v_add_f32 v108, 1.0, v108
    v_add_f32 v109, 1.0, v109
    v_add_f32 v110, 1.0, v110
    v_add_f32 v111, 1.0, v111
    v_add_f32 v112, 1.0, v112
    v_add_f32 v113, 1.0, v113
    v_add_f32 v114, 1.0, v114
    v_add_f32 v115, 1.0, v115
    v_add_f32 v116, 1.0, v116
    v_add_f32 v117, 1.0, v117
    v_add_f32 v118, 1.0, v118
    v_add_f32 v119, 1.0, v119
    v_add_f32 v120, 1.0, v120
    v_add_f32 v121, 1.0, v121
    v_add_f32 v122, 1.0, v122
    v_add_f32 v123, 1.0, v123
    v_add_f32 v124, 1.0, v124
    v_add_f32 v125, 1.0, v125
    v_add_f32 v126, 1.0, v126
    v_add_f32 v127, 1.0, v127
    v_add_f32 v128, 1.0, v128
    v_add_f32 v129, 1.0, v129
    v_add_f32 v130, 1.0, v130
    v_add_f32 v131, 1.0, v131
    v_add_f32 v132, 1.0, v132
    v_add_f32 v133, 1.0, v133
    v_rcp_f32 v102, v102
    v_rcp_f32 v103, v103
    v_rcp_f32 v104, v104
    v_rcp_f32 v105, v105
    v_rcp_f32 v106, v106
    v_rcp_f32 v107, v107
    v_rcp_f32 v108, v108
    v_rcp_f32 v109, v109
    v_rcp_f32 v110, v110
    v_rcp_f32 v111, v111
    v_rcp_f32 v112, v112
    v_rcp_f32 v113, v113
    v_rcp_f32 v114, v114
    v_rcp_f32 v115, v115
    v_rcp_f32 v116, v116
    v_rcp_f32 v117, v117
    v_rcp_f32 v118, v118
    v_rcp_f32 v119, v119
    v_rcp_f32 v120, v120
    v_rcp_f32 v121, v121
    v_rcp_f32 v122, v122
    v_rcp_f32 v123, v123
    v_rcp_f32 v124, v124
    v_rcp_f32 v125, v125
    v_rcp_f32 v126, v126
    v_rcp_f32 v127, v127
    v_rcp_f32 v128, v128
    v_rcp_f32 v129, v129
    v_rcp_f32 v130, v130
    v_rcp_f32 v131, v131
    v_rcp_f32 v132, v132
    v_rcp_f32 v133, v133
    v_pk_mul_f32 v[102:103], v[102:103], v[70:71]
    v_pk_mul_f32 v[104:105], v[104:105], v[72:73]
    v_pk_mul_f32 v[106:107], v[106:107], v[74:75]
    v_pk_mul_f32 v[108:109], v[108:109], v[76:77]
    v_pk_mul_f32 v[110:111], v[110:111], v[78:79]
    v_pk_mul_f32 v[112:113], v[112:113], v[80:81]
    v_pk_mul_f32 v[114:115], v[114:115], v[82:83]
    v_pk_mul_f32 v[116:117], v[116:117], v[84:85]
    v_pk_mul_f32 v[118:119], v[118:119], v[86:87]
    v_pk_mul_f32 v[120:121], v[120:121], v[88:89]
    v_pk_mul_f32 v[122:123], v[122:123], v[90:91]
    v_pk_mul_f32 v[124:125], v[124:125], v[92:93]
    v_pk_mul_f32 v[126:127], v[126:127], v[94:95]
    v_pk_mul_f32 v[128:129], v[128:129], v[96:97]
    v_pk_mul_f32 v[130:131], v[130:131], v[98:99]
    v_pk_mul_f32 v[132:133], v[132:133], v[100:101]
    v_cvt_pk_bf16_f32 v103, v102, v103
    v_cvt_pk_bf16_f32 v105, v104, v105
    v_cvt_pk_bf16_f32 v107, v106, v107
    v_cvt_pk_bf16_f32 v109, v108, v109
    v_cvt_pk_bf16_f32 v111, v110, v111
    v_cvt_pk_bf16_f32 v113, v112, v113
    v_cvt_pk_bf16_f32 v115, v114, v115
    v_cvt_pk_bf16_f32 v117, v116, v117
    v_cvt_pk_bf16_f32 v119, v118, v119
    v_cvt_pk_bf16_f32 v121, v120, v121
    v_cvt_pk_bf16_f32 v123, v122, v123
    v_cvt_pk_bf16_f32 v125, v124, v125
    v_cvt_pk_bf16_f32 v127, v126, v127
    v_cvt_pk_bf16_f32 v129, v128, v129
    v_cvt_pk_bf16_f32 v131, v130, v131
    v_cvt_pk_bf16_f32 v133, v132, v133
    v_lshlrev_b32 v102, 16, v103
    v_and_b32 v103, 0xffff0000, v103
    v_lshlrev_b32 v104, 16, v105
    v_and_b32 v105, 0xffff0000, v105
    v_lshlrev_b32 v106, 16, v107
    v_and_b32 v107, 0xffff0000, v107
    v_lshlrev_b32 v108, 16, v109
    v_and_b32 v109, 0xffff0000, v109
    v_lshlrev_b32 v110, 16, v111
    v_and_b32 v111, 0xffff0000, v111
    v_lshlrev_b32 v112, 16, v113
    v_and_b32 v113, 0xffff0000, v113
    v_lshlrev_b32 v114, 16, v115
    v_and_b32 v115, 0xffff0000, v115
    v_lshlrev_b32 v116, 16, v117
    v_and_b32 v117, 0xffff0000, v117
    v_lshlrev_b32 v118, 16, v119
    v_and_b32 v119, 0xffff0000, v119
    v_lshlrev_b32 v120, 16, v121
    v_and_b32 v121, 0xffff0000, v121
    v_lshlrev_b32 v122, 16, v123
    v_and_b32 v123, 0xffff0000, v123
    v_lshlrev_b32 v124, 16, v125
    v_and_b32 v125, 0xffff0000, v125
    v_lshlrev_b32 v126, 16, v127
    v_and_b32 v127, 0xffff0000, v127
    v_lshlrev_b32 v128, 16, v129
    v_and_b32 v129, 0xffff0000, v129
    v_lshlrev_b32 v130, 16, v131
    v_and_b32 v131, 0xffff0000, v131
    v_lshlrev_b32 v132, 16, v133
    v_and_b32 v133, 0xffff0000, v133
    s_nop 1
Lnofix:
    v_pk_fma_f32 v[144:145], v[144:145], v[102:103], v[38:39]
    v_pk_fma_f32 v[146:147], v[146:147], v[104:105], v[40:41]
    v_pk_fma_f32 v[148:149], v[148:149], v[106:107], v[42:43]
    v_pk_fma_f32 v[150:151], v[150:151], v[108:109], v[44:45]
    v_cvt_pk_bf16_f32 v216, v144, v145
    v_cvt_pk_bf16_f32 v217, v146, v147
    v_cvt_pk_bf16_f32 v218, v148, v149
    v_cvt_pk_bf16_f32 v219, v150, v151
    buffer_store_dwordx4 v[216:219], v7, s[88:91], s58 offen offset:0
    v_pk_fma_f32 v[152:153], v[152:153], v[110:111], v[46:47]
    v_pk_fma_f32 v[154:155], v[154:155], v[112:113], v[48:49]
    v_pk_fma_f32 v[156:157], v[156:157], v[114:115], v[50:51]
    v_pk_fma_f32 v[158:159], v[158:159], v[116:117], v[52:53]
    v_cvt_pk_bf16_f32 v220, v152, v153
    v_cvt_pk_bf16_f32 v221, v154, v155
    v_cvt_pk_bf16_f32 v222, v156, v157
    v_cvt_pk_bf16_f32 v223, v158, v159
    buffer_store_dwordx4 v[220:223], v7, s[88:91], s58 offen offset:64
    v_pk_fma_f32 v[160:161], v[160:161], v[118:119], v[54:55]
    v_pk_fma_f32 v[162:163], v[162:163], v[120:121], v[56:57]
    v_pk_fma_f32 v[164:165], v[164:165], v[122:123], v[58:59]
    v_pk_fma_f32 v[166:167], v[166:167], v[124:125], v[60:61]
    v_cvt_pk_bf16_f32 v224, v160, v161
    v_cvt_pk_bf16_f32 v225, v162, v163
    v_cvt_pk_bf16_f32 v226, v164, v165
    v_cvt_pk_bf16_f32 v227, v166, v167
    buffer_store_dwordx4 v[224:227], v8, s[88:91], s58 offen offset:0
    v_pk_fma_f32 v[168:169], v[168:169], v[126:127], v[62:63]
    v_pk_fma_f32 v[170:171], v[170:171], v[128:129], v[64:65]
    v_pk_fma_f32 v[172:173], v[172:173], v[130:131], v[66:67]
    v_pk_fma_f32 v[174:175], v[174:175], v[132:133], v[68:69]
    v_cvt_pk_bf16_f32 v228, v168, v169
    v_cvt_pk_bf16_f32 v229, v170, v171
    v_cvt_pk_bf16_f32 v230, v172, v173
    v_cvt_pk_bf16_f32 v231, v174, v175
    buffer_store_dwordx4 v[228:231], v8, s[88:91], s58 offen offset:64
    s_nop 0
    s_endpgm
Lwave0:
Lpt_1:
    s_sub_u32 s54, s54, 1
    s_cbranch_scc1 Lend
    buffer_load_dword v4, v12, s[48:51], 0 offen sc1
    v_lshrrev_b32 v5, 1, v12
    v_and_b32 v5, 0x3c, v5
    v_add_u32 v5, 128, v5
    s_waitcnt vmcnt(0)
    ds_bpermute_b32 v5, v5, v4
    v_readlane_b32 s53, v4, 48
    v_and_b32 v6, 4, v12
    v_lshlrev_b32 v6, 2, v6
    s_waitcnt lgkmcnt(0)
    v_bfe_u32 v5, v5, v6, 16
    v_cmp_ne_u32 vcc, 0, v4
    v_cmp_ne_u32 s[56:57], 0, v5
    s_nop 0
    s_and_b32 s56, s56, vcc_lo
    s_cmp_lg_u32 s53, 0
    s_cselect_b32 s56, s56, 0
    s_cmp_eq_u32 s56, -1
    s_cbranch_scc1 Lptd_2
    s_sleep 4
    s_branch Lpt_1
Lptd_2:
    v_lshlrev_b32 v6, 4, v12
    v_and_b32 v7, 63, v5
    v_add_u32 v7, v7, v6
    v_sub_u32 v7, 2047, v7
    v_bfe_u32 v5, v5, 6, 6
    v_add_u32 v5, v5, v6
    v_sub_u32 v5, 2047, v5
    v_and_b32 v6, 0xffff0000, v4
    v_or_b32 v7, v7, v6
    v_lshl_or_b32 v5, v4, 16, v5
    v_cmp_gt_u32 vcc, 128, v12
    s_nop 1
    v_cndmask_b32 v7, 0, v7, vcc
    v_cndmask_b32 v5, 0, v5, vcc
    v_mov_b32 v4, v7
    s_nop 1
    v_max_u32_dpp v4, v4, v4 row_ror:8 row_mask:0xf bank_mask:0xf
    s_nop 1
    v_max_u32_dpp v4, v4, v4 row_ror:4 row_mask:0xf bank_mask:0xf
    s_nop 1
    v_max_u32_dpp v4, v4, v4 row_ror:2 row_mask:0xf bank_mask:0xf
    s_nop 1
    v_max_u32_dpp v4, v4, v4 row_ror:1 row_mask:0xf bank_mask:0xf
    s_nop 0
    v_readlane_b32 s24, v4, 0
    v_readlane_b32 s56, v4, 16
    v_readlane_b32 s57, v4, 32
    v_readlane_b32 s58, v4, 48
    s_max_u32 s24, s24, s56
    s_max_u32 s57, s57, s58
    s_max_u32 s24, s24, s57
    v_cmp_eq_u32 vcc, s24, v7
    s_nop 1
    v_cndmask_b32 v4, v7, v5, vcc
    s_nop 1
    v_max_u32_dpp v4, v4, v4 row_ror:8 row_mask:0xf bank_mask:0xf
    s_nop 1
    v_max_u32_dpp v4, v4, v4 row_ror:4 row_mask:0xf bank_mask:0xf
    s_nop 1
    v_max_u32_dpp v4, v4, v4 row_ror:2 row_mask:0xf bank_mask:0xf
    s_nop 1
    v_max_u32_dpp v4, v4, v4 row_ror:1 row_mask:0xf bank_mask:0xf
    s_nop 0
    v_readlane_b32 s25, v4, 0
    v_readlane_b32 s56, v4, 16
    v_readlane_b32 s57, v4, 32
    v_readlane_b32 s58, v4, 48
    s_max_u32 s25, s25, s56
    s_max_u32 s57, s57, s58
    s_max_u32 s25, s25, s57
    s_mul_i32 s56, s26, 96
    s_and_b32 s60, s24, 0x7ff
    s_sub_u32 s60, 2047, s60
    s_sub_u32 s57, s60, s56
    s_cmp_lt_u32 s57, 96
    s_cselect_b32 s60, s60, -1
    s_and_b32 s61, s25, 0x7ff
    s_sub_u32 s61, 2047, s61
    s_sub_u32 s57, s61, s56
    s_cmp_lt_u32 s57, 96
    s_cselect_b32 s61, s61, -1
    v_mov_b32 v4, s60
    v_mov_b32 v5, s61
    v_mov_b32 v6, 159104
    ds_write_b64 v6, v[4:5]
    s_and_b32 s57, s60, s61
    s_cmp_eq_u32 s57, -1
    s_cbranch_scc1 Lw0_done
    v_lshlrev_b32 v8, 4, v1
    s_nop 1
Ly_poll:
    s_sub_u32 s54, s54, 1
    s_cbranch_scc1 Lend
    s_lshl_b32 s56, s27, 10
    s_add_u32 s56, s56, 7405568
    buffer_load_dwordx4 v[100:103], v8, s[44:47], s56 offen sc1
    s_add_u32 s56, s56, 10240
    buffer_load_dwordx4 v[104:107], v8, s[44:47], s56 offen sc1
    s_add_u32 s56, s56, 10240
    buffer_load_dwordx4 v[108:111], v8, s[44:47], s56 offen sc1
    s_add_u32 s56, s56, 10240
    buffer_load_dwordx4 v[112:115], v8, s[44:47], s56 offen sc1
    s_add_u32 s56, s56, 10240
    buffer_load_dwordx4 v[116:119], v8, s[44:47], s56 offen sc1
    s_add_u32 s56, s56, 10240
    buffer_load_dwordx4 v[120:123], v8, s[44:47], s56 offen sc1
    s_add_u32 s56, s56, 10240
    buffer_load_dwordx4 v[124:127], v8, s[44:47], s56 offen sc1
    s_add_u32 s56, s56, 10240
    buffer_load_dwordx4 v[128:131], v8, s[44:47], s56 offen sc1
    s_add_u32 s56, s56, 10240
    buffer_load_dwordx4 v[132:135], v8, s[44:47], s56 offen sc1
    s_add_u32 s56, s56, 10240
    buffer_load_dwordx4 v[136:139], v8, s[44:47], s56 offen sc1
    s_add_u32 s56, s56, 10240
    buffer_load_dwordx4 v[140:143], v8, s[44:47], s56 offen sc1
    s_add_u32 s56, s56, 10240
    buffer_load_dwordx4 v[144:147], v8, s[44:47], s56 offen sc1
    s_add_u32 s56, s56, 10240
    buffer_load_dwordx4 v[148:151], v8, s[44:47], s56 offen sc1
    s_add_u32 s56, s56, 10240
    buffer_load_dwordx4 v[152:155], v8, s[44:47], s56 offen sc1
    s_add_u32 s56, s56, 10240
    buffer_load_dwordx4 v[156:159], v8, s[44:47], s56 offen sc1
    s_add_u32 s56, s56, 10240
    buffer_load_dwordx4 v[160:163], v8, s[44:47], s56 offen sc1
    s_add_u32 s56, s56, 10240
    buffer_load_dwordx4 v[164:167], v8, s[44:47], s56 offen sc1
    s_add_u32 s56, s56, 10240
    buffer_load_dwordx4 v[168:171], v8, s[44:47], s56 offen sc1
    s_add_u32 s56, s56, 10240
    buffer_load_dwordx4 v[172:175], v8, s[44:47], s56 offen sc1
    s_add_u32 s56, s56, 10240
    buffer_load_dwordx4 v[176:179], v8, s[44:47], s56 offen sc1
    s_add_u32 s56, s56, 10240
    buffer_load_dwordx4 v[180:183], v8, s[44:47], s56 offen sc1
    s_add_u32 s56, s56, 10240
    buffer_load_dwordx4 v[184:187], v8, s[44:47], s56 offen sc1
    s_add_u32 s56, s56, 10240
    buffer_load_dwordx4 v[188:191], v8, s[44:47], s56 offen sc1
    s_add_u32 s56, s56, 10240
    buffer_load_dwordx4 v[192:195], v8, s[44:47], s56 offen sc1
    s_add_u32 s56, s56, 10240
    buffer_load_dwordx4 v[196:199], v8, s[44:47], s56 offen sc1
    s_add_u32 s56, s56, 10240
    buffer_load_dwordx4 v[200:203], v8, s[44:47], s56 offen sc1
    s_add_u32 s56, s56, 10240
    buffer_load_dwordx4 v[204:207], v8, s[44:47], s56 offen sc1
    s_add_u32 s56, s56, 10240
    s_mov_b64 s[56:57], -1
    s_waitcnt vmcnt(0)
    v_cmp_eq_u32 vcc, s53, v101
    s_nop 0
    s_and_b64 s[56:57], s[56:57], vcc
    v_cmp_eq_u32 vcc, s53, v103
    s_nop 0
    s_and_b64 s[56:57], s[56:57], vcc
    v_cmp_eq_u32 vcc, s53, v105
    s_nop 0
    s_and_b64 s[56:57], s[56:57], vcc
    v_cmp_eq_u32 vcc, s53, v107
    s_nop 0
    s_and_b64 s[56:57], s[56:57], vcc
    v_cmp_eq_u32 vcc, s53, v109
    s_nop 0
    s_and_b64 s[56:57], s[56:57], vcc
    v_cmp_eq_u32 vcc, s53, v111
    s_nop 0
    s_and_b64 s[56:57], s[56:57], vcc
    v_cmp_eq_u32 vcc, s53, v113
    s_nop 0
    s_and_b64 s[56:57], s[56:57], vcc
    v_cmp_eq_u32 vcc, s53, v115
    s_nop 0
    s_and_b64 s[56:57], s[56:57], vcc
    v_cmp_eq_u32 vcc, s53, v117
    s_nop 0
    s_and_b64 s[56:57], s[56:57], vcc
    v_cmp_eq_u32 vcc, s53, v119
    s_nop 0
    s_and_b64 s[56:57], s[56:57], vcc
    v_cmp_eq_u32 vcc, s53, v121
    s_nop 0
    s_and_b64 s[56:57], s[56:57], vcc
    v_cmp_eq_u32 vcc, s53, v123
    s_nop 0
    s_and_b64 s[56:57], s[56:57], vcc
    v_cmp_eq_u32 vcc, s53, v125
    s_nop 0
    s_and_b64 s[56:57], s[56:57], vcc
    v_cmp_eq_u32 vcc, s53, v127
    s_nop 0
    s_and_b64 s[56:57], s[56:57], vcc
    v_cmp_eq_u32 vcc, s53, v129
    s_nop 0
    s_and_b64 s[56:57], s[56:57], vcc
    v_cmp_eq_u32 vcc, s53, v131
    s_nop 0
    s_and_b64 s[56:57], s[56:57], vcc
    v_cmp_eq_u32 vcc, s53, v133
    s_nop 0
    s_and_b64 s[56:57], s[56:57], vcc
    v_cmp_eq_u32 vcc, s53, v135
    s_nop 0
    s_and_b64 s[56:57], s[56:57], vcc
    v_cmp_eq_u32 vcc, s53, v137
    s_nop 0
    s_and_b64 s[56:57], s[56:57], vcc
    v_cmp_eq_u32 vcc, s53, v139
    s_nop 0
    s_and_b64 s[56:57], s[56:57], vcc
    v_cmp_eq_u32 vcc, s53, v141
    s_nop 0
    s_and_b64 s[56:57], s[56:57], vcc
    v_cmp_eq_u32 vcc, s53, v143
    s_nop 0
    s_and_b64 s[56:57], s[56:57], vcc
    v_cmp_eq_u32 vcc, s53, v145
    s_nop 0
    s_and_b64 s[56:57], s[56:57], vcc
    v_cmp_eq_u32 vcc, s53, v147
    s_nop 0
    s_and_b64 s[56:57], s[56:57], vcc
    v_cmp_eq_u32 vcc, s53, v149
    s_nop 0
    s_and_b64 s[56:57], s[56:57], vcc
    v_cmp_eq_u32 vcc, s53, v151
    s_nop 0
    s_and_b64 s[56:57], s[56:57], vcc
    v_cmp_eq_u32 vcc, s53, v153
    s_nop 0
    s_and_b64 s[56:57], s[56:57], vcc
    v_cmp_eq_u32 vcc, s53, v155
    s_nop 0
    s_and_b64 s[56:57], s[56:57], vcc
    v_cmp_eq_u32 vcc, s53, v157
    s_nop 0
    s_and_b64 s[56:57], s[56:57], vcc
    v_cmp_eq_u32 vcc, s53, v159
    s_nop 0
    s_and_b64 s[56:57], s[56:57], vcc
    v_cmp_eq_u32 vcc, s53, v161
    s_nop 0
    s_and_b64 s[56:57], s[56:57], vcc
    v_cmp_eq_u32 vcc, s53, v163
    s_nop 0
    s_and_b64 s[56:57], s[56:57], vcc
    v_cmp_eq_u32 vcc, s53, v165
    s_nop 0
    s_and_b64 s[56:57], s[56:57], vcc
    v_cmp_eq_u32 vcc, s53, v167
    s_nop 0
    s_and_b64 s[56:57], s[56:57], vcc
    v_cmp_eq_u32 vcc, s53, v169
    s_nop 0
    s_and_b64 s[56:57], s[56:57], vcc
    v_cmp_eq_u32 vcc, s53, v171
    s_nop 0
    s_and_b64 s[56:57], s[56:57], vcc
    v_cmp_eq_u32 vcc, s53, v173
    s_nop 0
    s_and_b64 s[56:57], s[56:57], vcc
    v_cmp_eq_u32 vcc, s53, v175
    s_nop 0
    s_and_b64 s[56:57], s[56:57], vcc
    v_cmp_eq_u32 vcc, s53, v177
    s_nop 0
    s_and_b64 s[56:57], s[56:57], vcc
    v_cmp_eq_u32 vcc, s53, v179
    s_nop 0
    s_and_b64 s[56:57], s[56:57], vcc
    v_cmp_eq_u32 vcc, s53, v181
    s_nop 0
    s_and_b64 s[56:57], s[56:57], vcc
    v_cmp_eq_u32 vcc, s53, v183
    s_nop 0
    s_and_b64 s[56:57], s[56:57], vcc
    v_cmp_eq_u32 vcc, s53, v185
    s_nop 0
    s_and_b64 s[56:57], s[56:57], vcc
    v_cmp_eq_u32 vcc, s53, v187
    s_nop 0
    s_and_b64 s[56:57], s[56:57], vcc
    v_cmp_eq_u32 vcc, s53, v189
    s_nop 0
    s_and_b64 s[56:57], s[56:57], vcc
    v_cmp_eq_u32 vcc, s53, v191
    s_nop 0
    s_and_b64 s[56:57], s[56:57], vcc
    v_cmp_eq_u32 vcc, s53, v193
    s_nop 0
    s_and_b64 s[56:57], s[56:57], vcc
    v_cmp_eq_u32 vcc, s53, v195
    s_nop 0
    s_and_b64 s[56:57], s[56:57], vcc
    v_cmp_eq_u32 vcc, s53, v197
    s_nop 0
    s_and_b64 s[56:57], s[56:57], vcc
    v_cmp_eq_u32 vcc, s53, v199
    s_nop 0
    s_and_b64 s[56:57], s[56:57], vcc
    v_cmp_eq_u32 vcc, s53, v201
    s_nop 0
    s_and_b64 s[56:57], s[56:57], vcc
    v_cmp_eq_u32 vcc, s53, v203
    s_nop 0
    s_and_b64 s[56:57], s[56:57], vcc
    v_cmp_eq_u32 vcc, s53, v205
    s_nop 0
    s_and_b64 s[56:57], s[56:57], vcc
    v_cmp_eq_u32 vcc, s53, v207
    s_nop 0
    s_and_b64 s[56:57], s[56:57], vcc
    s_cmp_eq_u64 s[56:57], -1
    s_nop 0
    s_cbranch_scc0 Ly_poll
    v_add_f32 v100, v100, v104
    v_add_f32 v102, v102, v106
    v_add_f32 v100, v100, v108
    v_add_f32 v102, v102, v110
    v_add_f32 v100, v100, v112
    v_add_f32 v102, v102, v114
    v_add_f32 v100, v100, v116
    v_add_f32 v102, v102, v118
    v_add_f32 v100, v100, v120
    v_add_f32 v102, v102, v122
    v_add_f32 v100, v100, v124
    v_add_f32 v102, v102, v126
    v_add_f32 v100, v100, v128
    v_add_f32 v102, v102, v130
    v_add_f32 v100, v100, v132
    v_add_f32 v102, v102, v134
    v_add_f32 v100, v100, v136
    v_add_f32 v102, v102, v138
    v_add_f32 v100, v100, v140
    v_add_f32 v102, v102, v142
    v_add_f32 v100, v100, v144
    v_add_f32 v102, v102, v146
    v_add_f32 v100, v100, v148
    v_add_f32 v102, v102, v150
    v_add_f32 v100, v100, v152
    v_add_f32 v102, v102, v154
    v_add_f32 v100, v100, v156
    v_add_f32 v102, v102, v158
    v_add_f32 v100, v100, v160
    v_add_f32 v102, v102, v162
    v_add_f32 v100, v100, v164
    v_add_f32 v102, v102, v166
    v_add_f32 v100, v100, v168
    v_add_f32 v102, v102, v170
    v_add_f32 v100, v100, v172
    v_add_f32 v102, v102, v174
    v_add_f32 v100, v100, v176
    v_add_f32 v102, v102, v178
    v_add_f32 v100, v100, v180
    v_add_f32 v102, v102, v182
    v_add_f32 v100, v100, v184
    v_add_f32 v102, v102, v186
    v_add_f32 v100, v100, v188
    v_add_f32 v102, v102, v190
    v_add_f32 v100, v100, v192
    v_add_f32 v102, v102, v194
    v_add_f32 v100, v100, v196
    v_add_f32 v102, v102, v198
    v_add_f32 v100, v100, v200
    v_add_f32 v102, v102, v202
    v_add_f32 v100, v100, v204
    v_add_f32 v102, v102, v206
    s_lshr_b32 s56, s24, 16
    s_cmp_ge_u32 s56, 0x8000
    s_cselect_b32 s57, 0x8000, -1
    s_xor_b32 s56, s56, s57
    s_lshl_b32 s56, s56, 16
    v_mov_b32 v4, s56
    v_mul_f32 v4, 0xbfb8aa3b, v4
    v_exp_f32 v4, v4
    s_nop 0
    v_add_f32 v4, 1.0, v4
    v_rcp_f32 v4, v4
    s_nop 0
    v_cvt_pk_bf16_f32 v4, v4, v4
    v_lshlrev_b32 v4, 16, v4
    v_cvt_pk_bf16_f32 v100, v100, v100
    v_lshlrev_b32 v100, 16, v100
    v_mul_f32 v100, v100, v4
    v_cvt_pk_bf16_f32 v100, v100, v100
    v_lshlrev_b32 v100, 16, v100
    v_add_u32 v5, 158336, v12
    ds_write_b32 v5, v100 offset:0
    s_lshr_b32 s56, s25, 16
    s_cmp_ge_u32 s56, 0x8000
    s_cselect_b32 s57, 0x8000, -1
    s_xor_b32 s56, s56, s57
    s_lshl_b32 s56, s56, 16
    v_mov_b32 v4, s56
    v_mul_f32 v4, 0xbfb8aa3b, v4
    v_exp_f32 v4, v4
    s_nop 0
    v_add_f32 v4, 1.0, v4
    v_rcp_f32 v4, v4
    s_nop 0
    v_cvt_pk_bf16_f32 v4, v4, v4
    v_lshlrev_b32 v4, 16, v4
    v_cvt_pk_bf16_f32 v102, v102, v102
    v_lshlrev_b32 v102, 16, v102
    v_mul_f32 v102, v102, v4
    v_cvt_pk_bf16_f32 v102, v102, v102
    v_lshlrev_b32 v102, 16, v102
    v_add_u32 v5, 158336, v12
    ds_write_b32 v5, v102 offset:256
    v_mov_b32 v4, 0
    ds_write_b32 v5, v4 offset:512
    s_nop 0
Lw0_done:
    s_waitcnt lgkmcnt(0)
    s_barrier
    s_endpgm
Laux:
    s_mul_i32 s26, s56, 9
    s_lshl_b32 s58, s58, 2
    s_add_u32 s26, s26, s58
    s_add_u32 s26, s26, s57
    s_cmp_eq_u32 s26, 0
    s_cbranch_scc0 Laux2
    s_cmp_lg_u32 s3, 0
    s_cbranch_scc1 Lend
    s_mov_b64 exec, 1
    v_mov_b32 v4, 0
    v_mov_b32 v6, 192
    buffer_load_dword v5, v4, s[44:47], 0 offen sc1
    s_waitcnt vmcnt(0)
    v_add_u32 v5, 0x9e3779b8, v5
    v_or_b32 v5, 1, v5
    buffer_store_dword v5, v6, s[48:51], 0 offen sc1
    buffer_store_dword v5, v4, s[44:47], 0 offen sc1
    s_endpgm
Laux2:
    s_sub_u32 s26, s26, 1
    s_cmp_ge_u32 s26, 32
    s_cbranch_scc1 Lend
    s_mov_b32 s32, s14
    s_mov_b32 s33, s15
    s_mov_b32 s34, 2211840
    s_mov_b32 s35, 0x20000
    s_mov_b32 s36, s16
    s_mov_b32 s37, s17
    s_mov_b32 s38, 2211840
    s_mov_b32 s39, 0x20000
    s_mov_b32 s40, s18
    s_mov_b32 s41, s19
    s_mov_b32 s42, 2211840
    s_mov_b32 s43, 0x20000
    s_mov_b32 s60, s12
    s_mov_b32 s61, s13
    s_mov_b32 s62, 1280
    s_mov_b32 s63, 0x20000
    v_lshrrev_b32 v5, 3, v1
    v_and_b32 v6, 7, v1
    s_lshl_b32 s55, s3, 11
    s_lshl_b32 s56, s26, 6
    s_lshl_b32 s57, s3, 4
    s_add_u32 s56, s56, s57
    v_add_u32 v7, s56, v5
    v_mul_u32_u24 v7, 1280, v7
    v_xor_b32 v8, v6, v2
    v_lshl_add_u32 v14, v8, 4, v7
    v_xor_b32 v15, 64, v14
    v_add_u32 v15, 10240, v15
    s_mov_b32 m0, 155648
    s_nop 0
    buffer_load_dwordx4 v13, s[60:63], 0 offen lds
    s_mov_b64 exec, 0xffff
    buffer_load_dwordx4 v13, s[60:63], 0 offen offset:1024 lds
    s_mov_b64 exec, -1
    s_add_u32 m0, s55, 0
    s_mov_b32 s64, 0
    buffer_load_dwordx4 v14, s[28:31], s64 offen lds
    s_add_u32 m0, s55, 1024
    s_mov_b32 s64, 0
    buffer_load_dwordx4 v15, s[28:31], s64 offen lds
    s_add_u32 m0, s55, 8192
    s_mov_b32 s64, 128
    buffer_load_dwordx4 v14, s[28:31], s64 offen lds
    s_add_u32 m0, s55, 9216
    s_mov_b32 s64, 128
    buffer_load_dwordx4 v15, s[28:31], s64 offen lds
    s_add_u32 m0, s55, 16384
    s_mov_b32 s64, 256
    buffer_load_dwordx4 v14, s[28:31], s64 offen lds
    s_add_u32 m0, s55, 17408
    s_mov_b32 s64, 256
    buffer_load_dwordx4 v15, s[28:31], s64 offen lds
    s_add_u32 m0, s55, 24576
    s_mov_b32 s64, 384
    buffer_load_dwordx4 v14, s[28:31], s64 offen lds
    s_add_u32 m0, s55, 25600
    s_mov_b32 s64, 384
    buffer_load_dwordx4 v15, s[28:31], s64 offen lds
    s_add_u32 m0, s55, 32768
    s_mov_b32 s64, 512
    buffer_load_dwordx4 v14, s[28:31], s64 offen lds
    s_add_u32 m0, s55, 33792
    s_mov_b32 s64, 512
    buffer_load_dwordx4 v15, s[28:31], s64 offen lds
    s_add_u32 m0, s55, 40960
    s_mov_b32 s64, 640
    buffer_load_dwordx4 v14, s[28:31], s64 offen lds
    s_add_u32 m0, s55, 41984
    s_mov_b32 s64, 640
    buffer_load_dwordx4 v15, s[28:31], s64 offen lds
    s_add_u32 m0, s55, 49152
    s_mov_b32 s64, 768
    buffer_load_dwordx4 v14, s[28:31], s64 offen lds
    s_add_u32 m0, s55, 50176
    s_mov_b32 s64, 768
    buffer_load_dwordx4 v15, s[28:31], s64 offen lds
    s_add_u32 m0, s55, 57344
    s_mov_b32 s64, 896
    buffer_load_dwordx4 v14, s[28:31], s64 offen lds
    s_add_u32 m0, s55, 58368
    s_mov_b32 s64, 896
    buffer_load_dwordx4 v15, s[28:31], s64 offen lds
    s_add_u32 m0, s55, 65536
    s_mov_b32 s64, 1024
    buffer_load_dwordx4 v14, s[28:31], s64 offen lds
    s_add_u32 m0, s55, 66560
    s_mov_b32 s64, 1024
    buffer_load_dwordx4 v15, s[28:31], s64 offen lds
    s_add_u32 m0, s55, 73728
    s_mov_b32 s64, 1152
    buffer_load_dwordx4 v14, s[28:31], s64 offen lds
    s_add_u32 m0, s55, 74752
    s_mov_b32 s64, 1152
    buffer_load_dwordx4 v15, s[28:31], s64 offen lds
    v_and_b32 v8, 1, v2
    v_lshlrev_b32 v8, 1, v8
    v_xor_b32 v8, v8, v6
    v_lshlrev_b32 v8, 4, v8
    v_add_u32 v18, v7, v8
    v_xor_b32 v19, 64, v18
    v_add_u32 v19, 10240, v19
    v_add_u32 v9, s57, v5
    v_mul_u32_u24 v9, 3456, v9
    s_lshl_b32 s58, s26, 7
    v_add3_u32 v16, v9, v8, s58
    v_xor_b32 v17, 64, v16
    v_add_u32 v17, 27648, v17
    s_cmp_ge_u32 s26, 27
    s_cbranch_scc1 Lnogate
    s_add_u32 m0, s55, 81920
    s_mov_b32 s64, 0
    buffer_load_dwordx4 v16, s[32:35], s64 offen lds
    s_add_u32 m0, s55, 82944
    s_mov_b32 s64, 0
    buffer_load_dwordx4 v17, s[32:35], s64 offen lds
    s_add_u32 m0, s55, 90112
    s_mov_b32 s64, 221184
    buffer_load_dwordx4 v16, s[32:35], s64 offen lds
    s_add_u32 m0, s55, 91136
    s_mov_b32 s64, 221184
    buffer_load_dwordx4 v17, s[32:35], s64 offen lds
    s_add_u32 m0, s55, 98304
    s_mov_b32 s64, 442368
    buffer_load_dwordx4 v16, s[32:35], s64 offen lds
    s_add_u32 m0, s55, 99328
    s_mov_b32 s64, 442368
    buffer_load_dwordx4 v17, s[32:35], s64 offen lds
    s_add_u32 m0, s55, 106496
    s_mov_b32 s64, 663552
    buffer_load_dwordx4 v16, s[32:35], s64 offen lds
    s_add_u32 m0, s55, 107520
    s_mov_b32 s64, 663552
    buffer_load_dwordx4 v17, s[32:35], s64 offen lds
    s_add_u32 m0, s55, 114688
    s_mov_b32 s64, 884736
    buffer_load_dwordx4 v16, s[32:35], s64 offen lds
    s_add_u32 m0, s55, 115712
    s_mov_b32 s64, 884736
    buffer_load_dwordx4 v17, s[32:35], s64 offen lds
    s_add_u32 m0, s55, 122880
    s_mov_b32 s64, 1105920
    buffer_load_dwordx4 v16, s[32:35], s64 offen lds
    s_add_u32 m0, s55, 123904
    s_mov_b32 s64, 1105920
    buffer_load_dwordx4 v17, s[32:35], s64 offen lds
    s_add_u32 m0, s55, 131072
    s_mov_b32 s64, 1327104
    buffer_load_dwordx4 v16, s[32:35], s64 offen lds
    s_add_u32 m0, s55, 132096
    s_mov_b32 s64, 1327104
    buffer_load_dwordx4 v17, s[32:35], s64 offen lds
    s_add_u32 m0, s55, 139264
    s_mov_b32 s64, 1548288
    buffer_load_dwordx4 v16, s[32:35], s64 offen lds
    s_add_u32 m0, s55, 140288
    s_mov_b32 s64, 1548288
    buffer_load_dwordx4 v17, s[32:35], s64 offen lds
    s_add_u32 m0, s55, 147456
    s_mov_b32 s64, 1769472
    buffer_load_dwordx4 v16, s[32:35], s64 offen lds
    s_add_u32 m0, s55, 148480
    s_mov_b32 s64, 1769472
    buffer_load_dwordx4 v17, s[32:35], s64 offen lds
    s_waitcnt vmcnt(18)
    s_branch Lgate_done
Lnogate:
    s_waitcnt vmcnt(0)
Lgate_done:
    v_mov_b32 v20, 0x3f803f80
    v_mov_b32 v21, 0x3f803f80
    v_mov_b32 v22, 0x3f803f80
    v_mov_b32 v23, 0x3f803f80
    v_lshlrev_b32 v24, 4, v2
    v_add_u32 v24, 155648, v24
    v_lshrrev_b32 v10, 1, v3
    v_xor_b32 v10, v10, v2
    v_lshlrev_b32 v10, 4, v10
    v_lshl_add_u32 v10, v3, 7, v10
    v_add_u32 v26, s55, v10
    v_xor_b32 v27, 64, v26
    v_add_u32 v28, 40960, v26
    v_add_u32 v29, 40960, v27
    ds_read_b128 a[0:3], v26 offset:0
    ds_read_b128 a[80:83], v24 offset:0
    ds_read_b128 a[4:7], v27 offset:0
    ds_read_b128 a[84:87], v24 offset:64
    ds_read_b128 a[8:11], v26 offset:8192
    ds_read_b128 a[88:91], v24 offset:128
    ds_read_b128 a[12:15], v27 offset:8192
    ds_read_b128 a[92:95], v24 offset:192
    ds_read_b128 a[16:19], v26 offset:16384
    ds_read_b128 a[96:99], v24 offset:256
    ds_read_b128 a[20:23], v27 offset:16384
    ds_read_b128 a[100:103], v24 offset:320
    ds_read_b128 a[24:27], v26 offset:24576
    ds_read_b128 a[104:107], v24 offset:384
    ds_read_b128 a[28:31], v27 offset:24576
    ds_read_b128 a[108:111], v24 offset:448
    ds_read_b128 a[32:35], v26 offset:32768
    ds_read_b128 a[112:115], v24 offset:512
    ds_read_b128 a[36:39], v27 offset:32768
    ds_read_b128 a[116:119], v24 offset:576
    ds_read_b128 a[40:43], v28 offset:0
    ds_read_b128 a[120:123], v24 offset:640
    ds_read_b128 a[44:47], v29 offset:0
    ds_read_b128 a[124:127], v24 offset:704
    ds_read_b128 a[48:51], v28 offset:8192
    ds_read_b128 a[128:131], v24 offset:768
    ds_read_b128 a[52:55], v29 offset:8192
    ds_read_b128 a[132:135], v24 offset:832
    ds_read_b128 a[56:59], v28 offset:16384
    ds_read_b128 a[136:139], v24 offset:896
    ds_read_b128 a[60:63], v29 offset:16384
    ds_read_b128 a[140:143], v24 offset:960
    ds_read_b128 a[64:67], v28 offset:24576
    ds_read_b128 a[144:147], v24 offset:1024
    ds_read_b128 a[68:71], v29 offset:24576
    ds_read_b128 a[148:151], v24 offset:1088
    ds_read_b128 a[72:75], v28 offset:32768
    ds_read_b128 a[152:155], v24 offset:1152
    ds_read_b128 a[76:79], v29 offset:32768
    ds_read_b128 a[156:159], v24 offset:1216
    s_waitcnt lgkmcnt(0)
    v_mfma_f32_16x16x32_bf16 v[30:33], v[20:23], a[0:3], 0
    v_mfma_f32_16x16x32_bf16 v[34:37], a[0:3], a[0:3], 0
    v_mfma_f32_16x16x32_bf16 v[38:41], a[80:83], a[0:3], 0
    v_mfma_f32_16x16x32_bf16 v[42:45], a[80:83], v[20:23], 0
    v_mfma_f32_16x16x32_bf16 v[30:33], v[20:23], a[4:7], v[30:33]
    v_mfma_f32_16x16x32_bf16 v[34:37], a[4:7], a[4:7], v[34:37]
    v_mfma_f32_16x16x32_bf16 v[38:41], a[84:87], a[4:7], v[38:41]
    v_mfma_f32_16x16x32_bf16 v[42:45], a[84:87], v[20:23], v[42:45]
    v_mfma_f32_16x16x32_bf16 v[30:33], v[20:23], a[8:11], v[30:33]
    v_mfma_f32_16x16x32_bf16 v[34:37], a[8:11], a[8:11], v[34:37]
    v_mfma_f32_16x16x32_bf16 v[38:41], a[88:91], a[8:11], v[38:41]
    v_mfma_f32_16x16x32_bf16 v[42:45], a[88:91], v[20:23], v[42:45]
    v_mfma_f32_16x16x32_bf16 v[30:33], v[20:23], a[12:15], v[30:33]
    v_mfma_f32_16x16x32_bf16 v[34:37], a[12:15], a[12:15], v[34:37]
    v_mfma_f32_16x16x32_bf16 v[38:41], a[92:95], a[12:15], v[38:41]
    v_mfma_f32_16x16x32_bf16 v[42:45], a[92:95], v[20:23], v[42:45]
    v_mfma_f32_16x16x32_bf16 v[30:33], v[20:23], a[16:19], v[30:33]
    v_mfma_f32_16x16x32_bf16 v[34:37], a[16:19], a[16:19], v[34:37]
    v_mfma_f32_16x16x32_bf16 v[38:41], a[96:99], a[16:19], v[38:41]
    v_mfma_f32_16x16x32_bf16 v[42:45], a[96:99], v[20:23], v[42:45]
    v_mfma_f32_16x16x32_bf16 v[30:33], v[20:23], a[20:23], v[30:33]
    v_mfma_f32_16x16x32_bf16 v[34:37], a[20:23], a[20:23], v[34:37]
    v_mfma_f32_16x16x32_bf16 v[38:41], a[100:103], a[20:23], v[38:41]
    v_mfma_f32_16x16x32_bf16 v[42:45], a[100:103], v[20:23], v[42:45]
    v_mfma_f32_16x16x32_bf16 v[30:33], v[20:23], a[24:27], v[30:33]
    v_mfma_f32_16x16x32_bf16 v[34:37], a[24:27], a[24:27], v[34:37]
    v_mfma_f32_16x16x32_bf16 v[38:41], a[104:107], a[24:27], v[38:41]
    v_mfma_f32_16x16x32_bf16 v[42:45], a[104:107], v[20:23], v[42:45]
    v_mfma_f32_16x16x32_bf16 v[30:33], v[20:23], a[28:31], v[30:33]
    v_mfma_f32_16x16x32_bf16 v[34:37], a[28:31], a[28:31], v[34:37]
    v_mfma_f32_16x16x32_bf16 v[38:41], a[108:111], a[28:31], v[38:41]
    v_mfma_f32_16x16x32_bf16 v[42:45], a[108:111], v[20:23], v[42:45]
    v_mfma_f32_16x16x32_bf16 v[30:33], v[20:23], a[32:35], v[30:33]
    v_mfma_f32_16x16x32_bf16 v[34:37], a[32:35], a[32:35], v[34:37]
    v_mfma_f32_16x16x32_bf16 v[38:41], a[112:115], a[32:35], v[38:41]
    v_mfma_f32_16x16x32_bf16 v[42:45], a[112:115], v[20:23], v[42:45]
    v_mfma_f32_16x16x32_bf16 v[30:33], v[20:23], a[36:39], v[30:33]
    v_mfma_f32_16x16x32_bf16 v[34:37], a[36:39], a[36:39], v[34:37]
    v_mfma_f32_16x16x32_bf16 v[38:41], a[116:119], a[36:39], v[38:41]
    v_mfma_f32_16x16x32_bf16 v[42:45], a[116:119], v[20:23], v[42:45]
    v_mfma_f32_16x16x32_bf16 v[30:33], v[20:23], a[40:43], v[30:33]
    v_mfma_f32_16x16x32_bf16 v[34:37], a[40:43], a[40:43], v[34:37]
    v_mfma_f32_16x16x32_bf16 v[38:41], a[120:123], a[40:43], v[38:41]
    v_mfma_f32_16x16x32_bf16 v[42:45], a[120:123], v[20:23], v[42:45]
    v_mfma_f32_16x16x32_bf16 v[30:33], v[20:23], a[44:47], v[30:33]
    v_mfma_f32_16x16x32_bf16 v[34:37], a[44:47], a[44:47], v[34:37]
    v_mfma_f32_16x16x32_bf16 v[38:41], a[124:127], a[44:47], v[38:41]
    v_mfma_f32_16x16x32_bf16 v[42:45], a[124:127], v[20:23], v[42:45]
    v_mfma_f32_16x16x32_bf16 v[30:33], v[20:23], a[48:51], v[30:33]
    v_mfma_f32_16x16x32_bf16 v[34:37], a[48:51], a[48:51], v[34:37]
    v_mfma_f32_16x16x32_bf16 v[38:41], a[128:131], a[48:51], v[38:41]
    v_mfma_f32_16x16x32_bf16 v[42:45], a[128:131], v[20:23], v[42:45]
    v_mfma_f32_16x16x32_bf16 v[30:33], v[20:23], a[52:55], v[30:33]
    v_mfma_f32_16x16x32_bf16 v[34:37], a[52:55], a[52:55], v[34:37]
    v_mfma_f32_16x16x32_bf16 v[38:41], a[132:135], a[52:55], v[38:41]
    v_mfma_f32_16x16x32_bf16 v[42:45], a[132:135], v[20:23], v[42:45]
    v_mfma_f32_16x16x32_bf16 v[30:33], v[20:23], a[56:59], v[30:33]
    v_mfma_f32_16x16x32_bf16 v[34:37], a[56:59], a[56:59], v[34:37]
    v_mfma_f32_16x16x32_bf16 v[38:41], a[136:139], a[56:59], v[38:41]
    v_mfma_f32_16x16x32_bf16 v[42:45], a[136:139], v[20:23], v[42:45]
    v_mfma_f32_16x16x32_bf16 v[30:33], v[20:23], a[60:63], v[30:33]
    v_mfma_f32_16x16x32_bf16 v[34:37], a[60:63], a[60:63], v[34:37]
    v_mfma_f32_16x16x32_bf16 v[38:41], a[140:143], a[60:63], v[38:41]
    v_mfma_f32_16x16x32_bf16 v[42:45], a[140:143], v[20:23], v[42:45]
    v_mfma_f32_16x16x32_bf16 v[30:33], v[20:23], a[64:67], v[30:33]
    v_mfma_f32_16x16x32_bf16 v[34:37], a[64:67], a[64:67], v[34:37]
    v_mfma_f32_16x16x32_bf16 v[38:41], a[144:147], a[64:67], v[38:41]
    v_mfma_f32_16x16x32_bf16 v[42:45], a[144:147], v[20:23], v[42:45]
    v_mfma_f32_16x16x32_bf16 v[30:33], v[20:23], a[68:71], v[30:33]
    v_mfma_f32_16x16x32_bf16 v[34:37], a[68:71], a[68:71], v[34:37]
    v_mfma_f32_16x16x32_bf16 v[38:41], a[148:151], a[68:71], v[38:41]
    v_mfma_f32_16x16x32_bf16 v[42:45], a[148:151], v[20:23], v[42:45]
    v_mfma_f32_16x16x32_bf16 v[30:33], v[20:23], a[72:75], v[30:33]
    v_mfma_f32_16x16x32_bf16 v[34:37], a[72:75], a[72:75], v[34:37]
    v_mfma_f32_16x16x32_bf16 v[38:41], a[152:155], a[72:75], v[38:41]
    v_mfma_f32_16x16x32_bf16 v[42:45], a[152:155], v[20:23], v[42:45]
    v_mfma_f32_16x16x32_bf16 v[30:33], v[20:23], a[76:79], v[30:33]
    v_mfma_f32_16x16x32_bf16 v[34:37], a[76:79], a[76:79], v[34:37]
    v_mfma_f32_16x16x32_bf16 v[38:41], a[156:159], a[76:79], v[38:41]
    v_mfma_f32_16x16x32_bf16 v[42:45], a[156:159], v[20:23], v[42:45]
    s_mov_b32 s66, 0xaaaaaaaa
    s_mov_b32 s67, 0xaaaaaaaa
    s_mov_b32 s68, 0xcccccccc
    s_mov_b32 s69, 0xcccccccc
    v_lshrrev_b32 v25, 2, v3
    v_lshl_add_u32 v25, v25, 4, v3
    v_lshlrev_b32 v25, 2, v25
    v_cndmask_b32 v4, v34, v35, s[66:67]
    v_cndmask_b32 v5, v36, v37, s[66:67]
    v_cndmask_b32 v4, v4, v5, s[68:69]
    ds_bpermute_b32 v4, v25, v4
    v_mul_f32 v5, 0x3acccccd, v30
    v_cvt_pk_bf16_f32 v46, v5, v5
    v_lshlrev_b32 v46, 16, v46
    v_xor_b32 v46, 0x80000000, v46
    v_mul_f32 v5, v5, v5
    s_waitcnt lgkmcnt(0)
    v_mul_f32 v4, 0x3acccccd, v4
    v_sub_f32 v4, v4, v5
    v_max_f32 v4, 0, v4
    v_cvt_pk_bf16_f32 v4, v4, v4
    v_lshlrev_b32 v4, 16, v4
    v_add_f32 v4, 0x3727c5ac, v4
    v_cvt_pk_bf16_f32 v4, v4, v4
    v_lshlrev_b32 v4, 16, v4
    v_sqrt_f32 v4, v4
    s_nop 0
    v_cvt_pk_bf16_f32 v4, v4, v4
    v_lshlrev_b32 v4, 16, v4
    v_rcp_f32 v47, v4
    v_fma_f32 v4, v46, v42, v38
    v_mul_f32 v4, v4, v47
    v_cvt_pk_bf16_f32 v4, v4, v4
    v_ashrrev_i32 v5, 31, v4
    v_or_b32 v5, 0x80000000, v5
    v_xor_b32 v4, v4, v5
    v_and_b32 v4, 0xffff0000, v4
    v_max_u32 v4, 0x10000, v4
    s_lshl_b32 s56, s3, 4
    v_add_u32 v5, s56, v3
    v_sub_u32 v6, 63, v5
    v_or_b32 v4, v4, v6
    v_lshlrev_b32 v5, 2, v5
    v_add_u32 v5, 157696, v5
    ds_write_b32 v5, v4
    s_waitcnt lgkmcnt(0)
    s_barrier
    s_cmp_lg_u32 s3, 0
    s_cbranch_scc1 Lpub_done
    v_add_u32 v5, 157696, v12
    ds_read_b32 v6, v5
    s_waitcnt lgkmcnt(0)
    v_mov_b32 v4, v6
    s_nop 1
    v_max_u32_dpp v4, v4, v4 row_ror:8 row_mask:0xf bank_mask:0xf
    s_nop 1
    v_max_u32_dpp v4, v4, v4 row_ror:4 row_mask:0xf bank_mask:0xf
    s_nop 1
    v_max_u32_dpp v4, v4, v4 row_ror:2 row_mask:0xf bank_mask:0xf
    s_nop 1
    v_max_u32_dpp v4, v4, v4 row_ror:1 row_mask:0xf bank_mask:0xf
    s_nop 0
    v_readlane_b32 s65, v4, 0
    v_readlane_b32 s56, v4, 16
    v_readlane_b32 s57, v4, 32
    v_readlane_b32 s58, v4, 48
    s_max_u32 s65, s65, s56
    s_max_u32 s57, s57, s58
    s_max_u32 s65, s65, s57
    v_cmp_eq_u32 vcc, s65, v6
    s_nop 1
    v_cndmask_b32 v4, v6, 0, vcc
    s_nop 1
    v_max_u32_dpp v4, v4, v4 row_ror:8 row_mask:0xf bank_mask:0xf
    s_nop 1
    v_max_u32_dpp v4, v4, v4 row_ror:4 row_mask:0xf bank_mask:0xf
    s_nop 1
    v_max_u32_dpp v4, v4, v4 row_ror:2 row_mask:0xf bank_mask:0xf
    s_nop 1
    v_max_u32_dpp v4, v4, v4 row_ror:1 row_mask:0xf bank_mask:0xf
    s_nop 0
    v_readlane_b32 s70, v4, 0
    v_readlane_b32 s56, v4, 16
    v_readlane_b32 s57, v4, 32
    v_readlane_b32 s58, v4, 48
    s_max_u32 s70, s70, s56
    s_max_u32 s57, s57, s58
    s_max_u32 s70, s70, s57
    s_and_b32 s56, s65, 0xffff0000
    s_lshr_b32 s57, s70, 16
    s_or_b32 s56, s56, s57
    s_and_b32 s57, s65, 63
    s_and_b32 s58, s70, 63
    s_lshl_b32 s58, s58, 6
    s_or_b32 s57, s57, s58
    s_xor_b32 s57, s57, 0x8fff
    s_lshl_b32 s58, s26, 2
    s_lshl_b32 s59, s26, 1
    v_mov_b32 v4, s56
    v_mov_b32 v5, s57
    v_mov_b32 v6, s58
    v_mov_b32 v7, s59
    s_mov_b64 exec, 1
    buffer_store_dword v4, v6, s[48:51], 0 offen sc1
    buffer_store_short v5, v7, s[48:51], 0 offen offset:128 sc1
    s_mov_b64 exec, -1
Lpub_done:
    s_cmp_ge_u32 s26, 27
    s_cbranch_scc1 Lend
    s_add_u32 m0, s55, 73728
    s_mov_b32 s64, 1990656
    buffer_load_dwordx4 v16, s[32:35], s64 offen lds
    s_add_u32 m0, s55, 74752
    s_mov_b32 s64, 1990656
    buffer_load_dwordx4 v17, s[32:35], s64 offen lds
    s_add_u32 m0, s55, 0
    s_mov_b32 s64, 0
    buffer_load_dwordx4 v16, s[36:39], s64 offen lds
    s_add_u32 m0, s55, 1024
    s_mov_b32 s64, 0
    buffer_load_dwordx4 v17, s[36:39], s64 offen lds
    s_add_u32 m0, s55, 8192
    s_mov_b32 s64, 221184
    buffer_load_dwordx4 v16, s[36:39], s64 offen lds
    s_add_u32 m0, s55, 9216
    s_mov_b32 s64, 221184
    buffer_load_dwordx4 v17, s[36:39], s64 offen lds
    s_add_u32 m0, s55, 16384
    s_mov_b32 s64, 442368
    buffer_load_dwordx4 v16, s[36:39], s64 offen lds
    s_add_u32 m0, s55, 17408
    s_mov_b32 s64, 442368
    buffer_load_dwordx4 v17, s[36:39], s64 offen lds
    s_add_u32 m0, s55, 24576
    s_mov_b32 s64, 663552
    buffer_load_dwordx4 v16, s[36:39], s64 offen lds
    s_add_u32 m0, s55, 25600
    s_mov_b32 s64, 663552
    buffer_load_dwordx4 v17, s[36:39], s64 offen lds
    s_add_u32 m0, s55, 32768
    s_mov_b32 s64, 884736
    buffer_load_dwordx4 v16, s[36:39], s64 offen lds
    s_add_u32 m0, s55, 33792
    s_mov_b32 s64, 884736
    buffer_load_dwordx4 v17, s[36:39], s64 offen lds
    s_add_u32 m0, s55, 40960
    s_mov_b32 s64, 1105920
    buffer_load_dwordx4 v16, s[36:39], s64 offen lds
    s_add_u32 m0, s55, 41984
    s_mov_b32 s64, 1105920
    buffer_load_dwordx4 v17, s[36:39], s64 offen lds
    s_add_u32 m0, s55, 49152
    s_mov_b32 s64, 1327104
    buffer_load_dwordx4 v16, s[36:39], s64 offen lds
    s_add_u32 m0, s55, 50176
    s_mov_b32 s64, 1327104
    buffer_load_dwordx4 v17, s[36:39], s64 offen lds
    s_add_u32 m0, s55, 57344
    s_mov_b32 s64, 1548288
    buffer_load_dwordx4 v16, s[36:39], s64 offen lds
    s_add_u32 m0, s55, 58368
    s_mov_b32 s64, 1548288
    buffer_load_dwordx4 v17, s[36:39], s64 offen lds
    s_add_u32 m0, s55, 65536
    s_mov_b32 s64, 1769472
    buffer_load_dwordx4 v16, s[36:39], s64 offen lds
    s_add_u32 m0, s55, 66560
    s_mov_b32 s64, 1769472
    buffer_load_dwordx4 v17, s[36:39], s64 offen lds
    v_bfe_u32 v7, v1, 2, 2
    v_and_b32 v8, 3, v1
    v_and_b32 v9, 1, v2
    v_lshlrev_b32 v9, 1, v9
    v_lshrrev_b32 v10, 1, v7
    v_or_b32 v9, v9, v10
    v_lshl_add_u32 v48, v2, 3, v7
    v_lshlrev_b32 v48, 7, v48
    v_lshl_add_u32 v48, v9, 5, v48
    v_lshl_add_u32 v48, v8, 3, v48
    s_lshl_b32 s56, s3, 5
    v_xor_b32 v50, s56, v48
    v_add_u32 v51, 57344, v50
    v_add_u32 v52, 114688, v50
    s_waitcnt vmcnt(18)
    s_barrier
    ds_read_b64_tr_b16 a[80:81], v51 offset:24576
    ds_read_b64_tr_b16 a[82:83], v51 offset:25088
    ds_read_b64_tr_b16 a[84:85], v51 offset:28672
    ds_read_b64_tr_b16 a[86:87], v51 offset:29184
    ds_read_b64_tr_b16 a[88:89], v51 offset:32768
    ds_read_b64_tr_b16 a[90:91], v51 offset:33280
    ds_read_b64_tr_b16 a[92:93], v51 offset:36864
    ds_read_b64_tr_b16 a[94:95], v51 offset:37376
    ds_read_b64_tr_b16 a[96:97], v51 offset:40960
    ds_read_b64_tr_b16 a[98:99], v51 offset:41472
    ds_read_b64_tr_b16 a[100:101], v51 offset:45056
    ds_read_b64_tr_b16 a[102:103], v51 offset:45568
    ds_read_b64_tr_b16 a[104:105], v51 offset:49152
    ds_read_b64_tr_b16 a[106:107], v51 offset:49664
    ds_read_b64_tr_b16 a[108:109], v51 offset:53248
    ds_read_b64_tr_b16 a[110:111], v51 offset:53760
    ds_read_b64_tr_b16 a[112:113], v52 offset:0
    ds_read_b64_tr_b16 a[114:115], v52 offset:512
    ds_read_b64_tr_b16 a[116:117], v52 offset:4096
    ds_read_b64_tr_b16 a[118:119], v52 offset:4608
    ds_read_b64_tr_b16 a[120:121], v52 offset:8192
    ds_read_b64_tr_b16 a[122:123], v52 offset:8704
    ds_read_b64_tr_b16 a[124:125], v52 offset:12288
    ds_read_b64_tr_b16 a[126:127], v52 offset:12800
    ds_read_b64_tr_b16 a[128:129], v52 offset:16384
    ds_read_b64_tr_b16 a[130:131], v52 offset:16896
    ds_read_b64_tr_b16 a[132:133], v52 offset:20480
    ds_read_b64_tr_b16 a[134:135], v52 offset:20992
    ds_read_b64_tr_b16 a[136:137], v52 offset:24576
    ds_read_b64_tr_b16 a[138:139], v52 offset:25088
    ds_read_b64_tr_b16 a[140:141], v52 offset:28672
    ds_read_b64_tr_b16 a[142:143], v52 offset:29184
    ds_read_b64_tr_b16 a[144:145], v52 offset:32768
    ds_read_b64_tr_b16 a[146:147], v52 offset:33280
    ds_read_b64_tr_b16 a[148:149], v52 offset:36864
    ds_read_b64_tr_b16 a[150:151], v52 offset:37376
    ds_read_b64_tr_b16 a[152:153], v51 offset:16384
    ds_read_b64_tr_b16 a[154:155], v51 offset:16896
    ds_read_b64_tr_b16 a[156:157], v51 offset:20480
    ds_read_b64_tr_b16 a[158:159], v51 offset:20992
    s_waitcnt lgkmcnt(0)
    s_barrier
    s_add_u32 m0, s55, 73728
    s_mov_b32 s64, 1990656
    buffer_load_dwordx4 v16, s[36:39], s64 offen lds
    s_add_u32 m0, s55, 74752
    s_mov_b32 s64, 1990656
    buffer_load_dwordx4 v17, s[36:39], s64 offen lds
    s_cmp_lg_u32 s3, 0
    s_cbranch_scc1 Lsel_done
Lpt_3:
    s_sub_u32 s54, s54, 1
    s_cbranch_scc1 Lend
    buffer_load_dword v4, v12, s[48:51], 0 offen sc1
    v_lshrrev_b32 v5, 1, v12
    v_and_b32 v5, 0x3c, v5
    v_add_u32 v5, 128, v5
    s_waitcnt vmcnt(0)
    ds_bpermute_b32 v5, v5, v4
    v_readlane_b32 s53, v4, 48
    v_and_b32 v6, 4, v12
    v_lshlrev_b32 v6, 2, v6
    s_waitcnt lgkmcnt(0)
    v_bfe_u32 v5, v5, v6, 16
    v_cmp_ne_u32 vcc, 0, v4
    v_cmp_ne_u32 s[56:57], 0, v5
    s_nop 0
    s_and_b32 s56, s56, vcc_lo
    s_cmp_lg_u32 s53, 0
    s_cselect_b32 s56, s56, 0
    s_cmp_eq_u32 s56, -1
    s_cbranch_scc1 Lptd_4
    s_sleep 4
    s_branch Lpt_3
Lptd_4:
    v_lshlrev_b32 v6, 4, v12
    v_and_b32 v7, 63, v5
    v_add_u32 v7, v7, v6
    v_sub_u32 v7, 2047, v7
    v_bfe_u32 v5, v5, 6, 6
    v_add_u32 v5, v5, v6
    v_sub_u32 v5, 2047, v5
    v_and_b32 v6, 0xffff0000, v4
    v_or_b32 v7, v7, v6
    v_lshl_or_b32 v5, v4, 16, v5
    v_cmp_gt_u32 vcc, 128, v12
    s_nop 1
    v_cndmask_b32 v7, 0, v7, vcc
    v_cndmask_b32 v5, 0, v5, vcc
    v_mov_b32 v4, v7
    s_nop 1
    v_max_u32_dpp v4, v4, v4 row_ror:8 row_mask:0xf bank_mask:0xf
    s_nop 1
    v_max_u32_dpp v4, v4, v4 row_ror:4 row_mask:0xf bank_mask:0xf
    s_nop 1
    v_max_u32_dpp v4, v4, v4 row_ror:2 row_mask:0xf bank_mask:0xf
    s_nop 1
    v_max_u32_dpp v4, v4, v4 row_ror:1 row_mask:0xf bank_mask:0xf
    s_nop 0
    v_readlane_b32 s65, v4, 0
    v_readlane_b32 s56, v4, 16
    v_readlane_b32 s57, v4, 32
    v_readlane_b32 s58, v4, 48
    s_max_u32 s65, s65, s56
    s_max_u32 s57, s57, s58
    s_max_u32 s65, s65, s57
    v_cmp_eq_u32 vcc, s65, v7
    s_nop 1
    v_cndmask_b32 v4, v7, v5, vcc
    s_nop 1
    v_max_u32_dpp v4, v4, v4 row_ror:8 row_mask:0xf bank_mask:0xf
    s_nop 1
    v_max_u32_dpp v4, v4, v4 row_ror:4 row_mask:0xf bank_mask:0xf
    s_nop 1
    v_max_u32_dpp v4, v4, v4 row_ror:2 row_mask:0xf bank_mask:0xf
    s_nop 1
    v_max_u32_dpp v4, v4, v4 row_ror:1 row_mask:0xf bank_mask:0xf
    s_nop 0
    v_readlane_b32 s70, v4, 0
    v_readlane_b32 s56, v4, 16
    v_readlane_b32 s57, v4, 32
    v_readlane_b32 s58, v4, 48
    s_max_u32 s70, s70, s56
    s_max_u32 s57, s57, s58
    s_max_u32 s70, s70, s57
    s_and_b32 s56, s65, 0x7ff
    s_sub_u32 s56, 2047, s56
    s_mul_i32 s56, s56, 1280
    s_and_b32 s57, s70, 0x7ff
    s_sub_u32 s57, 2047, s57
    s_mul_i32 s57, s57, 1280
    v_mov_b32 v4, s56
    v_mov_b32 v5, s57
    v_cmp_gt_u32 vcc, 32, v1
    s_nop 1
    v_cndmask_b32 v4, v5, v4, vcc
    v_and_b32 v5, 31, v1
    v_lshl_add_u32 v4, v5, 3, v4
    buffer_load_dwordx2 v[54:55], v4, s[28:31], 0 offen offset:0
    buffer_load_dwordx2 v[56:57], v4, s[28:31], 0 offen offset:256
    buffer_load_dwordx2 v[58:59], v4, s[28:31], 0 offen offset:512
    buffer_load_dwordx2 v[60:61], v4, s[28:31], 0 offen offset:768
    buffer_load_dwordx2 v[62:63], v4, s[28:31], 0 offen offset:1024
    s_waitcnt vmcnt(0)
    v_lshlrev_b32 v64, 16, v54
    v_and_b32 v65, 0xffff0000, v54
    v_lshlrev_b32 v66, 16, v55
    v_and_b32 v67, 0xffff0000, v55
    v_lshlrev_b32 v68, 16, v56
    v_and_b32 v69, 0xffff0000, v56
    v_lshlrev_b32 v70, 16, v57
    v_and_b32 v71, 0xffff0000, v57
    v_lshlrev_b32 v72, 16, v58
    v_and_b32 v73, 0xffff0000, v58
    v_lshlrev_b32 v74, 16, v59
    v_and_b32 v75, 0xffff0000, v59
    v_lshlrev_b32 v76, 16, v60
    v_and_b32 v77, 0xffff0000, v60
    v_lshlrev_b32 v78, 16, v61
    v_and_b32 v79, 0xffff0000, v61
    v_lshlrev_b32 v80, 16, v62
    v_and_b32 v81, 0xffff0000, v62
    v_lshlrev_b32 v82, 16, v63
    v_and_b32 v83, 0xffff0000, v63
    v_add_f32 v6, v64, v65
    v_add_f32 v6, v6, v66
    v_add_f32 v6, v6, v67
    v_add_f32 v6, v6, v68
    v_add_f32 v6, v6, v69
    v_add_f32 v6, v6, v70
    v_add_f32 v6, v6, v71
    v_add_f32 v6, v6, v72
    v_add_f32 v6, v6, v73
    v_add_f32 v6, v6, v74
    v_add_f32 v6, v6, v75
    v_add_f32 v6, v6, v76
    v_add_f32 v6, v6, v77
    v_add_f32 v6, v6, v78
    v_add_f32 v6, v6, v79
    v_add_f32 v6, v6, v80
    v_add_f32 v6, v6, v81
    v_add_f32 v6, v6, v82
    v_add_f32 v6, v6, v83
    s_nop 1
    v_add_f32_dpp v6, v6, v6 row_ror:8 row_mask:0xf bank_mask:0xf
    s_nop 1
    v_add_f32_dpp v6, v6, v6 row_ror:4 row_mask:0xf bank_mask:0xf
    s_nop 1
    v_add_f32_dpp v6, v6, v6 row_ror:2 row_mask:0xf bank_mask:0xf
    s_nop 1
    v_add_f32_dpp v6, v6, v6 row_ror:1 row_mask:0xf bank_mask:0xf
    v_mov_b32 v7, v6
    s_nop 1
    v_permlane16_swap_b32 v6, v7
    v_add_f32 v6, v6, v7
    v_mul_f32 v6, 0x3acccccd, v6
    v_mov_b32 v8, 0
    v_sub_f32 v9, v64, v6
    v_fmac_f32 v8, v9, v9
    v_sub_f32 v9, v65, v6
    v_fmac_f32 v8, v9, v9
    v_sub_f32 v9, v66, v6
    v_fmac_f32 v8, v9, v9
    v_sub_f32 v9, v67, v6
    v_fmac_f32 v8, v9, v9
    v_sub_f32 v9, v68, v6
    v_fmac_f32 v8, v9, v9
    v_sub_f32 v9, v69, v6
    v_fmac_f32 v8, v9, v9
    v_sub_f32 v9, v70, v6
    v_fmac_f32 v8, v9, v9
    v_sub_f32 v9, v71, v6
    v_fmac_f32 v8, v9, v9
    v_sub_f32 v9, v72, v6
    v_fmac_f32 v8, v9, v9
    v_sub_f32 v9, v73, v6
    v_fmac_f32 v8, v9, v9
    v_sub_f32 v9, v74, v6
    v_fmac_f32 v8, v9, v9
    v_sub_f32 v9, v75, v6
    v_fmac_f32 v8, v9, v9
    v_sub_f32 v9, v76, v6
    v_fmac_f32 v8, v9, v9
    v_sub_f32 v9, v77, v6
    v_fmac_f32 v8, v9, v9
    v_sub_f32 v9, v78, v6
    v_fmac_f32 v8, v9, v9
    v_sub_f32 v9, v79, v6
    v_fmac_f32 v8, v9, v9
    v_sub_f32 v9, v80, v6
    v_fmac_f32 v8, v9, v9
    v_sub_f32 v9, v81, v6
    v_fmac_f32 v8, v9, v9
    v_sub_f32 v9, v82, v6
    v_fmac_f32 v8, v9, v9
    v_sub_f32 v9, v83, v6
    v_fmac_f32 v8, v9, v9
    s_nop 1
    v_add_f32_dpp v8, v8, v8 row_ror:8 row_mask:0xf bank_mask:0xf
    s_nop 1
    v_add_f32_dpp v8, v8, v8 row_ror:4 row_mask:0xf bank_mask:0xf
    s_nop 1
    v_add_f32_dpp v8, v8, v8 row_ror:2 row_mask:0xf bank_mask:0xf
    s_nop 1
    v_add_f32_dpp v8, v8, v8 row_ror:1 row_mask:0xf bank_mask:0xf
    v_mov_b32 v7, v8
    s_nop 1
    v_permlane16_swap_b32 v8, v7
    v_add_f32 v8, v8, v7
    v_mul_f32 v8, 0x3acccccd, v8
    v_cvt_pk_bf16_f32 v8, v8, v8
    v_lshlrev_b32 v8, 16, v8
    v_add_f32 v8, 0x3727c5ac, v8
    v_cvt_pk_bf16_f32 v8, v8, v8
    v_lshlrev_b32 v8, 16, v8
    v_sqrt_f32 v8, v8
    s_nop 0
    v_cvt_pk_bf16_f32 v8, v8, v8
    v_lshlrev_b32 v8, 16, v8
    v_rcp_f32 v8, v8
    v_cvt_pk_bf16_f32 v6, v6, v6
    v_lshlrev_b32 v6, 16, v6
    v_sub_f32 v64, v64, v6
    v_sub_f32 v65, v65, v6
    v_sub_f32 v66, v66, v6
    v_sub_f32 v67, v67, v6
    v_sub_f32 v68, v68, v6
    v_sub_f32 v69, v69, v6
    v_sub_f32 v70, v70, v6
    v_sub_f32 v71, v71, v6
    v_sub_f32 v72, v72, v6
    v_sub_f32 v73, v73, v6
    v_sub_f32 v74, v74, v6
    v_sub_f32 v75, v75, v6
    v_sub_f32 v76, v76, v6
    v_sub_f32 v77, v77, v6
    v_sub_f32 v78, v78, v6
    v_sub_f32 v79, v79, v6
    v_sub_f32 v80, v80, v6
    v_sub_f32 v81, v81, v6
    v_sub_f32 v82, v82, v6
    v_sub_f32 v83, v83, v6
    v_cvt_pk_bf16_f32 v65, v64, v65
    v_cvt_pk_bf16_f32 v67, v66, v67
    v_cvt_pk_bf16_f32 v69, v68, v69
    v_cvt_pk_bf16_f32 v71, v70, v71
    v_cvt_pk_bf16_f32 v73, v72, v73
    v_cvt_pk_bf16_f32 v75, v74, v75
    v_cvt_pk_bf16_f32 v77, v76, v77
    v_cvt_pk_bf16_f32 v79, v78, v79
    v_cvt_pk_bf16_f32 v81, v80, v81
    v_cvt_pk_bf16_f32 v83, v82, v83
    v_lshlrev_b32 v64, 16, v65
    v_and_b32 v65, 0xffff0000, v65
    v_lshlrev_b32 v66, 16, v67
    v_and_b32 v67, 0xffff0000, v67
    v_lshlrev_b32 v68, 16, v69
    v_and_b32 v69, 0xffff0000, v69
    v_lshlrev_b32 v70, 16, v71
    v_and_b32 v71, 0xffff0000, v71
    v_lshlrev_b32 v72, 16, v73
    v_and_b32 v73, 0xffff0000, v73
    v_lshlrev_b32 v74, 16, v75
    v_and_b32 v75, 0xffff0000, v75
    v_lshlrev_b32 v76, 16, v77
    v_and_b32 v77, 0xffff0000, v77
    v_lshlrev_b32 v78, 16, v79
    v_and_b32 v79, 0xffff0000, v79
    v_lshlrev_b32 v80, 16, v81
    v_and_b32 v81, 0xffff0000, v81
    v_lshlrev_b32 v82, 16, v83
    v_and_b32 v83, 0xffff0000, v83
    v_mul_f32 v64, v64, v8
    v_mul_f32 v65, v65, v8
    v_mul_f32 v66, v66, v8
    v_mul_f32 v67, v67, v8
    v_mul_f32 v68, v68, v8
    v_mul_f32 v69, v69, v8
    v_mul_f32 v70, v70, v8
    v_mul_f32 v71, v71, v8
    v_mul_f32 v72, v72, v8
    v_mul_f32 v73, v73, v8
    v_mul_f32 v74, v74, v8
    v_mul_f32 v75, v75, v8
    v_mul_f32 v76, v76, v8
    v_mul_f32 v77, v77, v8
    v_mul_f32 v78, v78, v8
    v_mul_f32 v79, v79, v8
    v_mul_f32 v80, v80, v8
    v_mul_f32 v81, v81, v8
    v_mul_f32 v82, v82, v8
    v_mul_f32 v83, v83, v8
    v_cvt_pk_bf16_f32 v54, v64, v65
    v_cvt_pk_bf16_f32 v55, v66, v67
    v_cvt_pk_bf16_f32 v56, v68, v69
    v_cvt_pk_bf16_f32 v57, v70, v71
    v_cvt_pk_bf16_f32 v58, v72, v73
    v_cvt_pk_bf16_f32 v59, v74, v75
    v_cvt_pk_bf16_f32 v60, v76, v77
    v_cvt_pk_bf16_f32 v61, v78, v79
    v_cvt_pk_bf16_f32 v62, v80, v81
    v_cvt_pk_bf16_f32 v63, v82, v83
    v_lshrrev_b32 v4, 5, v1
    v_mul_u32_u24 v4, 1344, v4
    v_lshl_add_u32 v4, v5, 3, v4
    v_add_u32 v4, 158208, v4
    ds_write_b64 v4, v[54:55] offset:0
    ds_write_b64 v4, v[56:57] offset:256
    ds_write_b64 v4, v[58:59] offset:512
    ds_write_b64 v4, v[60:61] offset:768
    ds_write_b64 v4, v[62:63] offset:1024
    v_mov_b32 v4, 157696
    v_mov_b32 v5, s53
    ds_write_b32 v4, v5
    s_nop 0
Lsel_done:
    s_add_u32 m0, s55, 81920
    s_mov_b32 s64, 0
    buffer_load_dwordx4 v18, s[40:43], s64 offen lds
    s_add_u32 m0, s55, 82944
    s_mov_b32 s64, 0
    buffer_load_dwordx4 v19, s[40:43], s64 offen lds
    s_add_u32 m0, s55, 90112
    s_mov_b32 s64, 128
    buffer_load_dwordx4 v18, s[40:43], s64 offen lds
    s_add_u32 m0, s55, 91136
    s_mov_b32 s64, 128
    buffer_load_dwordx4 v19, s[40:43], s64 offen lds
    s_add_u32 m0, s55, 98304
    s_mov_b32 s64, 256
    buffer_load_dwordx4 v18, s[40:43], s64 offen lds
    s_add_u32 m0, s55, 99328
    s_mov_b32 s64, 256
    buffer_load_dwordx4 v19, s[40:43], s64 offen lds
    s_add_u32 m0, s55, 106496
    s_mov_b32 s64, 384
    buffer_load_dwordx4 v18, s[40:43], s64 offen lds
    s_add_u32 m0, s55, 107520
    s_mov_b32 s64, 384
    buffer_load_dwordx4 v19, s[40:43], s64 offen lds
    s_add_u32 m0, s55, 114688
    s_mov_b32 s64, 512
    buffer_load_dwordx4 v18, s[40:43], s64 offen lds
    s_add_u32 m0, s55, 115712
    s_mov_b32 s64, 512
    buffer_load_dwordx4 v19, s[40:43], s64 offen lds
    s_add_u32 m0, s55, 122880
    s_mov_b32 s64, 640
    buffer_load_dwordx4 v18, s[40:43], s64 offen lds
    s_add_u32 m0, s55, 123904
    s_mov_b32 s64, 640
    buffer_load_dwordx4 v19, s[40:43], s64 offen lds
    s_add_u32 m0, s55, 131072
    s_mov_b32 s64, 768
    buffer_load_dwordx4 v18, s[40:43], s64 offen lds
    s_add_u32 m0, s55, 132096
    s_mov_b32 s64, 768
    buffer_load_dwordx4 v19, s[40:43], s64 offen lds
    s_add_u32 m0, s55, 139264
    s_mov_b32 s64, 896
    buffer_load_dwordx4 v18, s[40:43], s64 offen lds
    s_add_u32 m0, s55, 140288
    s_mov_b32 s64, 896
    buffer_load_dwordx4 v19, s[40:43], s64 offen lds
    s_add_u32 m0, s55, 147456
    s_mov_b32 s64, 1024
    buffer_load_dwordx4 v18, s[40:43], s64 offen lds
    s_add_u32 m0, s55, 148480
    s_mov_b32 s64, 1024
    buffer_load_dwordx4 v19, s[40:43], s64 offen lds
    s_waitcnt vmcnt(18) lgkmcnt(0)
    s_barrier
    ds_read_b64_tr_b16 a[160:161], v50 offset:0
    ds_read_b64_tr_b16 a[162:163], v50 offset:512
    ds_read_b64_tr_b16 a[164:165], v50 offset:4096
    ds_read_b64_tr_b16 a[166:167], v50 offset:4608
    ds_read_b64_tr_b16 a[168:169], v50 offset:8192
    ds_read_b64_tr_b16 a[170:171], v50 offset:8704
    ds_read_b64_tr_b16 a[172:173], v50 offset:12288
    ds_read_b64_tr_b16 a[174:175], v50 offset:12800
    ds_read_b64_tr_b16 a[176:177], v50 offset:16384
    ds_read_b64_tr_b16 a[178:179], v50 offset:16896
    ds_read_b64_tr_b16 a[180:181], v50 offset:20480
    ds_read_b64_tr_b16 a[182:183], v50 offset:20992
    ds_read_b64_tr_b16 a[184:185], v50 offset:24576
    ds_read_b64_tr_b16 a[186:187], v50 offset:25088
    ds_read_b64_tr_b16 a[188:189], v50 offset:28672
    ds_read_b64_tr_b16 a[190:191], v50 offset:29184
    ds_read_b64_tr_b16 a[192:193], v50 offset:32768
    ds_read_b64_tr_b16 a[194:195], v50 offset:33280
    ds_read_b64_tr_b16 a[196:197], v50 offset:36864
    ds_read_b64_tr_b16 a[198:199], v50 offset:37376
    ds_read_b64_tr_b16 a[200:201], v50 offset:40960
    ds_read_b64_tr_b16 a[202:203], v50 offset:41472
    ds_read_b64_tr_b16 a[204:205], v50 offset:45056
    ds_read_b64_tr_b16 a[206:207], v50 offset:45568
    ds_read_b64_tr_b16 a[208:209], v50 offset:49152
    ds_read_b64_tr_b16 a[210:211], v50 offset:49664
    ds_read_b64_tr_b16 a[212:213], v50 offset:53248
    ds_read_b64_tr_b16 a[214:215], v50 offset:53760
    ds_read_b64_tr_b16 a[216:217], v51 offset:0
    ds_read_b64_tr_b16 a[218:219], v51 offset:512
    ds_read_b64_tr_b16 a[220:221], v51 offset:4096
    ds_read_b64_tr_b16 a[222:223], v51 offset:4608
    ds_read_b64_tr_b16 a[224:225], v51 offset:8192
    ds_read_b64_tr_b16 a[226:227], v51 offset:8704
    ds_read_b64_tr_b16 a[228:229], v51 offset:12288
    ds_read_b64_tr_b16 a[230:231], v51 offset:12800
    ds_read_b64_tr_b16 a[232:233], v51 offset:16384
    ds_read_b64_tr_b16 a[234:235], v51 offset:16896
    ds_read_b64_tr_b16 a[236:237], v51 offset:20480
    ds_read_b64_tr_b16 a[238:239], v51 offset:20992
    v_and_b32 v4, 1, v1
    v_mul_u32_u24 v5, 1344, v4
    v_lshl_add_u32 v5, v2, 4, v5
    v_add_u32 v5, 158208, v5
    ds_read_b128 a[0:3], v5 offset:0
    ds_read_b128 a[4:7], v5 offset:64
    ds_read_b128 a[8:11], v5 offset:128
    ds_read_b128 a[12:15], v5 offset:192
    ds_read_b128 a[16:19], v5 offset:256
    ds_read_b128 a[20:23], v5 offset:320
    ds_read_b128 a[24:27], v5 offset:384
    ds_read_b128 a[28:31], v5 offset:448
    ds_read_b128 a[32:35], v5 offset:512
    ds_read_b128 a[36:39], v5 offset:576
    ds_read_b128 a[40:43], v5 offset:640
    ds_read_b128 a[44:47], v5 offset:704
    ds_read_b128 a[48:51], v5 offset:768
    ds_read_b128 a[52:55], v5 offset:832
    ds_read_b128 a[56:59], v5 offset:896
    ds_read_b128 a[60:63], v5 offset:960
    ds_read_b128 a[64:67], v5 offset:1024
    ds_read_b128 a[68:71], v5 offset:1088
    ds_read_b128 a[72:75], v5 offset:1152
    ds_read_b128 a[76:79], v5 offset:1216
    v_mov_b32 v6, 157696
    ds_read_b32 v6, v6
    s_waitcnt lgkmcnt(0)
    s_barrier
    v_readfirstlane_b32 s53, v6
    s_add_u32 m0, s55, 0
    s_mov_b32 s64, 1152
    buffer_load_dwordx4 v18, s[40:43], s64 offen lds
    s_add_u32 m0, s55, 1024
    s_mov_b32 s64, 1152
    buffer_load_dwordx4 v19, s[40:43], s64 offen lds
    v_mfma_f32_16x16x32_bf16 v[30:33], a[80:83], a[0:3], 0
    v_mfma_f32_16x16x32_bf16 v[34:37], a[160:163], a[0:3], 0
    v_mfma_f32_16x16x32_bf16 v[30:33], a[84:87], a[4:7], v[30:33]
    v_mfma_f32_16x16x32_bf16 v[34:37], a[164:167], a[4:7], v[34:37]
    v_mfma_f32_16x16x32_bf16 v[30:33], a[88:91], a[8:11], v[30:33]
    v_mfma_f32_16x16x32_bf16 v[34:37], a[168:171], a[8:11], v[34:37]
    v_mfma_f32_16x16x32_bf16 v[30:33], a[92:95], a[12:15], v[30:33]
    v_mfma_f32_16x16x32_bf16 v[34:37], a[172:175], a[12:15], v[34:37]
    v_mfma_f32_16x16x32_bf16 v[30:33], a[96:99], a[16:19], v[30:33]
    v_mfma_f32_16x16x32_bf16 v[34:37], a[176:179], a[16:19], v[34:37]
    v_mfma_f32_16x16x32_bf16 v[30:33], a[100:103], a[20:23], v[30:33]
    v_mfma_f32_16x16x32_bf16 v[34:37], a[180:183], a[20:23], v[34:37]
    v_mfma_f32_16x16x32_bf16 v[30:33], a[104:107], a[24:27], v[30:33]
    v_mfma_f32_16x16x32_bf16 v[34:37], a[184:187], a[24:27], v[34:37]
    v_mfma_f32_16x16x32_bf16 v[30:33], a[108:111], a[28:31], v[30:33]
    v_mfma_f32_16x16x32_bf16 v[34:37], a[188:191], a[28:31], v[34:37]
    v_mfma_f32_16x16x32_bf16 v[30:33], a[112:115], a[32:35], v[30:33]
    v_mfma_f32_16x16x32_bf16 v[34:37], a[192:195], a[32:35], v[34:37]
    v_mfma_f32_16x16x32_bf16 v[30:33], a[116:119], a[36:39], v[30:33]
    v_mfma_f32_16x16x32_bf16 v[34:37], a[196:199], a[36:39], v[34:37]
    v_mfma_f32_16x16x32_bf16 v[30:33], a[120:123], a[40:43], v[30:33]
    v_mfma_f32_16x16x32_bf16 v[34:37], a[200:203], a[40:43], v[34:37]
    v_mfma_f32_16x16x32_bf16 v[30:33], a[124:127], a[44:47], v[30:33]
    v_mfma_f32_16x16x32_bf16 v[34:37], a[204:207], a[44:47], v[34:37]
    v_mfma_f32_16x16x32_bf16 v[30:33], a[128:131], a[48:51], v[30:33]
    v_mfma_f32_16x16x32_bf16 v[34:37], a[208:211], a[48:51], v[34:37]
    v_mfma_f32_16x16x32_bf16 v[30:33], a[132:135], a[52:55], v[30:33]
    v_mfma_f32_16x16x32_bf16 v[34:37], a[212:215], a[52:55], v[34:37]
    v_mfma_f32_16x16x32_bf16 v[30:33], a[136:139], a[56:59], v[30:33]
    v_mfma_f32_16x16x32_bf16 v[34:37], a[216:219], a[56:59], v[34:37]
    v_mfma_f32_16x16x32_bf16 v[30:33], a[140:143], a[60:63], v[30:33]
    v_mfma_f32_16x16x32_bf16 v[34:37], a[220:223], a[60:63], v[34:37]
    v_mfma_f32_16x16x32_bf16 v[30:33], a[144:147], a[64:67], v[30:33]
    v_mfma_f32_16x16x32_bf16 v[34:37], a[224:227], a[64:67], v[34:37]
    v_mfma_f32_16x16x32_bf16 v[30:33], a[148:151], a[68:71], v[30:33]
    v_mfma_f32_16x16x32_bf16 v[34:37], a[228:231], a[68:71], v[34:37]
    v_mfma_f32_16x16x32_bf16 v[30:33], a[152:155], a[72:75], v[30:33]
    v_mfma_f32_16x16x32_bf16 v[34:37], a[232:235], a[72:75], v[34:37]
    v_mfma_f32_16x16x32_bf16 v[30:33], a[156:159], a[76:79], v[30:33]
    v_mfma_f32_16x16x32_bf16 v[34:37], a[236:239], a[76:79], v[34:37]
    s_nop 6
    v_cvt_pk_bf16_f32 v31, v30, v31
    v_cvt_pk_bf16_f32 v33, v32, v33
    v_lshlrev_b32 v30, 16, v31
    v_and_b32 v31, 0xffff0000, v31
    v_lshlrev_b32 v32, 16, v33
    v_and_b32 v33, 0xffff0000, v33
    v_cvt_pk_bf16_f32 v35, v34, v35
    v_cvt_pk_bf16_f32 v37, v36, v37
    v_lshlrev_b32 v34, 16, v35
    v_and_b32 v35, 0xffff0000, v35
    v_lshlrev_b32 v36, 16, v37
    v_and_b32 v37, 0xffff0000, v37
    v_mul_f32 v38, 0xbfb8aa3b, v30
    v_mul_f32 v39, 0xbfb8aa3b, v31
    v_mul_f32 v40, 0xbfb8aa3b, v32
    v_mul_f32 v41, 0xbfb8aa3b, v33
    v_exp_f32 v38, v38
    v_exp_f32 v39, v39
    v_exp_f32 v40, v40
    v_exp_f32 v41, v41
    v_add_f32 v38, 1.0, v38
    v_add_f32 v39, 1.0, v39
    v_add_f32 v40, 1.0, v40
    v_add_f32 v41, 1.0, v41
    v_rcp_f32 v38, v38
    v_rcp_f32 v39, v39
    v_rcp_f32 v40, v40
    v_rcp_f32 v41, v41
    v_pk_mul_f32 v[38:39], v[38:39], v[30:31]
    v_pk_mul_f32 v[40:41], v[40:41], v[32:33]
    v_cvt_pk_bf16_f32 v39, v38, v39
    v_cvt_pk_bf16_f32 v41, v40, v41
    v_lshlrev_b32 v38, 16, v39
    v_and_b32 v39, 0xffff0000, v39
    v_lshlrev_b32 v40, 16, v41
    v_and_b32 v41, 0xffff0000, v41
    v_pk_mul_f32 v[38:39], v[38:39], v[34:35]
    v_pk_mul_f32 v[40:41], v[40:41], v[36:37]
    v_cvt_pk_bf16_f32 v6, v38, v39
    v_cvt_pk_bf16_f32 v7, v40, v41
    s_lshl_b32 s56, s3, 5
    s_add_u32 s56, s56, 161792
    v_lshlrev_b32 v8, 7, v4
    v_lshl_add_u32 v9, v2, 3, v8
    v_add_u32 v9, s56, v9
    ds_write_b64 v9, v[6:7]
    s_waitcnt vmcnt(0) lgkmcnt(0)
    s_barrier
    v_lshl_add_u32 v9, v2, 4, v8
    v_add_u32 v9, 161792, v9
    ds_read_b128 v[84:87], v9 offset:0
    ds_read_b128 v[88:91], v9 offset:64
    v_cmp_eq_u32 s[72:73], 1, v2
    v_cmp_eq_u32 s[74:75], 2, v2
    v_cmp_eq_u32 s[76:77], 3, v2
    s_add_u32 s56, s3, 0
    s_add_u32 s57, s56, 10
    s_cmp_eq_u32 s56, 9
    s_cselect_b32 s57, 0, s57
    s_lshl_b32 s57, s57, 13
    v_xor_b32 v112, 0, v48
    v_add_u32 v112, s57, v112
    v_xor_b32 v113, 32, v48
    v_add_u32 v113, s57, v113
    v_xor_b32 v114, 64, v48
    v_add_u32 v114, s57, v114
    v_xor_b32 v115, 96, v48
    v_add_u32 v115, s57, v115
    ds_read_b64_tr_b16 a[0:1], v112 offset:0
    ds_read_b64_tr_b16 a[2:3], v112 offset:512
    ds_read_b64_tr_b16 a[4:5], v113 offset:0
    ds_read_b64_tr_b16 a[6:7], v113 offset:512
    ds_read_b64_tr_b16 a[8:9], v114 offset:0
    ds_read_b64_tr_b16 a[10:11], v114 offset:512
    ds_read_b64_tr_b16 a[12:13], v115 offset:0
    ds_read_b64_tr_b16 a[14:15], v115 offset:512
    ds_read_b64_tr_b16 a[16:17], v112 offset:4096
    ds_read_b64_tr_b16 a[18:19], v112 offset:4608
    ds_read_b64_tr_b16 a[20:21], v113 offset:4096
    ds_read_b64_tr_b16 a[22:23], v113 offset:4608
    ds_read_b64_tr_b16 a[24:25], v114 offset:4096
    ds_read_b64_tr_b16 a[26:27], v114 offset:4608
    ds_read_b64_tr_b16 a[28:29], v115 offset:4096
    ds_read_b64_tr_b16 a[30:31], v115 offset:4608
    s_waitcnt lgkmcnt(0)
    v_mfma_f32_16x16x32_bf16 v[92:95], v[84:87], a[0:3], 0
    v_mfma_f32_16x16x32_bf16 v[96:99], v[84:87], a[4:7], 0
    v_mfma_f32_16x16x32_bf16 v[100:103], v[84:87], a[8:11], 0
    v_mfma_f32_16x16x32_bf16 v[104:107], v[84:87], a[12:15], 0
    v_mfma_f32_16x16x32_bf16 v[92:95], v[88:91], a[16:19], v[92:95]
    v_mfma_f32_16x16x32_bf16 v[96:99], v[88:91], a[20:23], v[96:99]
    v_mfma_f32_16x16x32_bf16 v[100:103], v[88:91], a[24:27], v[100:103]
    v_mfma_f32_16x16x32_bf16 v[104:107], v[88:91], a[28:31], v[104:107]
    s_mul_i32 s57, s26, 10
    s_add_u32 s57, s57, s56
    s_lshl_b32 s57, s57, 10
    s_add_u32 s57, s57, 7405568
    v_mov_b32 v109, s53
    v_mov_b32 v111, s53
    v_cndmask_b32 v108, v92, v96, s[72:73]
    v_cndmask_b32 v108, v108, v100, s[74:75]
    v_cndmask_b32 v108, v108, v104, s[76:77]
    v_cndmask_b32 v110, v93, v97, s[72:73]
    v_cndmask_b32 v110, v110, v101, s[74:75]
    v_cndmask_b32 v110, v110, v105, s[76:77]
    buffer_store_dwordx4 v[108:111], v13, s[44:47], s57 offen sc1
    s_add_u32 s56, s3, 4
    s_add_u32 s57, s56, 10
    s_cmp_eq_u32 s56, 9
    s_cselect_b32 s57, 0, s57
    s_lshl_b32 s57, s57, 13
    v_xor_b32 v112, 0, v48
    v_add_u32 v112, s57, v112
    v_xor_b32 v113, 32, v48
    v_add_u32 v113, s57, v113
    v_xor_b32 v114, 64, v48
    v_add_u32 v114, s57, v114
    v_xor_b32 v115, 96, v48
    v_add_u32 v115, s57, v115
    ds_read_b64_tr_b16 a[0:1], v112 offset:0
    ds_read_b64_tr_b16 a[2:3], v112 offset:512
    ds_read_b64_tr_b16 a[4:5], v113 offset:0
    ds_read_b64_tr_b16 a[6:7], v113 offset:512
    ds_read_b64_tr_b16 a[8:9], v114 offset:0
    ds_read_b64_tr_b16 a[10:11], v114 offset:512
    ds_read_b64_tr_b16 a[12:13], v115 offset:0
    ds_read_b64_tr_b16 a[14:15], v115 offset:512
    ds_read_b64_tr_b16 a[16:17], v112 offset:4096
    ds_read_b64_tr_b16 a[18:19], v112 offset:4608
    ds_read_b64_tr_b16 a[20:21], v113 offset:4096
    ds_read_b64_tr_b16 a[22:23], v113 offset:4608
    ds_read_b64_tr_b16 a[24:25], v114 offset:4096
    ds_read_b64_tr_b16 a[26:27], v114 offset:4608
    ds_read_b64_tr_b16 a[28:29], v115 offset:4096
    ds_read_b64_tr_b16 a[30:31], v115 offset:4608
    s_waitcnt lgkmcnt(0)
    v_mfma_f32_16x16x32_bf16 v[92:95], v[84:87], a[0:3], 0
    v_mfma_f32_16x16x32_bf16 v[96:99], v[84:87], a[4:7], 0
    v_mfma_f32_16x16x32_bf16 v[100:103], v[84:87], a[8:11], 0
    v_mfma_f32_16x16x32_bf16 v[104:107], v[84:87], a[12:15], 0
    v_mfma_f32_16x16x32_bf16 v[92:95], v[88:91], a[16:19], v[92:95]
    v_mfma_f32_16x16x32_bf16 v[96:99], v[88:91], a[20:23], v[96:99]
    v_mfma_f32_16x16x32_bf16 v[100:103], v[88:91], a[24:27], v[100:103]
    v_mfma_f32_16x16x32_bf16 v[104:107], v[88:91], a[28:31], v[104:107]
    s_mul_i32 s57, s26, 10
    s_add_u32 s57, s57, s56
    s_lshl_b32 s57, s57, 10
    s_add_u32 s57, s57, 7405568
    v_mov_b32 v109, s53
    v_mov_b32 v111, s53
    v_cndmask_b32 v108, v92, v96, s[72:73]
    v_cndmask_b32 v108, v108, v100, s[74:75]
    v_cndmask_b32 v108, v108, v104, s[76:77]
    v_cndmask_b32 v110, v93, v97, s[72:73]
    v_cndmask_b32 v110, v110, v101, s[74:75]
    v_cndmask_b32 v110, v110, v105, s[76:77]
    buffer_store_dwordx4 v[108:111], v13, s[44:47], s57 offen sc1
    s_add_u32 s56, s3, 8
    s_cmp_ge_u32 s56, 10
    s_cbranch_scc1 Laux_end
    s_add_u32 s57, s56, 10
    s_cmp_eq_u32 s56, 9
    s_cselect_b32 s57, 0, s57
    s_lshl_b32 s57, s57, 13
    v_xor_b32 v112, 0, v48
    v_add_u32 v112, s57, v112
    v_xor_b32 v113, 32, v48
    v_add_u32 v113, s57, v113
    v_xor_b32 v114, 64, v48
    v_add_u32 v114, s57, v114
    v_xor_b32 v115, 96, v48
    v_add_u32 v115, s57, v115
    ds_read_b64_tr_b16 a[0:1], v112 offset:0
    ds_read_b64_tr_b16 a[2:3], v112 offset:512
    ds_read_b64_tr_b16 a[4:5], v113 offset:0
    ds_read_b64_tr_b16 a[6:7], v113 offset:512
    ds_read_b64_tr_b16 a[8:9], v114 offset:0
    ds_read_b64_tr_b16 a[10:11], v114 offset:512
    ds_read_b64_tr_b16 a[12:13], v115 offset:0
    ds_read_b64_tr_b16 a[14:15], v115 offset:512
    ds_read_b64_tr_b16 a[16:17], v112 offset:4096
    ds_read_b64_tr_b16 a[18:19], v112 offset:4608
    ds_read_b64_tr_b16 a[20:21], v113 offset:4096
    ds_read_b64_tr_b16 a[22:23], v113 offset:4608
    ds_read_b64_tr_b16 a[24:25], v114 offset:4096
    ds_read_b64_tr_b16 a[26:27], v114 offset:4608
    ds_read_b64_tr_b16 a[28:29], v115 offset:4096
    ds_read_b64_tr_b16 a[30:31], v115 offset:4608
    s_waitcnt lgkmcnt(0)
    v_mfma_f32_16x16x32_bf16 v[92:95], v[84:87], a[0:3], 0
    v_mfma_f32_16x16x32_bf16 v[96:99], v[84:87], a[4:7], 0
    v_mfma_f32_16x16x32_bf16 v[100:103], v[84:87], a[8:11], 0
    v_mfma_f32_16x16x32_bf16 v[104:107], v[84:87], a[12:15], 0
    v_mfma_f32_16x16x32_bf16 v[92:95], v[88:91], a[16:19], v[92:95]
    v_mfma_f32_16x16x32_bf16 v[96:99], v[88:91], a[20:23], v[96:99]
    v_mfma_f32_16x16x32_bf16 v[100:103], v[88:91], a[24:27], v[100:103]
    v_mfma_f32_16x16x32_bf16 v[104:107], v[88:91], a[28:31], v[104:107]
    s_mul_i32 s57, s26, 10
    s_add_u32 s57, s57, s56
    s_lshl_b32 s57, s57, 10
    s_add_u32 s57, s57, 7405568
    v_mov_b32 v109, s53
    v_mov_b32 v111, s53
    v_cndmask_b32 v108, v92, v96, s[72:73]
    v_cndmask_b32 v108, v108, v100, s[74:75]
    v_cndmask_b32 v108, v108, v104, s[76:77]
    v_cndmask_b32 v110, v93, v97, s[72:73]
    v_cndmask_b32 v110, v110, v101, s[74:75]
    v_cndmask_b32 v110, v110, v105, s[76:77]
    buffer_store_dwordx4 v[108:111], v13, s[44:47], s57 offen sc1
    s_nop 1
Laux_end:
Lend:
    s_endpgm
.section .rodata,"a"
.p2align 6
.amdhsa_kernel recurrent_scan__sliding_local_dilated__moe_arch_mod__prompt_kernel
  .amdhsa_next_free_vgpr 512
  .amdhsa_next_free_sgpr 102
  .amdhsa_accum_offset 256
  .amdhsa_group_segment_fixed_size 0
  .amdhsa_kernarg_size 88
  .amdhsa_user_sgpr_count 2
  .amdhsa_user_sgpr_kernarg_segment_ptr 1
  .amdhsa_system_sgpr_workgroup_id_x 1
  .amdhsa_float_denorm_mode_32 3
.end_amdhsa_kernel
```

```asm
; @launch grid=(256,1,1) block=(512,1,1) lds=163840
.amdgcn_target "amdgcn-amd-amdhsa--gfx950"
.text
.globl recurrent_scan__sliding_local_dilated__moe_arch_mod__prompt_kernel
.p2align 8
.type recurrent_scan__sliding_local_dilated__moe_arch_mod__prompt_kernel,@function
recurrent_scan__sliding_local_dilated__moe_arch_mod__prompt_kernel:
    s_load_dwordx16 s[4:19], s[0:1], 0
    s_load_dwordx4 s[20:23], s[0:1], 64
    s_load_dwordx2 s[24:25], s[0:1], 80
    v_lshrrev_b32 v4, 6, v0
    v_and_b32 v1, 63, v0
    s_cmp_ge_u32 s2, 256
    s_cbranch_scc1 Lend
    v_readfirstlane_b32 s3, v4
    s_getpc_b64 s[40:41]
    s_nop 3
Lpc:
    s_and_b32 s42, s2, 0xf8
    v_add_u32 v5, s42, v4
    v_and_b32 v6, 1, v0
    v_lshl_add_u32 v5, v5, 1, v6
    v_lshlrev_b32 v5, 7, v5
    v_min_u32 v5, Lend-Lpc, v5
    v_mov_b32 v7, s41
    v_add_co_u32 v6, vcc, s40, v5
    s_nop 1
    v_addc_co_u32 v7, vcc, 0, v7, vcc
    global_load_dword v0, v[6:7], off
    v_lshrrev_b32 v2, 4, v1
    v_and_b32 v3, 15, v1
    v_lshlrev_b32 v12, 2, v1
    v_lshlrev_b32 v13, 4, v1
    s_mov_b32 s39, 200000
    s_and_b32 s40, s2, 7
    s_lshr_b32 s41, s2, 3
    s_and_b32 s42, s40, 1
    s_lshr_b32 s40, s40, 1
    s_add_u32 s43, s42, 4
    s_and_b32 s26, s3, 3
    s_lshr_b32 s27, s3, 2
    s_cmp_lt_u32 s41, s43
    s_cbranch_scc1 Laux
    s_lshr_b32 s37, s40, 1
    s_and_b32 s40, s40, 1
    s_mul_i32 s40, s40, 55
    s_mul_i32 s42, s42, 28
    s_add_u32 s40, s40, s42
    s_add_u32 s40, s40, s41
    s_sub_u32 s40, s40, s43
    s_mul_i32 s36, s40, 13108
    s_lshr_b32 s36, s36, 16
    s_mul_i32 s41, s36, 5
    s_sub_u32 s40, s40, s41
    s_mul_i32 s37, s37, 5
    s_add_u32 s37, s37, s40
    s_cmp_lg_u32 s3, 0
    s_cbranch_scc1 Lcomp
Lloader:
    s_setprio 3
    v_lshrrev_b32 v5, 3, v1
    v_and_b32 v6, 7, v1
    v_and_b32 v8, 1, v2
    v_lshlrev_b32 v8, 1, v8
    v_xor_b32 v8, v8, v6
    s_lshl_b32 s43, s37, 7
    v_lshl_add_u32 v50, v8, 4, s43
    v_mov_b32 v7, 3840
    v_mad_u32_u24 v28, v5, v7, v50
    v_xor_b32 v29, 64, v28
    v_add_u32 v29, 29696, v29
    v_add_u32 v30, 59392, v28
    v_add_u32 v31, 59392, v29
    v_add_u32 v32, 122880, v28
    v_add_u32 v33, 122880, v29
    v_add_u32 v34, 182272, v28
    v_add_u32 v35, 182272, v29
    s_mul_i32 s42, s36, 96
    s_sub_u32 s42, s42, 16
    v_add_u32 v7, s42, v5
    v_xor_b32 v9, v6, v2
    v_lshlrev_b32 v9, 4, v9
    v_xor_b32 v10, 64, v9
    v_mov_b32 v11, 2047
    v_mov_b32 v8, 1280
    v_add_u32 v36, 0, v7
    v_med3_i32 v36, v36, 0, v11
    v_mad_u32_u24 v36, v36, v8, v9
    v_add_u32 v36, 4096, v36
    v_add_u32 v37, 8, v7
    v_med3_i32 v37, v37, 0, v11
    v_mad_u32_u24 v37, v37, v8, v10
    v_add_u32 v37, 3072, v37
    v_add_u32 v38, 16, v7
    v_med3_i32 v38, v38, 0, v11
    v_mad_u32_u24 v38, v38, v8, v9
    v_add_u32 v38, 2048, v38
    v_add_u32 v39, 24, v7
    v_med3_i32 v39, v39, 0, v11
    v_mad_u32_u24 v39, v39, v8, v10
    v_add_u32 v39, 1024, v39
    v_add_u32 v40, 32, v7
    v_med3_i32 v40, v40, 0, v11
    v_mad_u32_u24 v40, v40, v8, v9
    v_add_u32 v40, 4096, v40
    v_add_u32 v41, 40, v7
    v_med3_i32 v41, v41, 0, v11
    v_mad_u32_u24 v41, v41, v8, v10
    v_add_u32 v41, 3072, v41
    v_add_u32 v42, 48, v7
    v_med3_i32 v42, v42, 0, v11
    v_mad_u32_u24 v42, v42, v8, v9
    v_add_u32 v42, 2048, v42
    v_add_u32 v43, 56, v7
    v_med3_i32 v43, v43, 0, v11
    v_mad_u32_u24 v43, v43, v8, v10
    v_add_u32 v43, 1024, v43
    v_add_u32 v44, 64, v7
    v_med3_i32 v44, v44, 0, v11
    v_mad_u32_u24 v44, v44, v8, v9
    v_add_u32 v44, 4096, v44
    v_add_u32 v45, 72, v7
    v_med3_i32 v45, v45, 0, v11
    v_mad_u32_u24 v45, v45, v8, v10
    v_add_u32 v45, 3072, v45
    v_add_u32 v46, 80, v7
    v_med3_i32 v46, v46, 0, v11
    v_mad_u32_u24 v46, v46, v8, v9
    v_add_u32 v46, 2048, v46
    v_add_u32 v47, 88, v7
    v_med3_i32 v47, v47, 0, v11
    v_mad_u32_u24 v47, v47, v8, v10
    v_add_u32 v47, 1024, v47
    v_add_u32 v48, 96, v7
    v_med3_i32 v48, v48, 0, v11
    v_mad_u32_u24 v48, v48, v8, v9
    v_add_u32 v48, 4096, v48
    v_add_u32 v49, 104, v7
    v_med3_i32 v49, v49, 0, v11
    v_mad_u32_u24 v49, v49, v8, v10
    v_add_u32 v49, 3072, v49
    s_and_b32 s78, s36, 3
    s_lshl_b32 s78, s78, 2
    s_lshr_b32 s78, 0x9731, s78
    s_and_b32 s78, s78, 15
    s_mov_b32 s47, s37
    s_waitcnt lgkmcnt(0)
    s_sub_u32 s48, s4, 4096
    s_subb_u32 s49, s5, 0
    s_mov_b32 s50, 2625536
    s_mov_b32 s51, 0x20000
    s_mov_b64 s[52:53], s[6:7]
    s_mov_b32 s54, 2457600
    s_mov_b32 s55, 0x20000
    s_add_u32 s56, s6, 1280
    s_addc_u32 s57, s7, 0
    s_mov_b32 s58, 2456320
    s_mov_b32 s59, 0x20000
    s_add_u32 s60, s6, 2560
    s_addc_u32 s61, s7, 0
    s_mov_b32 s62, 2455040
    s_mov_b32 s63, 0x20000
    s_mul_i32 s68, s47, 245760
    s_lshl_b32 s46, s47, 7
    s_mov_b32 m0, 24576
    s_nop 0
    buffer_load_dwordx4 v36, s[48:51], s46 offen lds
    buffer_load_dwordx4 v37, s[48:51], s46 offen offset:1024 lds
    buffer_load_dwordx4 v38, s[48:51], s46 offen offset:2048 lds
    buffer_load_dwordx4 v39, s[48:51], s46 offen offset:3072 lds
    s_mov_b32 m0, 0
    s_nop 0
    buffer_load_dwordx4 v28, s[52:55], s68 offen lds
    buffer_load_dwordx4 v29, s[52:55], s68 offen offset:1024 lds
    buffer_load_dwordx4 v30, s[52:55], s68 offen offset:2048 lds
    buffer_load_dwordx4 v31, s[52:55], s68 offen offset:3072 lds
    s_mov_b32 m0, 28672
    s_nop 0
    buffer_load_dwordx4 v40, s[48:51], s46 offen lds
    buffer_load_dwordx4 v41, s[48:51], s46 offen offset:1024 lds
    buffer_load_dwordx4 v42, s[48:51], s46 offen offset:2048 lds
    buffer_load_dwordx4 v43, s[48:51], s46 offen offset:3072 lds
    s_mov_b32 m0, 8192
    s_nop 0
    buffer_load_dwordx4 v28, s[56:59], s68 offen lds
    buffer_load_dwordx4 v29, s[56:59], s68 offen offset:1024 lds
    buffer_load_dwordx4 v30, s[56:59], s68 offen offset:2048 lds
    buffer_load_dwordx4 v31, s[56:59], s68 offen offset:3072 lds
    s_mov_b32 m0, 32768
    s_nop 0
    buffer_load_dwordx4 v44, s[48:51], s46 offen lds
    buffer_load_dwordx4 v45, s[48:51], s46 offen offset:1024 lds
    buffer_load_dwordx4 v46, s[48:51], s46 offen offset:2048 lds
    buffer_load_dwordx4 v47, s[48:51], s46 offen offset:3072 lds
    s_mov_b32 m0, 16384
    s_nop 0
    buffer_load_dwordx4 v28, s[60:63], s68 offen lds
    buffer_load_dwordx4 v29, s[60:63], s68 offen offset:1024 lds
    buffer_load_dwordx4 v30, s[60:63], s68 offen offset:2048 lds
    buffer_load_dwordx4 v31, s[60:63], s68 offen offset:3072 lds
    s_mov_b32 m0, 36864
    s_nop 0
    buffer_load_dwordx4 v48, s[48:51], s46 offen lds
    buffer_load_dwordx4 v49, s[48:51], s46 offen offset:1024 lds
    s_mov_b32 m0, 4096
    s_nop 0
    buffer_load_dwordx4 v32, s[52:55], s68 offen lds
    buffer_load_dwordx4 v33, s[52:55], s68 offen offset:1024 lds
    buffer_load_dwordx4 v34, s[52:55], s68 offen offset:2048 lds
    buffer_load_dwordx4 v35, s[52:55], s68 offen offset:3072 lds
    s_mov_b32 m0, 12288
    s_nop 0
    buffer_load_dwordx4 v32, s[56:59], s68 offen lds
    buffer_load_dwordx4 v33, s[56:59], s68 offen offset:1024 lds
    buffer_load_dwordx4 v34, s[56:59], s68 offen offset:2048 lds
    buffer_load_dwordx4 v35, s[56:59], s68 offen offset:3072 lds
    s_mov_b32 m0, 20480
    s_nop 0
    buffer_load_dwordx4 v32, s[60:63], s68 offen lds
    buffer_load_dwordx4 v33, s[60:63], s68 offen offset:1024 lds
    buffer_load_dwordx4 v34, s[60:63], s68 offen offset:2048 lds
    buffer_load_dwordx4 v35, s[60:63], s68 offen offset:3072 lds
    s_add_u32 s47, s47, s78
    s_sub_u32 s42, s47, 10
    s_cmp_ge_u32 s47, 10
    s_cselect_b32 s47, s42, s47
    s_mov_b64 s[28:29], s[24:25]
    s_mov_b32 s30, 268435456
    s_mov_b32 s31, 0x20000
    s_mov_b64 s[32:33], s[22:23]
    s_mov_b32 s34, 256
    s_mov_b32 s35, 0x20000
    s_load_dword s38, s[28:29], 0
    s_sub_u32 s64, s8, 65536
    s_subb_u32 s65, s9, 0
    s_mov_b32 s66, 884736
    s_mov_b32 s67, 0x20000
    s_mul_i32 s69, s47, 245760
    s_lshl_b32 s46, s47, 7
    s_mov_b32 m0, 63616
    s_nop 0
    buffer_load_dwordx4 v36, s[48:51], s46 offen lds
    buffer_load_dwordx4 v37, s[48:51], s46 offen offset:1024 lds
    buffer_load_dwordx4 v38, s[48:51], s46 offen offset:2048 lds
    buffer_load_dwordx4 v39, s[48:51], s46 offen offset:3072 lds
    s_mov_b32 m0, 39040
    s_nop 0
    buffer_load_dwordx4 v28, s[52:55], s69 offen lds
    buffer_load_dwordx4 v29, s[52:55], s69 offen offset:1024 lds
    buffer_load_dwordx4 v30, s[52:55], s69 offen offset:2048 lds
    buffer_load_dwordx4 v31, s[52:55], s69 offen offset:3072 lds
    s_mov_b32 m0, 67712
    s_nop 0
    buffer_load_dwordx4 v40, s[48:51], s46 offen lds
    buffer_load_dwordx4 v41, s[48:51], s46 offen offset:1024 lds
    buffer_load_dwordx4 v42, s[48:51], s46 offen offset:2048 lds
    buffer_load_dwordx4 v43, s[48:51], s46 offen offset:3072 lds
    s_mov_b32 m0, 47232
    s_nop 0
    buffer_load_dwordx4 v28, s[56:59], s69 offen lds
    buffer_load_dwordx4 v29, s[56:59], s69 offen offset:1024 lds
    buffer_load_dwordx4 v30, s[56:59], s69 offen offset:2048 lds
    buffer_load_dwordx4 v31, s[56:59], s69 offen offset:3072 lds
    s_mov_b32 m0, 71808
    s_nop 0
    buffer_load_dwordx4 v44, s[48:51], s46 offen lds
    buffer_load_dwordx4 v45, s[48:51], s46 offen offset:1024 lds
    buffer_load_dwordx4 v46, s[48:51], s46 offen offset:2048 lds
    buffer_load_dwordx4 v47, s[48:51], s46 offen offset:3072 lds
    s_mov_b32 m0, 55424
    s_nop 0
    buffer_load_dwordx4 v28, s[60:63], s69 offen lds
    buffer_load_dwordx4 v29, s[60:63], s69 offen offset:1024 lds
    buffer_load_dwordx4 v30, s[60:63], s69 offen offset:2048 lds
    buffer_load_dwordx4 v31, s[60:63], s69 offen offset:3072 lds
    s_mov_b32 m0, 75904
    s_nop 0
    buffer_load_dwordx4 v48, s[48:51], s46 offen lds
    s_waitcnt vmcnt(55)
    buffer_load_dwordx4 v49, s[48:51], s46 offen offset:1024 lds
    s_mov_b32 m0, 43136
    s_nop 0
    buffer_load_dwordx4 v32, s[52:55], s69 offen lds
    buffer_load_dwordx4 v33, s[52:55], s69 offen offset:1024 lds
    buffer_load_dwordx4 v34, s[52:55], s69 offen offset:2048 lds
    buffer_load_dwordx4 v35, s[52:55], s69 offen offset:3072 lds
    s_mov_b32 m0, 51328
    s_nop 0
    buffer_load_dwordx4 v32, s[56:59], s69 offen lds
    buffer_load_dwordx4 v33, s[56:59], s69 offen offset:1024 lds
    buffer_load_dwordx4 v34, s[56:59], s69 offen offset:2048 lds
    s_waitcnt vmcnt(55)
    buffer_load_dwordx4 v35, s[56:59], s69 offen offset:3072 lds
    s_mov_b32 m0, 59520
    s_nop 0
    buffer_load_dwordx4 v32, s[60:63], s69 offen lds
    buffer_load_dwordx4 v33, s[60:63], s69 offen offset:1024 lds
    buffer_load_dwordx4 v34, s[60:63], s69 offen offset:2048 lds
    buffer_load_dwordx4 v35, s[60:63], s69 offen offset:3072 lds
    s_add_u32 s47, s47, s78
    s_sub_u32 s42, s47, 10
    s_cmp_ge_u32 s47, 10
    s_cselect_b32 s47, s42, s47
    s_waitcnt vmcnt(38) lgkmcnt(0)
    s_barrier
    s_add_u32 s38, s38, 0x9e3779b8
    s_or_b32 s38, s38, 1
    s_mul_i32 s70, s47, 245760
    s_lshl_b32 s46, s47, 7
    s_mov_b32 m0, 102656
    s_nop 0
    buffer_load_dwordx4 v36, s[48:51], s46 offen lds
    buffer_load_dwordx4 v37, s[48:51], s46 offen offset:1024 lds
    buffer_load_dwordx4 v38, s[48:51], s46 offen offset:2048 lds
    buffer_load_dwordx4 v39, s[48:51], s46 offen offset:3072 lds
    s_mov_b32 m0, 78080
    s_nop 0
    buffer_load_dwordx4 v28, s[52:55], s70 offen lds
    buffer_load_dwordx4 v29, s[52:55], s70 offen offset:1024 lds
    buffer_load_dwordx4 v30, s[52:55], s70 offen offset:2048 lds
    buffer_load_dwordx4 v31, s[52:55], s70 offen offset:3072 lds
    s_mov_b32 m0, 106752
    s_nop 0
    buffer_load_dwordx4 v40, s[48:51], s46 offen lds
    buffer_load_dwordx4 v41, s[48:51], s46 offen offset:1024 lds
    buffer_load_dwordx4 v42, s[48:51], s46 offen offset:2048 lds
    buffer_load_dwordx4 v43, s[48:51], s46 offen offset:3072 lds
    s_mov_b32 m0, 86272
    s_nop 0
    buffer_load_dwordx4 v28, s[56:59], s70 offen lds
    buffer_load_dwordx4 v29, s[56:59], s70 offen offset:1024 lds
    buffer_load_dwordx4 v30, s[56:59], s70 offen offset:2048 lds
    buffer_load_dwordx4 v31, s[56:59], s70 offen offset:3072 lds
    s_mov_b32 m0, 110848
    s_nop 0
    buffer_load_dwordx4 v44, s[48:51], s46 offen lds
    buffer_load_dwordx4 v45, s[48:51], s46 offen offset:1024 lds
    buffer_load_dwordx4 v46, s[48:51], s46 offen offset:2048 lds
    buffer_load_dwordx4 v47, s[48:51], s46 offen offset:3072 lds
    s_mov_b32 m0, 94464
    s_nop 0
    buffer_load_dwordx4 v28, s[60:63], s70 offen lds
    buffer_load_dwordx4 v29, s[60:63], s70 offen offset:1024 lds
    buffer_load_dwordx4 v30, s[60:63], s70 offen offset:2048 lds
    buffer_load_dwordx4 v31, s[60:63], s70 offen offset:3072 lds
    s_mov_b32 m0, 114944
    s_nop 0
    buffer_load_dwordx4 v48, s[48:51], s46 offen lds
    s_waitcnt vmcnt(55)
    buffer_load_dwordx4 v49, s[48:51], s46 offen offset:1024 lds
    s_mov_b32 m0, 82176
    s_nop 0
    buffer_load_dwordx4 v32, s[52:55], s70 offen lds
    buffer_load_dwordx4 v33, s[52:55], s70 offen offset:1024 lds
    buffer_load_dwordx4 v34, s[52:55], s70 offen offset:2048 lds
    buffer_load_dwordx4 v35, s[52:55], s70 offen offset:3072 lds
    s_mov_b32 m0, 90368
    s_nop 0
    buffer_load_dwordx4 v32, s[56:59], s70 offen lds
    buffer_load_dwordx4 v33, s[56:59], s70 offen offset:1024 lds
    buffer_load_dwordx4 v34, s[56:59], s70 offen offset:2048 lds
    s_waitcnt vmcnt(55)
    buffer_load_dwordx4 v35, s[56:59], s70 offen offset:3072 lds
    s_mov_b32 m0, 98560
    s_nop 0
    buffer_load_dwordx4 v32, s[60:63], s70 offen lds
    buffer_load_dwordx4 v33, s[60:63], s70 offen offset:1024 lds
    buffer_load_dwordx4 v34, s[60:63], s70 offen offset:2048 lds
    buffer_load_dwordx4 v35, s[60:63], s70 offen offset:3072 lds
    s_add_u32 s47, s47, s78
    s_sub_u32 s42, s47, 10
    s_cmp_ge_u32 s47, 10
    s_cselect_b32 s47, s42, s47
    s_waitcnt vmcnt(38) lgkmcnt(0)
    s_barrier
    s_mul_i32 s71, s47, 245760
    s_lshl_b32 s46, s47, 7
    s_mov_b32 m0, 141696
    s_nop 0
    buffer_load_dwordx4 v36, s[48:51], s46 offen lds
    buffer_load_dwordx4 v37, s[48:51], s46 offen offset:1024 lds
    buffer_load_dwordx4 v38, s[48:51], s46 offen offset:2048 lds
    buffer_load_dwordx4 v39, s[48:51], s46 offen offset:3072 lds
    s_mov_b32 m0, 117120
    s_nop 0
    buffer_load_dwordx4 v28, s[52:55], s71 offen lds
    buffer_load_dwordx4 v29, s[52:55], s71 offen offset:1024 lds
    buffer_load_dwordx4 v30, s[52:55], s71 offen offset:2048 lds
    buffer_load_dwordx4 v31, s[52:55], s71 offen offset:3072 lds
    s_mov_b32 m0, 145792
    s_nop 0
    buffer_load_dwordx4 v40, s[48:51], s46 offen lds
    buffer_load_dwordx4 v41, s[48:51], s46 offen offset:1024 lds
    buffer_load_dwordx4 v42, s[48:51], s46 offen offset:2048 lds
    buffer_load_dwordx4 v43, s[48:51], s46 offen offset:3072 lds
    s_mov_b32 m0, 125312
    s_nop 0
    buffer_load_dwordx4 v28, s[56:59], s71 offen lds
    buffer_load_dwordx4 v29, s[56:59], s71 offen offset:1024 lds
    buffer_load_dwordx4 v30, s[56:59], s71 offen offset:2048 lds
    buffer_load_dwordx4 v31, s[56:59], s71 offen offset:3072 lds
    s_mov_b32 m0, 149888
    s_nop 0
    buffer_load_dwordx4 v44, s[48:51], s46 offen lds
    buffer_load_dwordx4 v45, s[48:51], s46 offen offset:1024 lds
    buffer_load_dwordx4 v46, s[48:51], s46 offen offset:2048 lds
    buffer_load_dwordx4 v47, s[48:51], s46 offen offset:3072 lds
    s_mov_b32 m0, 133504
    s_nop 0
    buffer_load_dwordx4 v28, s[60:63], s71 offen lds
    buffer_load_dwordx4 v29, s[60:63], s71 offen offset:1024 lds
    buffer_load_dwordx4 v30, s[60:63], s71 offen offset:2048 lds
    buffer_load_dwordx4 v31, s[60:63], s71 offen offset:3072 lds
    s_mov_b32 m0, 153984
    s_nop 0
    buffer_load_dwordx4 v48, s[48:51], s46 offen lds
    s_waitcnt vmcnt(55)
    buffer_load_dwordx4 v49, s[48:51], s46 offen offset:1024 lds
    s_mov_b32 m0, 121216
    s_nop 0
    buffer_load_dwordx4 v32, s[52:55], s71 offen lds
    buffer_load_dwordx4 v33, s[52:55], s71 offen offset:1024 lds
    buffer_load_dwordx4 v34, s[52:55], s71 offen offset:2048 lds
    buffer_load_dwordx4 v35, s[52:55], s71 offen offset:3072 lds
    s_mov_b32 m0, 129408
    s_nop 0
    buffer_load_dwordx4 v32, s[56:59], s71 offen lds
    buffer_load_dwordx4 v33, s[56:59], s71 offen offset:1024 lds
    buffer_load_dwordx4 v34, s[56:59], s71 offen offset:2048 lds
    s_waitcnt vmcnt(55)
    buffer_load_dwordx4 v35, s[56:59], s71 offen offset:3072 lds
    s_mov_b32 m0, 137600
    s_nop 0
    buffer_load_dwordx4 v32, s[60:63], s71 offen lds
    buffer_load_dwordx4 v33, s[60:63], s71 offen offset:1024 lds
    buffer_load_dwordx4 v34, s[60:63], s71 offen offset:2048 lds
    buffer_load_dwordx4 v35, s[60:63], s71 offen offset:3072 lds
    s_add_u32 s47, s47, s78
    s_sub_u32 s42, s47, 10
    s_cmp_ge_u32 s47, 10
    s_cselect_b32 s47, s42, s47
    s_waitcnt vmcnt(38) lgkmcnt(0)
    s_barrier
    s_mul_i32 s72, s47, 245760
    s_lshl_b32 s46, s47, 7
    s_mov_b32 m0, 24576
    s_nop 0
    buffer_load_dwordx4 v36, s[48:51], s46 offen lds
    buffer_load_dwordx4 v37, s[48:51], s46 offen offset:1024 lds
    buffer_load_dwordx4 v38, s[48:51], s46 offen offset:2048 lds
    buffer_load_dwordx4 v39, s[48:51], s46 offen offset:3072 lds
    s_mov_b32 m0, 0
    s_nop 0
    buffer_load_dwordx4 v28, s[52:55], s72 offen lds
    buffer_load_dwordx4 v29, s[52:55], s72 offen offset:1024 lds
    buffer_load_dwordx4 v30, s[52:55], s72 offen offset:2048 lds
    buffer_load_dwordx4 v31, s[52:55], s72 offen offset:3072 lds
    s_mov_b32 m0, 28672
    s_nop 0
    buffer_load_dwordx4 v40, s[48:51], s46 offen lds
    buffer_load_dwordx4 v41, s[48:51], s46 offen offset:1024 lds
    buffer_load_dwordx4 v42, s[48:51], s46 offen offset:2048 lds
    buffer_load_dwordx4 v43, s[48:51], s46 offen offset:3072 lds
    s_mov_b32 m0, 8192
    s_nop 0
    buffer_load_dwordx4 v28, s[56:59], s72 offen lds
    buffer_load_dwordx4 v29, s[56:59], s72 offen offset:1024 lds
    buffer_load_dwordx4 v30, s[56:59], s72 offen offset:2048 lds
    buffer_load_dwordx4 v31, s[56:59], s72 offen offset:3072 lds
    s_mov_b32 m0, 32768
    s_nop 0
    buffer_load_dwordx4 v44, s[48:51], s46 offen lds
    buffer_load_dwordx4 v45, s[48:51], s46 offen offset:1024 lds
    buffer_load_dwordx4 v46, s[48:51], s46 offen offset:2048 lds
    buffer_load_dwordx4 v47, s[48:51], s46 offen offset:3072 lds
    s_mov_b32 m0, 16384
    s_nop 0
    buffer_load_dwordx4 v28, s[60:63], s72 offen lds
    buffer_load_dwordx4 v29, s[60:63], s72 offen offset:1024 lds
    buffer_load_dwordx4 v30, s[60:63], s72 offen offset:2048 lds
    buffer_load_dwordx4 v31, s[60:63], s72 offen offset:3072 lds
    s_mov_b32 m0, 36864
    s_nop 0
    buffer_load_dwordx4 v48, s[48:51], s46 offen lds
    s_waitcnt vmcnt(55)
    buffer_load_dwordx4 v49, s[48:51], s46 offen offset:1024 lds
    s_mov_b32 m0, 4096
    s_nop 0
    buffer_load_dwordx4 v32, s[52:55], s72 offen lds
    buffer_load_dwordx4 v33, s[52:55], s72 offen offset:1024 lds
    buffer_load_dwordx4 v34, s[52:55], s72 offen offset:2048 lds
    buffer_load_dwordx4 v35, s[52:55], s72 offen offset:3072 lds
    s_mov_b32 m0, 12288
    s_nop 0
    buffer_load_dwordx4 v32, s[56:59], s72 offen lds
    buffer_load_dwordx4 v33, s[56:59], s72 offen offset:1024 lds
    buffer_load_dwordx4 v34, s[56:59], s72 offen offset:2048 lds
    s_waitcnt vmcnt(55)
    buffer_load_dwordx4 v35, s[56:59], s72 offen offset:3072 lds
    s_mov_b32 m0, 20480
    s_nop 0
    buffer_load_dwordx4 v32, s[60:63], s72 offen lds
    buffer_load_dwordx4 v33, s[60:63], s72 offen offset:1024 lds
    buffer_load_dwordx4 v34, s[60:63], s72 offen offset:2048 lds
    buffer_load_dwordx4 v35, s[60:63], s72 offen offset:3072 lds
    s_add_u32 s47, s47, s78
    s_sub_u32 s42, s47, 10
    s_cmp_ge_u32 s47, 10
    s_cselect_b32 s47, s42, s47
    s_waitcnt vmcnt(38) lgkmcnt(0)
    s_barrier
    s_mul_i32 s73, s47, 245760
    s_lshl_b32 s46, s47, 7
    s_mov_b32 m0, 63616
    s_nop 0
    buffer_load_dwordx4 v36, s[48:51], s46 offen lds
    buffer_load_dwordx4 v37, s[48:51], s46 offen offset:1024 lds
    buffer_load_dwordx4 v38, s[48:51], s46 offen offset:2048 lds
    buffer_load_dwordx4 v39, s[48:51], s46 offen offset:3072 lds
    s_mov_b32 m0, 39040
    s_nop 0
    buffer_load_dwordx4 v28, s[52:55], s73 offen lds
    buffer_load_dwordx4 v29, s[52:55], s73 offen offset:1024 lds
    buffer_load_dwordx4 v30, s[52:55], s73 offen offset:2048 lds
    buffer_load_dwordx4 v31, s[52:55], s73 offen offset:3072 lds
    s_mov_b32 m0, 67712
    s_nop 0
    buffer_load_dwordx4 v40, s[48:51], s46 offen lds
    buffer_load_dwordx4 v41, s[48:51], s46 offen offset:1024 lds
    buffer_load_dwordx4 v42, s[48:51], s46 offen offset:2048 lds
    buffer_load_dwordx4 v43, s[48:51], s46 offen offset:3072 lds
    s_mov_b32 m0, 47232
    s_nop 0
    buffer_load_dwordx4 v28, s[56:59], s73 offen lds
    buffer_load_dwordx4 v29, s[56:59], s73 offen offset:1024 lds
    buffer_load_dwordx4 v30, s[56:59], s73 offen offset:2048 lds
    buffer_load_dwordx4 v31, s[56:59], s73 offen offset:3072 lds
    s_mov_b32 m0, 71808
    s_nop 0
    buffer_load_dwordx4 v44, s[48:51], s46 offen lds
    buffer_load_dwordx4 v45, s[48:51], s46 offen offset:1024 lds
    buffer_load_dwordx4 v46, s[48:51], s46 offen offset:2048 lds
    buffer_load_dwordx4 v47, s[48:51], s46 offen offset:3072 lds
    s_mov_b32 m0, 55424
    s_nop 0
    buffer_load_dwordx4 v28, s[60:63], s73 offen lds
    buffer_load_dwordx4 v29, s[60:63], s73 offen offset:1024 lds
    buffer_load_dwordx4 v30, s[60:63], s73 offen offset:2048 lds
    buffer_load_dwordx4 v31, s[60:63], s73 offen offset:3072 lds
    s_mov_b32 m0, 75904
    s_nop 0
    buffer_load_dwordx4 v48, s[48:51], s46 offen lds
    s_waitcnt vmcnt(55)
    buffer_load_dwordx4 v49, s[48:51], s46 offen offset:1024 lds
    s_mov_b32 m0, 43136
    s_nop 0
    buffer_load_dwordx4 v32, s[52:55], s73 offen lds
    buffer_load_dwordx4 v33, s[52:55], s73 offen offset:1024 lds
    buffer_load_dwordx4 v34, s[52:55], s73 offen offset:2048 lds
    buffer_load_dwordx4 v35, s[52:55], s73 offen offset:3072 lds
    s_mov_b32 m0, 51328
    s_nop 0
    buffer_load_dwordx4 v32, s[56:59], s73 offen lds
    buffer_load_dwordx4 v33, s[56:59], s73 offen offset:1024 lds
    buffer_load_dwordx4 v34, s[56:59], s73 offen offset:2048 lds
    s_waitcnt vmcnt(55)
    buffer_load_dwordx4 v35, s[56:59], s73 offen offset:3072 lds
    s_mov_b32 m0, 59520
    s_nop 0
    buffer_load_dwordx4 v32, s[60:63], s73 offen lds
    buffer_load_dwordx4 v33, s[60:63], s73 offen offset:1024 lds
    buffer_load_dwordx4 v34, s[60:63], s73 offen offset:2048 lds
    buffer_load_dwordx4 v35, s[60:63], s73 offen offset:3072 lds
    s_add_u32 s47, s47, s78
    s_sub_u32 s42, s47, 10
    s_cmp_ge_u32 s47, 10
    s_cselect_b32 s47, s42, s47
    s_waitcnt vmcnt(38) lgkmcnt(0)
    s_barrier
    s_mul_i32 s74, s47, 245760
    s_lshl_b32 s46, s47, 7
    s_mov_b32 m0, 102656
    s_nop 0
    buffer_load_dwordx4 v36, s[48:51], s46 offen lds
    buffer_load_dwordx4 v37, s[48:51], s46 offen offset:1024 lds
    buffer_load_dwordx4 v38, s[48:51], s46 offen offset:2048 lds
    buffer_load_dwordx4 v39, s[48:51], s46 offen offset:3072 lds
    s_mov_b32 m0, 78080
    s_nop 0
    buffer_load_dwordx4 v28, s[52:55], s74 offen lds
    buffer_load_dwordx4 v29, s[52:55], s74 offen offset:1024 lds
    buffer_load_dwordx4 v30, s[52:55], s74 offen offset:2048 lds
    buffer_load_dwordx4 v31, s[52:55], s74 offen offset:3072 lds
    s_mov_b32 m0, 106752
    s_nop 0
    buffer_load_dwordx4 v40, s[48:51], s46 offen lds
    buffer_load_dwordx4 v41, s[48:51], s46 offen offset:1024 lds
    buffer_load_dwordx4 v42, s[48:51], s46 offen offset:2048 lds
    buffer_load_dwordx4 v43, s[48:51], s46 offen offset:3072 lds
    s_mov_b32 m0, 86272
    s_nop 0
    buffer_load_dwordx4 v28, s[56:59], s74 offen lds
    buffer_load_dwordx4 v29, s[56:59], s74 offen offset:1024 lds
    buffer_load_dwordx4 v30, s[56:59], s74 offen offset:2048 lds
    buffer_load_dwordx4 v31, s[56:59], s74 offen offset:3072 lds
    s_mov_b32 m0, 110848
    s_nop 0
    buffer_load_dwordx4 v44, s[48:51], s46 offen lds
    buffer_load_dwordx4 v45, s[48:51], s46 offen offset:1024 lds
    buffer_load_dwordx4 v46, s[48:51], s46 offen offset:2048 lds
    buffer_load_dwordx4 v47, s[48:51], s46 offen offset:3072 lds
    s_mov_b32 m0, 82176
    s_nop 0
    buffer_load_dwordx4 v32, s[52:55], s74 offen lds
    buffer_load_dwordx4 v33, s[52:55], s74 offen offset:1024 lds
    buffer_load_dwordx4 v34, s[52:55], s74 offen offset:2048 lds
    buffer_load_dwordx4 v35, s[52:55], s74 offen offset:3072 lds
    s_mov_b32 m0, 114944
    s_nop 0
    buffer_load_dwordx4 v48, s[48:51], s46 offen lds
    s_waitcnt vmcnt(55)
    buffer_load_dwordx4 v49, s[48:51], s46 offen offset:1024 lds
    s_mov_b32 m0, 90368
    s_nop 0
    buffer_load_dwordx4 v32, s[56:59], s74 offen lds
    buffer_load_dwordx4 v33, s[56:59], s74 offen offset:1024 lds
    buffer_load_dwordx4 v34, s[56:59], s74 offen offset:2048 lds
    buffer_load_dwordx4 v35, s[56:59], s74 offen offset:3072 lds
    s_add_u32 s47, s47, s78
    s_sub_u32 s42, s47, 10
    s_cmp_ge_u32 s47, 10
    s_cselect_b32 s47, s42, s47
    s_waitcnt vmcnt(30) lgkmcnt(0)
    s_barrier
    s_mul_i32 s75, s47, 245760
    s_lshl_b32 s46, s47, 7
    s_mov_b32 m0, 141696
    s_nop 0
    buffer_load_dwordx4 v36, s[48:51], s46 offen lds
    buffer_load_dwordx4 v37, s[48:51], s46 offen offset:1024 lds
    buffer_load_dwordx4 v38, s[48:51], s46 offen offset:2048 lds
    buffer_load_dwordx4 v39, s[48:51], s46 offen offset:3072 lds
    s_mov_b32 m0, 117120
    s_nop 0
    buffer_load_dwordx4 v28, s[52:55], s75 offen lds
    buffer_load_dwordx4 v29, s[52:55], s75 offen offset:1024 lds
    buffer_load_dwordx4 v30, s[52:55], s75 offen offset:2048 lds
    buffer_load_dwordx4 v31, s[52:55], s75 offen offset:3072 lds
    s_mov_b32 m0, 145792
    s_nop 0
    buffer_load_dwordx4 v40, s[48:51], s46 offen lds
    buffer_load_dwordx4 v41, s[48:51], s46 offen offset:1024 lds
    buffer_load_dwordx4 v42, s[48:51], s46 offen offset:2048 lds
    buffer_load_dwordx4 v43, s[48:51], s46 offen offset:3072 lds
    s_mov_b32 m0, 125312
    s_nop 0
    buffer_load_dwordx4 v28, s[56:59], s75 offen lds
    buffer_load_dwordx4 v29, s[56:59], s75 offen offset:1024 lds
    buffer_load_dwordx4 v30, s[56:59], s75 offen offset:2048 lds
    buffer_load_dwordx4 v31, s[56:59], s75 offen offset:3072 lds
    s_mov_b32 m0, 149888
    s_nop 0
    buffer_load_dwordx4 v44, s[48:51], s46 offen lds
    buffer_load_dwordx4 v45, s[48:51], s46 offen offset:1024 lds
    buffer_load_dwordx4 v46, s[48:51], s46 offen offset:2048 lds
    buffer_load_dwordx4 v47, s[48:51], s46 offen offset:3072 lds
    s_mov_b32 m0, 121216
    s_nop 0
    buffer_load_dwordx4 v32, s[52:55], s75 offen lds
    buffer_load_dwordx4 v33, s[52:55], s75 offen offset:1024 lds
    buffer_load_dwordx4 v34, s[52:55], s75 offen offset:2048 lds
    buffer_load_dwordx4 v35, s[52:55], s75 offen offset:3072 lds
    s_mov_b32 m0, 153984
    s_nop 0
    buffer_load_dwordx4 v48, s[48:51], s46 offen lds
    buffer_load_dwordx4 v49, s[48:51], s46 offen offset:1024 lds
    s_mov_b32 m0, 129408
    s_nop 0
    buffer_load_dwordx4 v32, s[56:59], s75 offen lds
    buffer_load_dwordx4 v33, s[56:59], s75 offen offset:1024 lds
    buffer_load_dwordx4 v34, s[56:59], s75 offen offset:2048 lds
    buffer_load_dwordx4 v35, s[56:59], s75 offen offset:3072 lds
    s_add_u32 s47, s47, s78
    s_sub_u32 s42, s47, 10
    s_cmp_ge_u32 s47, 10
    s_cselect_b32 s47, s42, s47
    s_waitcnt vmcnt(30) lgkmcnt(0)
    s_barrier
    s_mul_i32 s76, s47, 245760
    s_lshl_b32 s46, s47, 7
    s_mov_b32 m0, 24576
    s_nop 0
    buffer_load_dwordx4 v36, s[48:51], s46 offen lds
    buffer_load_dwordx4 v37, s[48:51], s46 offen offset:1024 lds
    buffer_load_dwordx4 v38, s[48:51], s46 offen offset:2048 lds
    buffer_load_dwordx4 v39, s[48:51], s46 offen offset:3072 lds
    s_mov_b32 m0, 0
    s_nop 0
    buffer_load_dwordx4 v28, s[52:55], s76 offen lds
    buffer_load_dwordx4 v29, s[52:55], s76 offen offset:1024 lds
    buffer_load_dwordx4 v30, s[52:55], s76 offen offset:2048 lds
    buffer_load_dwordx4 v31, s[52:55], s76 offen offset:3072 lds
    s_mov_b32 m0, 28672
    s_nop 0
    buffer_load_dwordx4 v40, s[48:51], s46 offen lds
    buffer_load_dwordx4 v41, s[48:51], s46 offen offset:1024 lds
    buffer_load_dwordx4 v42, s[48:51], s46 offen offset:2048 lds
    buffer_load_dwordx4 v43, s[48:51], s46 offen offset:3072 lds
    s_mov_b32 m0, 8192
    s_nop 0
    buffer_load_dwordx4 v28, s[56:59], s76 offen lds
    buffer_load_dwordx4 v29, s[56:59], s76 offen offset:1024 lds
    buffer_load_dwordx4 v30, s[56:59], s76 offen offset:2048 lds
    buffer_load_dwordx4 v31, s[56:59], s76 offen offset:3072 lds
    s_mov_b32 m0, 32768
    s_nop 0
    buffer_load_dwordx4 v44, s[48:51], s46 offen lds
    buffer_load_dwordx4 v45, s[48:51], s46 offen offset:1024 lds
    buffer_load_dwordx4 v46, s[48:51], s46 offen offset:2048 lds
    buffer_load_dwordx4 v47, s[48:51], s46 offen offset:3072 lds
    s_mov_b32 m0, 4096
    s_nop 0
    buffer_load_dwordx4 v32, s[52:55], s76 offen lds
    buffer_load_dwordx4 v33, s[52:55], s76 offen offset:1024 lds
    buffer_load_dwordx4 v34, s[52:55], s76 offen offset:2048 lds
    buffer_load_dwordx4 v35, s[52:55], s76 offen offset:3072 lds
    s_mov_b32 m0, 36864
    s_nop 0
    buffer_load_dwordx4 v48, s[48:51], s46 offen lds
    buffer_load_dwordx4 v49, s[48:51], s46 offen offset:1024 lds
    s_mov_b32 m0, 12288
    s_nop 0
    buffer_load_dwordx4 v32, s[56:59], s76 offen lds
    buffer_load_dwordx4 v33, s[56:59], s76 offen offset:1024 lds
    buffer_load_dwordx4 v34, s[56:59], s76 offen offset:2048 lds
    buffer_load_dwordx4 v35, s[56:59], s76 offen offset:3072 lds
    s_add_u32 s47, s47, s78
    s_sub_u32 s42, s47, 10
    s_cmp_ge_u32 s47, 10
    s_cselect_b32 s47, s42, s47
    s_waitcnt vmcnt(30) lgkmcnt(0)
    s_barrier
    s_mul_i32 s77, s47, 245760
    s_lshl_b32 s46, s47, 7
    s_mov_b32 m0, 63616
    s_nop 0
    buffer_load_dwordx4 v36, s[48:51], s46 offen lds
    buffer_load_dwordx4 v37, s[48:51], s46 offen offset:1024 lds
    buffer_load_dwordx4 v38, s[48:51], s46 offen offset:2048 lds
    buffer_load_dwordx4 v39, s[48:51], s46 offen offset:3072 lds
    s_mov_b32 m0, 39040
    s_nop 0
    buffer_load_dwordx4 v28, s[52:55], s77 offen lds
    buffer_load_dwordx4 v29, s[52:55], s77 offen offset:1024 lds
    buffer_load_dwordx4 v30, s[52:55], s77 offen offset:2048 lds
    buffer_load_dwordx4 v31, s[52:55], s77 offen offset:3072 lds
    s_mov_b32 m0, 67712
    s_nop 0
    buffer_load_dwordx4 v40, s[48:51], s46 offen lds
    buffer_load_dwordx4 v41, s[48:51], s46 offen offset:1024 lds
    buffer_load_dwordx4 v42, s[48:51], s46 offen offset:2048 lds
    buffer_load_dwordx4 v43, s[48:51], s46 offen offset:3072 lds
    s_mov_b32 m0, 47232
    s_nop 0
    buffer_load_dwordx4 v28, s[56:59], s77 offen lds
    buffer_load_dwordx4 v29, s[56:59], s77 offen offset:1024 lds
    buffer_load_dwordx4 v30, s[56:59], s77 offen offset:2048 lds
    buffer_load_dwordx4 v31, s[56:59], s77 offen offset:3072 lds
    s_mov_b32 m0, 71808
    s_nop 0
    buffer_load_dwordx4 v44, s[48:51], s46 offen lds
    buffer_load_dwordx4 v45, s[48:51], s46 offen offset:1024 lds
    buffer_load_dwordx4 v46, s[48:51], s46 offen offset:2048 lds
    buffer_load_dwordx4 v47, s[48:51], s46 offen offset:3072 lds
    s_mov_b32 m0, 43136
    s_nop 0
    buffer_load_dwordx4 v32, s[52:55], s77 offen lds
    buffer_load_dwordx4 v33, s[52:55], s77 offen offset:1024 lds
    buffer_load_dwordx4 v34, s[52:55], s77 offen offset:2048 lds
    buffer_load_dwordx4 v35, s[52:55], s77 offen offset:3072 lds
    s_mov_b32 m0, 75904
    s_nop 0
    buffer_load_dwordx4 v48, s[48:51], s46 offen lds
    buffer_load_dwordx4 v49, s[48:51], s46 offen offset:1024 lds
    s_mov_b32 m0, 51328
    s_nop 0
    buffer_load_dwordx4 v32, s[56:59], s77 offen lds
    buffer_load_dwordx4 v33, s[56:59], s77 offen offset:1024 lds
    buffer_load_dwordx4 v34, s[56:59], s77 offen offset:2048 lds
    buffer_load_dwordx4 v35, s[56:59], s77 offen offset:3072 lds
    s_add_u32 s47, s47, s78
    s_sub_u32 s42, s47, 10
    s_cmp_ge_u32 s47, 10
    s_cselect_b32 s47, s42, s47
    s_waitcnt vmcnt(30) lgkmcnt(0)
    s_barrier
    s_mov_b32 m0, 94464
    s_nop 0
    buffer_load_dwordx4 v28, s[60:63], s74 offen lds
    buffer_load_dwordx4 v29, s[60:63], s74 offen offset:1024 lds
    buffer_load_dwordx4 v30, s[60:63], s74 offen offset:2048 lds
    buffer_load_dwordx4 v31, s[60:63], s74 offen offset:3072 lds
    s_mov_b32 m0, 98560
    s_nop 0
    buffer_load_dwordx4 v32, s[60:63], s74 offen lds
    buffer_load_dwordx4 v33, s[60:63], s74 offen offset:1024 lds
    buffer_load_dwordx4 v34, s[60:63], s74 offen offset:2048 lds
    buffer_load_dwordx4 v35, s[60:63], s74 offen offset:3072 lds
    s_mov_b32 m0, 133504
    s_nop 0
    buffer_load_dwordx4 v28, s[60:63], s75 offen lds
    buffer_load_dwordx4 v29, s[60:63], s75 offen offset:1024 lds
    buffer_load_dwordx4 v30, s[60:63], s75 offen offset:2048 lds
    buffer_load_dwordx4 v31, s[60:63], s75 offen offset:3072 lds
    s_mov_b32 m0, 137600
    s_nop 0
    buffer_load_dwordx4 v32, s[60:63], s75 offen lds
    buffer_load_dwordx4 v33, s[60:63], s75 offen offset:1024 lds
    buffer_load_dwordx4 v34, s[60:63], s75 offen offset:2048 lds
    buffer_load_dwordx4 v35, s[60:63], s75 offen offset:3072 lds
    s_mov_b32 m0, 16384
    s_nop 0
    buffer_load_dwordx4 v28, s[60:63], s76 offen lds
    buffer_load_dwordx4 v29, s[60:63], s76 offen offset:1024 lds
    buffer_load_dwordx4 v30, s[60:63], s76 offen offset:2048 lds
    buffer_load_dwordx4 v31, s[60:63], s76 offen offset:3072 lds
    s_mov_b32 m0, 20480
    s_nop 0
    buffer_load_dwordx4 v32, s[60:63], s76 offen lds
    buffer_load_dwordx4 v33, s[60:63], s76 offen offset:1024 lds
    buffer_load_dwordx4 v34, s[60:63], s76 offen offset:2048 lds
    buffer_load_dwordx4 v35, s[60:63], s76 offen offset:3072 lds
    s_mov_b32 m0, 55424
    s_nop 0
    buffer_load_dwordx4 v28, s[60:63], s77 offen lds
    buffer_load_dwordx4 v29, s[60:63], s77 offen offset:1024 lds
    buffer_load_dwordx4 v30, s[60:63], s77 offen offset:2048 lds
    buffer_load_dwordx4 v31, s[60:63], s77 offen offset:3072 lds
    s_mov_b32 m0, 59520
    s_nop 0
    buffer_load_dwordx4 v32, s[60:63], s77 offen lds
    buffer_load_dwordx4 v33, s[60:63], s77 offen offset:1024 lds
    buffer_load_dwordx4 v34, s[60:63], s77 offen offset:2048 lds
    buffer_load_dwordx4 v35, s[60:63], s77 offen offset:3072 lds
    v_lshrrev_b32 v8, 5, v1
    v_mul_u32_u24 v8, 20480, v8
    v_and_b32 v7, 3, v5
    v_mul_u32_u24 v7, 1280, v7
    v_add_u32 v7, 61440, v7
    v_add_u32 v55, v7, v50
    v_xor_b32 v62, 64, v55
    v_add_u32 v56, v55, v8
    v_sub_u32 v54, v55, v8
    v_add_u32 v57, v56, v8
    v_sub_u32 v53, v54, v8
    v_add_u32 v58, v57, v8
    v_sub_u32 v52, v53, v8
    v_add_u32 v63, v62, v8
    v_sub_u32 v61, v62, v8
    v_add_u32 v64, v63, v8
    v_sub_u32 v60, v61, v8
    v_add_u32 v65, v64, v8
    v_sub_u32 v59, v60, v8
    s_waitcnt vmcnt(32) lgkmcnt(0)
    s_barrier
    s_mov_b32 m0, 0
    s_mov_b32 s4, 45056
    buffer_load_dwordx4 v53, s[64:67], s4 offen lds
    s_mov_b32 s4, 28672
    buffer_load_dwordx4 v63, s[64:67], s4 offen offset:1024 lds
    s_mov_b32 s4, 32768
    buffer_load_dwordx4 v54, s[64:67], s4 offen offset:2048 lds
    s_mov_b32 s4, 36864
    buffer_load_dwordx4 v61, s[64:67], s4 offen offset:3072 lds
    s_mov_b32 m0, 4096
    s_mov_b32 s4, 24576
    buffer_load_dwordx4 v57, s[64:67], s4 offen lds
    s_mov_b32 s4, 8192
    buffer_load_dwordx4 v65, s[64:67], s4 offen offset:1024 lds
    s_mov_b32 s4, 53248
    buffer_load_dwordx4 v56, s[64:67], s4 offen offset:2048 lds
    s_mov_b32 s4, 77824
    buffer_load_dwordx4 v61, s[64:67], s4 offen offset:3072 lds
    s_mov_b32 m0, 8192
    s_mov_b32 s4, 106496
    buffer_load_dwordx4 v56, s[64:67], s4 offen lds
    s_mov_b32 s4, 110592
    buffer_load_dwordx4 v61, s[64:67], s4 offen offset:1024 lds
    s_mov_b32 s4, 114688
    buffer_load_dwordx4 v54, s[64:67], s4 offen offset:2048 lds
    s_mov_b32 s4, 118784
    buffer_load_dwordx4 v61, s[64:67], s4 offen offset:3072 lds
    s_mov_b32 m0, 12288
    s_mov_b32 s4, 86016
    buffer_load_dwordx4 v58, s[64:67], s4 offen lds
    s_mov_b32 s4, 131072
    buffer_load_dwordx4 v63, s[64:67], s4 offen offset:1024 lds
    s_mov_b32 s4, 155648
    buffer_load_dwordx4 v54, s[64:67], s4 offen offset:2048 lds
    s_mov_b32 s4, 159744
    buffer_load_dwordx4 v61, s[64:67], s4 offen offset:3072 lds
    s_waitcnt vmcnt(16)
    v_mov_b32 v5, 157980
    v_mov_b32 v6, 1
    s_mov_b64 exec, 1
    ds_add_u32 v5, v6
    s_mov_b64 exec, -1
    v_mov_b32 v5, 157972
    v_mov_b32 v6, 1
    s_mov_b64 exec, 1
    ds_add_u32 v5, v6
    s_mov_b64 exec, -1
    s_mov_b32 m0, 24576
    s_mov_b32 s4, 188416
    buffer_load_dwordx4 v54, s[64:67], s4 offen lds
    s_mov_b32 s4, 192512
    buffer_load_dwordx4 v61, s[64:67], s4 offen offset:1024 lds
    s_mov_b32 s4, 196608
    buffer_load_dwordx4 v54, s[64:67], s4 offen offset:2048 lds
    s_mov_b32 s4, 180224
    buffer_load_dwordx4 v63, s[64:67], s4 offen offset:3072 lds
    s_mov_b32 m0, 28672
    s_mov_b32 s4, 208896
    buffer_load_dwordx4 v56, s[64:67], s4 offen lds
    s_mov_b32 s4, 233472
    buffer_load_dwordx4 v61, s[64:67], s4 offen offset:1024 lds
    s_mov_b32 s4, 237568
    buffer_load_dwordx4 v54, s[64:67], s4 offen offset:2048 lds
    s_mov_b32 s4, 241664
    buffer_load_dwordx4 v61, s[64:67], s4 offen offset:3072 lds
    s_mov_b32 m0, 123136
    s_mov_b32 s4, 270336
    buffer_load_dwordx4 v54, s[64:67], s4 offen lds
    s_mov_b32 s4, 274432
    buffer_load_dwordx4 v61, s[64:67], s4 offen offset:1024 lds
    s_mov_b32 s4, 258048
    buffer_load_dwordx4 v56, s[64:67], s4 offen offset:2048 lds
    s_mov_b32 s4, 262144
    buffer_load_dwordx4 v65, s[64:67], s4 offen offset:3072 lds
    s_mov_b32 m0, 127232
    s_mov_b32 s4, 311296
    buffer_load_dwordx4 v54, s[64:67], s4 offen lds
    s_mov_b32 s4, 315392
    buffer_load_dwordx4 v61, s[64:67], s4 offen offset:1024 lds
    s_mov_b32 s4, 319488
    buffer_load_dwordx4 v54, s[64:67], s4 offen offset:2048 lds
    s_mov_b32 s4, 282624
    buffer_load_dwordx4 v63, s[64:67], s4 offen offset:3072 lds
    s_mov_b32 m0, 80000
    s_mov_b32 s4, 352256
    buffer_load_dwordx4 v54, s[64:67], s4 offen lds
    s_mov_b32 s4, 335872
    buffer_load_dwordx4 v63, s[64:67], s4 offen offset:1024 lds
    s_mov_b32 s4, 339968
    buffer_load_dwordx4 v58, s[64:67], s4 offen offset:2048 lds
    s_mov_b32 s4, 344064
    buffer_load_dwordx4 v64, s[64:67], s4 offen offset:3072 lds
    s_mov_b32 m0, 84096
    s_mov_b32 s4, 393216
    buffer_load_dwordx4 v54, s[64:67], s4 offen lds
    s_mov_b32 s4, 397312
    buffer_load_dwordx4 v61, s[64:67], s4 offen offset:1024 lds
    s_mov_b32 s4, 360448
    buffer_load_dwordx4 v56, s[64:67], s4 offen offset:2048 lds
    s_mov_b32 s4, 405504
    buffer_load_dwordx4 v60, s[64:67], s4 offen offset:3072 lds
Lcw_5:
    s_sub_u32 s39, s39, 1
    s_cbranch_scc1 Lend
    ds_read_b32 v6, v5
    s_waitcnt lgkmcnt(0)
    v_readfirstlane_b32 s42, v6
    s_nop 0
    s_cmp_lt_u32 s42, 8
    s_nop 1
    s_cbranch_scc1 Lcw_5
    s_lshl_b32 s40, s2, 7
    s_add_u32 s40, s40, 8257536
    v_mov_b32 v51, s40
    buffer_load_dwordx4 v[66:69], v51, s[28:31], 0 offen sc1
    s_mov_b32 m0, 32768
    s_mov_b32 s4, 454656
    buffer_load_dwordx4 v53, s[64:67], s4 offen lds
    s_mov_b32 s4, 438272
    buffer_load_dwordx4 v63, s[64:67], s4 offen offset:1024 lds
    s_mov_b32 s4, 442368
    buffer_load_dwordx4 v54, s[64:67], s4 offen offset:2048 lds
    s_mov_b32 s4, 446464
    buffer_load_dwordx4 v61, s[64:67], s4 offen offset:3072 lds
    s_mov_b32 m0, 36864
    s_mov_b32 s4, 434176
    buffer_load_dwordx4 v57, s[64:67], s4 offen lds
    s_mov_b32 s4, 417792
    buffer_load_dwordx4 v65, s[64:67], s4 offen offset:1024 lds
    s_mov_b32 s4, 462848
    buffer_load_dwordx4 v56, s[64:67], s4 offen offset:2048 lds
    s_mov_b32 s4, 487424
    buffer_load_dwordx4 v61, s[64:67], s4 offen offset:3072 lds
    s_mov_b32 m0, 40960
    s_mov_b32 s4, 516096
    buffer_load_dwordx4 v56, s[64:67], s4 offen lds
    s_mov_b32 s4, 520192
    buffer_load_dwordx4 v61, s[64:67], s4 offen offset:1024 lds
    s_mov_b32 s4, 524288
    buffer_load_dwordx4 v54, s[64:67], s4 offen offset:2048 lds
    s_mov_b32 s4, 528384
    buffer_load_dwordx4 v61, s[64:67], s4 offen offset:3072 lds
    s_mov_b32 m0, 45056
    s_mov_b32 s4, 495616
    buffer_load_dwordx4 v58, s[64:67], s4 offen lds
    s_mov_b32 s4, 540672
    buffer_load_dwordx4 v63, s[64:67], s4 offen offset:1024 lds
    s_mov_b32 s4, 565248
    buffer_load_dwordx4 v54, s[64:67], s4 offen offset:2048 lds
    s_mov_b32 s4, 569344
    buffer_load_dwordx4 v61, s[64:67], s4 offen offset:3072 lds
    s_mov_b32 m0, 63616
    s_mov_b32 s4, 598016
    buffer_load_dwordx4 v54, s[64:67], s4 offen lds
    s_mov_b32 s4, 602112
    buffer_load_dwordx4 v61, s[64:67], s4 offen offset:1024 lds
    s_mov_b32 s4, 606208
    buffer_load_dwordx4 v54, s[64:67], s4 offen offset:2048 lds
    s_mov_b32 s4, 589824
    buffer_load_dwordx4 v63, s[64:67], s4 offen offset:3072 lds
    s_mov_b32 m0, 67712
    s_mov_b32 s4, 618496
    buffer_load_dwordx4 v56, s[64:67], s4 offen lds
    s_mov_b32 s4, 643072
    buffer_load_dwordx4 v61, s[64:67], s4 offen offset:1024 lds
    s_mov_b32 s4, 647168
    s_waitcnt vmcnt(55)
    buffer_load_dwordx4 v54, s[64:67], s4 offen offset:2048 lds
    s_mov_b32 s4, 651264
    buffer_load_dwordx4 v61, s[64:67], s4 offen offset:3072 lds
    s_mov_b32 m0, 71808
    s_mov_b32 s4, 679936
    buffer_load_dwordx4 v54, s[64:67], s4 offen lds
    s_mov_b32 s4, 684032
    buffer_load_dwordx4 v61, s[64:67], s4 offen offset:1024 lds
    s_mov_b32 s4, 667648
    buffer_load_dwordx4 v56, s[64:67], s4 offen offset:2048 lds
    s_mov_b32 s4, 671744
    buffer_load_dwordx4 v65, s[64:67], s4 offen offset:3072 lds
    s_mov_b32 m0, 75904
    s_mov_b32 s4, 720896
    buffer_load_dwordx4 v54, s[64:67], s4 offen lds
    s_mov_b32 s4, 724992
    buffer_load_dwordx4 v61, s[64:67], s4 offen offset:1024 lds
    s_mov_b32 s4, 729088
    s_waitcnt vmcnt(55)
    buffer_load_dwordx4 v54, s[64:67], s4 offen offset:2048 lds
    s_mov_b32 s4, 692224
    buffer_load_dwordx4 v63, s[64:67], s4 offen offset:3072 lds
    s_mov_b32 m0, 49152
    s_mov_b32 s4, 761856
    buffer_load_dwordx4 v54, s[64:67], s4 offen lds
    s_mov_b32 s4, 745472
    buffer_load_dwordx4 v63, s[64:67], s4 offen offset:1024 lds
    s_mov_b32 s4, 749568
    buffer_load_dwordx4 v58, s[64:67], s4 offen offset:2048 lds
    s_mov_b32 s4, 753664
    buffer_load_dwordx4 v64, s[64:67], s4 offen offset:3072 lds
    s_mov_b32 m0, 88192
    s_mov_b32 s4, 802816
    buffer_load_dwordx4 v54, s[64:67], s4 offen lds
    s_mov_b32 s4, 806912
    buffer_load_dwordx4 v61, s[64:67], s4 offen offset:1024 lds
    s_mov_b32 s4, 770048
    s_waitcnt vmcnt(55)
    buffer_load_dwordx4 v56, s[64:67], s4 offen offset:2048 lds
    s_mov_b32 s4, 815104
    buffer_load_dwordx4 v60, s[64:67], s4 offen offset:3072 lds
    s_waitcnt vmcnt(0)
Lbc:
    v_readfirstlane_b32 s5, v66
    v_readfirstlane_b32 s40, v67
    v_readfirstlane_b32 s6, v68
    v_readfirstlane_b32 s41, v69
    s_cmp_eq_u32 s40, s38
    s_cselect_b32 s41, s41, s40
    s_cmp_eq_u32 s41, s38
    s_nop 0
    s_cbranch_scc1 Lbc_ok
    s_sub_u32 s39, s39, 1
    s_cbranch_scc1 Lend
    buffer_load_dwordx4 v[66:69], v51, s[28:31], 0 offen sc1
    s_waitcnt vmcnt(0)
    s_branch Lbc
Lbc_ok:
    s_mul_i32 s40, s36, 96
    s_and_b32 s7, s5, 0x7ff
    s_sub_u32 s7, 2047, s7
    s_sub_u32 s41, s7, s40
    s_cmp_lt_u32 s41, 96
    s_cselect_b32 s7, s7, -1
    s_and_b32 s8, s6, 0x7ff
    s_sub_u32 s8, 2047, s8
    s_sub_u32 s41, s8, s40
    s_cmp_lt_u32 s41, 96
    s_cselect_b32 s8, s8, -1
    v_mov_b32 v4, s7
    v_mov_b32 v5, s8
    v_mov_b32 v6, 157960
    ds_write_b64 v6, v[4:5]
    s_and_b32 s41, s7, s8
    s_cmp_eq_u32 s41, -1
    s_cbranch_scc1 Lw0_done
Ly_poll:
    s_sub_u32 s39, s39, 1
    s_cbranch_scc1 Lend
    s_lshl_b32 s40, s37, 10
    s_add_u32 s40, s40, 7405568
    buffer_load_dwordx4 v[16:19], v13, s[28:31], s40 offen sc1
    s_add_u32 s40, s40, 10240
    buffer_load_dwordx4 v[20:23], v13, s[28:31], s40 offen sc1
    s_add_u32 s40, s40, 10240
    buffer_load_dwordx4 v[24:27], v13, s[28:31], s40 offen sc1
    s_add_u32 s40, s40, 10240
    buffer_load_dwordx4 v[28:31], v13, s[28:31], s40 offen sc1
    s_add_u32 s40, s40, 10240
    buffer_load_dwordx4 v[32:35], v13, s[28:31], s40 offen sc1
    s_add_u32 s40, s40, 10240
    buffer_load_dwordx4 v[36:39], v13, s[28:31], s40 offen sc1
    s_add_u32 s40, s40, 10240
    buffer_load_dwordx4 v[40:43], v13, s[28:31], s40 offen sc1
    s_add_u32 s40, s40, 10240
    buffer_load_dwordx4 v[44:47], v13, s[28:31], s40 offen sc1
    s_add_u32 s40, s40, 10240
    buffer_load_dwordx4 v[48:51], v13, s[28:31], s40 offen sc1
    s_add_u32 s40, s40, 10240
    buffer_load_dwordx4 v[52:55], v13, s[28:31], s40 offen sc1
    s_add_u32 s40, s40, 10240
    buffer_load_dwordx4 v[56:59], v13, s[28:31], s40 offen sc1
    s_add_u32 s40, s40, 10240
    buffer_load_dwordx4 v[60:63], v13, s[28:31], s40 offen sc1
    s_add_u32 s40, s40, 10240
    buffer_load_dwordx4 v[64:67], v13, s[28:31], s40 offen sc1
    s_add_u32 s40, s40, 10240
    buffer_load_dwordx4 v[68:71], v13, s[28:31], s40 offen sc1
    s_add_u32 s40, s40, 10240
    buffer_load_dwordx4 v[72:75], v13, s[28:31], s40 offen sc1
    s_add_u32 s40, s40, 10240
    buffer_load_dwordx4 v[76:79], v13, s[28:31], s40 offen sc1
    s_add_u32 s40, s40, 10240
    buffer_load_dwordx4 v[80:83], v13, s[28:31], s40 offen sc1
    s_add_u32 s40, s40, 10240
    buffer_load_dwordx4 v[84:87], v13, s[28:31], s40 offen sc1
    s_add_u32 s40, s40, 10240
    buffer_load_dwordx4 v[88:91], v13, s[28:31], s40 offen sc1
    s_add_u32 s40, s40, 10240
    buffer_load_dwordx4 v[92:95], v13, s[28:31], s40 offen sc1
    s_add_u32 s40, s40, 10240
    buffer_load_dwordx4 v[96:99], v13, s[28:31], s40 offen sc1
    s_add_u32 s40, s40, 10240
    buffer_load_dwordx4 v[100:103], v13, s[28:31], s40 offen sc1
    s_add_u32 s40, s40, 10240
    buffer_load_dwordx4 v[104:107], v13, s[28:31], s40 offen sc1
    s_add_u32 s40, s40, 10240
    buffer_load_dwordx4 v[108:111], v13, s[28:31], s40 offen sc1
    s_add_u32 s40, s40, 10240
    buffer_load_dwordx4 v[112:115], v13, s[28:31], s40 offen sc1
    s_add_u32 s40, s40, 10240
    buffer_load_dwordx4 v[116:119], v13, s[28:31], s40 offen sc1
    s_add_u32 s40, s40, 10240
    buffer_load_dwordx4 v[120:123], v13, s[28:31], s40 offen sc1
    s_add_u32 s40, s40, 10240
    s_waitcnt vmcnt(0)
    v_xor_b32 v4, s38, v17
    v_xor_b32 v5, s38, v19
    v_or_b32 v4, v4, v5
    v_xor_b32 v5, s38, v21
    v_or_b32 v4, v4, v5
    v_xor_b32 v5, s38, v23
    v_or_b32 v4, v4, v5
    v_xor_b32 v5, s38, v25
    v_or_b32 v4, v4, v5
    v_xor_b32 v5, s38, v27
    v_or_b32 v4, v4, v5
    v_xor_b32 v5, s38, v29
    v_or_b32 v4, v4, v5
    v_xor_b32 v5, s38, v31
    v_or_b32 v4, v4, v5
    v_xor_b32 v5, s38, v33
    v_or_b32 v4, v4, v5
    v_xor_b32 v5, s38, v35
    v_or_b32 v4, v4, v5
    v_xor_b32 v5, s38, v37
    v_or_b32 v4, v4, v5
    v_xor_b32 v5, s38, v39
    v_or_b32 v4, v4, v5
    v_xor_b32 v5, s38, v41
    v_or_b32 v4, v4, v5
    v_xor_b32 v5, s38, v43
    v_or_b32 v4, v4, v5
    v_xor_b32 v5, s38, v45
    v_or_b32 v4, v4, v5
    v_xor_b32 v5, s38, v47
    v_or_b32 v4, v4, v5
    v_xor_b32 v5, s38, v49
    v_or_b32 v4, v4, v5
    v_xor_b32 v5, s38, v51
    v_or_b32 v4, v4, v5
    v_xor_b32 v5, s38, v53
    v_or_b32 v4, v4, v5
    v_xor_b32 v5, s38, v55
    v_or_b32 v4, v4, v5
    v_xor_b32 v5, s38, v57
    v_or_b32 v4, v4, v5
    v_xor_b32 v5, s38, v59
    v_or_b32 v4, v4, v5
    v_xor_b32 v5, s38, v61
    v_or_b32 v4, v4, v5
    v_xor_b32 v5, s38, v63
    v_or_b32 v4, v4, v5
    v_xor_b32 v5, s38, v65
    v_or_b32 v4, v4, v5
    v_xor_b32 v5, s38, v67
    v_or_b32 v4, v4, v5
    v_xor_b32 v5, s38, v69
    v_or_b32 v4, v4, v5
    v_xor_b32 v5, s38, v71
    v_or_b32 v4, v4, v5
    v_xor_b32 v5, s38, v73
    v_or_b32 v4, v4, v5
    v_xor_b32 v5, s38, v75
    v_or_b32 v4, v4, v5
    v_xor_b32 v5, s38, v77
    v_or_b32 v4, v4, v5
    v_xor_b32 v5, s38, v79
    v_or_b32 v4, v4, v5
    v_xor_b32 v5, s38, v81
    v_or_b32 v4, v4, v5
    v_xor_b32 v5, s38, v83
    v_or_b32 v4, v4, v5
    v_xor_b32 v5, s38, v85
    v_or_b32 v4, v4, v5
    v_xor_b32 v5, s38, v87
    v_or_b32 v4, v4, v5
    v_xor_b32 v5, s38, v89
    v_or_b32 v4, v4, v5
    v_xor_b32 v5, s38, v91
    v_or_b32 v4, v4, v5
    v_xor_b32 v5, s38, v93
    v_or_b32 v4, v4, v5
    v_xor_b32 v5, s38, v95
    v_or_b32 v4, v4, v5
    v_xor_b32 v5, s38, v97
    v_or_b32 v4, v4, v5
    v_xor_b32 v5, s38, v99
    v_or_b32 v4, v4, v5
    v_xor_b32 v5, s38, v101
    v_or_b32 v4, v4, v5
    v_xor_b32 v5, s38, v103
    v_or_b32 v4, v4, v5
    v_xor_b32 v5, s38, v105
    v_or_b32 v4, v4, v5
    v_xor_b32 v5, s38, v107
    v_or_b32 v4, v4, v5
    v_xor_b32 v5, s38, v109
    v_or_b32 v4, v4, v5
    v_xor_b32 v5, s38, v111
    v_or_b32 v4, v4, v5
    v_xor_b32 v5, s38, v113
    v_or_b32 v4, v4, v5
    v_xor_b32 v5, s38, v115
    v_or_b32 v4, v4, v5
    v_xor_b32 v5, s38, v117
    v_or_b32 v4, v4, v5
    v_xor_b32 v5, s38, v119
    v_or_b32 v4, v4, v5
    v_xor_b32 v5, s38, v121
    v_or_b32 v4, v4, v5
    v_xor_b32 v5, s38, v123
    v_or_b32 v4, v4, v5
    v_cmp_ne_u32 vcc, 0, v4
    s_nop 0
    s_cmp_lg_u64 vcc, 0
    s_nop 1
    s_cbranch_scc1 Ly_poll
    v_add_f32 v16, v16, v20
    v_add_f32 v18, v18, v22
    v_add_f32 v16, v16, v24
    v_add_f32 v18, v18, v26
    v_add_f32 v16, v16, v28
    v_add_f32 v18, v18, v30
    v_add_f32 v16, v16, v32
    v_add_f32 v18, v18, v34
    v_add_f32 v16, v16, v36
    v_add_f32 v18, v18, v38
    v_add_f32 v16, v16, v40
    v_add_f32 v18, v18, v42
    v_add_f32 v16, v16, v44
    v_add_f32 v18, v18, v46
    v_add_f32 v16, v16, v48
    v_add_f32 v18, v18, v50
    v_add_f32 v16, v16, v52
    v_add_f32 v18, v18, v54
    v_add_f32 v16, v16, v56
    v_add_f32 v18, v18, v58
    v_add_f32 v16, v16, v60
    v_add_f32 v18, v18, v62
    v_add_f32 v16, v16, v64
    v_add_f32 v18, v18, v66
    v_add_f32 v16, v16, v68
    v_add_f32 v18, v18, v70
    v_add_f32 v16, v16, v72
    v_add_f32 v18, v18, v74
    v_add_f32 v16, v16, v76
    v_add_f32 v18, v18, v78
    v_add_f32 v16, v16, v80
    v_add_f32 v18, v18, v82
    v_add_f32 v16, v16, v84
    v_add_f32 v18, v18, v86
    v_add_f32 v16, v16, v88
    v_add_f32 v18, v18, v90
    v_add_f32 v16, v16, v92
    v_add_f32 v18, v18, v94
    v_add_f32 v16, v16, v96
    v_add_f32 v18, v18, v98
    v_add_f32 v16, v16, v100
    v_add_f32 v18, v18, v102
    v_add_f32 v16, v16, v104
    v_add_f32 v18, v18, v106
    v_add_f32 v16, v16, v108
    v_add_f32 v18, v18, v110
    v_add_f32 v16, v16, v112
    v_add_f32 v18, v18, v114
    v_add_f32 v16, v16, v116
    v_add_f32 v18, v18, v118
    v_add_f32 v16, v16, v120
    v_add_f32 v18, v18, v122
    s_lshr_b32 s40, s5, 16
    s_cmp_ge_u32 s40, 0x8000
    s_cselect_b32 s41, 0x8000, -1
    s_xor_b32 s40, s40, s41
    s_lshl_b32 s40, s40, 16
    v_mov_b32 v4, s40
    v_mul_f32 v4, 0xbfb8aa3b, v4
    v_exp_f32 v4, v4
    s_nop 0
    v_add_f32 v4, 1.0, v4
    v_rcp_f32 v4, v4
    s_nop 0
    v_cvt_pk_bf16_f32 v4, v4, v4
    v_lshlrev_b32 v4, 16, v4
    v_cvt_pk_bf16_f32 v16, v16, v16
    v_lshlrev_b32 v16, 16, v16
    v_mul_f32 v16, v16, v4
    v_cvt_pk_bf16_f32 v16, v16, v16
    v_lshlrev_b32 v16, 16, v16
    v_add_u32 v5, 158208, v12
    ds_write_b32 v5, v16 offset:0
    s_lshr_b32 s40, s6, 16
    s_cmp_ge_u32 s40, 0x8000
    s_cselect_b32 s41, 0x8000, -1
    s_xor_b32 s40, s40, s41
    s_lshl_b32 s40, s40, 16
    v_mov_b32 v4, s40
    v_mul_f32 v4, 0xbfb8aa3b, v4
    v_exp_f32 v4, v4
    s_nop 0
    v_add_f32 v4, 1.0, v4
    v_rcp_f32 v4, v4
    s_nop 0
    v_cvt_pk_bf16_f32 v4, v4, v4
    v_lshlrev_b32 v4, 16, v4
    v_cvt_pk_bf16_f32 v18, v18, v18
    v_lshlrev_b32 v18, 16, v18
    v_mul_f32 v18, v18, v4
    v_cvt_pk_bf16_f32 v18, v18, v18
    v_lshlrev_b32 v18, 16, v18
    v_add_u32 v5, 158208, v12
    ds_write_b32 v5, v18 offset:256
    v_mov_b32 v4, 0
    ds_write_b32 v5, v4 offset:512
    v_mov_b32 v4, 157956
    ds_write_b32 v4, v4
    s_nop 0
Lw0_done:
    s_waitcnt lgkmcnt(0)
    s_endpgm
Lcomp:
    s_lshl_b32 s46, s26, 1
    s_add_u32 s46, s46, s27
    s_sub_u32 s40, s37, 5
    s_cmp_ge_u32 s37, 5
    s_cselect_b32 s44, s40, s37
    s_mov_b32 s45, 0xbfe10856
    s_cmp_eq_u32 s44, 1
    s_cselect_b32 s45, 0xaff80255, s45
    s_cmp_eq_u32 s44, 2
    s_cselect_b32 s45, 0xabfe4015, s45
    s_cmp_eq_u32 s44, 3
    s_cselect_b32 s45, 0xaa7fd005, s45
    s_cmp_eq_u32 s44, 4
    s_cselect_b32 s45, 0x6adfb401, s45
    s_lshl_b32 s41, s27, 13
    s_cmp_eq_u32 s46, 1
    s_cselect_b32 s41, 0, s41
    v_bfe_u32 v7, v1, 2, 2
    v_and_b32 v8, 3, v1
    v_lshl_add_u32 v18, v2, 3, v7
    v_lshlrev_b32 v18, 7, v18
    v_lshlrev_b32 v19, 2, v1
    v_and_b32 v19, 0x60, v19
    v_lshlrev_b32 v10, 1, v8
    v_add_u32 v9, s41, v18
    v_add_u32 v11, 0, v10
    v_bfe_u32 v11, s45, v11, 2
    v_lshl_add_u32 v11, v11, 2, v8
    v_lshlrev_b32 v11, 3, v11
    v_xad_u32 v20, v11, v19, v9
    v_add_u32 v11, 8, v10
    v_bfe_u32 v11, s45, v11, 2
    v_lshl_add_u32 v11, v11, 2, v8
    v_lshlrev_b32 v11, 3, v11
    v_xad_u32 v21, v11, v19, v9
    v_add_u32 v11, 16, v10
    v_bfe_u32 v11, s45, v11, 2
    v_lshl_add_u32 v11, v11, 2, v8
    v_lshlrev_b32 v11, 3, v11
    v_xad_u32 v22, v11, v19, v9
    v_add_u32 v11, 24, v10
    v_bfe_u32 v11, s45, v11, 2
    v_lshl_add_u32 v11, v11, 2, v8
    v_lshlrev_b32 v11, 3, v11
    v_xad_u32 v23, v11, v19, v9
    v_add_u32 v24, 78080, v20
    v_add_u32 v25, 78080, v21
    v_add_u32 v26, 78080, v22
    v_add_u32 v27, 78080, v23
    v_lshrrev_b32 v10, 1, v3
    v_xor_b32 v9, v10, v2
    v_lshlrev_b32 v9, 4, v9
    v_lshl_add_u32 v9, v3, 7, v9
    s_lshl_b32 s40, s46, 11
    s_xor_b32 s42, s40, 2048
    s_add_u32 s40, s40, 22528
    s_add_u32 s42, s42, 22528
    v_add_u32 v76, s40, v9
    v_add_u32 v78, s42, v9
    s_mul_i32 s43, s26, 6144
    s_add_u32 s43, s43, 98560
    v_add_u32 v125, s43, v13
    s_lshl_b32 s47, s46, 11
    s_add_u32 s47, s47, 139648
    s_waitcnt lgkmcnt(0)
    s_mov_b64 s[28:29], s[24:25]
    s_mov_b32 s30, 268435456
    s_mov_b32 s31, 0x20000
    s_mov_b64 s[32:33], s[22:23]
    s_mov_b32 s34, 256
    s_mov_b32 s35, 0x20000
    s_load_dword s38, s[28:29], 0
    s_cmp_eq_u32 s46, 1
    s_cbranch_scc1 Lhalo
    v_xor_b32 v77, 64, v76
    v_xor_b32 v79, 64, v78
    v_add_u32 v80, 78080, v76
    v_add_u32 v81, 78080, v77
    v_add_u32 v82, 78080, v78
    v_add_u32 v83, 78080, v79
    s_cmp_eq_u32 s27, 0
    s_cselect_b64 vcc, 0, -1
    s_sub_u32 s41, 16384, s41
    v_cndmask_b32 v84, v20, v22, vcc
    v_cndmask_b32 v85, v21, v23, vcc
    v_add_u32 v84, s41, v84
    v_add_u32 v85, s41, v85
    v_add_u32 v86, 78080, v84
    v_add_u32 v87, 78080, v85
    v_lshrrev_b32 v8, 1, v2
    v_xor_b32 v8, v8, v10
    v_lshlrev_b32 v8, 4, v8
    v_lshl_add_u32 v8, v3, 7, v8
    v_and_b32 v7, 1, v2
    v_lshl_add_u32 v124, v7, 3, v8
    v_add_u32 v4, s40, v124
    v_xor_b32 v5, 32, v4
    v_xor_b32 v6, 64, v4
    v_xor_b32 v7, 0x60, v4
    s_mov_b64 s[48:49], s[20:21]
    s_mov_b32 s50, 2621440
    s_mov_b32 s51, 0x20000
    v_mov_b32 v14, 0x3f803f80
    v_mov_b32 v15, 0x3f803f80
    v_mov_b32 v16, 0x3f803f80
    v_mov_b32 v17, 0x3f803f80
    s_mov_b32 s4, 0xaae00455
    s_cmp_eq_u32 s44, 1
    s_cselect_b32 s4, 0xaaf80155, s4
    s_cmp_eq_u32 s44, 2
    s_cselect_b32 s4, 0xaafe4055, s4
    s_cmp_eq_u32 s44, 3
    s_cselect_b32 s4, 0xaabfd055, s4
    s_cmp_eq_u32 s44, 4
    s_cselect_b32 s4, 0xaaeff455, s4
    v_lshlrev_b32 v10, 1, v2
    v_add_u32 v10, 8, v10
    v_bfe_u32 v10, s4, v10, 2
    v_cmp_eq_u32 s[6:7], 0, v10
    v_cmp_eq_u32 s[8:9], 3, v10
    v_cmp_eq_u32 s[10:11], 1, v10
    v_lshlrev_b32 v10, 1, v2
    v_add_u32 v10, 16, v10
    v_bfe_u32 v10, s4, v10, 2
    v_cmp_eq_u32 s[12:13], 0, v10
    v_cmp_eq_u32 s[14:15], 3, v10
    v_cmp_eq_u32 s[16:17], 2, v10
    s_mov_b32 s4, 0xaaaaaaaa
    s_mov_b32 s5, 0xaaaaaaaa
    s_mov_b32 s18, 0xfff0ffff
    s_mov_b32 s19, 0xf000ff00
    s_mov_b32 s20, 0xffc0fffc
    s_mov_b32 s21, 0xc000fc00
    v_mov_b32 v8, 0xffff
    v_not_b32 v9, v8
    v_cndmask_b32 v8, v8, v9, s[4:5]
    v_cndmask_b32 v118, 0, v8, s[18:19]
    v_cndmask_b32 v119, 0, v8, s[20:21]
    v_xor_b32 v116, v118, v8
    v_xor_b32 v117, v119, v8
    s_cmp_eq_u32 s36, 0
    s_cselect_b32 s40, s46, 0
    s_cmp_eq_u32 s40, 2
    s_cselect_b32 s22, 0xff800000, 0
    s_mul_i32 s40, s36, 6
    s_add_u32 s40, s40, s46
    s_sub_u32 s40, s40, 2
    s_lshl_b32 s24, s40, 7
    s_add_u32 s24, s24, 7340032
    s_mul_i32 s52, s40, 20480
    s_add_u32 s52, s52, 4194304
    s_lshl_b32 s40, s37, 11
    s_add_u32 s23, s40, s52
    s_add_u32 s53, s52, 4096
    s_add_u32 s54, s52, 8192
    s_add_u32 s55, s52, 12288
    s_add_u32 s56, s52, 16384
    s_mul_i32 s40, s36, 10
    s_add_u32 s40, s40, s37
    s_mul_i32 s57, s40, 6144
    s_lshl_b32 s40, s46, 10
    s_add_u32 s57, s57, s40
    s_add_u32 s57, s57, 1046528
    s_sub_u32 s58, s57, 6144
    s_add_u32 s59, s57, 6144
    s_cmp_eq_u32 s44, 0
    s_cselect_b32 s60, 0, -1
    s_cmp_eq_u32 s44, 4
    s_cselect_b32 s61, 0, -1
    s_lshl_b32 s40, s37, 2
    v_mov_b32 v97, s40
    s_mov_b32 s25, 0x3ea52b5c
    s_lshl_b32 s40, s46, 6
    s_add_u32 s40, s40, 156160
    v_lshl_add_u32 v94, v3, 2, s40
    v_and_b32 v8, 1, v1
    v_lshl_add_u32 v8, v2, 2, v8
    v_lshl_add_u32 v8, v8, 2, s40
    v_subrev_u32 v9, 64, v8
    v_cndmask_b32 v92, v9, v8, s[18:19]
    v_cndmask_b32 v93, v9, v8, s[20:21]
    v_lshlrev_b32 v95, 4, v2
    s_lshl_b32 s40, s27, 8
    s_add_u32 s40, s40, 157184
    v_add_u32 v95, s40, v95
    v_mov_b32 v96, 157968
    v_mov_b32 v100, -1
    v_mov_b32 v101, -1
    v_mov_b32 v102, -1
    v_mov_b32 v103, -1
    s_waitcnt lgkmcnt(0)
    s_barrier
    ds_read_b128 a[64:67], v76 offset:0
    ds_read_b128 a[68:71], v78 offset:0
    ds_read_b64_tr_b16 a[80:81], v20 offset:0
    ds_read_b64_tr_b16 a[82:83], v20 offset:512
    ds_read_b64_tr_b16 a[84:85], v21 offset:0
    ds_read_b64_tr_b16 a[86:87], v21 offset:512
    ds_read_b64_tr_b16 a[88:89], v22 offset:0
    ds_read_b64_tr_b16 a[90:91], v22 offset:512
    ds_read_b64_tr_b16 a[92:93], v23 offset:0
    ds_read_b64_tr_b16 a[94:95], v23 offset:512
    ds_read_b64_tr_b16 a[96:97], v84 offset:0
    ds_read_b64_tr_b16 a[98:99], v84 offset:512
    ds_read_b64_tr_b16 a[100:101], v85 offset:0
    ds_read_b64_tr_b16 a[102:103], v85 offset:512
    ds_read_b64 v[108:109], v4
    ds_read_b64 v[110:111], v5
    ds_read_b64 v[112:113], v6
    ds_read_b64 v[114:115], v7
    s_add_u32 s38, s38, 0x9e3779b8
    s_or_b32 s38, s38, 1
    s_waitcnt lgkmcnt(4)
    v_mfma_f32_16x16x32_bf16 v[28:31], a[80:83], a[64:67], 0
    ds_read_b128 a[72:75], v77 offset:0
    ds_read_b128 a[76:79], v79 offset:0
    v_mfma_f32_16x16x32_bf16 v[44:47], a[80:83], a[68:71], 0
    ds_read_b64_tr_b16 a[104:105], v20 offset:4096
    ds_read_b64_tr_b16 a[106:107], v20 offset:4608
    v_mfma_f32_16x16x32_bf16 v[32:35], a[84:87], a[64:67], 0
    ds_read_b64_tr_b16 a[108:109], v21 offset:4096
    ds_read_b64_tr_b16 a[110:111], v21 offset:4608
    v_mfma_f32_16x16x32_bf16 v[48:51], a[84:87], a[68:71], 0
    ds_read_b64_tr_b16 a[112:113], v22 offset:4096
    ds_read_b64_tr_b16 a[114:115], v22 offset:4608
    v_mfma_f32_16x16x32_bf16 v[36:39], a[88:91], a[64:67], 0
    ds_read_b64_tr_b16 a[116:117], v23 offset:4096
    ds_read_b64_tr_b16 a[118:119], v23 offset:4608
    v_mfma_f32_16x16x32_bf16 v[52:55], a[88:91], a[68:71], 0
    ds_read_b64_tr_b16 a[120:121], v84 offset:4096
    ds_read_b64_tr_b16 a[122:123], v84 offset:4608
    v_mfma_f32_16x16x32_bf16 v[40:43], a[92:95], a[64:67], 0
    ds_read_b64_tr_b16 a[124:125], v85 offset:4096
    ds_read_b64_tr_b16 a[126:127], v85 offset:4608
    v_mfma_f32_16x16x32_bf16 v[56:59], a[92:95], a[68:71], 0
    v_mfma_f32_16x16x32_bf16 v[60:63], a[64:67], a[96:99], 0
    v_mfma_f32_16x16x32_bf16 v[68:71], a[68:71], a[96:99], 0
    v_mfma_f32_16x16x32_bf16 v[64:67], a[64:67], a[100:103], 0
    v_mfma_f32_16x16x32_bf16 v[72:75], a[68:71], a[100:103], 0
    s_waitcnt lgkmcnt(0)
    s_barrier
    v_mfma_f32_16x16x32_bf16 v[28:31], a[104:107], a[72:75], v[28:31]
    ds_read_b128 a[64:67], v76 offset:39040
    ds_read_b128 a[68:71], v78 offset:39040
    v_mfma_f32_16x16x32_bf16 v[44:47], a[104:107], a[76:79], v[44:47]
    ds_read_b64_tr_b16 a[80:81], v20 offset:39040
    ds_read_b64_tr_b16 a[82:83], v20 offset:39552
    v_mfma_f32_16x16x32_bf16 v[32:35], a[108:111], a[72:75], v[32:35]
    ds_read_b64_tr_b16 a[84:85], v21 offset:39040
    ds_read_b64_tr_b16 a[86:87], v21 offset:39552
    v_mfma_f32_16x16x32_bf16 v[48:51], a[108:111], a[76:79], v[48:51]
    ds_read_b64_tr_b16 a[88:89], v22 offset:39040
    ds_read_b64_tr_b16 a[90:91], v22 offset:39552
    v_mfma_f32_16x16x32_bf16 v[36:39], a[112:115], a[72:75], v[36:39]
    ds_read_b64_tr_b16 a[92:93], v23 offset:39040
    ds_read_b64_tr_b16 a[94:95], v23 offset:39552
    v_mfma_f32_16x16x32_bf16 v[52:55], a[112:115], a[76:79], v[52:55]
    ds_read_b64_tr_b16 a[96:97], v84 offset:39040
    ds_read_b64_tr_b16 a[98:99], v84 offset:39552
    v_mfma_f32_16x16x32_bf16 v[40:43], a[116:119], a[72:75], v[40:43]
    ds_read_b64_tr_b16 a[100:101], v85 offset:39040
    ds_read_b64_tr_b16 a[102:103], v85 offset:39552
    v_mfma_f32_16x16x32_bf16 v[56:59], a[116:119], a[76:79], v[56:59]
    v_mfma_f32_16x16x32_bf16 v[60:63], a[72:75], a[120:123], v[60:63]
    v_mfma_f32_16x16x32_bf16 v[68:71], a[76:79], a[120:123], v[68:71]
    v_mfma_f32_16x16x32_bf16 v[64:67], a[72:75], a[124:127], v[64:67]
    v_mfma_f32_16x16x32_bf16 v[72:75], a[76:79], a[124:127], v[72:75]
    s_waitcnt lgkmcnt(0)
    v_mfma_f32_16x16x32_bf16 v[28:31], a[80:83], a[64:67], v[28:31]
    ds_read_b128 a[72:75], v77 offset:39040
    ds_read_b128 a[76:79], v79 offset:39040
    v_mfma_f32_16x16x32_bf16 v[44:47], a[80:83], a[68:71], v[44:47]
    ds_read_b64_tr_b16 a[104:105], v20 offset:43136
    ds_read_b64_tr_b16 a[106:107], v20 offset:43648
    v_mfma_f32_16x16x32_bf16 v[32:35], a[84:87], a[64:67], v[32:35]
    ds_read_b64_tr_b16 a[108:109], v21 offset:43136
    ds_read_b64_tr_b16 a[110:111], v21 offset:43648
    v_mfma_f32_16x16x32_bf16 v[48:51], a[84:87], a[68:71], v[48:51]
    ds_read_b64_tr_b16 a[112:113], v22 offset:43136
    ds_read_b64_tr_b16 a[114:115], v22 offset:43648
    v_mfma_f32_16x16x32_bf16 v[36:39], a[88:91], a[64:67], v[36:39]
    ds_read_b64_tr_b16 a[116:117], v23 offset:43136
    ds_read_b64_tr_b16 a[118:119], v23 offset:43648
    v_mfma_f32_16x16x32_bf16 v[52:55], a[88:91], a[68:71], v[52:55]
    ds_read_b64_tr_b16 a[120:121], v84 offset:43136
    ds_read_b64_tr_b16 a[122:123], v84 offset:43648
    v_mfma_f32_16x16x32_bf16 v[40:43], a[92:95], a[64:67], v[40:43]
    ds_read_b64_tr_b16 a[124:125], v85 offset:43136
    ds_read_b64_tr_b16 a[126:127], v85 offset:43648
    v_mfma_f32_16x16x32_bf16 v[56:59], a[92:95], a[68:71], v[56:59]
    v_mfma_f32_16x16x32_bf16 v[60:63], a[64:67], a[96:99], v[60:63]
    v_mfma_f32_16x16x32_bf16 v[68:71], a[68:71], a[96:99], v[68:71]
    v_mfma_f32_16x16x32_bf16 v[64:67], a[64:67], a[100:103], v[64:67]
    v_mfma_f32_16x16x32_bf16 v[72:75], a[68:71], a[100:103], v[72:75]
    s_waitcnt lgkmcnt(0)
    s_barrier
    v_mfma_f32_16x16x32_bf16 v[28:31], a[104:107], a[72:75], v[28:31]
    ds_read_b128 a[64:67], v80 offset:0
    ds_read_b128 a[68:71], v82 offset:0
    v_mfma_f32_16x16x32_bf16 v[44:47], a[104:107], a[76:79], v[44:47]
    ds_read_b64_tr_b16 a[80:81], v24 offset:0
    ds_read_b64_tr_b16 a[82:83], v24 offset:512
    v_mfma_f32_16x16x32_bf16 v[32:35], a[108:111], a[72:75], v[32:35]
    ds_read_b64_tr_b16 a[84:85], v25 offset:0
    ds_read_b64_tr_b16 a[86:87], v25 offset:512
    v_mfma_f32_16x16x32_bf16 v[48:51], a[108:111], a[76:79], v[48:51]
    ds_read_b64_tr_b16 a[88:89], v26 offset:0
    ds_read_b64_tr_b16 a[90:91], v26 offset:512
    v_mfma_f32_16x16x32_bf16 v[36:39], a[112:115], a[72:75], v[36:39]
    ds_read_b64_tr_b16 a[92:93], v27 offset:0
    ds_read_b64_tr_b16 a[94:95], v27 offset:512
    v_mfma_f32_16x16x32_bf16 v[52:55], a[112:115], a[76:79], v[52:55]
    ds_read_b64_tr_b16 a[96:97], v86 offset:0
    ds_read_b64_tr_b16 a[98:99], v86 offset:512
    v_mfma_f32_16x16x32_bf16 v[40:43], a[116:119], a[72:75], v[40:43]
    ds_read_b64_tr_b16 a[100:101], v87 offset:0
    ds_read_b64_tr_b16 a[102:103], v87 offset:512
    v_mfma_f32_16x16x32_bf16 v[56:59], a[116:119], a[76:79], v[56:59]
    v_mfma_f32_16x16x32_bf16 v[60:63], a[72:75], a[120:123], v[60:63]
    v_mfma_f32_16x16x32_bf16 v[68:71], a[76:79], a[120:123], v[68:71]
    v_mfma_f32_16x16x32_bf16 v[64:67], a[72:75], a[124:127], v[64:67]
    v_mfma_f32_16x16x32_bf16 v[72:75], a[76:79], a[124:127], v[72:75]
    s_waitcnt lgkmcnt(0)
    v_mfma_f32_16x16x32_bf16 v[28:31], a[80:83], a[64:67], v[28:31]
    ds_read_b128 a[72:75], v81 offset:0
    ds_read_b128 a[76:79], v83 offset:0
    v_mfma_f32_16x16x32_bf16 v[44:47], a[80:83], a[68:71], v[44:47]
    ds_read_b64_tr_b16 a[104:105], v24 offset:4096
    ds_read_b64_tr_b16 a[106:107], v24 offset:4608
    v_mfma_f32_16x16x32_bf16 v[32:35], a[84:87], a[64:67], v[32:35]
    ds_read_b64_tr_b16 a[108:109], v25 offset:4096
    ds_read_b64_tr_b16 a[110:111], v25 offset:4608
    v_mfma_f32_16x16x32_bf16 v[48:51], a[84:87], a[68:71], v[48:51]
    ds_read_b64_tr_b16 a[112:113], v26 offset:4096
    ds_read_b64_tr_b16 a[114:115], v26 offset:4608
    v_mfma_f32_16x16x32_bf16 v[36:39], a[88:91], a[64:67], v[36:39]
    ds_read_b64_tr_b16 a[116:117], v27 offset:4096
    ds_read_b64_tr_b16 a[118:119], v27 offset:4608
    v_mfma_f32_16x16x32_bf16 v[52:55], a[88:91], a[68:71], v[52:55]
    ds_read_b64_tr_b16 a[120:121], v86 offset:4096
    ds_read_b64_tr_b16 a[122:123], v86 offset:4608
    v_mfma_f32_16x16x32_bf16 v[40:43], a[92:95], a[64:67], v[40:43]
    ds_read_b64_tr_b16 a[124:125], v87 offset:4096
    ds_read_b64_tr_b16 a[126:127], v87 offset:4608
    v_mfma_f32_16x16x32_bf16 v[56:59], a[92:95], a[68:71], v[56:59]
    v_mfma_f32_16x16x32_bf16 v[60:63], a[64:67], a[96:99], v[60:63]
    v_mfma_f32_16x16x32_bf16 v[68:71], a[68:71], a[96:99], v[68:71]
    v_mfma_f32_16x16x32_bf16 v[64:67], a[64:67], a[100:103], v[64:67]
    v_mfma_f32_16x16x32_bf16 v[72:75], a[68:71], a[100:103], v[72:75]
    s_waitcnt lgkmcnt(0)
    s_barrier
    v_mfma_f32_16x16x32_bf16 v[28:31], a[104:107], a[72:75], v[28:31]
    ds_read_b128 a[64:67], v80 offset:39040
    ds_read_b128 a[68:71], v82 offset:39040
    v_mfma_f32_16x16x32_bf16 v[44:47], a[104:107], a[76:79], v[44:47]
    ds_read_b64_tr_b16 a[80:81], v24 offset:39040
    ds_read_b64_tr_b16 a[82:83], v24 offset:39552
    v_mfma_f32_16x16x32_bf16 v[32:35], a[108:111], a[72:75], v[32:35]
    ds_read_b64_tr_b16 a[84:85], v25 offset:39040
    ds_read_b64_tr_b16 a[86:87], v25 offset:39552
    v_mfma_f32_16x16x32_bf16 v[48:51], a[108:111], a[76:79], v[48:51]
    ds_read_b64_tr_b16 a[88:89], v26 offset:39040
    ds_read_b64_tr_b16 a[90:91], v26 offset:39552
    v_mfma_f32_16x16x32_bf16 v[36:39], a[112:115], a[72:75], v[36:39]
    ds_read_b64_tr_b16 a[92:93], v27 offset:39040
    ds_read_b64_tr_b16 a[94:95], v27 offset:39552
    v_mfma_f32_16x16x32_bf16 v[52:55], a[112:115], a[76:79], v[52:55]
    ds_read_b64_tr_b16 a[96:97], v86 offset:39040
    ds_read_b64_tr_b16 a[98:99], v86 offset:39552
    v_mfma_f32_16x16x32_bf16 v[40:43], a[116:119], a[72:75], v[40:43]
    ds_read_b64_tr_b16 a[100:101], v87 offset:39040
    ds_read_b64_tr_b16 a[102:103], v87 offset:39552
    v_mfma_f32_16x16x32_bf16 v[56:59], a[116:119], a[76:79], v[56:59]
    v_mfma_f32_16x16x32_bf16 v[60:63], a[72:75], a[120:123], v[60:63]
    v_mfma_f32_16x16x32_bf16 v[68:71], a[76:79], a[120:123], v[68:71]
    v_mfma_f32_16x16x32_bf16 v[64:67], a[72:75], a[124:127], v[64:67]
    v_mfma_f32_16x16x32_bf16 v[72:75], a[76:79], a[124:127], v[72:75]
    s_waitcnt lgkmcnt(0)
    v_mfma_f32_16x16x32_bf16 v[28:31], a[80:83], a[64:67], v[28:31]
    ds_read_b128 a[72:75], v81 offset:39040
    ds_read_b128 a[76:79], v83 offset:39040
    v_mfma_f32_16x16x32_bf16 v[44:47], a[80:83], a[68:71], v[44:47]
    ds_read_b64_tr_b16 a[104:105], v24 offset:43136
    ds_read_b64_tr_b16 a[106:107], v24 offset:43648
    v_mfma_f32_16x16x32_bf16 v[32:35], a[84:87], a[64:67], v[32:35]
    ds_read_b64_tr_b16 a[108:109], v25 offset:43136
    ds_read_b64_tr_b16 a[110:111], v25 offset:43648
    v_mfma_f32_16x16x32_bf16 v[48:51], a[84:87], a[68:71], v[48:51]
    ds_read_b64_tr_b16 a[112:113], v26 offset:43136
    ds_read_b64_tr_b16 a[114:115], v26 offset:43648
    v_mfma_f32_16x16x32_bf16 v[36:39], a[88:91], a[64:67], v[36:39]
    ds_read_b64_tr_b16 a[116:117], v27 offset:43136
    ds_read_b64_tr_b16 a[118:119], v27 offset:43648
    v_mfma_f32_16x16x32_bf16 v[52:55], a[88:91], a[68:71], v[52:55]
    ds_read_b64_tr_b16 a[120:121], v86 offset:43136
    ds_read_b64_tr_b16 a[122:123], v86 offset:43648
    v_mfma_f32_16x16x32_bf16 v[40:43], a[92:95], a[64:67], v[40:43]
    ds_read_b64_tr_b16 a[124:125], v87 offset:43136
    ds_read_b64_tr_b16 a[126:127], v87 offset:43648
    v_mfma_f32_16x16x32_bf16 v[56:59], a[92:95], a[68:71], v[56:59]
    v_mfma_f32_16x16x32_bf16 v[60:63], a[64:67], a[96:99], v[60:63]
    v_mfma_f32_16x16x32_bf16 v[68:71], a[68:71], a[96:99], v[68:71]
    v_mfma_f32_16x16x32_bf16 v[64:67], a[64:67], a[100:103], v[64:67]
    v_mfma_f32_16x16x32_bf16 v[72:75], a[68:71], a[100:103], v[72:75]
    s_waitcnt lgkmcnt(0)
    s_barrier
    v_mfma_f32_16x16x32_bf16 v[28:31], a[104:107], a[72:75], v[28:31]
    ds_read_b128 a[64:67], v76 offset:0
    ds_read_b128 a[68:71], v78 offset:0
    v_mfma_f32_16x16x32_bf16 v[44:47], a[104:107], a[76:79], v[44:47]
    ds_read_b64_tr_b16 a[80:81], v20 offset:0
    ds_read_b64_tr_b16 a[82:83], v20 offset:512
    v_mfma_f32_16x16x32_bf16 v[32:35], a[108:111], a[72:75], v[32:35]
    ds_read_b64_tr_b16 a[84:85], v21 offset:0
    ds_read_b64_tr_b16 a[86:87], v21 offset:512
    v_mfma_f32_16x16x32_bf16 v[48:51], a[108:111], a[76:79], v[48:51]
    ds_read_b64_tr_b16 a[88:89], v22 offset:0
    ds_read_b64_tr_b16 a[90:91], v22 offset:512
    v_mfma_f32_16x16x32_bf16 v[36:39], a[112:115], a[72:75], v[36:39]
    ds_read_b64_tr_b16 a[92:93], v23 offset:0
    ds_read_b64_tr_b16 a[94:95], v23 offset:512
    v_mfma_f32_16x16x32_bf16 v[52:55], a[112:115], a[76:79], v[52:55]
    ds_read_b64_tr_b16 a[96:97], v84 offset:0
    ds_read_b64_tr_b16 a[98:99], v84 offset:512
    v_mfma_f32_16x16x32_bf16 v[40:43], a[116:119], a[72:75], v[40:43]
    ds_read_b64_tr_b16 a[100:101], v85 offset:0
    ds_read_b64_tr_b16 a[102:103], v85 offset:512
    v_mfma_f32_16x16x32_bf16 v[56:59], a[116:119], a[76:79], v[56:59]
    v_mfma_f32_16x16x32_bf16 v[60:63], a[72:75], a[120:123], v[60:63]
    v_mfma_f32_16x16x32_bf16 v[68:71], a[76:79], a[120:123], v[68:71]
    v_mfma_f32_16x16x32_bf16 v[64:67], a[72:75], a[124:127], v[64:67]
    v_mfma_f32_16x16x32_bf16 v[72:75], a[76:79], a[124:127], v[72:75]
    buffer_store_dwordx4 v[100:103], v13, s[28:31], s23 offen offset:0 sc1
    buffer_store_dwordx4 v[100:103], v13, s[28:31], s23 offen offset:1024 sc1
    buffer_store_dwordx4 v[100:103], v13, s[28:31], s57 offen sc1
    s_waitcnt lgkmcnt(0)
    v_mfma_f32_16x16x32_bf16 v[28:31], a[80:83], a[64:67], v[28:31]
    ds_read_b128 a[72:75], v77 offset:0
    ds_read_b128 a[76:79], v79 offset:0
    v_mfma_f32_16x16x32_bf16 v[44:47], a[80:83], a[68:71], v[44:47]
    ds_read_b64_tr_b16 a[104:105], v20 offset:4096
    ds_read_b64_tr_b16 a[106:107], v20 offset:4608
    v_mfma_f32_16x16x32_bf16 v[32:35], a[84:87], a[64:67], v[32:35]
    ds_read_b64_tr_b16 a[108:109], v21 offset:4096
    ds_read_b64_tr_b16 a[110:111], v21 offset:4608
    v_mfma_f32_16x16x32_bf16 v[48:51], a[84:87], a[68:71], v[48:51]
    ds_read_b64_tr_b16 a[112:113], v22 offset:4096
    ds_read_b64_tr_b16 a[114:115], v22 offset:4608
    v_mfma_f32_16x16x32_bf16 v[36:39], a[88:91], a[64:67], v[36:39]
    ds_read_b64_tr_b16 a[116:117], v23 offset:4096
    ds_read_b64_tr_b16 a[118:119], v23 offset:4608
    v_mfma_f32_16x16x32_bf16 v[52:55], a[88:91], a[68:71], v[52:55]
    ds_read_b64_tr_b16 a[120:121], v84 offset:4096
    ds_read_b64_tr_b16 a[122:123], v84 offset:4608
    v_mfma_f32_16x16x32_bf16 v[40:43], a[92:95], a[64:67], v[40:43]
    ds_read_b64_tr_b16 a[124:125], v85 offset:4096
    ds_read_b64_tr_b16 a[126:127], v85 offset:4608
    v_mfma_f32_16x16x32_bf16 v[56:59], a[92:95], a[68:71], v[56:59]
    v_mfma_f32_16x16x32_bf16 v[60:63], a[64:67], a[96:99], v[60:63]
    v_mfma_f32_16x16x32_bf16 v[68:71], a[68:71], a[96:99], v[68:71]
    v_mfma_f32_16x16x32_bf16 v[64:67], a[64:67], a[100:103], v[64:67]
    v_mfma_f32_16x16x32_bf16 v[72:75], a[68:71], a[100:103], v[72:75]
    s_waitcnt lgkmcnt(0)
    s_barrier
    v_mfma_f32_16x16x32_bf16 v[28:31], a[104:107], a[72:75], v[28:31]
    ds_read_b128 a[64:67], v76 offset:39040
    ds_read_b128 a[68:71], v78 offset:39040
    v_mfma_f32_16x16x32_bf16 v[44:47], a[104:107], a[76:79], v[44:47]
    ds_read_b64_tr_b16 a[80:81], v20 offset:39040
    ds_read_b64_tr_b16 a[82:83], v20 offset:39552
    v_mfma_f32_16x16x32_bf16 v[32:35], a[108:111], a[72:75], v[32:35]
    ds_read_b64_tr_b16 a[84:85], v21 offset:39040
    ds_read_b64_tr_b16 a[86:87], v21 offset:39552
    v_mfma_f32_16x16x32_bf16 v[48:51], a[108:111], a[76:79], v[48:51]
    ds_read_b64_tr_b16 a[88:89], v22 offset:39040
    ds_read_b64_tr_b16 a[90:91], v22 offset:39552
    v_mfma_f32_16x16x32_bf16 v[36:39], a[112:115], a[72:75], v[36:39]
    ds_read_b64_tr_b16 a[92:93], v23 offset:39040
    ds_read_b64_tr_b16 a[94:95], v23 offset:39552
    v_mfma_f32_16x16x32_bf16 v[52:55], a[112:115], a[76:79], v[52:55]
    ds_read_b64_tr_b16 a[96:97], v84 offset:39040
    ds_read_b64_tr_b16 a[98:99], v84 offset:39552
    v_mfma_f32_16x16x32_bf16 v[40:43], a[116:119], a[72:75], v[40:43]
    ds_read_b64_tr_b16 a[100:101], v85 offset:39040
    ds_read_b64_tr_b16 a[102:103], v85 offset:39552
    v_mfma_f32_16x16x32_bf16 v[56:59], a[116:119], a[76:79], v[56:59]
    v_mfma_f32_16x16x32_bf16 v[60:63], a[72:75], a[120:123], v[60:63]
    v_mfma_f32_16x16x32_bf16 v[68:71], a[76:79], a[120:123], v[68:71]
    v_mfma_f32_16x16x32_bf16 v[64:67], a[72:75], a[124:127], v[64:67]
    v_mfma_f32_16x16x32_bf16 v[72:75], a[76:79], a[124:127], v[72:75]
    s_waitcnt lgkmcnt(0)
    v_mfma_f32_16x16x32_bf16 v[28:31], a[80:83], a[64:67], v[28:31]
    ds_read_b128 a[72:75], v77 offset:39040
    ds_read_b128 a[76:79], v79 offset:39040
    v_mfma_f32_16x16x32_bf16 v[44:47], a[80:83], a[68:71], v[44:47]
    ds_read_b64_tr_b16 a[104:105], v20 offset:43136
    ds_read_b64_tr_b16 a[106:107], v20 offset:43648
    v_mfma_f32_16x16x32_bf16 v[32:35], a[84:87], a[64:67], v[32:35]
    ds_read_b64_tr_b16 a[108:109], v21 offset:43136
    ds_read_b64_tr_b16 a[110:111], v21 offset:43648
    v_mfma_f32_16x16x32_bf16 v[48:51], a[84:87], a[68:71], v[48:51]
    ds_read_b64_tr_b16 a[112:113], v22 offset:43136
    ds_read_b64_tr_b16 a[114:115], v22 offset:43648
    v_mfma_f32_16x16x32_bf16 v[36:39], a[88:91], a[64:67], v[36:39]
    ds_read_b64_tr_b16 a[116:117], v23 offset:43136
    ds_read_b64_tr_b16 a[118:119], v23 offset:43648
    v_mfma_f32_16x16x32_bf16 v[52:55], a[88:91], a[68:71], v[52:55]
    ds_read_b64_tr_b16 a[120:121], v84 offset:43136
    ds_read_b64_tr_b16 a[122:123], v84 offset:43648
    v_mfma_f32_16x16x32_bf16 v[40:43], a[92:95], a[64:67], v[40:43]
    ds_read_b64_tr_b16 a[124:125], v85 offset:43136
    ds_read_b64_tr_b16 a[126:127], v85 offset:43648
    v_mfma_f32_16x16x32_bf16 v[56:59], a[92:95], a[68:71], v[56:59]
    v_mfma_f32_16x16x32_bf16 v[60:63], a[64:67], a[96:99], v[60:63]
    v_mfma_f32_16x16x32_bf16 v[68:71], a[68:71], a[96:99], v[68:71]
    v_mfma_f32_16x16x32_bf16 v[64:67], a[64:67], a[100:103], v[64:67]
    v_mfma_f32_16x16x32_bf16 v[72:75], a[68:71], a[100:103], v[72:75]
    s_waitcnt lgkmcnt(0)
    s_barrier
    v_mfma_f32_16x16x32_bf16 v[28:31], a[104:107], a[72:75], v[28:31]
    ds_read_b128 a[0:3], v80 offset:0
    ds_read_b128 a[4:7], v82 offset:0
    v_mfma_f32_16x16x32_bf16 v[44:47], a[104:107], a[76:79], v[44:47]
    ds_read_b64_tr_b16 a[80:81], v24 offset:0
    ds_read_b64_tr_b16 a[82:83], v24 offset:512
    v_mfma_f32_16x16x32_bf16 v[32:35], a[108:111], a[72:75], v[32:35]
    ds_read_b64_tr_b16 a[84:85], v25 offset:0
    ds_read_b64_tr_b16 a[86:87], v25 offset:512
    v_mfma_f32_16x16x32_bf16 v[48:51], a[108:111], a[76:79], v[48:51]
    ds_read_b64_tr_b16 a[88:89], v26 offset:0
    ds_read_b64_tr_b16 a[90:91], v26 offset:512
    v_mfma_f32_16x16x32_bf16 v[36:39], a[112:115], a[72:75], v[36:39]
    ds_read_b64_tr_b16 a[92:93], v27 offset:0
    ds_read_b64_tr_b16 a[94:95], v27 offset:512
    v_mfma_f32_16x16x32_bf16 v[52:55], a[112:115], a[76:79], v[52:55]
    v_mfma_f32_16x16x32_bf16 v[40:43], a[116:119], a[72:75], v[40:43]
    v_mfma_f32_16x16x32_bf16 v[56:59], a[116:119], a[76:79], v[56:59]
    v_mfma_f32_16x16x32_bf16 v[60:63], a[72:75], a[120:123], v[60:63]
    v_mfma_f32_16x16x32_bf16 v[68:71], a[76:79], a[120:123], v[68:71]
    v_mfma_f32_16x16x32_bf16 v[64:67], a[72:75], a[124:127], v[64:67]
    v_mfma_f32_16x16x32_bf16 v[72:75], a[76:79], a[124:127], v[72:75]
    s_waitcnt lgkmcnt(0)
    v_mfma_f32_16x16x32_bf16 v[28:31], a[80:83], a[0:3], v[28:31]
    ds_read_b128 a[8:11], v81 offset:0
    ds_read_b128 a[12:15], v83 offset:0
    v_mfma_f32_16x16x32_bf16 v[44:47], a[80:83], a[4:7], v[44:47]
    ds_read_b64_tr_b16 a[104:105], v24 offset:4096
    ds_read_b64_tr_b16 a[106:107], v24 offset:4608
    v_mfma_f32_16x16x32_bf16 v[32:35], a[84:87], a[0:3], v[32:35]
    ds_read_b64_tr_b16 a[108:109], v25 offset:4096
    ds_read_b64_tr_b16 a[110:111], v25 offset:4608
    v_mfma_f32_16x16x32_bf16 v[48:51], a[84:87], a[4:7], v[48:51]
    ds_read_b64_tr_b16 a[112:113], v26 offset:4096
    ds_read_b64_tr_b16 a[114:115], v26 offset:4608
    v_mfma_f32_16x16x32_bf16 v[36:39], a[88:91], a[0:3], v[36:39]
    ds_read_b64_tr_b16 a[116:117], v27 offset:4096
    ds_read_b64_tr_b16 a[118:119], v27 offset:4608
    v_mfma_f32_16x16x32_bf16 v[52:55], a[88:91], a[4:7], v[52:55]
    v_mfma_f32_16x16x32_bf16 v[40:43], a[92:95], a[0:3], v[40:43]
    v_mfma_f32_16x16x32_bf16 v[56:59], a[92:95], a[4:7], v[56:59]
    s_waitcnt lgkmcnt(0)
    s_barrier
    v_mfma_f32_16x16x32_bf16 v[28:31], a[104:107], a[8:11], v[28:31]
    ds_read_b128 a[16:19], v80 offset:39040
    ds_read_b128 a[20:23], v82 offset:39040
    v_mfma_f32_16x16x32_bf16 v[44:47], a[104:107], a[12:15], v[44:47]
    ds_read_b64_tr_b16 a[80:81], v24 offset:39040
    ds_read_b64_tr_b16 a[82:83], v24 offset:39552
    v_mfma_f32_16x16x32_bf16 v[32:35], a[108:111], a[8:11], v[32:35]
    ds_read_b64_tr_b16 a[84:85], v25 offset:39040
    ds_read_b64_tr_b16 a[86:87], v25 offset:39552
    v_mfma_f32_16x16x32_bf16 v[48:51], a[108:111], a[12:15], v[48:51]
    ds_read_b64_tr_b16 a[88:89], v26 offset:39040
    ds_read_b64_tr_b16 a[90:91], v26 offset:39552
    v_mfma_f32_16x16x32_bf16 v[36:39], a[112:115], a[8:11], v[36:39]
    ds_read_b64_tr_b16 a[92:93], v27 offset:39040
    ds_read_b64_tr_b16 a[94:95], v27 offset:39552
    v_mfma_f32_16x16x32_bf16 v[52:55], a[112:115], a[12:15], v[52:55]
    v_mfma_f32_16x16x32_bf16 v[40:43], a[116:119], a[8:11], v[40:43]
    v_mfma_f32_16x16x32_bf16 v[56:59], a[116:119], a[12:15], v[56:59]
    s_waitcnt lgkmcnt(0)
    v_mfma_f32_16x16x32_bf16 v[28:31], a[80:83], a[16:19], v[28:31]
    ds_read_b128 a[24:27], v81 offset:39040
    ds_read_b128 a[28:31], v83 offset:39040
    v_mfma_f32_16x16x32_bf16 v[44:47], a[80:83], a[20:23], v[44:47]
    ds_read_b64_tr_b16 a[104:105], v24 offset:43136
    ds_read_b64_tr_b16 a[106:107], v24 offset:43648
    v_mfma_f32_16x16x32_bf16 v[32:35], a[84:87], a[16:19], v[32:35]
    ds_read_b64_tr_b16 a[108:109], v25 offset:43136
    ds_read_b64_tr_b16 a[110:111], v25 offset:43648
    v_mfma_f32_16x16x32_bf16 v[48:51], a[84:87], a[20:23], v[48:51]
    ds_read_b64_tr_b16 a[112:113], v26 offset:43136
    ds_read_b64_tr_b16 a[114:115], v26 offset:43648
    v_mfma_f32_16x16x32_bf16 v[36:39], a[88:91], a[16:19], v[36:39]
    ds_read_b64_tr_b16 a[116:117], v27 offset:43136
    ds_read_b64_tr_b16 a[118:119], v27 offset:43648
    v_mfma_f32_16x16x32_bf16 v[52:55], a[88:91], a[20:23], v[52:55]
    v_mfma_f32_16x16x32_bf16 v[40:43], a[92:95], a[16:19], v[40:43]
    v_mfma_f32_16x16x32_bf16 v[56:59], a[92:95], a[20:23], v[56:59]
    s_waitcnt lgkmcnt(0)
    s_barrier
    v_mfma_f32_16x16x32_bf16 v[28:31], a[104:107], a[24:27], v[28:31]
    ds_read_b128 a[32:35], v76 offset:0
    ds_read_b128 a[36:39], v78 offset:0
    v_mfma_f32_16x16x32_bf16 v[44:47], a[104:107], a[28:31], v[44:47]
    ds_read_b64_tr_b16 a[80:81], v20 offset:0
    ds_read_b64_tr_b16 a[82:83], v20 offset:512
    v_mfma_f32_16x16x32_bf16 v[32:35], a[108:111], a[24:27], v[32:35]
    ds_read_b64_tr_b16 a[84:85], v21 offset:0
    ds_read_b64_tr_b16 a[86:87], v21 offset:512
    v_mfma_f32_16x16x32_bf16 v[48:51], a[108:111], a[28:31], v[48:51]
    ds_read_b64_tr_b16 a[88:89], v22 offset:0
    ds_read_b64_tr_b16 a[90:91], v22 offset:512
    v_mfma_f32_16x16x32_bf16 v[36:39], a[112:115], a[24:27], v[36:39]
    ds_read_b64_tr_b16 a[92:93], v23 offset:0
    ds_read_b64_tr_b16 a[94:95], v23 offset:512
    v_mfma_f32_16x16x32_bf16 v[52:55], a[112:115], a[28:31], v[52:55]
    v_mfma_f32_16x16x32_bf16 v[40:43], a[116:119], a[24:27], v[40:43]
    v_mfma_f32_16x16x32_bf16 v[56:59], a[116:119], a[28:31], v[56:59]
    v_mov_b32 v98, s38
    s_waitcnt vmcnt(0)
    s_mov_b64 exec, 1
    buffer_store_dword v98, v97, s[28:31], s24 offen sc1
    s_mov_b64 exec, -1
    s_waitcnt lgkmcnt(0)
    v_mfma_f32_16x16x32_bf16 v[28:31], a[80:83], a[32:35], v[28:31]
    ds_read_b128 a[40:43], v77 offset:0
    ds_read_b128 a[44:47], v79 offset:0
    v_mfma_f32_16x16x32_bf16 v[44:47], a[80:83], a[36:39], v[44:47]
    ds_read_b64_tr_b16 a[104:105], v20 offset:4096
    ds_read_b64_tr_b16 a[106:107], v20 offset:4608
    v_mfma_f32_16x16x32_bf16 v[32:35], a[84:87], a[32:35], v[32:35]
    ds_read_b64_tr_b16 a[108:109], v21 offset:4096
    ds_read_b64_tr_b16 a[110:111], v21 offset:4608
    v_mfma_f32_16x16x32_bf16 v[48:51], a[84:87], a[36:39], v[48:51]
    ds_read_b64_tr_b16 a[112:113], v22 offset:4096
    ds_read_b64_tr_b16 a[114:115], v22 offset:4608
    v_mfma_f32_16x16x32_bf16 v[36:39], a[88:91], a[32:35], v[36:39]
    ds_read_b64_tr_b16 a[116:117], v23 offset:4096
    ds_read_b64_tr_b16 a[118:119], v23 offset:4608
    v_mfma_f32_16x16x32_bf16 v[52:55], a[88:91], a[36:39], v[52:55]
    v_mfma_f32_16x16x32_bf16 v[40:43], a[92:95], a[32:35], v[40:43]
    v_mfma_f32_16x16x32_bf16 v[56:59], a[92:95], a[36:39], v[56:59]
    s_waitcnt lgkmcnt(0)
    s_barrier
    v_mfma_f32_16x16x32_bf16 v[28:31], a[104:107], a[40:43], v[28:31]
    ds_read_b128 a[48:51], v76 offset:39040
    ds_read_b128 a[52:55], v78 offset:39040
    v_mfma_f32_16x16x32_bf16 v[44:47], a[104:107], a[44:47], v[44:47]
    ds_read_b64_tr_b16 a[80:81], v20 offset:39040
    ds_read_b64_tr_b16 a[82:83], v20 offset:39552
    v_mfma_f32_16x16x32_bf16 v[32:35], a[108:111], a[40:43], v[32:35]
    ds_read_b64_tr_b16 a[84:85], v21 offset:39040
    ds_read_b64_tr_b16 a[86:87], v21 offset:39552
    v_mfma_f32_16x16x32_bf16 v[48:51], a[108:111], a[44:47], v[48:51]
    ds_read_b64_tr_b16 a[88:89], v22 offset:39040
    ds_read_b64_tr_b16 a[90:91], v22 offset:39552
    v_mfma_f32_16x16x32_bf16 v[36:39], a[112:115], a[40:43], v[36:39]
    ds_read_b64_tr_b16 a[92:93], v23 offset:39040
    ds_read_b64_tr_b16 a[94:95], v23 offset:39552
    v_mfma_f32_16x16x32_bf16 v[52:55], a[112:115], a[44:47], v[52:55]
    v_mfma_f32_16x16x32_bf16 v[40:43], a[116:119], a[40:43], v[40:43]
    v_mfma_f32_16x16x32_bf16 v[56:59], a[116:119], a[44:47], v[56:59]
    s_waitcnt lgkmcnt(0)
    v_mfma_f32_16x16x32_bf16 v[28:31], a[80:83], a[48:51], v[28:31]
    ds_read_b128 a[56:59], v77 offset:39040
    ds_read_b128 a[60:63], v79 offset:39040
    v_mfma_f32_16x16x32_bf16 v[44:47], a[80:83], a[52:55], v[44:47]
    ds_read_b64_tr_b16 a[104:105], v20 offset:43136
    ds_read_b64_tr_b16 a[106:107], v20 offset:43648
    v_mfma_f32_16x16x32_bf16 v[32:35], a[84:87], a[48:51], v[32:35]
    ds_read_b64_tr_b16 a[108:109], v21 offset:43136
    ds_read_b64_tr_b16 a[110:111], v21 offset:43648
    v_mfma_f32_16x16x32_bf16 v[48:51], a[84:87], a[52:55], v[48:51]
    ds_read_b64_tr_b16 a[112:113], v22 offset:43136
    ds_read_b64_tr_b16 a[114:115], v22 offset:43648
    v_mfma_f32_16x16x32_bf16 v[36:39], a[88:91], a[48:51], v[36:39]
    ds_read_b64_tr_b16 a[116:117], v23 offset:43136
    ds_read_b64_tr_b16 a[118:119], v23 offset:43648
    v_mfma_f32_16x16x32_bf16 v[52:55], a[88:91], a[52:55], v[52:55]
    ds_read_b32 v120, v94
    ds_read_b32 v121, v94 offset:512
    v_mfma_f32_16x16x32_bf16 v[40:43], a[92:95], a[48:51], v[40:43]
    v_xor_b32 v94, 64, v94
    ds_read_b32 v122, v94
    v_mfma_f32_16x16x32_bf16 v[56:59], a[92:95], a[52:55], v[56:59]
    ds_read_b32 v123, v92 offset:512
    ds_read_b32 v126, v93 offset:520
    v_mov_b32 v24, v84
    v_mov_b32 v25, v85
    v_mov_b32 v26, v86
    v_mov_b32 v27, v87
    s_waitcnt lgkmcnt(5)
    v_mfma_f32_16x16x32_bf16 v[44:47], a[104:107], a[60:63], v[44:47]
    v_mfma_f32_16x16x32_bf16 v[48:51], a[108:111], a[60:63], v[48:51]
    v_mfma_f32_16x16x32_bf16 v[52:55], a[112:115], a[60:63], v[52:55]
    v_mfma_f32_16x16x32_bf16 v[56:59], a[116:119], a[60:63], v[56:59]
    v_mfma_f32_16x16x32_bf16 v[28:31], a[104:107], a[56:59], v[28:31]
    v_mfma_f32_16x16x32_bf16 v[32:35], a[108:111], a[56:59], v[32:35]
    ds_read_b32 v7, v96
    ds_read_b128 v[76:79], v95 offset:0
    ds_read_b128 v[80:83], v95 offset:64
    ds_read_b128 v[84:87], v95 offset:128
    ds_read_b128 v[88:91], v95 offset:192
    v_mfma_f32_16x16x32_bf16 v[36:39], a[112:115], a[56:59], v[36:39]
    v_mfma_f32_16x16x32_bf16 v[40:43], a[116:119], a[56:59], v[40:43]
    s_waitcnt lgkmcnt(0)
    s_nop 6
Lqf:
    v_readfirstlane_b32 s42, v7
    s_nop 0
    s_cmp_eq_u32 s42, 0
    s_nop 1
    s_cbranch_scc1 Lqf_re
    s_cmp_eq_u32 s27, 0
    v_fmac_f32 v44, v76, v122
    v_fmac_f32 v45, v77, v122
    v_fmac_f32 v46, v78, v122
    v_fmac_f32 v47, v79, v122
    v_cvt_pk_bf16_f32 v44, v44, v45
    v_cvt_pk_bf16_f32 v45, v46, v47
    v_fmac_f32 v48, v80, v122
    v_fmac_f32 v49, v81, v122
    v_fmac_f32 v50, v82, v122
    v_fmac_f32 v51, v83, v122
    v_cvt_pk_bf16_f32 v46, v48, v49
    v_cvt_pk_bf16_f32 v47, v50, v51
    v_fmac_f32 v52, v84, v122
    v_fmac_f32 v53, v85, v122
    v_fmac_f32 v54, v86, v122
    v_fmac_f32 v55, v87, v122
    v_cvt_pk_bf16_f32 v48, v52, v53
    v_cvt_pk_bf16_f32 v49, v54, v55
    v_fmac_f32 v56, v88, v122
    v_fmac_f32 v57, v89, v122
    v_fmac_f32 v58, v90, v122
    v_fmac_f32 v59, v91, v122
    v_cvt_pk_bf16_f32 v50, v56, v57
    v_cvt_pk_bf16_f32 v51, v58, v59
    s_nop 0
    s_cbranch_scc0 Lh1
    ds_write_b128 v125, v[44:47] offset:0
    ds_write_b128 v125, v[48:51] offset:1024
    v_mov_b32 v5, 157972
    v_mov_b32 v6, 1
    s_mov_b64 exec, 1
    ds_add_u32 v5, v6
    s_mov_b64 exec, -1
    v_fmac_f32 v28, v76, v120
    v_fmac_f32 v29, v77, v120
    v_fmac_f32 v30, v78, v120
    v_fmac_f32 v31, v79, v120
    v_cvt_pk_bf16_f32 v28, v28, v29
    v_cvt_pk_bf16_f32 v29, v30, v31
    v_fmac_f32 v32, v80, v120
    v_fmac_f32 v33, v81, v120
    v_fmac_f32 v34, v82, v120
    v_fmac_f32 v35, v83, v120
    v_cvt_pk_bf16_f32 v30, v32, v33
    v_cvt_pk_bf16_f32 v31, v34, v35
    v_fmac_f32 v36, v84, v120
    v_fmac_f32 v37, v85, v120
    v_fmac_f32 v38, v86, v120
    v_fmac_f32 v39, v87, v120
    v_cvt_pk_bf16_f32 v32, v36, v37
    v_cvt_pk_bf16_f32 v33, v38, v39
    v_fmac_f32 v40, v88, v120
    v_fmac_f32 v41, v89, v120
    v_fmac_f32 v42, v90, v120
    v_fmac_f32 v43, v91, v120
    v_cvt_pk_bf16_f32 v34, v40, v41
    v_cvt_pk_bf16_f32 v35, v42, v43
    v_subrev_u32 v4, 6144, v125
    v_mov_b32 v8, s22
    v_mov_b32 v9, s22
    v_mov_b32 v10, s22
    v_mov_b32 v11, s22
    s_nop 1
Lcw_1:
    s_sub_u32 s39, s39, 1
    s_cbranch_scc1 Lend
    ds_read_b32 v6, v5
    s_waitcnt lgkmcnt(0)
    v_readfirstlane_b32 s42, v6
    s_nop 0
    s_cmp_lt_u32 s42, 8
    s_nop 1
    s_cbranch_scc1 Lcw_1
    ds_read_b128 v[52:55], v125 offset:2048
    ds_read_b128 v[56:59], v125 offset:3072
    ds_read_b128 v[44:47], v4 offset:4096
    ds_read_b128 v[48:51], v4 offset:5120
    s_branch Lh_join
Lh1:
    ds_write_b128 v125, v[44:47] offset:2048
    ds_write_b128 v125, v[48:51] offset:3072
    v_fmac_f32 v28, v76, v120
    v_fmac_f32 v29, v77, v120
    v_fmac_f32 v30, v78, v120
    v_fmac_f32 v31, v79, v120
    v_cvt_pk_bf16_f32 v52, v28, v29
    v_cvt_pk_bf16_f32 v53, v30, v31
    v_fmac_f32 v32, v80, v120
    v_fmac_f32 v33, v81, v120
    v_fmac_f32 v34, v82, v120
    v_fmac_f32 v35, v83, v120
    v_cvt_pk_bf16_f32 v54, v32, v33
    v_cvt_pk_bf16_f32 v55, v34, v35
    v_fmac_f32 v36, v84, v120
    v_fmac_f32 v37, v85, v120
    v_fmac_f32 v38, v86, v120
    v_fmac_f32 v39, v87, v120
    v_cvt_pk_bf16_f32 v56, v36, v37
    v_cvt_pk_bf16_f32 v57, v38, v39
    v_fmac_f32 v40, v88, v120
    v_fmac_f32 v41, v89, v120
    v_fmac_f32 v42, v90, v120
    v_fmac_f32 v43, v91, v120
    v_cvt_pk_bf16_f32 v58, v40, v41
    v_cvt_pk_bf16_f32 v59, v42, v43
    ds_write_b128 v125, v[52:55] offset:4096
    ds_write_b128 v125, v[56:59] offset:5120
    v_mov_b32 v5, 157972
    v_mov_b32 v6, 1
    s_mov_b64 exec, 1
    ds_add_u32 v5, v6
    s_mov_b64 exec, -1
    v_mov_b32 v8, s22
    v_mov_b32 v9, s22
    v_mov_b32 v10, s22
    v_mov_b32 v11, s22
    s_nop 1
Lcw_2:
    s_sub_u32 s39, s39, 1
    s_cbranch_scc1 Lend
    ds_read_b32 v6, v5
    s_waitcnt lgkmcnt(0)
    v_readfirstlane_b32 s42, v6
    s_nop 0
    s_cmp_lt_u32 s42, 8
    s_nop 1
    s_cbranch_scc1 Lcw_2
    ds_read_b128 v[28:31], v125 offset:0
    ds_read_b128 v[32:35], v125 offset:1024
Lh_join:
    buffer_load_dword v20, v12, s[28:31], s24 offen sc1
    ds_read_b64_tr_b16 a[64:65], v26 offset:0
    ds_read_b64_tr_b16 a[66:67], v26 offset:512
    ds_read_b64_tr_b16 a[68:69], v27 offset:0
    ds_read_b64_tr_b16 a[70:71], v27 offset:512
    ds_read_b64_tr_b16 a[72:73], v26 offset:4096
    ds_read_b64_tr_b16 a[74:75], v26 offset:4608
    ds_read_b64_tr_b16 a[76:77], v27 offset:4096
    ds_read_b64_tr_b16 a[78:79], v27 offset:4608
    s_waitcnt lgkmcnt(8)
    s_setprio 2
    v_cndmask_b32 v92, 0, v30, s[6:7]
    v_cndmask_b32 v93, 0, v31, s[6:7]
    v_cndmask_b32 v94, 0, v32, s[12:13]
    v_cndmask_b32 v95, 0, v33, s[12:13]
    v_cndmask_b32 v104, 0, v30, s[8:9]
    v_cndmask_b32 v105, 0, v31, s[8:9]
    v_mfma_f32_16x16x32_bf16 v[76:79], v[46:49], v[92:95], v[8:11]
    v_mfma_f32_16x16x32_bf16 v[80:83], v[54:57], v[92:95], 0
    v_cndmask_b32 v106, 0, v32, s[14:15]
    v_cndmask_b32 v107, 0, v33, s[14:15]
    v_mov_b32 v96, v28
    v_mov_b32 v97, v29
    v_mfma_f32_16x16x32_bf16 v[84:87], v[46:49], v[104:107], v[8:11]
    v_mfma_f32_16x16x32_bf16 v[88:91], v[54:57], v[104:107], 0
    v_cndmask_b32 v98, 0, v30, s[10:11]
    v_cndmask_b32 v99, 0, v31, s[10:11]
    v_cndmask_b32 v100, 0, v32, s[16:17]
    v_cndmask_b32 v101, 0, v33, s[16:17]
    v_mfma_f32_16x16x32_bf16 v[36:39], v[44:47], v[96:99], v[8:11]
    v_mfma_f32_16x16x32_bf16 v[40:43], v[52:55], v[96:99], 0
    v_cndmask_b32 v76, v76, v77, s[4:5]
    v_cndmask_b32 v80, v80, v81, s[4:5]
    v_cndmask_b32 v78, v78, v79, s[4:5]
    v_cndmask_b32 v82, v82, v83, s[4:5]
    v_cndmask_b32 v92, v76, v80, s[18:19]
    v_cndmask_b32 v94, v78, v82, s[20:21]
    v_min_u32 v4, -2, v92
    v_min_u32 v5, -2, v94
    v_cndmask_b32 v84, v84, v85, s[4:5]
    v_cndmask_b32 v88, v88, v89, s[4:5]
    v_cndmask_b32 v86, v86, v87, s[4:5]
    v_cndmask_b32 v90, v90, v91, s[4:5]
    v_cndmask_b32 v104, v84, v88, s[18:19]
    v_cndmask_b32 v106, v86, v90, s[20:21]
    v_min_u32 v6, -2, v104
    v_min_u32 v7, -2, v106
    buffer_store_dwordx4 v[4:7], v13, s[28:31], s57 offen sc1
    s_setprio 0
    ds_read_b64_tr_b16 a[80:81], v26 offset:39040
    ds_read_b64_tr_b16 a[82:83], v26 offset:39552
    ds_read_b64_tr_b16 a[84:85], v27 offset:39040
    ds_read_b64_tr_b16 a[86:87], v27 offset:39552
    ds_read_b64_tr_b16 a[88:89], v26 offset:43136
    ds_read_b64_tr_b16 a[90:91], v26 offset:43648
    ds_read_b64_tr_b16 a[92:93], v27 offset:43136
    ds_read_b64_tr_b16 a[94:95], v27 offset:43648
    ds_read_b64_tr_b16 a[96:97], v24 offset:0
    ds_read_b64_tr_b16 a[98:99], v24 offset:512
    ds_read_b64_tr_b16 a[100:101], v25 offset:0
    ds_read_b64_tr_b16 a[102:103], v25 offset:512
    ds_read_b64_tr_b16 a[104:105], v24 offset:4096
    ds_read_b64_tr_b16 a[106:107], v24 offset:4608
    ds_read_b64_tr_b16 a[108:109], v25 offset:4096
    ds_read_b64_tr_b16 a[110:111], v25 offset:4608
    ds_read_b64_tr_b16 a[112:113], v24 offset:39040
    ds_read_b64_tr_b16 a[114:115], v24 offset:39552
    ds_read_b64_tr_b16 a[116:117], v25 offset:39040
    ds_read_b64_tr_b16 a[118:119], v25 offset:39552
    ds_read_b64_tr_b16 a[120:121], v24 offset:43136
    ds_read_b64_tr_b16 a[122:123], v24 offset:43648
    ds_read_b64_tr_b16 a[124:125], v25 offset:43136
    ds_read_b64_tr_b16 a[126:127], v25 offset:43648
    s_waitcnt lgkmcnt(15)
    v_mfma_f32_16x16x32_bf16 v[60:63], a[0:3], a[64:67], v[60:63]
    v_mov_b32 v102, v34
    v_mov_b32 v103, v35
    v_mul_f32 v4, s25, v121
    v_mfma_f32_16x16x32_bf16 v[68:71], a[4:7], a[64:67], v[68:71]
    v_mfma_f32_16x16x32_bf16 v[76:79], v[48:51], v[100:103], v[8:11]
    v_mfma_f32_16x16x32_bf16 v[80:83], v[56:59], v[100:103], 0
    v_mfma_f32_16x16x32_bf16 v[64:67], a[0:3], a[68:71], v[64:67]
    v_mul_f32 v123, v123, v4
    v_mul_f32 v126, v126, v4
    v_cndmask_b32 v36, v36, v37, s[4:5]
    v_mfma_f32_16x16x32_bf16 v[72:75], a[4:7], a[68:71], v[72:75]
    v_cndmask_b32 v40, v40, v41, s[4:5]
    v_cndmask_b32 v38, v38, v39, s[4:5]
    v_mfma_f32_16x16x32_bf16 v[60:63], a[8:11], a[72:75], v[60:63]
    v_cndmask_b32 v42, v42, v43, s[4:5]
    v_cndmask_b32 v96, v36, v40, s[18:19]
    v_cndmask_b32 v98, v38, v42, s[20:21]
    v_mfma_f32_16x16x32_bf16 v[68:71], a[12:15], a[72:75], v[68:71]
    v_cndmask_b32 v76, v76, v77, s[4:5]
    v_cndmask_b32 v80, v80, v81, s[4:5]
    v_mfma_f32_16x16x32_bf16 v[64:67], a[8:11], a[76:79], v[64:67]
    v_cndmask_b32 v78, v78, v79, s[4:5]
    v_cndmask_b32 v82, v82, v83, s[4:5]
    v_cndmask_b32 v100, v76, v80, s[18:19]
    v_mfma_f32_16x16x32_bf16 v[72:75], a[12:15], a[76:79], v[72:75]
    v_cndmask_b32 v102, v78, v82, s[20:21]
    v_mul_f32 v96, v96, v123
    v_mfma_f32_16x16x32_bf16 v[60:63], a[16:19], a[80:83], v[60:63]
    v_mul_f32 v98, v98, v126
    v_mul_f32 v100, v100, v123
    v_mul_f32 v102, v102, v126
    v_mfma_f32_16x16x32_bf16 v[68:71], a[20:23], a[80:83], v[68:71]
    v_max_f32 v4, v96, v98
    v_max_f32 v5, v100, v102
    v_mfma_f32_16x16x32_bf16 v[64:67], a[16:19], a[84:87], v[64:67]
    v_mov_b32 v6, v4
    v_mov_b32 v7, v5
    s_nop 0
    v_permlane32_swap_b32 v4, v6
    v_mfma_f32_16x16x32_bf16 v[72:75], a[20:23], a[84:87], v[72:75]
    v_permlane32_swap_b32 v5, v7
    v_max_f32 v4, v4, v6
    v_mfma_f32_16x16x32_bf16 v[60:63], a[24:27], a[88:91], v[60:63]
    v_max_f32 v5, v5, v7
    v_mov_b32 v6, v4
    v_mov_b32 v7, v5
    v_mfma_f32_16x16x32_bf16 v[68:71], a[28:31], a[88:91], v[68:71]
    v_permlane16_swap_b32 v4, v6
    v_permlane16_swap_b32 v5, v7
    v_mfma_f32_16x16x32_bf16 v[64:67], a[24:27], a[92:95], v[64:67]
    v_max_f32 v4, v4, v6
    v_max_f32 v5, v5, v7
    v_mfma_f32_16x16x32_bf16 v[72:75], a[28:31], a[92:95], v[72:75]
    v_sub_f32 v96, v96, v4
    v_sub_f32 v98, v98, v4
    s_waitcnt lgkmcnt(12)
    v_mfma_f32_16x16x32_bf16 v[60:63], a[32:35], a[96:99], v[60:63]
    v_sub_f32 v100, v100, v5
    v_sub_f32 v102, v102, v5
    v_exp_f32 v96, v96
    v_mfma_f32_16x16x32_bf16 v[68:71], a[36:39], a[96:99], v[68:71]
    v_exp_f32 v98, v98
    v_exp_f32 v100, v100
    v_mfma_f32_16x16x32_bf16 v[64:67], a[32:35], a[100:103], v[64:67]
    v_exp_f32 v102, v102
    v_cvt_pk_bf16_f32 v96, v96, v96
    v_mfma_f32_16x16x32_bf16 v[72:75], a[36:39], a[100:103], v[72:75]
    v_cvt_pk_bf16_f32 v97, v98, v98
    v_cvt_pk_bf16_f32 v100, v100, v100
    s_waitcnt lgkmcnt(8)
    v_mfma_f32_16x16x32_bf16 v[60:63], a[40:43], a[104:107], v[60:63]
    v_cvt_pk_bf16_f32 v101, v102, v102
    v_and_b32 v98, v96, v118
    v_and_b32 v99, v97, v119
    v_mfma_f32_16x16x32_bf16 v[68:71], a[44:47], a[104:107], v[68:71]
    v_and_b32 v96, v96, v116
    v_and_b32 v97, v97, v117
    v_mfma_f32_16x16x32_bf16 v[64:67], a[40:43], a[108:111], v[64:67]
    v_and_b32 v102, v100, v118
    v_and_b32 v103, v101, v119
    v_mfma_f32_16x16x32_bf16 v[72:75], a[44:47], a[108:111], v[72:75]
    v_and_b32 v100, v100, v116
    v_and_b32 v101, v101, v117
    s_waitcnt lgkmcnt(4)
    v_mfma_f32_16x16x32_bf16 v[60:63], a[48:51], a[112:115], v[60:63]
    s_lshl_b32 s40, s46, 6
    s_add_u32 s40, s40, 156160
    v_lshl_add_u32 v48, v2, 4, s40
    v_xor_b32 v49, 64, v48
    ds_read_b128 v[28:31], v48 offset:0
    v_mfma_f32_16x16x32_bf16 v[68:71], a[52:55], a[112:115], v[68:71]
    ds_read_b128 v[32:35], v48 offset:512
    ds_read_b128 v[36:39], v49 offset:0
    ds_read_b128 v[40:43], v49 offset:512
    s_lshl_b32 s40, s27, 3
    s_add_u32 s40, s40, 157696
    v_mfma_f32_16x16x32_bf16 v[64:67], a[48:51], a[116:119], v[64:67]
    v_lshl_add_u32 v48, v3, 4, s40
    v_mov_b32 v49, 157952
    v_lshl_add_u32 v125, v1, 3, s47
    s_lshl_b32 s40, s27, 10
    v_add_u32 v50, s40, v125
    v_mfma_f32_16x16x32_bf16 v[72:75], a[52:55], a[116:119], v[72:75]
    s_lshl_b32 s41, s27, 12
    s_sub_u32 s41, 2048, s41
    v_add_u32 v51, s41, v50
    v_subrev_u32 v125, 2048, v125
    s_waitcnt vmcnt(1)
    s_nop 2
Lfl_chk:
    v_cmp_eq_u32 vcc, s38, v20
    s_nop 0
    s_and_b32 s40, vcc_lo, 0x3ff
    s_cmp_lg_u32 s40, 0x3ff
    s_nop 0
    s_cbranch_scc1 Lfl_re
    buffer_load_dwordx2 v[52:53], v13, s[28:31], s58 offen offset:8 sc1
    buffer_load_dwordx2 v[54:55], v13, s[28:31], s59 offen offset:0 sc1
    s_waitcnt lgkmcnt(4)
    v_mfma_f32_16x16x32_bf16 v[60:63], a[56:59], a[120:123], v[60:63]
    v_mfma_f32_16x16x32_bf16 v[68:71], a[60:63], a[120:123], v[68:71]
    v_mfma_f32_16x16x32_bf16 v[64:67], a[56:59], a[124:127], v[64:67]
    v_mfma_f32_16x16x32_bf16 v[72:75], a[60:63], a[124:127], v[72:75]
    ds_read_b32 v46, v49
    ds_read_b64 v[44:45], v48
    s_waitcnt lgkmcnt(0)
    s_nop 4
Lcsv:
    v_readfirstlane_b32 s42, v46
    s_nop 0
    s_cmp_eq_u32 s42, 0
    s_nop 1
    s_cbranch_scc1 Lcsv_re
    v_fmac_f32 v60, v28, v44
    v_fmac_f32 v61, v29, v44
    v_fmac_f32 v62, v30, v44
    v_fmac_f32 v63, v31, v44
    v_mul_f32 v60, v60, v32
    v_mul_f32 v61, v61, v33
    v_mul_f32 v62, v62, v34
    v_mul_f32 v63, v63, v35
    v_cvt_pk_bf16_f32 v60, v60, v61
    v_cvt_pk_bf16_f32 v61, v62, v63
    ds_write_b64 v50, v[60:61] offset:0
    v_fmac_f32 v64, v28, v45
    v_fmac_f32 v65, v29, v45
    v_fmac_f32 v66, v30, v45
    v_fmac_f32 v67, v31, v45
    v_mul_f32 v64, v64, v32
    v_mul_f32 v65, v65, v33
    v_mul_f32 v66, v66, v34
    v_mul_f32 v67, v67, v35
    v_cvt_pk_bf16_f32 v64, v64, v65
    v_cvt_pk_bf16_f32 v65, v66, v67
    ds_write_b64 v50, v[64:65] offset:512
    v_fmac_f32 v68, v36, v44
    v_fmac_f32 v69, v37, v44
    v_fmac_f32 v70, v38, v44
    v_fmac_f32 v71, v39, v44
    v_mul_f32 v68, v68, v40
    v_mul_f32 v69, v69, v41
    v_mul_f32 v70, v70, v42
    v_mul_f32 v71, v71, v43
    v_cvt_pk_bf16_f32 v68, v68, v69
    v_cvt_pk_bf16_f32 v69, v70, v71
    ds_write_b64 v51, v[68:69] offset:0
    v_fmac_f32 v72, v36, v45
    v_fmac_f32 v73, v37, v45
    v_fmac_f32 v74, v38, v45
    v_fmac_f32 v75, v39, v45
    v_mul_f32 v72, v72, v40
    v_mul_f32 v73, v73, v41
    v_mul_f32 v74, v74, v42
    v_mul_f32 v75, v75, v43
    v_cvt_pk_bf16_f32 v72, v72, v73
    v_cvt_pk_bf16_f32 v73, v74, v75
    ds_write_b64 v51, v[72:73] offset:512
    v_mov_b32 v8, 157976
    v_mov_b32 v9, 1
    s_mov_b64 exec, 1
    ds_add_u32 v8, v9
    s_mov_b64 exec, -1
    s_waitcnt vmcnt(0)
Lrx_chk:
    v_and_b32 v52, s60, v52
    v_and_b32 v53, s60, v53
    v_and_b32 v54, s61, v54
    v_and_b32 v55, s61, v55
    v_max3_u32 v4, v52, v53, v54
    v_max_u32 v4, v4, v55
    v_cmp_eq_u32 vcc, -1, v4
    s_nop 3
    s_cbranch_vccnz Lrx_re
    v_add_f32 v92, v92, v52
    v_add_f32 v94, v94, v53
    v_add_f32 v104, v104, v54
    v_add_f32 v106, v106, v55
    s_setprio 2
    s_nop 0
Lcw_3:
    s_sub_u32 s39, s39, 1
    s_cbranch_scc1 Lend
    ds_read_b32 v9, v8
    s_waitcnt lgkmcnt(0)
    v_readfirstlane_b32 s42, v9
    s_nop 0
    s_cmp_lt_u32 s42, 7
    s_nop 1
    s_cbranch_scc1 Lcw_3
    ds_read2st64_b64 v[60:63], v125 offset0:0 offset1:4
    ds_read2st64_b64 v[64:67], v125 offset0:1 offset1:5
    ds_read2st64_b64 v[68:71], v125 offset0:2 offset1:6
    ds_read2st64_b64 v[72:75], v125 offset0:3 offset1:7
    v_mul_f32 v92, v92, v123
    v_mul_f32 v94, v94, v126
    v_mul_f32 v104, v104, v123
    v_mul_f32 v106, v106, v126
    v_max_f32 v4, v92, v94
    v_max_f32 v5, v104, v106
    v_mov_b32 v6, v4
    v_mov_b32 v7, v5
    s_nop 0
    v_permlane32_swap_b32 v4, v6
    v_permlane32_swap_b32 v5, v7
    v_max_f32 v4, v4, v6
    v_max_f32 v5, v5, v7
    s_waitcnt lgkmcnt(0)
    v_mov_b32 v6, v4
    v_mfma_f32_16x16x32_bf16 v[80:83], v[14:17], v[96:99], 0
    v_mov_b32 v7, v5
    v_permlane16_swap_b32 v4, v6
    s_nop 0
    v_permlane16_swap_b32 v5, v7
    v_max_f32 v4, v4, v6
    v_mfma_f32_16x16x32_bf16 v[84:87], v[14:17], v[100:103], 0
    v_max_f32 v5, v5, v7
    v_sub_f32 v92, v92, v4
    v_sub_f32 v94, v94, v4
    v_sub_f32 v104, v104, v5
    v_mfma_f32_16x16x32_bf16 v[28:31], v[60:63], v[96:99], 0
    v_sub_f32 v106, v106, v5
    v_exp_f32 v92, v92
    v_exp_f32 v94, v94
    v_exp_f32 v104, v104
    v_exp_f32 v106, v106
    v_mfma_f32_16x16x32_bf16 v[32:35], v[64:67], v[96:99], 0
    v_cvt_pk_bf16_f32 v92, v92, v92
    v_cvt_pk_bf16_f32 v93, v94, v94
    v_cvt_pk_bf16_f32 v104, v104, v104
    v_cvt_pk_bf16_f32 v105, v106, v106
    v_mfma_f32_16x16x32_bf16 v[36:39], v[68:71], v[100:103], 0
    v_and_b32 v94, v92, v118
    v_and_b32 v95, v93, v119
    v_and_b32 v92, v92, v116
    v_and_b32 v93, v93, v117
    v_mfma_f32_16x16x32_bf16 v[40:43], v[72:75], v[100:103], 0
    v_and_b32 v106, v104, v118
    v_and_b32 v107, v105, v119
    v_and_b32 v104, v104, v116
    v_and_b32 v105, v105, v117
    v_mfma_f32_16x16x32_bf16 v[76:79], v[14:17], v[92:95], 0
    v_rcp_f32 v80, v80
    v_rcp_f32 v84, v84
    v_mfma_f32_16x16x32_bf16 v[88:91], v[14:17], v[104:107], 0
    v_mul_f32 v28, v28, v80
    v_mul_f32 v29, v29, v80
    v_mfma_f32_16x16x32_bf16 v[44:47], v[64:67], v[92:95], 0
    v_mul_f32 v30, v30, v80
    v_mfma_f32_16x16x32_bf16 v[48:51], v[68:71], v[92:95], 0
    v_mul_f32 v31, v31, v80
    v_cvt_pk_bf16_f32 v4, v28, v29
    v_mfma_f32_16x16x32_bf16 v[52:55], v[64:67], v[104:107], 0
    v_cvt_pk_bf16_f32 v5, v30, v31
    v_min_u32 v4, -2, v4
    v_mfma_f32_16x16x32_bf16 v[56:59], v[68:71], v[104:107], 0
    v_min_u32 v5, -2, v5
    v_mul_f32 v40, v40, v84
    v_mul_f32 v41, v41, v84
    v_mul_f32 v42, v42, v84
    v_mul_f32 v43, v43, v84
    v_cvt_pk_bf16_f32 v10, v40, v41
    v_cvt_pk_bf16_f32 v11, v42, v43
    v_min_u32 v10, -2, v10
    v_min_u32 v11, -2, v11
    v_rcp_f32 v76, v76
    v_rcp_f32 v88, v88
    v_cndmask_b32 v82, v80, v76, s[6:7]
    v_cndmask_b32 v82, v82, v88, s[8:9]
    v_cndmask_b32 v32, v32, v44, s[6:7]
    v_cndmask_b32 v33, v33, v45, s[6:7]
    v_cndmask_b32 v34, v34, v46, s[6:7]
    v_cndmask_b32 v35, v35, v47, s[6:7]
    v_cndmask_b32 v32, v32, v52, s[8:9]
    v_cndmask_b32 v33, v33, v53, s[8:9]
    v_cndmask_b32 v34, v34, v54, s[8:9]
    v_cndmask_b32 v35, v35, v55, s[8:9]
    v_mul_f32 v32, v32, v82
    v_mul_f32 v33, v33, v82
    v_mul_f32 v34, v34, v82
    v_mul_f32 v35, v35, v82
    v_cvt_pk_bf16_f32 v6, v32, v33
    v_cvt_pk_bf16_f32 v7, v34, v35
    v_min_u32 v6, -2, v6
    v_min_u32 v7, -2, v7
    buffer_store_dwordx4 v[4:7], v13, s[28:31], s23 offen offset:0 sc1
    v_cndmask_b32 v86, v84, v76, s[12:13]
    v_cndmask_b32 v86, v86, v88, s[14:15]
    v_cndmask_b32 v36, v36, v48, s[12:13]
    v_cndmask_b32 v37, v37, v49, s[12:13]
    v_cndmask_b32 v38, v38, v50, s[12:13]
    v_cndmask_b32 v39, v39, v51, s[12:13]
    v_cndmask_b32 v36, v36, v56, s[14:15]
    v_cndmask_b32 v37, v37, v57, s[14:15]
    v_cndmask_b32 v38, v38, v58, s[14:15]
    v_cndmask_b32 v39, v39, v59, s[14:15]
    v_mul_f32 v36, v36, v86
    v_mul_f32 v37, v37, v86
    v_mul_f32 v38, v38, v86
    v_mul_f32 v39, v39, v86
    v_cvt_pk_bf16_f32 v8, v36, v37
    v_cvt_pk_bf16_f32 v9, v38, v39
    v_min_u32 v8, -2, v8
    v_min_u32 v9, -2, v9
    buffer_store_dwordx4 v[8:11], v13, s[28:31], s23 offen offset:1024 sc1
    s_setprio 0
    v_lshlrev_b32 v28, 16, v108
    v_and_b32 v29, 0xffff0000, v108
    v_lshlrev_b32 v30, 16, v109
    v_and_b32 v31, 0xffff0000, v109
    v_lshlrev_b32 v32, 16, v110
    v_and_b32 v33, 0xffff0000, v110
    v_lshlrev_b32 v34, 16, v111
    v_and_b32 v35, 0xffff0000, v111
    v_lshlrev_b32 v36, 16, v112
    v_and_b32 v37, 0xffff0000, v112
    v_lshlrev_b32 v38, 16, v113
    v_and_b32 v39, 0xffff0000, v113
    v_lshlrev_b32 v40, 16, v114
    v_and_b32 v41, 0xffff0000, v114
    v_lshlrev_b32 v42, 16, v115
    v_and_b32 v43, 0xffff0000, v115
    v_add_f32 v28, v28, v120
    v_add_f32 v29, v29, v120
    v_add_f32 v30, v30, v120
    v_add_f32 v31, v31, v120
    v_add_f32 v32, v32, v120
    v_add_f32 v33, v33, v120
    v_add_f32 v34, v34, v120
    v_add_f32 v35, v35, v120
    v_add_f32 v36, v36, v120
    v_add_f32 v37, v37, v120
    v_add_f32 v38, v38, v120
    v_add_f32 v39, v39, v120
    v_add_f32 v40, v40, v120
    v_add_f32 v41, v41, v120
    v_add_f32 v42, v42, v120
    v_add_f32 v43, v43, v120
    v_cvt_pk_bf16_f32 v29, v28, v29
    v_cvt_pk_bf16_f32 v31, v30, v31
    v_cvt_pk_bf16_f32 v33, v32, v33
    v_cvt_pk_bf16_f32 v35, v34, v35
    v_cvt_pk_bf16_f32 v37, v36, v37
    v_cvt_pk_bf16_f32 v39, v38, v39
    v_cvt_pk_bf16_f32 v41, v40, v41
    v_cvt_pk_bf16_f32 v43, v42, v43
    v_lshlrev_b32 v28, 16, v29
    v_and_b32 v29, 0xffff0000, v29
    v_lshlrev_b32 v30, 16, v31
    v_and_b32 v31, 0xffff0000, v31
    v_lshlrev_b32 v32, 16, v33
    v_and_b32 v33, 0xffff0000, v33
    v_lshlrev_b32 v34, 16, v35
    v_and_b32 v35, 0xffff0000, v35
    v_lshlrev_b32 v36, 16, v37
    v_and_b32 v37, 0xffff0000, v37
    v_lshlrev_b32 v38, 16, v39
    v_and_b32 v39, 0xffff0000, v39
    v_lshlrev_b32 v40, 16, v41
    v_and_b32 v41, 0xffff0000, v41
    v_lshlrev_b32 v42, 16, v43
    v_and_b32 v43, 0xffff0000, v43
    v_mul_f32 v28, v28, v121
    v_mul_f32 v29, v29, v121
    v_mul_f32 v30, v30, v121
    v_mul_f32 v31, v31, v121
    v_mul_f32 v32, v32, v121
    v_mul_f32 v33, v33, v121
    v_mul_f32 v34, v34, v121
    v_mul_f32 v35, v35, v121
    v_mul_f32 v36, v36, v121
    v_mul_f32 v37, v37, v121
    v_mul_f32 v38, v38, v121
    v_mul_f32 v39, v39, v121
    v_mul_f32 v40, v40, v121
    v_mul_f32 v41, v41, v121
    v_mul_f32 v42, v42, v121
    v_mul_f32 v43, v43, v121
    v_cvt_pk_bf16_f32 v29, v28, v29
    v_cvt_pk_bf16_f32 v31, v30, v31
    v_cvt_pk_bf16_f32 v33, v32, v33
    v_cvt_pk_bf16_f32 v35, v34, v35
    v_cvt_pk_bf16_f32 v37, v36, v37
    v_cvt_pk_bf16_f32 v39, v38, v39
    v_cvt_pk_bf16_f32 v41, v40, v41
    v_cvt_pk_bf16_f32 v43, v42, v43
    v_lshlrev_b32 v28, 16, v29
    v_and_b32 v29, 0xffff0000, v29
    v_lshlrev_b32 v30, 16, v31
    v_and_b32 v31, 0xffff0000, v31
    v_lshlrev_b32 v32, 16, v33
    v_and_b32 v33, 0xffff0000, v33
    v_lshlrev_b32 v34, 16, v35
    v_and_b32 v35, 0xffff0000, v35
    v_lshlrev_b32 v36, 16, v37
    v_and_b32 v37, 0xffff0000, v37
    v_lshlrev_b32 v38, 16, v39
    v_and_b32 v39, 0xffff0000, v39
    v_lshlrev_b32 v40, 16, v41
    v_and_b32 v41, 0xffff0000, v41
    v_lshlrev_b32 v42, 16, v43
    v_and_b32 v43, 0xffff0000, v43
    v_mul_f32 v44, 0xbfb8aa3b, v28
    v_mul_f32 v45, 0xbfb8aa3b, v29
    v_mul_f32 v46, 0xbfb8aa3b, v30
    v_mul_f32 v47, 0xbfb8aa3b, v31
    v_mul_f32 v48, 0xbfb8aa3b, v32
    v_mul_f32 v49, 0xbfb8aa3b, v33
    v_mul_f32 v50, 0xbfb8aa3b, v34
    v_mul_f32 v51, 0xbfb8aa3b, v35
    v_mul_f32 v52, 0xbfb8aa3b, v36
    v_mul_f32 v53, 0xbfb8aa3b, v37
    v_mul_f32 v54, 0xbfb8aa3b, v38
    v_mul_f32 v55, 0xbfb8aa3b, v39
    v_mul_f32 v56, 0xbfb8aa3b, v40
    v_mul_f32 v57, 0xbfb8aa3b, v41
    v_mul_f32 v58, 0xbfb8aa3b, v42
    v_mul_f32 v59, 0xbfb8aa3b, v43
    v_exp_f32 v44, v44
    v_exp_f32 v45, v45
    v_exp_f32 v46, v46
    v_exp_f32 v47, v47
    v_exp_f32 v48, v48
    v_exp_f32 v49, v49
    v_exp_f32 v50, v50
    v_exp_f32 v51, v51
    v_exp_f32 v52, v52
    v_exp_f32 v53, v53
    v_exp_f32 v54, v54
    v_exp_f32 v55, v55
    v_exp_f32 v56, v56
    v_exp_f32 v57, v57
    v_exp_f32 v58, v58
    v_exp_f32 v59, v59
    v_add_f32 v44, 1.0, v44
    v_add_f32 v45, 1.0, v45
    v_add_f32 v46, 1.0, v46
    v_add_f32 v47, 1.0, v47
    v_add_f32 v48, 1.0, v48
    v_add_f32 v49, 1.0, v49
    v_add_f32 v50, 1.0, v50
    v_add_f32 v51, 1.0, v51
    v_add_f32 v52, 1.0, v52
    v_add_f32 v53, 1.0, v53
    v_add_f32 v54, 1.0, v54
    v_add_f32 v55, 1.0, v55
    v_add_f32 v56, 1.0, v56
    v_add_f32 v57, 1.0, v57
    v_add_f32 v58, 1.0, v58
    v_add_f32 v59, 1.0, v59
    v_rcp_f32 v44, v44
    v_rcp_f32 v45, v45
    v_rcp_f32 v46, v46
    v_rcp_f32 v47, v47
    v_rcp_f32 v48, v48
    v_rcp_f32 v49, v49
    v_rcp_f32 v50, v50
    v_rcp_f32 v51, v51
    v_rcp_f32 v52, v52
    v_rcp_f32 v53, v53
    v_rcp_f32 v54, v54
    v_rcp_f32 v55, v55
    v_rcp_f32 v56, v56
    v_rcp_f32 v57, v57
    v_rcp_f32 v58, v58
    v_rcp_f32 v59, v59
    v_mul_f32 v44, v44, v28
    v_mul_f32 v45, v45, v29
    v_mul_f32 v46, v46, v30
    v_mul_f32 v47, v47, v31
    v_mul_f32 v48, v48, v32
    v_mul_f32 v49, v49, v33
    v_mul_f32 v50, v50, v34
    v_mul_f32 v51, v51, v35
    v_mul_f32 v52, v52, v36
    v_mul_f32 v53, v53, v37
    v_mul_f32 v54, v54, v38
    v_mul_f32 v55, v55, v39
    v_mul_f32 v56, v56, v40
    v_mul_f32 v57, v57, v41
    v_mul_f32 v58, v58, v42
    v_mul_f32 v59, v59, v43
    v_cvt_pk_bf16_f32 v45, v44, v45
    v_cvt_pk_bf16_f32 v47, v46, v47
    v_cvt_pk_bf16_f32 v49, v48, v49
    v_cvt_pk_bf16_f32 v51, v50, v51
    v_cvt_pk_bf16_f32 v53, v52, v53
    v_cvt_pk_bf16_f32 v55, v54, v55
    v_cvt_pk_bf16_f32 v57, v56, v57
    v_cvt_pk_bf16_f32 v59, v58, v59
    v_accvgpr_write_b32 a0, v45
    v_accvgpr_write_b32 a1, v47
    v_accvgpr_write_b32 a2, v49
    v_accvgpr_write_b32 a3, v51
    v_accvgpr_write_b32 a4, v53
    v_accvgpr_write_b32 a5, v55
    v_accvgpr_write_b32 a6, v57
    v_accvgpr_write_b32 a7, v59
    v_accvgpr_write_b32 a8, v108
    v_accvgpr_write_b32 a9, v109
    v_accvgpr_write_b32 a10, v110
    v_accvgpr_write_b32 a11, v111
    v_accvgpr_write_b32 a12, v112
    v_accvgpr_write_b32 a13, v113
    v_accvgpr_write_b32 a14, v114
    v_accvgpr_write_b32 a15, v115
    v_and_b32 v6, 3, v1
    v_lshl_add_u32 v6, v6, 3, v19
    v_add_u32 v20, v6, v18
    v_xor_b32 v21, 32, v20
    v_xor_b32 v22, 64, v20
    v_xor_b32 v23, 96, v20
    v_add_u32 v24, 63616, v20
    v_add_u32 v25, 63616, v21
    v_add_u32 v26, 63616, v22
    v_add_u32 v27, 63616, v23
    v_mov_b32 v10, 157960
    ds_read_b64 v[8:9], v10
    s_mov_b32 s45, 0
Lld_0:
    buffer_load_dwordx4 v[28:31], v13, s[28:31], s52 offen offset:0 sc1
    buffer_load_dwordx4 v[32:35], v13, s[28:31], s52 offen offset:1024 sc1
Lld_1:
    buffer_load_dwordx4 v[36:39], v13, s[28:31], s52 offen offset:2048 sc1
    buffer_load_dwordx4 v[40:43], v13, s[28:31], s52 offen offset:3072 sc1
Lld_2:
    buffer_load_dwordx4 v[44:47], v13, s[28:31], s53 offen offset:0 sc1
    buffer_load_dwordx4 v[48:51], v13, s[28:31], s53 offen offset:1024 sc1
Lld_3:
    buffer_load_dwordx4 v[52:55], v13, s[28:31], s53 offen offset:2048 sc1
    buffer_load_dwordx4 v[56:59], v13, s[28:31], s53 offen offset:3072 sc1
Lld_4:
    buffer_load_dwordx4 v[60:63], v13, s[28:31], s54 offen offset:0 sc1
    buffer_load_dwordx4 v[64:67], v13, s[28:31], s54 offen offset:1024 sc1
Lld_5:
    buffer_load_dwordx4 v[68:71], v13, s[28:31], s54 offen offset:2048 sc1
    buffer_load_dwordx4 v[72:75], v13, s[28:31], s54 offen offset:3072 sc1
Lld_6:
    buffer_load_dwordx4 v[76:79], v13, s[28:31], s55 offen offset:0 sc1
    buffer_load_dwordx4 v[80:83], v13, s[28:31], s55 offen offset:1024 sc1
Lld_7:
    buffer_load_dwordx4 v[84:87], v13, s[28:31], s55 offen offset:2048 sc1
    buffer_load_dwordx4 v[88:91], v13, s[28:31], s55 offen offset:3072 sc1
Lld_8:
    buffer_load_dwordx4 v[92:95], v13, s[28:31], s56 offen offset:0 sc1
    buffer_load_dwordx4 v[96:99], v13, s[28:31], s56 offen offset:1024 sc1
Lld_9:
    buffer_load_dwordx4 v[100:103], v13, s[28:31], s56 offen offset:2048 sc1
    buffer_load_dwordx4 v[104:107], v13, s[28:31], s56 offen offset:3072 sc1
    s_cmp_lg_u32 s45, 0
    s_cbranch_scc1 Ldisp
    s_waitcnt lgkmcnt(0)
Linfo:
    v_readfirstlane_b32 s43, v8
    s_nop 0
    s_cmp_eq_u32 s43, -2
    s_nop 1
    s_cbranch_scc1 Linfo_re
    ds_read_b64_tr_b16 a[16:17], v20 offset:0
    ds_read_b64_tr_b16 a[18:19], v20 offset:512
    ds_read_b64_tr_b16 a[20:21], v21 offset:0
    ds_read_b64_tr_b16 a[22:23], v21 offset:512
    ds_read_b64_tr_b16 a[24:25], v22 offset:0
    ds_read_b64_tr_b16 a[26:27], v22 offset:512
    ds_read_b64_tr_b16 a[28:29], v23 offset:0
    ds_read_b64_tr_b16 a[30:31], v23 offset:512
    ds_read_b64_tr_b16 a[32:33], v20 offset:4096
    ds_read_b64_tr_b16 a[34:35], v20 offset:4608
    ds_read_b64_tr_b16 a[36:37], v21 offset:4096
    ds_read_b64_tr_b16 a[38:39], v21 offset:4608
    ds_read_b64_tr_b16 a[40:41], v22 offset:4096
    ds_read_b64_tr_b16 a[42:43], v22 offset:4608
    ds_read_b64_tr_b16 a[44:45], v23 offset:4096
    ds_read_b64_tr_b16 a[46:47], v23 offset:4608
    ds_read_b64_tr_b16 a[48:49], v20 offset:8192
    ds_read_b64_tr_b16 a[50:51], v20 offset:8704
    ds_read_b64_tr_b16 a[52:53], v21 offset:8192
    ds_read_b64_tr_b16 a[54:55], v21 offset:8704
    ds_read_b64_tr_b16 a[56:57], v22 offset:8192
    ds_read_b64_tr_b16 a[58:59], v22 offset:8704
    ds_read_b64_tr_b16 a[60:61], v23 offset:8192
    ds_read_b64_tr_b16 a[62:63], v23 offset:8704
    ds_read_b64_tr_b16 a[64:65], v20 offset:12288
    ds_read_b64_tr_b16 a[66:67], v20 offset:12800
    ds_read_b64_tr_b16 a[68:69], v21 offset:12288
    ds_read_b64_tr_b16 a[70:71], v21 offset:12800
    ds_read_b64_tr_b16 a[72:73], v22 offset:12288
    ds_read_b64_tr_b16 a[74:75], v22 offset:12800
    ds_read_b64_tr_b16 a[76:77], v23 offset:12288
    ds_read_b64_tr_b16 a[78:79], v23 offset:12800
    ds_read_b64_tr_b16 a[80:81], v20 offset:24576
    ds_read_b64_tr_b16 a[82:83], v20 offset:25088
    ds_read_b64_tr_b16 a[84:85], v21 offset:24576
    ds_read_b64_tr_b16 a[86:87], v21 offset:25088
    ds_read_b64_tr_b16 a[88:89], v22 offset:24576
    ds_read_b64_tr_b16 a[90:91], v22 offset:25088
    ds_read_b64_tr_b16 a[92:93], v23 offset:24576
    ds_read_b64_tr_b16 a[94:95], v23 offset:25088
    ds_read_b64_tr_b16 a[96:97], v20 offset:28672
    ds_read_b64_tr_b16 a[98:99], v20 offset:29184
    ds_read_b64_tr_b16 a[100:101], v21 offset:28672
    ds_read_b64_tr_b16 a[102:103], v21 offset:29184
    ds_read_b64_tr_b16 a[104:105], v22 offset:28672
    ds_read_b64_tr_b16 a[106:107], v22 offset:29184
    ds_read_b64_tr_b16 a[108:109], v23 offset:28672
    ds_read_b64_tr_b16 a[110:111], v23 offset:29184
    ds_read_b64_tr_b16 a[112:113], v24 offset:59520
    ds_read_b64_tr_b16 a[114:115], v24 offset:60032
    ds_read_b64_tr_b16 a[116:117], v25 offset:59520
    ds_read_b64_tr_b16 a[118:119], v25 offset:60032
    ds_read_b64_tr_b16 a[120:121], v26 offset:59520
    ds_read_b64_tr_b16 a[122:123], v26 offset:60032
    ds_read_b64_tr_b16 a[124:125], v27 offset:59520
    ds_read_b64_tr_b16 a[126:127], v27 offset:60032
Lchk_0:
    s_waitcnt vmcnt(18)
    v_max3_u32 v4, v28, v29, v30
    v_max3_u32 v5, v32, v33, v34
    v_max3_u32 v4, v4, v31, v35
    v_max_u32 v4, v4, v5
    v_cmp_eq_u32 vcc, -1, v4
    s_nop 3
    s_cbranch_vccnz Lre_0
    s_waitcnt lgkmcnt(15)
    v_mfma_f32_16x16x32_bf16 v[108:111], a[16:19], v[28:31], 0
    v_mfma_f32_16x16x32_bf16 v[112:115], a[20:23], v[28:31], 0
    v_mfma_f32_16x16x32_bf16 v[116:119], a[24:27], v[28:31], 0
    v_mfma_f32_16x16x32_bf16 v[14:17], a[28:31], v[28:31], 0
    ds_read_b64_tr_b16 a[16:17], v24 offset:63616
    ds_read_b64_tr_b16 a[18:19], v24 offset:64128
    ds_read_b64_tr_b16 a[20:21], v25 offset:63616
    ds_read_b64_tr_b16 a[22:23], v25 offset:64128
    ds_read_b64_tr_b16 a[24:25], v26 offset:63616
    ds_read_b64_tr_b16 a[26:27], v26 offset:64128
    ds_read_b64_tr_b16 a[28:29], v27 offset:63616
    ds_read_b64_tr_b16 a[30:31], v27 offset:64128
    v_mfma_f32_16x16x32_bf16 v[108:111], a[32:35], v[32:35], v[108:111]
    v_mfma_f32_16x16x32_bf16 v[112:115], a[36:39], v[32:35], v[112:115]
    v_mfma_f32_16x16x32_bf16 v[116:119], a[40:43], v[32:35], v[116:119]
    v_mfma_f32_16x16x32_bf16 v[14:17], a[44:47], v[32:35], v[14:17]
    ds_read_b64_tr_b16 a[32:33], v24 offset:16384
    ds_read_b64_tr_b16 a[34:35], v24 offset:16896
    ds_read_b64_tr_b16 a[36:37], v25 offset:16384
    ds_read_b64_tr_b16 a[38:39], v25 offset:16896
    ds_read_b64_tr_b16 a[40:41], v26 offset:16384
    ds_read_b64_tr_b16 a[42:43], v26 offset:16896
    ds_read_b64_tr_b16 a[44:45], v27 offset:16384
    ds_read_b64_tr_b16 a[46:47], v27 offset:16896
Lchk_1:
    s_waitcnt vmcnt(16)
    v_max3_u32 v4, v36, v37, v38
    v_max3_u32 v5, v40, v41, v42
    v_max3_u32 v4, v4, v39, v43
    v_max_u32 v4, v4, v5
    v_cmp_eq_u32 vcc, -1, v4
    s_nop 3
    s_cbranch_vccnz Lre_1
    v_mfma_f32_16x16x32_bf16 v[108:111], a[48:51], v[36:39], v[108:111]
    v_mfma_f32_16x16x32_bf16 v[112:115], a[52:55], v[36:39], v[112:115]
    v_mfma_f32_16x16x32_bf16 v[116:119], a[56:59], v[36:39], v[116:119]
    v_mfma_f32_16x16x32_bf16 v[14:17], a[60:63], v[36:39], v[14:17]
    ds_read_b64_tr_b16 a[48:49], v24 offset:20480
    ds_read_b64_tr_b16 a[50:51], v24 offset:20992
    ds_read_b64_tr_b16 a[52:53], v25 offset:20480
    ds_read_b64_tr_b16 a[54:55], v25 offset:20992
    ds_read_b64_tr_b16 a[56:57], v26 offset:20480
    ds_read_b64_tr_b16 a[58:59], v26 offset:20992
    ds_read_b64_tr_b16 a[60:61], v27 offset:20480
    ds_read_b64_tr_b16 a[62:63], v27 offset:20992
    v_mfma_f32_16x16x32_bf16 v[108:111], a[64:67], v[40:43], v[108:111]
    v_mfma_f32_16x16x32_bf16 v[112:115], a[68:71], v[40:43], v[112:115]
    v_mfma_f32_16x16x32_bf16 v[116:119], a[72:75], v[40:43], v[116:119]
    v_mfma_f32_16x16x32_bf16 v[14:17], a[76:79], v[40:43], v[14:17]
    ds_read_b64_tr_b16 a[64:65], v20 offset:32768
    ds_read_b64_tr_b16 a[66:67], v20 offset:33280
    ds_read_b64_tr_b16 a[68:69], v21 offset:32768
    ds_read_b64_tr_b16 a[70:71], v21 offset:33280
    ds_read_b64_tr_b16 a[72:73], v22 offset:32768
    ds_read_b64_tr_b16 a[74:75], v22 offset:33280
    ds_read_b64_tr_b16 a[76:77], v23 offset:32768
    ds_read_b64_tr_b16 a[78:79], v23 offset:33280
Lchk_2:
    s_waitcnt vmcnt(14)
    v_max3_u32 v4, v44, v45, v46
    v_max3_u32 v5, v48, v49, v50
    v_max3_u32 v4, v4, v47, v51
    v_max_u32 v4, v4, v5
    v_cmp_eq_u32 vcc, -1, v4
    s_nop 3
    s_cbranch_vccnz Lre_2
    v_mfma_f32_16x16x32_bf16 v[108:111], a[80:83], v[44:47], v[108:111]
    v_mfma_f32_16x16x32_bf16 v[112:115], a[84:87], v[44:47], v[112:115]
    v_mfma_f32_16x16x32_bf16 v[116:119], a[88:91], v[44:47], v[116:119]
    v_mfma_f32_16x16x32_bf16 v[14:17], a[92:95], v[44:47], v[14:17]
    ds_read_b64_tr_b16 a[80:81], v20 offset:36864
    ds_read_b64_tr_b16 a[82:83], v20 offset:37376
    ds_read_b64_tr_b16 a[84:85], v21 offset:36864
    ds_read_b64_tr_b16 a[86:87], v21 offset:37376
    ds_read_b64_tr_b16 a[88:89], v22 offset:36864
    ds_read_b64_tr_b16 a[90:91], v22 offset:37376
    ds_read_b64_tr_b16 a[92:93], v23 offset:36864
    ds_read_b64_tr_b16 a[94:95], v23 offset:37376
    s_waitcnt lgkmcnt(15)
    v_mfma_f32_16x16x32_bf16 v[108:111], a[96:99], v[48:51], v[108:111]
    v_mfma_f32_16x16x32_bf16 v[112:115], a[100:103], v[48:51], v[112:115]
    v_mfma_f32_16x16x32_bf16 v[116:119], a[104:107], v[48:51], v[116:119]
    v_mfma_f32_16x16x32_bf16 v[14:17], a[108:111], v[48:51], v[14:17]
    ds_read_b64_tr_b16 a[96:97], v20 offset:40960
    ds_read_b64_tr_b16 a[98:99], v20 offset:41472
    ds_read_b64_tr_b16 a[100:101], v21 offset:40960
    ds_read_b64_tr_b16 a[102:103], v21 offset:41472
    ds_read_b64_tr_b16 a[104:105], v22 offset:40960
    ds_read_b64_tr_b16 a[106:107], v22 offset:41472
    ds_read_b64_tr_b16 a[108:109], v23 offset:40960
    ds_read_b64_tr_b16 a[110:111], v23 offset:41472
Lchk_3:
    s_waitcnt vmcnt(12)
    v_max3_u32 v4, v52, v53, v54
    v_max3_u32 v5, v56, v57, v58
    v_max3_u32 v4, v4, v55, v59
    v_max_u32 v4, v4, v5
    v_cmp_eq_u32 vcc, -1, v4
    s_nop 3
    s_cbranch_vccnz Lre_3
    v_mfma_f32_16x16x32_bf16 v[108:111], a[112:115], v[52:55], v[108:111]
    v_mfma_f32_16x16x32_bf16 v[112:115], a[116:119], v[52:55], v[112:115]
    v_mfma_f32_16x16x32_bf16 v[116:119], a[120:123], v[52:55], v[116:119]
    v_mfma_f32_16x16x32_bf16 v[14:17], a[124:127], v[52:55], v[14:17]
    ds_read_b64_tr_b16 a[112:113], v20 offset:45056
    ds_read_b64_tr_b16 a[114:115], v20 offset:45568
    ds_read_b64_tr_b16 a[116:117], v21 offset:45056
    ds_read_b64_tr_b16 a[118:119], v21 offset:45568
    ds_read_b64_tr_b16 a[120:121], v22 offset:45056
    ds_read_b64_tr_b16 a[122:123], v22 offset:45568
    ds_read_b64_tr_b16 a[124:125], v23 offset:45056
    ds_read_b64_tr_b16 a[126:127], v23 offset:45568
    v_mfma_f32_16x16x32_bf16 v[108:111], a[16:19], v[56:59], v[108:111]
    v_mfma_f32_16x16x32_bf16 v[112:115], a[20:23], v[56:59], v[112:115]
    v_mfma_f32_16x16x32_bf16 v[116:119], a[24:27], v[56:59], v[116:119]
    v_mfma_f32_16x16x32_bf16 v[14:17], a[28:31], v[56:59], v[14:17]
    ds_read_b64_tr_b16 a[16:17], v24 offset:0
    ds_read_b64_tr_b16 a[18:19], v24 offset:512
    ds_read_b64_tr_b16 a[20:21], v25 offset:0
    ds_read_b64_tr_b16 a[22:23], v25 offset:512
    ds_read_b64_tr_b16 a[24:25], v26 offset:0
    ds_read_b64_tr_b16 a[26:27], v26 offset:512
    ds_read_b64_tr_b16 a[28:29], v27 offset:0
    ds_read_b64_tr_b16 a[30:31], v27 offset:512
Lchk_4:
    s_waitcnt vmcnt(10)
    v_max3_u32 v4, v60, v61, v62
    v_max3_u32 v5, v64, v65, v66
    v_max3_u32 v4, v4, v63, v67
    v_max_u32 v4, v4, v5
    v_cmp_eq_u32 vcc, -1, v4
    s_nop 3
    s_cbranch_vccnz Lre_4
    v_mfma_f32_16x16x32_bf16 v[108:111], a[32:35], v[60:63], v[108:111]
    v_mfma_f32_16x16x32_bf16 v[112:115], a[36:39], v[60:63], v[112:115]
    v_mfma_f32_16x16x32_bf16 v[116:119], a[40:43], v[60:63], v[116:119]
    v_mfma_f32_16x16x32_bf16 v[14:17], a[44:47], v[60:63], v[14:17]
    ds_read_b64_tr_b16 a[32:33], v24 offset:4096
    ds_read_b64_tr_b16 a[34:35], v24 offset:4608
    ds_read_b64_tr_b16 a[36:37], v25 offset:4096
    ds_read_b64_tr_b16 a[38:39], v25 offset:4608
    ds_read_b64_tr_b16 a[40:41], v26 offset:4096
    ds_read_b64_tr_b16 a[42:43], v26 offset:4608
    ds_read_b64_tr_b16 a[44:45], v27 offset:4096
    ds_read_b64_tr_b16 a[46:47], v27 offset:4608
    v_mfma_f32_16x16x32_bf16 v[108:111], a[48:51], v[64:67], v[108:111]
    v_mfma_f32_16x16x32_bf16 v[112:115], a[52:55], v[64:67], v[112:115]
    v_mfma_f32_16x16x32_bf16 v[116:119], a[56:59], v[64:67], v[116:119]
    v_mfma_f32_16x16x32_bf16 v[14:17], a[60:63], v[64:67], v[14:17]
    ds_read_b64_tr_b16 a[48:49], v24 offset:8192
    ds_read_b64_tr_b16 a[50:51], v24 offset:8704
    ds_read_b64_tr_b16 a[52:53], v25 offset:8192
    ds_read_b64_tr_b16 a[54:55], v25 offset:8704
    ds_read_b64_tr_b16 a[56:57], v26 offset:8192
    ds_read_b64_tr_b16 a[58:59], v26 offset:8704
    ds_read_b64_tr_b16 a[60:61], v27 offset:8192
    ds_read_b64_tr_b16 a[62:63], v27 offset:8704
Lchk_5:
    s_waitcnt vmcnt(8)
    v_max3_u32 v4, v68, v69, v70
    v_max3_u32 v5, v72, v73, v74
    v_max3_u32 v4, v4, v71, v75
    v_max_u32 v4, v4, v5
    v_cmp_eq_u32 vcc, -1, v4
    s_nop 3
    s_cbranch_vccnz Lre_5
    s_waitcnt lgkmcnt(15)
    v_mfma_f32_16x16x32_bf16 v[108:111], a[64:67], v[68:71], v[108:111]
    v_mfma_f32_16x16x32_bf16 v[112:115], a[68:71], v[68:71], v[112:115]
    v_mfma_f32_16x16x32_bf16 v[116:119], a[72:75], v[68:71], v[116:119]
    v_mfma_f32_16x16x32_bf16 v[14:17], a[76:79], v[68:71], v[14:17]
    ds_read_b64_tr_b16 a[64:65], v24 offset:12288
    ds_read_b64_tr_b16 a[66:67], v24 offset:12800
    ds_read_b64_tr_b16 a[68:69], v25 offset:12288
    ds_read_b64_tr_b16 a[70:71], v25 offset:12800
    ds_read_b64_tr_b16 a[72:73], v26 offset:12288
    ds_read_b64_tr_b16 a[74:75], v26 offset:12800
    ds_read_b64_tr_b16 a[76:77], v27 offset:12288
    ds_read_b64_tr_b16 a[78:79], v27 offset:12800
    v_mfma_f32_16x16x32_bf16 v[108:111], a[80:83], v[72:75], v[108:111]
    v_mfma_f32_16x16x32_bf16 v[112:115], a[84:87], v[72:75], v[112:115]
    v_mfma_f32_16x16x32_bf16 v[116:119], a[88:91], v[72:75], v[116:119]
    v_mfma_f32_16x16x32_bf16 v[14:17], a[92:95], v[72:75], v[14:17]
    ds_read_b64_tr_b16 a[80:81], v20 offset:49152
    ds_read_b64_tr_b16 a[82:83], v20 offset:49664
    ds_read_b64_tr_b16 a[84:85], v21 offset:49152
    ds_read_b64_tr_b16 a[86:87], v21 offset:49664
    ds_read_b64_tr_b16 a[88:89], v22 offset:49152
    ds_read_b64_tr_b16 a[90:91], v22 offset:49664
    ds_read_b64_tr_b16 a[92:93], v23 offset:49152
    ds_read_b64_tr_b16 a[94:95], v23 offset:49664
Lchk_6:
    s_waitcnt vmcnt(6)
    v_max3_u32 v4, v76, v77, v78
    v_max3_u32 v5, v80, v81, v82
    v_max3_u32 v4, v4, v79, v83
    v_max_u32 v4, v4, v5
    v_cmp_eq_u32 vcc, -1, v4
    s_nop 3
    s_cbranch_vccnz Lre_6
    v_mfma_f32_16x16x32_bf16 v[108:111], a[96:99], v[76:79], v[108:111]
    v_accvgpr_read_b32 v45, a0
    v_accvgpr_read_b32 v29, a8
    v_mfma_f32_16x16x32_bf16 v[112:115], a[100:103], v[76:79], v[112:115]
    v_accvgpr_read_b32 v47, a1
    v_accvgpr_read_b32 v31, a9
    v_mfma_f32_16x16x32_bf16 v[116:119], a[104:107], v[76:79], v[116:119]
    v_accvgpr_read_b32 v49, a2
    v_accvgpr_read_b32 v33, a10
    v_mfma_f32_16x16x32_bf16 v[14:17], a[108:111], v[76:79], v[14:17]
    v_accvgpr_read_b32 v51, a3
    v_accvgpr_read_b32 v35, a11
    ds_read_b64_tr_b16 a[96:97], v24 offset:24576
    ds_read_b64_tr_b16 a[98:99], v24 offset:25088
    ds_read_b64_tr_b16 a[100:101], v25 offset:24576
    ds_read_b64_tr_b16 a[102:103], v25 offset:25088
    ds_read_b64_tr_b16 a[104:105], v26 offset:24576
    ds_read_b64_tr_b16 a[106:107], v26 offset:25088
    ds_read_b64_tr_b16 a[108:109], v27 offset:24576
    ds_read_b64_tr_b16 a[110:111], v27 offset:25088
    v_mfma_f32_16x16x32_bf16 v[108:111], a[112:115], v[80:83], v[108:111]
    v_accvgpr_read_b32 v53, a4
    v_accvgpr_read_b32 v37, a12
    v_mfma_f32_16x16x32_bf16 v[112:115], a[116:119], v[80:83], v[112:115]
    v_accvgpr_read_b32 v55, a5
    v_accvgpr_read_b32 v39, a13
    v_mfma_f32_16x16x32_bf16 v[116:119], a[120:123], v[80:83], v[116:119]
    v_accvgpr_read_b32 v57, a6
    v_accvgpr_read_b32 v41, a14
    v_mfma_f32_16x16x32_bf16 v[14:17], a[124:127], v[80:83], v[14:17]
    v_accvgpr_read_b32 v59, a7
    v_accvgpr_read_b32 v43, a15
    s_nop 5
Lchk_7:
    s_waitcnt vmcnt(4)
    v_max3_u32 v4, v84, v85, v86
    v_max3_u32 v5, v88, v89, v90
    v_max3_u32 v4, v4, v87, v91
    v_max_u32 v4, v4, v5
    v_cmp_eq_u32 vcc, -1, v4
    s_nop 3
    s_cbranch_vccnz Lre_7
    v_mfma_f32_16x16x32_bf16 v[108:111], a[16:19], v[84:87], v[108:111]
    v_lshlrev_b32 v44, 16, v45
    v_and_b32 v45, 0xffff0000, v45
    v_lshlrev_b32 v46, 16, v47
    v_mfma_f32_16x16x32_bf16 v[112:115], a[20:23], v[84:87], v[112:115]
    v_and_b32 v47, 0xffff0000, v47
    v_lshlrev_b32 v48, 16, v49
    v_and_b32 v49, 0xffff0000, v49
    v_mfma_f32_16x16x32_bf16 v[116:119], a[24:27], v[84:87], v[116:119]
    v_lshlrev_b32 v50, 16, v51
    v_and_b32 v51, 0xffff0000, v51
    v_lshlrev_b32 v52, 16, v53
    v_mfma_f32_16x16x32_bf16 v[14:17], a[28:31], v[84:87], v[14:17]
    v_and_b32 v53, 0xffff0000, v53
    v_lshlrev_b32 v54, 16, v55
    v_and_b32 v55, 0xffff0000, v55
    s_waitcnt lgkmcnt(15)
    v_mfma_f32_16x16x32_bf16 v[108:111], a[32:35], v[88:91], v[108:111]
    v_lshlrev_b32 v56, 16, v57
    v_and_b32 v57, 0xffff0000, v57
    v_lshlrev_b32 v58, 16, v59
    v_mfma_f32_16x16x32_bf16 v[112:115], a[36:39], v[88:91], v[112:115]
    v_and_b32 v59, 0xffff0000, v59
    v_lshlrev_b32 v28, 16, v29
    v_and_b32 v29, 0xffff0000, v29
    v_mfma_f32_16x16x32_bf16 v[116:119], a[40:43], v[88:91], v[116:119]
    v_lshlrev_b32 v30, 16, v31
    v_and_b32 v31, 0xffff0000, v31
    v_lshlrev_b32 v32, 16, v33
    v_mfma_f32_16x16x32_bf16 v[14:17], a[44:47], v[88:91], v[14:17]
    v_and_b32 v33, 0xffff0000, v33
    v_lshlrev_b32 v34, 16, v35
    v_and_b32 v35, 0xffff0000, v35
    s_nop 4
Lchk_8:
    s_waitcnt vmcnt(2)
    v_max3_u32 v4, v92, v93, v94
    v_max3_u32 v5, v96, v97, v98
    v_max3_u32 v4, v4, v95, v99
    v_max_u32 v4, v4, v5
    v_cmp_eq_u32 vcc, -1, v4
    s_nop 3
    s_cbranch_vccnz Lre_8
    v_mfma_f32_16x16x32_bf16 v[108:111], a[48:51], v[92:95], v[108:111]
    v_lshlrev_b32 v36, 16, v37
    v_and_b32 v37, 0xffff0000, v37
    v_lshlrev_b32 v38, 16, v39
    v_and_b32 v39, 0xffff0000, v39
    v_mfma_f32_16x16x32_bf16 v[112:115], a[52:55], v[92:95], v[112:115]
    v_lshlrev_b32 v40, 16, v41
    v_and_b32 v41, 0xffff0000, v41
    v_lshlrev_b32 v42, 16, v43
    v_mfma_f32_16x16x32_bf16 v[116:119], a[56:59], v[92:95], v[116:119]
    v_and_b32 v43, 0xffff0000, v43
    s_mul_i32 s40, s36, 96
    s_lshl_b32 s41, s46, 4
    s_add_u32 s40, s40, s41
    v_mfma_f32_16x16x32_bf16 v[14:17], a[60:63], v[92:95], v[14:17]
    s_sub_u32 s40, s40, 32
    v_add_u32 v62, s40, v3
    v_lshrrev_b32 v6, 3, v1
    v_mfma_f32_16x16x32_bf16 v[108:111], a[64:67], v[96:99], v[108:111]
    v_add_u32 v6, s40, v6
    v_mul_u32_u24 v6, 1280, v6
    v_and_b32 v7, 7, v1
    v_xor_b32 v7, v7, v2
    v_mfma_f32_16x16x32_bf16 v[112:115], a[68:71], v[96:99], v[112:115]
    v_lshl_add_u32 v60, v7, 4, v6
    v_xor_b32 v61, 64, v60
    v_add_u32 v61, 10240, v61
    s_lshl_b32 s40, s46, 11
    v_mfma_f32_16x16x32_bf16 v[116:119], a[72:75], v[96:99], v[116:119]
    s_add_u32 s40, s40, 102656
    v_add_u32 v64, s40, v124
    v_xor_b32 v65, 32, v64
    v_xor_b32 v66, 64, v64
    v_mfma_f32_16x16x32_bf16 v[14:17], a[76:79], v[96:99], v[14:17]
    v_xor_b32 v67, 0x60, v64
    v_add_u32 v63, s40, v13
    s_lshl_b32 s24, s37, 7
    s_nop 4
Lchk_9:
    s_waitcnt vmcnt(0)
    v_max3_u32 v4, v100, v101, v102
    v_max3_u32 v5, v104, v105, v106
    v_max3_u32 v4, v4, v103, v107
    v_max_u32 v4, v4, v5
    v_cmp_eq_u32 vcc, -1, v4
    s_nop 3
    s_cbranch_vccnz Lre_9
    s_waitcnt lgkmcnt(8)
    v_mfma_f32_16x16x32_bf16 v[108:111], a[80:83], v[100:103], v[108:111]
    v_mfma_f32_16x16x32_bf16 v[112:115], a[84:87], v[100:103], v[112:115]
    v_mfma_f32_16x16x32_bf16 v[116:119], a[88:91], v[100:103], v[116:119]
    v_mfma_f32_16x16x32_bf16 v[14:17], a[92:95], v[100:103], v[14:17]
    s_waitcnt lgkmcnt(0)
    v_mfma_f32_16x16x32_bf16 v[108:111], a[96:99], v[104:107], v[108:111]
    v_mfma_f32_16x16x32_bf16 v[112:115], a[100:103], v[104:107], v[112:115]
    v_mfma_f32_16x16x32_bf16 v[116:119], a[104:107], v[104:107], v[116:119]
    v_mfma_f32_16x16x32_bf16 v[14:17], a[108:111], v[104:107], v[14:17]
    v_and_b32 v6, v8, v9
    s_nop 0
    v_readfirstlane_b32 s43, v6
    s_nop 0
    s_cmp_eq_u32 s43, -1
    s_nop 1
    s_cbranch_scc0 Lfix
Lnofix:
    v_fma_f32 v108, v108, v44, v28
    v_fma_f32 v109, v109, v45, v29
    v_fma_f32 v110, v110, v46, v30
    v_fma_f32 v111, v111, v47, v31
    v_cvt_pk_bf16_f32 v68, v108, v109
    v_cvt_pk_bf16_f32 v69, v110, v111
    ds_write_b64 v64, v[68:69]
    v_fma_f32 v112, v112, v48, v32
    v_fma_f32 v113, v113, v49, v33
    v_fma_f32 v114, v114, v50, v34
    v_fma_f32 v115, v115, v51, v35
    v_cvt_pk_bf16_f32 v70, v112, v113
    v_cvt_pk_bf16_f32 v71, v114, v115
    ds_write_b64 v65, v[70:71]
    v_fma_f32 v116, v116, v52, v36
    v_fma_f32 v117, v117, v53, v37
    v_fma_f32 v118, v118, v54, v38
    v_fma_f32 v119, v119, v55, v39
    v_cvt_pk_bf16_f32 v72, v116, v117
    v_cvt_pk_bf16_f32 v73, v118, v119
    ds_write_b64 v66, v[72:73]
    v_fma_f32 v14, v14, v56, v40
    v_fma_f32 v15, v15, v57, v41
    v_fma_f32 v16, v16, v58, v42
    v_fma_f32 v17, v17, v59, v43
    v_cvt_pk_bf16_f32 v74, v14, v15
    v_cvt_pk_bf16_f32 v75, v16, v17
    ds_write_b64 v67, v[74:75]
    ds_read_b128 v[76:79], v63 offset:0
    ds_read_b128 v[80:83], v63 offset:1024
    s_waitcnt lgkmcnt(1)
    buffer_store_dwordx4 v[76:79], v60, s[48:51], s24 offen
    s_waitcnt lgkmcnt(0)
    buffer_store_dwordx4 v[80:83], v61, s[48:51], s24 offen
    s_nop 0
    s_endpgm
Lqf_re:
    s_sub_u32 s39, s39, 1
    s_cbranch_scc1 Lend
    ds_read_b32 v7, v96
    ds_read_b128 v[76:79], v95 offset:0
    ds_read_b128 v[80:83], v95 offset:64
    ds_read_b128 v[84:87], v95 offset:128
    ds_read_b128 v[88:91], v95 offset:192
    s_waitcnt lgkmcnt(0)
    s_branch Lqf
Lcsv_re:
    s_sub_u32 s39, s39, 1
    s_cbranch_scc1 Lend
    ds_read_b32 v46, v49
    ds_read_b64 v[44:45], v48
    s_waitcnt lgkmcnt(0)
    s_branch Lcsv
Lrx_re:
    s_sub_u32 s39, s39, 1
    s_cbranch_scc1 Lend
    buffer_load_dwordx2 v[52:53], v13, s[28:31], s58 offen offset:8 sc1
    buffer_load_dwordx2 v[54:55], v13, s[28:31], s59 offen offset:0 sc1
    s_waitcnt vmcnt(0)
    s_branch Lrx_chk
Linfo_re:
    s_sub_u32 s39, s39, 1
    s_cbranch_scc1 Lend
    ds_read_b64 v[8:9], v10
    s_waitcnt lgkmcnt(0)
    s_branch Linfo
Lfl_re:
    s_sub_u32 s39, s39, 1
    s_cbranch_scc1 Lend
    buffer_load_dword v20, v12, s[28:31], s24 offen sc1
    s_waitcnt vmcnt(0)
    s_branch Lfl_chk
Lre_0:
    s_mov_b32 s45, 1
    s_branch Lprobe
Lre_1:
    s_mov_b32 s45, 2
    s_branch Lprobe
Lre_2:
    s_mov_b32 s45, 3
    s_branch Lprobe
Lre_3:
    s_mov_b32 s45, 4
    s_branch Lprobe
Lre_4:
    s_mov_b32 s45, 5
    s_branch Lprobe
Lre_5:
    s_mov_b32 s45, 6
    s_branch Lprobe
Lre_6:
    s_mov_b32 s45, 7
    s_branch Lprobe
Lre_7:
    s_mov_b32 s45, 8
    s_branch Lprobe
Lre_8:
    s_mov_b32 s45, 9
    s_branch Lprobe
Lre_9:
    s_mov_b32 s45, 10
    s_branch Lprobe
Lprobe:
    v_min_u32 v5, 19, v1
    v_lshlrev_b32 v5, 10, v5
    s_nop 1
Lprobe2:
    s_sub_u32 s39, s39, 1
    s_cbranch_scc1 Lend
    buffer_load_dword v4, v5, s[28:31], s52 offen offset:1020 sc1
    s_waitcnt vmcnt(0)
    v_cmp_eq_u32 vcc, -1, v4
    s_nop 3
    s_cbranch_vccnz Lprobe2
    s_cmp_eq_u32 s45, 1
    s_cbranch_scc1 Lld_0
    s_cmp_eq_u32 s45, 2
    s_cbranch_scc1 Lld_1
    s_cmp_eq_u32 s45, 3
    s_cbranch_scc1 Lld_2
    s_cmp_eq_u32 s45, 4
    s_cbranch_scc1 Lld_3
    s_cmp_eq_u32 s45, 5
    s_cbranch_scc1 Lld_4
    s_cmp_eq_u32 s45, 6
    s_cbranch_scc1 Lld_5
    s_cmp_eq_u32 s45, 7
    s_cbranch_scc1 Lld_6
    s_cmp_eq_u32 s45, 8
    s_cbranch_scc1 Lld_7
    s_cmp_eq_u32 s45, 9
    s_cbranch_scc1 Lld_8
    s_branch Lld_9
Ldisp:
    s_cmp_eq_u32 s45, 1
    s_cbranch_scc1 Lchk_0
    s_cmp_eq_u32 s45, 2
    s_cbranch_scc1 Lchk_1
    s_cmp_eq_u32 s45, 3
    s_cbranch_scc1 Lchk_2
    s_cmp_eq_u32 s45, 4
    s_cbranch_scc1 Lchk_3
    s_cmp_eq_u32 s45, 5
    s_cbranch_scc1 Lchk_4
    s_cmp_eq_u32 s45, 6
    s_cbranch_scc1 Lchk_5
    s_cmp_eq_u32 s45, 7
    s_cbranch_scc1 Lchk_6
    s_cmp_eq_u32 s45, 8
    s_cbranch_scc1 Lchk_7
    s_cmp_eq_u32 s45, 9
    s_cbranch_scc1 Lchk_8
    s_branch Lchk_9
Lfix:
    v_mov_b32 v10, 157956
    s_nop 1
Lfix_w:
    s_sub_u32 s39, s39, 1
    s_cbranch_scc1 Lend
    ds_read_b32 v6, v10
    s_waitcnt lgkmcnt(0)
    v_readfirstlane_b32 s43, v6
    s_nop 0
    s_cmp_eq_u32 s43, 0
    s_nop 1
    s_cbranch_scc1 Lfix_w
    v_mov_b32 v6, 158720
    v_mov_b32 v7, 158208
    v_cmp_eq_u32 vcc, v8, v62
    s_nop 1
    v_cndmask_b32 v6, v6, v7, vcc
    v_mov_b32 v7, 158464
    v_cmp_eq_u32 vcc, v9, v62
    s_nop 1
    v_cndmask_b32 v6, v6, v7, vcc
    v_lshl_add_u32 v6, v2, 4, v6
    ds_read_b128 v[92:95], v6 offset:0
    ds_read_b128 v[96:99], v6 offset:64
    ds_read_b128 v[100:103], v6 offset:128
    ds_read_b128 v[104:107], v6 offset:192
    v_accvgpr_read_b32 v68, a8
    v_accvgpr_read_b32 v69, a9
    v_accvgpr_read_b32 v70, a10
    v_accvgpr_read_b32 v71, a11
    v_accvgpr_read_b32 v72, a12
    v_accvgpr_read_b32 v73, a13
    v_accvgpr_read_b32 v74, a14
    v_accvgpr_read_b32 v75, a15
    v_lshlrev_b32 v76, 16, v68
    v_and_b32 v77, 0xffff0000, v68
    v_lshlrev_b32 v78, 16, v69
    v_and_b32 v79, 0xffff0000, v69
    v_lshlrev_b32 v80, 16, v70
    v_and_b32 v81, 0xffff0000, v70
    v_lshlrev_b32 v82, 16, v71
    v_and_b32 v83, 0xffff0000, v71
    v_lshlrev_b32 v84, 16, v72
    v_and_b32 v85, 0xffff0000, v72
    v_lshlrev_b32 v86, 16, v73
    v_and_b32 v87, 0xffff0000, v73
    v_lshlrev_b32 v88, 16, v74
    v_and_b32 v89, 0xffff0000, v74
    v_lshlrev_b32 v90, 16, v75
    v_and_b32 v91, 0xffff0000, v75
    v_add_f32 v76, v76, v120
    v_add_f32 v77, v77, v120
    v_add_f32 v78, v78, v120
    v_add_f32 v79, v79, v120
    v_add_f32 v80, v80, v120
    v_add_f32 v81, v81, v120
    v_add_f32 v82, v82, v120
    v_add_f32 v83, v83, v120
    v_add_f32 v84, v84, v120
    v_add_f32 v85, v85, v120
    v_add_f32 v86, v86, v120
    v_add_f32 v87, v87, v120
    v_add_f32 v88, v88, v120
    v_add_f32 v89, v89, v120
    v_add_f32 v90, v90, v120
    v_add_f32 v91, v91, v120
    v_cvt_pk_bf16_f32 v77, v76, v77
    v_cvt_pk_bf16_f32 v79, v78, v79
    v_cvt_pk_bf16_f32 v81, v80, v81
    v_cvt_pk_bf16_f32 v83, v82, v83
    v_cvt_pk_bf16_f32 v85, v84, v85
    v_cvt_pk_bf16_f32 v87, v86, v87
    v_cvt_pk_bf16_f32 v89, v88, v89
    v_cvt_pk_bf16_f32 v91, v90, v91
    v_lshlrev_b32 v76, 16, v77
    v_and_b32 v77, 0xffff0000, v77
    v_lshlrev_b32 v78, 16, v79
    v_and_b32 v79, 0xffff0000, v79
    v_lshlrev_b32 v80, 16, v81
    v_and_b32 v81, 0xffff0000, v81
    v_lshlrev_b32 v82, 16, v83
    v_and_b32 v83, 0xffff0000, v83
    v_lshlrev_b32 v84, 16, v85
    v_and_b32 v85, 0xffff0000, v85
    v_lshlrev_b32 v86, 16, v87
    v_and_b32 v87, 0xffff0000, v87
    v_lshlrev_b32 v88, 16, v89
    v_and_b32 v89, 0xffff0000, v89
    v_lshlrev_b32 v90, 16, v91
    v_and_b32 v91, 0xffff0000, v91
    v_mul_f32 v76, v76, v121
    v_mul_f32 v77, v77, v121
    v_mul_f32 v78, v78, v121
    v_mul_f32 v79, v79, v121
    v_mul_f32 v80, v80, v121
    v_mul_f32 v81, v81, v121
    v_mul_f32 v82, v82, v121
    v_mul_f32 v83, v83, v121
    v_mul_f32 v84, v84, v121
    v_mul_f32 v85, v85, v121
    v_mul_f32 v86, v86, v121
    v_mul_f32 v87, v87, v121
    v_mul_f32 v88, v88, v121
    v_mul_f32 v89, v89, v121
    v_mul_f32 v90, v90, v121
    v_mul_f32 v91, v91, v121
    v_cvt_pk_bf16_f32 v77, v76, v77
    v_cvt_pk_bf16_f32 v79, v78, v79
    v_cvt_pk_bf16_f32 v81, v80, v81
    v_cvt_pk_bf16_f32 v83, v82, v83
    v_cvt_pk_bf16_f32 v85, v84, v85
    v_cvt_pk_bf16_f32 v87, v86, v87
    v_cvt_pk_bf16_f32 v89, v88, v89
    v_cvt_pk_bf16_f32 v91, v90, v91
    v_lshlrev_b32 v76, 16, v77
    v_and_b32 v77, 0xffff0000, v77
    v_lshlrev_b32 v78, 16, v79
    v_and_b32 v79, 0xffff0000, v79
    v_lshlrev_b32 v80, 16, v81
    v_and_b32 v81, 0xffff0000, v81
    v_lshlrev_b32 v82, 16, v83
    v_and_b32 v83, 0xffff0000, v83
    v_lshlrev_b32 v84, 16, v85
    v_and_b32 v85, 0xffff0000, v85
    v_lshlrev_b32 v86, 16, v87
    v_and_b32 v87, 0xffff0000, v87
    v_lshlrev_b32 v88, 16, v89
    v_and_b32 v89, 0xffff0000, v89
    v_lshlrev_b32 v90, 16, v91
    v_and_b32 v91, 0xffff0000, v91
    s_waitcnt lgkmcnt(0)
    v_add_f32 v76, v76, v92
    v_add_f32 v77, v77, v93
    v_add_f32 v78, v78, v94
    v_add_f32 v79, v79, v95
    v_add_f32 v80, v80, v96
    v_add_f32 v81, v81, v97
    v_add_f32 v82, v82, v98
    v_add_f32 v83, v83, v99
    v_add_f32 v84, v84, v100
    v_add_f32 v85, v85, v101
    v_add_f32 v86, v86, v102
    v_add_f32 v87, v87, v103
    v_add_f32 v88, v88, v104
    v_add_f32 v89, v89, v105
    v_add_f32 v90, v90, v106
    v_add_f32 v91, v91, v107
    v_cvt_pk_bf16_f32 v77, v76, v77
    v_cvt_pk_bf16_f32 v79, v78, v79
    v_cvt_pk_bf16_f32 v81, v80, v81
    v_cvt_pk_bf16_f32 v83, v82, v83
    v_cvt_pk_bf16_f32 v85, v84, v85
    v_cvt_pk_bf16_f32 v87, v86, v87
    v_cvt_pk_bf16_f32 v89, v88, v89
    v_cvt_pk_bf16_f32 v91, v90, v91
    v_lshlrev_b32 v76, 16, v77
    v_and_b32 v77, 0xffff0000, v77
    v_lshlrev_b32 v78, 16, v79
    v_and_b32 v79, 0xffff0000, v79
    v_lshlrev_b32 v80, 16, v81
    v_and_b32 v81, 0xffff0000, v81
    v_lshlrev_b32 v82, 16, v83
    v_and_b32 v83, 0xffff0000, v83
    v_lshlrev_b32 v84, 16, v85
    v_and_b32 v85, 0xffff0000, v85
    v_lshlrev_b32 v86, 16, v87
    v_and_b32 v87, 0xffff0000, v87
    v_lshlrev_b32 v88, 16, v89
    v_and_b32 v89, 0xffff0000, v89
    v_lshlrev_b32 v90, 16, v91
    v_and_b32 v91, 0xffff0000, v91
    v_mul_f32 v44, 0xbfb8aa3b, v76
    v_mul_f32 v45, 0xbfb8aa3b, v77
    v_mul_f32 v46, 0xbfb8aa3b, v78
    v_mul_f32 v47, 0xbfb8aa3b, v79
    v_mul_f32 v48, 0xbfb8aa3b, v80
    v_mul_f32 v49, 0xbfb8aa3b, v81
    v_mul_f32 v50, 0xbfb8aa3b, v82
    v_mul_f32 v51, 0xbfb8aa3b, v83
    v_mul_f32 v52, 0xbfb8aa3b, v84
    v_mul_f32 v53, 0xbfb8aa3b, v85
    v_mul_f32 v54, 0xbfb8aa3b, v86
    v_mul_f32 v55, 0xbfb8aa3b, v87
    v_mul_f32 v56, 0xbfb8aa3b, v88
    v_mul_f32 v57, 0xbfb8aa3b, v89
    v_mul_f32 v58, 0xbfb8aa3b, v90
    v_mul_f32 v59, 0xbfb8aa3b, v91
    v_exp_f32 v44, v44
    v_exp_f32 v45, v45
    v_exp_f32 v46, v46
    v_exp_f32 v47, v47
    v_exp_f32 v48, v48
    v_exp_f32 v49, v49
    v_exp_f32 v50, v50
    v_exp_f32 v51, v51
    v_exp_f32 v52, v52
    v_exp_f32 v53, v53
    v_exp_f32 v54, v54
    v_exp_f32 v55, v55
    v_exp_f32 v56, v56
    v_exp_f32 v57, v57
    v_exp_f32 v58, v58
    v_exp_f32 v59, v59
    v_add_f32 v44, 1.0, v44
    v_add_f32 v45, 1.0, v45
    v_add_f32 v46, 1.0, v46
    v_add_f32 v47, 1.0, v47
    v_add_f32 v48, 1.0, v48
    v_add_f32 v49, 1.0, v49
    v_add_f32 v50, 1.0, v50
    v_add_f32 v51, 1.0, v51
    v_add_f32 v52, 1.0, v52
    v_add_f32 v53, 1.0, v53
    v_add_f32 v54, 1.0, v54
    v_add_f32 v55, 1.0, v55
    v_add_f32 v56, 1.0, v56
    v_add_f32 v57, 1.0, v57
    v_add_f32 v58, 1.0, v58
    v_add_f32 v59, 1.0, v59
    v_rcp_f32 v44, v44
    v_rcp_f32 v45, v45
    v_rcp_f32 v46, v46
    v_rcp_f32 v47, v47
    v_rcp_f32 v48, v48
    v_rcp_f32 v49, v49
    v_rcp_f32 v50, v50
    v_rcp_f32 v51, v51
    v_rcp_f32 v52, v52
    v_rcp_f32 v53, v53
    v_rcp_f32 v54, v54
    v_rcp_f32 v55, v55
    v_rcp_f32 v56, v56
    v_rcp_f32 v57, v57
    v_rcp_f32 v58, v58
    v_rcp_f32 v59, v59
    v_mul_f32 v44, v44, v76
    v_mul_f32 v45, v45, v77
    v_mul_f32 v46, v46, v78
    v_mul_f32 v47, v47, v79
    v_mul_f32 v48, v48, v80
    v_mul_f32 v49, v49, v81
    v_mul_f32 v50, v50, v82
    v_mul_f32 v51, v51, v83
    v_mul_f32 v52, v52, v84
    v_mul_f32 v53, v53, v85
    v_mul_f32 v54, v54, v86
    v_mul_f32 v55, v55, v87
    v_mul_f32 v56, v56, v88
    v_mul_f32 v57, v57, v89
    v_mul_f32 v58, v58, v90
    v_mul_f32 v59, v59, v91
    v_cvt_pk_bf16_f32 v45, v44, v45
    v_cvt_pk_bf16_f32 v47, v46, v47
    v_cvt_pk_bf16_f32 v49, v48, v49
    v_cvt_pk_bf16_f32 v51, v50, v51
    v_cvt_pk_bf16_f32 v53, v52, v53
    v_cvt_pk_bf16_f32 v55, v54, v55
    v_cvt_pk_bf16_f32 v57, v56, v57
    v_cvt_pk_bf16_f32 v59, v58, v59
    v_lshlrev_b32 v44, 16, v45
    v_and_b32 v45, 0xffff0000, v45
    v_lshlrev_b32 v46, 16, v47
    v_and_b32 v47, 0xffff0000, v47
    v_lshlrev_b32 v48, 16, v49
    v_and_b32 v49, 0xffff0000, v49
    v_lshlrev_b32 v50, 16, v51
    v_and_b32 v51, 0xffff0000, v51
    v_lshlrev_b32 v52, 16, v53
    v_and_b32 v53, 0xffff0000, v53
    v_lshlrev_b32 v54, 16, v55
    v_and_b32 v55, 0xffff0000, v55
    v_lshlrev_b32 v56, 16, v57
    v_and_b32 v57, 0xffff0000, v57
    v_lshlrev_b32 v58, 16, v59
    v_and_b32 v59, 0xffff0000, v59
    s_nop 0
    s_branch Lnofix
Lhalo:
    s_mov_b32 vcc_lo, 0x00010001
    s_mov_b32 vcc_hi, 0x00010001
    v_mov_b32 v11, 38912
    v_cndmask_b32 v76, v76, v11, vcc
    v_xor_b32 v77, 64, v76
    v_add_u32 v80, 78080, v76
    v_add_u32 v81, 78080, v77
    v_mov_b32 v14, 0x3f803f80
    v_mov_b32 v15, 0x3f803f80
    v_mov_b32 v16, 0x3f803f80
    v_mov_b32 v17, 0x3f803f80
    v_and_b32 v4, 7, v1
    v_lshlrev_b32 v4, 4, v4
    v_mul_u32_u24 v5, 39040, v2
    v_add_u32 v4, v4, v5
    ds_write_b128 v4, v[14:17] offset:38912
    v_mov_b32 v4, 157952
    v_mov_b32 v8, 0
    v_mov_b32 v9, 0
    v_mov_b32 v10, -2
    v_mov_b32 v11, -2
    ds_write_b128 v4, v[8:11]
    ds_write_b64 v4, v[8:9] offset:16
    ds_write_b64 v4, v[8:9] offset:24
    s_mul_i32 s40, s36, 96
    s_sub_u32 s40, s40, 16
    v_add_u32 v96, s40, v1
    v_min_u32 v5, 47, v1
    v_add3_u32 v97, s40, v5, 64
    v_mov_b32 v6, 2047
    v_med3_i32 v96, v96, 0, v6
    v_med3_i32 v97, v97, 0, v6
    v_lshlrev_b32 v96, 3, v96
    v_lshlrev_b32 v97, 3, v97
    s_mov_b32 s52, 8192000
    s_waitcnt lgkmcnt(0)
    s_barrier
    s_add_u32 s38, s38, 0x9e3779b8
    s_or_b32 s38, s38, 1
    ds_read_b128 v[108:111], v76 offset:0
    ds_read_b128 v[112:115], v77 offset:0
    ds_read_b64_tr_b16 a[0:1], v20 offset:0
    ds_read_b64_tr_b16 a[2:3], v20 offset:512
    ds_read_b64_tr_b16 a[4:5], v21 offset:0
    ds_read_b64_tr_b16 a[6:7], v21 offset:512
    ds_read_b64_tr_b16 a[8:9], v22 offset:0
    ds_read_b64_tr_b16 a[10:11], v22 offset:512
    ds_read_b64_tr_b16 a[12:13], v23 offset:0
    ds_read_b64_tr_b16 a[14:15], v23 offset:512
    ds_read_b64_tr_b16 a[16:17], v20 offset:8192
    ds_read_b64_tr_b16 a[18:19], v20 offset:8704
    ds_read_b64_tr_b16 a[20:21], v21 offset:8192
    ds_read_b64_tr_b16 a[22:23], v21 offset:8704
    ds_read_b64_tr_b16 a[24:25], v22 offset:8192
    ds_read_b64_tr_b16 a[26:27], v22 offset:8704
    s_waitcnt lgkmcnt(12)
    v_mfma_f32_16x16x32_bf16 v[28:31], a[0:3], v[108:111], 0
    ds_read_b64_tr_b16 a[28:29], v23 offset:8192
    ds_read_b64_tr_b16 a[30:31], v23 offset:8704
    s_waitcnt lgkmcnt(12)
    v_mfma_f32_16x16x32_bf16 v[32:35], a[4:7], v[108:111], 0
    ds_read_b64_tr_b16 a[32:33], v20 offset:16384
    ds_read_b64_tr_b16 a[34:35], v20 offset:16896
    s_waitcnt lgkmcnt(12)
    v_mfma_f32_16x16x32_bf16 v[36:39], a[8:11], v[108:111], 0
    ds_read_b64_tr_b16 a[36:37], v21 offset:16384
    ds_read_b64_tr_b16 a[38:39], v21 offset:16896
    s_waitcnt lgkmcnt(12)
    v_mfma_f32_16x16x32_bf16 v[40:43], a[12:15], v[108:111], 0
    ds_read_b64_tr_b16 a[40:41], v22 offset:16384
    ds_read_b64_tr_b16 a[42:43], v22 offset:16896
    s_waitcnt lgkmcnt(12)
    v_mfma_f32_16x16x32_bf16 v[44:47], a[16:19], v[108:111], 0
    ds_read_b64_tr_b16 a[44:45], v23 offset:16384
    ds_read_b64_tr_b16 a[46:47], v23 offset:16896
    s_waitcnt lgkmcnt(12)
    v_mfma_f32_16x16x32_bf16 v[48:51], a[20:23], v[108:111], 0
    ds_read_b64_tr_b16 a[48:49], v20 offset:4096
    ds_read_b64_tr_b16 a[50:51], v20 offset:4608
    s_waitcnt lgkmcnt(12)
    v_mfma_f32_16x16x32_bf16 v[52:55], a[24:27], v[108:111], 0
    ds_read_b64_tr_b16 a[52:53], v21 offset:4096
    ds_read_b64_tr_b16 a[54:55], v21 offset:4608
    s_waitcnt lgkmcnt(12)
    v_mfma_f32_16x16x32_bf16 v[56:59], a[28:31], v[108:111], 0
    ds_read_b64_tr_b16 a[56:57], v22 offset:4096
    ds_read_b64_tr_b16 a[58:59], v22 offset:4608
    s_waitcnt lgkmcnt(12)
    v_mfma_f32_16x16x32_bf16 v[60:63], v[108:111], a[32:35], 0
    ds_read_b64_tr_b16 a[60:61], v23 offset:4096
    ds_read_b64_tr_b16 a[62:63], v23 offset:4608
    s_waitcnt lgkmcnt(12)
    v_mfma_f32_16x16x32_bf16 v[64:67], v[108:111], a[36:39], 0
    ds_read_b64_tr_b16 a[64:65], v20 offset:12288
    ds_read_b64_tr_b16 a[66:67], v20 offset:12800
    s_waitcnt lgkmcnt(12)
    v_mfma_f32_16x16x32_bf16 v[68:71], v[108:111], a[40:43], 0
    ds_read_b64_tr_b16 a[68:69], v21 offset:12288
    ds_read_b64_tr_b16 a[70:71], v21 offset:12800
    s_waitcnt lgkmcnt(12)
    v_mfma_f32_16x16x32_bf16 v[72:75], v[108:111], a[44:47], 0
    ds_read_b64_tr_b16 a[72:73], v22 offset:12288
    ds_read_b64_tr_b16 a[74:75], v22 offset:12800
    s_waitcnt lgkmcnt(12)
    v_mfma_f32_16x16x32_bf16 v[28:31], a[48:51], v[112:115], v[28:31]
    ds_read_b64_tr_b16 a[76:77], v23 offset:12288
    ds_read_b64_tr_b16 a[78:79], v23 offset:12800
    s_waitcnt lgkmcnt(12)
    v_mfma_f32_16x16x32_bf16 v[32:35], a[52:55], v[112:115], v[32:35]
    ds_read_b64_tr_b16 a[80:81], v20 offset:20480
    ds_read_b64_tr_b16 a[82:83], v20 offset:20992
    s_waitcnt lgkmcnt(12)
    v_mfma_f32_16x16x32_bf16 v[36:39], a[56:59], v[112:115], v[36:39]
    ds_read_b64_tr_b16 a[84:85], v21 offset:20480
    ds_read_b64_tr_b16 a[86:87], v21 offset:20992
    s_waitcnt lgkmcnt(12)
    v_mfma_f32_16x16x32_bf16 v[40:43], a[60:63], v[112:115], v[40:43]
    ds_read_b64_tr_b16 a[88:89], v22 offset:20480
    ds_read_b64_tr_b16 a[90:91], v22 offset:20992
    s_waitcnt lgkmcnt(12)
    v_mfma_f32_16x16x32_bf16 v[44:47], a[64:67], v[112:115], v[44:47]
    ds_read_b64_tr_b16 a[92:93], v23 offset:20480
    ds_read_b64_tr_b16 a[94:95], v23 offset:20992
    s_waitcnt lgkmcnt(12)
    v_mfma_f32_16x16x32_bf16 v[48:51], a[68:71], v[112:115], v[48:51]
    s_waitcnt lgkmcnt(10)
    v_mfma_f32_16x16x32_bf16 v[52:55], a[72:75], v[112:115], v[52:55]
    s_waitcnt lgkmcnt(8)
    v_mfma_f32_16x16x32_bf16 v[56:59], a[76:79], v[112:115], v[56:59]
    s_waitcnt lgkmcnt(6)
    v_mfma_f32_16x16x32_bf16 v[60:63], v[112:115], a[80:83], v[60:63]
    s_waitcnt lgkmcnt(4)
    v_mfma_f32_16x16x32_bf16 v[64:67], v[112:115], a[84:87], v[64:67]
    s_waitcnt lgkmcnt(2)
    v_mfma_f32_16x16x32_bf16 v[68:71], v[112:115], a[88:91], v[68:71]
    s_waitcnt lgkmcnt(0)
    v_mfma_f32_16x16x32_bf16 v[72:75], v[112:115], a[92:95], v[72:75]
    s_waitcnt lgkmcnt(0)
    s_barrier
    ds_read_b128 v[108:111], v76 offset:39040
    ds_read_b128 v[112:115], v77 offset:39040
    ds_read_b64_tr_b16 a[0:1], v20 offset:39040
    ds_read_b64_tr_b16 a[2:3], v20 offset:39552
    ds_read_b64_tr_b16 a[4:5], v21 offset:39040
    ds_read_b64_tr_b16 a[6:7], v21 offset:39552
    ds_read_b64_tr_b16 a[8:9], v22 offset:39040
    ds_read_b64_tr_b16 a[10:11], v22 offset:39552
    ds_read_b64_tr_b16 a[12:13], v23 offset:39040
    ds_read_b64_tr_b16 a[14:15], v23 offset:39552
    ds_read_b64_tr_b16 a[16:17], v20 offset:47232
    ds_read_b64_tr_b16 a[18:19], v20 offset:47744
    ds_read_b64_tr_b16 a[20:21], v21 offset:47232
    ds_read_b64_tr_b16 a[22:23], v21 offset:47744
    ds_read_b64_tr_b16 a[24:25], v22 offset:47232
    ds_read_b64_tr_b16 a[26:27], v22 offset:47744
    s_waitcnt lgkmcnt(12)
    v_mfma_f32_16x16x32_bf16 v[28:31], a[0:3], v[108:111], v[28:31]
    ds_read_b64_tr_b16 a[28:29], v23 offset:47232
    ds_read_b64_tr_b16 a[30:31], v23 offset:47744
    s_waitcnt lgkmcnt(12)
    v_mfma_f32_16x16x32_bf16 v[32:35], a[4:7], v[108:111], v[32:35]
    ds_read_b64_tr_b16 a[32:33], v20 offset:55424
    ds_read_b64_tr_b16 a[34:35], v20 offset:55936
    s_waitcnt lgkmcnt(12)
    v_mfma_f32_16x16x32_bf16 v[36:39], a[8:11], v[108:111], v[36:39]
    ds_read_b64_tr_b16 a[36:37], v21 offset:55424
    ds_read_b64_tr_b16 a[38:39], v21 offset:55936
    s_waitcnt lgkmcnt(12)
    v_mfma_f32_16x16x32_bf16 v[40:43], a[12:15], v[108:111], v[40:43]
    ds_read_b64_tr_b16 a[40:41], v22 offset:55424
    ds_read_b64_tr_b16 a[42:43], v22 offset:55936
    s_waitcnt lgkmcnt(12)
    v_mfma_f32_16x16x32_bf16 v[44:47], a[16:19], v[108:111], v[44:47]
    ds_read_b64_tr_b16 a[44:45], v23 offset:55424
    ds_read_b64_tr_b16 a[46:47], v23 offset:55936
    s_waitcnt lgkmcnt(12)
    v_mfma_f32_16x16x32_bf16 v[48:51], a[20:23], v[108:111], v[48:51]
    ds_read_b64_tr_b16 a[48:49], v20 offset:43136
    ds_read_b64_tr_b16 a[50:51], v20 offset:43648
    s_waitcnt lgkmcnt(12)
    v_mfma_f32_16x16x32_bf16 v[52:55], a[24:27], v[108:111], v[52:55]
    ds_read_b64_tr_b16 a[52:53], v21 offset:43136
    ds_read_b64_tr_b16 a[54:55], v21 offset:43648
    s_waitcnt lgkmcnt(12)
    v_mfma_f32_16x16x32_bf16 v[56:59], a[28:31], v[108:111], v[56:59]
    ds_read_b64_tr_b16 a[56:57], v22 offset:43136
    ds_read_b64_tr_b16 a[58:59], v22 offset:43648
    s_waitcnt lgkmcnt(12)
    v_mfma_f32_16x16x32_bf16 v[60:63], v[108:111], a[32:35], v[60:63]
    ds_read_b64_tr_b16 a[60:61], v23 offset:43136
    ds_read_b64_tr_b16 a[62:63], v23 offset:43648
    s_waitcnt lgkmcnt(12)
    v_mfma_f32_16x16x32_bf16 v[64:67], v[108:111], a[36:39], v[64:67]
    ds_read_b64_tr_b16 a[64:65], v20 offset:51328
    ds_read_b64_tr_b16 a[66:67], v20 offset:51840
    s_waitcnt lgkmcnt(12)
    v_mfma_f32_16x16x32_bf16 v[68:71], v[108:111], a[40:43], v[68:71]
    ds_read_b64_tr_b16 a[68:69], v21 offset:51328
    ds_read_b64_tr_b16 a[70:71], v21 offset:51840
    s_waitcnt lgkmcnt(12)
    v_mfma_f32_16x16x32_bf16 v[72:75], v[108:111], a[44:47], v[72:75]
    ds_read_b64_tr_b16 a[72:73], v22 offset:51328
    ds_read_b64_tr_b16 a[74:75], v22 offset:51840
    s_waitcnt lgkmcnt(12)
    v_mfma_f32_16x16x32_bf16 v[28:31], a[48:51], v[112:115], v[28:31]
    ds_read_b64_tr_b16 a[76:77], v23 offset:51328
    ds_read_b64_tr_b16 a[78:79], v23 offset:51840
    s_waitcnt lgkmcnt(12)
    v_mfma_f32_16x16x32_bf16 v[32:35], a[52:55], v[112:115], v[32:35]
    ds_read_b64_tr_b16 a[80:81], v20 offset:59520
    ds_read_b64_tr_b16 a[82:83], v20 offset:60032
    s_waitcnt lgkmcnt(12)
    v_mfma_f32_16x16x32_bf16 v[36:39], a[56:59], v[112:115], v[36:39]
    ds_read_b64_tr_b16 a[84:85], v21 offset:59520
    ds_read_b64_tr_b16 a[86:87], v21 offset:60032
    s_waitcnt lgkmcnt(12)
    v_mfma_f32_16x16x32_bf16 v[40:43], a[60:63], v[112:115], v[40:43]
    ds_read_b64_tr_b16 a[88:89], v22 offset:59520
    ds_read_b64_tr_b16 a[90:91], v22 offset:60032
    s_waitcnt lgkmcnt(12)
    v_mfma_f32_16x16x32_bf16 v[44:47], a[64:67], v[112:115], v[44:47]
    ds_read_b64_tr_b16 a[92:93], v23 offset:59520
    ds_read_b64_tr_b16 a[94:95], v23 offset:60032
    s_waitcnt lgkmcnt(12)
    v_mfma_f32_16x16x32_bf16 v[48:51], a[68:71], v[112:115], v[48:51]
    s_waitcnt lgkmcnt(10)
    v_mfma_f32_16x16x32_bf16 v[52:55], a[72:75], v[112:115], v[52:55]
    s_waitcnt lgkmcnt(8)
    v_mfma_f32_16x16x32_bf16 v[56:59], a[76:79], v[112:115], v[56:59]
    s_waitcnt lgkmcnt(6)
    v_mfma_f32_16x16x32_bf16 v[60:63], v[112:115], a[80:83], v[60:63]
    s_waitcnt lgkmcnt(4)
    v_mfma_f32_16x16x32_bf16 v[64:67], v[112:115], a[84:87], v[64:67]
    s_waitcnt lgkmcnt(2)
    v_mfma_f32_16x16x32_bf16 v[68:71], v[112:115], a[88:91], v[68:71]
    s_waitcnt lgkmcnt(0)
    v_mfma_f32_16x16x32_bf16 v[72:75], v[112:115], a[92:95], v[72:75]
    s_mov_b64 exec, 1
    s_lshl_b32 s40, s2, 2
    s_add_u32 s40, s40, 8323072
    v_mov_b32 v4, s38
    v_mov_b32 v5, s40
    buffer_store_dword v4, v5, s[28:31], 0 offen sc1
    s_mov_b64 exec, -1
    s_waitcnt lgkmcnt(0)
    s_barrier
    ds_read_b128 v[108:111], v80 offset:0
    ds_read_b128 v[112:115], v81 offset:0
    ds_read_b64_tr_b16 a[0:1], v24 offset:0
    ds_read_b64_tr_b16 a[2:3], v24 offset:512
    ds_read_b64_tr_b16 a[4:5], v25 offset:0
    ds_read_b64_tr_b16 a[6:7], v25 offset:512
    ds_read_b64_tr_b16 a[8:9], v26 offset:0
    ds_read_b64_tr_b16 a[10:11], v26 offset:512
    ds_read_b64_tr_b16 a[12:13], v27 offset:0
    ds_read_b64_tr_b16 a[14:15], v27 offset:512
    ds_read_b64_tr_b16 a[16:17], v24 offset:8192
    ds_read_b64_tr_b16 a[18:19], v24 offset:8704
    ds_read_b64_tr_b16 a[20:21], v25 offset:8192
    ds_read_b64_tr_b16 a[22:23], v25 offset:8704
    ds_read_b64_tr_b16 a[24:25], v26 offset:8192
    ds_read_b64_tr_b16 a[26:27], v26 offset:8704
    s_waitcnt lgkmcnt(12)
    v_mfma_f32_16x16x32_bf16 v[28:31], a[0:3], v[108:111], v[28:31]
    ds_read_b64_tr_b16 a[28:29], v27 offset:8192
    ds_read_b64_tr_b16 a[30:31], v27 offset:8704
    s_waitcnt lgkmcnt(12)
    v_mfma_f32_16x16x32_bf16 v[32:35], a[4:7], v[108:111], v[32:35]
    ds_read_b64_tr_b16 a[32:33], v24 offset:16384
    ds_read_b64_tr_b16 a[34:35], v24 offset:16896
    s_waitcnt lgkmcnt(12)
    v_mfma_f32_16x16x32_bf16 v[36:39], a[8:11], v[108:111], v[36:39]
    ds_read_b64_tr_b16 a[36:37], v25 offset:16384
    ds_read_b64_tr_b16 a[38:39], v25 offset:16896
    s_waitcnt lgkmcnt(12)
    v_mfma_f32_16x16x32_bf16 v[40:43], a[12:15], v[108:111], v[40:43]
    ds_read_b64_tr_b16 a[40:41], v26 offset:16384
    ds_read_b64_tr_b16 a[42:43], v26 offset:16896
    s_waitcnt lgkmcnt(12)
    v_mfma_f32_16x16x32_bf16 v[44:47], a[16:19], v[108:111], v[44:47]
    ds_read_b64_tr_b16 a[44:45], v27 offset:16384
    ds_read_b64_tr_b16 a[46:47], v27 offset:16896
    s_waitcnt lgkmcnt(12)
    v_mfma_f32_16x16x32_bf16 v[48:51], a[20:23], v[108:111], v[48:51]
    ds_read_b64_tr_b16 a[48:49], v24 offset:4096
    ds_read_b64_tr_b16 a[50:51], v24 offset:4608
    s_waitcnt lgkmcnt(12)
    v_mfma_f32_16x16x32_bf16 v[52:55], a[24:27], v[108:111], v[52:55]
    ds_read_b64_tr_b16 a[52:53], v25 offset:4096
    ds_read_b64_tr_b16 a[54:55], v25 offset:4608
    s_waitcnt lgkmcnt(12)
    v_mfma_f32_16x16x32_bf16 v[56:59], a[28:31], v[108:111], v[56:59]
    ds_read_b64_tr_b16 a[56:57], v26 offset:4096
    ds_read_b64_tr_b16 a[58:59], v26 offset:4608
    s_waitcnt lgkmcnt(12)
    v_mfma_f32_16x16x32_bf16 v[60:63], v[108:111], a[32:35], v[60:63]
    ds_read_b64_tr_b16 a[60:61], v27 offset:4096
    ds_read_b64_tr_b16 a[62:63], v27 offset:4608
    s_waitcnt lgkmcnt(12)
    v_mfma_f32_16x16x32_bf16 v[64:67], v[108:111], a[36:39], v[64:67]
    ds_read_b64_tr_b16 a[64:65], v24 offset:12288
    ds_read_b64_tr_b16 a[66:67], v24 offset:12800
    s_waitcnt lgkmcnt(12)
    v_mfma_f32_16x16x32_bf16 v[68:71], v[108:111], a[40:43], v[68:71]
    ds_read_b64_tr_b16 a[68:69], v25 offset:12288
    ds_read_b64_tr_b16 a[70:71], v25 offset:12800
    s_waitcnt lgkmcnt(12)
    v_mfma_f32_16x16x32_bf16 v[72:75], v[108:111], a[44:47], v[72:75]
    ds_read_b64_tr_b16 a[72:73], v26 offset:12288
    ds_read_b64_tr_b16 a[74:75], v26 offset:12800
    s_waitcnt lgkmcnt(12)
    v_mfma_f32_16x16x32_bf16 v[28:31], a[48:51], v[112:115], v[28:31]
    ds_read_b64_tr_b16 a[76:77], v27 offset:12288
    ds_read_b64_tr_b16 a[78:79], v27 offset:12800
    s_waitcnt lgkmcnt(12)
    v_mfma_f32_16x16x32_bf16 v[32:35], a[52:55], v[112:115], v[32:35]
    ds_read_b64_tr_b16 a[80:81], v24 offset:20480
    ds_read_b64_tr_b16 a[82:83], v24 offset:20992
    s_waitcnt lgkmcnt(12)
    v_mfma_f32_16x16x32_bf16 v[36:39], a[56:59], v[112:115], v[36:39]
    ds_read_b64_tr_b16 a[84:85], v25 offset:20480
    ds_read_b64_tr_b16 a[86:87], v25 offset:20992
    s_waitcnt lgkmcnt(12)
    v_mfma_f32_16x16x32_bf16 v[40:43], a[60:63], v[112:115], v[40:43]
    ds_read_b64_tr_b16 a[88:89], v26 offset:20480
    ds_read_b64_tr_b16 a[90:91], v26 offset:20992
    s_waitcnt lgkmcnt(12)
    v_mfma_f32_16x16x32_bf16 v[44:47], a[64:67], v[112:115], v[44:47]
    ds_read_b64_tr_b16 a[92:93], v27 offset:20480
    ds_read_b64_tr_b16 a[94:95], v27 offset:20992
    s_waitcnt lgkmcnt(12)
    v_mfma_f32_16x16x32_bf16 v[48:51], a[68:71], v[112:115], v[48:51]
    s_waitcnt lgkmcnt(10)
    v_mfma_f32_16x16x32_bf16 v[52:55], a[72:75], v[112:115], v[52:55]
    s_waitcnt lgkmcnt(8)
    v_mfma_f32_16x16x32_bf16 v[56:59], a[76:79], v[112:115], v[56:59]
    s_waitcnt lgkmcnt(6)
    v_mfma_f32_16x16x32_bf16 v[60:63], v[112:115], a[80:83], v[60:63]
    s_waitcnt lgkmcnt(4)
    v_mfma_f32_16x16x32_bf16 v[64:67], v[112:115], a[84:87], v[64:67]
    s_waitcnt lgkmcnt(2)
    v_mfma_f32_16x16x32_bf16 v[68:71], v[112:115], a[88:91], v[68:71]
    s_waitcnt lgkmcnt(0)
    v_mfma_f32_16x16x32_bf16 v[72:75], v[112:115], a[92:95], v[72:75]
    s_waitcnt lgkmcnt(0)
    s_barrier
    ds_read_b128 v[108:111], v80 offset:39040
    ds_read_b128 v[112:115], v81 offset:39040
    ds_read_b64_tr_b16 a[0:1], v24 offset:39040
    ds_read_b64_tr_b16 a[2:3], v24 offset:39552
    ds_read_b64_tr_b16 a[4:5], v25 offset:39040
    ds_read_b64_tr_b16 a[6:7], v25 offset:39552
    ds_read_b64_tr_b16 a[8:9], v26 offset:39040
    ds_read_b64_tr_b16 a[10:11], v26 offset:39552
    ds_read_b64_tr_b16 a[12:13], v27 offset:39040
    ds_read_b64_tr_b16 a[14:15], v27 offset:39552
    ds_read_b64_tr_b16 a[16:17], v24 offset:47232
    ds_read_b64_tr_b16 a[18:19], v24 offset:47744
    ds_read_b64_tr_b16 a[20:21], v25 offset:47232
    ds_read_b64_tr_b16 a[22:23], v25 offset:47744
    ds_read_b64_tr_b16 a[24:25], v26 offset:47232
    ds_read_b64_tr_b16 a[26:27], v26 offset:47744
    s_waitcnt lgkmcnt(12)
    v_mfma_f32_16x16x32_bf16 v[28:31], a[0:3], v[108:111], v[28:31]
    ds_read_b64_tr_b16 a[28:29], v27 offset:47232
    ds_read_b64_tr_b16 a[30:31], v27 offset:47744
    s_waitcnt lgkmcnt(12)
    v_mfma_f32_16x16x32_bf16 v[32:35], a[4:7], v[108:111], v[32:35]
    ds_read_b64_tr_b16 a[32:33], v24 offset:55424
    ds_read_b64_tr_b16 a[34:35], v24 offset:55936
    s_waitcnt lgkmcnt(12)
    v_mfma_f32_16x16x32_bf16 v[36:39], a[8:11], v[108:111], v[36:39]
    ds_read_b64_tr_b16 a[36:37], v25 offset:55424
    ds_read_b64_tr_b16 a[38:39], v25 offset:55936
    s_waitcnt lgkmcnt(12)
    v_mfma_f32_16x16x32_bf16 v[40:43], a[12:15], v[108:111], v[40:43]
    ds_read_b64_tr_b16 a[40:41], v26 offset:55424
    ds_read_b64_tr_b16 a[42:43], v26 offset:55936
    s_waitcnt lgkmcnt(12)
    v_mfma_f32_16x16x32_bf16 v[44:47], a[16:19], v[108:111], v[44:47]
    ds_read_b64_tr_b16 a[44:45], v27 offset:55424
    ds_read_b64_tr_b16 a[46:47], v27 offset:55936
    s_waitcnt lgkmcnt(12)
    v_mfma_f32_16x16x32_bf16 v[48:51], a[20:23], v[108:111], v[48:51]
    ds_read_b64_tr_b16 a[48:49], v24 offset:43136
    ds_read_b64_tr_b16 a[50:51], v24 offset:43648
    s_waitcnt lgkmcnt(12)
    v_mfma_f32_16x16x32_bf16 v[52:55], a[24:27], v[108:111], v[52:55]
    ds_read_b64_tr_b16 a[52:53], v25 offset:43136
    ds_read_b64_tr_b16 a[54:55], v25 offset:43648
    s_waitcnt lgkmcnt(12)
    v_mfma_f32_16x16x32_bf16 v[56:59], a[28:31], v[108:111], v[56:59]
    ds_read_b64_tr_b16 a[56:57], v26 offset:43136
    ds_read_b64_tr_b16 a[58:59], v26 offset:43648
    s_waitcnt lgkmcnt(12)
    v_mfma_f32_16x16x32_bf16 v[60:63], v[108:111], a[32:35], v[60:63]
    ds_read_b64_tr_b16 a[60:61], v27 offset:43136
    ds_read_b64_tr_b16 a[62:63], v27 offset:43648
    s_waitcnt lgkmcnt(12)
    v_mfma_f32_16x16x32_bf16 v[64:67], v[108:111], a[36:39], v[64:67]
    ds_read_b64_tr_b16 a[64:65], v24 offset:51328
    ds_read_b64_tr_b16 a[66:67], v24 offset:51840
    s_waitcnt lgkmcnt(12)
    v_mfma_f32_16x16x32_bf16 v[68:71], v[108:111], a[40:43], v[68:71]
    ds_read_b64_tr_b16 a[68:69], v25 offset:51328
    ds_read_b64_tr_b16 a[70:71], v25 offset:51840
    s_waitcnt lgkmcnt(12)
    v_mfma_f32_16x16x32_bf16 v[72:75], v[108:111], a[44:47], v[72:75]
    ds_read_b64_tr_b16 a[72:73], v26 offset:51328
    ds_read_b64_tr_b16 a[74:75], v26 offset:51840
    s_waitcnt lgkmcnt(12)
    v_mfma_f32_16x16x32_bf16 v[28:31], a[48:51], v[112:115], v[28:31]
    ds_read_b64_tr_b16 a[76:77], v27 offset:51328
    ds_read_b64_tr_b16 a[78:79], v27 offset:51840
    s_waitcnt lgkmcnt(12)
    v_mfma_f32_16x16x32_bf16 v[32:35], a[52:55], v[112:115], v[32:35]
    ds_read_b64_tr_b16 a[80:81], v24 offset:59520
    ds_read_b64_tr_b16 a[82:83], v24 offset:60032
    s_waitcnt lgkmcnt(12)
    v_mfma_f32_16x16x32_bf16 v[36:39], a[56:59], v[112:115], v[36:39]
    ds_read_b64_tr_b16 a[84:85], v25 offset:59520
    ds_read_b64_tr_b16 a[86:87], v25 offset:60032
    s_waitcnt lgkmcnt(12)
    v_mfma_f32_16x16x32_bf16 v[40:43], a[60:63], v[112:115], v[40:43]
    ds_read_b64_tr_b16 a[88:89], v26 offset:59520
    ds_read_b64_tr_b16 a[90:91], v26 offset:60032
    s_waitcnt lgkmcnt(12)
    v_mfma_f32_16x16x32_bf16 v[44:47], a[64:67], v[112:115], v[44:47]
    ds_read_b64_tr_b16 a[92:93], v27 offset:59520
    ds_read_b64_tr_b16 a[94:95], v27 offset:60032
    s_waitcnt lgkmcnt(12)
    v_mfma_f32_16x16x32_bf16 v[48:51], a[68:71], v[112:115], v[48:51]
    s_waitcnt lgkmcnt(10)
    v_mfma_f32_16x16x32_bf16 v[52:55], a[72:75], v[112:115], v[52:55]
    s_waitcnt lgkmcnt(8)
    v_mfma_f32_16x16x32_bf16 v[56:59], a[76:79], v[112:115], v[56:59]
    s_waitcnt lgkmcnt(6)
    v_mfma_f32_16x16x32_bf16 v[60:63], v[112:115], a[80:83], v[60:63]
    s_waitcnt lgkmcnt(4)
    v_mfma_f32_16x16x32_bf16 v[64:67], v[112:115], a[84:87], v[64:67]
    s_waitcnt lgkmcnt(2)
    v_mfma_f32_16x16x32_bf16 v[68:71], v[112:115], a[88:91], v[68:71]
    s_waitcnt lgkmcnt(0)
    v_mfma_f32_16x16x32_bf16 v[72:75], v[112:115], a[92:95], v[72:75]
    s_waitcnt lgkmcnt(0)
    s_barrier
    ds_read_b128 v[108:111], v76 offset:0
    ds_read_b128 v[112:115], v77 offset:0
    ds_read_b64_tr_b16 a[0:1], v20 offset:0
    ds_read_b64_tr_b16 a[2:3], v20 offset:512
    ds_read_b64_tr_b16 a[4:5], v21 offset:0
    ds_read_b64_tr_b16 a[6:7], v21 offset:512
    ds_read_b64_tr_b16 a[8:9], v22 offset:0
    ds_read_b64_tr_b16 a[10:11], v22 offset:512
    ds_read_b64_tr_b16 a[12:13], v23 offset:0
    ds_read_b64_tr_b16 a[14:15], v23 offset:512
    ds_read_b64_tr_b16 a[16:17], v20 offset:8192
    ds_read_b64_tr_b16 a[18:19], v20 offset:8704
    ds_read_b64_tr_b16 a[20:21], v21 offset:8192
    ds_read_b64_tr_b16 a[22:23], v21 offset:8704
    ds_read_b64_tr_b16 a[24:25], v22 offset:8192
    ds_read_b64_tr_b16 a[26:27], v22 offset:8704
    s_waitcnt lgkmcnt(12)
    v_mfma_f32_16x16x32_bf16 v[28:31], a[0:3], v[108:111], v[28:31]
    ds_read_b64_tr_b16 a[28:29], v23 offset:8192
    ds_read_b64_tr_b16 a[30:31], v23 offset:8704
    s_waitcnt lgkmcnt(12)
    v_mfma_f32_16x16x32_bf16 v[32:35], a[4:7], v[108:111], v[32:35]
    ds_read_b64_tr_b16 a[32:33], v20 offset:16384
    ds_read_b64_tr_b16 a[34:35], v20 offset:16896
    s_waitcnt lgkmcnt(12)
    v_mfma_f32_16x16x32_bf16 v[36:39], a[8:11], v[108:111], v[36:39]
    ds_read_b64_tr_b16 a[36:37], v21 offset:16384
    ds_read_b64_tr_b16 a[38:39], v21 offset:16896
    s_waitcnt lgkmcnt(12)
    v_mfma_f32_16x16x32_bf16 v[40:43], a[12:15], v[108:111], v[40:43]
    ds_read_b64_tr_b16 a[40:41], v22 offset:16384
    ds_read_b64_tr_b16 a[42:43], v22 offset:16896
    s_waitcnt lgkmcnt(12)
    v_mfma_f32_16x16x32_bf16 v[44:47], a[16:19], v[108:111], v[44:47]
    ds_read_b64_tr_b16 a[44:45], v23 offset:16384
    ds_read_b64_tr_b16 a[46:47], v23 offset:16896
    s_waitcnt lgkmcnt(12)
    v_mfma_f32_16x16x32_bf16 v[48:51], a[20:23], v[108:111], v[48:51]
    ds_read_b64_tr_b16 a[48:49], v20 offset:4096
    ds_read_b64_tr_b16 a[50:51], v20 offset:4608
    s_waitcnt lgkmcnt(12)
    v_mfma_f32_16x16x32_bf16 v[52:55], a[24:27], v[108:111], v[52:55]
    ds_read_b64_tr_b16 a[52:53], v21 offset:4096
    ds_read_b64_tr_b16 a[54:55], v21 offset:4608
    s_waitcnt lgkmcnt(12)
    v_mfma_f32_16x16x32_bf16 v[56:59], a[28:31], v[108:111], v[56:59]
    ds_read_b64_tr_b16 a[56:57], v22 offset:4096
    ds_read_b64_tr_b16 a[58:59], v22 offset:4608
    s_waitcnt lgkmcnt(12)
    v_mfma_f32_16x16x32_bf16 v[60:63], v[108:111], a[32:35], v[60:63]
    ds_read_b64_tr_b16 a[60:61], v23 offset:4096
    ds_read_b64_tr_b16 a[62:63], v23 offset:4608
    s_waitcnt lgkmcnt(12)
    v_mfma_f32_16x16x32_bf16 v[64:67], v[108:111], a[36:39], v[64:67]
    ds_read_b64_tr_b16 a[64:65], v20 offset:12288
    ds_read_b64_tr_b16 a[66:67], v20 offset:12800
    s_waitcnt lgkmcnt(12)
    v_mfma_f32_16x16x32_bf16 v[68:71], v[108:111], a[40:43], v[68:71]
    ds_read_b64_tr_b16 a[68:69], v21 offset:12288
    ds_read_b64_tr_b16 a[70:71], v21 offset:12800
    s_waitcnt lgkmcnt(12)
    v_mfma_f32_16x16x32_bf16 v[72:75], v[108:111], a[44:47], v[72:75]
    ds_read_b64_tr_b16 a[72:73], v22 offset:12288
    ds_read_b64_tr_b16 a[74:75], v22 offset:12800
    s_waitcnt lgkmcnt(12)
    v_mfma_f32_16x16x32_bf16 v[28:31], a[48:51], v[112:115], v[28:31]
    ds_read_b64_tr_b16 a[76:77], v23 offset:12288
    ds_read_b64_tr_b16 a[78:79], v23 offset:12800
    s_waitcnt lgkmcnt(12)
    v_mfma_f32_16x16x32_bf16 v[32:35], a[52:55], v[112:115], v[32:35]
    ds_read_b64_tr_b16 a[80:81], v20 offset:20480
    ds_read_b64_tr_b16 a[82:83], v20 offset:20992
    s_waitcnt lgkmcnt(12)
    v_mfma_f32_16x16x32_bf16 v[36:39], a[56:59], v[112:115], v[36:39]
    ds_read_b64_tr_b16 a[84:85], v21 offset:20480
    ds_read_b64_tr_b16 a[86:87], v21 offset:20992
    s_waitcnt lgkmcnt(12)
    v_mfma_f32_16x16x32_bf16 v[40:43], a[60:63], v[112:115], v[40:43]
    ds_read_b64_tr_b16 a[88:89], v22 offset:20480
    ds_read_b64_tr_b16 a[90:91], v22 offset:20992
    s_waitcnt lgkmcnt(12)
    v_mfma_f32_16x16x32_bf16 v[44:47], a[64:67], v[112:115], v[44:47]
    ds_read_b64_tr_b16 a[92:93], v23 offset:20480
    ds_read_b64_tr_b16 a[94:95], v23 offset:20992
    s_waitcnt lgkmcnt(12)
    v_mfma_f32_16x16x32_bf16 v[48:51], a[68:71], v[112:115], v[48:51]
    s_waitcnt lgkmcnt(10)
    v_mfma_f32_16x16x32_bf16 v[52:55], a[72:75], v[112:115], v[52:55]
    s_waitcnt lgkmcnt(8)
    v_mfma_f32_16x16x32_bf16 v[56:59], a[76:79], v[112:115], v[56:59]
    s_waitcnt lgkmcnt(6)
    v_mfma_f32_16x16x32_bf16 v[60:63], v[112:115], a[80:83], v[60:63]
    s_waitcnt lgkmcnt(4)
    v_mfma_f32_16x16x32_bf16 v[64:67], v[112:115], a[84:87], v[64:67]
    s_waitcnt lgkmcnt(2)
    v_mfma_f32_16x16x32_bf16 v[68:71], v[112:115], a[88:91], v[68:71]
    s_waitcnt lgkmcnt(0)
    v_mfma_f32_16x16x32_bf16 v[72:75], v[112:115], a[92:95], v[72:75]
    s_waitcnt lgkmcnt(0)
    s_barrier
    ds_read_b128 v[108:111], v76 offset:39040
    ds_read_b128 v[112:115], v77 offset:39040
    ds_read_b64_tr_b16 a[0:1], v20 offset:39040
    ds_read_b64_tr_b16 a[2:3], v20 offset:39552
    ds_read_b64_tr_b16 a[4:5], v21 offset:39040
    ds_read_b64_tr_b16 a[6:7], v21 offset:39552
    ds_read_b64_tr_b16 a[8:9], v22 offset:39040
    ds_read_b64_tr_b16 a[10:11], v22 offset:39552
    ds_read_b64_tr_b16 a[12:13], v23 offset:39040
    ds_read_b64_tr_b16 a[14:15], v23 offset:39552
    ds_read_b64_tr_b16 a[16:17], v20 offset:47232
    ds_read_b64_tr_b16 a[18:19], v20 offset:47744
    ds_read_b64_tr_b16 a[20:21], v21 offset:47232
    ds_read_b64_tr_b16 a[22:23], v21 offset:47744
    ds_read_b64_tr_b16 a[24:25], v22 offset:47232
    ds_read_b64_tr_b16 a[26:27], v22 offset:47744
    s_waitcnt lgkmcnt(12)
    v_mfma_f32_16x16x32_bf16 v[28:31], a[0:3], v[108:111], v[28:31]
    ds_read_b64_tr_b16 a[28:29], v23 offset:47232
    ds_read_b64_tr_b16 a[30:31], v23 offset:47744
    s_waitcnt lgkmcnt(12)
    v_mfma_f32_16x16x32_bf16 v[32:35], a[4:7], v[108:111], v[32:35]
    ds_read_b64_tr_b16 a[32:33], v20 offset:55424
    ds_read_b64_tr_b16 a[34:35], v20 offset:55936
    s_waitcnt lgkmcnt(12)
    v_mfma_f32_16x16x32_bf16 v[36:39], a[8:11], v[108:111], v[36:39]
    ds_read_b64_tr_b16 a[36:37], v21 offset:55424
    ds_read_b64_tr_b16 a[38:39], v21 offset:55936
    s_waitcnt lgkmcnt(12)
    v_mfma_f32_16x16x32_bf16 v[40:43], a[12:15], v[108:111], v[40:43]
    ds_read_b64_tr_b16 a[40:41], v22 offset:55424
    ds_read_b64_tr_b16 a[42:43], v22 offset:55936
    s_waitcnt lgkmcnt(12)
    v_mfma_f32_16x16x32_bf16 v[44:47], a[16:19], v[108:111], v[44:47]
    ds_read_b64_tr_b16 a[44:45], v23 offset:55424
    ds_read_b64_tr_b16 a[46:47], v23 offset:55936
    s_waitcnt lgkmcnt(12)
    v_mfma_f32_16x16x32_bf16 v[48:51], a[20:23], v[108:111], v[48:51]
    ds_read_b64_tr_b16 a[48:49], v20 offset:43136
    ds_read_b64_tr_b16 a[50:51], v20 offset:43648
    s_waitcnt lgkmcnt(12)
    v_mfma_f32_16x16x32_bf16 v[52:55], a[24:27], v[108:111], v[52:55]
    ds_read_b64_tr_b16 a[52:53], v21 offset:43136
    ds_read_b64_tr_b16 a[54:55], v21 offset:43648
    s_waitcnt lgkmcnt(12)
    v_mfma_f32_16x16x32_bf16 v[56:59], a[28:31], v[108:111], v[56:59]
    ds_read_b64_tr_b16 a[56:57], v22 offset:43136
    ds_read_b64_tr_b16 a[58:59], v22 offset:43648
    s_waitcnt lgkmcnt(12)
    v_mfma_f32_16x16x32_bf16 v[60:63], v[108:111], a[32:35], v[60:63]
    ds_read_b64_tr_b16 a[60:61], v23 offset:43136
    ds_read_b64_tr_b16 a[62:63], v23 offset:43648
    s_waitcnt lgkmcnt(12)
    v_mfma_f32_16x16x32_bf16 v[64:67], v[108:111], a[36:39], v[64:67]
    ds_read_b64_tr_b16 a[64:65], v20 offset:51328
    ds_read_b64_tr_b16 a[66:67], v20 offset:51840
    s_waitcnt lgkmcnt(12)
    v_mfma_f32_16x16x32_bf16 v[68:71], v[108:111], a[40:43], v[68:71]
    ds_read_b64_tr_b16 a[68:69], v21 offset:51328
    ds_read_b64_tr_b16 a[70:71], v21 offset:51840
    s_waitcnt lgkmcnt(12)
    v_mfma_f32_16x16x32_bf16 v[72:75], v[108:111], a[44:47], v[72:75]
    ds_read_b64_tr_b16 a[72:73], v22 offset:51328
    ds_read_b64_tr_b16 a[74:75], v22 offset:51840
    s_waitcnt lgkmcnt(12)
    v_mfma_f32_16x16x32_bf16 v[28:31], a[48:51], v[112:115], v[28:31]
    ds_read_b64_tr_b16 a[76:77], v23 offset:51328
    ds_read_b64_tr_b16 a[78:79], v23 offset:51840
    s_waitcnt lgkmcnt(12)
    v_mfma_f32_16x16x32_bf16 v[32:35], a[52:55], v[112:115], v[32:35]
    ds_read_b64_tr_b16 a[80:81], v20 offset:59520
    ds_read_b64_tr_b16 a[82:83], v20 offset:60032
    s_waitcnt lgkmcnt(12)
    v_mfma_f32_16x16x32_bf16 v[36:39], a[56:59], v[112:115], v[36:39]
    ds_read_b64_tr_b16 a[84:85], v21 offset:59520
    ds_read_b64_tr_b16 a[86:87], v21 offset:60032
    s_waitcnt lgkmcnt(12)
    v_mfma_f32_16x16x32_bf16 v[40:43], a[60:63], v[112:115], v[40:43]
    ds_read_b64_tr_b16 a[88:89], v22 offset:59520
    ds_read_b64_tr_b16 a[90:91], v22 offset:60032
    s_waitcnt lgkmcnt(12)
    v_mfma_f32_16x16x32_bf16 v[44:47], a[64:67], v[112:115], v[44:47]
    ds_read_b64_tr_b16 a[92:93], v23 offset:59520
    ds_read_b64_tr_b16 a[94:95], v23 offset:60032
    s_waitcnt lgkmcnt(12)
    v_mfma_f32_16x16x32_bf16 v[48:51], a[68:71], v[112:115], v[48:51]
    s_waitcnt lgkmcnt(10)
    v_mfma_f32_16x16x32_bf16 v[52:55], a[72:75], v[112:115], v[52:55]
    s_waitcnt lgkmcnt(8)
    v_mfma_f32_16x16x32_bf16 v[56:59], a[76:79], v[112:115], v[56:59]
    s_waitcnt lgkmcnt(6)
    v_mfma_f32_16x16x32_bf16 v[60:63], v[112:115], a[80:83], v[60:63]
    s_waitcnt lgkmcnt(4)
    v_mfma_f32_16x16x32_bf16 v[64:67], v[112:115], a[84:87], v[64:67]
    s_waitcnt lgkmcnt(2)
    v_mfma_f32_16x16x32_bf16 v[68:71], v[112:115], a[88:91], v[68:71]
    s_waitcnt lgkmcnt(0)
    v_mfma_f32_16x16x32_bf16 v[72:75], v[112:115], a[92:95], v[72:75]
    s_waitcnt lgkmcnt(0)
    s_barrier
    ds_read_b128 a[96:99], v80 offset:0
    ds_read_b128 a[100:103], v81 offset:0
    ds_read_b64_tr_b16 a[0:1], v24 offset:0
    ds_read_b64_tr_b16 a[2:3], v24 offset:512
    ds_read_b64_tr_b16 a[4:5], v25 offset:0
    ds_read_b64_tr_b16 a[6:7], v25 offset:512
    ds_read_b64_tr_b16 a[8:9], v26 offset:0
    ds_read_b64_tr_b16 a[10:11], v26 offset:512
    ds_read_b64_tr_b16 a[12:13], v27 offset:0
    ds_read_b64_tr_b16 a[14:15], v27 offset:512
    ds_read_b64_tr_b16 a[16:17], v24 offset:8192
    ds_read_b64_tr_b16 a[18:19], v24 offset:8704
    ds_read_b64_tr_b16 a[20:21], v25 offset:8192
    ds_read_b64_tr_b16 a[22:23], v25 offset:8704
    ds_read_b64_tr_b16 a[24:25], v26 offset:8192
    ds_read_b64_tr_b16 a[26:27], v26 offset:8704
    s_waitcnt lgkmcnt(12)
    v_mfma_f32_16x16x32_bf16 v[28:31], a[0:3], a[96:99], v[28:31]
    ds_read_b64_tr_b16 a[28:29], v27 offset:8192
    ds_read_b64_tr_b16 a[30:31], v27 offset:8704
    s_waitcnt lgkmcnt(12)
    v_mfma_f32_16x16x32_bf16 v[32:35], a[4:7], a[96:99], v[32:35]
    ds_read_b64_tr_b16 a[48:49], v24 offset:4096
    ds_read_b64_tr_b16 a[50:51], v24 offset:4608
    s_waitcnt lgkmcnt(12)
    v_mfma_f32_16x16x32_bf16 v[36:39], a[8:11], a[96:99], v[36:39]
    ds_read_b64_tr_b16 a[52:53], v25 offset:4096
    ds_read_b64_tr_b16 a[54:55], v25 offset:4608
    s_waitcnt lgkmcnt(12)
    v_mfma_f32_16x16x32_bf16 v[40:43], a[12:15], a[96:99], v[40:43]
    ds_read_b64_tr_b16 a[56:57], v26 offset:4096
    ds_read_b64_tr_b16 a[58:59], v26 offset:4608
    s_waitcnt lgkmcnt(12)
    v_mfma_f32_16x16x32_bf16 v[44:47], a[16:19], a[96:99], v[44:47]
    ds_read_b64_tr_b16 a[60:61], v27 offset:4096
    ds_read_b64_tr_b16 a[62:63], v27 offset:4608
    s_waitcnt lgkmcnt(12)
    v_mfma_f32_16x16x32_bf16 v[48:51], a[20:23], a[96:99], v[48:51]
    ds_read_b64_tr_b16 a[64:65], v24 offset:12288
    ds_read_b64_tr_b16 a[66:67], v24 offset:12800
    s_waitcnt lgkmcnt(12)
    v_mfma_f32_16x16x32_bf16 v[52:55], a[24:27], a[96:99], v[52:55]
    ds_read_b64_tr_b16 a[68:69], v25 offset:12288
    ds_read_b64_tr_b16 a[70:71], v25 offset:12800
    s_waitcnt lgkmcnt(12)
    v_mfma_f32_16x16x32_bf16 v[56:59], a[28:31], a[96:99], v[56:59]
    ds_read_b64_tr_b16 a[72:73], v26 offset:12288
    ds_read_b64_tr_b16 a[74:75], v26 offset:12800
    s_waitcnt lgkmcnt(12)
    v_mfma_f32_16x16x32_bf16 v[28:31], a[48:51], a[100:103], v[28:31]
    ds_read_b64_tr_b16 a[76:77], v27 offset:12288
    ds_read_b64_tr_b16 a[78:79], v27 offset:12800
    s_waitcnt lgkmcnt(12)
    v_mfma_f32_16x16x32_bf16 v[32:35], a[52:55], a[100:103], v[32:35]
    s_waitcnt lgkmcnt(10)
    v_mfma_f32_16x16x32_bf16 v[36:39], a[56:59], a[100:103], v[36:39]
    s_waitcnt lgkmcnt(8)
    v_mfma_f32_16x16x32_bf16 v[40:43], a[60:63], a[100:103], v[40:43]
    s_waitcnt lgkmcnt(6)
    v_mfma_f32_16x16x32_bf16 v[44:47], a[64:67], a[100:103], v[44:47]
    s_waitcnt lgkmcnt(4)
    v_mfma_f32_16x16x32_bf16 v[48:51], a[68:71], a[100:103], v[48:51]
    s_waitcnt lgkmcnt(2)
    v_mfma_f32_16x16x32_bf16 v[52:55], a[72:75], a[100:103], v[52:55]
    s_waitcnt lgkmcnt(0)
    v_mfma_f32_16x16x32_bf16 v[56:59], a[76:79], a[100:103], v[56:59]
    buffer_load_dwordx2 v[92:93], v96, s[28:31], s52 offen sc1
    buffer_load_dwordx2 v[94:95], v97, s[28:31], s52 offen sc1
    s_waitcnt lgkmcnt(0)
    s_barrier
    ds_read_b128 a[104:107], v80 offset:39040
    ds_read_b128 a[108:111], v81 offset:39040
    ds_read_b64_tr_b16 a[0:1], v24 offset:39040
    ds_read_b64_tr_b16 a[2:3], v24 offset:39552
    ds_read_b64_tr_b16 a[4:5], v25 offset:39040
    ds_read_b64_tr_b16 a[6:7], v25 offset:39552
    ds_read_b64_tr_b16 a[8:9], v26 offset:39040
    ds_read_b64_tr_b16 a[10:11], v26 offset:39552
    ds_read_b64_tr_b16 a[12:13], v27 offset:39040
    ds_read_b64_tr_b16 a[14:15], v27 offset:39552
    ds_read_b64_tr_b16 a[16:17], v24 offset:47232
    ds_read_b64_tr_b16 a[18:19], v24 offset:47744
    ds_read_b64_tr_b16 a[20:21], v25 offset:47232
    ds_read_b64_tr_b16 a[22:23], v25 offset:47744
    ds_read_b64_tr_b16 a[24:25], v26 offset:47232
    ds_read_b64_tr_b16 a[26:27], v26 offset:47744
    s_waitcnt lgkmcnt(12)
    v_mfma_f32_16x16x32_bf16 v[28:31], a[0:3], a[104:107], v[28:31]
    ds_read_b64_tr_b16 a[28:29], v27 offset:47232
    ds_read_b64_tr_b16 a[30:31], v27 offset:47744
    s_waitcnt lgkmcnt(12)
    v_mfma_f32_16x16x32_bf16 v[32:35], a[4:7], a[104:107], v[32:35]
    ds_read_b64_tr_b16 a[48:49], v24 offset:43136
    ds_read_b64_tr_b16 a[50:51], v24 offset:43648
    s_waitcnt lgkmcnt(12)
    v_mfma_f32_16x16x32_bf16 v[36:39], a[8:11], a[104:107], v[36:39]
    ds_read_b64_tr_b16 a[52:53], v25 offset:43136
    ds_read_b64_tr_b16 a[54:55], v25 offset:43648
    s_waitcnt lgkmcnt(12)
    v_mfma_f32_16x16x32_bf16 v[40:43], a[12:15], a[104:107], v[40:43]
    ds_read_b64_tr_b16 a[56:57], v26 offset:43136
    ds_read_b64_tr_b16 a[58:59], v26 offset:43648
    s_waitcnt lgkmcnt(12)
    v_mfma_f32_16x16x32_bf16 v[44:47], a[16:19], a[104:107], v[44:47]
    ds_read_b64_tr_b16 a[60:61], v27 offset:43136
    ds_read_b64_tr_b16 a[62:63], v27 offset:43648
    s_waitcnt lgkmcnt(12)
    v_mfma_f32_16x16x32_bf16 v[48:51], a[20:23], a[104:107], v[48:51]
    ds_read_b64_tr_b16 a[64:65], v24 offset:51328
    ds_read_b64_tr_b16 a[66:67], v24 offset:51840
    s_waitcnt lgkmcnt(12)
    v_mfma_f32_16x16x32_bf16 v[52:55], a[24:27], a[104:107], v[52:55]
    ds_read_b64_tr_b16 a[68:69], v25 offset:51328
    ds_read_b64_tr_b16 a[70:71], v25 offset:51840
    s_waitcnt lgkmcnt(12)
    v_mfma_f32_16x16x32_bf16 v[56:59], a[28:31], a[104:107], v[56:59]
    ds_read_b64_tr_b16 a[72:73], v26 offset:51328
    ds_read_b64_tr_b16 a[74:75], v26 offset:51840
    s_waitcnt lgkmcnt(12)
    v_mfma_f32_16x16x32_bf16 v[28:31], a[48:51], a[108:111], v[28:31]
    ds_read_b64_tr_b16 a[76:77], v27 offset:51328
    ds_read_b64_tr_b16 a[78:79], v27 offset:51840
    s_waitcnt lgkmcnt(12)
    v_mfma_f32_16x16x32_bf16 v[32:35], a[52:55], a[108:111], v[32:35]
    s_waitcnt lgkmcnt(10)
    v_mfma_f32_16x16x32_bf16 v[36:39], a[56:59], a[108:111], v[36:39]
    s_waitcnt lgkmcnt(8)
    v_mfma_f32_16x16x32_bf16 v[40:43], a[60:63], a[108:111], v[40:43]
    s_waitcnt lgkmcnt(6)
    v_mfma_f32_16x16x32_bf16 v[44:47], a[64:67], a[108:111], v[44:47]
    s_waitcnt lgkmcnt(4)
    v_mfma_f32_16x16x32_bf16 v[48:51], a[68:71], a[108:111], v[48:51]
    s_waitcnt lgkmcnt(2)
    v_mfma_f32_16x16x32_bf16 v[52:55], a[72:75], a[108:111], v[52:55]
    s_waitcnt lgkmcnt(0)
    v_mfma_f32_16x16x32_bf16 v[56:59], a[76:79], a[108:111], v[56:59]
    s_waitcnt lgkmcnt(0)
    s_barrier
    ds_read_b128 a[112:115], v76 offset:0
    ds_read_b128 a[116:119], v77 offset:0
    ds_read_b64_tr_b16 a[0:1], v20 offset:0
    ds_read_b64_tr_b16 a[2:3], v20 offset:512
    ds_read_b64_tr_b16 a[4:5], v21 offset:0
    ds_read_b64_tr_b16 a[6:7], v21 offset:512
    ds_read_b64_tr_b16 a[8:9], v22 offset:0
    ds_read_b64_tr_b16 a[10:11], v22 offset:512
    ds_read_b64_tr_b16 a[12:13], v23 offset:0
    ds_read_b64_tr_b16 a[14:15], v23 offset:512
    ds_read_b64_tr_b16 a[16:17], v20 offset:8192
    ds_read_b64_tr_b16 a[18:19], v20 offset:8704
    ds_read_b64_tr_b16 a[20:21], v21 offset:8192
    ds_read_b64_tr_b16 a[22:23], v21 offset:8704
    ds_read_b64_tr_b16 a[24:25], v22 offset:8192
    ds_read_b64_tr_b16 a[26:27], v22 offset:8704
    s_waitcnt lgkmcnt(12)
    v_mfma_f32_16x16x32_bf16 v[28:31], a[0:3], a[112:115], v[28:31]
    ds_read_b64_tr_b16 a[28:29], v23 offset:8192
    ds_read_b64_tr_b16 a[30:31], v23 offset:8704
    s_waitcnt lgkmcnt(12)
    v_mfma_f32_16x16x32_bf16 v[32:35], a[4:7], a[112:115], v[32:35]
    ds_read_b64_tr_b16 a[48:49], v20 offset:4096
    ds_read_b64_tr_b16 a[50:51], v20 offset:4608
    s_waitcnt lgkmcnt(12)
    v_mfma_f32_16x16x32_bf16 v[36:39], a[8:11], a[112:115], v[36:39]
    ds_read_b64_tr_b16 a[52:53], v21 offset:4096
    ds_read_b64_tr_b16 a[54:55], v21 offset:4608
    s_waitcnt lgkmcnt(12)
    v_mfma_f32_16x16x32_bf16 v[40:43], a[12:15], a[112:115], v[40:43]
    ds_read_b64_tr_b16 a[56:57], v22 offset:4096
    ds_read_b64_tr_b16 a[58:59], v22 offset:4608
    s_waitcnt lgkmcnt(12)
    v_mfma_f32_16x16x32_bf16 v[44:47], a[16:19], a[112:115], v[44:47]
    ds_read_b64_tr_b16 a[60:61], v23 offset:4096
    ds_read_b64_tr_b16 a[62:63], v23 offset:4608
    s_waitcnt lgkmcnt(12)
    v_mfma_f32_16x16x32_bf16 v[48:51], a[20:23], a[112:115], v[48:51]
    ds_read_b64_tr_b16 a[64:65], v20 offset:12288
    ds_read_b64_tr_b16 a[66:67], v20 offset:12800
    s_waitcnt lgkmcnt(12)
    v_mfma_f32_16x16x32_bf16 v[52:55], a[24:27], a[112:115], v[52:55]
    ds_read_b64_tr_b16 a[68:69], v21 offset:12288
    ds_read_b64_tr_b16 a[70:71], v21 offset:12800
    s_waitcnt lgkmcnt(12)
    v_mfma_f32_16x16x32_bf16 v[56:59], a[28:31], a[112:115], v[56:59]
    ds_read_b64_tr_b16 a[72:73], v22 offset:12288
    ds_read_b64_tr_b16 a[74:75], v22 offset:12800
    s_waitcnt lgkmcnt(12)
    v_mfma_f32_16x16x32_bf16 v[28:31], a[48:51], a[116:119], v[28:31]
    ds_read_b64_tr_b16 a[76:77], v23 offset:12288
    ds_read_b64_tr_b16 a[78:79], v23 offset:12800
    s_waitcnt lgkmcnt(12)
    v_mfma_f32_16x16x32_bf16 v[32:35], a[52:55], a[116:119], v[32:35]
    s_waitcnt lgkmcnt(10)
    v_mfma_f32_16x16x32_bf16 v[36:39], a[56:59], a[116:119], v[36:39]
    s_waitcnt lgkmcnt(8)
    v_mfma_f32_16x16x32_bf16 v[40:43], a[60:63], a[116:119], v[40:43]
    s_waitcnt lgkmcnt(6)
    v_mfma_f32_16x16x32_bf16 v[44:47], a[64:67], a[116:119], v[44:47]
    s_waitcnt lgkmcnt(4)
    v_mfma_f32_16x16x32_bf16 v[48:51], a[68:71], a[116:119], v[48:51]
    s_waitcnt lgkmcnt(2)
    v_mfma_f32_16x16x32_bf16 v[52:55], a[72:75], a[116:119], v[52:55]
    s_waitcnt lgkmcnt(0)
    v_mfma_f32_16x16x32_bf16 v[56:59], a[76:79], a[116:119], v[56:59]
    s_waitcnt vmcnt(0)
    s_nop 6
Lst_chk:
    v_cmp_ne_u32 vcc, s38, v93
    v_cmp_ne_u32 s[40:41], s38, v95
    s_nop 0
    s_or_b64 s[40:41], s[40:41], vcc
    s_nop 1
    s_cbranch_scc1 Lst_re
    v_add_u32 v4, 156224, v12
    v_min_u32 v5, 47, v1
    v_lshlrev_b32 v5, 2, v5
    v_add_u32 v5, 156480, v5
    v_lshlrev_b32 v93, 16, v92
    v_and_b32 v92, 0xffff0000, v92
    v_rcp_f32 v93, v93
    ds_write_b32 v4, v92
    ds_write_b32 v4, v93 offset:512
    v_lshlrev_b32 v95, 16, v94
    v_and_b32 v94, 0xffff0000, v94
    v_rcp_f32 v95, v95
    ds_write_b32 v5, v94
    ds_write_b32 v5, v95 offset:512
    v_lshlrev_b32 v6, 4, v2
    v_add_u32 v6, 157184, v6
    v_mov_b32 v7, 157968
    v_lshlrev_b32 v8, 2, v3
    v_add_u32 v8, 156224, v8
    ds_read_b32 v120, v8
    s_waitcnt lgkmcnt(0)
    s_barrier
    ds_read_b128 a[120:123], v76 offset:39040
    ds_read_b128 a[124:127], v77 offset:39040
    ds_read_b64_tr_b16 a[0:1], v20 offset:39040
    ds_read_b64_tr_b16 a[2:3], v20 offset:39552
    ds_read_b64_tr_b16 a[4:5], v21 offset:39040
    ds_read_b64_tr_b16 a[6:7], v21 offset:39552
    ds_read_b64_tr_b16 a[8:9], v22 offset:39040
    ds_read_b64_tr_b16 a[10:11], v22 offset:39552
    ds_read_b64_tr_b16 a[12:13], v23 offset:39040
    ds_read_b64_tr_b16 a[14:15], v23 offset:39552
    ds_read_b64_tr_b16 a[16:17], v20 offset:47232
    ds_read_b64_tr_b16 a[18:19], v20 offset:47744
    ds_read_b64_tr_b16 a[20:21], v21 offset:47232
    ds_read_b64_tr_b16 a[22:23], v21 offset:47744
    ds_read_b64_tr_b16 a[24:25], v22 offset:47232
    ds_read_b64_tr_b16 a[26:27], v22 offset:47744
    s_waitcnt lgkmcnt(12)
    v_mfma_f32_16x16x32_bf16 v[28:31], a[0:3], a[120:123], v[28:31]
    ds_read_b64_tr_b16 a[28:29], v23 offset:47232
    ds_read_b64_tr_b16 a[30:31], v23 offset:47744
    s_waitcnt lgkmcnt(12)
    v_mfma_f32_16x16x32_bf16 v[32:35], a[4:7], a[120:123], v[32:35]
    ds_read_b64_tr_b16 a[48:49], v20 offset:43136
    ds_read_b64_tr_b16 a[50:51], v20 offset:43648
    s_waitcnt lgkmcnt(12)
    v_mfma_f32_16x16x32_bf16 v[36:39], a[8:11], a[120:123], v[36:39]
    ds_read_b64_tr_b16 a[52:53], v21 offset:43136
    ds_read_b64_tr_b16 a[54:55], v21 offset:43648
    s_waitcnt lgkmcnt(12)
    v_mfma_f32_16x16x32_bf16 v[40:43], a[12:15], a[120:123], v[40:43]
    ds_read_b64_tr_b16 a[56:57], v22 offset:43136
    ds_read_b64_tr_b16 a[58:59], v22 offset:43648
    s_waitcnt lgkmcnt(12)
    v_mfma_f32_16x16x32_bf16 v[44:47], a[16:19], a[120:123], v[44:47]
    ds_read_b64_tr_b16 a[60:61], v23 offset:43136
    ds_read_b64_tr_b16 a[62:63], v23 offset:43648
    s_waitcnt lgkmcnt(12)
    v_mfma_f32_16x16x32_bf16 v[48:51], a[20:23], a[120:123], v[48:51]
    ds_read_b64_tr_b16 a[64:65], v20 offset:51328
    ds_read_b64_tr_b16 a[66:67], v20 offset:51840
    s_waitcnt lgkmcnt(12)
    v_mfma_f32_16x16x32_bf16 v[52:55], a[24:27], a[120:123], v[52:55]
    ds_read_b64_tr_b16 a[68:69], v21 offset:51328
    ds_read_b64_tr_b16 a[70:71], v21 offset:51840
    s_waitcnt lgkmcnt(12)
    v_mfma_f32_16x16x32_bf16 v[56:59], a[28:31], a[120:123], v[56:59]
    ds_read_b64_tr_b16 a[72:73], v22 offset:51328
    ds_read_b64_tr_b16 a[74:75], v22 offset:51840
    s_waitcnt lgkmcnt(12)
    v_mfma_f32_16x16x32_bf16 v[28:31], a[48:51], a[124:127], v[28:31]
    ds_read_b64_tr_b16 a[76:77], v23 offset:51328
    ds_read_b64_tr_b16 a[78:79], v23 offset:51840
    s_waitcnt lgkmcnt(12)
    v_mfma_f32_16x16x32_bf16 v[32:35], a[52:55], a[124:127], v[32:35]
    s_waitcnt lgkmcnt(10)
    v_mfma_f32_16x16x32_bf16 v[36:39], a[56:59], a[124:127], v[36:39]
    s_waitcnt lgkmcnt(8)
    v_mfma_f32_16x16x32_bf16 v[40:43], a[60:63], a[124:127], v[40:43]
    s_waitcnt lgkmcnt(6)
    v_mfma_f32_16x16x32_bf16 v[44:47], a[64:67], a[124:127], v[44:47]
    s_waitcnt lgkmcnt(4)
    v_mfma_f32_16x16x32_bf16 v[48:51], a[68:71], a[124:127], v[48:51]
    s_waitcnt lgkmcnt(2)
    v_mfma_f32_16x16x32_bf16 v[52:55], a[72:75], a[124:127], v[52:55]
    s_waitcnt lgkmcnt(0)
    v_mfma_f32_16x16x32_bf16 v[56:59], a[76:79], a[124:127], v[56:59]
    s_mov_b32 exec_lo, 0x00010001
    s_mov_b32 exec_hi, 0x00010001
    ds_write_b128 v6, v[28:31] offset:0
    ds_write_b128 v6, v[32:35] offset:64
    ds_write_b128 v6, v[36:39] offset:128
    ds_write_b128 v6, v[40:43] offset:192
    ds_write_b128 v6, v[44:47] offset:256
    ds_write_b128 v6, v[48:51] offset:320
    ds_write_b128 v6, v[52:55] offset:384
    ds_write_b128 v6, v[56:59] offset:448
    ds_write_b32 v7, v7
    s_mov_b64 exec, -1
    ds_read_b128 v[76:79], v6 offset:256
    ds_read_b128 v[80:83], v6 offset:320
    ds_read_b128 v[84:87], v6 offset:384
    ds_read_b128 v[88:91], v6 offset:448
    s_waitcnt lgkmcnt(0)
    v_fmac_f32 v44, v76, v120
    v_fmac_f32 v45, v77, v120
    v_fmac_f32 v46, v78, v120
    v_fmac_f32 v47, v79, v120
    v_cvt_pk_bf16_f32 v44, v44, v45
    v_cvt_pk_bf16_f32 v45, v46, v47
    v_fmac_f32 v48, v80, v120
    v_fmac_f32 v49, v81, v120
    v_fmac_f32 v50, v82, v120
    v_fmac_f32 v51, v83, v120
    v_cvt_pk_bf16_f32 v46, v48, v49
    v_cvt_pk_bf16_f32 v47, v50, v51
    v_fmac_f32 v52, v84, v120
    v_fmac_f32 v53, v85, v120
    v_fmac_f32 v54, v86, v120
    v_fmac_f32 v55, v87, v120
    v_cvt_pk_bf16_f32 v48, v52, v53
    v_cvt_pk_bf16_f32 v49, v54, v55
    v_fmac_f32 v56, v88, v120
    v_fmac_f32 v57, v89, v120
    v_fmac_f32 v58, v90, v120
    v_fmac_f32 v59, v91, v120
    v_cvt_pk_bf16_f32 v50, v56, v57
    v_cvt_pk_bf16_f32 v51, v58, v59
    ds_write_b128 v125, v[44:47] offset:4096
    ds_write_b128 v125, v[48:51] offset:5120
    v_mov_b32 v5, 157972
    v_mov_b32 v6, 1
    s_mov_b64 exec, 1
    ds_add_u32 v5, v6
    s_mov_b64 exec, -1
    v_mov_b32 v5, 157980
    s_nop 1
Lcw_4:
    s_sub_u32 s39, s39, 1
    s_cbranch_scc1 Lend
    ds_read_b32 v6, v5
    s_waitcnt lgkmcnt(0)
    v_readfirstlane_b32 s42, v6
    s_nop 0
    s_cmp_lt_u32 s42, 1
    s_nop 1
    s_cbranch_scc1 Lcw_4
    ds_read_b64_tr_b16 a[0:1], v24 offset:16384
    ds_read_b64_tr_b16 a[2:3], v24 offset:16896
    ds_read_b64_tr_b16 a[4:5], v25 offset:16384
    ds_read_b64_tr_b16 a[6:7], v25 offset:16896
    ds_read_b64_tr_b16 a[8:9], v26 offset:16384
    ds_read_b64_tr_b16 a[10:11], v26 offset:16896
    ds_read_b64_tr_b16 a[12:13], v27 offset:16384
    ds_read_b64_tr_b16 a[14:15], v27 offset:16896
    ds_read_b64_tr_b16 a[16:17], v24 offset:20480
    ds_read_b64_tr_b16 a[18:19], v24 offset:20992
    ds_read_b64_tr_b16 a[20:21], v25 offset:20480
    ds_read_b64_tr_b16 a[22:23], v25 offset:20992
    ds_read_b64_tr_b16 a[24:25], v26 offset:20480
    ds_read_b64_tr_b16 a[26:27], v26 offset:20992
    ds_read_b64_tr_b16 a[28:29], v27 offset:20480
    ds_read_b64_tr_b16 a[30:31], v27 offset:20992
    ds_read_b64_tr_b16 a[32:33], v24 offset:55424
    ds_read_b64_tr_b16 a[34:35], v24 offset:55936
    ds_read_b64_tr_b16 a[36:37], v25 offset:55424
    ds_read_b64_tr_b16 a[38:39], v25 offset:55936
    ds_read_b64_tr_b16 a[40:41], v26 offset:55424
    ds_read_b64_tr_b16 a[42:43], v26 offset:55936
    ds_read_b64_tr_b16 a[44:45], v27 offset:55424
    ds_read_b64_tr_b16 a[46:47], v27 offset:55936
    ds_read_b64_tr_b16 a[48:49], v24 offset:59520
    ds_read_b64_tr_b16 a[50:51], v24 offset:60032
    ds_read_b64_tr_b16 a[52:53], v25 offset:59520
    ds_read_b64_tr_b16 a[54:55], v25 offset:60032
    ds_read_b64_tr_b16 a[56:57], v26 offset:59520
    ds_read_b64_tr_b16 a[58:59], v26 offset:60032
    ds_read_b64_tr_b16 a[60:61], v27 offset:59520
    ds_read_b64_tr_b16 a[62:63], v27 offset:60032
    ds_read_b64_tr_b16 a[64:65], v20 offset:16384
    ds_read_b64_tr_b16 a[66:67], v20 offset:16896
    ds_read_b64_tr_b16 a[68:69], v21 offset:16384
    ds_read_b64_tr_b16 a[70:71], v21 offset:16896
    ds_read_b64_tr_b16 a[72:73], v22 offset:16384
    ds_read_b64_tr_b16 a[74:75], v22 offset:16896
    ds_read_b64_tr_b16 a[76:77], v23 offset:16384
    ds_read_b64_tr_b16 a[78:79], v23 offset:16896
    ds_read_b64_tr_b16 a[80:81], v20 offset:20480
    ds_read_b64_tr_b16 a[82:83], v20 offset:20992
    ds_read_b64_tr_b16 a[84:85], v21 offset:20480
    ds_read_b64_tr_b16 a[86:87], v21 offset:20992
    ds_read_b64_tr_b16 a[88:89], v22 offset:20480
    ds_read_b64_tr_b16 a[90:91], v22 offset:20992
    ds_read_b64_tr_b16 a[92:93], v23 offset:20480
    ds_read_b64_tr_b16 a[94:95], v23 offset:20992
    s_waitcnt lgkmcnt(15)
    v_mfma_f32_16x16x32_bf16 v[60:63], a[96:99], a[0:3], v[60:63]
    v_mfma_f32_16x16x32_bf16 v[64:67], a[96:99], a[4:7], v[64:67]
    v_mfma_f32_16x16x32_bf16 v[68:71], a[96:99], a[8:11], v[68:71]
    v_mfma_f32_16x16x32_bf16 v[72:75], a[96:99], a[12:15], v[72:75]
    ds_read_b64_tr_b16 a[0:1], v20 offset:55424
    ds_read_b64_tr_b16 a[2:3], v20 offset:55936
    ds_read_b64_tr_b16 a[4:5], v21 offset:55424
    ds_read_b64_tr_b16 a[6:7], v21 offset:55936
    ds_read_b64_tr_b16 a[8:9], v22 offset:55424
    ds_read_b64_tr_b16 a[10:11], v22 offset:55936
    ds_read_b64_tr_b16 a[12:13], v23 offset:55424
    ds_read_b64_tr_b16 a[14:15], v23 offset:55936
    v_mfma_f32_16x16x32_bf16 v[60:63], a[100:103], a[16:19], v[60:63]
    v_mfma_f32_16x16x32_bf16 v[64:67], a[100:103], a[20:23], v[64:67]
    v_mfma_f32_16x16x32_bf16 v[68:71], a[100:103], a[24:27], v[68:71]
    v_mfma_f32_16x16x32_bf16 v[72:75], a[100:103], a[28:31], v[72:75]
    ds_read_b64_tr_b16 a[16:17], v20 offset:59520
    ds_read_b64_tr_b16 a[18:19], v20 offset:60032
    ds_read_b64_tr_b16 a[20:21], v21 offset:59520
    ds_read_b64_tr_b16 a[22:23], v21 offset:60032
    ds_read_b64_tr_b16 a[24:25], v22 offset:59520
    ds_read_b64_tr_b16 a[26:27], v22 offset:60032
    ds_read_b64_tr_b16 a[28:29], v23 offset:59520
    ds_read_b64_tr_b16 a[30:31], v23 offset:60032
    v_mfma_f32_16x16x32_bf16 v[60:63], a[104:107], a[32:35], v[60:63]
    v_mfma_f32_16x16x32_bf16 v[64:67], a[104:107], a[36:39], v[64:67]
    v_mfma_f32_16x16x32_bf16 v[68:71], a[104:107], a[40:43], v[68:71]
    v_mfma_f32_16x16x32_bf16 v[72:75], a[104:107], a[44:47], v[72:75]
    v_mfma_f32_16x16x32_bf16 v[60:63], a[108:111], a[48:51], v[60:63]
    v_mfma_f32_16x16x32_bf16 v[64:67], a[108:111], a[52:55], v[64:67]
    v_mfma_f32_16x16x32_bf16 v[68:71], a[108:111], a[56:59], v[68:71]
    v_mfma_f32_16x16x32_bf16 v[72:75], a[108:111], a[60:63], v[72:75]
    s_waitcnt lgkmcnt(15)
    v_mfma_f32_16x16x32_bf16 v[60:63], a[112:115], a[64:67], v[60:63]
    v_mfma_f32_16x16x32_bf16 v[64:67], a[112:115], a[68:71], v[64:67]
    v_mfma_f32_16x16x32_bf16 v[68:71], a[112:115], a[72:75], v[68:71]
    v_mfma_f32_16x16x32_bf16 v[72:75], a[112:115], a[76:79], v[72:75]
    v_mfma_f32_16x16x32_bf16 v[60:63], a[116:119], a[80:83], v[60:63]
    v_mfma_f32_16x16x32_bf16 v[64:67], a[116:119], a[84:87], v[64:67]
    v_mfma_f32_16x16x32_bf16 v[68:71], a[116:119], a[88:91], v[68:71]
    v_mfma_f32_16x16x32_bf16 v[72:75], a[116:119], a[92:95], v[72:75]
    s_waitcnt lgkmcnt(8)
    v_mfma_f32_16x16x32_bf16 v[60:63], a[120:123], a[0:3], v[60:63]
    v_mfma_f32_16x16x32_bf16 v[64:67], a[120:123], a[4:7], v[64:67]
    v_mfma_f32_16x16x32_bf16 v[68:71], a[120:123], a[8:11], v[68:71]
    v_mfma_f32_16x16x32_bf16 v[72:75], a[120:123], a[12:15], v[72:75]
    s_waitcnt lgkmcnt(0)
    v_mfma_f32_16x16x32_bf16 v[60:63], a[124:127], a[16:19], v[60:63]
    v_mfma_f32_16x16x32_bf16 v[64:67], a[124:127], a[20:23], v[64:67]
    v_mfma_f32_16x16x32_bf16 v[68:71], a[124:127], a[24:27], v[68:71]
    v_mfma_f32_16x16x32_bf16 v[72:75], a[124:127], a[28:31], v[72:75]
    v_lshlrev_b32 v5, 4, v3
    v_add_u32 v5, 157696, v5
    v_mov_b32 v6, 157952
    v_lshlrev_b32 v4, 4, v2
    v_add_u32 v4, 156224, v4
    v_lshl_add_u32 v125, v1, 3, s47
    s_mov_b64 exec, 0xffff
    ds_write_b32 v5, v60 offset:0
    ds_write_b32 v5, v64 offset:4
    ds_write_b32 v5, v68 offset:8
    ds_write_b32 v5, v72 offset:12
    ds_write_b32 v6, v6
    s_mov_b64 exec, -1
    ds_read_b128 v[36:39], v5
    ds_read_b128 v[28:31], v4
    ds_read_b128 v[32:35], v4 offset:512
    s_waitcnt lgkmcnt(0)
    v_fmac_f32 v60, v28, v36
    v_fmac_f32 v61, v29, v36
    v_fmac_f32 v62, v30, v36
    v_fmac_f32 v63, v31, v36
    v_mul_f32 v60, v60, v32
    v_mul_f32 v61, v61, v33
    v_mul_f32 v62, v62, v34
    v_mul_f32 v63, v63, v35
    v_cvt_pk_bf16_f32 v60, v60, v61
    v_cvt_pk_bf16_f32 v61, v62, v63
    ds_write_b64 v125, v[60:61] offset:0
    v_fmac_f32 v64, v28, v37
    v_fmac_f32 v65, v29, v37
    v_fmac_f32 v66, v30, v37
    v_fmac_f32 v67, v31, v37
    v_mul_f32 v64, v64, v32
    v_mul_f32 v65, v65, v33
    v_mul_f32 v66, v66, v34
    v_mul_f32 v67, v67, v35
    v_cvt_pk_bf16_f32 v64, v64, v65
    v_cvt_pk_bf16_f32 v65, v66, v67
    ds_write_b64 v125, v[64:65] offset:512
    v_fmac_f32 v68, v28, v38
    v_fmac_f32 v69, v29, v38
    v_fmac_f32 v70, v30, v38
    v_fmac_f32 v71, v31, v38
    v_mul_f32 v68, v68, v32
    v_mul_f32 v69, v69, v33
    v_mul_f32 v70, v70, v34
    v_mul_f32 v71, v71, v35
    v_cvt_pk_bf16_f32 v68, v68, v69
    v_cvt_pk_bf16_f32 v69, v70, v71
    ds_write_b64 v125, v[68:69] offset:1024
    v_fmac_f32 v72, v28, v39
    v_fmac_f32 v73, v29, v39
    v_fmac_f32 v74, v30, v39
    v_fmac_f32 v75, v31, v39
    v_mul_f32 v72, v72, v32
    v_mul_f32 v73, v73, v33
    v_mul_f32 v74, v74, v34
    v_mul_f32 v75, v75, v35
    v_cvt_pk_bf16_f32 v72, v72, v73
    v_cvt_pk_bf16_f32 v73, v74, v75
    ds_write_b64 v125, v[72:73] offset:1536
    v_mov_b32 v8, 157976
    v_mov_b32 v9, 1
    s_mov_b64 exec, 1
    ds_add_u32 v8, v9
    s_mov_b64 exec, -1
    s_endpgm
Lst_re:
    s_sub_u32 s39, s39, 1
    s_cbranch_scc1 Lend
    buffer_load_dwordx2 v[92:93], v96, s[28:31], s52 offen sc1
    buffer_load_dwordx2 v[94:95], v97, s[28:31], s52 offen sc1
    s_waitcnt vmcnt(0)
    s_branch Lst_chk
Laux:
    s_mul_i32 s36, s40, 9
    s_lshl_b32 s42, s42, 2
    s_add_u32 s36, s36, s42
    s_add_u32 s36, s36, s41
    s_cmp_lt_u32 s36, 32
    s_cbranch_scc1 Laux2
    s_cmp_lg_u32 s3, 0
    s_cbranch_scc1 Lend
    s_waitcnt lgkmcnt(0)
    s_mov_b64 s[28:29], s[24:25]
    s_mov_b32 s30, 268435456
    s_mov_b32 s31, 0x20000
    s_mov_b64 s[32:33], s[22:23]
    s_mov_b32 s34, 256
    s_mov_b32 s35, 0x20000
    s_load_dword s38, s[28:29], 0
    s_waitcnt lgkmcnt(0)
    s_add_u32 s38, s38, 0x9e3779b8
    s_or_b32 s38, s38, 1
    s_mov_b64 exec, 1
    s_lshl_b32 s40, s2, 2
    s_add_u32 s40, s40, 8323072
    v_mov_b32 v4, s38
    v_mov_b32 v5, s40
    buffer_store_dword v4, v5, s[28:31], 0 offen sc1
    s_mov_b64 exec, -1
    s_cmp_lg_u32 s36, 32
    s_cbranch_scc1 Lend
Lpt_6:
    s_sub_u32 s39, s39, 1
    s_cbranch_scc1 Lend
    buffer_load_dword v4, v12, s[32:35], 0 offen offset:64 sc1
    v_lshrrev_b32 v5, 1, v12
    v_and_b32 v5, 0x3c, v5
    v_add_u32 v5, 128, v5
    s_waitcnt vmcnt(0)
    ds_bpermute_b32 v5, v5, v4
    v_and_b32 v6, 4, v12
    v_lshlrev_b32 v6, 2, v6
    s_waitcnt lgkmcnt(0)
    v_bfe_u32 v5, v5, v6, 16
    v_cmp_ne_u32 vcc, 0, v4
    v_cmp_ne_u32 s[40:41], 0, v5
    s_nop 0
    s_and_b32 s40, s40, vcc_lo
    s_cmp_eq_u32 s40, -1
    s_nop 0
    s_cbranch_scc1 Lptd_7
    s_sleep 2
    s_branch Lpt_6
Lptd_7:
    v_lshlrev_b32 v6, 4, v12
    v_and_b32 v7, 63, v5
    v_add_u32 v7, v7, v6
    v_sub_u32 v7, 2047, v7
    v_bfe_u32 v5, v5, 6, 6
    v_add_u32 v5, v5, v6
    v_sub_u32 v5, 2047, v5
    v_and_b32 v6, 0xffff0000, v4
    v_or_b32 v7, v7, v6
    v_lshl_or_b32 v5, v4, 16, v5
    v_cmp_gt_u32 vcc, 128, v12
    s_nop 1
    v_cndmask_b32 v7, 0, v7, vcc
    v_cndmask_b32 v5, 0, v5, vcc
    v_mov_b32 v4, v7
    s_nop 1
    v_max_u32_dpp v4, v4, v4 row_ror:8 row_mask:0xf bank_mask:0xf
    s_nop 1
    v_max_u32_dpp v4, v4, v4 row_ror:4 row_mask:0xf bank_mask:0xf
    s_nop 1
    v_max_u32_dpp v4, v4, v4 row_ror:2 row_mask:0xf bank_mask:0xf
    s_nop 1
    v_max_u32_dpp v4, v4, v4 row_ror:1 row_mask:0xf bank_mask:0xf
    s_nop 0
    v_readlane_b32 s44, v4, 0
    v_readlane_b32 s40, v4, 16
    v_readlane_b32 s41, v4, 32
    v_readlane_b32 s42, v4, 48
    s_max_u32 s44, s44, s40
    s_max_u32 s41, s41, s42
    s_max_u32 s44, s44, s41
    v_cmp_eq_u32 vcc, s44, v7
    s_nop 1
    v_cndmask_b32 v4, v7, v5, vcc
    s_nop 1
    v_max_u32_dpp v4, v4, v4 row_ror:8 row_mask:0xf bank_mask:0xf
    s_nop 1
    v_max_u32_dpp v4, v4, v4 row_ror:4 row_mask:0xf bank_mask:0xf
    s_nop 1
    v_max_u32_dpp v4, v4, v4 row_ror:2 row_mask:0xf bank_mask:0xf
    s_nop 1
    v_max_u32_dpp v4, v4, v4 row_ror:1 row_mask:0xf bank_mask:0xf
    s_nop 0
    v_readlane_b32 s45, v4, 0
    v_readlane_b32 s40, v4, 16
    v_readlane_b32 s41, v4, 32
    v_readlane_b32 s42, v4, 48
    s_max_u32 s45, s45, s40
    s_max_u32 s41, s41, s42
    s_max_u32 s45, s45, s41
    v_mov_b32 v8, s44
    v_mov_b32 v9, s38
    v_mov_b32 v10, s45
    v_mov_b32 v11, s38
    v_lshlrev_b32 v4, 7, v1
    s_mov_b32 s40, 8257536
    buffer_store_dwordx4 v[8:11], v4, s[28:31], s40 offen sc1
    s_add_u32 s40, s40, 8192
    buffer_store_dwordx4 v[8:11], v4, s[28:31], s40 offen sc1
    s_add_u32 s40, s40, 8192
    buffer_store_dwordx4 v[8:11], v4, s[28:31], s40 offen sc1
    s_add_u32 s40, s40, 8192
    buffer_store_dwordx4 v[8:11], v4, s[28:31], s40 offen sc1
    s_add_u32 s40, s40, 8192
    s_mov_b32 s40, 8323072
Lmaster:
    s_sub_u32 s39, s39, 1
    s_cbranch_scc1 Lend
    s_sleep 16
    buffer_load_dwordx4 v[4:7], v13, s[28:31], s40 offen sc1
    s_waitcnt vmcnt(0)
    v_xor_b32 v4, s38, v4
    v_xor_b32 v5, s38, v5
    v_xor_b32 v6, s38, v6
    v_xor_b32 v7, s38, v7
    v_or3_b32 v4, v4, v5, v6
    v_or_b32 v4, v4, v7
    v_cmp_ne_u32 vcc, 0, v4
    s_nop 3
    s_cbranch_vccnz Lmaster
    s_mov_b64 exec, 1
    buffer_store_dword v9, v4, s[28:31], 0 offen sc1
    s_endpgm
Laux2:
    v_lshrrev_b32 v5, 3, v1
    v_and_b32 v6, 7, v1
    s_lshl_b32 s44, s26, 11
    s_lshl_b32 s40, s36, 6
    s_lshl_b32 s41, s26, 4
    s_add_u32 s40, s40, s41
    v_add_u32 v7, s40, v5
    v_mul_u32_u24 v7, 1280, v7
    s_cmp_eq_u32 s27, 0
    s_cbranch_scc0 Laux_ld
    v_xor_b32 v8, v6, v2
    v_lshl_add_u32 v20, v8, 4, v7
    v_xor_b32 v21, 64, v20
    v_add_u32 v21, 9216, v21
    s_waitcnt lgkmcnt(0)
    s_mov_b64 s[48:49], s[4:5]
    s_mov_b32 s50, 2621440
    s_mov_b32 s51, 0x20000
    s_mov_b64 s[52:53], s[12:13]
    s_mov_b32 s54, 1280
    s_mov_b32 s55, 0x20000
    s_mov_b32 m0, 155648
    s_nop 0
    buffer_load_dwordx4 v13, s[52:55], 0 offen lds
    s_mov_b64 exec, 0xffff
    buffer_load_dwordx4 v13, s[52:55], 0 offen offset:1024 lds
    s_mov_b64 exec, -1
    s_add_u32 m0, s44, 0
    s_mov_b32 s45, 0
    buffer_load_dwordx4 v20, s[48:51], s45 offen lds
    buffer_load_dwordx4 v21, s[48:51], s45 offen offset:1024 lds
    s_add_u32 m0, s44, 8192
    s_mov_b32 s45, 128
    buffer_load_dwordx4 v20, s[48:51], s45 offen lds
    buffer_load_dwordx4 v21, s[48:51], s45 offen offset:1024 lds
    s_add_u32 m0, s44, 16384
    s_mov_b32 s45, 256
    buffer_load_dwordx4 v20, s[48:51], s45 offen lds
    buffer_load_dwordx4 v21, s[48:51], s45 offen offset:1024 lds
    s_add_u32 m0, s44, 24576
    s_mov_b32 s45, 384
    buffer_load_dwordx4 v20, s[48:51], s45 offen lds
    buffer_load_dwordx4 v21, s[48:51], s45 offen offset:1024 lds
    s_add_u32 m0, s44, 32768
    s_mov_b32 s45, 512
    buffer_load_dwordx4 v20, s[48:51], s45 offen lds
    buffer_load_dwordx4 v21, s[48:51], s45 offen offset:1024 lds
    s_add_u32 m0, s44, 40960
    s_mov_b32 s45, 640
    buffer_load_dwordx4 v20, s[48:51], s45 offen lds
    buffer_load_dwordx4 v21, s[48:51], s45 offen offset:1024 lds
    s_add_u32 m0, s44, 49152
    s_mov_b32 s45, 768
    buffer_load_dwordx4 v20, s[48:51], s45 offen lds
    buffer_load_dwordx4 v21, s[48:51], s45 offen offset:1024 lds
    s_add_u32 m0, s44, 57344
    s_mov_b32 s45, 896
    buffer_load_dwordx4 v20, s[48:51], s45 offen lds
    buffer_load_dwordx4 v21, s[48:51], s45 offen offset:1024 lds
    s_add_u32 m0, s44, 65536
    s_mov_b32 s45, 1024
    buffer_load_dwordx4 v20, s[48:51], s45 offen lds
    buffer_load_dwordx4 v21, s[48:51], s45 offen offset:1024 lds
    s_add_u32 m0, s44, 73728
    s_mov_b32 s45, 1152
    buffer_load_dwordx4 v20, s[48:51], s45 offen lds
    buffer_load_dwordx4 v21, s[48:51], s45 offen offset:1024 lds
    s_mov_b64 s[28:29], s[24:25]
    s_mov_b32 s30, 268435456
    s_mov_b32 s31, 0x20000
    s_mov_b64 s[32:33], s[22:23]
    s_mov_b32 s34, 256
    s_mov_b32 s35, 0x20000
    s_load_dword s38, s[28:29], 0
    v_mov_b32 v22, 0x3f803f80
    v_mov_b32 v23, 0x3f803f80
    v_mov_b32 v24, 0x3f803f80
    v_mov_b32 v25, 0x3f803f80
    v_lshlrev_b32 v15, 4, v2
    v_add_u32 v15, 155648, v15
    v_lshrrev_b32 v10, 1, v3
    v_xor_b32 v10, v10, v2
    v_lshlrev_b32 v10, 4, v10
    v_lshl_add_u32 v10, v3, 7, v10
    v_add_u32 v26, s44, v10
    v_xor_b32 v27, 64, v26
    v_add_u32 v28, 40960, v26
    v_add_u32 v29, 40960, v27
    s_mov_b32 s46, 0xaaaaaaaa
    s_mov_b32 s47, 0xaaaaaaaa
    s_mov_b32 s56, 0xcccccccc
    s_mov_b32 s57, 0xcccccccc
    v_lshrrev_b32 v19, 2, v3
    v_lshl_add_u32 v19, v19, 4, v3
    v_lshlrev_b32 v19, 2, v19
    v_bfe_u32 v10, v1, 2, 2
    v_and_b32 v8, 3, v1
    v_lshl_add_u32 v14, v2, 3, v10
    v_lshlrev_b32 v14, 7, v14
    v_lshlrev_b32 v9, 2, v1
    v_and_b32 v9, 0x60, v9
    v_add_u32 v14, v14, v9
    v_lshl_add_u32 v14, v8, 3, v14
    s_lshl_b32 s40, s26, 5
    v_xor_b32 v16, s40, v14
    v_add_u32 v17, 57344, v16
    v_add_u32 v18, 114688, v16
    s_waitcnt lgkmcnt(0)
    s_add_u32 s38, s38, 0x9e3779b8
    s_or_b32 s38, s38, 1
    s_waitcnt vmcnt(18)
    ds_read_b128 a[80:83], v26 offset:0
    ds_read_b128 a[84:87], v15 offset:0
    ds_read_b128 a[88:91], v27 offset:0
    ds_read_b128 a[92:95], v15 offset:64
    s_waitcnt vmcnt(16)
    ds_read_b128 a[96:99], v26 offset:8192
    ds_read_b128 a[100:103], v15 offset:128
    ds_read_b128 a[104:107], v27 offset:8192
    ds_read_b128 a[108:111], v15 offset:192
    s_waitcnt lgkmcnt(4)
    v_mfma_f32_16x16x32_bf16 v[36:39], a[80:83], a[80:83], 0
    v_mfma_f32_16x16x32_bf16 v[32:35], v[22:25], a[80:83], 0
    v_mfma_f32_16x16x32_bf16 v[40:43], a[84:87], a[80:83], 0
    v_mfma_f32_16x16x32_bf16 v[44:47], a[84:87], v[22:25], 0
    v_mfma_f32_16x16x32_bf16 v[36:39], a[88:91], a[88:91], v[36:39]
    v_mfma_f32_16x16x32_bf16 v[32:35], v[22:25], a[88:91], v[32:35]
    v_mfma_f32_16x16x32_bf16 v[40:43], a[92:95], a[88:91], v[40:43]
    v_mfma_f32_16x16x32_bf16 v[44:47], a[92:95], v[22:25], v[44:47]
    s_waitcnt vmcnt(14)
    ds_read_b128 a[80:83], v26 offset:16384
    ds_read_b128 a[84:87], v15 offset:256
    ds_read_b128 a[88:91], v27 offset:16384
    ds_read_b128 a[92:95], v15 offset:320
    s_waitcnt lgkmcnt(4)
    v_mfma_f32_16x16x32_bf16 v[36:39], a[96:99], a[96:99], v[36:39]
    v_mfma_f32_16x16x32_bf16 v[32:35], v[22:25], a[96:99], v[32:35]
    v_mfma_f32_16x16x32_bf16 v[40:43], a[100:103], a[96:99], v[40:43]
    v_mfma_f32_16x16x32_bf16 v[44:47], a[100:103], v[22:25], v[44:47]
    v_mfma_f32_16x16x32_bf16 v[36:39], a[104:107], a[104:107], v[36:39]
    v_mfma_f32_16x16x32_bf16 v[32:35], v[22:25], a[104:107], v[32:35]
    v_mfma_f32_16x16x32_bf16 v[40:43], a[108:111], a[104:107], v[40:43]
    v_mfma_f32_16x16x32_bf16 v[44:47], a[108:111], v[22:25], v[44:47]
    s_waitcnt vmcnt(12)
    ds_read_b128 a[96:99], v26 offset:24576
    ds_read_b128 a[100:103], v15 offset:384
    ds_read_b128 a[104:107], v27 offset:24576
    ds_read_b128 a[108:111], v15 offset:448
    s_waitcnt lgkmcnt(4)
    v_mfma_f32_16x16x32_bf16 v[36:39], a[80:83], a[80:83], v[36:39]
    v_mfma_f32_16x16x32_bf16 v[32:35], v[22:25], a[80:83], v[32:35]
    v_mfma_f32_16x16x32_bf16 v[40:43], a[84:87], a[80:83], v[40:43]
    v_mfma_f32_16x16x32_bf16 v[44:47], a[84:87], v[22:25], v[44:47]
    v_mfma_f32_16x16x32_bf16 v[36:39], a[88:91], a[88:91], v[36:39]
    v_mfma_f32_16x16x32_bf16 v[32:35], v[22:25], a[88:91], v[32:35]
    v_mfma_f32_16x16x32_bf16 v[40:43], a[92:95], a[88:91], v[40:43]
    v_mfma_f32_16x16x32_bf16 v[44:47], a[92:95], v[22:25], v[44:47]
    s_waitcnt vmcnt(10)
    ds_read_b128 a[80:83], v26 offset:32768
    ds_read_b128 a[84:87], v15 offset:512
    ds_read_b128 a[88:91], v27 offset:32768
    ds_read_b128 a[92:95], v15 offset:576
    s_waitcnt lgkmcnt(4)
    v_mfma_f32_16x16x32_bf16 v[36:39], a[96:99], a[96:99], v[36:39]
    v_mfma_f32_16x16x32_bf16 v[32:35], v[22:25], a[96:99], v[32:35]
    v_mfma_f32_16x16x32_bf16 v[40:43], a[100:103], a[96:99], v[40:43]
    v_mfma_f32_16x16x32_bf16 v[44:47], a[100:103], v[22:25], v[44:47]
    v_mfma_f32_16x16x32_bf16 v[36:39], a[104:107], a[104:107], v[36:39]
    v_mfma_f32_16x16x32_bf16 v[32:35], v[22:25], a[104:107], v[32:35]
    v_mfma_f32_16x16x32_bf16 v[40:43], a[108:111], a[104:107], v[40:43]
    v_mfma_f32_16x16x32_bf16 v[44:47], a[108:111], v[22:25], v[44:47]
    s_waitcnt vmcnt(8)
    ds_read_b128 a[96:99], v28 offset:0
    ds_read_b128 a[100:103], v15 offset:640
    ds_read_b128 a[104:107], v29 offset:0
    ds_read_b128 a[108:111], v15 offset:704
    s_waitcnt lgkmcnt(4)
    v_mfma_f32_16x16x32_bf16 v[36:39], a[80:83], a[80:83], v[36:39]
    v_mfma_f32_16x16x32_bf16 v[32:35], v[22:25], a[80:83], v[32:35]
    v_mfma_f32_16x16x32_bf16 v[40:43], a[84:87], a[80:83], v[40:43]
    v_mfma_f32_16x16x32_bf16 v[44:47], a[84:87], v[22:25], v[44:47]
    v_mfma_f32_16x16x32_bf16 v[36:39], a[88:91], a[88:91], v[36:39]
    v_mfma_f32_16x16x32_bf16 v[32:35], v[22:25], a[88:91], v[32:35]
    v_mfma_f32_16x16x32_bf16 v[40:43], a[92:95], a[88:91], v[40:43]
    v_mfma_f32_16x16x32_bf16 v[44:47], a[92:95], v[22:25], v[44:47]
    s_waitcnt vmcnt(6)
    ds_read_b128 a[80:83], v28 offset:8192
    ds_read_b128 a[84:87], v15 offset:768
    ds_read_b128 a[88:91], v29 offset:8192
    ds_read_b128 a[92:95], v15 offset:832
    s_waitcnt lgkmcnt(4)
    v_mfma_f32_16x16x32_bf16 v[36:39], a[96:99], a[96:99], v[36:39]
    v_mfma_f32_16x16x32_bf16 v[32:35], v[22:25], a[96:99], v[32:35]
    v_mfma_f32_16x16x32_bf16 v[40:43], a[100:103], a[96:99], v[40:43]
    v_mfma_f32_16x16x32_bf16 v[44:47], a[100:103], v[22:25], v[44:47]
    v_mfma_f32_16x16x32_bf16 v[36:39], a[104:107], a[104:107], v[36:39]
    v_mfma_f32_16x16x32_bf16 v[32:35], v[22:25], a[104:107], v[32:35]
    v_mfma_f32_16x16x32_bf16 v[40:43], a[108:111], a[104:107], v[40:43]
    v_mfma_f32_16x16x32_bf16 v[44:47], a[108:111], v[22:25], v[44:47]
    s_waitcnt vmcnt(4)
    ds_read_b128 a[96:99], v28 offset:16384
    ds_read_b128 a[100:103], v15 offset:896
    ds_read_b128 a[104:107], v29 offset:16384
    ds_read_b128 a[108:111], v15 offset:960
    s_waitcnt lgkmcnt(4)
    v_mfma_f32_16x16x32_bf16 v[36:39], a[80:83], a[80:83], v[36:39]
    v_mfma_f32_16x16x32_bf16 v[32:35], v[22:25], a[80:83], v[32:35]
    v_mfma_f32_16x16x32_bf16 v[40:43], a[84:87], a[80:83], v[40:43]
    v_mfma_f32_16x16x32_bf16 v[44:47], a[84:87], v[22:25], v[44:47]
    v_mfma_f32_16x16x32_bf16 v[36:39], a[88:91], a[88:91], v[36:39]
    v_mfma_f32_16x16x32_bf16 v[32:35], v[22:25], a[88:91], v[32:35]
    v_mfma_f32_16x16x32_bf16 v[40:43], a[92:95], a[88:91], v[40:43]
    v_mfma_f32_16x16x32_bf16 v[44:47], a[92:95], v[22:25], v[44:47]
    s_waitcnt vmcnt(2)
    ds_read_b128 a[80:83], v28 offset:24576
    ds_read_b128 a[84:87], v15 offset:1024
    ds_read_b128 a[88:91], v29 offset:24576
    ds_read_b128 a[92:95], v15 offset:1088
    s_waitcnt lgkmcnt(4)
    v_mfma_f32_16x16x32_bf16 v[36:39], a[96:99], a[96:99], v[36:39]
    v_mfma_f32_16x16x32_bf16 v[32:35], v[22:25], a[96:99], v[32:35]
    v_mfma_f32_16x16x32_bf16 v[40:43], a[100:103], a[96:99], v[40:43]
    v_mfma_f32_16x16x32_bf16 v[44:47], a[100:103], v[22:25], v[44:47]
    v_mfma_f32_16x16x32_bf16 v[36:39], a[104:107], a[104:107], v[36:39]
    v_mfma_f32_16x16x32_bf16 v[32:35], v[22:25], a[104:107], v[32:35]
    v_mfma_f32_16x16x32_bf16 v[40:43], a[108:111], a[104:107], v[40:43]
    v_mfma_f32_16x16x32_bf16 v[44:47], a[108:111], v[22:25], v[44:47]
    s_waitcnt vmcnt(0)
    ds_read_b128 a[96:99], v28 offset:32768
    ds_read_b128 a[100:103], v15 offset:1152
    ds_read_b128 a[104:107], v29 offset:32768
    ds_read_b128 a[108:111], v15 offset:1216
    s_waitcnt lgkmcnt(4)
    v_mfma_f32_16x16x32_bf16 v[36:39], a[80:83], a[80:83], v[36:39]
    v_mfma_f32_16x16x32_bf16 v[32:35], v[22:25], a[80:83], v[32:35]
    v_mfma_f32_16x16x32_bf16 v[40:43], a[84:87], a[80:83], v[40:43]
    v_mfma_f32_16x16x32_bf16 v[44:47], a[84:87], v[22:25], v[44:47]
    v_mfma_f32_16x16x32_bf16 v[36:39], a[88:91], a[88:91], v[36:39]
    v_mfma_f32_16x16x32_bf16 v[32:35], v[22:25], a[88:91], v[32:35]
    v_mfma_f32_16x16x32_bf16 v[40:43], a[92:95], a[88:91], v[40:43]
    v_mfma_f32_16x16x32_bf16 v[44:47], a[92:95], v[22:25], v[44:47]
    s_waitcnt lgkmcnt(0)
    v_mfma_f32_16x16x32_bf16 v[36:39], a[96:99], a[96:99], v[36:39]
    v_mfma_f32_16x16x32_bf16 v[32:35], v[22:25], a[96:99], v[32:35]
    v_mfma_f32_16x16x32_bf16 v[40:43], a[100:103], a[96:99], v[40:43]
    v_mfma_f32_16x16x32_bf16 v[44:47], a[100:103], v[22:25], v[44:47]
    v_mfma_f32_16x16x32_bf16 v[36:39], a[104:107], a[104:107], v[36:39]
    v_mfma_f32_16x16x32_bf16 v[32:35], v[22:25], a[104:107], v[32:35]
    v_mfma_f32_16x16x32_bf16 v[40:43], a[108:111], a[104:107], v[40:43]
    v_mfma_f32_16x16x32_bf16 v[44:47], a[108:111], v[22:25], v[44:47]
    s_nop 4
    v_cndmask_b32 v4, v36, v37, s[46:47]
    v_cndmask_b32 v5, v38, v39, s[46:47]
    v_cndmask_b32 v4, v4, v5, s[56:57]
    ds_bpermute_b32 v4, v19, v4
    v_mul_f32 v5, 0xbacccccd, v32
    v_cvt_pk_bf16_f32 v30, v5, v5
    v_lshlrev_b32 v30, 16, v30
    v_mul_f32 v5, v5, v5
    v_mov_b32 v6, 0x3acccccd
    s_waitcnt lgkmcnt(0)
    v_fma_f32 v4, v4, v6, -v5
    v_max_f32 v4, 0, v4
    v_cvt_pk_bf16_f32 v4, v4, v4
    v_lshlrev_b32 v4, 16, v4
    v_add_f32 v4, 0x3727c5ac, v4
    v_cvt_pk_bf16_f32 v4, v4, v4
    v_lshlrev_b32 v4, 16, v4
    v_sqrt_f32 v4, v4
    s_nop 0
    v_cvt_pk_bf16_f32 v4, v4, v4
    v_lshlrev_b32 v4, 16, v4
    v_rcp_f32 v31, v4
    v_lshrrev_b32 v8, 16, v4
    v_or_b32 v8, v8, v30
    v_mov_b32 v9, s38
    s_lshl_b32 s40, s36, 9
    s_lshl_b32 s41, s26, 7
    s_add_u32 s40, s40, s41
    s_add_u32 s40, s40, 8192000
    v_lshlrev_b32 v10, 3, v1
    s_mov_b64 exec, 0xffff
    buffer_store_dwordx2 v[8:9], v10, s[28:31], s40 offen sc1
    s_mov_b64 exec, -1
    v_fma_f32 v4, v30, v44, v40
    v_mul_f32 v4, v4, v31
    v_cvt_pk_bf16_f32 v4, v4, v4
    v_ashrrev_i32 v5, 31, v4
    v_or_b32 v5, 0x80000000, v5
    v_xor_b32 v4, v4, v5
    v_and_b32 v4, 0xffff0000, v4
    v_max_u32 v4, 0x10000, v4
    s_lshl_b32 s40, s26, 4
    v_add_u32 v5, s40, v3
    v_sub_u32 v6, 63, v5
    v_or_b32 v4, v4, v6
    v_lshlrev_b32 v5, 2, v5
    v_add_u32 v5, 157696, v5
    ds_write_b32 v5, v4
    s_waitcnt lgkmcnt(0)
    s_barrier
    s_cmp_lg_u32 s26, 0
    s_cbranch_scc1 Lpub_done
    v_add_u32 v5, 157696, v12
    ds_read_b32 v6, v5
    s_waitcnt lgkmcnt(0)
    v_mov_b32 v4, v6
    s_nop 1
    v_max_u32_dpp v4, v4, v4 row_ror:8 row_mask:0xf bank_mask:0xf
    s_nop 1
    v_max_u32_dpp v4, v4, v4 row_ror:4 row_mask:0xf bank_mask:0xf
    s_nop 1
    v_max_u32_dpp v4, v4, v4 row_ror:2 row_mask:0xf bank_mask:0xf
    s_nop 1
    v_max_u32_dpp v4, v4, v4 row_ror:1 row_mask:0xf bank_mask:0xf
    s_nop 0
    v_readlane_b32 s58, v4, 0
    v_readlane_b32 s40, v4, 16
    v_readlane_b32 s41, v4, 32
    v_readlane_b32 s42, v4, 48
    s_max_u32 s58, s58, s40
    s_max_u32 s41, s41, s42
    s_max_u32 s58, s58, s41
    v_cmp_eq_u32 vcc, s58, v6
    s_nop 1
    v_cndmask_b32 v4, v6, 0, vcc
    s_nop 1
    v_max_u32_dpp v4, v4, v4 row_ror:8 row_mask:0xf bank_mask:0xf
    s_nop 1
    v_max_u32_dpp v4, v4, v4 row_ror:4 row_mask:0xf bank_mask:0xf
    s_nop 1
    v_max_u32_dpp v4, v4, v4 row_ror:2 row_mask:0xf bank_mask:0xf
    s_nop 1
    v_max_u32_dpp v4, v4, v4 row_ror:1 row_mask:0xf bank_mask:0xf
    s_nop 0
    v_readlane_b32 s59, v4, 0
    v_readlane_b32 s40, v4, 16
    v_readlane_b32 s41, v4, 32
    v_readlane_b32 s42, v4, 48
    s_max_u32 s59, s59, s40
    s_max_u32 s41, s41, s42
    s_max_u32 s59, s59, s41
    s_and_b32 s40, s58, 0xffff0000
    s_lshr_b32 s41, s59, 16
    s_or_b32 s40, s40, s41
    s_and_b32 s41, s58, 63
    s_and_b32 s42, s59, 63
    s_lshl_b32 s42, s42, 6
    s_or_b32 s41, s41, s42
    s_xor_b32 s41, s41, 0x8fff
    s_lshl_b32 s42, s36, 2
    s_lshl_b32 s43, s36, 1
    v_mov_b32 v4, s40
    v_mov_b32 v5, s41
    v_mov_b32 v6, s42
    v_mov_b32 v7, s43
    s_mov_b64 exec, 1
    buffer_store_dword v4, v6, s[32:35], 0 offen offset:64 sc1
    buffer_store_short v5, v7, s[32:35], 0 offen offset:192 sc1
    s_mov_b64 exec, -1
    s_mov_b64 exec, 1
    s_lshl_b32 s40, s2, 2
    s_add_u32 s40, s40, 8323072
    v_mov_b32 v4, s38
    v_mov_b32 v5, s40
    buffer_store_dword v4, v5, s[28:31], 0 offen sc1
    s_mov_b64 exec, -1
Lpub_done:
    s_cmp_ge_u32 s36, 27
    s_cbranch_scc1 Lend
    s_barrier
    ds_read_b64_tr_b16 a[0:1], v17 offset:24576
    ds_read_b64_tr_b16 a[2:3], v17 offset:25088
    ds_read_b64_tr_b16 a[4:5], v17 offset:28672
    ds_read_b64_tr_b16 a[6:7], v17 offset:29184
    ds_read_b64_tr_b16 a[8:9], v17 offset:32768
    ds_read_b64_tr_b16 a[10:11], v17 offset:33280
    ds_read_b64_tr_b16 a[12:13], v17 offset:36864
    ds_read_b64_tr_b16 a[14:15], v17 offset:37376
    ds_read_b64_tr_b16 a[16:17], v17 offset:40960
    ds_read_b64_tr_b16 a[18:19], v17 offset:41472
    ds_read_b64_tr_b16 a[20:21], v17 offset:45056
    ds_read_b64_tr_b16 a[22:23], v17 offset:45568
    ds_read_b64_tr_b16 a[24:25], v17 offset:49152
    ds_read_b64_tr_b16 a[26:27], v17 offset:49664
    ds_read_b64_tr_b16 a[28:29], v17 offset:53248
    ds_read_b64_tr_b16 a[30:31], v17 offset:53760
    ds_read_b64_tr_b16 a[32:33], v18 offset:0
    ds_read_b64_tr_b16 a[34:35], v18 offset:512
    ds_read_b64_tr_b16 a[36:37], v18 offset:4096
    ds_read_b64_tr_b16 a[38:39], v18 offset:4608
    ds_read_b64_tr_b16 a[40:41], v18 offset:8192
    ds_read_b64_tr_b16 a[42:43], v18 offset:8704
    ds_read_b64_tr_b16 a[44:45], v18 offset:12288
    ds_read_b64_tr_b16 a[46:47], v18 offset:12800
    ds_read_b64_tr_b16 a[48:49], v18 offset:16384
    ds_read_b64_tr_b16 a[50:51], v18 offset:16896
    ds_read_b64_tr_b16 a[52:53], v18 offset:20480
    ds_read_b64_tr_b16 a[54:55], v18 offset:20992
    ds_read_b64_tr_b16 a[56:57], v18 offset:24576
    ds_read_b64_tr_b16 a[58:59], v18 offset:25088
    ds_read_b64_tr_b16 a[60:61], v18 offset:28672
    ds_read_b64_tr_b16 a[62:63], v18 offset:29184
    ds_read_b64_tr_b16 a[64:65], v18 offset:32768
    ds_read_b64_tr_b16 a[66:67], v18 offset:33280
    ds_read_b64_tr_b16 a[68:69], v18 offset:36864
    ds_read_b64_tr_b16 a[70:71], v18 offset:37376
    ds_read_b64_tr_b16 a[72:73], v17 offset:16384
    ds_read_b64_tr_b16 a[74:75], v17 offset:16896
    ds_read_b64_tr_b16 a[76:77], v17 offset:20480
    ds_read_b64_tr_b16 a[78:79], v17 offset:20992
    s_waitcnt lgkmcnt(0)
    s_barrier
    s_cmp_lg_u32 s26, 0
    s_cbranch_scc1 Lsel_done
Lpt_8:
    s_sub_u32 s39, s39, 1
    s_cbranch_scc1 Lend
    buffer_load_dword v4, v12, s[32:35], 0 offen offset:64 sc1
    v_lshrrev_b32 v5, 1, v12
    v_and_b32 v5, 0x3c, v5
    v_add_u32 v5, 128, v5
    s_waitcnt vmcnt(0)
    ds_bpermute_b32 v5, v5, v4
    v_and_b32 v6, 4, v12
    v_lshlrev_b32 v6, 2, v6
    s_waitcnt lgkmcnt(0)
    v_bfe_u32 v5, v5, v6, 16
    v_cmp_ne_u32 vcc, 0, v4
    v_cmp_ne_u32 s[40:41], 0, v5
    s_nop 0
    s_and_b32 s40, s40, vcc_lo
    s_cmp_eq_u32 s40, -1
    s_nop 0
    s_cbranch_scc1 Lptd_9
    s_sleep 2
    s_branch Lpt_8
Lptd_9:
    v_lshlrev_b32 v6, 4, v12
    v_and_b32 v7, 63, v5
    v_add_u32 v7, v7, v6
    v_sub_u32 v7, 2047, v7
    v_bfe_u32 v5, v5, 6, 6
    v_add_u32 v5, v5, v6
    v_sub_u32 v5, 2047, v5
    v_and_b32 v6, 0xffff0000, v4
    v_or_b32 v7, v7, v6
    v_lshl_or_b32 v5, v4, 16, v5
    v_cmp_gt_u32 vcc, 128, v12
    s_nop 1
    v_cndmask_b32 v7, 0, v7, vcc
    v_cndmask_b32 v5, 0, v5, vcc
    v_mov_b32 v4, v7
    s_nop 1
    v_max_u32_dpp v4, v4, v4 row_ror:8 row_mask:0xf bank_mask:0xf
    s_nop 1
    v_max_u32_dpp v4, v4, v4 row_ror:4 row_mask:0xf bank_mask:0xf
    s_nop 1
    v_max_u32_dpp v4, v4, v4 row_ror:2 row_mask:0xf bank_mask:0xf
    s_nop 1
    v_max_u32_dpp v4, v4, v4 row_ror:1 row_mask:0xf bank_mask:0xf
    s_nop 0
    v_readlane_b32 s58, v4, 0
    v_readlane_b32 s40, v4, 16
    v_readlane_b32 s41, v4, 32
    v_readlane_b32 s42, v4, 48
    s_max_u32 s58, s58, s40
    s_max_u32 s41, s41, s42
    s_max_u32 s58, s58, s41
    v_cmp_eq_u32 vcc, s58, v7
    s_nop 1
    v_cndmask_b32 v4, v7, v5, vcc
    s_nop 1
    v_max_u32_dpp v4, v4, v4 row_ror:8 row_mask:0xf bank_mask:0xf
    s_nop 1
    v_max_u32_dpp v4, v4, v4 row_ror:4 row_mask:0xf bank_mask:0xf
    s_nop 1
    v_max_u32_dpp v4, v4, v4 row_ror:2 row_mask:0xf bank_mask:0xf
    s_nop 1
    v_max_u32_dpp v4, v4, v4 row_ror:1 row_mask:0xf bank_mask:0xf
    s_nop 0
    v_readlane_b32 s59, v4, 0
    v_readlane_b32 s40, v4, 16
    v_readlane_b32 s41, v4, 32
    v_readlane_b32 s42, v4, 48
    s_max_u32 s59, s59, s40
    s_max_u32 s41, s41, s42
    s_max_u32 s59, s59, s41
    s_and_b32 s40, s58, 0x7ff
    s_sub_u32 s40, 2047, s40
    s_mul_i32 s40, s40, 1280
    s_and_b32 s41, s59, 0x7ff
    s_sub_u32 s41, 2047, s41
    s_mul_i32 s41, s41, 1280
    v_mov_b32 v4, s40
    v_mov_b32 v5, s41
    v_cmp_gt_u32 vcc, 32, v1
    s_nop 1
    v_cndmask_b32 v4, v5, v4, vcc
    v_and_b32 v10, 31, v1
    v_lshl_add_u32 v4, v10, 3, v4
    buffer_load_dwordx2 v[48:49], v4, s[48:51], 0 offen offset:0
    buffer_load_dwordx2 v[50:51], v4, s[48:51], 0 offen offset:256
    buffer_load_dwordx2 v[52:53], v4, s[48:51], 0 offen offset:512
    buffer_load_dwordx2 v[54:55], v4, s[48:51], 0 offen offset:768
    buffer_load_dwordx2 v[56:57], v4, s[48:51], 0 offen offset:1024
    s_waitcnt vmcnt(0)
    v_lshlrev_b32 v58, 16, v48
    v_and_b32 v59, 0xffff0000, v48
    v_lshlrev_b32 v60, 16, v49
    v_and_b32 v61, 0xffff0000, v49
    v_lshlrev_b32 v62, 16, v50
    v_and_b32 v63, 0xffff0000, v50
    v_lshlrev_b32 v64, 16, v51
    v_and_b32 v65, 0xffff0000, v51
    v_lshlrev_b32 v66, 16, v52
    v_and_b32 v67, 0xffff0000, v52
    v_lshlrev_b32 v68, 16, v53
    v_and_b32 v69, 0xffff0000, v53
    v_lshlrev_b32 v70, 16, v54
    v_and_b32 v71, 0xffff0000, v54
    v_lshlrev_b32 v72, 16, v55
    v_and_b32 v73, 0xffff0000, v55
    v_lshlrev_b32 v74, 16, v56
    v_and_b32 v75, 0xffff0000, v56
    v_lshlrev_b32 v76, 16, v57
    v_and_b32 v77, 0xffff0000, v57
    v_add_f32 v6, v58, v59
    v_add_f32 v6, v6, v60
    v_add_f32 v6, v6, v61
    v_add_f32 v6, v6, v62
    v_add_f32 v6, v6, v63
    v_add_f32 v6, v6, v64
    v_add_f32 v6, v6, v65
    v_add_f32 v6, v6, v66
    v_add_f32 v6, v6, v67
    v_add_f32 v6, v6, v68
    v_add_f32 v6, v6, v69
    v_add_f32 v6, v6, v70
    v_add_f32 v6, v6, v71
    v_add_f32 v6, v6, v72
    v_add_f32 v6, v6, v73
    v_add_f32 v6, v6, v74
    v_add_f32 v6, v6, v75
    v_add_f32 v6, v6, v76
    v_add_f32 v6, v6, v77
    s_nop 1
    v_add_f32_dpp v6, v6, v6 row_ror:8 row_mask:0xf bank_mask:0xf
    s_nop 1
    v_add_f32_dpp v6, v6, v6 row_ror:4 row_mask:0xf bank_mask:0xf
    s_nop 1
    v_add_f32_dpp v6, v6, v6 row_ror:2 row_mask:0xf bank_mask:0xf
    s_nop 1
    v_add_f32_dpp v6, v6, v6 row_ror:1 row_mask:0xf bank_mask:0xf
    v_mov_b32 v7, v6
    s_nop 1
    v_permlane16_swap_b32 v6, v7
    v_add_f32 v6, v6, v7
    v_mul_f32 v6, 0x3acccccd, v6
    v_mov_b32 v8, 0
    v_sub_f32 v9, v58, v6
    v_fmac_f32 v8, v9, v9
    v_sub_f32 v9, v59, v6
    v_fmac_f32 v8, v9, v9
    v_sub_f32 v9, v60, v6
    v_fmac_f32 v8, v9, v9
    v_sub_f32 v9, v61, v6
    v_fmac_f32 v8, v9, v9
    v_sub_f32 v9, v62, v6
    v_fmac_f32 v8, v9, v9
    v_sub_f32 v9, v63, v6
    v_fmac_f32 v8, v9, v9
    v_sub_f32 v9, v64, v6
    v_fmac_f32 v8, v9, v9
    v_sub_f32 v9, v65, v6
    v_fmac_f32 v8, v9, v9
    v_sub_f32 v9, v66, v6
    v_fmac_f32 v8, v9, v9
    v_sub_f32 v9, v67, v6
    v_fmac_f32 v8, v9, v9
    v_sub_f32 v9, v68, v6
    v_fmac_f32 v8, v9, v9
    v_sub_f32 v9, v69, v6
    v_fmac_f32 v8, v9, v9
    v_sub_f32 v9, v70, v6
    v_fmac_f32 v8, v9, v9
    v_sub_f32 v9, v71, v6
    v_fmac_f32 v8, v9, v9
    v_sub_f32 v9, v72, v6
    v_fmac_f32 v8, v9, v9
    v_sub_f32 v9, v73, v6
    v_fmac_f32 v8, v9, v9
    v_sub_f32 v9, v74, v6
    v_fmac_f32 v8, v9, v9
    v_sub_f32 v9, v75, v6
    v_fmac_f32 v8, v9, v9
    v_sub_f32 v9, v76, v6
    v_fmac_f32 v8, v9, v9
    v_sub_f32 v9, v77, v6
    v_fmac_f32 v8, v9, v9
    s_nop 1
    v_add_f32_dpp v8, v8, v8 row_ror:8 row_mask:0xf bank_mask:0xf
    s_nop 1
    v_add_f32_dpp v8, v8, v8 row_ror:4 row_mask:0xf bank_mask:0xf
    s_nop 1
    v_add_f32_dpp v8, v8, v8 row_ror:2 row_mask:0xf bank_mask:0xf
    s_nop 1
    v_add_f32_dpp v8, v8, v8 row_ror:1 row_mask:0xf bank_mask:0xf
    v_mov_b32 v7, v8
    s_nop 1
    v_permlane16_swap_b32 v8, v7
    v_add_f32 v8, v8, v7
    v_mul_f32 v8, 0x3acccccd, v8
    v_cvt_pk_bf16_f32 v8, v8, v8
    v_lshlrev_b32 v8, 16, v8
    v_add_f32 v8, 0x3727c5ac, v8
    v_cvt_pk_bf16_f32 v8, v8, v8
    v_lshlrev_b32 v8, 16, v8
    v_sqrt_f32 v8, v8
    s_nop 0
    v_cvt_pk_bf16_f32 v8, v8, v8
    v_lshlrev_b32 v8, 16, v8
    v_rcp_f32 v8, v8
    v_cvt_pk_bf16_f32 v6, v6, v6
    v_lshlrev_b32 v6, 16, v6
    v_sub_f32 v58, v58, v6
    v_sub_f32 v59, v59, v6
    v_sub_f32 v60, v60, v6
    v_sub_f32 v61, v61, v6
    v_sub_f32 v62, v62, v6
    v_sub_f32 v63, v63, v6
    v_sub_f32 v64, v64, v6
    v_sub_f32 v65, v65, v6
    v_sub_f32 v66, v66, v6
    v_sub_f32 v67, v67, v6
    v_sub_f32 v68, v68, v6
    v_sub_f32 v69, v69, v6
    v_sub_f32 v70, v70, v6
    v_sub_f32 v71, v71, v6
    v_sub_f32 v72, v72, v6
    v_sub_f32 v73, v73, v6
    v_sub_f32 v74, v74, v6
    v_sub_f32 v75, v75, v6
    v_sub_f32 v76, v76, v6
    v_sub_f32 v77, v77, v6
    v_cvt_pk_bf16_f32 v59, v58, v59
    v_cvt_pk_bf16_f32 v61, v60, v61
    v_cvt_pk_bf16_f32 v63, v62, v63
    v_cvt_pk_bf16_f32 v65, v64, v65
    v_cvt_pk_bf16_f32 v67, v66, v67
    v_cvt_pk_bf16_f32 v69, v68, v69
    v_cvt_pk_bf16_f32 v71, v70, v71
    v_cvt_pk_bf16_f32 v73, v72, v73
    v_cvt_pk_bf16_f32 v75, v74, v75
    v_cvt_pk_bf16_f32 v77, v76, v77
    v_lshlrev_b32 v58, 16, v59
    v_and_b32 v59, 0xffff0000, v59
    v_lshlrev_b32 v60, 16, v61
    v_and_b32 v61, 0xffff0000, v61
    v_lshlrev_b32 v62, 16, v63
    v_and_b32 v63, 0xffff0000, v63
    v_lshlrev_b32 v64, 16, v65
    v_and_b32 v65, 0xffff0000, v65
    v_lshlrev_b32 v66, 16, v67
    v_and_b32 v67, 0xffff0000, v67
    v_lshlrev_b32 v68, 16, v69
    v_and_b32 v69, 0xffff0000, v69
    v_lshlrev_b32 v70, 16, v71
    v_and_b32 v71, 0xffff0000, v71
    v_lshlrev_b32 v72, 16, v73
    v_and_b32 v73, 0xffff0000, v73
    v_lshlrev_b32 v74, 16, v75
    v_and_b32 v75, 0xffff0000, v75
    v_lshlrev_b32 v76, 16, v77
    v_and_b32 v77, 0xffff0000, v77
    v_mul_f32 v58, v58, v8
    v_mul_f32 v59, v59, v8
    v_mul_f32 v60, v60, v8
    v_mul_f32 v61, v61, v8
    v_mul_f32 v62, v62, v8
    v_mul_f32 v63, v63, v8
    v_mul_f32 v64, v64, v8
    v_mul_f32 v65, v65, v8
    v_mul_f32 v66, v66, v8
    v_mul_f32 v67, v67, v8
    v_mul_f32 v68, v68, v8
    v_mul_f32 v69, v69, v8
    v_mul_f32 v70, v70, v8
    v_mul_f32 v71, v71, v8
    v_mul_f32 v72, v72, v8
    v_mul_f32 v73, v73, v8
    v_mul_f32 v74, v74, v8
    v_mul_f32 v75, v75, v8
    v_mul_f32 v76, v76, v8
    v_mul_f32 v77, v77, v8
    v_cvt_pk_bf16_f32 v48, v58, v59
    v_cvt_pk_bf16_f32 v49, v60, v61
    v_cvt_pk_bf16_f32 v50, v62, v63
    v_cvt_pk_bf16_f32 v51, v64, v65
    v_cvt_pk_bf16_f32 v52, v66, v67
    v_cvt_pk_bf16_f32 v53, v68, v69
    v_cvt_pk_bf16_f32 v54, v70, v71
    v_cvt_pk_bf16_f32 v55, v72, v73
    v_cvt_pk_bf16_f32 v56, v74, v75
    v_cvt_pk_bf16_f32 v57, v76, v77
    v_lshrrev_b32 v4, 5, v1
    v_mul_u32_u24 v4, 1344, v4
    v_lshl_add_u32 v4, v10, 3, v4
    v_add_u32 v4, 158208, v4
    ds_write_b64 v4, v[48:49] offset:0
    ds_write_b64 v4, v[50:51] offset:256
    ds_write_b64 v4, v[52:53] offset:512
    ds_write_b64 v4, v[54:55] offset:768
    ds_write_b64 v4, v[56:57] offset:1024
    s_waitcnt lgkmcnt(0)
Lsel_done:
    s_barrier
    s_branch Laux_mm
Laux_ld:
    s_cmp_ge_u32 s36, 27
    s_cbranch_scc1 Lend
    v_and_b32 v8, 1, v2
    v_lshlrev_b32 v8, 1, v8
    v_xor_b32 v8, v8, v6
    v_lshlrev_b32 v8, 4, v8
    v_add_u32 v22, v7, v8
    v_xor_b32 v23, 64, v22
    v_add_u32 v23, 9216, v23
    v_add_u32 v9, s41, v5
    v_mul_u32_u24 v9, 3456, v9
    s_lshl_b32 s42, s36, 7
    v_add3_u32 v20, v9, v8, s42
    v_xor_b32 v21, 64, v20
    v_add_u32 v21, 26624, v21
    v_bfe_u32 v10, v1, 2, 2
    v_and_b32 v8, 3, v1
    v_lshl_add_u32 v14, v2, 3, v10
    v_lshlrev_b32 v14, 7, v14
    v_lshlrev_b32 v9, 2, v1
    v_and_b32 v9, 0x60, v9
    v_add_u32 v14, v14, v9
    v_lshl_add_u32 v14, v8, 3, v14
    s_lshl_b32 s40, s26, 5
    v_xor_b32 v16, s40, v14
    v_add_u32 v17, 57344, v16
    v_add_u32 v18, 114688, v16
    s_waitcnt lgkmcnt(0)
    s_mov_b64 s[28:29], s[24:25]
    s_mov_b32 s30, 268435456
    s_mov_b32 s31, 0x20000
    s_mov_b64 s[32:33], s[22:23]
    s_mov_b32 s34, 256
    s_mov_b32 s35, 0x20000
    s_load_dword s38, s[28:29], 0
    s_mov_b64 s[60:61], s[14:15]
    s_mov_b32 s62, 2211840
    s_mov_b32 s63, 0x20000
    s_mov_b64 s[64:65], s[16:17]
    s_mov_b32 s66, 2211840
    s_mov_b32 s67, 0x20000
    s_mov_b64 s[68:69], s[18:19]
    s_mov_b32 s70, 2211840
    s_mov_b32 s71, 0x20000
    s_add_u32 m0, s44, 81920
    s_mov_b32 s45, 0
    buffer_load_dwordx4 v20, s[60:63], s45 offen nt lds
    buffer_load_dwordx4 v21, s[60:63], s45 offen offset:1024 nt lds
    s_add_u32 m0, s44, 90112
    s_mov_b32 s45, 221184
    buffer_load_dwordx4 v20, s[60:63], s45 offen nt lds
    buffer_load_dwordx4 v21, s[60:63], s45 offen offset:1024 nt lds
    s_add_u32 m0, s44, 98304
    s_mov_b32 s45, 442368
    buffer_load_dwordx4 v20, s[60:63], s45 offen nt lds
    buffer_load_dwordx4 v21, s[60:63], s45 offen offset:1024 nt lds
    s_add_u32 m0, s44, 106496
    s_mov_b32 s45, 663552
    buffer_load_dwordx4 v20, s[60:63], s45 offen nt lds
    buffer_load_dwordx4 v21, s[60:63], s45 offen offset:1024 nt lds
    s_add_u32 m0, s44, 114688
    s_mov_b32 s45, 884736
    buffer_load_dwordx4 v20, s[60:63], s45 offen nt lds
    buffer_load_dwordx4 v21, s[60:63], s45 offen offset:1024 nt lds
    s_add_u32 m0, s44, 122880
    s_mov_b32 s45, 1105920
    buffer_load_dwordx4 v20, s[60:63], s45 offen nt lds
    buffer_load_dwordx4 v21, s[60:63], s45 offen offset:1024 nt lds
    s_add_u32 m0, s44, 131072
    s_mov_b32 s45, 1327104
    buffer_load_dwordx4 v20, s[60:63], s45 offen nt lds
    buffer_load_dwordx4 v21, s[60:63], s45 offen offset:1024 nt lds
    s_add_u32 m0, s44, 139264
    s_mov_b32 s45, 1548288
    buffer_load_dwordx4 v20, s[60:63], s45 offen nt lds
    buffer_load_dwordx4 v21, s[60:63], s45 offen offset:1024 nt lds
    s_add_u32 m0, s44, 147456
    s_mov_b32 s45, 1769472
    buffer_load_dwordx4 v20, s[60:63], s45 offen nt lds
    buffer_load_dwordx4 v21, s[60:63], s45 offen offset:1024 nt lds
    s_waitcnt lgkmcnt(0)
    s_add_u32 s38, s38, 0x9e3779b8
    s_or_b32 s38, s38, 1
    s_barrier
    s_add_u32 m0, s44, 73728
    s_mov_b32 s45, 1990656
    buffer_load_dwordx4 v20, s[60:63], s45 offen nt lds
    buffer_load_dwordx4 v21, s[60:63], s45 offen offset:1024 nt lds
    s_add_u32 m0, s44, 0
    s_mov_b32 s45, 0
    buffer_load_dwordx4 v20, s[64:67], s45 offen nt lds
    buffer_load_dwordx4 v21, s[64:67], s45 offen offset:1024 nt lds
    s_add_u32 m0, s44, 8192
    s_mov_b32 s45, 221184
    buffer_load_dwordx4 v20, s[64:67], s45 offen nt lds
    buffer_load_dwordx4 v21, s[64:67], s45 offen offset:1024 nt lds
    s_add_u32 m0, s44, 16384
    s_mov_b32 s45, 442368
    buffer_load_dwordx4 v20, s[64:67], s45 offen nt lds
    buffer_load_dwordx4 v21, s[64:67], s45 offen offset:1024 nt lds
    s_add_u32 m0, s44, 24576
    s_mov_b32 s45, 663552
    buffer_load_dwordx4 v20, s[64:67], s45 offen nt lds
    buffer_load_dwordx4 v21, s[64:67], s45 offen offset:1024 nt lds
    s_add_u32 m0, s44, 32768
    s_mov_b32 s45, 884736
    buffer_load_dwordx4 v20, s[64:67], s45 offen nt lds
    buffer_load_dwordx4 v21, s[64:67], s45 offen offset:1024 nt lds
    s_add_u32 m0, s44, 40960
    s_mov_b32 s45, 1105920
    buffer_load_dwordx4 v20, s[64:67], s45 offen nt lds
    buffer_load_dwordx4 v21, s[64:67], s45 offen offset:1024 nt lds
    s_add_u32 m0, s44, 49152
    s_mov_b32 s45, 1327104
    buffer_load_dwordx4 v20, s[64:67], s45 offen nt lds
    buffer_load_dwordx4 v21, s[64:67], s45 offen offset:1024 nt lds
    s_add_u32 m0, s44, 57344
    s_mov_b32 s45, 1548288
    buffer_load_dwordx4 v20, s[64:67], s45 offen nt lds
    buffer_load_dwordx4 v21, s[64:67], s45 offen offset:1024 nt lds
    s_add_u32 m0, s44, 65536
    s_mov_b32 s45, 1769472
    buffer_load_dwordx4 v20, s[64:67], s45 offen nt lds
    buffer_load_dwordx4 v21, s[64:67], s45 offen offset:1024 nt lds
    s_waitcnt vmcnt(18)
    s_barrier
    s_barrier
    s_add_u32 m0, s44, 73728
    s_mov_b32 s45, 1990656
    buffer_load_dwordx4 v20, s[64:67], s45 offen nt lds
    buffer_load_dwordx4 v21, s[64:67], s45 offen offset:1024 nt lds
    s_add_u32 m0, s44, 81920
    s_mov_b32 s45, 0
    buffer_load_dwordx4 v22, s[68:71], s45 offen nt lds
    buffer_load_dwordx4 v23, s[68:71], s45 offen offset:1024 nt lds
    s_add_u32 m0, s44, 90112
    s_mov_b32 s45, 128
    buffer_load_dwordx4 v22, s[68:71], s45 offen nt lds
    buffer_load_dwordx4 v23, s[68:71], s45 offen offset:1024 nt lds
    s_add_u32 m0, s44, 98304
    s_mov_b32 s45, 256
    buffer_load_dwordx4 v22, s[68:71], s45 offen nt lds
    buffer_load_dwordx4 v23, s[68:71], s45 offen offset:1024 nt lds
    s_add_u32 m0, s44, 106496
    s_mov_b32 s45, 384
    buffer_load_dwordx4 v22, s[68:71], s45 offen nt lds
    buffer_load_dwordx4 v23, s[68:71], s45 offen offset:1024 nt lds
    s_add_u32 m0, s44, 114688
    s_mov_b32 s45, 512
    buffer_load_dwordx4 v22, s[68:71], s45 offen nt lds
    buffer_load_dwordx4 v23, s[68:71], s45 offen offset:1024 nt lds
    s_add_u32 m0, s44, 122880
    s_mov_b32 s45, 640
    buffer_load_dwordx4 v22, s[68:71], s45 offen nt lds
    buffer_load_dwordx4 v23, s[68:71], s45 offen offset:1024 nt lds
    s_add_u32 m0, s44, 131072
    s_mov_b32 s45, 768
    buffer_load_dwordx4 v22, s[68:71], s45 offen nt lds
    buffer_load_dwordx4 v23, s[68:71], s45 offen offset:1024 nt lds
    s_add_u32 m0, s44, 139264
    s_mov_b32 s45, 896
    buffer_load_dwordx4 v22, s[68:71], s45 offen nt lds
    buffer_load_dwordx4 v23, s[68:71], s45 offen offset:1024 nt lds
    s_add_u32 m0, s44, 147456
    s_mov_b32 s45, 1024
    buffer_load_dwordx4 v22, s[68:71], s45 offen nt lds
    buffer_load_dwordx4 v23, s[68:71], s45 offen offset:1024 nt lds
    s_waitcnt vmcnt(18)
    s_barrier
    ds_read_b64_tr_b16 a[0:1], v16 offset:0
    ds_read_b64_tr_b16 a[2:3], v16 offset:512
    ds_read_b64_tr_b16 a[4:5], v16 offset:4096
    ds_read_b64_tr_b16 a[6:7], v16 offset:4608
    ds_read_b64_tr_b16 a[8:9], v16 offset:8192
    ds_read_b64_tr_b16 a[10:11], v16 offset:8704
    ds_read_b64_tr_b16 a[12:13], v16 offset:12288
    ds_read_b64_tr_b16 a[14:15], v16 offset:12800
    ds_read_b64_tr_b16 a[16:17], v16 offset:16384
    ds_read_b64_tr_b16 a[18:19], v16 offset:16896
    ds_read_b64_tr_b16 a[20:21], v16 offset:20480
    ds_read_b64_tr_b16 a[22:23], v16 offset:20992
    ds_read_b64_tr_b16 a[24:25], v16 offset:24576
    ds_read_b64_tr_b16 a[26:27], v16 offset:25088
    ds_read_b64_tr_b16 a[28:29], v16 offset:28672
    ds_read_b64_tr_b16 a[30:31], v16 offset:29184
    ds_read_b64_tr_b16 a[32:33], v16 offset:32768
    ds_read_b64_tr_b16 a[34:35], v16 offset:33280
    ds_read_b64_tr_b16 a[36:37], v16 offset:36864
    ds_read_b64_tr_b16 a[38:39], v16 offset:37376
    ds_read_b64_tr_b16 a[40:41], v16 offset:40960
    ds_read_b64_tr_b16 a[42:43], v16 offset:41472
    ds_read_b64_tr_b16 a[44:45], v16 offset:45056
    ds_read_b64_tr_b16 a[46:47], v16 offset:45568
    ds_read_b64_tr_b16 a[48:49], v16 offset:49152
    ds_read_b64_tr_b16 a[50:51], v16 offset:49664
    ds_read_b64_tr_b16 a[52:53], v16 offset:53248
    ds_read_b64_tr_b16 a[54:55], v16 offset:53760
    ds_read_b64_tr_b16 a[56:57], v17 offset:0
    ds_read_b64_tr_b16 a[58:59], v17 offset:512
    ds_read_b64_tr_b16 a[60:61], v17 offset:4096
    ds_read_b64_tr_b16 a[62:63], v17 offset:4608
    ds_read_b64_tr_b16 a[64:65], v17 offset:8192
    ds_read_b64_tr_b16 a[66:67], v17 offset:8704
    ds_read_b64_tr_b16 a[68:69], v17 offset:12288
    ds_read_b64_tr_b16 a[70:71], v17 offset:12800
    ds_read_b64_tr_b16 a[72:73], v17 offset:16384
    ds_read_b64_tr_b16 a[74:75], v17 offset:16896
    ds_read_b64_tr_b16 a[76:77], v17 offset:20480
    ds_read_b64_tr_b16 a[78:79], v17 offset:20992
Laux_mm:
    v_and_b32 v4, 1, v1
    v_mul_u32_u24 v5, 1344, v4
    v_lshl_add_u32 v5, v2, 4, v5
    v_add_u32 v5, 158208, v5
    ds_read_b128 v[40:43], v5 offset:0
    ds_read_b128 v[44:47], v5 offset:64
    ds_read_b128 v[48:51], v5 offset:128
    ds_read_b128 v[52:55], v5 offset:192
    ds_read_b128 v[56:59], v5 offset:256
    ds_read_b128 v[60:63], v5 offset:320
    ds_read_b128 v[64:67], v5 offset:384
    ds_read_b128 v[68:71], v5 offset:448
    ds_read_b128 v[72:75], v5 offset:512
    ds_read_b128 v[76:79], v5 offset:576
    ds_read_b128 v[80:83], v5 offset:640
    ds_read_b128 v[84:87], v5 offset:704
    ds_read_b128 v[88:91], v5 offset:768
    ds_read_b128 v[92:95], v5 offset:832
    ds_read_b128 v[96:99], v5 offset:896
    ds_read_b128 v[100:103], v5 offset:960
    ds_read_b128 v[104:107], v5 offset:1024
    ds_read_b128 v[108:111], v5 offset:1088
    ds_read_b128 v[112:115], v5 offset:1152
    ds_read_b128 v[116:119], v5 offset:1216
    s_waitcnt lgkmcnt(0)
    s_barrier
    s_cmp_eq_u32 s27, 0
    s_cbranch_scc1 Lno_d9
    s_add_u32 m0, s44, 0
    s_mov_b32 s45, 1152
    buffer_load_dwordx4 v22, s[68:71], s45 offen nt lds
    buffer_load_dwordx4 v23, s[68:71], s45 offen offset:1024 nt lds
Lno_d9:
    v_mfma_f32_16x16x32_bf16 v[120:123], a[0:3], v[40:43], 0
    v_mfma_f32_16x16x32_bf16 v[124:127], a[4:7], v[44:47], 0
    v_mfma_f32_16x16x32_bf16 v[120:123], a[8:11], v[48:51], v[120:123]
    v_mfma_f32_16x16x32_bf16 v[124:127], a[12:15], v[52:55], v[124:127]
    v_mfma_f32_16x16x32_bf16 v[120:123], a[16:19], v[56:59], v[120:123]
    v_mfma_f32_16x16x32_bf16 v[124:127], a[20:23], v[60:63], v[124:127]
    v_mfma_f32_16x16x32_bf16 v[120:123], a[24:27], v[64:67], v[120:123]
    v_mfma_f32_16x16x32_bf16 v[124:127], a[28:31], v[68:71], v[124:127]
    v_mfma_f32_16x16x32_bf16 v[120:123], a[32:35], v[72:75], v[120:123]
    v_mfma_f32_16x16x32_bf16 v[124:127], a[36:39], v[76:79], v[124:127]
    v_mfma_f32_16x16x32_bf16 v[120:123], a[40:43], v[80:83], v[120:123]
    v_mfma_f32_16x16x32_bf16 v[124:127], a[44:47], v[84:87], v[124:127]
    v_mfma_f32_16x16x32_bf16 v[120:123], a[48:51], v[88:91], v[120:123]
    v_mfma_f32_16x16x32_bf16 v[124:127], a[52:55], v[92:95], v[124:127]
    v_mfma_f32_16x16x32_bf16 v[120:123], a[56:59], v[96:99], v[120:123]
    v_mfma_f32_16x16x32_bf16 v[124:127], a[60:63], v[100:103], v[124:127]
    v_mfma_f32_16x16x32_bf16 v[120:123], a[64:67], v[104:107], v[120:123]
    v_mfma_f32_16x16x32_bf16 v[124:127], a[68:71], v[108:111], v[124:127]
    v_mfma_f32_16x16x32_bf16 v[120:123], a[72:75], v[112:115], v[120:123]
    v_mfma_f32_16x16x32_bf16 v[124:127], a[76:79], v[116:119], v[124:127]
    s_lshl_b32 s40, s26, 7
    s_add_u32 s40, s40, 162048
    v_lshl_add_u32 v6, v2, 1, v4
    v_lshl_add_u32 v6, v6, 4, s40
    s_nop 3
    v_add_f32 v120, v120, v124
    v_add_f32 v121, v121, v125
    v_add_f32 v122, v122, v126
    v_add_f32 v123, v123, v127
    v_cvt_pk_bf16_f32 v121, v120, v121
    v_cvt_pk_bf16_f32 v123, v122, v123
    v_lshlrev_b32 v120, 16, v121
    v_and_b32 v121, 0xffff0000, v121
    v_lshlrev_b32 v122, 16, v123
    v_and_b32 v123, 0xffff0000, v123
    s_cmp_eq_u32 s27, 0
    s_cbranch_scc1 Lgw
    ds_write_b128 v6, v[120:123]
    s_waitcnt lgkmcnt(0)
    s_barrier
    s_waitcnt vmcnt(0)
    s_branch Lhd
Lgw:
    v_mul_f32 v36, 0xbfb8aa3b, v120
    v_mul_f32 v37, 0xbfb8aa3b, v121
    v_mul_f32 v38, 0xbfb8aa3b, v122
    v_mul_f32 v39, 0xbfb8aa3b, v123
    v_exp_f32 v36, v36
    v_exp_f32 v37, v37
    v_exp_f32 v38, v38
    v_exp_f32 v39, v39
    v_add_f32 v36, 1.0, v36
    v_add_f32 v37, 1.0, v37
    v_add_f32 v38, 1.0, v38
    v_add_f32 v39, 1.0, v39
    v_rcp_f32 v36, v36
    v_rcp_f32 v37, v37
    v_rcp_f32 v38, v38
    v_rcp_f32 v39, v39
    v_mul_f32 v36, v36, v120
    v_mul_f32 v37, v37, v121
    v_mul_f32 v38, v38, v122
    v_mul_f32 v39, v39, v123
    v_cvt_pk_bf16_f32 v37, v36, v37
    v_cvt_pk_bf16_f32 v39, v38, v39
    v_lshlrev_b32 v36, 16, v37
    v_and_b32 v37, 0xffff0000, v37
    v_lshlrev_b32 v38, 16, v39
    v_and_b32 v39, 0xffff0000, v39
    s_barrier
    ds_read_b128 v[124:127], v6
    s_lshl_b32 s40, s26, 5
    s_add_u32 s40, s40, 161792
    v_lshlrev_b32 v8, 7, v4
    v_lshl_add_u32 v9, v2, 3, v8
    v_add_u32 v9, s40, v9
    s_waitcnt lgkmcnt(0)
    v_mul_f32 v36, v36, v124
    v_mul_f32 v37, v37, v125
    v_mul_f32 v38, v38, v126
    v_mul_f32 v39, v39, v127
    v_cvt_pk_bf16_f32 v6, v36, v37
    v_cvt_pk_bf16_f32 v7, v38, v39
    ds_write_b64 v9, v[6:7]
    s_waitcnt lgkmcnt(0)
Lhd:
    s_barrier
    v_lshlrev_b32 v8, 7, v4
    v_lshl_add_u32 v9, v2, 4, v8
    v_add_u32 v9, 161792, v9
    ds_read_b128 v[40:43], v9 offset:0
    ds_read_b128 v[44:47], v9 offset:64
    v_cmp_eq_u32 s[72:73], 1, v2
    v_cmp_eq_u32 s[74:75], 2, v2
    v_cmp_eq_u32 s[76:77], 3, v2
    s_mov_b32 s37, s3
    s_nop 3
Ldown:
    s_add_u32 s41, s37, 10
    s_cmp_eq_u32 s37, 9
    s_cselect_b32 s41, 0, s41
    s_lshl_b32 s41, s41, 13
    v_add_u32 v68, s41, v14
    v_xor_b32 v69, 32, v68
    v_xor_b32 v70, 64, v68
    v_xor_b32 v71, 96, v68
    ds_read_b64_tr_b16 a[0:1], v68 offset:0
    ds_read_b64_tr_b16 a[2:3], v68 offset:512
    ds_read_b64_tr_b16 a[4:5], v69 offset:0
    ds_read_b64_tr_b16 a[6:7], v69 offset:512
    ds_read_b64_tr_b16 a[8:9], v70 offset:0
    ds_read_b64_tr_b16 a[10:11], v70 offset:512
    ds_read_b64_tr_b16 a[12:13], v71 offset:0
    ds_read_b64_tr_b16 a[14:15], v71 offset:512
    ds_read_b64_tr_b16 a[16:17], v68 offset:4096
    ds_read_b64_tr_b16 a[18:19], v68 offset:4608
    ds_read_b64_tr_b16 a[20:21], v69 offset:4096
    ds_read_b64_tr_b16 a[22:23], v69 offset:4608
    ds_read_b64_tr_b16 a[24:25], v70 offset:4096
    ds_read_b64_tr_b16 a[26:27], v70 offset:4608
    ds_read_b64_tr_b16 a[28:29], v71 offset:4096
    ds_read_b64_tr_b16 a[30:31], v71 offset:4608
    s_mul_i32 s41, s36, 10
    s_add_u32 s41, s41, s37
    s_lshl_b32 s41, s41, 10
    s_add_u32 s41, s41, 7405568
    v_mov_b32 v65, s38
    v_mov_b32 v67, s38
    s_waitcnt lgkmcnt(0)
    v_mfma_f32_16x16x32_bf16 v[48:51], v[40:43], a[0:3], 0
    v_mfma_f32_16x16x32_bf16 v[52:55], v[40:43], a[4:7], 0
    v_mfma_f32_16x16x32_bf16 v[56:59], v[40:43], a[8:11], 0
    v_mfma_f32_16x16x32_bf16 v[60:63], v[40:43], a[12:15], 0
    v_mfma_f32_16x16x32_bf16 v[48:51], v[44:47], a[16:19], v[48:51]
    v_mfma_f32_16x16x32_bf16 v[52:55], v[44:47], a[20:23], v[52:55]
    v_mfma_f32_16x16x32_bf16 v[56:59], v[44:47], a[24:27], v[56:59]
    v_mfma_f32_16x16x32_bf16 v[60:63], v[44:47], a[28:31], v[60:63]
    s_nop 5
    v_cndmask_b32 v64, v48, v52, s[72:73]
    v_cndmask_b32 v64, v64, v56, s[74:75]
    v_cndmask_b32 v64, v64, v60, s[76:77]
    v_cndmask_b32 v66, v49, v53, s[72:73]
    v_cndmask_b32 v66, v66, v57, s[74:75]
    v_cndmask_b32 v66, v66, v61, s[76:77]
    buffer_store_dwordx4 v[64:67], v13, s[28:31], s41 offen sc1
    s_add_u32 s37, s37, 8
    s_cmp_lt_u32 s37, 10
    s_cbranch_scc1 Ldown
Lend:
    s_endpgm
.section .rodata,"a"
.p2align 6
.amdhsa_kernel recurrent_scan__sliding_local_dilated__moe_arch_mod__prompt_kernel
  .amdhsa_next_free_vgpr 256
  .amdhsa_next_free_sgpr 102
  .amdhsa_accum_offset 128
  .amdhsa_group_segment_fixed_size 0
  .amdhsa_kernarg_size 88
  .amdhsa_user_sgpr_count 2
  .amdhsa_user_sgpr_kernarg_segment_ptr 1
  .amdhsa_system_sgpr_workgroup_id_x 1
  .amdhsa_float_denorm_mode_32 3
.end_amdhsa_kernel
```

```asm
; @launch grid=(256,1,1) block=(512,1,1) lds=163840
.amdgcn_target "amdgcn-amd-amdhsa--gfx950"
.text
.globl recurrent_scan__sliding_local_dilated__moe_arch_mod__prompt_kernel
.p2align 8
.type recurrent_scan__sliding_local_dilated__moe_arch_mod__prompt_kernel,@function
recurrent_scan__sliding_local_dilated__moe_arch_mod__prompt_kernel:
    s_load_dwordx16 s[4:19], s[0:1], 0
    s_load_dwordx4 s[20:23], s[0:1], 64
    s_load_dwordx2 s[24:25], s[0:1], 80
    v_lshrrev_b32 v4, 6, v0
    v_and_b32 v1, 63, v0
    s_cmp_ge_u32 s2, 256
    s_cbranch_scc1 Lend
    v_readfirstlane_b32 s3, v4
    s_getpc_b64 s[40:41]
Lpc:
    s_and_b32 s42, s2, 0xf8
    v_add_u32 v5, s42, v4
    v_and_b32 v6, 1, v0
    v_lshl_add_u32 v5, v5, 1, v6
    v_lshlrev_b32 v5, 7, v5
    v_min_u32 v5, Lend-Lpc, v5
    v_mov_b32 v7, s41
    v_add_co_u32 v6, vcc, s40, v5
    s_nop 1
    v_addc_co_u32 v7, vcc, 0, v7, vcc
    global_load_dword v0, v[6:7], off
    v_lshrrev_b32 v2, 4, v1
    v_and_b32 v3, 15, v1
    v_lshlrev_b32 v12, 2, v1
    v_lshlrev_b32 v13, 4, v1
    s_mov_b32 s39, 200000
    s_and_b32 s40, s2, 7
    s_lshr_b32 s41, s2, 3
    s_and_b32 s42, s40, 1
    s_lshr_b32 s40, s40, 1
    s_add_u32 s43, s42, 4
    s_and_b32 s26, s3, 3
    s_lshr_b32 s27, s3, 2
    s_cmp_lt_u32 s41, s43
    s_cbranch_scc1 Laux
    s_lshr_b32 s37, s40, 1
    s_and_b32 s40, s40, 1
    s_mul_i32 s40, s40, 55
    s_mul_i32 s42, s42, 28
    s_add_u32 s40, s40, s42
    s_add_u32 s40, s40, s41
    s_sub_u32 s40, s40, s43
    s_mul_i32 s36, s40, 13108
    s_lshr_b32 s36, s36, 16
    s_mul_i32 s41, s36, 5
    s_sub_u32 s40, s40, s41
    s_mul_i32 s37, s37, 5
    s_add_u32 s37, s37, s40
    s_mul_i32 s46, s37, 2
    s_mul_i32 s40, s36, 2
    s_add_u32 s46, s46, s40
    s_mul_i32 s40, s36, 0
    s_lshr_b32 s40, s40, 16
    s_add_u32 s46, s46, s40
    s_mul_i32 s40, s46, 6554
    s_lshr_b32 s40, s40, 16
    s_mul_i32 s40, s40, 10
    s_sub_u32 s46, s46, s40
    s_cmp_lg_u32 s3, 0
    s_cbranch_scc1 Lcomp
Lloader:
    s_setprio 3
    v_lshrrev_b32 v5, 3, v1
    v_and_b32 v6, 7, v1
    v_and_b32 v8, 1, v2
    v_lshlrev_b32 v8, 1, v8
    v_xor_b32 v8, v8, v6
    s_lshl_b32 s43, s37, 7
    v_lshl_add_u32 v50, v8, 4, s43
    v_mov_b32 v7, 3840
    v_mad_u32_u24 v28, v5, v7, v50
    v_xor_b32 v29, 64, v28
    v_add_u32 v29, 29696, v29
    v_add_u32 v30, 59392, v28
    v_add_u32 v31, 59392, v29
    v_add_u32 v32, 122880, v28
    v_add_u32 v33, 122880, v29
    v_add_u32 v34, 182272, v28
    v_add_u32 v35, 182272, v29
    s_mul_i32 s42, s36, 96
    s_sub_u32 s42, s42, 16
    v_add_u32 v7, s42, v5
    v_xor_b32 v9, v6, v2
    v_lshlrev_b32 v9, 4, v9
    v_xor_b32 v10, 64, v9
    v_mov_b32 v11, 2047
    v_mov_b32 v8, 1280
    v_add_u32 v36, 0, v7
    v_med3_i32 v36, v36, 0, v11
    v_mad_u32_u24 v36, v36, v8, v9
    v_add_u32 v36, 4096, v36
    v_add_u32 v37, 8, v7
    v_med3_i32 v37, v37, 0, v11
    v_mad_u32_u24 v37, v37, v8, v10
    v_add_u32 v37, 3072, v37
    v_add_u32 v38, 16, v7
    v_med3_i32 v38, v38, 0, v11
    v_mad_u32_u24 v38, v38, v8, v9
    v_add_u32 v38, 2048, v38
    v_add_u32 v39, 24, v7
    v_med3_i32 v39, v39, 0, v11
    v_mad_u32_u24 v39, v39, v8, v10
    v_add_u32 v39, 1024, v39
    v_add_u32 v40, 32, v7
    v_med3_i32 v40, v40, 0, v11
    v_mad_u32_u24 v40, v40, v8, v9
    v_add_u32 v40, 4096, v40
    v_add_u32 v41, 40, v7
    v_med3_i32 v41, v41, 0, v11
    v_mad_u32_u24 v41, v41, v8, v10
    v_add_u32 v41, 3072, v41
    v_add_u32 v42, 48, v7
    v_med3_i32 v42, v42, 0, v11
    v_mad_u32_u24 v42, v42, v8, v9
    v_add_u32 v42, 2048, v42
    v_add_u32 v43, 56, v7
    v_med3_i32 v43, v43, 0, v11
    v_mad_u32_u24 v43, v43, v8, v10
    v_add_u32 v43, 1024, v43
    v_add_u32 v44, 64, v7
    v_med3_i32 v44, v44, 0, v11
    v_mad_u32_u24 v44, v44, v8, v9
    v_add_u32 v44, 4096, v44
    v_add_u32 v45, 72, v7
    v_med3_i32 v45, v45, 0, v11
    v_mad_u32_u24 v45, v45, v8, v10
    v_add_u32 v45, 3072, v45
    v_add_u32 v46, 80, v7
    v_med3_i32 v46, v46, 0, v11
    v_mad_u32_u24 v46, v46, v8, v9
    v_add_u32 v46, 2048, v46
    v_add_u32 v47, 88, v7
    v_med3_i32 v47, v47, 0, v11
    v_mad_u32_u24 v47, v47, v8, v10
    v_add_u32 v47, 1024, v47
    v_add_u32 v48, 96, v7
    v_med3_i32 v48, v48, 0, v11
    v_mad_u32_u24 v48, v48, v8, v9
    v_add_u32 v48, 4096, v48
    v_add_u32 v49, 104, v7
    v_med3_i32 v49, v49, 0, v11
    v_mad_u32_u24 v49, v49, v8, v10
    v_add_u32 v49, 3072, v49
    s_mov_b32 s78, s46
    s_waitcnt lgkmcnt(0)
    s_sub_u32 s48, s4, 4096
    s_subb_u32 s49, s5, 0
    s_mov_b32 s50, 2625536
    s_mov_b32 s51, 0x20000
    s_mov_b64 s[52:53], s[6:7]
    s_mov_b32 s54, 2457600
    s_mov_b32 s55, 0x20000
    s_add_u32 s56, s6, 1280
    s_addc_u32 s57, s7, 0
    s_mov_b32 s58, 2456320
    s_mov_b32 s59, 0x20000
    s_add_u32 s60, s6, 2560
    s_addc_u32 s61, s7, 0
    s_mov_b32 s62, 2455040
    s_mov_b32 s63, 0x20000
    s_mul_i32 s68, s78, 245760
    s_lshl_b32 s47, s78, 7
    s_mov_b32 m0, 24576
    s_nop 0
    buffer_load_dwordx4 v36, s[48:51], s47 offen lds
    buffer_load_dwordx4 v37, s[48:51], s47 offen offset:1024 lds
    buffer_load_dwordx4 v38, s[48:51], s47 offen offset:2048 lds
    buffer_load_dwordx4 v39, s[48:51], s47 offen offset:3072 lds
    s_mov_b32 m0, 0
    s_nop 0
    buffer_load_dwordx4 v28, s[52:55], s68 offen lds
    buffer_load_dwordx4 v29, s[52:55], s68 offen offset:1024 lds
    buffer_load_dwordx4 v30, s[52:55], s68 offen offset:2048 lds
    buffer_load_dwordx4 v31, s[52:55], s68 offen offset:3072 lds
    s_mov_b32 m0, 28672
    s_nop 0
    buffer_load_dwordx4 v40, s[48:51], s47 offen lds
    buffer_load_dwordx4 v41, s[48:51], s47 offen offset:1024 lds
    buffer_load_dwordx4 v42, s[48:51], s47 offen offset:2048 lds
    buffer_load_dwordx4 v43, s[48:51], s47 offen offset:3072 lds
    s_mov_b32 m0, 8192
    s_nop 0
    buffer_load_dwordx4 v28, s[56:59], s68 offen lds
    buffer_load_dwordx4 v29, s[56:59], s68 offen offset:1024 lds
    buffer_load_dwordx4 v30, s[56:59], s68 offen offset:2048 lds
    buffer_load_dwordx4 v31, s[56:59], s68 offen offset:3072 lds
    s_mov_b32 m0, 32768
    s_nop 0
    buffer_load_dwordx4 v44, s[48:51], s47 offen lds
    buffer_load_dwordx4 v45, s[48:51], s47 offen offset:1024 lds
    buffer_load_dwordx4 v46, s[48:51], s47 offen offset:2048 lds
    buffer_load_dwordx4 v47, s[48:51], s47 offen offset:3072 lds
    s_mov_b32 m0, 16384
    s_nop 0
    buffer_load_dwordx4 v28, s[60:63], s68 offen lds
    buffer_load_dwordx4 v29, s[60:63], s68 offen offset:1024 lds
    buffer_load_dwordx4 v30, s[60:63], s68 offen offset:2048 lds
    buffer_load_dwordx4 v31, s[60:63], s68 offen offset:3072 lds
    s_mov_b32 m0, 36864
    s_nop 0
    buffer_load_dwordx4 v48, s[48:51], s47 offen lds
    buffer_load_dwordx4 v49, s[48:51], s47 offen offset:1024 lds
    s_mov_b32 m0, 4096
    s_nop 0
    buffer_load_dwordx4 v32, s[52:55], s68 offen lds
    buffer_load_dwordx4 v33, s[52:55], s68 offen offset:1024 lds
    buffer_load_dwordx4 v34, s[52:55], s68 offen offset:2048 lds
    buffer_load_dwordx4 v35, s[52:55], s68 offen offset:3072 lds
    s_mov_b32 m0, 12288
    s_nop 0
    buffer_load_dwordx4 v32, s[56:59], s68 offen lds
    buffer_load_dwordx4 v33, s[56:59], s68 offen offset:1024 lds
    buffer_load_dwordx4 v34, s[56:59], s68 offen offset:2048 lds
    buffer_load_dwordx4 v35, s[56:59], s68 offen offset:3072 lds
    s_mov_b32 m0, 20480
    s_nop 0
    buffer_load_dwordx4 v32, s[60:63], s68 offen lds
    buffer_load_dwordx4 v33, s[60:63], s68 offen offset:1024 lds
    buffer_load_dwordx4 v34, s[60:63], s68 offen offset:2048 lds
    buffer_load_dwordx4 v35, s[60:63], s68 offen offset:3072 lds
    s_add_u32 s78, s78, 1
    s_cmp_eq_u32 s78, 10
    s_cselect_b32 s78, 0, s78
    s_mov_b64 s[28:29], s[24:25]
    s_mov_b32 s30, 268435456
    s_mov_b32 s31, 0x20000
    s_mov_b64 s[32:33], s[22:23]
    s_mov_b32 s34, 256
    s_mov_b32 s35, 0x20000
    s_load_dword s38, s[28:29], 0
    s_sub_u32 s64, s8, 65536
    s_subb_u32 s65, s9, 0
    s_mov_b32 s66, 884736
    s_mov_b32 s67, 0x20000
    s_mul_i32 s69, s78, 245760
    s_lshl_b32 s47, s78, 7
    s_mov_b32 m0, 63616
    s_nop 0
    buffer_load_dwordx4 v36, s[48:51], s47 offen lds
    buffer_load_dwordx4 v37, s[48:51], s47 offen offset:1024 lds
    buffer_load_dwordx4 v38, s[48:51], s47 offen offset:2048 lds
    buffer_load_dwordx4 v39, s[48:51], s47 offen offset:3072 lds
    s_mov_b32 m0, 39040
    s_nop 0
    buffer_load_dwordx4 v28, s[52:55], s69 offen lds
    buffer_load_dwordx4 v29, s[52:55], s69 offen offset:1024 lds
    buffer_load_dwordx4 v30, s[52:55], s69 offen offset:2048 lds
    buffer_load_dwordx4 v31, s[52:55], s69 offen offset:3072 lds
    s_mov_b32 m0, 67712
    s_nop 0
    buffer_load_dwordx4 v40, s[48:51], s47 offen lds
    buffer_load_dwordx4 v41, s[48:51], s47 offen offset:1024 lds
    buffer_load_dwordx4 v42, s[48:51], s47 offen offset:2048 lds
    buffer_load_dwordx4 v43, s[48:51], s47 offen offset:3072 lds
    s_mov_b32 m0, 47232
    s_nop 0
    buffer_load_dwordx4 v28, s[56:59], s69 offen lds
    buffer_load_dwordx4 v29, s[56:59], s69 offen offset:1024 lds
    buffer_load_dwordx4 v30, s[56:59], s69 offen offset:2048 lds
    buffer_load_dwordx4 v31, s[56:59], s69 offen offset:3072 lds
    s_mov_b32 m0, 71808
    s_nop 0
    buffer_load_dwordx4 v44, s[48:51], s47 offen lds
    buffer_load_dwordx4 v45, s[48:51], s47 offen offset:1024 lds
    buffer_load_dwordx4 v46, s[48:51], s47 offen offset:2048 lds
    buffer_load_dwordx4 v47, s[48:51], s47 offen offset:3072 lds
    s_mov_b32 m0, 55424
    s_nop 0
    buffer_load_dwordx4 v28, s[60:63], s69 offen lds
    buffer_load_dwordx4 v29, s[60:63], s69 offen offset:1024 lds
    buffer_load_dwordx4 v30, s[60:63], s69 offen offset:2048 lds
    buffer_load_dwordx4 v31, s[60:63], s69 offen offset:3072 lds
    s_mov_b32 m0, 75904
    s_nop 0
    buffer_load_dwordx4 v48, s[48:51], s47 offen lds
    s_waitcnt vmcnt(55)
    buffer_load_dwordx4 v49, s[48:51], s47 offen offset:1024 lds
    s_mov_b32 m0, 43136
    s_nop 0
    buffer_load_dwordx4 v32, s[52:55], s69 offen lds
    buffer_load_dwordx4 v33, s[52:55], s69 offen offset:1024 lds
    buffer_load_dwordx4 v34, s[52:55], s69 offen offset:2048 lds
    buffer_load_dwordx4 v35, s[52:55], s69 offen offset:3072 lds
    s_mov_b32 m0, 51328
    s_nop 0
    buffer_load_dwordx4 v32, s[56:59], s69 offen lds
    buffer_load_dwordx4 v33, s[56:59], s69 offen offset:1024 lds
    buffer_load_dwordx4 v34, s[56:59], s69 offen offset:2048 lds
    s_waitcnt vmcnt(55)
    buffer_load_dwordx4 v35, s[56:59], s69 offen offset:3072 lds
    s_mov_b32 m0, 59520
    s_nop 0
    buffer_load_dwordx4 v32, s[60:63], s69 offen lds
    buffer_load_dwordx4 v33, s[60:63], s69 offen offset:1024 lds
    buffer_load_dwordx4 v34, s[60:63], s69 offen offset:2048 lds
    buffer_load_dwordx4 v35, s[60:63], s69 offen offset:3072 lds
    s_add_u32 s78, s78, 1
    s_cmp_eq_u32 s78, 10
    s_cselect_b32 s78, 0, s78
    s_waitcnt vmcnt(38) lgkmcnt(0)
    s_barrier
    s_add_u32 s38, s38, 0x9e3779b8
    s_or_b32 s38, s38, 1
    s_mul_i32 s70, s78, 245760
    s_lshl_b32 s47, s78, 7
    s_mov_b32 m0, 102656
    s_nop 0
    buffer_load_dwordx4 v36, s[48:51], s47 offen lds
    buffer_load_dwordx4 v37, s[48:51], s47 offen offset:1024 lds
    buffer_load_dwordx4 v38, s[48:51], s47 offen offset:2048 lds
    buffer_load_dwordx4 v39, s[48:51], s47 offen offset:3072 lds
    s_mov_b32 m0, 78080
    s_nop 0
    buffer_load_dwordx4 v28, s[52:55], s70 offen lds
    buffer_load_dwordx4 v29, s[52:55], s70 offen offset:1024 lds
    buffer_load_dwordx4 v30, s[52:55], s70 offen offset:2048 lds
    buffer_load_dwordx4 v31, s[52:55], s70 offen offset:3072 lds
    s_mov_b32 m0, 106752
    s_nop 0
    buffer_load_dwordx4 v40, s[48:51], s47 offen lds
    buffer_load_dwordx4 v41, s[48:51], s47 offen offset:1024 lds
    buffer_load_dwordx4 v42, s[48:51], s47 offen offset:2048 lds
    buffer_load_dwordx4 v43, s[48:51], s47 offen offset:3072 lds
    s_mov_b32 m0, 86272
    s_nop 0
    buffer_load_dwordx4 v28, s[56:59], s70 offen lds
    buffer_load_dwordx4 v29, s[56:59], s70 offen offset:1024 lds
    buffer_load_dwordx4 v30, s[56:59], s70 offen offset:2048 lds
    buffer_load_dwordx4 v31, s[56:59], s70 offen offset:3072 lds
    s_mov_b32 m0, 110848
    s_nop 0
    buffer_load_dwordx4 v44, s[48:51], s47 offen lds
    buffer_load_dwordx4 v45, s[48:51], s47 offen offset:1024 lds
    buffer_load_dwordx4 v46, s[48:51], s47 offen offset:2048 lds
    buffer_load_dwordx4 v47, s[48:51], s47 offen offset:3072 lds
    s_mov_b32 m0, 94464
    s_nop 0
    buffer_load_dwordx4 v28, s[60:63], s70 offen lds
    buffer_load_dwordx4 v29, s[60:63], s70 offen offset:1024 lds
    buffer_load_dwordx4 v30, s[60:63], s70 offen offset:2048 lds
    buffer_load_dwordx4 v31, s[60:63], s70 offen offset:3072 lds
    s_mov_b32 m0, 114944
    s_nop 0
    buffer_load_dwordx4 v48, s[48:51], s47 offen lds
    s_waitcnt vmcnt(55)
    buffer_load_dwordx4 v49, s[48:51], s47 offen offset:1024 lds
    s_mov_b32 m0, 82176
    s_nop 0
    buffer_load_dwordx4 v32, s[52:55], s70 offen lds
    buffer_load_dwordx4 v33, s[52:55], s70 offen offset:1024 lds
    buffer_load_dwordx4 v34, s[52:55], s70 offen offset:2048 lds
    buffer_load_dwordx4 v35, s[52:55], s70 offen offset:3072 lds
    s_mov_b32 m0, 90368
    s_nop 0
    buffer_load_dwordx4 v32, s[56:59], s70 offen lds
    buffer_load_dwordx4 v33, s[56:59], s70 offen offset:1024 lds
    buffer_load_dwordx4 v34, s[56:59], s70 offen offset:2048 lds
    s_waitcnt vmcnt(55)
    buffer_load_dwordx4 v35, s[56:59], s70 offen offset:3072 lds
    s_mov_b32 m0, 98560
    s_nop 0
    buffer_load_dwordx4 v32, s[60:63], s70 offen lds
    buffer_load_dwordx4 v33, s[60:63], s70 offen offset:1024 lds
    buffer_load_dwordx4 v34, s[60:63], s70 offen offset:2048 lds
    buffer_load_dwordx4 v35, s[60:63], s70 offen offset:3072 lds
    s_add_u32 s78, s78, 1
    s_cmp_eq_u32 s78, 10
    s_cselect_b32 s78, 0, s78
    s_waitcnt vmcnt(38) lgkmcnt(0)
    s_barrier
    s_mul_i32 s71, s78, 245760
    s_lshl_b32 s47, s78, 7
    s_mov_b32 m0, 141696
    s_nop 0
    buffer_load_dwordx4 v36, s[48:51], s47 offen lds
    buffer_load_dwordx4 v37, s[48:51], s47 offen offset:1024 lds
    buffer_load_dwordx4 v38, s[48:51], s47 offen offset:2048 lds
    buffer_load_dwordx4 v39, s[48:51], s47 offen offset:3072 lds
    s_mov_b32 m0, 117120
    s_nop 0
    buffer_load_dwordx4 v28, s[52:55], s71 offen lds
    buffer_load_dwordx4 v29, s[52:55], s71 offen offset:1024 lds
    buffer_load_dwordx4 v30, s[52:55], s71 offen offset:2048 lds
    buffer_load_dwordx4 v31, s[52:55], s71 offen offset:3072 lds
    s_mov_b32 m0, 145792
    s_nop 0
    buffer_load_dwordx4 v40, s[48:51], s47 offen lds
    buffer_load_dwordx4 v41, s[48:51], s47 offen offset:1024 lds
    buffer_load_dwordx4 v42, s[48:51], s47 offen offset:2048 lds
    buffer_load_dwordx4 v43, s[48:51], s47 offen offset:3072 lds
    s_mov_b32 m0, 125312
    s_nop 0
    buffer_load_dwordx4 v28, s[56:59], s71 offen lds
    buffer_load_dwordx4 v29, s[56:59], s71 offen offset:1024 lds
    buffer_load_dwordx4 v30, s[56:59], s71 offen offset:2048 lds
    buffer_load_dwordx4 v31, s[56:59], s71 offen offset:3072 lds
    s_mov_b32 m0, 149888
    s_nop 0
    buffer_load_dwordx4 v44, s[48:51], s47 offen lds
    buffer_load_dwordx4 v45, s[48:51], s47 offen offset:1024 lds
    buffer_load_dwordx4 v46, s[48:51], s47 offen offset:2048 lds
    buffer_load_dwordx4 v47, s[48:51], s47 offen offset:3072 lds
    s_mov_b32 m0, 133504
    s_nop 0
    buffer_load_dwordx4 v28, s[60:63], s71 offen lds
    buffer_load_dwordx4 v29, s[60:63], s71 offen offset:1024 lds
    buffer_load_dwordx4 v30, s[60:63], s71 offen offset:2048 lds
    buffer_load_dwordx4 v31, s[60:63], s71 offen offset:3072 lds
    s_mov_b32 m0, 153984
    s_nop 0
    buffer_load_dwordx4 v48, s[48:51], s47 offen lds
    s_waitcnt vmcnt(55)
    buffer_load_dwordx4 v49, s[48:51], s47 offen offset:1024 lds
    s_mov_b32 m0, 121216
    s_nop 0
    buffer_load_dwordx4 v32, s[52:55], s71 offen lds
    buffer_load_dwordx4 v33, s[52:55], s71 offen offset:1024 lds
    buffer_load_dwordx4 v34, s[52:55], s71 offen offset:2048 lds
    buffer_load_dwordx4 v35, s[52:55], s71 offen offset:3072 lds
    s_mov_b32 m0, 129408
    s_nop 0
    buffer_load_dwordx4 v32, s[56:59], s71 offen lds
    buffer_load_dwordx4 v33, s[56:59], s71 offen offset:1024 lds
    buffer_load_dwordx4 v34, s[56:59], s71 offen offset:2048 lds
    s_waitcnt vmcnt(55)
    buffer_load_dwordx4 v35, s[56:59], s71 offen offset:3072 lds
    s_mov_b32 m0, 137600
    s_nop 0
    buffer_load_dwordx4 v32, s[60:63], s71 offen lds
    buffer_load_dwordx4 v33, s[60:63], s71 offen offset:1024 lds
    buffer_load_dwordx4 v34, s[60:63], s71 offen offset:2048 lds
    buffer_load_dwordx4 v35, s[60:63], s71 offen offset:3072 lds
    s_add_u32 s78, s78, 1
    s_cmp_eq_u32 s78, 10
    s_cselect_b32 s78, 0, s78
    s_waitcnt vmcnt(38) lgkmcnt(0)
    s_barrier
    s_mul_i32 s72, s78, 245760
    s_lshl_b32 s47, s78, 7
    s_mov_b32 m0, 24576
    s_nop 0
    buffer_load_dwordx4 v36, s[48:51], s47 offen lds
    buffer_load_dwordx4 v37, s[48:51], s47 offen offset:1024 lds
    buffer_load_dwordx4 v38, s[48:51], s47 offen offset:2048 lds
    buffer_load_dwordx4 v39, s[48:51], s47 offen offset:3072 lds
    s_mov_b32 m0, 0
    s_nop 0
    buffer_load_dwordx4 v28, s[52:55], s72 offen lds
    buffer_load_dwordx4 v29, s[52:55], s72 offen offset:1024 lds
    buffer_load_dwordx4 v30, s[52:55], s72 offen offset:2048 lds
    buffer_load_dwordx4 v31, s[52:55], s72 offen offset:3072 lds
    s_mov_b32 m0, 28672
    s_nop 0
    buffer_load_dwordx4 v40, s[48:51], s47 offen lds
    buffer_load_dwordx4 v41, s[48:51], s47 offen offset:1024 lds
    buffer_load_dwordx4 v42, s[48:51], s47 offen offset:2048 lds
    buffer_load_dwordx4 v43, s[48:51], s47 offen offset:3072 lds
    s_mov_b32 m0, 8192
    s_nop 0
    buffer_load_dwordx4 v28, s[56:59], s72 offen lds
    buffer_load_dwordx4 v29, s[56:59], s72 offen offset:1024 lds
    buffer_load_dwordx4 v30, s[56:59], s72 offen offset:2048 lds
    buffer_load_dwordx4 v31, s[56:59], s72 offen offset:3072 lds
    s_mov_b32 m0, 32768
    s_nop 0
    buffer_load_dwordx4 v44, s[48:51], s47 offen lds
    buffer_load_dwordx4 v45, s[48:51], s47 offen offset:1024 lds
    buffer_load_dwordx4 v46, s[48:51], s47 offen offset:2048 lds
    buffer_load_dwordx4 v47, s[48:51], s47 offen offset:3072 lds
    s_mov_b32 m0, 16384
    s_nop 0
    buffer_load_dwordx4 v28, s[60:63], s72 offen lds
    buffer_load_dwordx4 v29, s[60:63], s72 offen offset:1024 lds
    buffer_load_dwordx4 v30, s[60:63], s72 offen offset:2048 lds
    buffer_load_dwordx4 v31, s[60:63], s72 offen offset:3072 lds
    s_mov_b32 m0, 36864
    s_nop 0
    buffer_load_dwordx4 v48, s[48:51], s47 offen lds
    s_waitcnt vmcnt(55)
    buffer_load_dwordx4 v49, s[48:51], s47 offen offset:1024 lds
    s_mov_b32 m0, 4096
    s_nop 0
    buffer_load_dwordx4 v32, s[52:55], s72 offen lds
    buffer_load_dwordx4 v33, s[52:55], s72 offen offset:1024 lds
    buffer_load_dwordx4 v34, s[52:55], s72 offen offset:2048 lds
    buffer_load_dwordx4 v35, s[52:55], s72 offen offset:3072 lds
    s_mov_b32 m0, 12288
    s_nop 0
    buffer_load_dwordx4 v32, s[56:59], s72 offen lds
    buffer_load_dwordx4 v33, s[56:59], s72 offen offset:1024 lds
    buffer_load_dwordx4 v34, s[56:59], s72 offen offset:2048 lds
    s_waitcnt vmcnt(55)
    buffer_load_dwordx4 v35, s[56:59], s72 offen offset:3072 lds
    s_mov_b32 m0, 20480
    s_nop 0
    buffer_load_dwordx4 v32, s[60:63], s72 offen lds
    buffer_load_dwordx4 v33, s[60:63], s72 offen offset:1024 lds
    buffer_load_dwordx4 v34, s[60:63], s72 offen offset:2048 lds
    buffer_load_dwordx4 v35, s[60:63], s72 offen offset:3072 lds
    s_add_u32 s78, s78, 1
    s_cmp_eq_u32 s78, 10
    s_cselect_b32 s78, 0, s78
    s_waitcnt vmcnt(38) lgkmcnt(0)
    s_barrier
    s_mul_i32 s73, s78, 245760
    s_lshl_b32 s47, s78, 7
    s_mov_b32 m0, 63616
    s_nop 0
    buffer_load_dwordx4 v36, s[48:51], s47 offen lds
    buffer_load_dwordx4 v37, s[48:51], s47 offen offset:1024 lds
    buffer_load_dwordx4 v38, s[48:51], s47 offen offset:2048 lds
    buffer_load_dwordx4 v39, s[48:51], s47 offen offset:3072 lds
    s_mov_b32 m0, 39040
    s_nop 0
    buffer_load_dwordx4 v28, s[52:55], s73 offen lds
    buffer_load_dwordx4 v29, s[52:55], s73 offen offset:1024 lds
    buffer_load_dwordx4 v30, s[52:55], s73 offen offset:2048 lds
    buffer_load_dwordx4 v31, s[52:55], s73 offen offset:3072 lds
    s_mov_b32 m0, 67712
    s_nop 0
    buffer_load_dwordx4 v40, s[48:51], s47 offen lds
    buffer_load_dwordx4 v41, s[48:51], s47 offen offset:1024 lds
    buffer_load_dwordx4 v42, s[48:51], s47 offen offset:2048 lds
    buffer_load_dwordx4 v43, s[48:51], s47 offen offset:3072 lds
    s_mov_b32 m0, 47232
    s_nop 0
    buffer_load_dwordx4 v28, s[56:59], s73 offen lds
    buffer_load_dwordx4 v29, s[56:59], s73 offen offset:1024 lds
    buffer_load_dwordx4 v30, s[56:59], s73 offen offset:2048 lds
    buffer_load_dwordx4 v31, s[56:59], s73 offen offset:3072 lds
    s_mov_b32 m0, 71808
    s_nop 0
    buffer_load_dwordx4 v44, s[48:51], s47 offen lds
    buffer_load_dwordx4 v45, s[48:51], s47 offen offset:1024 lds
    buffer_load_dwordx4 v46, s[48:51], s47 offen offset:2048 lds
    buffer_load_dwordx4 v47, s[48:51], s47 offen offset:3072 lds
    s_mov_b32 m0, 55424
    s_nop 0
    buffer_load_dwordx4 v28, s[60:63], s73 offen lds
    buffer_load_dwordx4 v29, s[60:63], s73 offen offset:1024 lds
    buffer_load_dwordx4 v30, s[60:63], s73 offen offset:2048 lds
    buffer_load_dwordx4 v31, s[60:63], s73 offen offset:3072 lds
    s_mov_b32 m0, 75904
    s_nop 0
    buffer_load_dwordx4 v48, s[48:51], s47 offen lds
    s_waitcnt vmcnt(55)
    buffer_load_dwordx4 v49, s[48:51], s47 offen offset:1024 lds
    s_mov_b32 m0, 43136
    s_nop 0
    buffer_load_dwordx4 v32, s[52:55], s73 offen lds
    buffer_load_dwordx4 v33, s[52:55], s73 offen offset:1024 lds
    buffer_load_dwordx4 v34, s[52:55], s73 offen offset:2048 lds
    buffer_load_dwordx4 v35, s[52:55], s73 offen offset:3072 lds
    s_mov_b32 m0, 51328
    s_nop 0
    buffer_load_dwordx4 v32, s[56:59], s73 offen lds
    buffer_load_dwordx4 v33, s[56:59], s73 offen offset:1024 lds
    buffer_load_dwordx4 v34, s[56:59], s73 offen offset:2048 lds
    s_waitcnt vmcnt(55)
    buffer_load_dwordx4 v35, s[56:59], s73 offen offset:3072 lds
    s_mov_b32 m0, 59520
    s_nop 0
    buffer_load_dwordx4 v32, s[60:63], s73 offen lds
    buffer_load_dwordx4 v33, s[60:63], s73 offen offset:1024 lds
    buffer_load_dwordx4 v34, s[60:63], s73 offen offset:2048 lds
    buffer_load_dwordx4 v35, s[60:63], s73 offen offset:3072 lds
    s_add_u32 s78, s78, 1
    s_cmp_eq_u32 s78, 10
    s_cselect_b32 s78, 0, s78
    s_waitcnt vmcnt(38) lgkmcnt(0)
    s_barrier
    s_mul_i32 s74, s78, 245760
    s_lshl_b32 s47, s78, 7
    s_mov_b32 m0, 102656
    s_nop 0
    buffer_load_dwordx4 v36, s[48:51], s47 offen lds
    buffer_load_dwordx4 v37, s[48:51], s47 offen offset:1024 lds
    buffer_load_dwordx4 v38, s[48:51], s47 offen offset:2048 lds
    buffer_load_dwordx4 v39, s[48:51], s47 offen offset:3072 lds
    s_mov_b32 m0, 78080
    s_nop 0
    buffer_load_dwordx4 v28, s[52:55], s74 offen lds
    buffer_load_dwordx4 v29, s[52:55], s74 offen offset:1024 lds
    buffer_load_dwordx4 v30, s[52:55], s74 offen offset:2048 lds
    buffer_load_dwordx4 v31, s[52:55], s74 offen offset:3072 lds
    s_mov_b32 m0, 106752
    s_nop 0
    buffer_load_dwordx4 v40, s[48:51], s47 offen lds
    buffer_load_dwordx4 v41, s[48:51], s47 offen offset:1024 lds
    buffer_load_dwordx4 v42, s[48:51], s47 offen offset:2048 lds
    buffer_load_dwordx4 v43, s[48:51], s47 offen offset:3072 lds
    s_mov_b32 m0, 86272
    s_nop 0
    buffer_load_dwordx4 v28, s[56:59], s74 offen lds
    buffer_load_dwordx4 v29, s[56:59], s74 offen offset:1024 lds
    buffer_load_dwordx4 v30, s[56:59], s74 offen offset:2048 lds
    buffer_load_dwordx4 v31, s[56:59], s74 offen offset:3072 lds
    s_mov_b32 m0, 110848
    s_nop 0
    buffer_load_dwordx4 v44, s[48:51], s47 offen lds
    buffer_load_dwordx4 v45, s[48:51], s47 offen offset:1024 lds
    buffer_load_dwordx4 v46, s[48:51], s47 offen offset:2048 lds
    buffer_load_dwordx4 v47, s[48:51], s47 offen offset:3072 lds
    s_mov_b32 m0, 82176
    s_nop 0
    buffer_load_dwordx4 v32, s[52:55], s74 offen lds
    buffer_load_dwordx4 v33, s[52:55], s74 offen offset:1024 lds
    buffer_load_dwordx4 v34, s[52:55], s74 offen offset:2048 lds
    buffer_load_dwordx4 v35, s[52:55], s74 offen offset:3072 lds
    s_mov_b32 m0, 114944
    s_nop 0
    buffer_load_dwordx4 v48, s[48:51], s47 offen lds
    s_waitcnt vmcnt(55)
    buffer_load_dwordx4 v49, s[48:51], s47 offen offset:1024 lds
    s_mov_b32 m0, 90368
    s_nop 0
    buffer_load_dwordx4 v32, s[56:59], s74 offen lds
    buffer_load_dwordx4 v33, s[56:59], s74 offen offset:1024 lds
    buffer_load_dwordx4 v34, s[56:59], s74 offen offset:2048 lds
    buffer_load_dwordx4 v35, s[56:59], s74 offen offset:3072 lds
    s_add_u32 s78, s78, 1
    s_cmp_eq_u32 s78, 10
    s_cselect_b32 s78, 0, s78
    s_waitcnt vmcnt(30) lgkmcnt(0)
    s_barrier
    s_mul_i32 s75, s78, 245760
    s_lshl_b32 s47, s78, 7
    s_mov_b32 m0, 141696
    s_nop 0
    buffer_load_dwordx4 v36, s[48:51], s47 offen lds
    buffer_load_dwordx4 v37, s[48:51], s47 offen offset:1024 lds
    buffer_load_dwordx4 v38, s[48:51], s47 offen offset:2048 lds
    buffer_load_dwordx4 v39, s[48:51], s47 offen offset:3072 lds
    s_mov_b32 m0, 117120
    s_nop 0
    buffer_load_dwordx4 v28, s[52:55], s75 offen lds
    buffer_load_dwordx4 v29, s[52:55], s75 offen offset:1024 lds
    buffer_load_dwordx4 v30, s[52:55], s75 offen offset:2048 lds
    buffer_load_dwordx4 v31, s[52:55], s75 offen offset:3072 lds
    s_mov_b32 m0, 145792
    s_nop 0
    buffer_load_dwordx4 v40, s[48:51], s47 offen lds
    buffer_load_dwordx4 v41, s[48:51], s47 offen offset:1024 lds
    buffer_load_dwordx4 v42, s[48:51], s47 offen offset:2048 lds
    buffer_load_dwordx4 v43, s[48:51], s47 offen offset:3072 lds
    s_mov_b32 m0, 125312
    s_nop 0
    buffer_load_dwordx4 v28, s[56:59], s75 offen lds
    buffer_load_dwordx4 v29, s[56:59], s75 offen offset:1024 lds
    buffer_load_dwordx4 v30, s[56:59], s75 offen offset:2048 lds
    buffer_load_dwordx4 v31, s[56:59], s75 offen offset:3072 lds
    s_mov_b32 m0, 149888
    s_nop 0
    buffer_load_dwordx4 v44, s[48:51], s47 offen lds
    buffer_load_dwordx4 v45, s[48:51], s47 offen offset:1024 lds
    buffer_load_dwordx4 v46, s[48:51], s47 offen offset:2048 lds
    buffer_load_dwordx4 v47, s[48:51], s47 offen offset:3072 lds
    s_mov_b32 m0, 121216
    s_nop 0
    buffer_load_dwordx4 v32, s[52:55], s75 offen lds
    buffer_load_dwordx4 v33, s[52:55], s75 offen offset:1024 lds
    buffer_load_dwordx4 v34, s[52:55], s75 offen offset:2048 lds
    buffer_load_dwordx4 v35, s[52:55], s75 offen offset:3072 lds
    s_mov_b32 m0, 153984
    s_nop 0
    buffer_load_dwordx4 v48, s[48:51], s47 offen lds
    buffer_load_dwordx4 v49, s[48:51], s47 offen offset:1024 lds
    s_mov_b32 m0, 129408
    s_nop 0
    buffer_load_dwordx4 v32, s[56:59], s75 offen lds
    buffer_load_dwordx4 v33, s[56:59], s75 offen offset:1024 lds
    buffer_load_dwordx4 v34, s[56:59], s75 offen offset:2048 lds
    buffer_load_dwordx4 v35, s[56:59], s75 offen offset:3072 lds
    s_add_u32 s78, s78, 1
    s_cmp_eq_u32 s78, 10
    s_cselect_b32 s78, 0, s78
    s_waitcnt vmcnt(30) lgkmcnt(0)
    s_barrier
    s_mul_i32 s76, s78, 245760
    s_lshl_b32 s47, s78, 7
    s_mov_b32 m0, 24576
    s_nop 0
    buffer_load_dwordx4 v36, s[48:51], s47 offen lds
    buffer_load_dwordx4 v37, s[48:51], s47 offen offset:1024 lds
    buffer_load_dwordx4 v38, s[48:51], s47 offen offset:2048 lds
    buffer_load_dwordx4 v39, s[48:51], s47 offen offset:3072 lds
    s_mov_b32 m0, 0
    s_nop 0
    buffer_load_dwordx4 v28, s[52:55], s76 offen lds
    buffer_load_dwordx4 v29, s[52:55], s76 offen offset:1024 lds
    buffer_load_dwordx4 v30, s[52:55], s76 offen offset:2048 lds
    buffer_load_dwordx4 v31, s[52:55], s76 offen offset:3072 lds
    s_mov_b32 m0, 28672
    s_nop 0
    buffer_load_dwordx4 v40, s[48:51], s47 offen lds
    buffer_load_dwordx4 v41, s[48:51], s47 offen offset:1024 lds
    buffer_load_dwordx4 v42, s[48:51], s47 offen offset:2048 lds
    buffer_load_dwordx4 v43, s[48:51], s47 offen offset:3072 lds
    s_mov_b32 m0, 8192
    s_nop 0
    buffer_load_dwordx4 v28, s[56:59], s76 offen lds
    buffer_load_dwordx4 v29, s[56:59], s76 offen offset:1024 lds
    buffer_load_dwordx4 v30, s[56:59], s76 offen offset:2048 lds
    buffer_load_dwordx4 v31, s[56:59], s76 offen offset:3072 lds
    s_mov_b32 m0, 32768
    s_nop 0
    buffer_load_dwordx4 v44, s[48:51], s47 offen lds
    buffer_load_dwordx4 v45, s[48:51], s47 offen offset:1024 lds
    buffer_load_dwordx4 v46, s[48:51], s47 offen offset:2048 lds
    buffer_load_dwordx4 v47, s[48:51], s47 offen offset:3072 lds
    s_mov_b32 m0, 4096
    s_nop 0
    buffer_load_dwordx4 v32, s[52:55], s76 offen lds
    buffer_load_dwordx4 v33, s[52:55], s76 offen offset:1024 lds
    buffer_load_dwordx4 v34, s[52:55], s76 offen offset:2048 lds
    buffer_load_dwordx4 v35, s[52:55], s76 offen offset:3072 lds
    s_mov_b32 m0, 36864
    s_nop 0
    buffer_load_dwordx4 v48, s[48:51], s47 offen lds
    buffer_load_dwordx4 v49, s[48:51], s47 offen offset:1024 lds
    s_mov_b32 m0, 12288
    s_nop 0
    buffer_load_dwordx4 v32, s[56:59], s76 offen lds
    buffer_load_dwordx4 v33, s[56:59], s76 offen offset:1024 lds
    buffer_load_dwordx4 v34, s[56:59], s76 offen offset:2048 lds
    buffer_load_dwordx4 v35, s[56:59], s76 offen offset:3072 lds
    s_add_u32 s78, s78, 1
    s_cmp_eq_u32 s78, 10
    s_cselect_b32 s78, 0, s78
    s_waitcnt vmcnt(30) lgkmcnt(0)
    s_barrier
    s_mul_i32 s77, s78, 245760
    s_lshl_b32 s47, s78, 7
    s_mov_b32 m0, 63616
    s_nop 0
    buffer_load_dwordx4 v36, s[48:51], s47 offen lds
    buffer_load_dwordx4 v37, s[48:51], s47 offen offset:1024 lds
    buffer_load_dwordx4 v38, s[48:51], s47 offen offset:2048 lds
    buffer_load_dwordx4 v39, s[48:51], s47 offen offset:3072 lds
    s_mov_b32 m0, 39040
    s_nop 0
    buffer_load_dwordx4 v28, s[52:55], s77 offen lds
    buffer_load_dwordx4 v29, s[52:55], s77 offen offset:1024 lds
    buffer_load_dwordx4 v30, s[52:55], s77 offen offset:2048 lds
    buffer_load_dwordx4 v31, s[52:55], s77 offen offset:3072 lds
    s_mov_b32 m0, 67712
    s_nop 0
    buffer_load_dwordx4 v40, s[48:51], s47 offen lds
    buffer_load_dwordx4 v41, s[48:51], s47 offen offset:1024 lds
    buffer_load_dwordx4 v42, s[48:51], s47 offen offset:2048 lds
    buffer_load_dwordx4 v43, s[48:51], s47 offen offset:3072 lds
    s_mov_b32 m0, 47232
    s_nop 0
    buffer_load_dwordx4 v28, s[56:59], s77 offen lds
    buffer_load_dwordx4 v29, s[56:59], s77 offen offset:1024 lds
    buffer_load_dwordx4 v30, s[56:59], s77 offen offset:2048 lds
    buffer_load_dwordx4 v31, s[56:59], s77 offen offset:3072 lds
    s_mov_b32 m0, 71808
    s_nop 0
    buffer_load_dwordx4 v44, s[48:51], s47 offen lds
    buffer_load_dwordx4 v45, s[48:51], s47 offen offset:1024 lds
    buffer_load_dwordx4 v46, s[48:51], s47 offen offset:2048 lds
    buffer_load_dwordx4 v47, s[48:51], s47 offen offset:3072 lds
    s_mov_b32 m0, 43136
    s_nop 0
    buffer_load_dwordx4 v32, s[52:55], s77 offen lds
    buffer_load_dwordx4 v33, s[52:55], s77 offen offset:1024 lds
    buffer_load_dwordx4 v34, s[52:55], s77 offen offset:2048 lds
    buffer_load_dwordx4 v35, s[52:55], s77 offen offset:3072 lds
    s_mov_b32 m0, 75904
    s_nop 0
    buffer_load_dwordx4 v48, s[48:51], s47 offen lds
    buffer_load_dwordx4 v49, s[48:51], s47 offen offset:1024 lds
    s_mov_b32 m0, 51328
    s_nop 0
    buffer_load_dwordx4 v32, s[56:59], s77 offen lds
    buffer_load_dwordx4 v33, s[56:59], s77 offen offset:1024 lds
    buffer_load_dwordx4 v34, s[56:59], s77 offen offset:2048 lds
    buffer_load_dwordx4 v35, s[56:59], s77 offen offset:3072 lds
    s_add_u32 s78, s78, 1
    s_cmp_eq_u32 s78, 10
    s_cselect_b32 s78, 0, s78
    s_waitcnt vmcnt(30) lgkmcnt(0)
    s_barrier
    s_mov_b32 m0, 94464
    s_nop 0
    buffer_load_dwordx4 v28, s[60:63], s74 offen lds
    buffer_load_dwordx4 v29, s[60:63], s74 offen offset:1024 lds
    buffer_load_dwordx4 v30, s[60:63], s74 offen offset:2048 lds
    buffer_load_dwordx4 v31, s[60:63], s74 offen offset:3072 lds
    s_mov_b32 m0, 98560
    s_nop 0
    buffer_load_dwordx4 v32, s[60:63], s74 offen lds
    buffer_load_dwordx4 v33, s[60:63], s74 offen offset:1024 lds
    buffer_load_dwordx4 v34, s[60:63], s74 offen offset:2048 lds
    buffer_load_dwordx4 v35, s[60:63], s74 offen offset:3072 lds
    s_mov_b32 m0, 133504
    s_nop 0
    buffer_load_dwordx4 v28, s[60:63], s75 offen lds
    buffer_load_dwordx4 v29, s[60:63], s75 offen offset:1024 lds
    buffer_load_dwordx4 v30, s[60:63], s75 offen offset:2048 lds
    buffer_load_dwordx4 v31, s[60:63], s75 offen offset:3072 lds
    s_mov_b32 m0, 137600
    s_nop 0
    buffer_load_dwordx4 v32, s[60:63], s75 offen lds
    buffer_load_dwordx4 v33, s[60:63], s75 offen offset:1024 lds
    buffer_load_dwordx4 v34, s[60:63], s75 offen offset:2048 lds
    buffer_load_dwordx4 v35, s[60:63], s75 offen offset:3072 lds
    s_mov_b32 m0, 16384
    s_nop 0
    buffer_load_dwordx4 v28, s[60:63], s76 offen lds
    buffer_load_dwordx4 v29, s[60:63], s76 offen offset:1024 lds
    buffer_load_dwordx4 v30, s[60:63], s76 offen offset:2048 lds
    buffer_load_dwordx4 v31, s[60:63], s76 offen offset:3072 lds
    s_mov_b32 m0, 20480
    s_nop 0
    buffer_load_dwordx4 v32, s[60:63], s76 offen lds
    buffer_load_dwordx4 v33, s[60:63], s76 offen offset:1024 lds
    buffer_load_dwordx4 v34, s[60:63], s76 offen offset:2048 lds
    buffer_load_dwordx4 v35, s[60:63], s76 offen offset:3072 lds
    s_mov_b32 m0, 55424
    s_nop 0
    buffer_load_dwordx4 v28, s[60:63], s77 offen lds
    buffer_load_dwordx4 v29, s[60:63], s77 offen offset:1024 lds
    buffer_load_dwordx4 v30, s[60:63], s77 offen offset:2048 lds
    buffer_load_dwordx4 v31, s[60:63], s77 offen offset:3072 lds
    s_mov_b32 m0, 59520
    s_nop 0
    buffer_load_dwordx4 v32, s[60:63], s77 offen lds
    buffer_load_dwordx4 v33, s[60:63], s77 offen offset:1024 lds
    buffer_load_dwordx4 v34, s[60:63], s77 offen offset:2048 lds
    buffer_load_dwordx4 v35, s[60:63], s77 offen offset:3072 lds
    v_lshrrev_b32 v8, 5, v1
    v_mul_u32_u24 v8, 20480, v8
    v_and_b32 v7, 3, v5
    v_mul_u32_u24 v7, 1280, v7
    v_add_u32 v7, 61440, v7
    v_add_u32 v55, v7, v50
    v_xor_b32 v62, 64, v55
    v_add_u32 v56, v55, v8
    v_sub_u32 v54, v55, v8
    v_add_u32 v57, v56, v8
    v_sub_u32 v53, v54, v8
    v_add_u32 v58, v57, v8
    v_sub_u32 v52, v53, v8
    v_add_u32 v63, v62, v8
    v_sub_u32 v61, v62, v8
    v_add_u32 v64, v63, v8
    v_sub_u32 v60, v61, v8
    v_add_u32 v65, v64, v8
    v_sub_u32 v59, v60, v8
    s_waitcnt vmcnt(32) lgkmcnt(0)
    s_barrier
    s_mov_b32 m0, 0
    s_mov_b32 s4, 45056
    buffer_load_dwordx4 v53, s[64:67], s4 offen lds
    s_mov_b32 s4, 28672
    buffer_load_dwordx4 v63, s[64:67], s4 offen offset:1024 lds
    s_mov_b32 s4, 32768
    buffer_load_dwordx4 v54, s[64:67], s4 offen offset:2048 lds
    s_mov_b32 s4, 36864
    buffer_load_dwordx4 v61, s[64:67], s4 offen offset:3072 lds
    s_mov_b32 m0, 4096
    s_mov_b32 s4, 24576
    buffer_load_dwordx4 v57, s[64:67], s4 offen lds
    s_mov_b32 s4, 8192
    buffer_load_dwordx4 v65, s[64:67], s4 offen offset:1024 lds
    s_mov_b32 s4, 53248
    buffer_load_dwordx4 v56, s[64:67], s4 offen offset:2048 lds
    s_mov_b32 s4, 77824
    buffer_load_dwordx4 v61, s[64:67], s4 offen offset:3072 lds
    s_mov_b32 m0, 8192
    s_mov_b32 s4, 106496
    buffer_load_dwordx4 v56, s[64:67], s4 offen lds
    s_mov_b32 s4, 110592
    buffer_load_dwordx4 v61, s[64:67], s4 offen offset:1024 lds
    s_mov_b32 s4, 114688
    buffer_load_dwordx4 v54, s[64:67], s4 offen offset:2048 lds
    s_mov_b32 s4, 118784
    buffer_load_dwordx4 v61, s[64:67], s4 offen offset:3072 lds
    s_mov_b32 m0, 12288
    s_mov_b32 s4, 86016
    buffer_load_dwordx4 v58, s[64:67], s4 offen lds
    s_mov_b32 s4, 131072
    buffer_load_dwordx4 v63, s[64:67], s4 offen offset:1024 lds
    s_mov_b32 s4, 155648
    buffer_load_dwordx4 v54, s[64:67], s4 offen offset:2048 lds
    s_mov_b32 s4, 159744
    buffer_load_dwordx4 v61, s[64:67], s4 offen offset:3072 lds
    s_waitcnt vmcnt(16)
    v_mov_b32 v5, 157980
    v_mov_b32 v6, 1
    s_mov_b64 exec, 1
    ds_add_u32 v5, v6
    s_mov_b64 exec, -1
    v_mov_b32 v5, 157972
    v_mov_b32 v6, 1
    s_mov_b64 exec, 1
    ds_add_u32 v5, v6
    s_mov_b64 exec, -1
    s_mov_b32 m0, 24576
    s_mov_b32 s4, 188416
    buffer_load_dwordx4 v54, s[64:67], s4 offen lds
    s_mov_b32 s4, 192512
    buffer_load_dwordx4 v61, s[64:67], s4 offen offset:1024 lds
    s_mov_b32 s4, 196608
    buffer_load_dwordx4 v54, s[64:67], s4 offen offset:2048 lds
    s_mov_b32 s4, 180224
    buffer_load_dwordx4 v63, s[64:67], s4 offen offset:3072 lds
    s_mov_b32 m0, 28672
    s_mov_b32 s4, 208896
    buffer_load_dwordx4 v56, s[64:67], s4 offen lds
    s_mov_b32 s4, 233472
    buffer_load_dwordx4 v61, s[64:67], s4 offen offset:1024 lds
    s_mov_b32 s4, 237568
    buffer_load_dwordx4 v54, s[64:67], s4 offen offset:2048 lds
    s_mov_b32 s4, 241664
    buffer_load_dwordx4 v61, s[64:67], s4 offen offset:3072 lds
    s_mov_b32 m0, 123136
    s_mov_b32 s4, 270336
    buffer_load_dwordx4 v54, s[64:67], s4 offen lds
    s_mov_b32 s4, 274432
    buffer_load_dwordx4 v61, s[64:67], s4 offen offset:1024 lds
    s_mov_b32 s4, 258048
    buffer_load_dwordx4 v56, s[64:67], s4 offen offset:2048 lds
    s_mov_b32 s4, 262144
    buffer_load_dwordx4 v65, s[64:67], s4 offen offset:3072 lds
    s_mov_b32 m0, 127232
    s_mov_b32 s4, 311296
    buffer_load_dwordx4 v54, s[64:67], s4 offen lds
    s_mov_b32 s4, 315392
    buffer_load_dwordx4 v61, s[64:67], s4 offen offset:1024 lds
    s_mov_b32 s4, 319488
    buffer_load_dwordx4 v54, s[64:67], s4 offen offset:2048 lds
    s_mov_b32 s4, 282624
    buffer_load_dwordx4 v63, s[64:67], s4 offen offset:3072 lds
    s_mov_b32 m0, 80000
    s_mov_b32 s4, 352256
    buffer_load_dwordx4 v54, s[64:67], s4 offen lds
    s_mov_b32 s4, 335872
    buffer_load_dwordx4 v63, s[64:67], s4 offen offset:1024 lds
    s_mov_b32 s4, 339968
    buffer_load_dwordx4 v58, s[64:67], s4 offen offset:2048 lds
    s_mov_b32 s4, 344064
    buffer_load_dwordx4 v64, s[64:67], s4 offen offset:3072 lds
    s_mov_b32 m0, 84096
    s_mov_b32 s4, 393216
    buffer_load_dwordx4 v54, s[64:67], s4 offen lds
    s_mov_b32 s4, 397312
    buffer_load_dwordx4 v61, s[64:67], s4 offen offset:1024 lds
    s_mov_b32 s4, 360448
    buffer_load_dwordx4 v56, s[64:67], s4 offen offset:2048 lds
    s_mov_b32 s4, 405504
    buffer_load_dwordx4 v60, s[64:67], s4 offen offset:3072 lds
Lcw_5:
    s_sub_u32 s39, s39, 1
    s_cbranch_scc1 Lend
    ds_read_b32 v6, v5
    s_waitcnt lgkmcnt(0)
    v_readfirstlane_b32 s42, v6
    s_nop 0
    s_cmp_lt_u32 s42, 8
    s_cbranch_scc1 Lcw_5
    s_lshl_b32 s40, s2, 7
    s_add_u32 s40, s40, 8257536
    v_mov_b32 v51, s40
    buffer_load_dwordx4 v[66:69], v51, s[28:31], 0 offen sc1
    s_mov_b32 m0, 32768
    s_mov_b32 s4, 454656
    buffer_load_dwordx4 v53, s[64:67], s4 offen lds
    s_mov_b32 s4, 438272
    buffer_load_dwordx4 v63, s[64:67], s4 offen offset:1024 lds
    s_mov_b32 s4, 442368
    buffer_load_dwordx4 v54, s[64:67], s4 offen offset:2048 lds
    s_mov_b32 s4, 446464
    buffer_load_dwordx4 v61, s[64:67], s4 offen offset:3072 lds
    s_mov_b32 m0, 36864
    s_mov_b32 s4, 434176
    buffer_load_dwordx4 v57, s[64:67], s4 offen lds
    s_mov_b32 s4, 417792
    buffer_load_dwordx4 v65, s[64:67], s4 offen offset:1024 lds
    s_mov_b32 s4, 462848
    buffer_load_dwordx4 v56, s[64:67], s4 offen offset:2048 lds
    s_mov_b32 s4, 487424
    buffer_load_dwordx4 v61, s[64:67], s4 offen offset:3072 lds
    s_mov_b32 m0, 40960
    s_mov_b32 s4, 516096
    buffer_load_dwordx4 v56, s[64:67], s4 offen lds
    s_mov_b32 s4, 520192
    buffer_load_dwordx4 v61, s[64:67], s4 offen offset:1024 lds
    s_mov_b32 s4, 524288
    buffer_load_dwordx4 v54, s[64:67], s4 offen offset:2048 lds
    s_mov_b32 s4, 528384
    buffer_load_dwordx4 v61, s[64:67], s4 offen offset:3072 lds
    s_mov_b32 m0, 45056
    s_mov_b32 s4, 495616
    buffer_load_dwordx4 v58, s[64:67], s4 offen lds
    s_mov_b32 s4, 540672
    buffer_load_dwordx4 v63, s[64:67], s4 offen offset:1024 lds
    s_mov_b32 s4, 565248
    buffer_load_dwordx4 v54, s[64:67], s4 offen offset:2048 lds
    s_mov_b32 s4, 569344
    buffer_load_dwordx4 v61, s[64:67], s4 offen offset:3072 lds
    s_mov_b32 m0, 63616
    s_mov_b32 s4, 598016
    buffer_load_dwordx4 v54, s[64:67], s4 offen lds
    s_mov_b32 s4, 602112
    buffer_load_dwordx4 v61, s[64:67], s4 offen offset:1024 lds
    s_mov_b32 s4, 606208
    buffer_load_dwordx4 v54, s[64:67], s4 offen offset:2048 lds
    s_mov_b32 s4, 589824
    buffer_load_dwordx4 v63, s[64:67], s4 offen offset:3072 lds
    s_mov_b32 m0, 67712
    s_mov_b32 s4, 618496
    buffer_load_dwordx4 v56, s[64:67], s4 offen lds
    s_mov_b32 s4, 643072
    buffer_load_dwordx4 v61, s[64:67], s4 offen offset:1024 lds
    s_mov_b32 s4, 647168
    s_waitcnt vmcnt(55)
    buffer_load_dwordx4 v54, s[64:67], s4 offen offset:2048 lds
    s_mov_b32 s4, 651264
    buffer_load_dwordx4 v61, s[64:67], s4 offen offset:3072 lds
    s_mov_b32 m0, 71808
    s_mov_b32 s4, 679936
    buffer_load_dwordx4 v54, s[64:67], s4 offen lds
    s_mov_b32 s4, 684032
    buffer_load_dwordx4 v61, s[64:67], s4 offen offset:1024 lds
    s_mov_b32 s4, 667648
    buffer_load_dwordx4 v56, s[64:67], s4 offen offset:2048 lds
    s_mov_b32 s4, 671744
    buffer_load_dwordx4 v65, s[64:67], s4 offen offset:3072 lds
    s_mov_b32 m0, 75904
    s_mov_b32 s4, 720896
    buffer_load_dwordx4 v54, s[64:67], s4 offen lds
    s_mov_b32 s4, 724992
    buffer_load_dwordx4 v61, s[64:67], s4 offen offset:1024 lds
    s_mov_b32 s4, 729088
    s_waitcnt vmcnt(55)
    buffer_load_dwordx4 v54, s[64:67], s4 offen offset:2048 lds
    s_mov_b32 s4, 692224
    buffer_load_dwordx4 v63, s[64:67], s4 offen offset:3072 lds
    s_mov_b32 m0, 49152
    s_mov_b32 s4, 761856
    buffer_load_dwordx4 v54, s[64:67], s4 offen lds
    s_mov_b32 s4, 745472
    buffer_load_dwordx4 v63, s[64:67], s4 offen offset:1024 lds
    s_mov_b32 s4, 749568
    buffer_load_dwordx4 v58, s[64:67], s4 offen offset:2048 lds
    s_mov_b32 s4, 753664
    buffer_load_dwordx4 v64, s[64:67], s4 offen offset:3072 lds
    s_mov_b32 m0, 88192
    s_mov_b32 s4, 802816
    buffer_load_dwordx4 v54, s[64:67], s4 offen lds
    s_mov_b32 s4, 806912
    buffer_load_dwordx4 v61, s[64:67], s4 offen offset:1024 lds
    s_mov_b32 s4, 770048
    s_waitcnt vmcnt(55)
    buffer_load_dwordx4 v56, s[64:67], s4 offen offset:2048 lds
    s_mov_b32 s4, 815104
    buffer_load_dwordx4 v60, s[64:67], s4 offen offset:3072 lds
    s_waitcnt vmcnt(0)
Lbc:
    v_readfirstlane_b32 s5, v66
    v_readfirstlane_b32 s40, v67
    v_readfirstlane_b32 s6, v68
    v_readfirstlane_b32 s41, v69
    s_cmp_eq_u32 s40, s38
    s_cselect_b32 s41, s41, s40
    s_cmp_eq_u32 s41, s38
    s_cbranch_scc1 Lbc_ok
    s_sub_u32 s39, s39, 1
    s_cbranch_scc1 Lend
    buffer_load_dwordx4 v[66:69], v51, s[28:31], 0 offen sc1
    s_waitcnt vmcnt(0)
    s_branch Lbc
Lbc_ok:
    s_mul_i32 s40, s36, 96
    s_and_b32 s7, s5, 0x7ff
    s_sub_u32 s7, 2047, s7
    s_sub_u32 s41, s7, s40
    s_cmp_lt_u32 s41, 96
    s_cselect_b32 s7, s7, -1
    s_and_b32 s8, s6, 0x7ff
    s_sub_u32 s8, 2047, s8
    s_sub_u32 s41, s8, s40
    s_cmp_lt_u32 s41, 96
    s_cselect_b32 s8, s8, -1
    v_mov_b32 v4, s7
    v_mov_b32 v5, s8
    v_mov_b32 v6, 157960
    ds_write_b64 v6, v[4:5]
    s_and_b32 s41, s7, s8
    s_cmp_eq_u32 s41, -1
    s_cbranch_scc1 Lw0_done
    v_min_u32 v7, 26, v1
    v_mul_u32_u24 v7, 10240, v7
Ly_poll:
    s_sub_u32 s39, s39, 1
    s_cbranch_scc1 Lend
    s_lshl_b32 s40, s37, 10
    s_add_u32 s40, s40, 7405568
    buffer_load_dword v4, v7, s[28:31], s40 offen offset:1020 sc1
    s_waitcnt vmcnt(0)
    v_cmp_ne_u32 vcc, s38, v4
    s_nop 0
    s_cbranch_vccnz Ly_poll
    buffer_load_dwordx4 v[16:19], v13, s[28:31], s40 offen sc1
    s_add_u32 s40, s40, 10240
    buffer_load_dwordx4 v[20:23], v13, s[28:31], s40 offen sc1
    s_add_u32 s40, s40, 10240
    buffer_load_dwordx4 v[24:27], v13, s[28:31], s40 offen sc1
    s_add_u32 s40, s40, 10240
    buffer_load_dwordx4 v[28:31], v13, s[28:31], s40 offen sc1
    s_add_u32 s40, s40, 10240
    buffer_load_dwordx4 v[32:35], v13, s[28:31], s40 offen sc1
    s_add_u32 s40, s40, 10240
    buffer_load_dwordx4 v[36:39], v13, s[28:31], s40 offen sc1
    s_add_u32 s40, s40, 10240
    buffer_load_dwordx4 v[40:43], v13, s[28:31], s40 offen sc1
    s_add_u32 s40, s40, 10240
    buffer_load_dwordx4 v[44:47], v13, s[28:31], s40 offen sc1
    s_add_u32 s40, s40, 10240
    buffer_load_dwordx4 v[48:51], v13, s[28:31], s40 offen sc1
    s_add_u32 s40, s40, 10240
    buffer_load_dwordx4 v[52:55], v13, s[28:31], s40 offen sc1
    s_add_u32 s40, s40, 10240
    buffer_load_dwordx4 v[56:59], v13, s[28:31], s40 offen sc1
    s_add_u32 s40, s40, 10240
    buffer_load_dwordx4 v[60:63], v13, s[28:31], s40 offen sc1
    s_add_u32 s40, s40, 10240
    buffer_load_dwordx4 v[64:67], v13, s[28:31], s40 offen sc1
    s_add_u32 s40, s40, 10240
    buffer_load_dwordx4 v[68:71], v13, s[28:31], s40 offen sc1
    s_add_u32 s40, s40, 10240
    buffer_load_dwordx4 v[72:75], v13, s[28:31], s40 offen sc1
    s_add_u32 s40, s40, 10240
    buffer_load_dwordx4 v[76:79], v13, s[28:31], s40 offen sc1
    s_add_u32 s40, s40, 10240
    buffer_load_dwordx4 v[80:83], v13, s[28:31], s40 offen sc1
    s_add_u32 s40, s40, 10240
    buffer_load_dwordx4 v[84:87], v13, s[28:31], s40 offen sc1
    s_add_u32 s40, s40, 10240
    buffer_load_dwordx4 v[88:91], v13, s[28:31], s40 offen sc1
    s_add_u32 s40, s40, 10240
    buffer_load_dwordx4 v[92:95], v13, s[28:31], s40 offen sc1
    s_add_u32 s40, s40, 10240
    buffer_load_dwordx4 v[96:99], v13, s[28:31], s40 offen sc1
    s_add_u32 s40, s40, 10240
    buffer_load_dwordx4 v[100:103], v13, s[28:31], s40 offen sc1
    s_add_u32 s40, s40, 10240
    buffer_load_dwordx4 v[104:107], v13, s[28:31], s40 offen sc1
    s_add_u32 s40, s40, 10240
    buffer_load_dwordx4 v[108:111], v13, s[28:31], s40 offen sc1
    s_add_u32 s40, s40, 10240
    buffer_load_dwordx4 v[112:115], v13, s[28:31], s40 offen sc1
    s_add_u32 s40, s40, 10240
    buffer_load_dwordx4 v[116:119], v13, s[28:31], s40 offen sc1
    s_add_u32 s40, s40, 10240
    buffer_load_dwordx4 v[120:123], v13, s[28:31], s40 offen sc1
    s_add_u32 s40, s40, 10240
    s_waitcnt vmcnt(0)
    v_xor_b32 v4, s38, v17
    v_xor_b32 v5, s38, v19
    v_or_b32 v4, v4, v5
    v_xor_b32 v5, s38, v21
    v_or_b32 v4, v4, v5
    v_xor_b32 v5, s38, v23
    v_or_b32 v4, v4, v5
    v_xor_b32 v5, s38, v25
    v_or_b32 v4, v4, v5
    v_xor_b32 v5, s38, v27
    v_or_b32 v4, v4, v5
    v_xor_b32 v5, s38, v29
    v_or_b32 v4, v4, v5
    v_xor_b32 v5, s38, v31
    v_or_b32 v4, v4, v5
    v_xor_b32 v5, s38, v33
    v_or_b32 v4, v4, v5
    v_xor_b32 v5, s38, v35
    v_or_b32 v4, v4, v5
    v_xor_b32 v5, s38, v37
    v_or_b32 v4, v4, v5
    v_xor_b32 v5, s38, v39
    v_or_b32 v4, v4, v5
    v_xor_b32 v5, s38, v41
    v_or_b32 v4, v4, v5
    v_xor_b32 v5, s38, v43
    v_or_b32 v4, v4, v5
    v_xor_b32 v5, s38, v45
    v_or_b32 v4, v4, v5
    v_xor_b32 v5, s38, v47
    v_or_b32 v4, v4, v5
    v_xor_b32 v5, s38, v49
    v_or_b32 v4, v4, v5
    v_xor_b32 v5, s38, v51
    v_or_b32 v4, v4, v5
    v_xor_b32 v5, s38, v53
    v_or_b32 v4, v4, v5
    v_xor_b32 v5, s38, v55
    v_or_b32 v4, v4, v5
    v_xor_b32 v5, s38, v57
    v_or_b32 v4, v4, v5
    v_xor_b32 v5, s38, v59
    v_or_b32 v4, v4, v5
    v_xor_b32 v5, s38, v61
    v_or_b32 v4, v4, v5
    v_xor_b32 v5, s38, v63
    v_or_b32 v4, v4, v5
    v_xor_b32 v5, s38, v65
    v_or_b32 v4, v4, v5
    v_xor_b32 v5, s38, v67
    v_or_b32 v4, v4, v5
    v_xor_b32 v5, s38, v69
    v_or_b32 v4, v4, v5
    v_xor_b32 v5, s38, v71
    v_or_b32 v4, v4, v5
    v_xor_b32 v5, s38, v73
    v_or_b32 v4, v4, v5
    v_xor_b32 v5, s38, v75
    v_or_b32 v4, v4, v5
    v_xor_b32 v5, s38, v77
    v_or_b32 v4, v4, v5
    v_xor_b32 v5, s38, v79
    v_or_b32 v4, v4, v5
    v_xor_b32 v5, s38, v81
    v_or_b32 v4, v4, v5
    v_xor_b32 v5, s38, v83
    v_or_b32 v4, v4, v5
    v_xor_b32 v5, s38, v85
    v_or_b32 v4, v4, v5
    v_xor_b32 v5, s38, v87
    v_or_b32 v4, v4, v5
    v_xor_b32 v5, s38, v89
    v_or_b32 v4, v4, v5
    v_xor_b32 v5, s38, v91
    v_or_b32 v4, v4, v5
    v_xor_b32 v5, s38, v93
    v_or_b32 v4, v4, v5
    v_xor_b32 v5, s38, v95
    v_or_b32 v4, v4, v5
    v_xor_b32 v5, s38, v97
    v_or_b32 v4, v4, v5
    v_xor_b32 v5, s38, v99
    v_or_b32 v4, v4, v5
    v_xor_b32 v5, s38, v101
    v_or_b32 v4, v4, v5
    v_xor_b32 v5, s38, v103
    v_or_b32 v4, v4, v5
    v_xor_b32 v5, s38, v105
    v_or_b32 v4, v4, v5
    v_xor_b32 v5, s38, v107
    v_or_b32 v4, v4, v5
    v_xor_b32 v5, s38, v109
    v_or_b32 v4, v4, v5
    v_xor_b32 v5, s38, v111
    v_or_b32 v4, v4, v5
    v_xor_b32 v5, s38, v113
    v_or_b32 v4, v4, v5
    v_xor_b32 v5, s38, v115
    v_or_b32 v4, v4, v5
    v_xor_b32 v5, s38, v117
    v_or_b32 v4, v4, v5
    v_xor_b32 v5, s38, v119
    v_or_b32 v4, v4, v5
    v_xor_b32 v5, s38, v121
    v_or_b32 v4, v4, v5
    v_xor_b32 v5, s38, v123
    v_or_b32 v4, v4, v5
    v_cmp_ne_u32 vcc, 0, v4
    s_nop 0
    s_cmp_lg_u64 vcc, 0
    s_cbranch_scc1 Ly_poll
    v_add_f32 v16, v16, v20
    v_add_f32 v18, v18, v22
    v_add_f32 v16, v16, v24
    v_add_f32 v18, v18, v26
    v_add_f32 v16, v16, v28
    v_add_f32 v18, v18, v30
    v_add_f32 v16, v16, v32
    v_add_f32 v18, v18, v34
    v_add_f32 v16, v16, v36
    v_add_f32 v18, v18, v38
    v_add_f32 v16, v16, v40
    v_add_f32 v18, v18, v42
    v_add_f32 v16, v16, v44
    v_add_f32 v18, v18, v46
    v_add_f32 v16, v16, v48
    v_add_f32 v18, v18, v50
    v_add_f32 v16, v16, v52
    v_add_f32 v18, v18, v54
    v_add_f32 v16, v16, v56
    v_add_f32 v18, v18, v58
    v_add_f32 v16, v16, v60
    v_add_f32 v18, v18, v62
    v_add_f32 v16, v16, v64
    v_add_f32 v18, v18, v66
    v_add_f32 v16, v16, v68
    v_add_f32 v18, v18, v70
    v_add_f32 v16, v16, v72
    v_add_f32 v18, v18, v74
    v_add_f32 v16, v16, v76
    v_add_f32 v18, v18, v78
    v_add_f32 v16, v16, v80
    v_add_f32 v18, v18, v82
    v_add_f32 v16, v16, v84
    v_add_f32 v18, v18, v86
    v_add_f32 v16, v16, v88
    v_add_f32 v18, v18, v90
    v_add_f32 v16, v16, v92
    v_add_f32 v18, v18, v94
    v_add_f32 v16, v16, v96
    v_add_f32 v18, v18, v98
    v_add_f32 v16, v16, v100
    v_add_f32 v18, v18, v102
    v_add_f32 v16, v16, v104
    v_add_f32 v18, v18, v106
    v_add_f32 v16, v16, v108
    v_add_f32 v18, v18, v110
    v_add_f32 v16, v16, v112
    v_add_f32 v18, v18, v114
    v_add_f32 v16, v16, v116
    v_add_f32 v18, v18, v118
    v_add_f32 v16, v16, v120
    v_add_f32 v18, v18, v122
    s_lshr_b32 s40, s5, 16
    s_cmp_ge_u32 s40, 0x8000
    s_cselect_b32 s41, 0x8000, -1
    s_xor_b32 s40, s40, s41
    s_lshl_b32 s40, s40, 16
    v_mov_b32 v4, s40
    v_mul_f32 v4, 0xbfb8aa3b, v4
    v_exp_f32 v4, v4
    s_nop 0
    v_add_f32 v4, 1.0, v4
    v_rcp_f32 v4, v4
    s_nop 0
    v_cvt_pk_bf16_f32 v4, v4, v4
    v_lshlrev_b32 v4, 16, v4
    v_cvt_pk_bf16_f32 v16, v16, v16
    v_lshlrev_b32 v16, 16, v16
    v_mul_f32 v16, v16, v4
    v_cvt_pk_bf16_f32 v16, v16, v16
    v_lshlrev_b32 v16, 16, v16
    v_add_u32 v5, 158208, v12
    ds_write_b32 v5, v16 offset:0
    s_lshr_b32 s40, s6, 16
    s_cmp_ge_u32 s40, 0x8000
    s_cselect_b32 s41, 0x8000, -1
    s_xor_b32 s40, s40, s41
    s_lshl_b32 s40, s40, 16
    v_mov_b32 v4, s40
    v_mul_f32 v4, 0xbfb8aa3b, v4
    v_exp_f32 v4, v4
    s_nop 0
    v_add_f32 v4, 1.0, v4
    v_rcp_f32 v4, v4
    s_nop 0
    v_cvt_pk_bf16_f32 v4, v4, v4
    v_lshlrev_b32 v4, 16, v4
    v_cvt_pk_bf16_f32 v18, v18, v18
    v_lshlrev_b32 v18, 16, v18
    v_mul_f32 v18, v18, v4
    v_cvt_pk_bf16_f32 v18, v18, v18
    v_lshlrev_b32 v18, 16, v18
    v_add_u32 v5, 158208, v12
    ds_write_b32 v5, v18 offset:256
    v_mov_b32 v4, 0
    ds_write_b32 v5, v4 offset:512
    v_mov_b32 v4, 157956
    ds_write_b32 v4, v4
Lw0_done:
    s_waitcnt lgkmcnt(0)
    s_endpgm
Lcomp:
    s_lshl_b32 s47, s26, 1
    s_add_u32 s47, s47, s27
    s_sub_u32 s40, s37, 5
    s_cmp_ge_u32 s37, 5
    s_cselect_b32 s44, s40, s37
    s_mov_b32 s45, 0xbfe10856
    s_cmp_eq_u32 s44, 1
    s_cselect_b32 s45, 0xaff80255, s45
    s_cmp_eq_u32 s44, 2
    s_cselect_b32 s45, 0xabfe4015, s45
    s_cmp_eq_u32 s44, 3
    s_cselect_b32 s45, 0xaa7fd005, s45
    s_cmp_eq_u32 s44, 4
    s_cselect_b32 s45, 0x6adfb401, s45
    s_lshl_b32 s41, s27, 13
    s_cmp_eq_u32 s47, 1
    s_cselect_b32 s41, 0, s41
    v_bfe_u32 v7, v1, 2, 2
    v_and_b32 v8, 3, v1
    v_lshl_add_u32 v18, v2, 3, v7
    v_lshlrev_b32 v18, 7, v18
    v_lshlrev_b32 v19, 2, v1
    v_and_b32 v19, 0x60, v19
    v_lshlrev_b32 v10, 1, v8
    v_add_u32 v9, s41, v18
    v_add_u32 v11, 0, v10
    v_bfe_u32 v11, s45, v11, 2
    v_lshl_add_u32 v11, v11, 2, v8
    v_lshlrev_b32 v11, 3, v11
    v_xad_u32 v20, v11, v19, v9
    v_add_u32 v11, 8, v10
    v_bfe_u32 v11, s45, v11, 2
    v_lshl_add_u32 v11, v11, 2, v8
    v_lshlrev_b32 v11, 3, v11
    v_xad_u32 v21, v11, v19, v9
    v_add_u32 v11, 16, v10
    v_bfe_u32 v11, s45, v11, 2
    v_lshl_add_u32 v11, v11, 2, v8
    v_lshlrev_b32 v11, 3, v11
    v_xad_u32 v22, v11, v19, v9
    v_add_u32 v11, 24, v10
    v_bfe_u32 v11, s45, v11, 2
    v_lshl_add_u32 v11, v11, 2, v8
    v_lshlrev_b32 v11, 3, v11
    v_xad_u32 v23, v11, v19, v9
    v_add_u32 v24, 78080, v20
    v_add_u32 v25, 78080, v21
    v_add_u32 v26, 78080, v22
    v_add_u32 v27, 78080, v23
    v_lshrrev_b32 v10, 1, v3
    v_xor_b32 v9, v10, v2
    v_lshlrev_b32 v9, 4, v9
    v_lshl_add_u32 v9, v3, 7, v9
    s_lshl_b32 s40, s47, 11
    s_xor_b32 s42, s40, 2048
    s_add_u32 s40, s40, 22528
    s_add_u32 s42, s42, 22528
    v_add_u32 v76, s40, v9
    v_add_u32 v78, s42, v9
    s_mul_i32 s43, s26, 6144
    s_add_u32 s43, s43, 98560
    v_add_u32 v125, s43, v13
    s_lshl_b32 s52, s47, 11
    s_add_u32 s52, s52, 139648
    s_waitcnt lgkmcnt(0)
    s_mov_b64 s[28:29], s[24:25]
    s_mov_b32 s30, 268435456
    s_mov_b32 s31, 0x20000
    s_mov_b64 s[32:33], s[22:23]
    s_mov_b32 s34, 256
    s_mov_b32 s35, 0x20000
    s_load_dword s38, s[28:29], 0
    s_cmp_eq_u32 s47, 1
    s_cbranch_scc1 Lhalo
    v_xor_b32 v77, 64, v76
    v_xor_b32 v79, 64, v78
    v_add_u32 v80, 78080, v76
    v_add_u32 v81, 78080, v77
    v_add_u32 v82, 78080, v78
    v_add_u32 v83, 78080, v79
    s_cmp_eq_u32 s27, 0
    s_cselect_b64 vcc, 0, -1
    s_sub_u32 s41, 16384, s41
    v_cndmask_b32 v84, v20, v22, vcc
    v_cndmask_b32 v85, v21, v23, vcc
    v_add_u32 v84, s41, v84
    v_add_u32 v85, s41, v85
    v_add_u32 v86, 78080, v84
    v_add_u32 v87, 78080, v85
    v_lshrrev_b32 v8, 1, v2
    v_xor_b32 v8, v8, v10
    v_lshlrev_b32 v8, 4, v8
    v_lshl_add_u32 v8, v3, 7, v8
    v_and_b32 v7, 1, v2
    v_lshl_add_u32 v124, v7, 3, v8
    s_sub_u32 s46, s37, s46
    s_add_u32 s42, s46, 10
    s_cmp_lt_i32 s46, 0
    s_cselect_b32 s46, s42, s46
    s_and_b32 s42, s46, 3
    s_mul_i32 s42, s42, 39040
    s_add_u32 s42, s42, s40
    v_add_u32 v4, s42, v124
    v_xor_b32 v5, 32, v4
    v_xor_b32 v6, 64, v4
    v_xor_b32 v7, 0x60, v4
    s_mov_b64 s[48:49], s[20:21]
    s_mov_b32 s50, 2621440
    s_mov_b32 s51, 0x20000
    v_mov_b32 v14, 0x3f803f80
    v_mov_b32 v15, 0x3f803f80
    v_mov_b32 v16, 0x3f803f80
    v_mov_b32 v17, 0x3f803f80
    s_mov_b32 s4, 0xaae00455
    s_cmp_eq_u32 s44, 1
    s_cselect_b32 s4, 0xaaf80155, s4
    s_cmp_eq_u32 s44, 2
    s_cselect_b32 s4, 0xaafe4055, s4
    s_cmp_eq_u32 s44, 3
    s_cselect_b32 s4, 0xaabfd055, s4
    s_cmp_eq_u32 s44, 4
    s_cselect_b32 s4, 0xaaeff455, s4
    v_lshlrev_b32 v10, 1, v2
    v_add_u32 v10, 8, v10
    v_bfe_u32 v10, s4, v10, 2
    v_cmp_eq_u32 s[6:7], 0, v10
    v_cmp_eq_u32 s[8:9], 3, v10
    v_cmp_eq_u32 s[10:11], 1, v10
    v_lshlrev_b32 v10, 1, v2
    v_add_u32 v10, 16, v10
    v_bfe_u32 v10, s4, v10, 2
    v_cmp_eq_u32 s[12:13], 0, v10
    v_cmp_eq_u32 s[14:15], 3, v10
    v_cmp_eq_u32 s[16:17], 2, v10
    s_mov_b32 s4, 0xaaaaaaaa
    s_mov_b32 s5, 0xaaaaaaaa
    s_mov_b32 s18, 0xfff0ffff
    s_mov_b32 s19, 0xf000ff00
    s_mov_b32 s20, 0xffc0fffc
    s_mov_b32 s21, 0xc000fc00
    v_mov_b32 v8, 0xffff
    v_not_b32 v9, v8
    v_cndmask_b32 v8, v8, v9, s[4:5]
    v_cndmask_b32 v118, 0, v8, s[18:19]
    v_cndmask_b32 v119, 0, v8, s[20:21]
    v_xor_b32 v116, v118, v8
    v_xor_b32 v117, v119, v8
    s_cmp_eq_u32 s36, 0
    s_cselect_b32 s40, s47, 0
    s_cmp_eq_u32 s40, 2
    s_cselect_b32 s22, 0xff800000, 0
    s_mul_i32 s40, s36, 6
    s_add_u32 s40, s40, s47
    s_sub_u32 s40, s40, 2
    s_lshl_b32 s24, s40, 7
    s_add_u32 s24, s24, 7340032
    s_mul_i32 s53, s40, 20480
    s_add_u32 s53, s53, 4194304
    s_lshl_b32 s40, s37, 11
    s_add_u32 s23, s40, s53
    s_add_u32 s54, s53, 4096
    s_add_u32 s55, s53, 8192
    s_add_u32 s56, s53, 12288
    s_add_u32 s57, s53, 16384
    s_mul_i32 s40, s36, 10
    s_add_u32 s40, s40, s37
    s_mul_i32 s58, s40, 6144
    s_lshl_b32 s40, s47, 10
    s_add_u32 s58, s58, s40
    s_add_u32 s58, s58, 1046528
    s_sub_u32 s59, s58, 6144
    s_add_u32 s60, s58, 6144
    s_cmp_eq_u32 s44, 0
    s_cselect_b32 s61, 0, -1
    s_cmp_eq_u32 s44, 4
    s_cselect_b32 s62, 0, -1
    s_lshl_b32 s40, s37, 2
    v_mov_b32 v97, s40
    s_mov_b32 s25, 0x3ea52b5c
    s_lshl_b32 s40, s47, 6
    s_add_u32 s40, s40, 156160
    v_lshl_add_u32 v94, v3, 2, s40
    v_and_b32 v8, 1, v1
    v_lshl_add_u32 v8, v2, 2, v8
    v_lshl_add_u32 v8, v8, 2, s40
    v_subrev_u32 v9, 64, v8
    v_cndmask_b32 v92, v9, v8, s[18:19]
    v_cndmask_b32 v93, v9, v8, s[20:21]
    v_lshlrev_b32 v95, 4, v2
    s_lshl_b32 s40, s27, 8
    s_add_u32 s40, s40, 157184
    v_add_u32 v95, s40, v95
    v_mov_b32 v96, 157968
    v_mov_b32 v100, -1
    v_mov_b32 v101, -1
    v_mov_b32 v102, -1
    v_mov_b32 v103, -1
    s_waitcnt lgkmcnt(0)
    s_barrier
    ds_read_b128 a[64:67], v76 offset:0
    ds_read_b128 a[68:71], v78 offset:0
    ds_read_b64_tr_b16 a[80:81], v20 offset:0
    ds_read_b64_tr_b16 a[82:83], v20 offset:512
    ds_read_b64_tr_b16 a[84:85], v21 offset:0
    ds_read_b64_tr_b16 a[86:87], v21 offset:512
    ds_read_b64_tr_b16 a[88:89], v22 offset:0
    ds_read_b64_tr_b16 a[90:91], v22 offset:512
    ds_read_b64_tr_b16 a[92:93], v23 offset:0
    ds_read_b64_tr_b16 a[94:95], v23 offset:512
    ds_read_b64_tr_b16 a[96:97], v84 offset:0
    ds_read_b64_tr_b16 a[98:99], v84 offset:512
    ds_read_b64_tr_b16 a[100:101], v85 offset:0
    ds_read_b64_tr_b16 a[102:103], v85 offset:512
    s_add_u32 s38, s38, 0x9e3779b8
    s_or_b32 s38, s38, 1
    s_cmp_lg_u32 s46, 0
    s_cbranch_scc1 Lxe0
    ds_read_b64 v[108:109], v4
    ds_read_b64 v[110:111], v5
    ds_read_b64 v[112:113], v6
    ds_read_b64 v[114:115], v7
Lxe0:
    s_waitcnt lgkmcnt(10)
    v_mfma_f32_16x16x32_bf16 v[28:31], a[80:83], a[64:67], 0
    ds_read_b128 a[72:75], v77 offset:0
    ds_read_b128 a[76:79], v79 offset:0
    v_mfma_f32_16x16x32_bf16 v[44:47], a[80:83], a[68:71], 0
    ds_read_b64_tr_b16 a[104:105], v20 offset:4096
    s_waitcnt lgkmcnt(11)
    v_mfma_f32_16x16x32_bf16 v[32:35], a[84:87], a[64:67], 0
    ds_read_b64_tr_b16 a[106:107], v20 offset:4608
    ds_read_b64_tr_b16 a[108:109], v21 offset:4096
    v_mfma_f32_16x16x32_bf16 v[48:51], a[84:87], a[68:71], 0
    ds_read_b64_tr_b16 a[110:111], v21 offset:4608
    s_waitcnt lgkmcnt(12)
    v_mfma_f32_16x16x32_bf16 v[36:39], a[88:91], a[64:67], 0
    ds_read_b64_tr_b16 a[112:113], v22 offset:4096
    v_mfma_f32_16x16x32_bf16 v[52:55], a[88:91], a[68:71], 0
    ds_read_b64_tr_b16 a[114:115], v22 offset:4608
    ds_read_b64_tr_b16 a[116:117], v23 offset:4096
    s_waitcnt lgkmcnt(13)
    v_mfma_f32_16x16x32_bf16 v[40:43], a[92:95], a[64:67], 0
    ds_read_b64_tr_b16 a[118:119], v23 offset:4608
    v_mfma_f32_16x16x32_bf16 v[56:59], a[92:95], a[68:71], 0
    ds_read_b64_tr_b16 a[120:121], v84 offset:4096
    ds_read_b64_tr_b16 a[122:123], v84 offset:4608
    s_waitcnt lgkmcnt(14)
    v_mfma_f32_16x16x32_bf16 v[60:63], a[64:67], a[96:99], 0
    ds_read_b64_tr_b16 a[124:125], v85 offset:4096
    v_mfma_f32_16x16x32_bf16 v[68:71], a[68:71], a[96:99], 0
    ds_read_b64_tr_b16 a[126:127], v85 offset:4608
    s_waitcnt lgkmcnt(14)
    v_mfma_f32_16x16x32_bf16 v[64:67], a[64:67], a[100:103], 0
    v_mfma_f32_16x16x32_bf16 v[72:75], a[68:71], a[100:103], 0
    s_barrier
    s_waitcnt lgkmcnt(10)
    v_mfma_f32_16x16x32_bf16 v[28:31], a[104:107], a[72:75], v[28:31]
    ds_read_b128 a[64:67], v76 offset:39040
    ds_read_b128 a[68:71], v78 offset:39040
    v_mfma_f32_16x16x32_bf16 v[44:47], a[104:107], a[76:79], v[44:47]
    ds_read_b64_tr_b16 a[80:81], v20 offset:39040
    s_waitcnt lgkmcnt(11)
    v_mfma_f32_16x16x32_bf16 v[32:35], a[108:111], a[72:75], v[32:35]
    ds_read_b64_tr_b16 a[82:83], v20 offset:39552
    ds_read_b64_tr_b16 a[84:85], v21 offset:39040
    v_mfma_f32_16x16x32_bf16 v[48:51], a[108:111], a[76:79], v[48:51]
    ds_read_b64_tr_b16 a[86:87], v21 offset:39552
    s_waitcnt lgkmcnt(12)
    v_mfma_f32_16x16x32_bf16 v[36:39], a[112:115], a[72:75], v[36:39]
    ds_read_b64_tr_b16 a[88:89], v22 offset:39040
    v_mfma_f32_16x16x32_bf16 v[52:55], a[112:115], a[76:79], v[52:55]
    ds_read_b64_tr_b16 a[90:91], v22 offset:39552
    ds_read_b64_tr_b16 a[92:93], v23 offset:39040
    s_waitcnt lgkmcnt(13)
    v_mfma_f32_16x16x32_bf16 v[40:43], a[116:119], a[72:75], v[40:43]
    ds_read_b64_tr_b16 a[94:95], v23 offset:39552
    v_mfma_f32_16x16x32_bf16 v[56:59], a[116:119], a[76:79], v[56:59]
    ds_read_b64_tr_b16 a[96:97], v84 offset:39040
    ds_read_b64_tr_b16 a[98:99], v84 offset:39552
    s_waitcnt lgkmcnt(14)
    v_mfma_f32_16x16x32_bf16 v[60:63], a[72:75], a[120:123], v[60:63]
    ds_read_b64_tr_b16 a[100:101], v85 offset:39040
    v_mfma_f32_16x16x32_bf16 v[68:71], a[76:79], a[120:123], v[68:71]
    ds_read_b64_tr_b16 a[102:103], v85 offset:39552
    s_waitcnt lgkmcnt(14)
    v_mfma_f32_16x16x32_bf16 v[64:67], a[72:75], a[124:127], v[64:67]
    v_mfma_f32_16x16x32_bf16 v[72:75], a[76:79], a[124:127], v[72:75]
    s_cmp_lg_u32 s46, 1
    s_cbranch_scc1 Lxe1
    ds_read_b64 v[108:109], v4
    ds_read_b64 v[110:111], v5
    ds_read_b64 v[112:113], v6
    ds_read_b64 v[114:115], v7
Lxe1:
    s_waitcnt lgkmcnt(10)
    v_mfma_f32_16x16x32_bf16 v[28:31], a[80:83], a[64:67], v[28:31]
    ds_read_b128 a[72:75], v77 offset:39040
    ds_read_b128 a[76:79], v79 offset:39040
    v_mfma_f32_16x16x32_bf16 v[44:47], a[80:83], a[68:71], v[44:47]
    ds_read_b64_tr_b16 a[104:105], v20 offset:43136
    s_waitcnt lgkmcnt(11)
    v_mfma_f32_16x16x32_bf16 v[32:35], a[84:87], a[64:67], v[32:35]
    ds_read_b64_tr_b16 a[106:107], v20 offset:43648
    ds_read_b64_tr_b16 a[108:109], v21 offset:43136
    v_mfma_f32_16x16x32_bf16 v[48:51], a[84:87], a[68:71], v[48:51]
    ds_read_b64_tr_b16 a[110:111], v21 offset:43648
    s_waitcnt lgkmcnt(12)
    v_mfma_f32_16x16x32_bf16 v[36:39], a[88:91], a[64:67], v[36:39]
    ds_read_b64_tr_b16 a[112:113], v22 offset:43136
    v_mfma_f32_16x16x32_bf16 v[52:55], a[88:91], a[68:71], v[52:55]
    ds_read_b64_tr_b16 a[114:115], v22 offset:43648
    ds_read_b64_tr_b16 a[116:117], v23 offset:43136
    s_waitcnt lgkmcnt(13)
    v_mfma_f32_16x16x32_bf16 v[40:43], a[92:95], a[64:67], v[40:43]
    ds_read_b64_tr_b16 a[118:119], v23 offset:43648
    v_mfma_f32_16x16x32_bf16 v[56:59], a[92:95], a[68:71], v[56:59]
    ds_read_b64_tr_b16 a[120:121], v84 offset:43136
    ds_read_b64_tr_b16 a[122:123], v84 offset:43648
    s_waitcnt lgkmcnt(14)
    v_mfma_f32_16x16x32_bf16 v[60:63], a[64:67], a[96:99], v[60:63]
    ds_read_b64_tr_b16 a[124:125], v85 offset:43136
    v_mfma_f32_16x16x32_bf16 v[68:71], a[68:71], a[96:99], v[68:71]
    ds_read_b64_tr_b16 a[126:127], v85 offset:43648
    s_waitcnt lgkmcnt(14)
    v_mfma_f32_16x16x32_bf16 v[64:67], a[64:67], a[100:103], v[64:67]
    v_mfma_f32_16x16x32_bf16 v[72:75], a[68:71], a[100:103], v[72:75]
    s_barrier
    s_waitcnt lgkmcnt(10)
    v_mfma_f32_16x16x32_bf16 v[28:31], a[104:107], a[72:75], v[28:31]
    ds_read_b128 a[64:67], v80 offset:0
    ds_read_b128 a[68:71], v82 offset:0
    v_mfma_f32_16x16x32_bf16 v[44:47], a[104:107], a[76:79], v[44:47]
    ds_read_b64_tr_b16 a[80:81], v24 offset:0
    s_waitcnt lgkmcnt(11)
    v_mfma_f32_16x16x32_bf16 v[32:35], a[108:111], a[72:75], v[32:35]
    ds_read_b64_tr_b16 a[82:83], v24 offset:512
    ds_read_b64_tr_b16 a[84:85], v25 offset:0
    v_mfma_f32_16x16x32_bf16 v[48:51], a[108:111], a[76:79], v[48:51]
    ds_read_b64_tr_b16 a[86:87], v25 offset:512
    s_waitcnt lgkmcnt(12)
    v_mfma_f32_16x16x32_bf16 v[36:39], a[112:115], a[72:75], v[36:39]
    ds_read_b64_tr_b16 a[88:89], v26 offset:0
    v_mfma_f32_16x16x32_bf16 v[52:55], a[112:115], a[76:79], v[52:55]
    ds_read_b64_tr_b16 a[90:91], v26 offset:512
    ds_read_b64_tr_b16 a[92:93], v27 offset:0
    s_waitcnt lgkmcnt(13)
    v_mfma_f32_16x16x32_bf16 v[40:43], a[116:119], a[72:75], v[40:43]
    ds_read_b64_tr_b16 a[94:95], v27 offset:512
    v_mfma_f32_16x16x32_bf16 v[56:59], a[116:119], a[76:79], v[56:59]
    ds_read_b64_tr_b16 a[96:97], v86 offset:0
    ds_read_b64_tr_b16 a[98:99], v86 offset:512
    s_waitcnt lgkmcnt(14)
    v_mfma_f32_16x16x32_bf16 v[60:63], a[72:75], a[120:123], v[60:63]
    ds_read_b64_tr_b16 a[100:101], v87 offset:0
    v_mfma_f32_16x16x32_bf16 v[68:71], a[76:79], a[120:123], v[68:71]
    ds_read_b64_tr_b16 a[102:103], v87 offset:512
    s_waitcnt lgkmcnt(14)
    v_mfma_f32_16x16x32_bf16 v[64:67], a[72:75], a[124:127], v[64:67]
    v_mfma_f32_16x16x32_bf16 v[72:75], a[76:79], a[124:127], v[72:75]
    buffer_store_dwordx4 v[100:103], v13, s[28:31], s58 offen sc1
    s_cmp_lg_u32 s46, 2
    s_cbranch_scc1 Lxe2
    ds_read_b64 v[108:109], v4
    ds_read_b64 v[110:111], v5
    ds_read_b64 v[112:113], v6
    ds_read_b64 v[114:115], v7
Lxe2:
    s_waitcnt lgkmcnt(10)
    v_mfma_f32_16x16x32_bf16 v[28:31], a[80:83], a[64:67], v[28:31]
    ds_read_b128 a[72:75], v81 offset:0
    ds_read_b128 a[76:79], v83 offset:0
    v_mfma_f32_16x16x32_bf16 v[44:47], a[80:83], a[68:71], v[44:47]
    ds_read_b64_tr_b16 a[104:105], v24 offset:4096
    s_waitcnt lgkmcnt(11)
    v_mfma_f32_16x16x32_bf16 v[32:35], a[84:87], a[64:67], v[32:35]
    ds_read_b64_tr_b16 a[106:107], v24 offset:4608
    ds_read_b64_tr_b16 a[108:109], v25 offset:4096
    v_mfma_f32_16x16x32_bf16 v[48:51], a[84:87], a[68:71], v[48:51]
    ds_read_b64_tr_b16 a[110:111], v25 offset:4608
    s_waitcnt lgkmcnt(12)
    v_mfma_f32_16x16x32_bf16 v[36:39], a[88:91], a[64:67], v[36:39]
    ds_read_b64_tr_b16 a[112:113], v26 offset:4096
    v_mfma_f32_16x16x32_bf16 v[52:55], a[88:91], a[68:71], v[52:55]
    ds_read_b64_tr_b16 a[114:115], v26 offset:4608
    ds_read_b64_tr_b16 a[116:117], v27 offset:4096
    s_waitcnt lgkmcnt(13)
    v_mfma_f32_16x16x32_bf16 v[40:43], a[92:95], a[64:67], v[40:43]
    ds_read_b64_tr_b16 a[118:119], v27 offset:4608
    v_mfma_f32_16x16x32_bf16 v[56:59], a[92:95], a[68:71], v[56:59]
    ds_read_b64_tr_b16 a[120:121], v86 offset:4096
    ds_read_b64_tr_b16 a[122:123], v86 offset:4608
    s_waitcnt lgkmcnt(14)
    v_mfma_f32_16x16x32_bf16 v[60:63], a[64:67], a[96:99], v[60:63]
    ds_read_b64_tr_b16 a[124:125], v87 offset:4096
    v_mfma_f32_16x16x32_bf16 v[68:71], a[68:71], a[96:99], v[68:71]
    ds_read_b64_tr_b16 a[126:127], v87 offset:4608
    s_waitcnt lgkmcnt(14)
    v_mfma_f32_16x16x32_bf16 v[64:67], a[64:67], a[100:103], v[64:67]
    v_mfma_f32_16x16x32_bf16 v[72:75], a[68:71], a[100:103], v[72:75]
    s_barrier
    s_waitcnt lgkmcnt(10)
    v_mfma_f32_16x16x32_bf16 v[28:31], a[104:107], a[72:75], v[28:31]
    ds_read_b128 a[64:67], v80 offset:39040
    ds_read_b128 a[68:71], v82 offset:39040
    v_mfma_f32_16x16x32_bf16 v[44:47], a[104:107], a[76:79], v[44:47]
    ds_read_b64_tr_b16 a[80:81], v24 offset:39040
    s_waitcnt lgkmcnt(11)
    v_mfma_f32_16x16x32_bf16 v[32:35], a[108:111], a[72:75], v[32:35]
    ds_read_b64_tr_b16 a[82:83], v24 offset:39552
    ds_read_b64_tr_b16 a[84:85], v25 offset:39040
    v_mfma_f32_16x16x32_bf16 v[48:51], a[108:111], a[76:79], v[48:51]
    ds_read_b64_tr_b16 a[86:87], v25 offset:39552
    s_waitcnt lgkmcnt(12)
    v_mfma_f32_16x16x32_bf16 v[36:39], a[112:115], a[72:75], v[36:39]
    ds_read_b64_tr_b16 a[88:89], v26 offset:39040
    v_mfma_f32_16x16x32_bf16 v[52:55], a[112:115], a[76:79], v[52:55]
    ds_read_b64_tr_b16 a[90:91], v26 offset:39552
    ds_read_b64_tr_b16 a[92:93], v27 offset:39040
    s_waitcnt lgkmcnt(13)
    v_mfma_f32_16x16x32_bf16 v[40:43], a[116:119], a[72:75], v[40:43]
    ds_read_b64_tr_b16 a[94:95], v27 offset:39552
    v_mfma_f32_16x16x32_bf16 v[56:59], a[116:119], a[76:79], v[56:59]
    ds_read_b64_tr_b16 a[96:97], v86 offset:39040
    ds_read_b64_tr_b16 a[98:99], v86 offset:39552
    s_waitcnt lgkmcnt(14)
    v_mfma_f32_16x16x32_bf16 v[60:63], a[72:75], a[120:123], v[60:63]
    ds_read_b64_tr_b16 a[100:101], v87 offset:39040
    v_mfma_f32_16x16x32_bf16 v[68:71], a[76:79], a[120:123], v[68:71]
    ds_read_b64_tr_b16 a[102:103], v87 offset:39552
    s_waitcnt lgkmcnt(14)
    v_mfma_f32_16x16x32_bf16 v[64:67], a[72:75], a[124:127], v[64:67]
    v_mfma_f32_16x16x32_bf16 v[72:75], a[76:79], a[124:127], v[72:75]
    s_cmp_lg_u32 s46, 3
    s_cbranch_scc1 Lxe3
    ds_read_b64 v[108:109], v4
    ds_read_b64 v[110:111], v5
    ds_read_b64 v[112:113], v6
    ds_read_b64 v[114:115], v7
Lxe3:
    s_waitcnt lgkmcnt(10)
    v_mfma_f32_16x16x32_bf16 v[28:31], a[80:83], a[64:67], v[28:31]
    ds_read_b128 a[72:75], v81 offset:39040
    ds_read_b128 a[76:79], v83 offset:39040
    v_mfma_f32_16x16x32_bf16 v[44:47], a[80:83], a[68:71], v[44:47]
    ds_read_b64_tr_b16 a[104:105], v24 offset:43136
    s_waitcnt lgkmcnt(11)
    v_mfma_f32_16x16x32_bf16 v[32:35], a[84:87], a[64:67], v[32:35]
    ds_read_b64_tr_b16 a[106:107], v24 offset:43648
    ds_read_b64_tr_b16 a[108:109], v25 offset:43136
    v_mfma_f32_16x16x32_bf16 v[48:51], a[84:87], a[68:71], v[48:51]
    ds_read_b64_tr_b16 a[110:111], v25 offset:43648
    s_waitcnt lgkmcnt(12)
    v_mfma_f32_16x16x32_bf16 v[36:39], a[88:91], a[64:67], v[36:39]
    ds_read_b64_tr_b16 a[112:113], v26 offset:43136
    v_mfma_f32_16x16x32_bf16 v[52:55], a[88:91], a[68:71], v[52:55]
    ds_read_b64_tr_b16 a[114:115], v26 offset:43648
    ds_read_b64_tr_b16 a[116:117], v27 offset:43136
    s_waitcnt lgkmcnt(13)
    v_mfma_f32_16x16x32_bf16 v[40:43], a[92:95], a[64:67], v[40:43]
    ds_read_b64_tr_b16 a[118:119], v27 offset:43648
    v_mfma_f32_16x16x32_bf16 v[56:59], a[92:95], a[68:71], v[56:59]
    ds_read_b64_tr_b16 a[120:121], v86 offset:43136
    ds_read_b64_tr_b16 a[122:123], v86 offset:43648
    s_waitcnt lgkmcnt(14)
    v_mfma_f32_16x16x32_bf16 v[60:63], a[64:67], a[96:99], v[60:63]
    ds_read_b64_tr_b16 a[124:125], v87 offset:43136
    v_mfma_f32_16x16x32_bf16 v[68:71], a[68:71], a[96:99], v[68:71]
    ds_read_b64_tr_b16 a[126:127], v87 offset:43648
    s_waitcnt lgkmcnt(14)
    v_mfma_f32_16x16x32_bf16 v[64:67], a[64:67], a[100:103], v[64:67]
    v_mfma_f32_16x16x32_bf16 v[72:75], a[68:71], a[100:103], v[72:75]
    s_barrier
    s_waitcnt lgkmcnt(10)
    v_mfma_f32_16x16x32_bf16 v[28:31], a[104:107], a[72:75], v[28:31]
    ds_read_b128 a[64:67], v76 offset:0
    ds_read_b128 a[68:71], v78 offset:0
    v_mfma_f32_16x16x32_bf16 v[44:47], a[104:107], a[76:79], v[44:47]
    ds_read_b64_tr_b16 a[80:81], v20 offset:0
    s_waitcnt lgkmcnt(11)
    v_mfma_f32_16x16x32_bf16 v[32:35], a[108:111], a[72:75], v[32:35]
    ds_read_b64_tr_b16 a[82:83], v20 offset:512
    ds_read_b64_tr_b16 a[84:85], v21 offset:0
    v_mfma_f32_16x16x32_bf16 v[48:51], a[108:111], a[76:79], v[48:51]
    ds_read_b64_tr_b16 a[86:87], v21 offset:512
    s_waitcnt lgkmcnt(12)
    v_mfma_f32_16x16x32_bf16 v[36:39], a[112:115], a[72:75], v[36:39]
    ds_read_b64_tr_b16 a[88:89], v22 offset:0
    v_mfma_f32_16x16x32_bf16 v[52:55], a[112:115], a[76:79], v[52:55]
    ds_read_b64_tr_b16 a[90:91], v22 offset:512
    ds_read_b64_tr_b16 a[92:93], v23 offset:0
    s_waitcnt lgkmcnt(13)
    v_mfma_f32_16x16x32_bf16 v[40:43], a[116:119], a[72:75], v[40:43]
    ds_read_b64_tr_b16 a[94:95], v23 offset:512
    v_mfma_f32_16x16x32_bf16 v[56:59], a[116:119], a[76:79], v[56:59]
    ds_read_b64_tr_b16 a[96:97], v84 offset:0
    ds_read_b64_tr_b16 a[98:99], v84 offset:512
    s_waitcnt lgkmcnt(14)
    v_mfma_f32_16x16x32_bf16 v[60:63], a[72:75], a[120:123], v[60:63]
    ds_read_b64_tr_b16 a[100:101], v85 offset:0
    v_mfma_f32_16x16x32_bf16 v[68:71], a[76:79], a[120:123], v[68:71]
    ds_read_b64_tr_b16 a[102:103], v85 offset:512
    s_waitcnt lgkmcnt(14)
    v_mfma_f32_16x16x32_bf16 v[64:67], a[72:75], a[124:127], v[64:67]
    v_mfma_f32_16x16x32_bf16 v[72:75], a[76:79], a[124:127], v[72:75]
    buffer_store_dwordx4 v[100:103], v13, s[28:31], s23 offen offset:0 sc1
    s_cmp_lg_u32 s46, 4
    s_cbranch_scc1 Lxe4
    ds_read_b64 v[108:109], v4
    ds_read_b64 v[110:111], v5
    ds_read_b64 v[112:113], v6
    ds_read_b64 v[114:115], v7
Lxe4:
    s_waitcnt lgkmcnt(10)
    v_mfma_f32_16x16x32_bf16 v[28:31], a[80:83], a[64:67], v[28:31]
    ds_read_b128 a[72:75], v77 offset:0
    ds_read_b128 a[76:79], v79 offset:0
    v_mfma_f32_16x16x32_bf16 v[44:47], a[80:83], a[68:71], v[44:47]
    ds_read_b64_tr_b16 a[104:105], v20 offset:4096
    s_waitcnt lgkmcnt(11)
    v_mfma_f32_16x16x32_bf16 v[32:35], a[84:87], a[64:67], v[32:35]
    ds_read_b64_tr_b16 a[106:107], v20 offset:4608
    ds_read_b64_tr_b16 a[108:109], v21 offset:4096
    v_mfma_f32_16x16x32_bf16 v[48:51], a[84:87], a[68:71], v[48:51]
    ds_read_b64_tr_b16 a[110:111], v21 offset:4608
    s_waitcnt lgkmcnt(12)
    v_mfma_f32_16x16x32_bf16 v[36:39], a[88:91], a[64:67], v[36:39]
    ds_read_b64_tr_b16 a[112:113], v22 offset:4096
    v_mfma_f32_16x16x32_bf16 v[52:55], a[88:91], a[68:71], v[52:55]
    ds_read_b64_tr_b16 a[114:115], v22 offset:4608
    ds_read_b64_tr_b16 a[116:117], v23 offset:4096
    s_waitcnt lgkmcnt(13)
    v_mfma_f32_16x16x32_bf16 v[40:43], a[92:95], a[64:67], v[40:43]
    ds_read_b64_tr_b16 a[118:119], v23 offset:4608
    v_mfma_f32_16x16x32_bf16 v[56:59], a[92:95], a[68:71], v[56:59]
    ds_read_b64_tr_b16 a[120:121], v84 offset:4096
    ds_read_b64_tr_b16 a[122:123], v84 offset:4608
    s_waitcnt lgkmcnt(14)
    v_mfma_f32_16x16x32_bf16 v[60:63], a[64:67], a[96:99], v[60:63]
    ds_read_b64_tr_b16 a[124:125], v85 offset:4096
    v_mfma_f32_16x16x32_bf16 v[68:71], a[68:71], a[96:99], v[68:71]
    ds_read_b64_tr_b16 a[126:127], v85 offset:4608
    s_waitcnt lgkmcnt(14)
    v_mfma_f32_16x16x32_bf16 v[64:67], a[64:67], a[100:103], v[64:67]
    v_mfma_f32_16x16x32_bf16 v[72:75], a[68:71], a[100:103], v[72:75]
    s_barrier
    s_waitcnt lgkmcnt(10)
    v_mfma_f32_16x16x32_bf16 v[28:31], a[104:107], a[72:75], v[28:31]
    ds_read_b128 a[64:67], v76 offset:39040
    ds_read_b128 a[68:71], v78 offset:39040
    v_mfma_f32_16x16x32_bf16 v[44:47], a[104:107], a[76:79], v[44:47]
    ds_read_b64_tr_b16 a[80:81], v20 offset:39040
    s_waitcnt lgkmcnt(11)
    v_mfma_f32_16x16x32_bf16 v[32:35], a[108:111], a[72:75], v[32:35]
    ds_read_b64_tr_b16 a[82:83], v20 offset:39552
    ds_read_b64_tr_b16 a[84:85], v21 offset:39040
    v_mfma_f32_16x16x32_bf16 v[48:51], a[108:111], a[76:79], v[48:51]
    ds_read_b64_tr_b16 a[86:87], v21 offset:39552
    s_waitcnt lgkmcnt(12)
    v_mfma_f32_16x16x32_bf16 v[36:39], a[112:115], a[72:75], v[36:39]
    ds_read_b64_tr_b16 a[88:89], v22 offset:39040
    v_mfma_f32_16x16x32_bf16 v[52:55], a[112:115], a[76:79], v[52:55]
    ds_read_b64_tr_b16 a[90:91], v22 offset:39552
    ds_read_b64_tr_b16 a[92:93], v23 offset:39040
    s_waitcnt lgkmcnt(13)
    v_mfma_f32_16x16x32_bf16 v[40:43], a[116:119], a[72:75], v[40:43]
    ds_read_b64_tr_b16 a[94:95], v23 offset:39552
    v_mfma_f32_16x16x32_bf16 v[56:59], a[116:119], a[76:79], v[56:59]
    ds_read_b64_tr_b16 a[96:97], v84 offset:39040
    ds_read_b64_tr_b16 a[98:99], v84 offset:39552
    s_waitcnt lgkmcnt(14)
    v_mfma_f32_16x16x32_bf16 v[60:63], a[72:75], a[120:123], v[60:63]
    ds_read_b64_tr_b16 a[100:101], v85 offset:39040
    v_mfma_f32_16x16x32_bf16 v[68:71], a[76:79], a[120:123], v[68:71]
    ds_read_b64_tr_b16 a[102:103], v85 offset:39552
    s_waitcnt lgkmcnt(14)
    v_mfma_f32_16x16x32_bf16 v[64:67], a[72:75], a[124:127], v[64:67]
    v_mfma_f32_16x16x32_bf16 v[72:75], a[76:79], a[124:127], v[72:75]
    s_cmp_lg_u32 s46, 5
    s_cbranch_scc1 Lxe5
    ds_read_b64 v[108:109], v4
    ds_read_b64 v[110:111], v5
    ds_read_b64 v[112:113], v6
    ds_read_b64 v[114:115], v7
Lxe5:
    s_waitcnt lgkmcnt(10)
    v_mfma_f32_16x16x32_bf16 v[28:31], a[80:83], a[64:67], v[28:31]
    ds_read_b128 a[72:75], v77 offset:39040
    ds_read_b128 a[76:79], v79 offset:39040
    v_mfma_f32_16x16x32_bf16 v[44:47], a[80:83], a[68:71], v[44:47]
    ds_read_b64_tr_b16 a[104:105], v20 offset:43136
    s_waitcnt lgkmcnt(11)
    v_mfma_f32_16x16x32_bf16 v[32:35], a[84:87], a[64:67], v[32:35]
    ds_read_b64_tr_b16 a[106:107], v20 offset:43648
    ds_read_b64_tr_b16 a[108:109], v21 offset:43136
    v_mfma_f32_16x16x32_bf16 v[48:51], a[84:87], a[68:71], v[48:51]
    ds_read_b64_tr_b16 a[110:111], v21 offset:43648
    s_waitcnt lgkmcnt(12)
    v_mfma_f32_16x16x32_bf16 v[36:39], a[88:91], a[64:67], v[36:39]
    ds_read_b64_tr_b16 a[112:113], v22 offset:43136
    v_mfma_f32_16x16x32_bf16 v[52:55], a[88:91], a[68:71], v[52:55]
    ds_read_b64_tr_b16 a[114:115], v22 offset:43648
    ds_read_b64_tr_b16 a[116:117], v23 offset:43136
    s_waitcnt lgkmcnt(13)
    v_mfma_f32_16x16x32_bf16 v[40:43], a[92:95], a[64:67], v[40:43]
    ds_read_b64_tr_b16 a[118:119], v23 offset:43648
    v_mfma_f32_16x16x32_bf16 v[56:59], a[92:95], a[68:71], v[56:59]
    ds_read_b64_tr_b16 a[120:121], v84 offset:43136
    ds_read_b64_tr_b16 a[122:123], v84 offset:43648
    s_waitcnt lgkmcnt(14)
    v_mfma_f32_16x16x32_bf16 v[60:63], a[64:67], a[96:99], v[60:63]
    ds_read_b64_tr_b16 a[124:125], v85 offset:43136
    v_mfma_f32_16x16x32_bf16 v[68:71], a[68:71], a[96:99], v[68:71]
    ds_read_b64_tr_b16 a[126:127], v85 offset:43648
    s_waitcnt lgkmcnt(14)
    v_mfma_f32_16x16x32_bf16 v[64:67], a[64:67], a[100:103], v[64:67]
    v_mfma_f32_16x16x32_bf16 v[72:75], a[68:71], a[100:103], v[72:75]
    s_barrier
    s_waitcnt lgkmcnt(10)
    v_mfma_f32_16x16x32_bf16 v[28:31], a[104:107], a[72:75], v[28:31]
    ds_read_b128 a[0:3], v80 offset:0
    v_mfma_f32_16x16x32_bf16 v[44:47], a[104:107], a[76:79], v[44:47]
    ds_read_b128 a[4:7], v82 offset:0
    s_waitcnt lgkmcnt(10)
    v_mfma_f32_16x16x32_bf16 v[32:35], a[108:111], a[72:75], v[32:35]
    ds_read_b64_tr_b16 a[80:81], v24 offset:0
    v_mfma_f32_16x16x32_bf16 v[48:51], a[108:111], a[76:79], v[48:51]
    ds_read_b64_tr_b16 a[82:83], v24 offset:512
    s_waitcnt lgkmcnt(10)
    v_mfma_f32_16x16x32_bf16 v[36:39], a[112:115], a[72:75], v[36:39]
    ds_read_b64_tr_b16 a[84:85], v25 offset:0
    v_mfma_f32_16x16x32_bf16 v[52:55], a[112:115], a[76:79], v[52:55]
    ds_read_b64_tr_b16 a[86:87], v25 offset:512
    s_waitcnt lgkmcnt(10)
    v_mfma_f32_16x16x32_bf16 v[40:43], a[116:119], a[72:75], v[40:43]
    ds_read_b64_tr_b16 a[88:89], v26 offset:0
    v_mfma_f32_16x16x32_bf16 v[56:59], a[116:119], a[76:79], v[56:59]
    ds_read_b64_tr_b16 a[90:91], v26 offset:512
    s_waitcnt lgkmcnt(10)
    v_mfma_f32_16x16x32_bf16 v[60:63], a[72:75], a[120:123], v[60:63]
    ds_read_b64_tr_b16 a[92:93], v27 offset:0
    v_mfma_f32_16x16x32_bf16 v[68:71], a[76:79], a[120:123], v[68:71]
    ds_read_b64_tr_b16 a[94:95], v27 offset:512
    s_waitcnt lgkmcnt(10)
    v_mfma_f32_16x16x32_bf16 v[64:67], a[72:75], a[124:127], v[64:67]
    v_mfma_f32_16x16x32_bf16 v[72:75], a[76:79], a[124:127], v[72:75]
    buffer_store_dwordx4 v[100:103], v13, s[28:31], s23 offen offset:1024 sc1
    s_cmp_lg_u32 s46, 6
    s_cbranch_scc1 Lxe6
    ds_read_b64 v[108:109], v4
    ds_read_b64 v[110:111], v5
    ds_read_b64 v[112:113], v6
    ds_read_b64 v[114:115], v7
Lxe6:
    s_waitcnt lgkmcnt(6)
    v_mfma_f32_16x16x32_bf16 v[28:31], a[80:83], a[0:3], v[28:31]
    ds_read_b128 a[8:11], v81 offset:0
    ds_read_b128 a[12:15], v83 offset:0
    v_mfma_f32_16x16x32_bf16 v[44:47], a[80:83], a[4:7], v[44:47]
    ds_read_b64_tr_b16 a[104:105], v24 offset:4096
    ds_read_b64_tr_b16 a[106:107], v24 offset:4608
    s_waitcnt lgkmcnt(8)
    v_mfma_f32_16x16x32_bf16 v[32:35], a[84:87], a[0:3], v[32:35]
    ds_read_b64_tr_b16 a[108:109], v25 offset:4096
    v_mfma_f32_16x16x32_bf16 v[48:51], a[84:87], a[4:7], v[48:51]
    ds_read_b64_tr_b16 a[110:111], v25 offset:4608
    ds_read_b64_tr_b16 a[112:113], v26 offset:4096
    s_waitcnt lgkmcnt(9)
    v_mfma_f32_16x16x32_bf16 v[36:39], a[88:91], a[0:3], v[36:39]
    ds_read_b64_tr_b16 a[114:115], v26 offset:4608
    ds_read_b64_tr_b16 a[116:117], v27 offset:4096
    v_mfma_f32_16x16x32_bf16 v[52:55], a[88:91], a[4:7], v[52:55]
    ds_read_b64_tr_b16 a[118:119], v27 offset:4608
    s_waitcnt lgkmcnt(10)
    v_mfma_f32_16x16x32_bf16 v[40:43], a[92:95], a[0:3], v[40:43]
    v_mfma_f32_16x16x32_bf16 v[56:59], a[92:95], a[4:7], v[56:59]
    s_barrier
    s_waitcnt lgkmcnt(6)
    v_mfma_f32_16x16x32_bf16 v[28:31], a[104:107], a[8:11], v[28:31]
    ds_read_b128 a[16:19], v80 offset:39040
    ds_read_b128 a[20:23], v82 offset:39040
    v_mfma_f32_16x16x32_bf16 v[44:47], a[104:107], a[12:15], v[44:47]
    ds_read_b64_tr_b16 a[80:81], v24 offset:39040
    ds_read_b64_tr_b16 a[82:83], v24 offset:39552
    s_waitcnt lgkmcnt(8)
    v_mfma_f32_16x16x32_bf16 v[32:35], a[108:111], a[8:11], v[32:35]
    ds_read_b64_tr_b16 a[84:85], v25 offset:39040
    v_mfma_f32_16x16x32_bf16 v[48:51], a[108:111], a[12:15], v[48:51]
    ds_read_b64_tr_b16 a[86:87], v25 offset:39552
    ds_read_b64_tr_b16 a[88:89], v26 offset:39040
    s_waitcnt lgkmcnt(9)
    v_mfma_f32_16x16x32_bf16 v[36:39], a[112:115], a[8:11], v[36:39]
    ds_read_b64_tr_b16 a[90:91], v26 offset:39552
    ds_read_b64_tr_b16 a[92:93], v27 offset:39040
    v_mfma_f32_16x16x32_bf16 v[52:55], a[112:115], a[12:15], v[52:55]
    ds_read_b64_tr_b16 a[94:95], v27 offset:39552
    s_waitcnt lgkmcnt(10)
    v_mfma_f32_16x16x32_bf16 v[40:43], a[116:119], a[8:11], v[40:43]
    v_mfma_f32_16x16x32_bf16 v[56:59], a[116:119], a[12:15], v[56:59]
    s_cmp_lg_u32 s46, 7
    s_cbranch_scc1 Lxe7
    ds_read_b64 v[108:109], v4
    ds_read_b64 v[110:111], v5
    ds_read_b64 v[112:113], v6
    ds_read_b64 v[114:115], v7
Lxe7:
    s_waitcnt lgkmcnt(6)
    v_mfma_f32_16x16x32_bf16 v[28:31], a[80:83], a[16:19], v[28:31]
    ds_read_b128 a[24:27], v81 offset:39040
    ds_read_b128 a[28:31], v83 offset:39040
    v_mfma_f32_16x16x32_bf16 v[44:47], a[80:83], a[20:23], v[44:47]
    ds_read_b64_tr_b16 a[104:105], v24 offset:43136
    ds_read_b64_tr_b16 a[106:107], v24 offset:43648
    s_waitcnt lgkmcnt(8)
    v_mfma_f32_16x16x32_bf16 v[32:35], a[84:87], a[16:19], v[32:35]
    ds_read_b64_tr_b16 a[108:109], v25 offset:43136
    v_mfma_f32_16x16x32_bf16 v[48:51], a[84:87], a[20:23], v[48:51]
    ds_read_b64_tr_b16 a[110:111], v25 offset:43648
    ds_read_b64_tr_b16 a[112:113], v26 offset:43136
    s_waitcnt lgkmcnt(9)
    v_mfma_f32_16x16x32_bf16 v[36:39], a[88:91], a[16:19], v[36:39]
    ds_read_b64_tr_b16 a[114:115], v26 offset:43648
    ds_read_b64_tr_b16 a[116:117], v27 offset:43136
    v_mfma_f32_16x16x32_bf16 v[52:55], a[88:91], a[20:23], v[52:55]
    ds_read_b64_tr_b16 a[118:119], v27 offset:43648
    s_waitcnt lgkmcnt(10)
    v_mfma_f32_16x16x32_bf16 v[40:43], a[92:95], a[16:19], v[40:43]
    v_mfma_f32_16x16x32_bf16 v[56:59], a[92:95], a[20:23], v[56:59]
    s_barrier
    s_waitcnt lgkmcnt(6)
    v_mfma_f32_16x16x32_bf16 v[28:31], a[104:107], a[24:27], v[28:31]
    ds_read_b128 a[32:35], v76 offset:0
    ds_read_b128 a[36:39], v78 offset:0
    v_mfma_f32_16x16x32_bf16 v[44:47], a[104:107], a[28:31], v[44:47]
    ds_read_b64_tr_b16 a[80:81], v20 offset:0
    ds_read_b64_tr_b16 a[82:83], v20 offset:512
    s_waitcnt lgkmcnt(8)
    v_mfma_f32_16x16x32_bf16 v[32:35], a[108:111], a[24:27], v[32:35]
    ds_read_b64_tr_b16 a[84:85], v21 offset:0
    v_mfma_f32_16x16x32_bf16 v[48:51], a[108:111], a[28:31], v[48:51]
    ds_read_b64_tr_b16 a[86:87], v21 offset:512
    ds_read_b64_tr_b16 a[88:89], v22 offset:0
    s_waitcnt lgkmcnt(9)
    v_mfma_f32_16x16x32_bf16 v[36:39], a[112:115], a[24:27], v[36:39]
    ds_read_b64_tr_b16 a[90:91], v22 offset:512
    ds_read_b64_tr_b16 a[92:93], v23 offset:0
    v_mfma_f32_16x16x32_bf16 v[52:55], a[112:115], a[28:31], v[52:55]
    ds_read_b64_tr_b16 a[94:95], v23 offset:512
    s_waitcnt lgkmcnt(10)
    v_mfma_f32_16x16x32_bf16 v[40:43], a[116:119], a[24:27], v[40:43]
    v_mfma_f32_16x16x32_bf16 v[56:59], a[116:119], a[28:31], v[56:59]
    s_cmp_lg_u32 s46, 8
    s_cbranch_scc1 Lxe8
    ds_read_b64 v[108:109], v4
    ds_read_b64 v[110:111], v5
    ds_read_b64 v[112:113], v6
    ds_read_b64 v[114:115], v7
Lxe8:
    s_waitcnt lgkmcnt(6)
    v_mfma_f32_16x16x32_bf16 v[28:31], a[80:83], a[32:35], v[28:31]
    ds_read_b128 a[40:43], v77 offset:0
    ds_read_b128 a[44:47], v79 offset:0
    v_mfma_f32_16x16x32_bf16 v[44:47], a[80:83], a[36:39], v[44:47]
    ds_read_b64_tr_b16 a[104:105], v20 offset:4096
    ds_read_b64_tr_b16 a[106:107], v20 offset:4608
    s_waitcnt lgkmcnt(8)
    v_mfma_f32_16x16x32_bf16 v[32:35], a[84:87], a[32:35], v[32:35]
    ds_read_b64_tr_b16 a[108:109], v21 offset:4096
    v_mfma_f32_16x16x32_bf16 v[48:51], a[84:87], a[36:39], v[48:51]
    ds_read_b64_tr_b16 a[110:111], v21 offset:4608
    ds_read_b64_tr_b16 a[112:113], v22 offset:4096
    s_waitcnt lgkmcnt(9)
    v_mfma_f32_16x16x32_bf16 v[36:39], a[88:91], a[32:35], v[36:39]
    ds_read_b64_tr_b16 a[114:115], v22 offset:4608
    ds_read_b64_tr_b16 a[116:117], v23 offset:4096
    v_mfma_f32_16x16x32_bf16 v[52:55], a[88:91], a[36:39], v[52:55]
    ds_read_b64_tr_b16 a[118:119], v23 offset:4608
    s_waitcnt lgkmcnt(10)
    v_mfma_f32_16x16x32_bf16 v[40:43], a[92:95], a[32:35], v[40:43]
    v_mfma_f32_16x16x32_bf16 v[56:59], a[92:95], a[36:39], v[56:59]
    s_waitcnt lgkmcnt(0)
    s_barrier
    v_mfma_f32_16x16x32_bf16 v[28:31], a[104:107], a[40:43], v[28:31]
    ds_read_b128 a[48:51], v76 offset:39040
    ds_read_b128 a[52:55], v78 offset:39040
    v_mfma_f32_16x16x32_bf16 v[44:47], a[104:107], a[44:47], v[44:47]
    ds_read_b64_tr_b16 a[80:81], v20 offset:39040
    ds_read_b64_tr_b16 a[82:83], v20 offset:39552
    v_mfma_f32_16x16x32_bf16 v[32:35], a[108:111], a[40:43], v[32:35]
    ds_read_b64_tr_b16 a[84:85], v21 offset:39040
    v_mfma_f32_16x16x32_bf16 v[48:51], a[108:111], a[44:47], v[48:51]
    ds_read_b64_tr_b16 a[86:87], v21 offset:39552
    ds_read_b64_tr_b16 a[88:89], v22 offset:39040
    v_mfma_f32_16x16x32_bf16 v[36:39], a[112:115], a[40:43], v[36:39]
    ds_read_b64_tr_b16 a[90:91], v22 offset:39552
    ds_read_b64_tr_b16 a[92:93], v23 offset:39040
    v_mfma_f32_16x16x32_bf16 v[52:55], a[112:115], a[44:47], v[52:55]
    ds_read_b64_tr_b16 a[94:95], v23 offset:39552
    v_mfma_f32_16x16x32_bf16 v[40:43], a[116:119], a[40:43], v[40:43]
    v_mfma_f32_16x16x32_bf16 v[56:59], a[116:119], a[44:47], v[56:59]
    v_mov_b32 v98, s38
    s_waitcnt vmcnt(0)
    s_mov_b64 exec, 1
    buffer_store_dword v98, v97, s[28:31], s24 offen sc1
    s_mov_b64 exec, -1
    s_cmp_lg_u32 s46, 9
    s_cbranch_scc1 Lxe9
    ds_read_b64 v[108:109], v4
    ds_read_b64 v[110:111], v5
    ds_read_b64 v[112:113], v6
    ds_read_b64 v[114:115], v7
Lxe9:
    s_waitcnt lgkmcnt(6)
    v_mfma_f32_16x16x32_bf16 v[28:31], a[80:83], a[48:51], v[28:31]
    ds_read_b128 a[56:59], v77 offset:39040
    ds_read_b128 a[60:63], v79 offset:39040
    ds_read_b64_tr_b16 a[104:105], v20 offset:43136
    ds_read_b64_tr_b16 a[106:107], v20 offset:43648
    v_mfma_f32_16x16x32_bf16 v[44:47], a[80:83], a[52:55], v[44:47]
    ds_read_b64_tr_b16 a[108:109], v21 offset:43136
    ds_read_b64_tr_b16 a[110:111], v21 offset:43648
    ds_read_b64_tr_b16 a[112:113], v22 offset:43136
    s_waitcnt lgkmcnt(11)
    v_mfma_f32_16x16x32_bf16 v[32:35], a[84:87], a[48:51], v[32:35]
    ds_read_b64_tr_b16 a[114:115], v22 offset:43648
    ds_read_b64_tr_b16 a[116:117], v23 offset:43136
    ds_read_b64_tr_b16 a[118:119], v23 offset:43648
    v_mfma_f32_16x16x32_bf16 v[48:51], a[84:87], a[52:55], v[48:51]
    ds_read_b32 v120, v94
    ds_read_b32 v121, v94 offset:512
    v_xor_b32 v94, 64, v94
    ds_read_b32 v122, v94
    s_waitcnt lgkmcnt(15)
    v_mfma_f32_16x16x32_bf16 v[36:39], a[88:91], a[48:51], v[36:39]
    ds_read_b32 v123, v92 offset:512
    ds_read_b32 v126, v93 offset:520
    v_mov_b32 v24, v84
    v_mfma_f32_16x16x32_bf16 v[52:55], a[88:91], a[52:55], v[52:55]
    v_mov_b32 v25, v85
    v_mov_b32 v26, v86
    v_mov_b32 v27, v87
    s_waitcnt lgkmcnt(15)
    v_mfma_f32_16x16x32_bf16 v[40:43], a[92:95], a[48:51], v[40:43]
    v_mfma_f32_16x16x32_bf16 v[56:59], a[92:95], a[52:55], v[56:59]
    s_waitcnt lgkmcnt(5)
    v_mfma_f32_16x16x32_bf16 v[44:47], a[104:107], a[60:63], v[44:47]
    v_mfma_f32_16x16x32_bf16 v[48:51], a[108:111], a[60:63], v[48:51]
    v_mfma_f32_16x16x32_bf16 v[52:55], a[112:115], a[60:63], v[52:55]
    v_mfma_f32_16x16x32_bf16 v[56:59], a[116:119], a[60:63], v[56:59]
    v_mfma_f32_16x16x32_bf16 v[28:31], a[104:107], a[56:59], v[28:31]
    v_mfma_f32_16x16x32_bf16 v[32:35], a[108:111], a[56:59], v[32:35]
    ds_read_b32 v7, v96
    ds_read_b128 v[76:79], v95 offset:0
    ds_read_b128 v[80:83], v95 offset:64
    ds_read_b128 v[84:87], v95 offset:128
    ds_read_b128 v[88:91], v95 offset:192
    v_mfma_f32_16x16x32_bf16 v[36:39], a[112:115], a[56:59], v[36:39]
    v_mfma_f32_16x16x32_bf16 v[40:43], a[116:119], a[56:59], v[40:43]
    s_waitcnt lgkmcnt(0)
Lqf:
    v_readfirstlane_b32 s42, v7
    s_nop 0
    s_cmp_eq_u32 s42, 0
    s_cbranch_scc1 Lqf_re
    s_cmp_eq_u32 s27, 0
    v_fmac_f32 v44, v76, v122
    v_fmac_f32 v45, v77, v122
    v_fmac_f32 v46, v78, v122
    v_fmac_f32 v47, v79, v122
    v_cvt_pk_bf16_f32 v44, v44, v45
    v_cvt_pk_bf16_f32 v45, v46, v47
    v_fmac_f32 v48, v80, v122
    v_fmac_f32 v49, v81, v122
    v_fmac_f32 v50, v82, v122
    v_fmac_f32 v51, v83, v122
    v_cvt_pk_bf16_f32 v46, v48, v49
    v_cvt_pk_bf16_f32 v47, v50, v51
    v_fmac_f32 v52, v84, v122
    v_fmac_f32 v53, v85, v122
    v_fmac_f32 v54, v86, v122
    v_fmac_f32 v55, v87, v122
    v_cvt_pk_bf16_f32 v48, v52, v53
    v_cvt_pk_bf16_f32 v49, v54, v55
    v_fmac_f32 v56, v88, v122
    v_fmac_f32 v57, v89, v122
    v_fmac_f32 v58, v90, v122
    v_fmac_f32 v59, v91, v122
    v_cvt_pk_bf16_f32 v50, v56, v57
    v_cvt_pk_bf16_f32 v51, v58, v59
    s_cbranch_scc0 Lh1
    ds_write_b128 v125, v[44:47] offset:0
    ds_write_b128 v125, v[48:51] offset:1024
    v_mov_b32 v5, 157972
    v_mov_b32 v6, 1
    s_mov_b64 exec, 1
    ds_add_u32 v5, v6
    s_mov_b64 exec, -1
    v_fmac_f32 v28, v76, v120
    v_fmac_f32 v29, v77, v120
    v_fmac_f32 v30, v78, v120
    v_fmac_f32 v31, v79, v120
    v_cvt_pk_bf16_f32 v28, v28, v29
    v_cvt_pk_bf16_f32 v29, v30, v31
    v_fmac_f32 v32, v80, v120
    v_fmac_f32 v33, v81, v120
    v_fmac_f32 v34, v82, v120
    v_fmac_f32 v35, v83, v120
    v_cvt_pk_bf16_f32 v30, v32, v33
    v_cvt_pk_bf16_f32 v31, v34, v35
    v_fmac_f32 v36, v84, v120
    v_fmac_f32 v37, v85, v120
    v_fmac_f32 v38, v86, v120
    v_fmac_f32 v39, v87, v120
    v_cvt_pk_bf16_f32 v32, v36, v37
    v_cvt_pk_bf16_f32 v33, v38, v39
    v_fmac_f32 v40, v88, v120
    v_fmac_f32 v41, v89, v120
    v_fmac_f32 v42, v90, v120
    v_fmac_f32 v43, v91, v120
    v_cvt_pk_bf16_f32 v34, v40, v41
    v_cvt_pk_bf16_f32 v35, v42, v43
    v_subrev_u32 v4, 6144, v125
    v_mov_b32 v8, s22
    v_mov_b32 v9, s22
    v_mov_b32 v10, s22
    v_mov_b32 v11, s22
Lcw_1:
    s_sub_u32 s39, s39, 1
    s_cbranch_scc1 Lend
    ds_read_b32 v6, v5
    s_waitcnt lgkmcnt(0)
    v_readfirstlane_b32 s42, v6
    s_nop 0
    s_cmp_lt_u32 s42, 8
    s_cbranch_scc1 Lcw_1
    ds_read_b128 v[52:55], v125 offset:2048
    ds_read_b128 v[56:59], v125 offset:3072
    ds_read_b128 v[44:47], v4 offset:4096
    ds_read_b128 v[48:51], v4 offset:5120
    s_branch Lh_join
Lh1:
    ds_write_b128 v125, v[44:47] offset:2048
    ds_write_b128 v125, v[48:51] offset:3072
    v_fmac_f32 v28, v76, v120
    v_fmac_f32 v29, v77, v120
    v_fmac_f32 v30, v78, v120
    v_fmac_f32 v31, v79, v120
    v_cvt_pk_bf16_f32 v52, v28, v29
    v_cvt_pk_bf16_f32 v53, v30, v31
    v_fmac_f32 v32, v80, v120
    v_fmac_f32 v33, v81, v120
    v_fmac_f32 v34, v82, v120
    v_fmac_f32 v35, v83, v120
    v_cvt_pk_bf16_f32 v54, v32, v33
    v_cvt_pk_bf16_f32 v55, v34, v35
    v_fmac_f32 v36, v84, v120
    v_fmac_f32 v37, v85, v120
    v_fmac_f32 v38, v86, v120
    v_fmac_f32 v39, v87, v120
    v_cvt_pk_bf16_f32 v56, v36, v37
    v_cvt_pk_bf16_f32 v57, v38, v39
    v_fmac_f32 v40, v88, v120
    v_fmac_f32 v41, v89, v120
    v_fmac_f32 v42, v90, v120
    v_fmac_f32 v43, v91, v120
    v_cvt_pk_bf16_f32 v58, v40, v41
    v_cvt_pk_bf16_f32 v59, v42, v43
    ds_write_b128 v125, v[52:55] offset:4096
    ds_write_b128 v125, v[56:59] offset:5120
    v_mov_b32 v5, 157972
    v_mov_b32 v6, 1
    s_mov_b64 exec, 1
    ds_add_u32 v5, v6
    s_mov_b64 exec, -1
    v_mov_b32 v8, s22
    v_mov_b32 v9, s22
    v_mov_b32 v10, s22
    v_mov_b32 v11, s22
Lcw_2:
    s_sub_u32 s39, s39, 1
    s_cbranch_scc1 Lend
    ds_read_b32 v6, v5
    s_waitcnt lgkmcnt(0)
    v_readfirstlane_b32 s42, v6
    s_nop 0
    s_cmp_lt_u32 s42, 8
    s_cbranch_scc1 Lcw_2
    ds_read_b128 v[28:31], v125 offset:0
    ds_read_b128 v[32:35], v125 offset:1024
Lh_join:
    buffer_load_dword v20, v12, s[28:31], s24 offen sc1
    ds_read_b64_tr_b16 a[64:65], v26 offset:0
    ds_read_b64_tr_b16 a[66:67], v26 offset:512
    ds_read_b64_tr_b16 a[68:69], v27 offset:0
    ds_read_b64_tr_b16 a[70:71], v27 offset:512
    ds_read_b64_tr_b16 a[72:73], v26 offset:4096
    ds_read_b64_tr_b16 a[74:75], v26 offset:4608
    ds_read_b64_tr_b16 a[76:77], v27 offset:4096
    ds_read_b64_tr_b16 a[78:79], v27 offset:4608
    s_waitcnt lgkmcnt(8)
    s_setprio 2
    v_cndmask_b32 v92, 0, v30, s[6:7]
    v_cndmask_b32 v93, 0, v31, s[6:7]
    v_cndmask_b32 v94, 0, v32, s[12:13]
    v_cndmask_b32 v95, 0, v33, s[12:13]
    v_cndmask_b32 v104, 0, v30, s[8:9]
    v_cndmask_b32 v105, 0, v31, s[8:9]
    v_mfma_f32_16x16x32_bf16 v[76:79], v[46:49], v[92:95], v[8:11]
    v_mfma_f32_16x16x32_bf16 v[80:83], v[54:57], v[92:95], 0
    v_cndmask_b32 v106, 0, v32, s[14:15]
    v_cndmask_b32 v107, 0, v33, s[14:15]
    v_mov_b32 v96, v28
    v_mov_b32 v97, v29
    v_mfma_f32_16x16x32_bf16 v[84:87], v[46:49], v[104:107], v[8:11]
    v_mfma_f32_16x16x32_bf16 v[88:91], v[54:57], v[104:107], 0
    v_cndmask_b32 v98, 0, v30, s[10:11]
    v_cndmask_b32 v99, 0, v31, s[10:11]
    v_cndmask_b32 v100, 0, v32, s[16:17]
    v_cndmask_b32 v101, 0, v33, s[16:17]
    v_mfma_f32_16x16x32_bf16 v[36:39], v[44:47], v[96:99], v[8:11]
    v_mfma_f32_16x16x32_bf16 v[40:43], v[52:55], v[96:99], 0
    v_cndmask_b32 v76, v76, v77, s[4:5]
    v_cndmask_b32 v80, v80, v81, s[4:5]
    v_cndmask_b32 v78, v78, v79, s[4:5]
    v_cndmask_b32 v82, v82, v83, s[4:5]
    v_cndmask_b32 v92, v76, v80, s[18:19]
    v_cndmask_b32 v94, v78, v82, s[20:21]
    v_min_u32 v4, -2, v92
    v_min_u32 v5, -2, v94
    v_cndmask_b32 v84, v84, v85, s[4:5]
    v_cndmask_b32 v88, v88, v89, s[4:5]
    v_cndmask_b32 v86, v86, v87, s[4:5]
    v_cndmask_b32 v90, v90, v91, s[4:5]
    v_cndmask_b32 v104, v84, v88, s[18:19]
    v_cndmask_b32 v106, v86, v90, s[20:21]
    v_min_u32 v6, -2, v104
    v_min_u32 v7, -2, v106
    buffer_store_dwordx4 v[4:7], v13, s[28:31], s58 offen sc1
    s_setprio 0
    ds_read_b64_tr_b16 a[80:81], v26 offset:39040
    ds_read_b64_tr_b16 a[82:83], v26 offset:39552
    ds_read_b64_tr_b16 a[84:85], v27 offset:39040
    ds_read_b64_tr_b16 a[86:87], v27 offset:39552
    ds_read_b64_tr_b16 a[88:89], v26 offset:43136
    ds_read_b64_tr_b16 a[90:91], v26 offset:43648
    ds_read_b64_tr_b16 a[92:93], v27 offset:43136
    ds_read_b64_tr_b16 a[94:95], v27 offset:43648
    ds_read_b64_tr_b16 a[96:97], v24 offset:0
    ds_read_b64_tr_b16 a[98:99], v24 offset:512
    ds_read_b64_tr_b16 a[100:101], v25 offset:0
    ds_read_b64_tr_b16 a[102:103], v25 offset:512
    ds_read_b64_tr_b16 a[104:105], v24 offset:4096
    ds_read_b64_tr_b16 a[106:107], v24 offset:4608
    ds_read_b64_tr_b16 a[108:109], v25 offset:4096
    ds_read_b64_tr_b16 a[110:111], v25 offset:4608
    ds_read_b64_tr_b16 a[112:113], v24 offset:39040
    ds_read_b64_tr_b16 a[114:115], v24 offset:39552
    ds_read_b64_tr_b16 a[116:117], v25 offset:39040
    ds_read_b64_tr_b16 a[118:119], v25 offset:39552
    ds_read_b64_tr_b16 a[120:121], v24 offset:43136
    ds_read_b64_tr_b16 a[122:123], v24 offset:43648
    ds_read_b64_tr_b16 a[124:125], v25 offset:43136
    ds_read_b64_tr_b16 a[126:127], v25 offset:43648
    s_waitcnt lgkmcnt(15)
    v_mfma_f32_16x16x32_bf16 v[60:63], a[0:3], a[64:67], v[60:63]
    v_mov_b32 v102, v34
    v_mov_b32 v103, v35
    v_mul_f32 v4, s25, v121
    v_mfma_f32_16x16x32_bf16 v[68:71], a[4:7], a[64:67], v[68:71]
    v_mfma_f32_16x16x32_bf16 v[76:79], v[48:51], v[100:103], v[8:11]
    v_mfma_f32_16x16x32_bf16 v[80:83], v[56:59], v[100:103], 0
    v_mfma_f32_16x16x32_bf16 v[64:67], a[0:3], a[68:71], v[64:67]
    v_mul_f32 v123, v123, v4
    v_mul_f32 v126, v126, v4
    v_cndmask_b32 v36, v36, v37, s[4:5]
    v_mfma_f32_16x16x32_bf16 v[72:75], a[4:7], a[68:71], v[72:75]
    v_cndmask_b32 v40, v40, v41, s[4:5]
    v_cndmask_b32 v38, v38, v39, s[4:5]
    v_mfma_f32_16x16x32_bf16 v[60:63], a[8:11], a[72:75], v[60:63]
    v_cndmask_b32 v42, v42, v43, s[4:5]
    v_cndmask_b32 v96, v36, v40, s[18:19]
    v_cndmask_b32 v98, v38, v42, s[20:21]
    v_mfma_f32_16x16x32_bf16 v[68:71], a[12:15], a[72:75], v[68:71]
    v_cndmask_b32 v76, v76, v77, s[4:5]
    v_cndmask_b32 v80, v80, v81, s[4:5]
    v_mfma_f32_16x16x32_bf16 v[64:67], a[8:11], a[76:79], v[64:67]
    v_cndmask_b32 v78, v78, v79, s[4:5]
    v_cndmask_b32 v82, v82, v83, s[4:5]
    v_cndmask_b32 v100, v76, v80, s[18:19]
    v_mfma_f32_16x16x32_bf16 v[72:75], a[12:15], a[76:79], v[72:75]
    v_cndmask_b32 v102, v78, v82, s[20:21]
    v_mul_f32 v96, v96, v123
    v_mfma_f32_16x16x32_bf16 v[60:63], a[16:19], a[80:83], v[60:63]
    v_mul_f32 v98, v98, v126
    v_mul_f32 v100, v100, v123
    v_mul_f32 v102, v102, v126
    v_mfma_f32_16x16x32_bf16 v[68:71], a[20:23], a[80:83], v[68:71]
    v_max_f32 v4, v96, v98
    v_max_f32 v5, v100, v102
    v_mfma_f32_16x16x32_bf16 v[64:67], a[16:19], a[84:87], v[64:67]
    v_mov_b32 v6, v4
    v_mov_b32 v7, v5
    s_nop 0
    v_permlane32_swap_b32 v4, v6
    v_mfma_f32_16x16x32_bf16 v[72:75], a[20:23], a[84:87], v[72:75]
    v_permlane32_swap_b32 v5, v7
    v_max_f32 v4, v4, v6
    v_mfma_f32_16x16x32_bf16 v[60:63], a[24:27], a[88:91], v[60:63]
    v_max_f32 v5, v5, v7
    v_mov_b32 v6, v4
    v_mov_b32 v7, v5
    v_mfma_f32_16x16x32_bf16 v[68:71], a[28:31], a[88:91], v[68:71]
    v_permlane16_swap_b32 v4, v6
    v_permlane16_swap_b32 v5, v7
    v_mfma_f32_16x16x32_bf16 v[64:67], a[24:27], a[92:95], v[64:67]
    v_max_f32 v4, v4, v6
    v_max_f32 v5, v5, v7
    v_mfma_f32_16x16x32_bf16 v[72:75], a[28:31], a[92:95], v[72:75]
    v_sub_f32 v96, v96, v4
    v_sub_f32 v98, v98, v4
    s_waitcnt lgkmcnt(12)
    v_mfma_f32_16x16x32_bf16 v[60:63], a[32:35], a[96:99], v[60:63]
    v_sub_f32 v100, v100, v5
    v_sub_f32 v102, v102, v5
    v_exp_f32 v96, v96
    v_mfma_f32_16x16x32_bf16 v[68:71], a[36:39], a[96:99], v[68:71]
    v_exp_f32 v98, v98
    v_exp_f32 v100, v100
    v_mfma_f32_16x16x32_bf16 v[64:67], a[32:35], a[100:103], v[64:67]
    v_exp_f32 v102, v102
    v_cvt_pk_bf16_f32 v96, v96, v96
    v_mfma_f32_16x16x32_bf16 v[72:75], a[36:39], a[100:103], v[72:75]
    v_cvt_pk_bf16_f32 v97, v98, v98
    v_cvt_pk_bf16_f32 v100, v100, v100
    s_waitcnt lgkmcnt(8)
    v_mfma_f32_16x16x32_bf16 v[60:63], a[40:43], a[104:107], v[60:63]
    v_cvt_pk_bf16_f32 v101, v102, v102
    v_and_b32 v98, v96, v118
    v_and_b32 v99, v97, v119
    v_mfma_f32_16x16x32_bf16 v[68:71], a[44:47], a[104:107], v[68:71]
    v_and_b32 v96, v96, v116
    v_and_b32 v97, v97, v117
    v_mfma_f32_16x16x32_bf16 v[64:67], a[40:43], a[108:111], v[64:67]
    v_and_b32 v102, v100, v118
    v_and_b32 v103, v101, v119
    v_mfma_f32_16x16x32_bf16 v[72:75], a[44:47], a[108:111], v[72:75]
    v_and_b32 v100, v100, v116
    v_and_b32 v101, v101, v117
    s_waitcnt lgkmcnt(4)
    v_mfma_f32_16x16x32_bf16 v[60:63], a[48:51], a[112:115], v[60:63]
    s_lshl_b32 s40, s47, 6
    s_add_u32 s40, s40, 156160
    v_lshl_add_u32 v48, v2, 4, s40
    v_xor_b32 v49, 64, v48
    ds_read_b128 v[28:31], v48 offset:0
    v_mfma_f32_16x16x32_bf16 v[68:71], a[52:55], a[112:115], v[68:71]
    ds_read_b128 v[32:35], v48 offset:512
    ds_read_b128 v[36:39], v49 offset:0
    ds_read_b128 v[40:43], v49 offset:512
    s_lshl_b32 s40, s27, 3
    s_add_u32 s40, s40, 157696
    v_mfma_f32_16x16x32_bf16 v[64:67], a[48:51], a[116:119], v[64:67]
    v_lshl_add_u32 v48, v3, 4, s40
    v_mov_b32 v49, 157952
    v_lshl_add_u32 v125, v1, 3, s52
    s_lshl_b32 s40, s27, 10
    v_add_u32 v50, s40, v125
    v_mfma_f32_16x16x32_bf16 v[72:75], a[52:55], a[116:119], v[72:75]
    s_lshl_b32 s41, s27, 12
    s_sub_u32 s41, 2048, s41
    v_add_u32 v51, s41, v50
    v_subrev_u32 v125, 2048, v125
    s_waitcnt vmcnt(1)
Lfl_chk:
    v_cmp_eq_u32 vcc, s38, v20
    s_nop 0
    s_and_b32 s40, vcc_lo, 0x3ff
    s_cmp_lg_u32 s40, 0x3ff
    s_cbranch_scc1 Lfl_re
    buffer_load_dwordx2 v[52:53], v13, s[28:31], s59 offen offset:8 sc1
    buffer_load_dwordx2 v[54:55], v13, s[28:31], s60 offen offset:0 sc1
    s_waitcnt lgkmcnt(4)
    v_mfma_f32_16x16x32_bf16 v[60:63], a[56:59], a[120:123], v[60:63]
    v_mfma_f32_16x16x32_bf16 v[68:71], a[60:63], a[120:123], v[68:71]
    v_mfma_f32_16x16x32_bf16 v[64:67], a[56:59], a[124:127], v[64:67]
    v_mfma_f32_16x16x32_bf16 v[72:75], a[60:63], a[124:127], v[72:75]
    ds_read_b32 v46, v49
    ds_read_b64 v[44:45], v48
    s_waitcnt lgkmcnt(0)
Lcsv:
    v_readfirstlane_b32 s42, v46
    s_nop 0
    s_cmp_eq_u32 s42, 0
    s_cbranch_scc1 Lcsv_re
    v_fmac_f32 v60, v28, v44
    v_fmac_f32 v61, v29, v44
    v_fmac_f32 v62, v30, v44
    v_fmac_f32 v63, v31, v44
    v_mul_f32 v60, v60, v32
    v_mul_f32 v61, v61, v33
    v_mul_f32 v62, v62, v34
    v_mul_f32 v63, v63, v35
    v_cvt_pk_bf16_f32 v60, v60, v61
    v_cvt_pk_bf16_f32 v61, v62, v63
    ds_write_b64 v50, v[60:61] offset:0
    v_fmac_f32 v64, v28, v45
    v_fmac_f32 v65, v29, v45
    v_fmac_f32 v66, v30, v45
    v_fmac_f32 v67, v31, v45
    v_mul_f32 v64, v64, v32
    v_mul_f32 v65, v65, v33
    v_mul_f32 v66, v66, v34
    v_mul_f32 v67, v67, v35
    v_cvt_pk_bf16_f32 v64, v64, v65
    v_cvt_pk_bf16_f32 v65, v66, v67
    ds_write_b64 v50, v[64:65] offset:512
    v_fmac_f32 v68, v36, v44
    v_fmac_f32 v69, v37, v44
    v_fmac_f32 v70, v38, v44
    v_fmac_f32 v71, v39, v44
    v_mul_f32 v68, v68, v40
    v_mul_f32 v69, v69, v41
    v_mul_f32 v70, v70, v42
    v_mul_f32 v71, v71, v43
    v_cvt_pk_bf16_f32 v68, v68, v69
    v_cvt_pk_bf16_f32 v69, v70, v71
    ds_write_b64 v51, v[68:69] offset:0
    v_fmac_f32 v72, v36, v45
    v_fmac_f32 v73, v37, v45
    v_fmac_f32 v74, v38, v45
    v_fmac_f32 v75, v39, v45
    v_mul_f32 v72, v72, v40
    v_mul_f32 v73, v73, v41
    v_mul_f32 v74, v74, v42
    v_mul_f32 v75, v75, v43
    v_cvt_pk_bf16_f32 v72, v72, v73
    v_cvt_pk_bf16_f32 v73, v74, v75
    ds_write_b64 v51, v[72:73] offset:512
    v_mov_b32 v8, 157976
    v_mov_b32 v9, 1
    s_mov_b64 exec, 1
    ds_add_u32 v8, v9
    s_mov_b64 exec, -1
    s_waitcnt vmcnt(0)
Lrx_chk:
    v_and_b32 v52, s61, v52
    v_and_b32 v53, s61, v53
    v_and_b32 v54, s62, v54
    v_and_b32 v55, s62, v55
    v_max3_u32 v4, v52, v53, v54
    v_max_u32 v4, v4, v55
    v_cmp_eq_u32 vcc, -1, v4
    s_nop 0
    s_cbranch_vccnz Lrx_re
    v_add_f32 v92, v92, v52
    v_add_f32 v94, v94, v53
    v_add_f32 v104, v104, v54
    v_add_f32 v106, v106, v55
    s_setprio 2
Lcw_3:
    s_sub_u32 s39, s39, 1
    s_cbranch_scc1 Lend
    ds_read_b32 v9, v8
    s_waitcnt lgkmcnt(0)
    v_readfirstlane_b32 s42, v9
    s_nop 0
    s_cmp_lt_u32 s42, 7
    s_cbranch_scc1 Lcw_3
    ds_read2st64_b64 v[60:63], v125 offset0:0 offset1:4
    ds_read2st64_b64 v[64:67], v125 offset0:1 offset1:5
    ds_read2st64_b64 v[68:71], v125 offset0:2 offset1:6
    ds_read2st64_b64 v[72:75], v125 offset0:3 offset1:7
    v_mul_f32 v92, v92, v123
    v_mul_f32 v94, v94, v126
    v_mul_f32 v104, v104, v123
    v_mul_f32 v106, v106, v126
    v_max_f32 v4, v92, v94
    v_max_f32 v5, v104, v106
    v_mov_b32 v6, v4
    v_mov_b32 v7, v5
    s_nop 0
    v_permlane32_swap_b32 v4, v6
    v_permlane32_swap_b32 v5, v7
    v_max_f32 v4, v4, v6
    v_max_f32 v5, v5, v7
    s_waitcnt lgkmcnt(0)
    v_mov_b32 v6, v4
    v_mfma_f32_16x16x32_bf16 v[80:83], v[14:17], v[96:99], 0
    v_mov_b32 v7, v5
    v_permlane16_swap_b32 v4, v6
    s_nop 0
    v_permlane16_swap_b32 v5, v7
    v_max_f32 v4, v4, v6
    v_mfma_f32_16x16x32_bf16 v[84:87], v[14:17], v[100:103], 0
    v_max_f32 v5, v5, v7
    v_sub_f32 v92, v92, v4
    v_sub_f32 v94, v94, v4
    v_sub_f32 v104, v104, v5
    v_mfma_f32_16x16x32_bf16 v[28:31], v[60:63], v[96:99], 0
    v_sub_f32 v106, v106, v5
    v_exp_f32 v92, v92
    v_exp_f32 v94, v94
    v_exp_f32 v104, v104
    v_exp_f32 v106, v106
    v_mfma_f32_16x16x32_bf16 v[32:35], v[64:67], v[96:99], 0
    v_cvt_pk_bf16_f32 v92, v92, v92
    v_cvt_pk_bf16_f32 v93, v94, v94
    v_cvt_pk_bf16_f32 v104, v104, v104
    v_cvt_pk_bf16_f32 v105, v106, v106
    v_mfma_f32_16x16x32_bf16 v[36:39], v[68:71], v[100:103], 0
    v_and_b32 v94, v92, v118
    v_and_b32 v95, v93, v119
    v_and_b32 v92, v92, v116
    v_and_b32 v93, v93, v117
    v_mfma_f32_16x16x32_bf16 v[40:43], v[72:75], v[100:103], 0
    v_and_b32 v106, v104, v118
    v_and_b32 v107, v105, v119
    v_and_b32 v104, v104, v116
    v_and_b32 v105, v105, v117
    v_mfma_f32_16x16x32_bf16 v[76:79], v[14:17], v[92:95], 0
    v_rcp_f32 v80, v80
    v_rcp_f32 v84, v84
    v_mfma_f32_16x16x32_bf16 v[88:91], v[14:17], v[104:107], 0
    v_mul_f32 v28, v28, v80
    v_mul_f32 v29, v29, v80
    v_mfma_f32_16x16x32_bf16 v[44:47], v[64:67], v[92:95], 0
    v_mul_f32 v30, v30, v80
    v_mfma_f32_16x16x32_bf16 v[48:51], v[68:71], v[92:95], 0
    v_mul_f32 v31, v31, v80
    v_cvt_pk_bf16_f32 v4, v28, v29
    v_mfma_f32_16x16x32_bf16 v[52:55], v[64:67], v[104:107], 0
    v_cvt_pk_bf16_f32 v5, v30, v31
    v_min_u32 v4, -2, v4
    v_mfma_f32_16x16x32_bf16 v[56:59], v[68:71], v[104:107], 0
    v_min_u32 v5, -2, v5
    v_mul_f32 v40, v40, v84
    v_mul_f32 v41, v41, v84
    v_mul_f32 v42, v42, v84
    v_mul_f32 v43, v43, v84
    v_cvt_pk_bf16_f32 v10, v40, v41
    v_cvt_pk_bf16_f32 v11, v42, v43
    v_min_u32 v10, -2, v10
    v_min_u32 v11, -2, v11
    v_rcp_f32 v76, v76
    v_rcp_f32 v88, v88
    v_cndmask_b32 v82, v80, v76, s[6:7]
    v_cndmask_b32 v82, v82, v88, s[8:9]
    v_cndmask_b32 v32, v32, v44, s[6:7]
    v_cndmask_b32 v33, v33, v45, s[6:7]
    v_cndmask_b32 v34, v34, v46, s[6:7]
    v_cndmask_b32 v35, v35, v47, s[6:7]
    v_cndmask_b32 v32, v32, v52, s[8:9]
    v_cndmask_b32 v33, v33, v53, s[8:9]
    v_cndmask_b32 v34, v34, v54, s[8:9]
    v_cndmask_b32 v35, v35, v55, s[8:9]
    v_mul_f32 v32, v32, v82
    v_mul_f32 v33, v33, v82
    v_mul_f32 v34, v34, v82
    v_mul_f32 v35, v35, v82
    v_cvt_pk_bf16_f32 v6, v32, v33
    v_cvt_pk_bf16_f32 v7, v34, v35
    v_min_u32 v6, -2, v6
    v_min_u32 v7, -2, v7
    buffer_store_dwordx4 v[4:7], v13, s[28:31], s23 offen offset:0 sc1
    v_cndmask_b32 v86, v84, v76, s[12:13]
    v_cndmask_b32 v86, v86, v88, s[14:15]
    v_cndmask_b32 v36, v36, v48, s[12:13]
    v_cndmask_b32 v37, v37, v49, s[12:13]
    v_cndmask_b32 v38, v38, v50, s[12:13]
    v_cndmask_b32 v39, v39, v51, s[12:13]
    v_cndmask_b32 v36, v36, v56, s[14:15]
    v_cndmask_b32 v37, v37, v57, s[14:15]
    v_cndmask_b32 v38, v38, v58, s[14:15]
    v_cndmask_b32 v39, v39, v59, s[14:15]
    v_mul_f32 v36, v36, v86
    v_mul_f32 v37, v37, v86
    v_mul_f32 v38, v38, v86
    v_mul_f32 v39, v39, v86
    v_cvt_pk_bf16_f32 v8, v36, v37
    v_cvt_pk_bf16_f32 v9, v38, v39
    v_min_u32 v8, -2, v8
    v_min_u32 v9, -2, v9
    buffer_store_dwordx4 v[8:11], v13, s[28:31], s23 offen offset:1024 sc1
    s_setprio 0
    v_lshlrev_b32 v28, 16, v108
    v_and_b32 v29, 0xffff0000, v108
    v_lshlrev_b32 v30, 16, v109
    v_and_b32 v31, 0xffff0000, v109
    v_lshlrev_b32 v32, 16, v110
    v_and_b32 v33, 0xffff0000, v110
    v_lshlrev_b32 v34, 16, v111
    v_and_b32 v35, 0xffff0000, v111
    v_lshlrev_b32 v36, 16, v112
    v_and_b32 v37, 0xffff0000, v112
    v_lshlrev_b32 v38, 16, v113
    v_and_b32 v39, 0xffff0000, v113
    v_lshlrev_b32 v40, 16, v114
    v_and_b32 v41, 0xffff0000, v114
    v_lshlrev_b32 v42, 16, v115
    v_and_b32 v43, 0xffff0000, v115
    v_add_f32 v28, v28, v120
    v_add_f32 v29, v29, v120
    v_add_f32 v30, v30, v120
    v_add_f32 v31, v31, v120
    v_add_f32 v32, v32, v120
    v_add_f32 v33, v33, v120
    v_add_f32 v34, v34, v120
    v_add_f32 v35, v35, v120
    v_add_f32 v36, v36, v120
    v_add_f32 v37, v37, v120
    v_add_f32 v38, v38, v120
    v_add_f32 v39, v39, v120
    v_add_f32 v40, v40, v120
    v_add_f32 v41, v41, v120
    v_add_f32 v42, v42, v120
    v_add_f32 v43, v43, v120
    v_cvt_pk_bf16_f32 v29, v28, v29
    v_cvt_pk_bf16_f32 v31, v30, v31
    v_cvt_pk_bf16_f32 v33, v32, v33
    v_cvt_pk_bf16_f32 v35, v34, v35
    v_cvt_pk_bf16_f32 v37, v36, v37
    v_cvt_pk_bf16_f32 v39, v38, v39
    v_cvt_pk_bf16_f32 v41, v40, v41
    v_cvt_pk_bf16_f32 v43, v42, v43
    v_lshlrev_b32 v28, 16, v29
    v_and_b32 v29, 0xffff0000, v29
    v_lshlrev_b32 v30, 16, v31
    v_and_b32 v31, 0xffff0000, v31
    v_lshlrev_b32 v32, 16, v33
    v_and_b32 v33, 0xffff0000, v33
    v_lshlrev_b32 v34, 16, v35
    v_and_b32 v35, 0xffff0000, v35
    v_lshlrev_b32 v36, 16, v37
    v_and_b32 v37, 0xffff0000, v37
    v_lshlrev_b32 v38, 16, v39
    v_and_b32 v39, 0xffff0000, v39
    v_lshlrev_b32 v40, 16, v41
    v_and_b32 v41, 0xffff0000, v41
    v_lshlrev_b32 v42, 16, v43
    v_and_b32 v43, 0xffff0000, v43
    v_mul_f32 v28, v28, v121
    v_mul_f32 v29, v29, v121
    v_mul_f32 v30, v30, v121
    v_mul_f32 v31, v31, v121
    v_mul_f32 v32, v32, v121
    v_mul_f32 v33, v33, v121
    v_mul_f32 v34, v34, v121
    v_mul_f32 v35, v35, v121
    v_mul_f32 v36, v36, v121
    v_mul_f32 v37, v37, v121
    v_mul_f32 v38, v38, v121
    v_mul_f32 v39, v39, v121
    v_mul_f32 v40, v40, v121
    v_mul_f32 v41, v41, v121
    v_mul_f32 v42, v42, v121
    v_mul_f32 v43, v43, v121
    v_cvt_pk_bf16_f32 v29, v28, v29
    v_cvt_pk_bf16_f32 v31, v30, v31
    v_cvt_pk_bf16_f32 v33, v32, v33
    v_cvt_pk_bf16_f32 v35, v34, v35
    v_cvt_pk_bf16_f32 v37, v36, v37
    v_cvt_pk_bf16_f32 v39, v38, v39
    v_cvt_pk_bf16_f32 v41, v40, v41
    v_cvt_pk_bf16_f32 v43, v42, v43
    v_lshlrev_b32 v28, 16, v29
    v_and_b32 v29, 0xffff0000, v29
    v_lshlrev_b32 v30, 16, v31
    v_and_b32 v31, 0xffff0000, v31
    v_lshlrev_b32 v32, 16, v33
    v_and_b32 v33, 0xffff0000, v33
    v_lshlrev_b32 v34, 16, v35
    v_and_b32 v35, 0xffff0000, v35
    v_lshlrev_b32 v36, 16, v37
    v_and_b32 v37, 0xffff0000, v37
    v_lshlrev_b32 v38, 16, v39
    v_and_b32 v39, 0xffff0000, v39
    v_lshlrev_b32 v40, 16, v41
    v_and_b32 v41, 0xffff0000, v41
    v_lshlrev_b32 v42, 16, v43
    v_and_b32 v43, 0xffff0000, v43
    v_mul_f32 v44, 0xbfb8aa3b, v28
    v_mul_f32 v45, 0xbfb8aa3b, v29
    v_mul_f32 v46, 0xbfb8aa3b, v30
    v_mul_f32 v47, 0xbfb8aa3b, v31
    v_mul_f32 v48, 0xbfb8aa3b, v32
    v_mul_f32 v49, 0xbfb8aa3b, v33
    v_mul_f32 v50, 0xbfb8aa3b, v34
    v_mul_f32 v51, 0xbfb8aa3b, v35
    v_mul_f32 v52, 0xbfb8aa3b, v36
    v_mul_f32 v53, 0xbfb8aa3b, v37
    v_mul_f32 v54, 0xbfb8aa3b, v38
    v_mul_f32 v55, 0xbfb8aa3b, v39
    v_mul_f32 v56, 0xbfb8aa3b, v40
    v_mul_f32 v57, 0xbfb8aa3b, v41
    v_mul_f32 v58, 0xbfb8aa3b, v42
    v_mul_f32 v59, 0xbfb8aa3b, v43
    v_exp_f32 v44, v44
    v_exp_f32 v45, v45
    v_exp_f32 v46, v46
    v_exp_f32 v47, v47
    v_exp_f32 v48, v48
    v_exp_f32 v49, v49
    v_exp_f32 v50, v50
    v_exp_f32 v51, v51
    v_exp_f32 v52, v52
    v_exp_f32 v53, v53
    v_exp_f32 v54, v54
    v_exp_f32 v55, v55
    v_exp_f32 v56, v56
    v_exp_f32 v57, v57
    v_exp_f32 v58, v58
    v_exp_f32 v59, v59
    v_add_f32 v44, 1.0, v44
    v_add_f32 v45, 1.0, v45
    v_add_f32 v46, 1.0, v46
    v_add_f32 v47, 1.0, v47
    v_add_f32 v48, 1.0, v48
    v_add_f32 v49, 1.0, v49
    v_add_f32 v50, 1.0, v50
    v_add_f32 v51, 1.0, v51
    v_add_f32 v52, 1.0, v52
    v_add_f32 v53, 1.0, v53
    v_add_f32 v54, 1.0, v54
    v_add_f32 v55, 1.0, v55
    v_add_f32 v56, 1.0, v56
    v_add_f32 v57, 1.0, v57
    v_add_f32 v58, 1.0, v58
    v_add_f32 v59, 1.0, v59
    v_rcp_f32 v44, v44
    v_rcp_f32 v45, v45
    v_rcp_f32 v46, v46
    v_rcp_f32 v47, v47
    v_rcp_f32 v48, v48
    v_rcp_f32 v49, v49
    v_rcp_f32 v50, v50
    v_rcp_f32 v51, v51
    v_rcp_f32 v52, v52
    v_rcp_f32 v53, v53
    v_rcp_f32 v54, v54
    v_rcp_f32 v55, v55
    v_rcp_f32 v56, v56
    v_rcp_f32 v57, v57
    v_rcp_f32 v58, v58
    v_rcp_f32 v59, v59
    v_mul_f32 v44, v44, v28
    v_mul_f32 v45, v45, v29
    v_mul_f32 v46, v46, v30
    v_mul_f32 v47, v47, v31
    v_mul_f32 v48, v48, v32
    v_mul_f32 v49, v49, v33
    v_mul_f32 v50, v50, v34
    v_mul_f32 v51, v51, v35
    v_mul_f32 v52, v52, v36
    v_mul_f32 v53, v53, v37
    v_mul_f32 v54, v54, v38
    v_mul_f32 v55, v55, v39
    v_mul_f32 v56, v56, v40
    v_mul_f32 v57, v57, v41
    v_mul_f32 v58, v58, v42
    v_mul_f32 v59, v59, v43
    v_cvt_pk_bf16_f32 v45, v44, v45
    v_cvt_pk_bf16_f32 v47, v46, v47
    v_cvt_pk_bf16_f32 v49, v48, v49
    v_cvt_pk_bf16_f32 v51, v50, v51
    v_cvt_pk_bf16_f32 v53, v52, v53
    v_cvt_pk_bf16_f32 v55, v54, v55
    v_cvt_pk_bf16_f32 v57, v56, v57
    v_cvt_pk_bf16_f32 v59, v58, v59
    v_accvgpr_write_b32 a0, v45
    v_accvgpr_write_b32 a1, v47
    v_accvgpr_write_b32 a2, v49
    v_accvgpr_write_b32 a3, v51
    v_accvgpr_write_b32 a4, v53
    v_accvgpr_write_b32 a5, v55
    v_accvgpr_write_b32 a6, v57
    v_accvgpr_write_b32 a7, v59
    v_accvgpr_write_b32 a8, v108
    v_accvgpr_write_b32 a9, v109
    v_accvgpr_write_b32 a10, v110
    v_accvgpr_write_b32 a11, v111
    v_accvgpr_write_b32 a12, v112
    v_accvgpr_write_b32 a13, v113
    v_accvgpr_write_b32 a14, v114
    v_accvgpr_write_b32 a15, v115
    v_and_b32 v6, 3, v1
    v_lshl_add_u32 v6, v6, 3, v19
    v_add_u32 v20, v6, v18
    v_xor_b32 v21, 32, v20
    v_xor_b32 v22, 64, v20
    v_xor_b32 v23, 96, v20
    v_add_u32 v24, 63616, v20
    v_add_u32 v25, 63616, v21
    v_add_u32 v26, 63616, v22
    v_add_u32 v27, 63616, v23
    v_mov_b32 v10, 157960
    ds_read_b64 v[8:9], v10
    s_mov_b32 s45, 0
Lld_0:
    buffer_load_dwordx4 v[28:31], v13, s[28:31], s53 offen offset:0 sc1
    buffer_load_dwordx4 v[32:35], v13, s[28:31], s53 offen offset:1024 sc1
Lld_1:
    buffer_load_dwordx4 v[36:39], v13, s[28:31], s53 offen offset:2048 sc1
    buffer_load_dwordx4 v[40:43], v13, s[28:31], s53 offen offset:3072 sc1
Lld_2:
    buffer_load_dwordx4 v[44:47], v13, s[28:31], s54 offen offset:0 sc1
    buffer_load_dwordx4 v[48:51], v13, s[28:31], s54 offen offset:1024 sc1
Lld_3:
    buffer_load_dwordx4 v[52:55], v13, s[28:31], s54 offen offset:2048 sc1
    buffer_load_dwordx4 v[56:59], v13, s[28:31], s54 offen offset:3072 sc1
Lld_4:
    buffer_load_dwordx4 v[60:63], v13, s[28:31], s55 offen offset:0 sc1
    buffer_load_dwordx4 v[64:67], v13, s[28:31], s55 offen offset:1024 sc1
Lld_5:
    buffer_load_dwordx4 v[68:71], v13, s[28:31], s55 offen offset:2048 sc1
    buffer_load_dwordx4 v[72:75], v13, s[28:31], s55 offen offset:3072 sc1
Lld_6:
    buffer_load_dwordx4 v[76:79], v13, s[28:31], s56 offen offset:0 sc1
    buffer_load_dwordx4 v[80:83], v13, s[28:31], s56 offen offset:1024 sc1
Lld_7:
    buffer_load_dwordx4 v[84:87], v13, s[28:31], s56 offen offset:2048 sc1
    buffer_load_dwordx4 v[88:91], v13, s[28:31], s56 offen offset:3072 sc1
Lld_8:
    buffer_load_dwordx4 v[92:95], v13, s[28:31], s57 offen offset:0 sc1
    buffer_load_dwordx4 v[96:99], v13, s[28:31], s57 offen offset:1024 sc1
Lld_9:
    buffer_load_dwordx4 v[100:103], v13, s[28:31], s57 offen offset:2048 sc1
    buffer_load_dwordx4 v[104:107], v13, s[28:31], s57 offen offset:3072 sc1
    s_cmp_lg_u32 s45, 0
    s_cbranch_scc1 Ldisp
    s_waitcnt lgkmcnt(0)
Linfo:
    v_readfirstlane_b32 s43, v8
    s_nop 0
    s_cmp_eq_u32 s43, -2
    s_cbranch_scc1 Linfo_re
    ds_read_b64_tr_b16 a[16:17], v20 offset:0
    ds_read_b64_tr_b16 a[18:19], v20 offset:512
    ds_read_b64_tr_b16 a[20:21], v21 offset:0
    ds_read_b64_tr_b16 a[22:23], v21 offset:512
    ds_read_b64_tr_b16 a[24:25], v22 offset:0
    ds_read_b64_tr_b16 a[26:27], v22 offset:512
    ds_read_b64_tr_b16 a[28:29], v23 offset:0
    ds_read_b64_tr_b16 a[30:31], v23 offset:512
    ds_read_b64_tr_b16 a[32:33], v20 offset:4096
    ds_read_b64_tr_b16 a[34:35], v20 offset:4608
    ds_read_b64_tr_b16 a[36:37], v21 offset:4096
    ds_read_b64_tr_b16 a[38:39], v21 offset:4608
    ds_read_b64_tr_b16 a[40:41], v22 offset:4096
    ds_read_b64_tr_b16 a[42:43], v22 offset:4608
    ds_read_b64_tr_b16 a[44:45], v23 offset:4096
    ds_read_b64_tr_b16 a[46:47], v23 offset:4608
    ds_read_b64_tr_b16 a[48:49], v20 offset:8192
    ds_read_b64_tr_b16 a[50:51], v20 offset:8704
    ds_read_b64_tr_b16 a[52:53], v21 offset:8192
    ds_read_b64_tr_b16 a[54:55], v21 offset:8704
    ds_read_b64_tr_b16 a[56:57], v22 offset:8192
    ds_read_b64_tr_b16 a[58:59], v22 offset:8704
    ds_read_b64_tr_b16 a[60:61], v23 offset:8192
    ds_read_b64_tr_b16 a[62:63], v23 offset:8704
    ds_read_b64_tr_b16 a[64:65], v20 offset:12288
    ds_read_b64_tr_b16 a[66:67], v20 offset:12800
    ds_read_b64_tr_b16 a[68:69], v21 offset:12288
    ds_read_b64_tr_b16 a[70:71], v21 offset:12800
    ds_read_b64_tr_b16 a[72:73], v22 offset:12288
    ds_read_b64_tr_b16 a[74:75], v22 offset:12800
    ds_read_b64_tr_b16 a[76:77], v23 offset:12288
    ds_read_b64_tr_b16 a[78:79], v23 offset:12800
    ds_read_b64_tr_b16 a[80:81], v20 offset:24576
    ds_read_b64_tr_b16 a[82:83], v20 offset:25088
    ds_read_b64_tr_b16 a[84:85], v21 offset:24576
    ds_read_b64_tr_b16 a[86:87], v21 offset:25088
    ds_read_b64_tr_b16 a[88:89], v22 offset:24576
    ds_read_b64_tr_b16 a[90:91], v22 offset:25088
    ds_read_b64_tr_b16 a[92:93], v23 offset:24576
    ds_read_b64_tr_b16 a[94:95], v23 offset:25088
    ds_read_b64_tr_b16 a[96:97], v20 offset:28672
    ds_read_b64_tr_b16 a[98:99], v20 offset:29184
    ds_read_b64_tr_b16 a[100:101], v21 offset:28672
    ds_read_b64_tr_b16 a[102:103], v21 offset:29184
    ds_read_b64_tr_b16 a[104:105], v22 offset:28672
    ds_read_b64_tr_b16 a[106:107], v22 offset:29184
    ds_read_b64_tr_b16 a[108:109], v23 offset:28672
    ds_read_b64_tr_b16 a[110:111], v23 offset:29184
    ds_read_b64_tr_b16 a[112:113], v24 offset:59520
    ds_read_b64_tr_b16 a[114:115], v24 offset:60032
    ds_read_b64_tr_b16 a[116:117], v25 offset:59520
    ds_read_b64_tr_b16 a[118:119], v25 offset:60032
    ds_read_b64_tr_b16 a[120:121], v26 offset:59520
    ds_read_b64_tr_b16 a[122:123], v26 offset:60032
    ds_read_b64_tr_b16 a[124:125], v27 offset:59520
    ds_read_b64_tr_b16 a[126:127], v27 offset:60032
Lchk_0:
    s_waitcnt vmcnt(18)
    v_max3_u32 v4, v28, v29, v30
    v_max3_u32 v5, v32, v33, v34
    v_max3_u32 v4, v4, v31, v35
    v_max_u32 v4, v4, v5
    v_cmp_eq_u32 vcc, -1, v4
    s_nop 0
    s_cbranch_vccnz Lre_0
    s_waitcnt lgkmcnt(15)
    v_mfma_f32_16x16x32_bf16 v[108:111], a[16:19], v[28:31], 0
    v_mfma_f32_16x16x32_bf16 v[112:115], a[20:23], v[28:31], 0
    v_mfma_f32_16x16x32_bf16 v[116:119], a[24:27], v[28:31], 0
    v_mfma_f32_16x16x32_bf16 v[14:17], a[28:31], v[28:31], 0
    ds_read_b64_tr_b16 a[16:17], v24 offset:63616
    ds_read_b64_tr_b16 a[18:19], v24 offset:64128
    ds_read_b64_tr_b16 a[20:21], v25 offset:63616
    ds_read_b64_tr_b16 a[22:23], v25 offset:64128
    ds_read_b64_tr_b16 a[24:25], v26 offset:63616
    ds_read_b64_tr_b16 a[26:27], v26 offset:64128
    ds_read_b64_tr_b16 a[28:29], v27 offset:63616
    ds_read_b64_tr_b16 a[30:31], v27 offset:64128
    v_mfma_f32_16x16x32_bf16 v[108:111], a[32:35], v[32:35], v[108:111]
    v_mfma_f32_16x16x32_bf16 v[112:115], a[36:39], v[32:35], v[112:115]
    v_mfma_f32_16x16x32_bf16 v[116:119], a[40:43], v[32:35], v[116:119]
    v_mfma_f32_16x16x32_bf16 v[14:17], a[44:47], v[32:35], v[14:17]
    ds_read_b64_tr_b16 a[32:33], v24 offset:16384
    ds_read_b64_tr_b16 a[34:35], v24 offset:16896
    ds_read_b64_tr_b16 a[36:37], v25 offset:16384
    ds_read_b64_tr_b16 a[38:39], v25 offset:16896
    ds_read_b64_tr_b16 a[40:41], v26 offset:16384
    ds_read_b64_tr_b16 a[42:43], v26 offset:16896
    ds_read_b64_tr_b16 a[44:45], v27 offset:16384
    ds_read_b64_tr_b16 a[46:47], v27 offset:16896
Lchk_1:
    s_waitcnt vmcnt(16)
    v_max3_u32 v4, v36, v37, v38
    v_max3_u32 v5, v40, v41, v42
    v_max3_u32 v4, v4, v39, v43
    v_max_u32 v4, v4, v5
    v_cmp_eq_u32 vcc, -1, v4
    s_nop 0
    s_cbranch_vccnz Lre_1
    v_mfma_f32_16x16x32_bf16 v[108:111], a[48:51], v[36:39], v[108:111]
    v_mfma_f32_16x16x32_bf16 v[112:115], a[52:55], v[36:39], v[112:115]
    v_mfma_f32_16x16x32_bf16 v[116:119], a[56:59], v[36:39], v[116:119]
    v_mfma_f32_16x16x32_bf16 v[14:17], a[60:63], v[36:39], v[14:17]
    ds_read_b64_tr_b16 a[48:49], v24 offset:20480
    ds_read_b64_tr_b16 a[50:51], v24 offset:20992
    ds_read_b64_tr_b16 a[52:53], v25 offset:20480
    ds_read_b64_tr_b16 a[54:55], v25 offset:20992
    ds_read_b64_tr_b16 a[56:57], v26 offset:20480
    ds_read_b64_tr_b16 a[58:59], v26 offset:20992
    ds_read_b64_tr_b16 a[60:61], v27 offset:20480
    ds_read_b64_tr_b16 a[62:63], v27 offset:20992
    v_mfma_f32_16x16x32_bf16 v[108:111], a[64:67], v[40:43], v[108:111]
    v_mfma_f32_16x16x32_bf16 v[112:115], a[68:71], v[40:43], v[112:115]
    v_mfma_f32_16x16x32_bf16 v[116:119], a[72:75], v[40:43], v[116:119]
    v_mfma_f32_16x16x32_bf16 v[14:17], a[76:79], v[40:43], v[14:17]
    ds_read_b64_tr_b16 a[64:65], v20 offset:32768
    ds_read_b64_tr_b16 a[66:67], v20 offset:33280
    ds_read_b64_tr_b16 a[68:69], v21 offset:32768
    ds_read_b64_tr_b16 a[70:71], v21 offset:33280
    ds_read_b64_tr_b16 a[72:73], v22 offset:32768
    ds_read_b64_tr_b16 a[74:75], v22 offset:33280
    ds_read_b64_tr_b16 a[76:77], v23 offset:32768
    ds_read_b64_tr_b16 a[78:79], v23 offset:33280
Lchk_2:
    s_waitcnt vmcnt(14)
    v_max3_u32 v4, v44, v45, v46
    v_max3_u32 v5, v48, v49, v50
    v_max3_u32 v4, v4, v47, v51
    v_max_u32 v4, v4, v5
    v_cmp_eq_u32 vcc, -1, v4
    s_nop 0
    s_cbranch_vccnz Lre_2
    v_mfma_f32_16x16x32_bf16 v[108:111], a[80:83], v[44:47], v[108:111]
    v_mfma_f32_16x16x32_bf16 v[112:115], a[84:87], v[44:47], v[112:115]
    v_mfma_f32_16x16x32_bf16 v[116:119], a[88:91], v[44:47], v[116:119]
    v_mfma_f32_16x16x32_bf16 v[14:17], a[92:95], v[44:47], v[14:17]
    ds_read_b64_tr_b16 a[80:81], v20 offset:36864
    ds_read_b64_tr_b16 a[82:83], v20 offset:37376
    ds_read_b64_tr_b16 a[84:85], v21 offset:36864
    ds_read_b64_tr_b16 a[86:87], v21 offset:37376
    ds_read_b64_tr_b16 a[88:89], v22 offset:36864
    ds_read_b64_tr_b16 a[90:91], v22 offset:37376
    ds_read_b64_tr_b16 a[92:93], v23 offset:36864
    ds_read_b64_tr_b16 a[94:95], v23 offset:37376
    s_waitcnt lgkmcnt(15)
    v_mfma_f32_16x16x32_bf16 v[108:111], a[96:99], v[48:51], v[108:111]
    v_mfma_f32_16x16x32_bf16 v[112:115], a[100:103], v[48:51], v[112:115]
    v_mfma_f32_16x16x32_bf16 v[116:119], a[104:107], v[48:51], v[116:119]
    v_mfma_f32_16x16x32_bf16 v[14:17], a[108:111], v[48:51], v[14:17]
    ds_read_b64_tr_b16 a[96:97], v20 offset:40960
    ds_read_b64_tr_b16 a[98:99], v20 offset:41472
    ds_read_b64_tr_b16 a[100:101], v21 offset:40960
    ds_read_b64_tr_b16 a[102:103], v21 offset:41472
    ds_read_b64_tr_b16 a[104:105], v22 offset:40960
    ds_read_b64_tr_b16 a[106:107], v22 offset:41472
    ds_read_b64_tr_b16 a[108:109], v23 offset:40960
    ds_read_b64_tr_b16 a[110:111], v23 offset:41472
Lchk_3:
    s_waitcnt vmcnt(12)
    v_max3_u32 v4, v52, v53, v54
    v_max3_u32 v5, v56, v57, v58
    v_max3_u32 v4, v4, v55, v59
    v_max_u32 v4, v4, v5
    v_cmp_eq_u32 vcc, -1, v4
    s_nop 0
    s_cbranch_vccnz Lre_3
    v_mfma_f32_16x16x32_bf16 v[108:111], a[112:115], v[52:55], v[108:111]
    v_mfma_f32_16x16x32_bf16 v[112:115], a[116:119], v[52:55], v[112:115]
    v_mfma_f32_16x16x32_bf16 v[116:119], a[120:123], v[52:55], v[116:119]
    v_mfma_f32_16x16x32_bf16 v[14:17], a[124:127], v[52:55], v[14:17]
    ds_read_b64_tr_b16 a[112:113], v20 offset:45056
    ds_read_b64_tr_b16 a[114:115], v20 offset:45568
    ds_read_b64_tr_b16 a[116:117], v21 offset:45056
    ds_read_b64_tr_b16 a[118:119], v21 offset:45568
    ds_read_b64_tr_b16 a[120:121], v22 offset:45056
    ds_read_b64_tr_b16 a[122:123], v22 offset:45568
    ds_read_b64_tr_b16 a[124:125], v23 offset:45056
    ds_read_b64_tr_b16 a[126:127], v23 offset:45568
    v_mfma_f32_16x16x32_bf16 v[108:111], a[16:19], v[56:59], v[108:111]
    v_mfma_f32_16x16x32_bf16 v[112:115], a[20:23], v[56:59], v[112:115]
    v_mfma_f32_16x16x32_bf16 v[116:119], a[24:27], v[56:59], v[116:119]
    v_mfma_f32_16x16x32_bf16 v[14:17], a[28:31], v[56:59], v[14:17]
    ds_read_b64_tr_b16 a[16:17], v24 offset:0
    ds_read_b64_tr_b16 a[18:19], v24 offset:512
    ds_read_b64_tr_b16 a[20:21], v25 offset:0
    ds_read_b64_tr_b16 a[22:23], v25 offset:512
    ds_read_b64_tr_b16 a[24:25], v26 offset:0
    ds_read_b64_tr_b16 a[26:27], v26 offset:512
    ds_read_b64_tr_b16 a[28:29], v27 offset:0
    ds_read_b64_tr_b16 a[30:31], v27 offset:512
Lchk_4:
    s_waitcnt vmcnt(10)
    v_max3_u32 v4, v60, v61, v62
    v_max3_u32 v5, v64, v65, v66
    v_max3_u32 v4, v4, v63, v67
    v_max_u32 v4, v4, v5
    v_cmp_eq_u32 vcc, -1, v4
    s_nop 0
    s_cbranch_vccnz Lre_4
    v_mfma_f32_16x16x32_bf16 v[108:111], a[32:35], v[60:63], v[108:111]
    v_mfma_f32_16x16x32_bf16 v[112:115], a[36:39], v[60:63], v[112:115]
    v_mfma_f32_16x16x32_bf16 v[116:119], a[40:43], v[60:63], v[116:119]
    v_mfma_f32_16x16x32_bf16 v[14:17], a[44:47], v[60:63], v[14:17]
    ds_read_b64_tr_b16 a[32:33], v24 offset:4096
    ds_read_b64_tr_b16 a[34:35], v24 offset:4608
    ds_read_b64_tr_b16 a[36:37], v25 offset:4096
    ds_read_b64_tr_b16 a[38:39], v25 offset:4608
    ds_read_b64_tr_b16 a[40:41], v26 offset:4096
    ds_read_b64_tr_b16 a[42:43], v26 offset:4608
    ds_read_b64_tr_b16 a[44:45], v27 offset:4096
    ds_read_b64_tr_b16 a[46:47], v27 offset:4608
    v_mfma_f32_16x16x32_bf16 v[108:111], a[48:51], v[64:67], v[108:111]
    v_mfma_f32_16x16x32_bf16 v[112:115], a[52:55], v[64:67], v[112:115]
    v_mfma_f32_16x16x32_bf16 v[116:119], a[56:59], v[64:67], v[116:119]
    v_mfma_f32_16x16x32_bf16 v[14:17], a[60:63], v[64:67], v[14:17]
    ds_read_b64_tr_b16 a[48:49], v24 offset:8192
    ds_read_b64_tr_b16 a[50:51], v24 offset:8704
    ds_read_b64_tr_b16 a[52:53], v25 offset:8192
    ds_read_b64_tr_b16 a[54:55], v25 offset:8704
    ds_read_b64_tr_b16 a[56:57], v26 offset:8192
    ds_read_b64_tr_b16 a[58:59], v26 offset:8704
    ds_read_b64_tr_b16 a[60:61], v27 offset:8192
    ds_read_b64_tr_b16 a[62:63], v27 offset:8704
Lchk_5:
    s_waitcnt vmcnt(8)
    v_max3_u32 v4, v68, v69, v70
    v_max3_u32 v5, v72, v73, v74
    v_max3_u32 v4, v4, v71, v75
    v_max_u32 v4, v4, v5
    v_cmp_eq_u32 vcc, -1, v4
    s_nop 0
    s_cbranch_vccnz Lre_5
    s_waitcnt lgkmcnt(15)
    v_mfma_f32_16x16x32_bf16 v[108:111], a[64:67], v[68:71], v[108:111]
    v_mfma_f32_16x16x32_bf16 v[112:115], a[68:71], v[68:71], v[112:115]
    v_mfma_f32_16x16x32_bf16 v[116:119], a[72:75], v[68:71], v[116:119]
    v_mfma_f32_16x16x32_bf16 v[14:17], a[76:79], v[68:71], v[14:17]
    ds_read_b64_tr_b16 a[64:65], v24 offset:12288
    ds_read_b64_tr_b16 a[66:67], v24 offset:12800
    ds_read_b64_tr_b16 a[68:69], v25 offset:12288
    ds_read_b64_tr_b16 a[70:71], v25 offset:12800
    ds_read_b64_tr_b16 a[72:73], v26 offset:12288
    ds_read_b64_tr_b16 a[74:75], v26 offset:12800
    ds_read_b64_tr_b16 a[76:77], v27 offset:12288
    ds_read_b64_tr_b16 a[78:79], v27 offset:12800
    v_mfma_f32_16x16x32_bf16 v[108:111], a[80:83], v[72:75], v[108:111]
    v_mfma_f32_16x16x32_bf16 v[112:115], a[84:87], v[72:75], v[112:115]
    v_mfma_f32_16x16x32_bf16 v[116:119], a[88:91], v[72:75], v[116:119]
    v_mfma_f32_16x16x32_bf16 v[14:17], a[92:95], v[72:75], v[14:17]
    ds_read_b64_tr_b16 a[80:81], v20 offset:49152
    ds_read_b64_tr_b16 a[82:83], v20 offset:49664
    ds_read_b64_tr_b16 a[84:85], v21 offset:49152
    ds_read_b64_tr_b16 a[86:87], v21 offset:49664
    ds_read_b64_tr_b16 a[88:89], v22 offset:49152
    ds_read_b64_tr_b16 a[90:91], v22 offset:49664
    ds_read_b64_tr_b16 a[92:93], v23 offset:49152
    ds_read_b64_tr_b16 a[94:95], v23 offset:49664
Lchk_6:
    s_waitcnt vmcnt(6)
    v_max3_u32 v4, v76, v77, v78
    v_max3_u32 v5, v80, v81, v82
    v_max3_u32 v4, v4, v79, v83
    v_max_u32 v4, v4, v5
    v_cmp_eq_u32 vcc, -1, v4
    s_nop 0
    s_cbranch_vccnz Lre_6
    v_mfma_f32_16x16x32_bf16 v[108:111], a[96:99], v[76:79], v[108:111]
    v_accvgpr_read_b32 v45, a0
    v_accvgpr_read_b32 v29, a8
    v_mfma_f32_16x16x32_bf16 v[112:115], a[100:103], v[76:79], v[112:115]
    v_accvgpr_read_b32 v47, a1
    v_accvgpr_read_b32 v31, a9
    v_mfma_f32_16x16x32_bf16 v[116:119], a[104:107], v[76:79], v[116:119]
    v_accvgpr_read_b32 v49, a2
    v_accvgpr_read_b32 v33, a10
    v_mfma_f32_16x16x32_bf16 v[14:17], a[108:111], v[76:79], v[14:17]
    v_accvgpr_read_b32 v51, a3
    v_accvgpr_read_b32 v35, a11
    ds_read_b64_tr_b16 a[96:97], v24 offset:24576
    ds_read_b64_tr_b16 a[98:99], v24 offset:25088
    ds_read_b64_tr_b16 a[100:101], v25 offset:24576
    ds_read_b64_tr_b16 a[102:103], v25 offset:25088
    ds_read_b64_tr_b16 a[104:105], v26 offset:24576
    ds_read_b64_tr_b16 a[106:107], v26 offset:25088
    ds_read_b64_tr_b16 a[108:109], v27 offset:24576
    ds_read_b64_tr_b16 a[110:111], v27 offset:25088
    v_mfma_f32_16x16x32_bf16 v[108:111], a[112:115], v[80:83], v[108:111]
    v_accvgpr_read_b32 v53, a4
    v_accvgpr_read_b32 v37, a12
    v_mfma_f32_16x16x32_bf16 v[112:115], a[116:119], v[80:83], v[112:115]
    v_accvgpr_read_b32 v55, a5
    v_accvgpr_read_b32 v39, a13
    v_mfma_f32_16x16x32_bf16 v[116:119], a[120:123], v[80:83], v[116:119]
    v_accvgpr_read_b32 v57, a6
    v_accvgpr_read_b32 v41, a14
    v_mfma_f32_16x16x32_bf16 v[14:17], a[124:127], v[80:83], v[14:17]
    v_accvgpr_read_b32 v59, a7
    v_accvgpr_read_b32 v43, a15
Lchk_7:
    s_waitcnt vmcnt(4)
    v_max3_u32 v4, v84, v85, v86
    v_max3_u32 v5, v88, v89, v90
    v_max3_u32 v4, v4, v87, v91
    v_max_u32 v4, v4, v5
    v_cmp_eq_u32 vcc, -1, v4
    s_nop 0
    s_cbranch_vccnz Lre_7
    v_mfma_f32_16x16x32_bf16 v[108:111], a[16:19], v[84:87], v[108:111]
    v_lshlrev_b32 v44, 16, v45
    v_and_b32 v45, 0xffff0000, v45
    v_lshlrev_b32 v46, 16, v47
    v_mfma_f32_16x16x32_bf16 v[112:115], a[20:23], v[84:87], v[112:115]
    v_and_b32 v47, 0xffff0000, v47
    v_lshlrev_b32 v48, 16, v49
    v_and_b32 v49, 0xffff0000, v49
    v_mfma_f32_16x16x32_bf16 v[116:119], a[24:27], v[84:87], v[116:119]
    v_lshlrev_b32 v50, 16, v51
    v_and_b32 v51, 0xffff0000, v51
    v_lshlrev_b32 v52, 16, v53
    v_mfma_f32_16x16x32_bf16 v[14:17], a[28:31], v[84:87], v[14:17]
    v_and_b32 v53, 0xffff0000, v53
    v_lshlrev_b32 v54, 16, v55
    v_and_b32 v55, 0xffff0000, v55
    s_waitcnt lgkmcnt(15)
    v_mfma_f32_16x16x32_bf16 v[108:111], a[32:35], v[88:91], v[108:111]
    v_lshlrev_b32 v56, 16, v57
    v_and_b32 v57, 0xffff0000, v57
    v_lshlrev_b32 v58, 16, v59
    v_mfma_f32_16x16x32_bf16 v[112:115], a[36:39], v[88:91], v[112:115]
    v_and_b32 v59, 0xffff0000, v59
    v_lshlrev_b32 v28, 16, v29
    v_and_b32 v29, 0xffff0000, v29
    v_mfma_f32_16x16x32_bf16 v[116:119], a[40:43], v[88:91], v[116:119]
    v_lshlrev_b32 v30, 16, v31
    v_and_b32 v31, 0xffff0000, v31
    v_lshlrev_b32 v32, 16, v33
    v_mfma_f32_16x16x32_bf16 v[14:17], a[44:47], v[88:91], v[14:17]
    v_and_b32 v33, 0xffff0000, v33
    v_lshlrev_b32 v34, 16, v35
    v_and_b32 v35, 0xffff0000, v35
Lchk_8:
    s_waitcnt vmcnt(2)
    v_max3_u32 v4, v92, v93, v94
    v_max3_u32 v5, v96, v97, v98
    v_max3_u32 v4, v4, v95, v99
    v_max_u32 v4, v4, v5
    v_cmp_eq_u32 vcc, -1, v4
    s_nop 0
    s_cbranch_vccnz Lre_8
    v_mfma_f32_16x16x32_bf16 v[108:111], a[48:51], v[92:95], v[108:111]
    v_lshlrev_b32 v36, 16, v37
    v_and_b32 v37, 0xffff0000, v37
    v_lshlrev_b32 v38, 16, v39
    v_and_b32 v39, 0xffff0000, v39
    v_mfma_f32_16x16x32_bf16 v[112:115], a[52:55], v[92:95], v[112:115]
    v_lshlrev_b32 v40, 16, v41
    v_and_b32 v41, 0xffff0000, v41
    v_lshlrev_b32 v42, 16, v43
    v_mfma_f32_16x16x32_bf16 v[116:119], a[56:59], v[92:95], v[116:119]
    v_and_b32 v43, 0xffff0000, v43
    s_mul_i32 s40, s36, 96
    s_lshl_b32 s41, s47, 4
    s_add_u32 s40, s40, s41
    v_mfma_f32_16x16x32_bf16 v[14:17], a[60:63], v[92:95], v[14:17]
    s_sub_u32 s40, s40, 32
    v_add_u32 v62, s40, v3
    v_lshrrev_b32 v6, 3, v1
    v_mfma_f32_16x16x32_bf16 v[108:111], a[64:67], v[96:99], v[108:111]
    v_add_u32 v6, s40, v6
    v_mul_u32_u24 v6, 1280, v6
    v_and_b32 v7, 7, v1
    v_xor_b32 v7, v7, v2
    v_mfma_f32_16x16x32_bf16 v[112:115], a[68:71], v[96:99], v[112:115]
    v_lshl_add_u32 v60, v7, 4, v6
    v_xor_b32 v61, 64, v60
    v_add_u32 v61, 10240, v61
    s_lshl_b32 s40, s47, 11
    v_mfma_f32_16x16x32_bf16 v[116:119], a[72:75], v[96:99], v[116:119]
    s_add_u32 s40, s40, 102656
    v_add_u32 v64, s40, v124
    v_xor_b32 v65, 32, v64
    v_xor_b32 v66, 64, v64
    v_mfma_f32_16x16x32_bf16 v[14:17], a[76:79], v[96:99], v[14:17]
    v_xor_b32 v67, 0x60, v64
    v_add_u32 v63, s40, v13
    s_lshl_b32 s24, s37, 7
Lchk_9:
    s_waitcnt vmcnt(0)
    v_max3_u32 v4, v100, v101, v102
    v_max3_u32 v5, v104, v105, v106
    v_max3_u32 v4, v4, v103, v107
    v_max_u32 v4, v4, v5
    v_cmp_eq_u32 vcc, -1, v4
    s_nop 0
    s_cbranch_vccnz Lre_9
    s_waitcnt lgkmcnt(8)
    v_mfma_f32_16x16x32_bf16 v[108:111], a[80:83], v[100:103], v[108:111]
    v_mfma_f32_16x16x32_bf16 v[112:115], a[84:87], v[100:103], v[112:115]
    v_mfma_f32_16x16x32_bf16 v[116:119], a[88:91], v[100:103], v[116:119]
    v_mfma_f32_16x16x32_bf16 v[14:17], a[92:95], v[100:103], v[14:17]
    s_waitcnt lgkmcnt(0)
    v_mfma_f32_16x16x32_bf16 v[108:111], a[96:99], v[104:107], v[108:111]
    v_mfma_f32_16x16x32_bf16 v[112:115], a[100:103], v[104:107], v[112:115]
    v_mfma_f32_16x16x32_bf16 v[116:119], a[104:107], v[104:107], v[116:119]
    v_mfma_f32_16x16x32_bf16 v[14:17], a[108:111], v[104:107], v[14:17]
    v_and_b32 v6, v8, v9
    s_nop 0
    v_readfirstlane_b32 s43, v6
    s_nop 0
    s_cmp_eq_u32 s43, -1
    s_cbranch_scc0 Lfix
Lnofix:
    v_fma_f32 v108, v108, v44, v28
    v_fma_f32 v109, v109, v45, v29
    v_fma_f32 v110, v110, v46, v30
    v_fma_f32 v111, v111, v47, v31
    v_cvt_pk_bf16_f32 v68, v108, v109
    v_cvt_pk_bf16_f32 v69, v110, v111
    ds_write_b64 v64, v[68:69]
    v_fma_f32 v112, v112, v48, v32
    v_fma_f32 v113, v113, v49, v33
    v_fma_f32 v114, v114, v50, v34
    v_fma_f32 v115, v115, v51, v35
    v_cvt_pk_bf16_f32 v70, v112, v113
    v_cvt_pk_bf16_f32 v71, v114, v115
    ds_write_b64 v65, v[70:71]
    v_fma_f32 v116, v116, v52, v36
    v_fma_f32 v117, v117, v53, v37
    v_fma_f32 v118, v118, v54, v38
    v_fma_f32 v119, v119, v55, v39
    v_cvt_pk_bf16_f32 v72, v116, v117
    v_cvt_pk_bf16_f32 v73, v118, v119
    ds_write_b64 v66, v[72:73]
    v_fma_f32 v14, v14, v56, v40
    v_fma_f32 v15, v15, v57, v41
    v_fma_f32 v16, v16, v58, v42
    v_fma_f32 v17, v17, v59, v43
    v_cvt_pk_bf16_f32 v74, v14, v15
    v_cvt_pk_bf16_f32 v75, v16, v17
    ds_write_b64 v67, v[74:75]
    ds_read_b128 v[76:79], v63 offset:0
    ds_read_b128 v[80:83], v63 offset:1024
    s_waitcnt lgkmcnt(1)
    buffer_store_dwordx4 v[76:79], v60, s[48:51], s24 offen
    s_waitcnt lgkmcnt(0)
    buffer_store_dwordx4 v[80:83], v61, s[48:51], s24 offen
    s_endpgm
Lqf_re:
    s_sub_u32 s39, s39, 1
    s_cbranch_scc1 Lend
    ds_read_b32 v7, v96
    ds_read_b128 v[76:79], v95 offset:0
    ds_read_b128 v[80:83], v95 offset:64
    ds_read_b128 v[84:87], v95 offset:128
    ds_read_b128 v[88:91], v95 offset:192
    s_waitcnt lgkmcnt(0)
    s_branch Lqf
Lcsv_re:
    s_sub_u32 s39, s39, 1
    s_cbranch_scc1 Lend
    ds_read_b32 v46, v49
    ds_read_b64 v[44:45], v48
    s_waitcnt lgkmcnt(0)
    s_branch Lcsv
Lrx_re:
    s_sub_u32 s39, s39, 1
    s_cbranch_scc1 Lend
    buffer_load_dwordx2 v[52:53], v13, s[28:31], s59 offen offset:8 sc1
    buffer_load_dwordx2 v[54:55], v13, s[28:31], s60 offen offset:0 sc1
    s_waitcnt vmcnt(0)
    s_branch Lrx_chk
Linfo_re:
    s_sub_u32 s39, s39, 1
    s_cbranch_scc1 Lend
    ds_read_b64 v[8:9], v10
    s_waitcnt lgkmcnt(0)
    s_branch Linfo
Lfl_re:
    s_sub_u32 s39, s39, 1
    s_cbranch_scc1 Lend
    buffer_load_dword v20, v12, s[28:31], s24 offen sc1
    s_waitcnt vmcnt(0)
    s_branch Lfl_chk
Lre_0:
    s_mov_b32 s45, 1
    s_branch Lprobe
Lre_1:
    s_mov_b32 s45, 2
    s_branch Lprobe
Lre_2:
    s_mov_b32 s45, 3
    s_branch Lprobe
Lre_3:
    s_mov_b32 s45, 4
    s_branch Lprobe
Lre_4:
    s_mov_b32 s45, 5
    s_branch Lprobe
Lre_5:
    s_mov_b32 s45, 6
    s_branch Lprobe
Lre_6:
    s_mov_b32 s45, 7
    s_branch Lprobe
Lre_7:
    s_mov_b32 s45, 8
    s_branch Lprobe
Lre_8:
    s_mov_b32 s45, 9
    s_branch Lprobe
Lre_9:
    s_mov_b32 s45, 10
    s_branch Lprobe
Lprobe:
    v_min_u32 v5, 19, v1
    v_lshlrev_b32 v5, 10, v5
Lprobe2:
    s_sub_u32 s39, s39, 1
    s_cbranch_scc1 Lend
    buffer_load_dword v4, v5, s[28:31], s53 offen offset:1020 sc1
    s_waitcnt vmcnt(0)
    v_cmp_eq_u32 vcc, -1, v4
    s_nop 0
    s_cbranch_vccnz Lprobe2
    s_cmp_eq_u32 s45, 1
    s_cbranch_scc1 Lld_0
    s_cmp_eq_u32 s45, 2
    s_cbranch_scc1 Lld_1
    s_cmp_eq_u32 s45, 3
    s_cbranch_scc1 Lld_2
    s_cmp_eq_u32 s45, 4
    s_cbranch_scc1 Lld_3
    s_cmp_eq_u32 s45, 5
    s_cbranch_scc1 Lld_4
    s_cmp_eq_u32 s45, 6
    s_cbranch_scc1 Lld_5
    s_cmp_eq_u32 s45, 7
    s_cbranch_scc1 Lld_6
    s_cmp_eq_u32 s45, 8
    s_cbranch_scc1 Lld_7
    s_cmp_eq_u32 s45, 9
    s_cbranch_scc1 Lld_8
    s_branch Lld_9
Ldisp:
    s_cmp_eq_u32 s45, 1
    s_cbranch_scc1 Lchk_0
    s_cmp_eq_u32 s45, 2
    s_cbranch_scc1 Lchk_1
    s_cmp_eq_u32 s45, 3
    s_cbranch_scc1 Lchk_2
    s_cmp_eq_u32 s45, 4
    s_cbranch_scc1 Lchk_3
    s_cmp_eq_u32 s45, 5
    s_cbranch_scc1 Lchk_4
    s_cmp_eq_u32 s45, 6
    s_cbranch_scc1 Lchk_5
    s_cmp_eq_u32 s45, 7
    s_cbranch_scc1 Lchk_6
    s_cmp_eq_u32 s45, 8
    s_cbranch_scc1 Lchk_7
    s_cmp_eq_u32 s45, 9
    s_cbranch_scc1 Lchk_8
    s_branch Lchk_9
Lfix:
    v_mov_b32 v10, 157956
Lfix_w:
    s_sub_u32 s39, s39, 1
    s_cbranch_scc1 Lend
    ds_read_b32 v6, v10
    s_waitcnt lgkmcnt(0)
    v_readfirstlane_b32 s43, v6
    s_nop 0
    s_cmp_eq_u32 s43, 0
    s_cbranch_scc1 Lfix_w
    v_mov_b32 v6, 158720
    v_mov_b32 v7, 158208
    v_cmp_eq_u32 vcc, v8, v62
    s_nop 1
    v_cndmask_b32 v6, v6, v7, vcc
    v_mov_b32 v7, 158464
    v_cmp_eq_u32 vcc, v9, v62
    s_nop 1
    v_cndmask_b32 v6, v6, v7, vcc
    v_lshl_add_u32 v6, v2, 4, v6
    ds_read_b128 v[92:95], v6 offset:0
    ds_read_b128 v[96:99], v6 offset:64
    ds_read_b128 v[100:103], v6 offset:128
    ds_read_b128 v[104:107], v6 offset:192
    v_accvgpr_read_b32 v68, a8
    v_accvgpr_read_b32 v69, a9
    v_accvgpr_read_b32 v70, a10
    v_accvgpr_read_b32 v71, a11
    v_accvgpr_read_b32 v72, a12
    v_accvgpr_read_b32 v73, a13
    v_accvgpr_read_b32 v74, a14
    v_accvgpr_read_b32 v75, a15
    v_lshlrev_b32 v76, 16, v68
    v_and_b32 v77, 0xffff0000, v68
    v_lshlrev_b32 v78, 16, v69
    v_and_b32 v79, 0xffff0000, v69
    v_lshlrev_b32 v80, 16, v70
    v_and_b32 v81, 0xffff0000, v70
    v_lshlrev_b32 v82, 16, v71
    v_and_b32 v83, 0xffff0000, v71
    v_lshlrev_b32 v84, 16, v72
    v_and_b32 v85, 0xffff0000, v72
    v_lshlrev_b32 v86, 16, v73
    v_and_b32 v87, 0xffff0000, v73
    v_lshlrev_b32 v88, 16, v74
    v_and_b32 v89, 0xffff0000, v74
    v_lshlrev_b32 v90, 16, v75
    v_and_b32 v91, 0xffff0000, v75
    v_add_f32 v76, v76, v120
    v_add_f32 v77, v77, v120
    v_add_f32 v78, v78, v120
    v_add_f32 v79, v79, v120
    v_add_f32 v80, v80, v120
    v_add_f32 v81, v81, v120
    v_add_f32 v82, v82, v120
    v_add_f32 v83, v83, v120
    v_add_f32 v84, v84, v120
    v_add_f32 v85, v85, v120
    v_add_f32 v86, v86, v120
    v_add_f32 v87, v87, v120
    v_add_f32 v88, v88, v120
    v_add_f32 v89, v89, v120
    v_add_f32 v90, v90, v120
    v_add_f32 v91, v91, v120
    v_cvt_pk_bf16_f32 v77, v76, v77
    v_cvt_pk_bf16_f32 v79, v78, v79
    v_cvt_pk_bf16_f32 v81, v80, v81
    v_cvt_pk_bf16_f32 v83, v82, v83
    v_cvt_pk_bf16_f32 v85, v84, v85
    v_cvt_pk_bf16_f32 v87, v86, v87
    v_cvt_pk_bf16_f32 v89, v88, v89
    v_cvt_pk_bf16_f32 v91, v90, v91
    v_lshlrev_b32 v76, 16, v77
    v_and_b32 v77, 0xffff0000, v77
    v_lshlrev_b32 v78, 16, v79
    v_and_b32 v79, 0xffff0000, v79
    v_lshlrev_b32 v80, 16, v81
    v_and_b32 v81, 0xffff0000, v81
    v_lshlrev_b32 v82, 16, v83
    v_and_b32 v83, 0xffff0000, v83
    v_lshlrev_b32 v84, 16, v85
    v_and_b32 v85, 0xffff0000, v85
    v_lshlrev_b32 v86, 16, v87
    v_and_b32 v87, 0xffff0000, v87
    v_lshlrev_b32 v88, 16, v89
    v_and_b32 v89, 0xffff0000, v89
    v_lshlrev_b32 v90, 16, v91
    v_and_b32 v91, 0xffff0000, v91
    v_mul_f32 v76, v76, v121
    v_mul_f32 v77, v77, v121
    v_mul_f32 v78, v78, v121
    v_mul_f32 v79, v79, v121
    v_mul_f32 v80, v80, v121
    v_mul_f32 v81, v81, v121
    v_mul_f32 v82, v82, v121
    v_mul_f32 v83, v83, v121
    v_mul_f32 v84, v84, v121
    v_mul_f32 v85, v85, v121
    v_mul_f32 v86, v86, v121
    v_mul_f32 v87, v87, v121
    v_mul_f32 v88, v88, v121
    v_mul_f32 v89, v89, v121
    v_mul_f32 v90, v90, v121
    v_mul_f32 v91, v91, v121
    v_cvt_pk_bf16_f32 v77, v76, v77
    v_cvt_pk_bf16_f32 v79, v78, v79
    v_cvt_pk_bf16_f32 v81, v80, v81
    v_cvt_pk_bf16_f32 v83, v82, v83
    v_cvt_pk_bf16_f32 v85, v84, v85
    v_cvt_pk_bf16_f32 v87, v86, v87
    v_cvt_pk_bf16_f32 v89, v88, v89
    v_cvt_pk_bf16_f32 v91, v90, v91
    v_lshlrev_b32 v76, 16, v77
    v_and_b32 v77, 0xffff0000, v77
    v_lshlrev_b32 v78, 16, v79
    v_and_b32 v79, 0xffff0000, v79
    v_lshlrev_b32 v80, 16, v81
    v_and_b32 v81, 0xffff0000, v81
    v_lshlrev_b32 v82, 16, v83
    v_and_b32 v83, 0xffff0000, v83
    v_lshlrev_b32 v84, 16, v85
    v_and_b32 v85, 0xffff0000, v85
    v_lshlrev_b32 v86, 16, v87
    v_and_b32 v87, 0xffff0000, v87
    v_lshlrev_b32 v88, 16, v89
    v_and_b32 v89, 0xffff0000, v89
    v_lshlrev_b32 v90, 16, v91
    v_and_b32 v91, 0xffff0000, v91
    s_waitcnt lgkmcnt(0)
    v_add_f32 v76, v76, v92
    v_add_f32 v77, v77, v93
    v_add_f32 v78, v78, v94
    v_add_f32 v79, v79, v95
    v_add_f32 v80, v80, v96
    v_add_f32 v81, v81, v97
    v_add_f32 v82, v82, v98
    v_add_f32 v83, v83, v99
    v_add_f32 v84, v84, v100
    v_add_f32 v85, v85, v101
    v_add_f32 v86, v86, v102
    v_add_f32 v87, v87, v103
    v_add_f32 v88, v88, v104
    v_add_f32 v89, v89, v105
    v_add_f32 v90, v90, v106
    v_add_f32 v91, v91, v107
    v_cvt_pk_bf16_f32 v77, v76, v77
    v_cvt_pk_bf16_f32 v79, v78, v79
    v_cvt_pk_bf16_f32 v81, v80, v81
    v_cvt_pk_bf16_f32 v83, v82, v83
    v_cvt_pk_bf16_f32 v85, v84, v85
    v_cvt_pk_bf16_f32 v87, v86, v87
    v_cvt_pk_bf16_f32 v89, v88, v89
    v_cvt_pk_bf16_f32 v91, v90, v91
    v_lshlrev_b32 v76, 16, v77
    v_and_b32 v77, 0xffff0000, v77
    v_lshlrev_b32 v78, 16, v79
    v_and_b32 v79, 0xffff0000, v79
    v_lshlrev_b32 v80, 16, v81
    v_and_b32 v81, 0xffff0000, v81
    v_lshlrev_b32 v82, 16, v83
    v_and_b32 v83, 0xffff0000, v83
    v_lshlrev_b32 v84, 16, v85
    v_and_b32 v85, 0xffff0000, v85
    v_lshlrev_b32 v86, 16, v87
    v_and_b32 v87, 0xffff0000, v87
    v_lshlrev_b32 v88, 16, v89
    v_and_b32 v89, 0xffff0000, v89
    v_lshlrev_b32 v90, 16, v91
    v_and_b32 v91, 0xffff0000, v91
    v_mul_f32 v44, 0xbfb8aa3b, v76
    v_mul_f32 v45, 0xbfb8aa3b, v77
    v_mul_f32 v46, 0xbfb8aa3b, v78
    v_mul_f32 v47, 0xbfb8aa3b, v79
    v_mul_f32 v48, 0xbfb8aa3b, v80
    v_mul_f32 v49, 0xbfb8aa3b, v81
    v_mul_f32 v50, 0xbfb8aa3b, v82
    v_mul_f32 v51, 0xbfb8aa3b, v83
    v_mul_f32 v52, 0xbfb8aa3b, v84
    v_mul_f32 v53, 0xbfb8aa3b, v85
    v_mul_f32 v54, 0xbfb8aa3b, v86
    v_mul_f32 v55, 0xbfb8aa3b, v87
    v_mul_f32 v56, 0xbfb8aa3b, v88
    v_mul_f32 v57, 0xbfb8aa3b, v89
    v_mul_f32 v58, 0xbfb8aa3b, v90
    v_mul_f32 v59, 0xbfb8aa3b, v91
    v_exp_f32 v44, v44
    v_exp_f32 v45, v45
    v_exp_f32 v46, v46
    v_exp_f32 v47, v47
    v_exp_f32 v48, v48
    v_exp_f32 v49, v49
    v_exp_f32 v50, v50
    v_exp_f32 v51, v51
    v_exp_f32 v52, v52
    v_exp_f32 v53, v53
    v_exp_f32 v54, v54
    v_exp_f32 v55, v55
    v_exp_f32 v56, v56
    v_exp_f32 v57, v57
    v_exp_f32 v58, v58
    v_exp_f32 v59, v59
    v_add_f32 v44, 1.0, v44
    v_add_f32 v45, 1.0, v45
    v_add_f32 v46, 1.0, v46
    v_add_f32 v47, 1.0, v47
    v_add_f32 v48, 1.0, v48
    v_add_f32 v49, 1.0, v49
    v_add_f32 v50, 1.0, v50
    v_add_f32 v51, 1.0, v51
    v_add_f32 v52, 1.0, v52
    v_add_f32 v53, 1.0, v53
    v_add_f32 v54, 1.0, v54
    v_add_f32 v55, 1.0, v55
    v_add_f32 v56, 1.0, v56
    v_add_f32 v57, 1.0, v57
    v_add_f32 v58, 1.0, v58
    v_add_f32 v59, 1.0, v59
    v_rcp_f32 v44, v44
    v_rcp_f32 v45, v45
    v_rcp_f32 v46, v46
    v_rcp_f32 v47, v47
    v_rcp_f32 v48, v48
    v_rcp_f32 v49, v49
    v_rcp_f32 v50, v50
    v_rcp_f32 v51, v51
    v_rcp_f32 v52, v52
    v_rcp_f32 v53, v53
    v_rcp_f32 v54, v54
    v_rcp_f32 v55, v55
    v_rcp_f32 v56, v56
    v_rcp_f32 v57, v57
    v_rcp_f32 v58, v58
    v_rcp_f32 v59, v59
    v_mul_f32 v44, v44, v76
    v_mul_f32 v45, v45, v77
    v_mul_f32 v46, v46, v78
    v_mul_f32 v47, v47, v79
    v_mul_f32 v48, v48, v80
    v_mul_f32 v49, v49, v81
    v_mul_f32 v50, v50, v82
    v_mul_f32 v51, v51, v83
    v_mul_f32 v52, v52, v84
    v_mul_f32 v53, v53, v85
    v_mul_f32 v54, v54, v86
    v_mul_f32 v55, v55, v87
    v_mul_f32 v56, v56, v88
    v_mul_f32 v57, v57, v89
    v_mul_f32 v58, v58, v90
    v_mul_f32 v59, v59, v91
    v_cvt_pk_bf16_f32 v45, v44, v45
    v_cvt_pk_bf16_f32 v47, v46, v47
    v_cvt_pk_bf16_f32 v49, v48, v49
    v_cvt_pk_bf16_f32 v51, v50, v51
    v_cvt_pk_bf16_f32 v53, v52, v53
    v_cvt_pk_bf16_f32 v55, v54, v55
    v_cvt_pk_bf16_f32 v57, v56, v57
    v_cvt_pk_bf16_f32 v59, v58, v59
    v_lshlrev_b32 v44, 16, v45
    v_and_b32 v45, 0xffff0000, v45
    v_lshlrev_b32 v46, 16, v47
    v_and_b32 v47, 0xffff0000, v47
    v_lshlrev_b32 v48, 16, v49
    v_and_b32 v49, 0xffff0000, v49
    v_lshlrev_b32 v50, 16, v51
    v_and_b32 v51, 0xffff0000, v51
    v_lshlrev_b32 v52, 16, v53
    v_and_b32 v53, 0xffff0000, v53
    v_lshlrev_b32 v54, 16, v55
    v_and_b32 v55, 0xffff0000, v55
    v_lshlrev_b32 v56, 16, v57
    v_and_b32 v57, 0xffff0000, v57
    v_lshlrev_b32 v58, 16, v59
    v_and_b32 v59, 0xffff0000, v59
    s_branch Lnofix
Lhalo:
    s_mov_b32 vcc_lo, 0x00010001
    s_mov_b32 vcc_hi, 0x00010001
    v_mov_b32 v11, 38912
    v_cndmask_b32 v76, v76, v11, vcc
    v_xor_b32 v77, 64, v76
    v_add_u32 v80, 78080, v76
    v_add_u32 v81, 78080, v77
    v_mov_b32 v14, 0x3f803f80
    v_mov_b32 v15, 0x3f803f80
    v_mov_b32 v16, 0x3f803f80
    v_mov_b32 v17, 0x3f803f80
    v_and_b32 v4, 7, v1
    v_lshlrev_b32 v4, 4, v4
    v_mul_u32_u24 v5, 39040, v2
    v_add_u32 v4, v4, v5
    ds_write_b128 v4, v[14:17] offset:38912
    v_mov_b32 v4, 157952
    v_mov_b32 v8, 0
    v_mov_b32 v9, 0
    v_mov_b32 v10, -2
    v_mov_b32 v11, -2
    ds_write_b128 v4, v[8:11]
    ds_write_b64 v4, v[8:9] offset:16
    ds_write_b64 v4, v[8:9] offset:24
    s_mul_i32 s40, s36, 96
    s_sub_u32 s40, s40, 16
    v_add_u32 v96, s40, v1
    v_min_u32 v5, 47, v1
    v_add3_u32 v97, s40, v5, 64
    v_mov_b32 v6, 2047
    v_med3_i32 v96, v96, 0, v6
    v_med3_i32 v97, v97, 0, v6
    v_lshlrev_b32 v96, 3, v96
    v_lshlrev_b32 v97, 3, v97
    s_mov_b32 s53, 8192000
    s_waitcnt lgkmcnt(0)
    s_barrier
    s_add_u32 s38, s38, 0x9e3779b8
    s_or_b32 s38, s38, 1
    ds_read_b128 v[108:111], v76 offset:0
    ds_read_b128 v[112:115], v77 offset:0
    ds_read_b64_tr_b16 a[0:1], v20 offset:0
    ds_read_b64_tr_b16 a[2:3], v20 offset:512
    ds_read_b64_tr_b16 a[4:5], v21 offset:0
    ds_read_b64_tr_b16 a[6:7], v21 offset:512
    ds_read_b64_tr_b16 a[8:9], v22 offset:0
    ds_read_b64_tr_b16 a[10:11], v22 offset:512
    ds_read_b64_tr_b16 a[12:13], v23 offset:0
    ds_read_b64_tr_b16 a[14:15], v23 offset:512
    ds_read_b64_tr_b16 a[16:17], v20 offset:8192
    ds_read_b64_tr_b16 a[18:19], v20 offset:8704
    ds_read_b64_tr_b16 a[20:21], v21 offset:8192
    ds_read_b64_tr_b16 a[22:23], v21 offset:8704
    ds_read_b64_tr_b16 a[24:25], v22 offset:8192
    ds_read_b64_tr_b16 a[26:27], v22 offset:8704
    s_waitcnt lgkmcnt(12)
    v_mfma_f32_16x16x32_bf16 v[28:31], a[0:3], v[108:111], 0
    ds_read_b64_tr_b16 a[28:29], v23 offset:8192
    ds_read_b64_tr_b16 a[30:31], v23 offset:8704
    s_waitcnt lgkmcnt(12)
    v_mfma_f32_16x16x32_bf16 v[32:35], a[4:7], v[108:111], 0
    ds_read_b64_tr_b16 a[32:33], v20 offset:16384
    ds_read_b64_tr_b16 a[34:35], v20 offset:16896
    s_waitcnt lgkmcnt(12)
    v_mfma_f32_16x16x32_bf16 v[36:39], a[8:11], v[108:111], 0
    ds_read_b64_tr_b16 a[36:37], v21 offset:16384
    ds_read_b64_tr_b16 a[38:39], v21 offset:16896
    s_waitcnt lgkmcnt(12)
    v_mfma_f32_16x16x32_bf16 v[40:43], a[12:15], v[108:111], 0
    ds_read_b64_tr_b16 a[40:41], v22 offset:16384
    ds_read_b64_tr_b16 a[42:43], v22 offset:16896
    s_waitcnt lgkmcnt(12)
    v_mfma_f32_16x16x32_bf16 v[44:47], a[16:19], v[108:111], 0
    ds_read_b64_tr_b16 a[44:45], v23 offset:16384
    ds_read_b64_tr_b16 a[46:47], v23 offset:16896
    s_waitcnt lgkmcnt(12)
    v_mfma_f32_16x16x32_bf16 v[48:51], a[20:23], v[108:111], 0
    ds_read_b64_tr_b16 a[48:49], v20 offset:4096
    ds_read_b64_tr_b16 a[50:51], v20 offset:4608
    s_waitcnt lgkmcnt(12)
    v_mfma_f32_16x16x32_bf16 v[52:55], a[24:27], v[108:111], 0
    ds_read_b64_tr_b16 a[52:53], v21 offset:4096
    ds_read_b64_tr_b16 a[54:55], v21 offset:4608
    s_waitcnt lgkmcnt(12)
    v_mfma_f32_16x16x32_bf16 v[56:59], a[28:31], v[108:111], 0
    ds_read_b64_tr_b16 a[56:57], v22 offset:4096
    ds_read_b64_tr_b16 a[58:59], v22 offset:4608
    s_waitcnt lgkmcnt(12)
    v_mfma_f32_16x16x32_bf16 v[60:63], v[108:111], a[32:35], 0
    ds_read_b64_tr_b16 a[60:61], v23 offset:4096
    ds_read_b64_tr_b16 a[62:63], v23 offset:4608
    s_waitcnt lgkmcnt(12)
    v_mfma_f32_16x16x32_bf16 v[64:67], v[108:111], a[36:39], 0
    ds_read_b64_tr_b16 a[64:65], v20 offset:12288
    ds_read_b64_tr_b16 a[66:67], v20 offset:12800
    s_waitcnt lgkmcnt(12)
    v_mfma_f32_16x16x32_bf16 v[68:71], v[108:111], a[40:43], 0
    ds_read_b64_tr_b16 a[68:69], v21 offset:12288
    ds_read_b64_tr_b16 a[70:71], v21 offset:12800
    s_waitcnt lgkmcnt(12)
    v_mfma_f32_16x16x32_bf16 v[72:75], v[108:111], a[44:47], 0
    ds_read_b64_tr_b16 a[72:73], v22 offset:12288
    ds_read_b64_tr_b16 a[74:75], v22 offset:12800
    s_waitcnt lgkmcnt(12)
    v_mfma_f32_16x16x32_bf16 v[28:31], a[48:51], v[112:115], v[28:31]
    ds_read_b64_tr_b16 a[76:77], v23 offset:12288
    ds_read_b64_tr_b16 a[78:79], v23 offset:12800
    s_waitcnt lgkmcnt(12)
    v_mfma_f32_16x16x32_bf16 v[32:35], a[52:55], v[112:115], v[32:35]
    ds_read_b64_tr_b16 a[80:81], v20 offset:20480
    ds_read_b64_tr_b16 a[82:83], v20 offset:20992
    s_waitcnt lgkmcnt(12)
    v_mfma_f32_16x16x32_bf16 v[36:39], a[56:59], v[112:115], v[36:39]
    ds_read_b64_tr_b16 a[84:85], v21 offset:20480
    ds_read_b64_tr_b16 a[86:87], v21 offset:20992
    s_waitcnt lgkmcnt(12)
    v_mfma_f32_16x16x32_bf16 v[40:43], a[60:63], v[112:115], v[40:43]
    ds_read_b64_tr_b16 a[88:89], v22 offset:20480
    ds_read_b64_tr_b16 a[90:91], v22 offset:20992
    s_waitcnt lgkmcnt(12)
    v_mfma_f32_16x16x32_bf16 v[44:47], a[64:67], v[112:115], v[44:47]
    ds_read_b64_tr_b16 a[92:93], v23 offset:20480
    ds_read_b64_tr_b16 a[94:95], v23 offset:20992
    s_waitcnt lgkmcnt(12)
    v_mfma_f32_16x16x32_bf16 v[48:51], a[68:71], v[112:115], v[48:51]
    s_waitcnt lgkmcnt(10)
    v_mfma_f32_16x16x32_bf16 v[52:55], a[72:75], v[112:115], v[52:55]
    s_waitcnt lgkmcnt(8)
    v_mfma_f32_16x16x32_bf16 v[56:59], a[76:79], v[112:115], v[56:59]
    s_waitcnt lgkmcnt(6)
    v_mfma_f32_16x16x32_bf16 v[60:63], v[112:115], a[80:83], v[60:63]
    s_waitcnt lgkmcnt(4)
    v_mfma_f32_16x16x32_bf16 v[64:67], v[112:115], a[84:87], v[64:67]
    s_waitcnt lgkmcnt(2)
    v_mfma_f32_16x16x32_bf16 v[68:71], v[112:115], a[88:91], v[68:71]
    s_waitcnt lgkmcnt(0)
    v_mfma_f32_16x16x32_bf16 v[72:75], v[112:115], a[92:95], v[72:75]
    s_waitcnt lgkmcnt(0)
    s_barrier
    ds_read_b128 v[108:111], v76 offset:39040
    ds_read_b128 v[112:115], v77 offset:39040
    ds_read_b64_tr_b16 a[0:1], v20 offset:39040
    ds_read_b64_tr_b16 a[2:3], v20 offset:39552
    ds_read_b64_tr_b16 a[4:5], v21 offset:39040
    ds_read_b64_tr_b16 a[6:7], v21 offset:39552
    ds_read_b64_tr_b16 a[8:9], v22 offset:39040
    ds_read_b64_tr_b16 a[10:11], v22 offset:39552
    ds_read_b64_tr_b16 a[12:13], v23 offset:39040
    ds_read_b64_tr_b16 a[14:15], v23 offset:39552
    ds_read_b64_tr_b16 a[16:17], v20 offset:47232
    ds_read_b64_tr_b16 a[18:19], v20 offset:47744
    ds_read_b64_tr_b16 a[20:21], v21 offset:47232
    ds_read_b64_tr_b16 a[22:23], v21 offset:47744
    ds_read_b64_tr_b16 a[24:25], v22 offset:47232
    ds_read_b64_tr_b16 a[26:27], v22 offset:47744
    s_waitcnt lgkmcnt(12)
    v_mfma_f32_16x16x32_bf16 v[28:31], a[0:3], v[108:111], v[28:31]
    ds_read_b64_tr_b16 a[28:29], v23 offset:47232
    ds_read_b64_tr_b16 a[30:31], v23 offset:47744
    s_waitcnt lgkmcnt(12)
    v_mfma_f32_16x16x32_bf16 v[32:35], a[4:7], v[108:111], v[32:35]
    ds_read_b64_tr_b16 a[32:33], v20 offset:55424
    ds_read_b64_tr_b16 a[34:35], v20 offset:55936
    s_waitcnt lgkmcnt(12)
    v_mfma_f32_16x16x32_bf16 v[36:39], a[8:11], v[108:111], v[36:39]
    ds_read_b64_tr_b16 a[36:37], v21 offset:55424
    ds_read_b64_tr_b16 a[38:39], v21 offset:55936
    s_waitcnt lgkmcnt(12)
    v_mfma_f32_16x16x32_bf16 v[40:43], a[12:15], v[108:111], v[40:43]
    ds_read_b64_tr_b16 a[40:41], v22 offset:55424
    ds_read_b64_tr_b16 a[42:43], v22 offset:55936
    s_waitcnt lgkmcnt(12)
    v_mfma_f32_16x16x32_bf16 v[44:47], a[16:19], v[108:111], v[44:47]
    ds_read_b64_tr_b16 a[44:45], v23 offset:55424
    ds_read_b64_tr_b16 a[46:47], v23 offset:55936
    s_waitcnt lgkmcnt(12)
    v_mfma_f32_16x16x32_bf16 v[48:51], a[20:23], v[108:111], v[48:51]
    ds_read_b64_tr_b16 a[48:49], v20 offset:43136
    ds_read_b64_tr_b16 a[50:51], v20 offset:43648
    s_waitcnt lgkmcnt(12)
    v_mfma_f32_16x16x32_bf16 v[52:55], a[24:27], v[108:111], v[52:55]
    ds_read_b64_tr_b16 a[52:53], v21 offset:43136
    ds_read_b64_tr_b16 a[54:55], v21 offset:43648
    s_waitcnt lgkmcnt(12)
    v_mfma_f32_16x16x32_bf16 v[56:59], a[28:31], v[108:111], v[56:59]
    ds_read_b64_tr_b16 a[56:57], v22 offset:43136
    ds_read_b64_tr_b16 a[58:59], v22 offset:43648
    s_waitcnt lgkmcnt(12)
    v_mfma_f32_16x16x32_bf16 v[60:63], v[108:111], a[32:35], v[60:63]
    ds_read_b64_tr_b16 a[60:61], v23 offset:43136
    ds_read_b64_tr_b16 a[62:63], v23 offset:43648
    s_waitcnt lgkmcnt(12)
    v_mfma_f32_16x16x32_bf16 v[64:67], v[108:111], a[36:39], v[64:67]
    ds_read_b64_tr_b16 a[64:65], v20 offset:51328
    ds_read_b64_tr_b16 a[66:67], v20 offset:51840
    s_waitcnt lgkmcnt(12)
    v_mfma_f32_16x16x32_bf16 v[68:71], v[108:111], a[40:43], v[68:71]
    ds_read_b64_tr_b16 a[68:69], v21 offset:51328
    ds_read_b64_tr_b16 a[70:71], v21 offset:51840
    s_waitcnt lgkmcnt(12)
    v_mfma_f32_16x16x32_bf16 v[72:75], v[108:111], a[44:47], v[72:75]
    ds_read_b64_tr_b16 a[72:73], v22 offset:51328
    ds_read_b64_tr_b16 a[74:75], v22 offset:51840
    s_waitcnt lgkmcnt(12)
    v_mfma_f32_16x16x32_bf16 v[28:31], a[48:51], v[112:115], v[28:31]
    ds_read_b64_tr_b16 a[76:77], v23 offset:51328
    ds_read_b64_tr_b16 a[78:79], v23 offset:51840
    s_waitcnt lgkmcnt(12)
    v_mfma_f32_16x16x32_bf16 v[32:35], a[52:55], v[112:115], v[32:35]
    ds_read_b64_tr_b16 a[80:81], v20 offset:59520
    ds_read_b64_tr_b16 a[82:83], v20 offset:60032
    s_waitcnt lgkmcnt(12)
    v_mfma_f32_16x16x32_bf16 v[36:39], a[56:59], v[112:115], v[36:39]
    ds_read_b64_tr_b16 a[84:85], v21 offset:59520
    ds_read_b64_tr_b16 a[86:87], v21 offset:60032
    s_waitcnt lgkmcnt(12)
    v_mfma_f32_16x16x32_bf16 v[40:43], a[60:63], v[112:115], v[40:43]
    ds_read_b64_tr_b16 a[88:89], v22 offset:59520
    ds_read_b64_tr_b16 a[90:91], v22 offset:60032
    s_waitcnt lgkmcnt(12)
    v_mfma_f32_16x16x32_bf16 v[44:47], a[64:67], v[112:115], v[44:47]
    ds_read_b64_tr_b16 a[92:93], v23 offset:59520
    ds_read_b64_tr_b16 a[94:95], v23 offset:60032
    s_waitcnt lgkmcnt(12)
    v_mfma_f32_16x16x32_bf16 v[48:51], a[68:71], v[112:115], v[48:51]
    s_waitcnt lgkmcnt(10)
    v_mfma_f32_16x16x32_bf16 v[52:55], a[72:75], v[112:115], v[52:55]
    s_waitcnt lgkmcnt(8)
    v_mfma_f32_16x16x32_bf16 v[56:59], a[76:79], v[112:115], v[56:59]
    s_waitcnt lgkmcnt(6)
    v_mfma_f32_16x16x32_bf16 v[60:63], v[112:115], a[80:83], v[60:63]
    s_waitcnt lgkmcnt(4)
    v_mfma_f32_16x16x32_bf16 v[64:67], v[112:115], a[84:87], v[64:67]
    s_waitcnt lgkmcnt(2)
    v_mfma_f32_16x16x32_bf16 v[68:71], v[112:115], a[88:91], v[68:71]
    s_waitcnt lgkmcnt(0)
    v_mfma_f32_16x16x32_bf16 v[72:75], v[112:115], a[92:95], v[72:75]
    s_mov_b64 exec, 1
    s_lshl_b32 s40, s2, 2
    s_add_u32 s40, s40, 8323072
    v_mov_b32 v4, s38
    v_mov_b32 v5, s40
    buffer_store_dword v4, v5, s[28:31], 0 offen sc1
    s_mov_b64 exec, -1
    s_waitcnt lgkmcnt(0)
    s_barrier
    ds_read_b128 v[108:111], v80 offset:0
    ds_read_b128 v[112:115], v81 offset:0
    ds_read_b64_tr_b16 a[0:1], v24 offset:0
    ds_read_b64_tr_b16 a[2:3], v24 offset:512
    ds_read_b64_tr_b16 a[4:5], v25 offset:0
    ds_read_b64_tr_b16 a[6:7], v25 offset:512
    ds_read_b64_tr_b16 a[8:9], v26 offset:0
    ds_read_b64_tr_b16 a[10:11], v26 offset:512
    ds_read_b64_tr_b16 a[12:13], v27 offset:0
    ds_read_b64_tr_b16 a[14:15], v27 offset:512
    ds_read_b64_tr_b16 a[16:17], v24 offset:8192
    ds_read_b64_tr_b16 a[18:19], v24 offset:8704
    ds_read_b64_tr_b16 a[20:21], v25 offset:8192
    ds_read_b64_tr_b16 a[22:23], v25 offset:8704
    ds_read_b64_tr_b16 a[24:25], v26 offset:8192
    ds_read_b64_tr_b16 a[26:27], v26 offset:8704
    s_waitcnt lgkmcnt(12)
    v_mfma_f32_16x16x32_bf16 v[28:31], a[0:3], v[108:111], v[28:31]
    ds_read_b64_tr_b16 a[28:29], v27 offset:8192
    ds_read_b64_tr_b16 a[30:31], v27 offset:8704
    s_waitcnt lgkmcnt(12)
    v_mfma_f32_16x16x32_bf16 v[32:35], a[4:7], v[108:111], v[32:35]
    ds_read_b64_tr_b16 a[32:33], v24 offset:16384
    ds_read_b64_tr_b16 a[34:35], v24 offset:16896
    s_waitcnt lgkmcnt(12)
    v_mfma_f32_16x16x32_bf16 v[36:39], a[8:11], v[108:111], v[36:39]
    ds_read_b64_tr_b16 a[36:37], v25 offset:16384
    ds_read_b64_tr_b16 a[38:39], v25 offset:16896
    s_waitcnt lgkmcnt(12)
    v_mfma_f32_16x16x32_bf16 v[40:43], a[12:15], v[108:111], v[40:43]
    ds_read_b64_tr_b16 a[40:41], v26 offset:16384
    ds_read_b64_tr_b16 a[42:43], v26 offset:16896
    s_waitcnt lgkmcnt(12)
    v_mfma_f32_16x16x32_bf16 v[44:47], a[16:19], v[108:111], v[44:47]
    ds_read_b64_tr_b16 a[44:45], v27 offset:16384
    ds_read_b64_tr_b16 a[46:47], v27 offset:16896
    s_waitcnt lgkmcnt(12)
    v_mfma_f32_16x16x32_bf16 v[48:51], a[20:23], v[108:111], v[48:51]
    ds_read_b64_tr_b16 a[48:49], v24 offset:4096
    ds_read_b64_tr_b16 a[50:51], v24 offset:4608
    s_waitcnt lgkmcnt(12)
    v_mfma_f32_16x16x32_bf16 v[52:55], a[24:27], v[108:111], v[52:55]
    ds_read_b64_tr_b16 a[52:53], v25 offset:4096
    ds_read_b64_tr_b16 a[54:55], v25 offset:4608
    s_waitcnt lgkmcnt(12)
    v_mfma_f32_16x16x32_bf16 v[56:59], a[28:31], v[108:111], v[56:59]
    ds_read_b64_tr_b16 a[56:57], v26 offset:4096
    ds_read_b64_tr_b16 a[58:59], v26 offset:4608
    s_waitcnt lgkmcnt(12)
    v_mfma_f32_16x16x32_bf16 v[60:63], v[108:111], a[32:35], v[60:63]
    ds_read_b64_tr_b16 a[60:61], v27 offset:4096
    ds_read_b64_tr_b16 a[62:63], v27 offset:4608
    s_waitcnt lgkmcnt(12)
    v_mfma_f32_16x16x32_bf16 v[64:67], v[108:111], a[36:39], v[64:67]
    ds_read_b64_tr_b16 a[64:65], v24 offset:12288
    ds_read_b64_tr_b16 a[66:67], v24 offset:12800
    s_waitcnt lgkmcnt(12)
    v_mfma_f32_16x16x32_bf16 v[68:71], v[108:111], a[40:43], v[68:71]
    ds_read_b64_tr_b16 a[68:69], v25 offset:12288
    ds_read_b64_tr_b16 a[70:71], v25 offset:12800
    s_waitcnt lgkmcnt(12)
    v_mfma_f32_16x16x32_bf16 v[72:75], v[108:111], a[44:47], v[72:75]
    ds_read_b64_tr_b16 a[72:73], v26 offset:12288
    ds_read_b64_tr_b16 a[74:75], v26 offset:12800
    s_waitcnt lgkmcnt(12)
    v_mfma_f32_16x16x32_bf16 v[28:31], a[48:51], v[112:115], v[28:31]
    ds_read_b64_tr_b16 a[76:77], v27 offset:12288
    ds_read_b64_tr_b16 a[78:79], v27 offset:12800
    s_waitcnt lgkmcnt(12)
    v_mfma_f32_16x16x32_bf16 v[32:35], a[52:55], v[112:115], v[32:35]
    ds_read_b64_tr_b16 a[80:81], v24 offset:20480
    ds_read_b64_tr_b16 a[82:83], v24 offset:20992
    s_waitcnt lgkmcnt(12)
    v_mfma_f32_16x16x32_bf16 v[36:39], a[56:59], v[112:115], v[36:39]
    ds_read_b64_tr_b16 a[84:85], v25 offset:20480
    ds_read_b64_tr_b16 a[86:87], v25 offset:20992
    s_waitcnt lgkmcnt(12)
    v_mfma_f32_16x16x32_bf16 v[40:43], a[60:63], v[112:115], v[40:43]
    ds_read_b64_tr_b16 a[88:89], v26 offset:20480
    ds_read_b64_tr_b16 a[90:91], v26 offset:20992
    s_waitcnt lgkmcnt(12)
    v_mfma_f32_16x16x32_bf16 v[44:47], a[64:67], v[112:115], v[44:47]
    ds_read_b64_tr_b16 a[92:93], v27 offset:20480
    ds_read_b64_tr_b16 a[94:95], v27 offset:20992
    s_waitcnt lgkmcnt(12)
    v_mfma_f32_16x16x32_bf16 v[48:51], a[68:71], v[112:115], v[48:51]
    s_waitcnt lgkmcnt(10)
    v_mfma_f32_16x16x32_bf16 v[52:55], a[72:75], v[112:115], v[52:55]
    s_waitcnt lgkmcnt(8)
    v_mfma_f32_16x16x32_bf16 v[56:59], a[76:79], v[112:115], v[56:59]
    s_waitcnt lgkmcnt(6)
    v_mfma_f32_16x16x32_bf16 v[60:63], v[112:115], a[80:83], v[60:63]
    s_waitcnt lgkmcnt(4)
    v_mfma_f32_16x16x32_bf16 v[64:67], v[112:115], a[84:87], v[64:67]
    s_waitcnt lgkmcnt(2)
    v_mfma_f32_16x16x32_bf16 v[68:71], v[112:115], a[88:91], v[68:71]
    s_waitcnt lgkmcnt(0)
    v_mfma_f32_16x16x32_bf16 v[72:75], v[112:115], a[92:95], v[72:75]
    s_waitcnt lgkmcnt(0)
    s_barrier
    ds_read_b128 v[108:111], v80 offset:39040
    ds_read_b128 v[112:115], v81 offset:39040
    ds_read_b64_tr_b16 a[0:1], v24 offset:39040
    ds_read_b64_tr_b16 a[2:3], v24 offset:39552
    ds_read_b64_tr_b16 a[4:5], v25 offset:39040
    ds_read_b64_tr_b16 a[6:7], v25 offset:39552
    ds_read_b64_tr_b16 a[8:9], v26 offset:39040
    ds_read_b64_tr_b16 a[10:11], v26 offset:39552
    ds_read_b64_tr_b16 a[12:13], v27 offset:39040
    ds_read_b64_tr_b16 a[14:15], v27 offset:39552
    ds_read_b64_tr_b16 a[16:17], v24 offset:47232
    ds_read_b64_tr_b16 a[18:19], v24 offset:47744
    ds_read_b64_tr_b16 a[20:21], v25 offset:47232
    ds_read_b64_tr_b16 a[22:23], v25 offset:47744
    ds_read_b64_tr_b16 a[24:25], v26 offset:47232
    ds_read_b64_tr_b16 a[26:27], v26 offset:47744
    s_waitcnt lgkmcnt(12)
    v_mfma_f32_16x16x32_bf16 v[28:31], a[0:3], v[108:111], v[28:31]
    ds_read_b64_tr_b16 a[28:29], v27 offset:47232
    ds_read_b64_tr_b16 a[30:31], v27 offset:47744
    s_waitcnt lgkmcnt(12)
    v_mfma_f32_16x16x32_bf16 v[32:35], a[4:7], v[108:111], v[32:35]
    ds_read_b64_tr_b16 a[32:33], v24 offset:55424
    ds_read_b64_tr_b16 a[34:35], v24 offset:55936
    s_waitcnt lgkmcnt(12)
    v_mfma_f32_16x16x32_bf16 v[36:39], a[8:11], v[108:111], v[36:39]
    ds_read_b64_tr_b16 a[36:37], v25 offset:55424
    ds_read_b64_tr_b16 a[38:39], v25 offset:55936
    s_waitcnt lgkmcnt(12)
    v_mfma_f32_16x16x32_bf16 v[40:43], a[12:15], v[108:111], v[40:43]
    ds_read_b64_tr_b16 a[40:41], v26 offset:55424
    ds_read_b64_tr_b16 a[42:43], v26 offset:55936
    s_waitcnt lgkmcnt(12)
    v_mfma_f32_16x16x32_bf16 v[44:47], a[16:19], v[108:111], v[44:47]
    ds_read_b64_tr_b16 a[44:45], v27 offset:55424
    ds_read_b64_tr_b16 a[46:47], v27 offset:55936
    s_waitcnt lgkmcnt(12)
    v_mfma_f32_16x16x32_bf16 v[48:51], a[20:23], v[108:111], v[48:51]
    ds_read_b64_tr_b16 a[48:49], v24 offset:43136
    ds_read_b64_tr_b16 a[50:51], v24 offset:43648
    s_waitcnt lgkmcnt(12)
    v_mfma_f32_16x16x32_bf16 v[52:55], a[24:27], v[108:111], v[52:55]
    ds_read_b64_tr_b16 a[52:53], v25 offset:43136
    ds_read_b64_tr_b16 a[54:55], v25 offset:43648
    s_waitcnt lgkmcnt(12)
    v_mfma_f32_16x16x32_bf16 v[56:59], a[28:31], v[108:111], v[56:59]
    ds_read_b64_tr_b16 a[56:57], v26 offset:43136
    ds_read_b64_tr_b16 a[58:59], v26 offset:43648
    s_waitcnt lgkmcnt(12)
    v_mfma_f32_16x16x32_bf16 v[60:63], v[108:111], a[32:35], v[60:63]
    ds_read_b64_tr_b16 a[60:61], v27 offset:43136
    ds_read_b64_tr_b16 a[62:63], v27 offset:43648
    s_waitcnt lgkmcnt(12)
    v_mfma_f32_16x16x32_bf16 v[64:67], v[108:111], a[36:39], v[64:67]
    ds_read_b64_tr_b16 a[64:65], v24 offset:51328
    ds_read_b64_tr_b16 a[66:67], v24 offset:51840
    s_waitcnt lgkmcnt(12)
    v_mfma_f32_16x16x32_bf16 v[68:71], v[108:111], a[40:43], v[68:71]
    ds_read_b64_tr_b16 a[68:69], v25 offset:51328
    ds_read_b64_tr_b16 a[70:71], v25 offset:51840
    s_waitcnt lgkmcnt(12)
    v_mfma_f32_16x16x32_bf16 v[72:75], v[108:111], a[44:47], v[72:75]
    ds_read_b64_tr_b16 a[72:73], v26 offset:51328
    ds_read_b64_tr_b16 a[74:75], v26 offset:51840
    s_waitcnt lgkmcnt(12)
    v_mfma_f32_16x16x32_bf16 v[28:31], a[48:51], v[112:115], v[28:31]
    ds_read_b64_tr_b16 a[76:77], v27 offset:51328
    ds_read_b64_tr_b16 a[78:79], v27 offset:51840
    s_waitcnt lgkmcnt(12)
    v_mfma_f32_16x16x32_bf16 v[32:35], a[52:55], v[112:115], v[32:35]
    ds_read_b64_tr_b16 a[80:81], v24 offset:59520
    ds_read_b64_tr_b16 a[82:83], v24 offset:60032
    s_waitcnt lgkmcnt(12)
    v_mfma_f32_16x16x32_bf16 v[36:39], a[56:59], v[112:115], v[36:39]
    ds_read_b64_tr_b16 a[84:85], v25 offset:59520
    ds_read_b64_tr_b16 a[86:87], v25 offset:60032
    s_waitcnt lgkmcnt(12)
    v_mfma_f32_16x16x32_bf16 v[40:43], a[60:63], v[112:115], v[40:43]
    ds_read_b64_tr_b16 a[88:89], v26 offset:59520
    ds_read_b64_tr_b16 a[90:91], v26 offset:60032
    s_waitcnt lgkmcnt(12)
    v_mfma_f32_16x16x32_bf16 v[44:47], a[64:67], v[112:115], v[44:47]
    ds_read_b64_tr_b16 a[92:93], v27 offset:59520
    ds_read_b64_tr_b16 a[94:95], v27 offset:60032
    s_waitcnt lgkmcnt(12)
    v_mfma_f32_16x16x32_bf16 v[48:51], a[68:71], v[112:115], v[48:51]
    s_waitcnt lgkmcnt(10)
    v_mfma_f32_16x16x32_bf16 v[52:55], a[72:75], v[112:115], v[52:55]
    s_waitcnt lgkmcnt(8)
    v_mfma_f32_16x16x32_bf16 v[56:59], a[76:79], v[112:115], v[56:59]
    s_waitcnt lgkmcnt(6)
    v_mfma_f32_16x16x32_bf16 v[60:63], v[112:115], a[80:83], v[60:63]
    s_waitcnt lgkmcnt(4)
    v_mfma_f32_16x16x32_bf16 v[64:67], v[112:115], a[84:87], v[64:67]
    s_waitcnt lgkmcnt(2)
    v_mfma_f32_16x16x32_bf16 v[68:71], v[112:115], a[88:91], v[68:71]
    s_waitcnt lgkmcnt(0)
    v_mfma_f32_16x16x32_bf16 v[72:75], v[112:115], a[92:95], v[72:75]
    s_waitcnt lgkmcnt(0)
    s_barrier
    ds_read_b128 v[108:111], v76 offset:0
    ds_read_b128 v[112:115], v77 offset:0
    ds_read_b64_tr_b16 a[0:1], v20 offset:0
    ds_read_b64_tr_b16 a[2:3], v20 offset:512
    ds_read_b64_tr_b16 a[4:5], v21 offset:0
    ds_read_b64_tr_b16 a[6:7], v21 offset:512
    ds_read_b64_tr_b16 a[8:9], v22 offset:0
    ds_read_b64_tr_b16 a[10:11], v22 offset:512
    ds_read_b64_tr_b16 a[12:13], v23 offset:0
    ds_read_b64_tr_b16 a[14:15], v23 offset:512
    ds_read_b64_tr_b16 a[16:17], v20 offset:8192
    ds_read_b64_tr_b16 a[18:19], v20 offset:8704
    ds_read_b64_tr_b16 a[20:21], v21 offset:8192
    ds_read_b64_tr_b16 a[22:23], v21 offset:8704
    ds_read_b64_tr_b16 a[24:25], v22 offset:8192
    ds_read_b64_tr_b16 a[26:27], v22 offset:8704
    s_waitcnt lgkmcnt(12)
    v_mfma_f32_16x16x32_bf16 v[28:31], a[0:3], v[108:111], v[28:31]
    ds_read_b64_tr_b16 a[28:29], v23 offset:8192
    ds_read_b64_tr_b16 a[30:31], v23 offset:8704
    s_waitcnt lgkmcnt(12)
    v_mfma_f32_16x16x32_bf16 v[32:35], a[4:7], v[108:111], v[32:35]
    ds_read_b64_tr_b16 a[32:33], v20 offset:16384
    ds_read_b64_tr_b16 a[34:35], v20 offset:16896
    s_waitcnt lgkmcnt(12)
    v_mfma_f32_16x16x32_bf16 v[36:39], a[8:11], v[108:111], v[36:39]
    ds_read_b64_tr_b16 a[36:37], v21 offset:16384
    ds_read_b64_tr_b16 a[38:39], v21 offset:16896
    s_waitcnt lgkmcnt(12)
    v_mfma_f32_16x16x32_bf16 v[40:43], a[12:15], v[108:111], v[40:43]
    ds_read_b64_tr_b16 a[40:41], v22 offset:16384
    ds_read_b64_tr_b16 a[42:43], v22 offset:16896
    s_waitcnt lgkmcnt(12)
    v_mfma_f32_16x16x32_bf16 v[44:47], a[16:19], v[108:111], v[44:47]
    ds_read_b64_tr_b16 a[44:45], v23 offset:16384
    ds_read_b64_tr_b16 a[46:47], v23 offset:16896
    s_waitcnt lgkmcnt(12)
    v_mfma_f32_16x16x32_bf16 v[48:51], a[20:23], v[108:111], v[48:51]
    ds_read_b64_tr_b16 a[48:49], v20 offset:4096
    ds_read_b64_tr_b16 a[50:51], v20 offset:4608
    s_waitcnt lgkmcnt(12)
    v_mfma_f32_16x16x32_bf16 v[52:55], a[24:27], v[108:111], v[52:55]
    ds_read_b64_tr_b16 a[52:53], v21 offset:4096
    ds_read_b64_tr_b16 a[54:55], v21 offset:4608
    s_waitcnt lgkmcnt(12)
    v_mfma_f32_16x16x32_bf16 v[56:59], a[28:31], v[108:111], v[56:59]
    ds_read_b64_tr_b16 a[56:57], v22 offset:4096
    ds_read_b64_tr_b16 a[58:59], v22 offset:4608
    s_waitcnt lgkmcnt(12)
    v_mfma_f32_16x16x32_bf16 v[60:63], v[108:111], a[32:35], v[60:63]
    ds_read_b64_tr_b16 a[60:61], v23 offset:4096
    ds_read_b64_tr_b16 a[62:63], v23 offset:4608
    s_waitcnt lgkmcnt(12)
    v_mfma_f32_16x16x32_bf16 v[64:67], v[108:111], a[36:39], v[64:67]
    ds_read_b64_tr_b16 a[64:65], v20 offset:12288
    ds_read_b64_tr_b16 a[66:67], v20 offset:12800
    s_waitcnt lgkmcnt(12)
    v_mfma_f32_16x16x32_bf16 v[68:71], v[108:111], a[40:43], v[68:71]
    ds_read_b64_tr_b16 a[68:69], v21 offset:12288
    ds_read_b64_tr_b16 a[70:71], v21 offset:12800
    s_waitcnt lgkmcnt(12)
    v_mfma_f32_16x16x32_bf16 v[72:75], v[108:111], a[44:47], v[72:75]
    ds_read_b64_tr_b16 a[72:73], v22 offset:12288
    ds_read_b64_tr_b16 a[74:75], v22 offset:12800
    s_waitcnt lgkmcnt(12)
    v_mfma_f32_16x16x32_bf16 v[28:31], a[48:51], v[112:115], v[28:31]
    ds_read_b64_tr_b16 a[76:77], v23 offset:12288
    ds_read_b64_tr_b16 a[78:79], v23 offset:12800
    s_waitcnt lgkmcnt(12)
    v_mfma_f32_16x16x32_bf16 v[32:35], a[52:55], v[112:115], v[32:35]
    ds_read_b64_tr_b16 a[80:81], v20 offset:20480
    ds_read_b64_tr_b16 a[82:83], v20 offset:20992
    s_waitcnt lgkmcnt(12)
    v_mfma_f32_16x16x32_bf16 v[36:39], a[56:59], v[112:115], v[36:39]
    ds_read_b64_tr_b16 a[84:85], v21 offset:20480
    ds_read_b64_tr_b16 a[86:87], v21 offset:20992
    s_waitcnt lgkmcnt(12)
    v_mfma_f32_16x16x32_bf16 v[40:43], a[60:63], v[112:115], v[40:43]
    ds_read_b64_tr_b16 a[88:89], v22 offset:20480
    ds_read_b64_tr_b16 a[90:91], v22 offset:20992
    s_waitcnt lgkmcnt(12)
    v_mfma_f32_16x16x32_bf16 v[44:47], a[64:67], v[112:115], v[44:47]
    ds_read_b64_tr_b16 a[92:93], v23 offset:20480
    ds_read_b64_tr_b16 a[94:95], v23 offset:20992
    s_waitcnt lgkmcnt(12)
    v_mfma_f32_16x16x32_bf16 v[48:51], a[68:71], v[112:115], v[48:51]
    s_waitcnt lgkmcnt(10)
    v_mfma_f32_16x16x32_bf16 v[52:55], a[72:75], v[112:115], v[52:55]
    s_waitcnt lgkmcnt(8)
    v_mfma_f32_16x16x32_bf16 v[56:59], a[76:79], v[112:115], v[56:59]
    s_waitcnt lgkmcnt(6)
    v_mfma_f32_16x16x32_bf16 v[60:63], v[112:115], a[80:83], v[60:63]
    s_waitcnt lgkmcnt(4)
    v_mfma_f32_16x16x32_bf16 v[64:67], v[112:115], a[84:87], v[64:67]
    s_waitcnt lgkmcnt(2)
    v_mfma_f32_16x16x32_bf16 v[68:71], v[112:115], a[88:91], v[68:71]
    s_waitcnt lgkmcnt(0)
    v_mfma_f32_16x16x32_bf16 v[72:75], v[112:115], a[92:95], v[72:75]
    s_waitcnt lgkmcnt(0)
    s_barrier
    ds_read_b128 v[108:111], v76 offset:39040
    ds_read_b128 v[112:115], v77 offset:39040
    ds_read_b64_tr_b16 a[0:1], v20 offset:39040
    ds_read_b64_tr_b16 a[2:3], v20 offset:39552
    ds_read_b64_tr_b16 a[4:5], v21 offset:39040
    ds_read_b64_tr_b16 a[6:7], v21 offset:39552
    ds_read_b64_tr_b16 a[8:9], v22 offset:39040
    ds_read_b64_tr_b16 a[10:11], v22 offset:39552
    ds_read_b64_tr_b16 a[12:13], v23 offset:39040
    ds_read_b64_tr_b16 a[14:15], v23 offset:39552
    ds_read_b64_tr_b16 a[16:17], v20 offset:47232
    ds_read_b64_tr_b16 a[18:19], v20 offset:47744
    ds_read_b64_tr_b16 a[20:21], v21 offset:47232
    ds_read_b64_tr_b16 a[22:23], v21 offset:47744
    ds_read_b64_tr_b16 a[24:25], v22 offset:47232
    ds_read_b64_tr_b16 a[26:27], v22 offset:47744
    s_waitcnt lgkmcnt(12)
    v_mfma_f32_16x16x32_bf16 v[28:31], a[0:3], v[108:111], v[28:31]
    ds_read_b64_tr_b16 a[28:29], v23 offset:47232
    ds_read_b64_tr_b16 a[30:31], v23 offset:47744
    s_waitcnt lgkmcnt(12)
    v_mfma_f32_16x16x32_bf16 v[32:35], a[4:7], v[108:111], v[32:35]
    ds_read_b64_tr_b16 a[32:33], v20 offset:55424
    ds_read_b64_tr_b16 a[34:35], v20 offset:55936
    s_waitcnt lgkmcnt(12)
    v_mfma_f32_16x16x32_bf16 v[36:39], a[8:11], v[108:111], v[36:39]
    ds_read_b64_tr_b16 a[36:37], v21 offset:55424
    ds_read_b64_tr_b16 a[38:39], v21 offset:55936
    s_waitcnt lgkmcnt(12)
    v_mfma_f32_16x16x32_bf16 v[40:43], a[12:15], v[108:111], v[40:43]
    ds_read_b64_tr_b16 a[40:41], v22 offset:55424
    ds_read_b64_tr_b16 a[42:43], v22 offset:55936
    s_waitcnt lgkmcnt(12)
    v_mfma_f32_16x16x32_bf16 v[44:47], a[16:19], v[108:111], v[44:47]
    ds_read_b64_tr_b16 a[44:45], v23 offset:55424
    ds_read_b64_tr_b16 a[46:47], v23 offset:55936
    s_waitcnt lgkmcnt(12)
    v_mfma_f32_16x16x32_bf16 v[48:51], a[20:23], v[108:111], v[48:51]
    ds_read_b64_tr_b16 a[48:49], v20 offset:43136
    ds_read_b64_tr_b16 a[50:51], v20 offset:43648
    s_waitcnt lgkmcnt(12)
    v_mfma_f32_16x16x32_bf16 v[52:55], a[24:27], v[108:111], v[52:55]
    ds_read_b64_tr_b16 a[52:53], v21 offset:43136
    ds_read_b64_tr_b16 a[54:55], v21 offset:43648
    s_waitcnt lgkmcnt(12)
    v_mfma_f32_16x16x32_bf16 v[56:59], a[28:31], v[108:111], v[56:59]
    ds_read_b64_tr_b16 a[56:57], v22 offset:43136
    ds_read_b64_tr_b16 a[58:59], v22 offset:43648
    s_waitcnt lgkmcnt(12)
    v_mfma_f32_16x16x32_bf16 v[60:63], v[108:111], a[32:35], v[60:63]
    ds_read_b64_tr_b16 a[60:61], v23 offset:43136
    ds_read_b64_tr_b16 a[62:63], v23 offset:43648
    s_waitcnt lgkmcnt(12)
    v_mfma_f32_16x16x32_bf16 v[64:67], v[108:111], a[36:39], v[64:67]
    ds_read_b64_tr_b16 a[64:65], v20 offset:51328
    ds_read_b64_tr_b16 a[66:67], v20 offset:51840
    s_waitcnt lgkmcnt(12)
    v_mfma_f32_16x16x32_bf16 v[68:71], v[108:111], a[40:43], v[68:71]
    ds_read_b64_tr_b16 a[68:69], v21 offset:51328
    ds_read_b64_tr_b16 a[70:71], v21 offset:51840
    s_waitcnt lgkmcnt(12)
    v_mfma_f32_16x16x32_bf16 v[72:75], v[108:111], a[44:47], v[72:75]
    ds_read_b64_tr_b16 a[72:73], v22 offset:51328
    ds_read_b64_tr_b16 a[74:75], v22 offset:51840
    s_waitcnt lgkmcnt(12)
    v_mfma_f32_16x16x32_bf16 v[28:31], a[48:51], v[112:115], v[28:31]
    ds_read_b64_tr_b16 a[76:77], v23 offset:51328
    ds_read_b64_tr_b16 a[78:79], v23 offset:51840
    s_waitcnt lgkmcnt(12)
    v_mfma_f32_16x16x32_bf16 v[32:35], a[52:55], v[112:115], v[32:35]
    ds_read_b64_tr_b16 a[80:81], v20 offset:59520
    ds_read_b64_tr_b16 a[82:83], v20 offset:60032
    s_waitcnt lgkmcnt(12)
    v_mfma_f32_16x16x32_bf16 v[36:39], a[56:59], v[112:115], v[36:39]
    ds_read_b64_tr_b16 a[84:85], v21 offset:59520
    ds_read_b64_tr_b16 a[86:87], v21 offset:60032
    s_waitcnt lgkmcnt(12)
    v_mfma_f32_16x16x32_bf16 v[40:43], a[60:63], v[112:115], v[40:43]
    ds_read_b64_tr_b16 a[88:89], v22 offset:59520
    ds_read_b64_tr_b16 a[90:91], v22 offset:60032
    s_waitcnt lgkmcnt(12)
    v_mfma_f32_16x16x32_bf16 v[44:47], a[64:67], v[112:115], v[44:47]
    ds_read_b64_tr_b16 a[92:93], v23 offset:59520
    ds_read_b64_tr_b16 a[94:95], v23 offset:60032
    s_waitcnt lgkmcnt(12)
    v_mfma_f32_16x16x32_bf16 v[48:51], a[68:71], v[112:115], v[48:51]
    s_waitcnt lgkmcnt(10)
    v_mfma_f32_16x16x32_bf16 v[52:55], a[72:75], v[112:115], v[52:55]
    s_waitcnt lgkmcnt(8)
    v_mfma_f32_16x16x32_bf16 v[56:59], a[76:79], v[112:115], v[56:59]
    s_waitcnt lgkmcnt(6)
    v_mfma_f32_16x16x32_bf16 v[60:63], v[112:115], a[80:83], v[60:63]
    s_waitcnt lgkmcnt(4)
    v_mfma_f32_16x16x32_bf16 v[64:67], v[112:115], a[84:87], v[64:67]
    s_waitcnt lgkmcnt(2)
    v_mfma_f32_16x16x32_bf16 v[68:71], v[112:115], a[88:91], v[68:71]
    s_waitcnt lgkmcnt(0)
    v_mfma_f32_16x16x32_bf16 v[72:75], v[112:115], a[92:95], v[72:75]
    s_waitcnt lgkmcnt(0)
    s_barrier
    ds_read_b128 a[96:99], v80 offset:0
    ds_read_b128 a[100:103], v81 offset:0
    ds_read_b64_tr_b16 a[0:1], v24 offset:0
    ds_read_b64_tr_b16 a[2:3], v24 offset:512
    ds_read_b64_tr_b16 a[4:5], v25 offset:0
    ds_read_b64_tr_b16 a[6:7], v25 offset:512
    ds_read_b64_tr_b16 a[8:9], v26 offset:0
    ds_read_b64_tr_b16 a[10:11], v26 offset:512
    ds_read_b64_tr_b16 a[12:13], v27 offset:0
    ds_read_b64_tr_b16 a[14:15], v27 offset:512
    ds_read_b64_tr_b16 a[16:17], v24 offset:8192
    ds_read_b64_tr_b16 a[18:19], v24 offset:8704
    ds_read_b64_tr_b16 a[20:21], v25 offset:8192
    ds_read_b64_tr_b16 a[22:23], v25 offset:8704
    ds_read_b64_tr_b16 a[24:25], v26 offset:8192
    ds_read_b64_tr_b16 a[26:27], v26 offset:8704
    s_waitcnt lgkmcnt(12)
    v_mfma_f32_16x16x32_bf16 v[28:31], a[0:3], a[96:99], v[28:31]
    ds_read_b64_tr_b16 a[28:29], v27 offset:8192
    ds_read_b64_tr_b16 a[30:31], v27 offset:8704
    s_waitcnt lgkmcnt(12)
    v_mfma_f32_16x16x32_bf16 v[32:35], a[4:7], a[96:99], v[32:35]
    ds_read_b64_tr_b16 a[48:49], v24 offset:4096
    ds_read_b64_tr_b16 a[50:51], v24 offset:4608
    s_waitcnt lgkmcnt(12)
    v_mfma_f32_16x16x32_bf16 v[36:39], a[8:11], a[96:99], v[36:39]
    ds_read_b64_tr_b16 a[52:53], v25 offset:4096
    ds_read_b64_tr_b16 a[54:55], v25 offset:4608
    s_waitcnt lgkmcnt(12)
    v_mfma_f32_16x16x32_bf16 v[40:43], a[12:15], a[96:99], v[40:43]
    ds_read_b64_tr_b16 a[56:57], v26 offset:4096
    ds_read_b64_tr_b16 a[58:59], v26 offset:4608
    s_waitcnt lgkmcnt(12)
    v_mfma_f32_16x16x32_bf16 v[44:47], a[16:19], a[96:99], v[44:47]
    ds_read_b64_tr_b16 a[60:61], v27 offset:4096
    ds_read_b64_tr_b16 a[62:63], v27 offset:4608
    s_waitcnt lgkmcnt(12)
    v_mfma_f32_16x16x32_bf16 v[48:51], a[20:23], a[96:99], v[48:51]
    ds_read_b64_tr_b16 a[64:65], v24 offset:12288
    ds_read_b64_tr_b16 a[66:67], v24 offset:12800
    s_waitcnt lgkmcnt(12)
    v_mfma_f32_16x16x32_bf16 v[52:55], a[24:27], a[96:99], v[52:55]
    ds_read_b64_tr_b16 a[68:69], v25 offset:12288
    ds_read_b64_tr_b16 a[70:71], v25 offset:12800
    s_waitcnt lgkmcnt(12)
    v_mfma_f32_16x16x32_bf16 v[56:59], a[28:31], a[96:99], v[56:59]
    ds_read_b64_tr_b16 a[72:73], v26 offset:12288
    ds_read_b64_tr_b16 a[74:75], v26 offset:12800
    s_waitcnt lgkmcnt(12)
    v_mfma_f32_16x16x32_bf16 v[28:31], a[48:51], a[100:103], v[28:31]
    ds_read_b64_tr_b16 a[76:77], v27 offset:12288
    ds_read_b64_tr_b16 a[78:79], v27 offset:12800
    s_waitcnt lgkmcnt(12)
    v_mfma_f32_16x16x32_bf16 v[32:35], a[52:55], a[100:103], v[32:35]
    s_waitcnt lgkmcnt(10)
    v_mfma_f32_16x16x32_bf16 v[36:39], a[56:59], a[100:103], v[36:39]
    s_waitcnt lgkmcnt(8)
    v_mfma_f32_16x16x32_bf16 v[40:43], a[60:63], a[100:103], v[40:43]
    s_waitcnt lgkmcnt(6)
    v_mfma_f32_16x16x32_bf16 v[44:47], a[64:67], a[100:103], v[44:47]
    s_waitcnt lgkmcnt(4)
    v_mfma_f32_16x16x32_bf16 v[48:51], a[68:71], a[100:103], v[48:51]
    s_waitcnt lgkmcnt(2)
    v_mfma_f32_16x16x32_bf16 v[52:55], a[72:75], a[100:103], v[52:55]
    s_waitcnt lgkmcnt(0)
    v_mfma_f32_16x16x32_bf16 v[56:59], a[76:79], a[100:103], v[56:59]
    buffer_load_dwordx2 v[92:93], v96, s[28:31], s53 offen sc1
    buffer_load_dwordx2 v[94:95], v97, s[28:31], s53 offen sc1
    s_waitcnt lgkmcnt(0)
    s_barrier
    ds_read_b128 a[104:107], v80 offset:39040
    ds_read_b128 a[108:111], v81 offset:39040
    ds_read_b64_tr_b16 a[0:1], v24 offset:39040
    ds_read_b64_tr_b16 a[2:3], v24 offset:39552
    ds_read_b64_tr_b16 a[4:5], v25 offset:39040
    ds_read_b64_tr_b16 a[6:7], v25 offset:39552
    ds_read_b64_tr_b16 a[8:9], v26 offset:39040
    ds_read_b64_tr_b16 a[10:11], v26 offset:39552
    ds_read_b64_tr_b16 a[12:13], v27 offset:39040
    ds_read_b64_tr_b16 a[14:15], v27 offset:39552
    ds_read_b64_tr_b16 a[16:17], v24 offset:47232
    ds_read_b64_tr_b16 a[18:19], v24 offset:47744
    ds_read_b64_tr_b16 a[20:21], v25 offset:47232
    ds_read_b64_tr_b16 a[22:23], v25 offset:47744
    ds_read_b64_tr_b16 a[24:25], v26 offset:47232
    ds_read_b64_tr_b16 a[26:27], v26 offset:47744
    s_waitcnt lgkmcnt(12)
    v_mfma_f32_16x16x32_bf16 v[28:31], a[0:3], a[104:107], v[28:31]
    ds_read_b64_tr_b16 a[28:29], v27 offset:47232
    ds_read_b64_tr_b16 a[30:31], v27 offset:47744
    s_waitcnt lgkmcnt(12)
    v_mfma_f32_16x16x32_bf16 v[32:35], a[4:7], a[104:107], v[32:35]
    ds_read_b64_tr_b16 a[48:49], v24 offset:43136
    ds_read_b64_tr_b16 a[50:51], v24 offset:43648
    s_waitcnt lgkmcnt(12)
    v_mfma_f32_16x16x32_bf16 v[36:39], a[8:11], a[104:107], v[36:39]
    ds_read_b64_tr_b16 a[52:53], v25 offset:43136
    ds_read_b64_tr_b16 a[54:55], v25 offset:43648
    s_waitcnt lgkmcnt(12)
    v_mfma_f32_16x16x32_bf16 v[40:43], a[12:15], a[104:107], v[40:43]
    ds_read_b64_tr_b16 a[56:57], v26 offset:43136
    ds_read_b64_tr_b16 a[58:59], v26 offset:43648
    s_waitcnt lgkmcnt(12)
    v_mfma_f32_16x16x32_bf16 v[44:47], a[16:19], a[104:107], v[44:47]
    ds_read_b64_tr_b16 a[60:61], v27 offset:43136
    ds_read_b64_tr_b16 a[62:63], v27 offset:43648
    s_waitcnt lgkmcnt(12)
    v_mfma_f32_16x16x32_bf16 v[48:51], a[20:23], a[104:107], v[48:51]
    ds_read_b64_tr_b16 a[64:65], v24 offset:51328
    ds_read_b64_tr_b16 a[66:67], v24 offset:51840
    s_waitcnt lgkmcnt(12)
    v_mfma_f32_16x16x32_bf16 v[52:55], a[24:27], a[104:107], v[52:55]
    ds_read_b64_tr_b16 a[68:69], v25 offset:51328
    ds_read_b64_tr_b16 a[70:71], v25 offset:51840
    s_waitcnt lgkmcnt(12)
    v_mfma_f32_16x16x32_bf16 v[56:59], a[28:31], a[104:107], v[56:59]
    ds_read_b64_tr_b16 a[72:73], v26 offset:51328
    ds_read_b64_tr_b16 a[74:75], v26 offset:51840
    s_waitcnt lgkmcnt(12)
    v_mfma_f32_16x16x32_bf16 v[28:31], a[48:51], a[108:111], v[28:31]
    ds_read_b64_tr_b16 a[76:77], v27 offset:51328
    ds_read_b64_tr_b16 a[78:79], v27 offset:51840
    s_waitcnt lgkmcnt(12)
    v_mfma_f32_16x16x32_bf16 v[32:35], a[52:55], a[108:111], v[32:35]
    s_waitcnt lgkmcnt(10)
    v_mfma_f32_16x16x32_bf16 v[36:39], a[56:59], a[108:111], v[36:39]
    s_waitcnt lgkmcnt(8)
    v_mfma_f32_16x16x32_bf16 v[40:43], a[60:63], a[108:111], v[40:43]
    s_waitcnt lgkmcnt(6)
    v_mfma_f32_16x16x32_bf16 v[44:47], a[64:67], a[108:111], v[44:47]
    s_waitcnt lgkmcnt(4)
    v_mfma_f32_16x16x32_bf16 v[48:51], a[68:71], a[108:111], v[48:51]
    s_waitcnt lgkmcnt(2)
    v_mfma_f32_16x16x32_bf16 v[52:55], a[72:75], a[108:111], v[52:55]
    s_waitcnt lgkmcnt(0)
    v_mfma_f32_16x16x32_bf16 v[56:59], a[76:79], a[108:111], v[56:59]
    s_waitcnt lgkmcnt(0)
    s_barrier
    ds_read_b128 a[112:115], v76 offset:0
    ds_read_b128 a[116:119], v77 offset:0
    ds_read_b64_tr_b16 a[0:1], v20 offset:0
    ds_read_b64_tr_b16 a[2:3], v20 offset:512
    ds_read_b64_tr_b16 a[4:5], v21 offset:0
    ds_read_b64_tr_b16 a[6:7], v21 offset:512
    ds_read_b64_tr_b16 a[8:9], v22 offset:0
    ds_read_b64_tr_b16 a[10:11], v22 offset:512
    ds_read_b64_tr_b16 a[12:13], v23 offset:0
    ds_read_b64_tr_b16 a[14:15], v23 offset:512
    ds_read_b64_tr_b16 a[16:17], v20 offset:8192
    ds_read_b64_tr_b16 a[18:19], v20 offset:8704
    ds_read_b64_tr_b16 a[20:21], v21 offset:8192
    ds_read_b64_tr_b16 a[22:23], v21 offset:8704
    ds_read_b64_tr_b16 a[24:25], v22 offset:8192
    ds_read_b64_tr_b16 a[26:27], v22 offset:8704
    s_waitcnt lgkmcnt(12)
    v_mfma_f32_16x16x32_bf16 v[28:31], a[0:3], a[112:115], v[28:31]
    ds_read_b64_tr_b16 a[28:29], v23 offset:8192
    ds_read_b64_tr_b16 a[30:31], v23 offset:8704
    s_waitcnt lgkmcnt(12)
    v_mfma_f32_16x16x32_bf16 v[32:35], a[4:7], a[112:115], v[32:35]
    ds_read_b64_tr_b16 a[48:49], v20 offset:4096
    ds_read_b64_tr_b16 a[50:51], v20 offset:4608
    s_waitcnt lgkmcnt(12)
    v_mfma_f32_16x16x32_bf16 v[36:39], a[8:11], a[112:115], v[36:39]
    ds_read_b64_tr_b16 a[52:53], v21 offset:4096
    ds_read_b64_tr_b16 a[54:55], v21 offset:4608
    s_waitcnt lgkmcnt(12)
    v_mfma_f32_16x16x32_bf16 v[40:43], a[12:15], a[112:115], v[40:43]
    ds_read_b64_tr_b16 a[56:57], v22 offset:4096
    ds_read_b64_tr_b16 a[58:59], v22 offset:4608
    s_waitcnt lgkmcnt(12)
    v_mfma_f32_16x16x32_bf16 v[44:47], a[16:19], a[112:115], v[44:47]
    ds_read_b64_tr_b16 a[60:61], v23 offset:4096
    ds_read_b64_tr_b16 a[62:63], v23 offset:4608
    s_waitcnt lgkmcnt(12)
    v_mfma_f32_16x16x32_bf16 v[48:51], a[20:23], a[112:115], v[48:51]
    ds_read_b64_tr_b16 a[64:65], v20 offset:12288
    ds_read_b64_tr_b16 a[66:67], v20 offset:12800
    s_waitcnt lgkmcnt(12)
    v_mfma_f32_16x16x32_bf16 v[52:55], a[24:27], a[112:115], v[52:55]
    ds_read_b64_tr_b16 a[68:69], v21 offset:12288
    ds_read_b64_tr_b16 a[70:71], v21 offset:12800
    s_waitcnt lgkmcnt(12)
    v_mfma_f32_16x16x32_bf16 v[56:59], a[28:31], a[112:115], v[56:59]
    ds_read_b64_tr_b16 a[72:73], v22 offset:12288
    ds_read_b64_tr_b16 a[74:75], v22 offset:12800
    s_waitcnt lgkmcnt(12)
    v_mfma_f32_16x16x32_bf16 v[28:31], a[48:51], a[116:119], v[28:31]
    ds_read_b64_tr_b16 a[76:77], v23 offset:12288
    ds_read_b64_tr_b16 a[78:79], v23 offset:12800
    s_waitcnt lgkmcnt(12)
    v_mfma_f32_16x16x32_bf16 v[32:35], a[52:55], a[116:119], v[32:35]
    s_waitcnt lgkmcnt(10)
    v_mfma_f32_16x16x32_bf16 v[36:39], a[56:59], a[116:119], v[36:39]
    s_waitcnt lgkmcnt(8)
    v_mfma_f32_16x16x32_bf16 v[40:43], a[60:63], a[116:119], v[40:43]
    s_waitcnt lgkmcnt(6)
    v_mfma_f32_16x16x32_bf16 v[44:47], a[64:67], a[116:119], v[44:47]
    s_waitcnt lgkmcnt(4)
    v_mfma_f32_16x16x32_bf16 v[48:51], a[68:71], a[116:119], v[48:51]
    s_waitcnt lgkmcnt(2)
    v_mfma_f32_16x16x32_bf16 v[52:55], a[72:75], a[116:119], v[52:55]
    s_waitcnt lgkmcnt(0)
    v_mfma_f32_16x16x32_bf16 v[56:59], a[76:79], a[116:119], v[56:59]
    s_waitcnt vmcnt(0)
Lst_chk:
    v_cmp_ne_u32 vcc, s38, v93
    v_cmp_ne_u32 s[40:41], s38, v95
    s_nop 0
    s_or_b64 s[40:41], s[40:41], vcc
    s_cbranch_scc1 Lst_re
    v_add_u32 v4, 156224, v12
    v_min_u32 v5, 47, v1
    v_lshlrev_b32 v5, 2, v5
    v_add_u32 v5, 156480, v5
    v_lshlrev_b32 v93, 16, v92
    v_and_b32 v92, 0xffff0000, v92
    v_rcp_f32 v93, v93
    ds_write_b32 v4, v92
    ds_write_b32 v4, v93 offset:512
    v_lshlrev_b32 v95, 16, v94
    v_and_b32 v94, 0xffff0000, v94
    v_rcp_f32 v95, v95
    ds_write_b32 v5, v94
    ds_write_b32 v5, v95 offset:512
    v_lshlrev_b32 v6, 4, v2
    v_add_u32 v6, 157184, v6
    v_mov_b32 v7, 157968
    v_lshlrev_b32 v8, 2, v3
    v_add_u32 v8, 156224, v8
    ds_read_b32 v120, v8
    s_waitcnt lgkmcnt(0)
    s_barrier
    ds_read_b128 a[120:123], v76 offset:39040
    ds_read_b128 a[124:127], v77 offset:39040
    ds_read_b64_tr_b16 a[0:1], v20 offset:39040
    ds_read_b64_tr_b16 a[2:3], v20 offset:39552
    ds_read_b64_tr_b16 a[4:5], v21 offset:39040
    ds_read_b64_tr_b16 a[6:7], v21 offset:39552
    ds_read_b64_tr_b16 a[8:9], v22 offset:39040
    ds_read_b64_tr_b16 a[10:11], v22 offset:39552
    ds_read_b64_tr_b16 a[12:13], v23 offset:39040
    ds_read_b64_tr_b16 a[14:15], v23 offset:39552
    ds_read_b64_tr_b16 a[16:17], v20 offset:47232
    ds_read_b64_tr_b16 a[18:19], v20 offset:47744
    ds_read_b64_tr_b16 a[20:21], v21 offset:47232
    ds_read_b64_tr_b16 a[22:23], v21 offset:47744
    ds_read_b64_tr_b16 a[24:25], v22 offset:47232
    ds_read_b64_tr_b16 a[26:27], v22 offset:47744
    s_waitcnt lgkmcnt(12)
    v_mfma_f32_16x16x32_bf16 v[28:31], a[0:3], a[120:123], v[28:31]
    ds_read_b64_tr_b16 a[28:29], v23 offset:47232
    ds_read_b64_tr_b16 a[30:31], v23 offset:47744
    s_waitcnt lgkmcnt(12)
    v_mfma_f32_16x16x32_bf16 v[32:35], a[4:7], a[120:123], v[32:35]
    ds_read_b64_tr_b16 a[48:49], v20 offset:43136
    ds_read_b64_tr_b16 a[50:51], v20 offset:43648
    s_waitcnt lgkmcnt(12)
    v_mfma_f32_16x16x32_bf16 v[36:39], a[8:11], a[120:123], v[36:39]
    ds_read_b64_tr_b16 a[52:53], v21 offset:43136
    ds_read_b64_tr_b16 a[54:55], v21 offset:43648
    s_waitcnt lgkmcnt(12)
    v_mfma_f32_16x16x32_bf16 v[40:43], a[12:15], a[120:123], v[40:43]
    ds_read_b64_tr_b16 a[56:57], v22 offset:43136
    ds_read_b64_tr_b16 a[58:59], v22 offset:43648
    s_waitcnt lgkmcnt(12)
    v_mfma_f32_16x16x32_bf16 v[44:47], a[16:19], a[120:123], v[44:47]
    ds_read_b64_tr_b16 a[60:61], v23 offset:43136
    ds_read_b64_tr_b16 a[62:63], v23 offset:43648
    s_waitcnt lgkmcnt(12)
    v_mfma_f32_16x16x32_bf16 v[48:51], a[20:23], a[120:123], v[48:51]
    ds_read_b64_tr_b16 a[64:65], v20 offset:51328
    ds_read_b64_tr_b16 a[66:67], v20 offset:51840
    s_waitcnt lgkmcnt(12)
    v_mfma_f32_16x16x32_bf16 v[52:55], a[24:27], a[120:123], v[52:55]
    ds_read_b64_tr_b16 a[68:69], v21 offset:51328
    ds_read_b64_tr_b16 a[70:71], v21 offset:51840
    s_waitcnt lgkmcnt(12)
    v_mfma_f32_16x16x32_bf16 v[56:59], a[28:31], a[120:123], v[56:59]
    ds_read_b64_tr_b16 a[72:73], v22 offset:51328
    ds_read_b64_tr_b16 a[74:75], v22 offset:51840
    s_waitcnt lgkmcnt(12)
    v_mfma_f32_16x16x32_bf16 v[28:31], a[48:51], a[124:127], v[28:31]
    ds_read_b64_tr_b16 a[76:77], v23 offset:51328
    ds_read_b64_tr_b16 a[78:79], v23 offset:51840
    s_waitcnt lgkmcnt(12)
    v_mfma_f32_16x16x32_bf16 v[32:35], a[52:55], a[124:127], v[32:35]
    s_waitcnt lgkmcnt(10)
    v_mfma_f32_16x16x32_bf16 v[36:39], a[56:59], a[124:127], v[36:39]
    s_waitcnt lgkmcnt(8)
    v_mfma_f32_16x16x32_bf16 v[40:43], a[60:63], a[124:127], v[40:43]
    s_waitcnt lgkmcnt(6)
    v_mfma_f32_16x16x32_bf16 v[44:47], a[64:67], a[124:127], v[44:47]
    s_waitcnt lgkmcnt(4)
    v_mfma_f32_16x16x32_bf16 v[48:51], a[68:71], a[124:127], v[48:51]
    s_waitcnt lgkmcnt(2)
    v_mfma_f32_16x16x32_bf16 v[52:55], a[72:75], a[124:127], v[52:55]
    s_waitcnt lgkmcnt(0)
    v_mfma_f32_16x16x32_bf16 v[56:59], a[76:79], a[124:127], v[56:59]
    s_mov_b32 exec_lo, 0x00010001
    s_mov_b32 exec_hi, 0x00010001
    ds_write_b128 v6, v[28:31] offset:0
    ds_write_b128 v6, v[32:35] offset:64
    ds_write_b128 v6, v[36:39] offset:128
    ds_write_b128 v6, v[40:43] offset:192
    ds_write_b128 v6, v[44:47] offset:256
    ds_write_b128 v6, v[48:51] offset:320
    ds_write_b128 v6, v[52:55] offset:384
    ds_write_b128 v6, v[56:59] offset:448
    ds_write_b32 v7, v7
    s_mov_b64 exec, -1
    ds_read_b128 v[76:79], v6 offset:256
    ds_read_b128 v[80:83], v6 offset:320
    ds_read_b128 v[84:87], v6 offset:384
    ds_read_b128 v[88:91], v6 offset:448
    s_waitcnt lgkmcnt(0)
    v_fmac_f32 v44, v76, v120
    v_fmac_f32 v45, v77, v120
    v_fmac_f32 v46, v78, v120
    v_fmac_f32 v47, v79, v120
    v_cvt_pk_bf16_f32 v44, v44, v45
    v_cvt_pk_bf16_f32 v45, v46, v47
    v_fmac_f32 v48, v80, v120
    v_fmac_f32 v49, v81, v120
    v_fmac_f32 v50, v82, v120
    v_fmac_f32 v51, v83, v120
    v_cvt_pk_bf16_f32 v46, v48, v49
    v_cvt_pk_bf16_f32 v47, v50, v51
    v_fmac_f32 v52, v84, v120
    v_fmac_f32 v53, v85, v120
    v_fmac_f32 v54, v86, v120
    v_fmac_f32 v55, v87, v120
    v_cvt_pk_bf16_f32 v48, v52, v53
    v_cvt_pk_bf16_f32 v49, v54, v55
    v_fmac_f32 v56, v88, v120
    v_fmac_f32 v57, v89, v120
    v_fmac_f32 v58, v90, v120
    v_fmac_f32 v59, v91, v120
    v_cvt_pk_bf16_f32 v50, v56, v57
    v_cvt_pk_bf16_f32 v51, v58, v59
    ds_write_b128 v125, v[44:47] offset:4096
    ds_write_b128 v125, v[48:51] offset:5120
    v_mov_b32 v5, 157972
    v_mov_b32 v6, 1
    s_mov_b64 exec, 1
    ds_add_u32 v5, v6
    s_mov_b64 exec, -1
    v_mov_b32 v5, 157980
Lcw_4:
    s_sub_u32 s39, s39, 1
    s_cbranch_scc1 Lend
    ds_read_b32 v6, v5
    s_waitcnt lgkmcnt(0)
    v_readfirstlane_b32 s42, v6
    s_nop 0
    s_cmp_lt_u32 s42, 1
    s_cbranch_scc1 Lcw_4
    ds_read_b64_tr_b16 a[0:1], v24 offset:16384
    ds_read_b64_tr_b16 a[2:3], v24 offset:16896
    ds_read_b64_tr_b16 a[4:5], v25 offset:16384
    ds_read_b64_tr_b16 a[6:7], v25 offset:16896
    ds_read_b64_tr_b16 a[8:9], v26 offset:16384
    ds_read_b64_tr_b16 a[10:11], v26 offset:16896
    ds_read_b64_tr_b16 a[12:13], v27 offset:16384
    ds_read_b64_tr_b16 a[14:15], v27 offset:16896
    ds_read_b64_tr_b16 a[16:17], v24 offset:20480
    ds_read_b64_tr_b16 a[18:19], v24 offset:20992
    ds_read_b64_tr_b16 a[20:21], v25 offset:20480
    ds_read_b64_tr_b16 a[22:23], v25 offset:20992
    ds_read_b64_tr_b16 a[24:25], v26 offset:20480
    ds_read_b64_tr_b16 a[26:27], v26 offset:20992
    ds_read_b64_tr_b16 a[28:29], v27 offset:20480
    ds_read_b64_tr_b16 a[30:31], v27 offset:20992
    ds_read_b64_tr_b16 a[32:33], v24 offset:55424
    ds_read_b64_tr_b16 a[34:35], v24 offset:55936
    ds_read_b64_tr_b16 a[36:37], v25 offset:55424
    ds_read_b64_tr_b16 a[38:39], v25 offset:55936
    ds_read_b64_tr_b16 a[40:41], v26 offset:55424
    ds_read_b64_tr_b16 a[42:43], v26 offset:55936
    ds_read_b64_tr_b16 a[44:45], v27 offset:55424
    ds_read_b64_tr_b16 a[46:47], v27 offset:55936
    ds_read_b64_tr_b16 a[48:49], v24 offset:59520
    ds_read_b64_tr_b16 a[50:51], v24 offset:60032
    ds_read_b64_tr_b16 a[52:53], v25 offset:59520
    ds_read_b64_tr_b16 a[54:55], v25 offset:60032
    ds_read_b64_tr_b16 a[56:57], v26 offset:59520
    ds_read_b64_tr_b16 a[58:59], v26 offset:60032
    ds_read_b64_tr_b16 a[60:61], v27 offset:59520
    ds_read_b64_tr_b16 a[62:63], v27 offset:60032
    ds_read_b64_tr_b16 a[64:65], v20 offset:16384
    ds_read_b64_tr_b16 a[66:67], v20 offset:16896
    ds_read_b64_tr_b16 a[68:69], v21 offset:16384
    ds_read_b64_tr_b16 a[70:71], v21 offset:16896
    ds_read_b64_tr_b16 a[72:73], v22 offset:16384
    ds_read_b64_tr_b16 a[74:75], v22 offset:16896
    ds_read_b64_tr_b16 a[76:77], v23 offset:16384
    ds_read_b64_tr_b16 a[78:79], v23 offset:16896
    ds_read_b64_tr_b16 a[80:81], v20 offset:20480
    ds_read_b64_tr_b16 a[82:83], v20 offset:20992
    ds_read_b64_tr_b16 a[84:85], v21 offset:20480
    ds_read_b64_tr_b16 a[86:87], v21 offset:20992
    ds_read_b64_tr_b16 a[88:89], v22 offset:20480
    ds_read_b64_tr_b16 a[90:91], v22 offset:20992
    ds_read_b64_tr_b16 a[92:93], v23 offset:20480
    ds_read_b64_tr_b16 a[94:95], v23 offset:20992
    s_waitcnt lgkmcnt(15)
    v_mfma_f32_16x16x32_bf16 v[60:63], a[96:99], a[0:3], v[60:63]
    v_mfma_f32_16x16x32_bf16 v[64:67], a[96:99], a[4:7], v[64:67]
    v_mfma_f32_16x16x32_bf16 v[68:71], a[96:99], a[8:11], v[68:71]
    v_mfma_f32_16x16x32_bf16 v[72:75], a[96:99], a[12:15], v[72:75]
    ds_read_b64_tr_b16 a[0:1], v20 offset:55424
    ds_read_b64_tr_b16 a[2:3], v20 offset:55936
    ds_read_b64_tr_b16 a[4:5], v21 offset:55424
    ds_read_b64_tr_b16 a[6:7], v21 offset:55936
    ds_read_b64_tr_b16 a[8:9], v22 offset:55424
    ds_read_b64_tr_b16 a[10:11], v22 offset:55936
    ds_read_b64_tr_b16 a[12:13], v23 offset:55424
    ds_read_b64_tr_b16 a[14:15], v23 offset:55936
    v_mfma_f32_16x16x32_bf16 v[60:63], a[100:103], a[16:19], v[60:63]
    v_mfma_f32_16x16x32_bf16 v[64:67], a[100:103], a[20:23], v[64:67]
    v_mfma_f32_16x16x32_bf16 v[68:71], a[100:103], a[24:27], v[68:71]
    v_mfma_f32_16x16x32_bf16 v[72:75], a[100:103], a[28:31], v[72:75]
    ds_read_b64_tr_b16 a[16:17], v20 offset:59520
    ds_read_b64_tr_b16 a[18:19], v20 offset:60032
    ds_read_b64_tr_b16 a[20:21], v21 offset:59520
    ds_read_b64_tr_b16 a[22:23], v21 offset:60032
    ds_read_b64_tr_b16 a[24:25], v22 offset:59520
    ds_read_b64_tr_b16 a[26:27], v22 offset:60032
    ds_read_b64_tr_b16 a[28:29], v23 offset:59520
    ds_read_b64_tr_b16 a[30:31], v23 offset:60032
    v_mfma_f32_16x16x32_bf16 v[60:63], a[104:107], a[32:35], v[60:63]
    v_mfma_f32_16x16x32_bf16 v[64:67], a[104:107], a[36:39], v[64:67]
    v_mfma_f32_16x16x32_bf16 v[68:71], a[104:107], a[40:43], v[68:71]
    v_mfma_f32_16x16x32_bf16 v[72:75], a[104:107], a[44:47], v[72:75]
    v_mfma_f32_16x16x32_bf16 v[60:63], a[108:111], a[48:51], v[60:63]
    v_mfma_f32_16x16x32_bf16 v[64:67], a[108:111], a[52:55], v[64:67]
    v_mfma_f32_16x16x32_bf16 v[68:71], a[108:111], a[56:59], v[68:71]
    v_mfma_f32_16x16x32_bf16 v[72:75], a[108:111], a[60:63], v[72:75]
    s_waitcnt lgkmcnt(15)
    v_mfma_f32_16x16x32_bf16 v[60:63], a[112:115], a[64:67], v[60:63]
    v_mfma_f32_16x16x32_bf16 v[64:67], a[112:115], a[68:71], v[64:67]
    v_mfma_f32_16x16x32_bf16 v[68:71], a[112:115], a[72:75], v[68:71]
    v_mfma_f32_16x16x32_bf16 v[72:75], a[112:115], a[76:79], v[72:75]
    v_mfma_f32_16x16x32_bf16 v[60:63], a[116:119], a[80:83], v[60:63]
    v_mfma_f32_16x16x32_bf16 v[64:67], a[116:119], a[84:87], v[64:67]
    v_mfma_f32_16x16x32_bf16 v[68:71], a[116:119], a[88:91], v[68:71]
    v_mfma_f32_16x16x32_bf16 v[72:75], a[116:119], a[92:95], v[72:75]
    s_waitcnt lgkmcnt(8)
    v_mfma_f32_16x16x32_bf16 v[60:63], a[120:123], a[0:3], v[60:63]
    v_mfma_f32_16x16x32_bf16 v[64:67], a[120:123], a[4:7], v[64:67]
    v_mfma_f32_16x16x32_bf16 v[68:71], a[120:123], a[8:11], v[68:71]
    v_mfma_f32_16x16x32_bf16 v[72:75], a[120:123], a[12:15], v[72:75]
    s_waitcnt lgkmcnt(0)
    v_mfma_f32_16x16x32_bf16 v[60:63], a[124:127], a[16:19], v[60:63]
    v_mfma_f32_16x16x32_bf16 v[64:67], a[124:127], a[20:23], v[64:67]
    v_mfma_f32_16x16x32_bf16 v[68:71], a[124:127], a[24:27], v[68:71]
    v_mfma_f32_16x16x32_bf16 v[72:75], a[124:127], a[28:31], v[72:75]
    v_lshlrev_b32 v5, 4, v3
    v_add_u32 v5, 157696, v5
    v_mov_b32 v6, 157952
    v_lshlrev_b32 v4, 4, v2
    v_add_u32 v4, 156224, v4
    v_lshl_add_u32 v125, v1, 3, s52
    s_mov_b64 exec, 0xffff
    ds_write_b32 v5, v60 offset:0
    ds_write_b32 v5, v64 offset:4
    ds_write_b32 v5, v68 offset:8
    ds_write_b32 v5, v72 offset:12
    ds_write_b32 v6, v6
    s_mov_b64 exec, -1
    ds_read_b128 v[36:39], v5
    ds_read_b128 v[28:31], v4
    ds_read_b128 v[32:35], v4 offset:512
    s_waitcnt lgkmcnt(0)
    v_fmac_f32 v60, v28, v36
    v_fmac_f32 v61, v29, v36
    v_fmac_f32 v62, v30, v36
    v_fmac_f32 v63, v31, v36
    v_mul_f32 v60, v60, v32
    v_mul_f32 v61, v61, v33
    v_mul_f32 v62, v62, v34
    v_mul_f32 v63, v63, v35
    v_cvt_pk_bf16_f32 v60, v60, v61
    v_cvt_pk_bf16_f32 v61, v62, v63
    ds_write_b64 v125, v[60:61] offset:0
    v_fmac_f32 v64, v28, v37
    v_fmac_f32 v65, v29, v37
    v_fmac_f32 v66, v30, v37
    v_fmac_f32 v67, v31, v37
    v_mul_f32 v64, v64, v32
    v_mul_f32 v65, v65, v33
    v_mul_f32 v66, v66, v34
    v_mul_f32 v67, v67, v35
    v_cvt_pk_bf16_f32 v64, v64, v65
    v_cvt_pk_bf16_f32 v65, v66, v67
    ds_write_b64 v125, v[64:65] offset:512
    v_fmac_f32 v68, v28, v38
    v_fmac_f32 v69, v29, v38
    v_fmac_f32 v70, v30, v38
    v_fmac_f32 v71, v31, v38
    v_mul_f32 v68, v68, v32
    v_mul_f32 v69, v69, v33
    v_mul_f32 v70, v70, v34
    v_mul_f32 v71, v71, v35
    v_cvt_pk_bf16_f32 v68, v68, v69
    v_cvt_pk_bf16_f32 v69, v70, v71
    ds_write_b64 v125, v[68:69] offset:1024
    v_fmac_f32 v72, v28, v39
    v_fmac_f32 v73, v29, v39
    v_fmac_f32 v74, v30, v39
    v_fmac_f32 v75, v31, v39
    v_mul_f32 v72, v72, v32
    v_mul_f32 v73, v73, v33
    v_mul_f32 v74, v74, v34
    v_mul_f32 v75, v75, v35
    v_cvt_pk_bf16_f32 v72, v72, v73
    v_cvt_pk_bf16_f32 v73, v74, v75
    ds_write_b64 v125, v[72:73] offset:1536
    v_mov_b32 v8, 157976
    v_mov_b32 v9, 1
    s_mov_b64 exec, 1
    ds_add_u32 v8, v9
    s_mov_b64 exec, -1
    s_endpgm
Lst_re:
    s_sub_u32 s39, s39, 1
    s_cbranch_scc1 Lend
    buffer_load_dwordx2 v[92:93], v96, s[28:31], s53 offen sc1
    buffer_load_dwordx2 v[94:95], v97, s[28:31], s53 offen sc1
    s_waitcnt vmcnt(0)
    s_branch Lst_chk
Laux:
    s_mul_i32 s36, s40, 9
    s_lshl_b32 s42, s42, 2
    s_add_u32 s36, s36, s42
    s_add_u32 s36, s36, s41
    s_cmp_ge_u32 s36, 32
    s_cbranch_scc1 Lmst
    v_lshrrev_b32 v5, 3, v1
    v_and_b32 v6, 7, v1
    s_lshl_b32 s44, s3, 14
    s_cmp_eq_u32 s27, 0
    s_cbranch_scc0 Laux_u
    s_lshl_b32 s40, s36, 6
    s_lshl_b32 s41, s26, 4
    s_add_u32 s40, s40, s41
    v_add_u32 v7, s40, v5
    v_mul_u32_u24 v7, 1280, v7
    v_xor_b32 v8, v6, v2
    v_lshl_add_u32 v92, v8, 4, v7
    v_add_u32 v92, 4096, v92
    v_xor_b32 v93, 64, v92
    v_add_u32 v93, 9216, v93
    v_subrev_u32 v94, 1920, v92
    v_subrev_u32 v95, 1920, v93
    s_waitcnt lgkmcnt(0)
    s_sub_u32 s56, s4, 4096
    s_subb_u32 s57, s5, 0
    s_mov_b32 s58, 2625536
    s_mov_b32 s59, 0x20000
    s_mov_b64 s[64:65], s[12:13]
    s_mov_b32 s66, 1280
    s_mov_b32 s67, 0x20000
    s_mov_b32 m0, 131072
    s_nop 0
    buffer_load_dwordx4 v13, s[64:67], 0 offen lds
    s_mov_b64 exec, 0xffff
    buffer_load_dwordx4 v13, s[64:67], 0 offen offset:1024 lds
    s_mov_b64 exec, -1
    s_add_u32 m0, s44, 0
    s_mov_b32 s45, 0
    buffer_load_dwordx4 v92, s[56:59], s45 offen lds
    buffer_load_dwordx4 v93, s[56:59], s45 offen offset:1024 lds
    buffer_load_dwordx4 v94, s[56:59], s45 offen offset:2048 lds
    buffer_load_dwordx4 v95, s[56:59], s45 offen offset:3072 lds
    s_add_u32 m0, s44, 4096
    s_mov_b32 s45, 256
    buffer_load_dwordx4 v92, s[56:59], s45 offen lds
    buffer_load_dwordx4 v93, s[56:59], s45 offen offset:1024 lds
    buffer_load_dwordx4 v94, s[56:59], s45 offen offset:2048 lds
    buffer_load_dwordx4 v95, s[56:59], s45 offen offset:3072 lds
    s_add_u32 m0, s44, 8192
    s_mov_b32 s45, 512
    buffer_load_dwordx4 v92, s[56:59], s45 offen lds
    buffer_load_dwordx4 v93, s[56:59], s45 offen offset:1024 lds
    buffer_load_dwordx4 v94, s[56:59], s45 offen offset:2048 lds
    buffer_load_dwordx4 v95, s[56:59], s45 offen offset:3072 lds
    s_add_u32 m0, s44, 12288
    s_mov_b32 s45, 768
    buffer_load_dwordx4 v92, s[56:59], s45 offen lds
    buffer_load_dwordx4 v93, s[56:59], s45 offen offset:1024 lds
    buffer_load_dwordx4 v94, s[56:59], s45 offen offset:2048 lds
    buffer_load_dwordx4 v95, s[56:59], s45 offen offset:3072 lds
    s_mov_b64 s[28:29], s[24:25]
    s_mov_b32 s30, 268435456
    s_mov_b32 s31, 0x20000
    s_mov_b64 s[32:33], s[22:23]
    s_mov_b32 s34, 256
    s_mov_b32 s35, 0x20000
    s_load_dword s38, s[28:29], 0
    s_mov_b64 s[48:49], s[14:15]
    s_mov_b32 s50, 2211840
    s_mov_b32 s51, 0x20000
    s_mov_b64 s[52:53], s[18:19]
    s_mov_b32 s54, 2211840
    s_mov_b32 s55, 0x20000
    v_and_b32 v8, 1, v2
    v_lshlrev_b32 v8, 1, v8
    v_xor_b32 v8, v8, v6
    v_lshlrev_b32 v8, 4, v8
    v_mul_u32_u24 v9, 3456, v5
    s_lshl_b32 s42, s36, 7
    v_add3_u32 v18, v9, v8, s42
    v_xor_b32 v19, 64, v18
    v_add_u32 v19, 26624, v19
    v_add_u32 v20, 53248, v18
    v_add_u32 v21, 53248, v19
    s_mul_i32 s46, s26, 110592
    v_mul_u32_u24 v9, 1280, v5
    v_add_u32 v22, v9, v8
    v_xor_b32 v23, 64, v22
    v_add_u32 v23, 9216, v23
    v_add_u32 v24, 18432, v22
    v_add_u32 v25, 18432, v23
    s_mul_i32 s47, s36, 81920
    s_lshl_b32 s42, s3, 7
    s_add_u32 s47, s47, s42
    s_lshl_b32 s62, s2, 7
    s_add_u32 s62, s62, 8257536
    v_mov_b32 v96, 0x3f803f80
    v_mov_b32 v97, 0x3f803f80
    v_mov_b32 v98, 0x3f803f80
    v_mov_b32 v99, 0x3f803f80
    v_lshlrev_b32 v100, 4, v2
    v_add_u32 v100, 131072, v100
    v_lshrrev_b32 v10, 1, v3
    v_xor_b32 v10, v10, v2
    v_lshlrev_b32 v10, 4, v10
    v_lshl_add_u32 v10, v3, 7, v10
    v_add_u32 v102, s44, v10
    v_xor_b32 v103, 64, v102
    s_mov_b32 s68, 0xaaaaaaaa
    s_mov_b32 s69, 0xaaaaaaaa
    s_mov_b32 s70, 0xcccccccc
    s_mov_b32 s71, 0xcccccccc
    v_lshrrev_b32 v101, 2, v3
    v_lshl_add_u32 v101, v101, 4, v3
    v_lshlrev_b32 v101, 2, v101
    v_bfe_u32 v10, v1, 2, 2
    v_and_b32 v8, 3, v1
    v_lshl_add_u32 v14, v2, 3, v10
    v_lshlrev_b32 v14, 7, v14
    v_lshlrev_b32 v9, 2, v1
    v_and_b32 v9, 0x60, v9
    v_add3_u32 v14, v14, v9, s44
    v_lshl_add_u32 v14, v8, 3, v14
    v_xor_b32 v15, 32, v14
    v_xor_b32 v16, 64, v14
    v_xor_b32 v17, 96, v14
    s_lshl_b32 s40, s26, 6
    s_add_u32 s40, s40, 4096
    v_lshl_add_u32 v26, v2, 4, s40
    s_waitcnt lgkmcnt(0)
    s_add_u32 s38, s38, 0x9e3779b8
    s_or_b32 s38, s38, 1
    s_waitcnt vmcnt(12)
    ds_read_b128 a[80:83], v102 offset:0
    ds_read_b128 a[84:87], v100 offset:0
    ds_read_b128 a[88:91], v103 offset:0
    ds_read_b128 a[92:95], v100 offset:64
    ds_read_b128 a[96:99], v102 offset:2048
    ds_read_b128 a[100:103], v100 offset:128
    ds_read_b128 a[104:107], v103 offset:2048
    ds_read_b128 a[108:111], v100 offset:192
    s_waitcnt lgkmcnt(0)
    s_add_u32 m0, s44, 0
    s_mov_b32 s45, 1024
    buffer_load_dwordx4 v92, s[56:59], s45 offen lds
    buffer_load_dwordx4 v93, s[56:59], s45 offen offset:1024 lds
    buffer_load_dwordx4 v94, s[56:59], s45 offen offset:2048 lds
    buffer_load_dwordx4 v95, s[56:59], s45 offen offset:3072 lds
    s_barrier
    v_mfma_f32_16x16x32_bf16 v[116:119], a[80:83], a[80:83], 0
    v_mfma_f32_16x16x32_bf16 v[112:115], v[96:99], a[80:83], 0
    v_mfma_f32_16x16x32_bf16 v[120:123], a[84:87], a[80:83], 0
    v_mfma_f32_16x16x32_bf16 v[124:127], a[84:87], v[96:99], 0
    v_mfma_f32_16x16x32_bf16 v[116:119], a[88:91], a[88:91], v[116:119]
    v_mfma_f32_16x16x32_bf16 v[112:115], v[96:99], a[88:91], v[112:115]
    v_mfma_f32_16x16x32_bf16 v[120:123], a[92:95], a[88:91], v[120:123]
    v_mfma_f32_16x16x32_bf16 v[124:127], a[92:95], v[96:99], v[124:127]
    v_mfma_f32_16x16x32_bf16 v[116:119], a[96:99], a[96:99], v[116:119]
    v_mfma_f32_16x16x32_bf16 v[112:115], v[96:99], a[96:99], v[112:115]
    v_mfma_f32_16x16x32_bf16 v[120:123], a[100:103], a[96:99], v[120:123]
    v_mfma_f32_16x16x32_bf16 v[124:127], a[100:103], v[96:99], v[124:127]
    v_mfma_f32_16x16x32_bf16 v[116:119], a[104:107], a[104:107], v[116:119]
    v_mfma_f32_16x16x32_bf16 v[112:115], v[96:99], a[104:107], v[112:115]
    v_mfma_f32_16x16x32_bf16 v[120:123], a[108:111], a[104:107], v[120:123]
    v_mfma_f32_16x16x32_bf16 v[124:127], a[108:111], v[96:99], v[124:127]
    s_waitcnt vmcnt(12)
    ds_read_b128 a[80:83], v102 offset:4096
    ds_read_b128 a[84:87], v100 offset:256
    ds_read_b128 a[88:91], v103 offset:4096
    ds_read_b128 a[92:95], v100 offset:320
    ds_read_b128 a[96:99], v102 offset:6144
    ds_read_b128 a[100:103], v100 offset:384
    ds_read_b128 a[104:107], v103 offset:6144
    ds_read_b128 a[108:111], v100 offset:448
    s_waitcnt lgkmcnt(0)
    v_mfma_f32_16x16x32_bf16 v[116:119], a[80:83], a[80:83], v[116:119]
    v_mfma_f32_16x16x32_bf16 v[112:115], v[96:99], a[80:83], v[112:115]
    v_mfma_f32_16x16x32_bf16 v[120:123], a[84:87], a[80:83], v[120:123]
    v_mfma_f32_16x16x32_bf16 v[124:127], a[84:87], v[96:99], v[124:127]
    v_mfma_f32_16x16x32_bf16 v[116:119], a[88:91], a[88:91], v[116:119]
    v_mfma_f32_16x16x32_bf16 v[112:115], v[96:99], a[88:91], v[112:115]
    v_mfma_f32_16x16x32_bf16 v[120:123], a[92:95], a[88:91], v[120:123]
    v_mfma_f32_16x16x32_bf16 v[124:127], a[92:95], v[96:99], v[124:127]
    v_mfma_f32_16x16x32_bf16 v[116:119], a[96:99], a[96:99], v[116:119]
    v_mfma_f32_16x16x32_bf16 v[112:115], v[96:99], a[96:99], v[112:115]
    v_mfma_f32_16x16x32_bf16 v[120:123], a[100:103], a[96:99], v[120:123]
    v_mfma_f32_16x16x32_bf16 v[124:127], a[100:103], v[96:99], v[124:127]
    v_mfma_f32_16x16x32_bf16 v[116:119], a[104:107], a[104:107], v[116:119]
    v_mfma_f32_16x16x32_bf16 v[112:115], v[96:99], a[104:107], v[112:115]
    v_mfma_f32_16x16x32_bf16 v[120:123], a[108:111], a[104:107], v[120:123]
    v_mfma_f32_16x16x32_bf16 v[124:127], a[108:111], v[96:99], v[124:127]
    s_waitcnt vmcnt(8)
    ds_read_b128 a[80:83], v102 offset:8192
    ds_read_b128 a[84:87], v100 offset:512
    ds_read_b128 a[88:91], v103 offset:8192
    ds_read_b128 a[92:95], v100 offset:576
    ds_read_b128 a[96:99], v102 offset:10240
    ds_read_b128 a[100:103], v100 offset:640
    ds_read_b128 a[104:107], v103 offset:10240
    ds_read_b128 a[108:111], v100 offset:704
    s_waitcnt lgkmcnt(0)
    v_mfma_f32_16x16x32_bf16 v[116:119], a[80:83], a[80:83], v[116:119]
    v_mfma_f32_16x16x32_bf16 v[112:115], v[96:99], a[80:83], v[112:115]
    v_mfma_f32_16x16x32_bf16 v[120:123], a[84:87], a[80:83], v[120:123]
    v_mfma_f32_16x16x32_bf16 v[124:127], a[84:87], v[96:99], v[124:127]
    v_mfma_f32_16x16x32_bf16 v[116:119], a[88:91], a[88:91], v[116:119]
    v_mfma_f32_16x16x32_bf16 v[112:115], v[96:99], a[88:91], v[112:115]
    v_mfma_f32_16x16x32_bf16 v[120:123], a[92:95], a[88:91], v[120:123]
    v_mfma_f32_16x16x32_bf16 v[124:127], a[92:95], v[96:99], v[124:127]
    v_mfma_f32_16x16x32_bf16 v[116:119], a[96:99], a[96:99], v[116:119]
    v_mfma_f32_16x16x32_bf16 v[112:115], v[96:99], a[96:99], v[112:115]
    v_mfma_f32_16x16x32_bf16 v[120:123], a[100:103], a[96:99], v[120:123]
    v_mfma_f32_16x16x32_bf16 v[124:127], a[100:103], v[96:99], v[124:127]
    v_mfma_f32_16x16x32_bf16 v[116:119], a[104:107], a[104:107], v[116:119]
    v_mfma_f32_16x16x32_bf16 v[112:115], v[96:99], a[104:107], v[112:115]
    v_mfma_f32_16x16x32_bf16 v[120:123], a[108:111], a[104:107], v[120:123]
    v_mfma_f32_16x16x32_bf16 v[124:127], a[108:111], v[96:99], v[124:127]
    s_waitcnt vmcnt(4)
    ds_read_b128 a[80:83], v102 offset:12288
    ds_read_b128 a[84:87], v100 offset:768
    ds_read_b128 a[88:91], v103 offset:12288
    ds_read_b128 a[92:95], v100 offset:832
    ds_read_b128 a[96:99], v102 offset:14336
    ds_read_b128 a[100:103], v100 offset:896
    ds_read_b128 a[104:107], v103 offset:14336
    ds_read_b128 a[108:111], v100 offset:960
    s_waitcnt lgkmcnt(0)
    v_mfma_f32_16x16x32_bf16 v[116:119], a[80:83], a[80:83], v[116:119]
    v_mfma_f32_16x16x32_bf16 v[112:115], v[96:99], a[80:83], v[112:115]
    v_mfma_f32_16x16x32_bf16 v[120:123], a[84:87], a[80:83], v[120:123]
    v_mfma_f32_16x16x32_bf16 v[124:127], a[84:87], v[96:99], v[124:127]
    v_mfma_f32_16x16x32_bf16 v[116:119], a[88:91], a[88:91], v[116:119]
    v_mfma_f32_16x16x32_bf16 v[112:115], v[96:99], a[88:91], v[112:115]
    v_mfma_f32_16x16x32_bf16 v[120:123], a[92:95], a[88:91], v[120:123]
    v_mfma_f32_16x16x32_bf16 v[124:127], a[92:95], v[96:99], v[124:127]
    v_mfma_f32_16x16x32_bf16 v[116:119], a[96:99], a[96:99], v[116:119]
    v_mfma_f32_16x16x32_bf16 v[112:115], v[96:99], a[96:99], v[112:115]
    v_mfma_f32_16x16x32_bf16 v[120:123], a[100:103], a[96:99], v[120:123]
    v_mfma_f32_16x16x32_bf16 v[124:127], a[100:103], v[96:99], v[124:127]
    v_mfma_f32_16x16x32_bf16 v[116:119], a[104:107], a[104:107], v[116:119]
    v_mfma_f32_16x16x32_bf16 v[112:115], v[96:99], a[104:107], v[112:115]
    v_mfma_f32_16x16x32_bf16 v[120:123], a[108:111], a[104:107], v[120:123]
    v_mfma_f32_16x16x32_bf16 v[124:127], a[108:111], v[96:99], v[124:127]
    s_waitcnt vmcnt(0)
    ds_read_b128 a[80:83], v102 offset:0
    ds_read_b128 a[84:87], v100 offset:1024
    ds_read_b128 a[88:91], v103 offset:0
    ds_read_b128 a[92:95], v100 offset:1088
    ds_read_b128 a[96:99], v102 offset:2048
    ds_read_b128 a[100:103], v100 offset:1152
    ds_read_b128 a[104:107], v103 offset:2048
    ds_read_b128 a[108:111], v100 offset:1216
    s_waitcnt lgkmcnt(0)
    v_mfma_f32_16x16x32_bf16 v[116:119], a[80:83], a[80:83], v[116:119]
    v_mfma_f32_16x16x32_bf16 v[112:115], v[96:99], a[80:83], v[112:115]
    v_mfma_f32_16x16x32_bf16 v[120:123], a[84:87], a[80:83], v[120:123]
    v_mfma_f32_16x16x32_bf16 v[124:127], a[84:87], v[96:99], v[124:127]
    v_mfma_f32_16x16x32_bf16 v[116:119], a[88:91], a[88:91], v[116:119]
    v_mfma_f32_16x16x32_bf16 v[112:115], v[96:99], a[88:91], v[112:115]
    v_mfma_f32_16x16x32_bf16 v[120:123], a[92:95], a[88:91], v[120:123]
    v_mfma_f32_16x16x32_bf16 v[124:127], a[92:95], v[96:99], v[124:127]
    v_mfma_f32_16x16x32_bf16 v[116:119], a[96:99], a[96:99], v[116:119]
    v_mfma_f32_16x16x32_bf16 v[112:115], v[96:99], a[96:99], v[112:115]
    v_mfma_f32_16x16x32_bf16 v[120:123], a[100:103], a[96:99], v[120:123]
    v_mfma_f32_16x16x32_bf16 v[124:127], a[100:103], v[96:99], v[124:127]
    v_mfma_f32_16x16x32_bf16 v[116:119], a[104:107], a[104:107], v[116:119]
    v_mfma_f32_16x16x32_bf16 v[112:115], v[96:99], a[104:107], v[112:115]
    v_mfma_f32_16x16x32_bf16 v[120:123], a[108:111], a[104:107], v[120:123]
    v_mfma_f32_16x16x32_bf16 v[124:127], a[108:111], v[96:99], v[124:127]
    s_nop 4
    v_cndmask_b32 v4, v116, v117, s[68:69]
    v_cndmask_b32 v5, v118, v119, s[68:69]
    v_cndmask_b32 v4, v4, v5, s[70:71]
    ds_bpermute_b32 v4, v101, v4
    v_mul_f32 v5, 0xbacccccd, v112
    v_cvt_pk_bf16_f32 v104, v5, v5
    v_lshlrev_b32 v104, 16, v104
    v_mul_f32 v5, v5, v5
    v_mov_b32 v6, 0x3acccccd
    s_waitcnt lgkmcnt(0)
    v_fma_f32 v4, v4, v6, -v5
    v_max_f32 v4, 0, v4
    v_cvt_pk_bf16_f32 v4, v4, v4
    v_lshlrev_b32 v4, 16, v4
    v_add_f32 v4, 0x3727c5ac, v4
    v_cvt_pk_bf16_f32 v4, v4, v4
    v_lshlrev_b32 v4, 16, v4
    v_sqrt_f32 v4, v4
    s_nop 0
    v_cvt_pk_bf16_f32 v4, v4, v4
    v_lshlrev_b32 v4, 16, v4
    v_rcp_f32 v105, v4
    v_lshrrev_b32 v8, 16, v4
    v_or_b32 v8, v8, v104
    v_mov_b32 v9, s38
    s_lshl_b32 s40, s36, 9
    s_lshl_b32 s41, s26, 7
    s_add_u32 s40, s40, s41
    s_add_u32 s40, s40, 8192000
    v_lshlrev_b32 v10, 3, v1
    s_mov_b64 exec, 0xffff
    buffer_store_dwordx2 v[8:9], v10, s[28:31], s40 offen sc1
    s_mov_b64 exec, -1
    v_fma_f32 v4, v104, v124, v120
    v_mul_f32 v4, v4, v105
    v_cvt_pk_bf16_f32 v4, v4, v4
    v_ashrrev_i32 v5, 31, v4
    v_or_b32 v5, 0x80000000, v5
    v_xor_b32 v4, v4, v5
    v_and_b32 v4, 0xffff0000, v4
    v_max_u32 v4, 0x10000, v4
    s_lshl_b32 s40, s26, 4
    v_add_u32 v5, s40, v3
    v_sub_u32 v6, 63, v5
    v_or_b32 v4, v4, v6
    v_lshlrev_b32 v5, 2, v5
    v_add_u32 v5, 132608, v5
    ds_write_b32 v5, v4
    s_waitcnt lgkmcnt(0)
    s_barrier
    s_cmp_lg_u32 s26, 0
    s_cbranch_scc1 Lpub_done
    s_setprio 3
    v_add_u32 v5, 132608, v12
    ds_read_b32 v6, v5
    s_waitcnt lgkmcnt(0)
    v_mov_b32 v4, v6
    s_nop 1
    v_max_u32_dpp v4, v4, v4 row_ror:8 row_mask:0xf bank_mask:0xf
    s_nop 1
    v_max_u32_dpp v4, v4, v4 row_ror:4 row_mask:0xf bank_mask:0xf
    s_nop 1
    v_max_u32_dpp v4, v4, v4 row_ror:2 row_mask:0xf bank_mask:0xf
    s_nop 1
    v_max_u32_dpp v4, v4, v4 row_ror:1 row_mask:0xf bank_mask:0xf
    s_nop 0
    v_readlane_b32 s63, v4, 0
    v_readlane_b32 s40, v4, 16
    v_readlane_b32 s41, v4, 32
    v_readlane_b32 s42, v4, 48
    s_max_u32 s63, s63, s40
    s_max_u32 s41, s41, s42
    s_max_u32 s63, s63, s41
    v_cmp_eq_u32 vcc, s63, v6
    s_nop 1
    v_cndmask_b32 v4, v6, 0, vcc
    s_nop 1
    v_max_u32_dpp v4, v4, v4 row_ror:8 row_mask:0xf bank_mask:0xf
    s_nop 1
    v_max_u32_dpp v4, v4, v4 row_ror:4 row_mask:0xf bank_mask:0xf
    s_nop 1
    v_max_u32_dpp v4, v4, v4 row_ror:2 row_mask:0xf bank_mask:0xf
    s_nop 1
    v_max_u32_dpp v4, v4, v4 row_ror:1 row_mask:0xf bank_mask:0xf
    s_nop 0
    v_readlane_b32 s72, v4, 0
    v_readlane_b32 s40, v4, 16
    v_readlane_b32 s41, v4, 32
    v_readlane_b32 s42, v4, 48
    s_max_u32 s72, s72, s40
    s_max_u32 s41, s41, s42
    s_max_u32 s72, s72, s41
    s_and_b32 s40, s63, 0xffff0000
    s_lshr_b32 s41, s72, 16
    s_or_b32 s40, s40, s41
    s_and_b32 s41, s63, 63
    s_and_b32 s42, s72, 63
    s_lshl_b32 s42, s42, 6
    s_or_b32 s41, s41, s42
    s_xor_b32 s41, s41, 0x8fff
    s_lshl_b32 s42, s36, 2
    s_lshl_b32 s43, s36, 1
    v_mov_b32 v4, s40
    v_mov_b32 v5, s41
    v_mov_b32 v6, s42
    v_mov_b32 v7, s43
    s_mov_b64 exec, 1
    buffer_store_dword v4, v6, s[32:35], 0 offen offset:64 sc1
    buffer_store_short v5, v7, s[32:35], 0 offen offset:192 sc1
    s_mov_b64 exec, -1
    s_mov_b64 exec, 1
    s_lshl_b32 s40, s2, 2
    s_add_u32 s40, s40, 8323072
    v_mov_b32 v4, s38
    v_mov_b32 v5, s40
    buffer_store_dword v4, v5, s[28:31], 0 offen sc1
    s_mov_b64 exec, -1
Lpub_done:
    s_cmp_ge_u32 s36, 27
    s_cbranch_scc1 Lend
    s_add_u32 m0, s44, 4096
    s_add_u32 s45, s46, 0
    buffer_load_dwordx4 v18, s[48:51], s45 offen nt lds
    buffer_load_dwordx4 v19, s[48:51], s45 offen offset:1024 nt lds
    buffer_load_dwordx4 v20, s[48:51], s45 offen offset:2048 nt lds
    buffer_load_dwordx4 v21, s[48:51], s45 offen offset:3072 nt lds
    s_add_u32 m0, s44, 8192
    s_add_u32 s45, s46, 442368
    buffer_load_dwordx4 v18, s[48:51], s45 offen nt lds
    buffer_load_dwordx4 v19, s[48:51], s45 offen offset:1024 nt lds
    buffer_load_dwordx4 v20, s[48:51], s45 offen offset:2048 nt lds
    buffer_load_dwordx4 v21, s[48:51], s45 offen offset:3072 nt lds
    s_add_u32 m0, s44, 12288
    s_add_u32 s45, s46, 884736
    buffer_load_dwordx4 v18, s[48:51], s45 offen nt lds
    buffer_load_dwordx4 v19, s[48:51], s45 offen offset:1024 nt lds
    buffer_load_dwordx4 v20, s[48:51], s45 offen offset:2048 nt lds
    buffer_load_dwordx4 v21, s[48:51], s45 offen offset:3072 nt lds
    s_add_u32 m0, s44, 0
    s_add_u32 s45, s46, 1327104
    buffer_load_dwordx4 v18, s[48:51], s45 offen nt lds
    buffer_load_dwordx4 v19, s[48:51], s45 offen offset:1024 nt lds
    buffer_load_dwordx4 v20, s[48:51], s45 offen offset:2048 nt lds
    buffer_load_dwordx4 v21, s[48:51], s45 offen offset:3072 nt lds
    s_waitcnt vmcnt(12)
    ds_read_b64_tr_b16 a[0:1], v14 offset:4096
    ds_read_b64_tr_b16 a[2:3], v14 offset:4608
    ds_read_b64_tr_b16 a[4:5], v15 offset:4096
    ds_read_b64_tr_b16 a[6:7], v15 offset:4608
    ds_read_b64_tr_b16 a[8:9], v16 offset:4096
    ds_read_b64_tr_b16 a[10:11], v16 offset:4608
    ds_read_b64_tr_b16 a[12:13], v17 offset:4096
    ds_read_b64_tr_b16 a[14:15], v17 offset:4608
    s_waitcnt lgkmcnt(0)
    s_add_u32 m0, s44, 4096
    s_add_u32 s45, s46, 1769472
    buffer_load_dwordx4 v18, s[48:51], s45 offen nt lds
    buffer_load_dwordx4 v19, s[48:51], s45 offen offset:1024 nt lds
    buffer_load_dwordx4 v20, s[48:51], s45 offen offset:2048 nt lds
    buffer_load_dwordx4 v21, s[48:51], s45 offen offset:3072 nt lds
    s_waitcnt vmcnt(12)
    ds_read_b64_tr_b16 a[16:17], v14 offset:8192
    ds_read_b64_tr_b16 a[18:19], v14 offset:8704
    ds_read_b64_tr_b16 a[20:21], v15 offset:8192
    ds_read_b64_tr_b16 a[22:23], v15 offset:8704
    ds_read_b64_tr_b16 a[24:25], v16 offset:8192
    ds_read_b64_tr_b16 a[26:27], v16 offset:8704
    ds_read_b64_tr_b16 a[28:29], v17 offset:8192
    ds_read_b64_tr_b16 a[30:31], v17 offset:8704
    buffer_load_dwordx4 v[112:115], off, s[28:31], s62 sc1
    s_waitcnt lgkmcnt(0)
    s_add_u32 m0, s44, 8192
    s_add_u32 s45, s47, 0
    buffer_load_dwordx4 v22, s[52:55], s45 offen nt lds
    buffer_load_dwordx4 v23, s[52:55], s45 offen offset:1024 nt lds
    buffer_load_dwordx4 v24, s[52:55], s45 offen offset:2048 nt lds
    buffer_load_dwordx4 v25, s[52:55], s45 offen offset:3072 nt lds
    s_waitcnt vmcnt(13)
    ds_read_b64_tr_b16 a[32:33], v14 offset:12288
    ds_read_b64_tr_b16 a[34:35], v14 offset:12800
    ds_read_b64_tr_b16 a[36:37], v15 offset:12288
    ds_read_b64_tr_b16 a[38:39], v15 offset:12800
    ds_read_b64_tr_b16 a[40:41], v16 offset:12288
    ds_read_b64_tr_b16 a[42:43], v16 offset:12800
    ds_read_b64_tr_b16 a[44:45], v17 offset:12288
    ds_read_b64_tr_b16 a[46:47], v17 offset:12800
    s_waitcnt lgkmcnt(0)
    s_add_u32 m0, s44, 12288
    s_add_u32 s45, s47, 40960
    buffer_load_dwordx4 v22, s[52:55], s45 offen nt lds
    buffer_load_dwordx4 v23, s[52:55], s45 offen offset:1024 nt lds
    buffer_load_dwordx4 v24, s[52:55], s45 offen offset:2048 nt lds
    buffer_load_dwordx4 v25, s[52:55], s45 offen offset:3072 nt lds
    s_waitcnt vmcnt(13)
    ds_read_b64_tr_b16 a[48:49], v14 offset:0
    ds_read_b64_tr_b16 a[50:51], v14 offset:512
    ds_read_b64_tr_b16 a[52:53], v15 offset:0
    ds_read_b64_tr_b16 a[54:55], v15 offset:512
    ds_read_b64_tr_b16 a[56:57], v16 offset:0
    ds_read_b64_tr_b16 a[58:59], v16 offset:512
    ds_read_b64_tr_b16 a[60:61], v17 offset:0
    ds_read_b64_tr_b16 a[62:63], v17 offset:512
    s_waitcnt vmcnt(9)
    ds_read_b64_tr_b16 a[64:65], v14 offset:4096
    ds_read_b64_tr_b16 a[66:67], v14 offset:4608
    ds_read_b64_tr_b16 a[68:69], v15 offset:4096
    ds_read_b64_tr_b16 a[70:71], v15 offset:4608
    ds_read_b64_tr_b16 a[72:73], v16 offset:4096
    ds_read_b64_tr_b16 a[74:75], v16 offset:4608
    ds_read_b64_tr_b16 a[76:77], v17 offset:4096
    ds_read_b64_tr_b16 a[78:79], v17 offset:4608
    s_waitcnt vmcnt(8)
Lbc0:
    v_readfirstlane_b32 s40, v112
    v_readfirstlane_b32 s42, v113
    v_readfirstlane_b32 s41, v114
    v_readfirstlane_b32 s43, v115
    s_cmp_eq_u32 s42, s38
    s_cselect_b32 s43, s43, s42
    s_cmp_eq_u32 s43, s38
    s_cbranch_scc1 Lbc_ok0
    s_sub_u32 s39, s39, 1
    s_cbranch_scc1 Lend
    buffer_load_dwordx4 v[112:115], off, s[28:31], s62 sc1
    s_waitcnt vmcnt(0)
    s_branch Lbc0
Lbc_ok0:
    s_and_b32 s40, s40, 0x7ff
    s_sub_u32 s40, 2047, s40
    s_and_b32 s41, s41, 0x7ff
    s_sub_u32 s41, 2047, s41
    v_mov_b32 v4, s40
    v_mov_b32 v5, s41
    s_mov_b32 vcc_lo, 0xaaaaaaaa
    s_mov_b32 vcc_hi, 0xaaaaaaaa
    v_cndmask_b32 v4, v4, v5, vcc
    v_lshlrev_b32 v118, 3, v4
    v_add_u32 v118, 8192000, v118
    v_mul_u32_u24 v4, 1280, v4
    v_add_u32 v4, v4, v26
    v_mov_b32 v92, 0x3f803f80
    v_mov_b32 v93, 0x3f803f80
    v_mov_b32 v94, 0x3f803f80
    v_mov_b32 v95, 0x3f803f80
    v_mov_b32 v96, 0x3f803f80
    v_mov_b32 v97, 0x3f803f80
    v_mov_b32 v98, 0x3f803f80
    v_mov_b32 v99, 0x3f803f80
    v_mov_b32 v100, 0x3f803f80
    v_mov_b32 v101, 0x3f803f80
    v_mov_b32 v102, 0x3f803f80
    v_mov_b32 v103, 0x3f803f80
    v_mov_b32 v104, 0x3f803f80
    v_mov_b32 v105, 0x3f803f80
    v_mov_b32 v106, 0x3f803f80
    v_mov_b32 v107, 0x3f803f80
    v_mov_b32 v108, 0x3f803f80
    v_mov_b32 v109, 0x3f803f80
    v_mov_b32 v110, 0x3f803f80
    v_mov_b32 v111, 0x3f803f80
    s_mov_b32 exec_lo, 0x00030003
    s_mov_b32 exec_hi, 0x00030003
    buffer_load_dwordx4 v[92:95], v4, s[56:59], 0 offen offset:0
    buffer_load_dwordx4 v[96:99], v4, s[56:59], 0 offen offset:256
    buffer_load_dwordx4 v[100:103], v4, s[56:59], 0 offen offset:512
    buffer_load_dwordx4 v[104:107], v4, s[56:59], 0 offen offset:768
    buffer_load_dwordx4 v[108:111], v4, s[56:59], 0 offen offset:1024
    buffer_load_dwordx2 v[116:117], v118, s[28:31], 0 offen sc1
    s_mov_b64 exec, -1
    s_waitcnt vmcnt(10)
    ds_read_b64_tr_b16 v[28:29], v14 offset:8192
    ds_read_b64_tr_b16 v[30:31], v14 offset:8704
    ds_read_b64_tr_b16 v[32:33], v15 offset:8192
    ds_read_b64_tr_b16 v[34:35], v15 offset:8704
    ds_read_b64_tr_b16 v[36:37], v16 offset:8192
    ds_read_b64_tr_b16 v[38:39], v16 offset:8704
    ds_read_b64_tr_b16 v[40:41], v17 offset:8192
    ds_read_b64_tr_b16 v[42:43], v17 offset:8704
    s_waitcnt vmcnt(6)
    ds_read_b64_tr_b16 v[44:45], v14 offset:12288
    ds_read_b64_tr_b16 v[46:47], v14 offset:12800
    ds_read_b64_tr_b16 v[48:49], v15 offset:12288
    ds_read_b64_tr_b16 v[50:51], v15 offset:12800
    ds_read_b64_tr_b16 v[52:53], v16 offset:12288
    ds_read_b64_tr_b16 v[54:55], v16 offset:12800
    ds_read_b64_tr_b16 v[56:57], v17 offset:12288
    ds_read_b64_tr_b16 v[58:59], v17 offset:12800
    s_branch Laux_mm
Laux_u:
    s_cmp_ge_u32 s36, 27
    s_cbranch_scc1 Lend
    v_and_b32 v8, 1, v2
    v_lshlrev_b32 v8, 1, v8
    v_xor_b32 v8, v8, v6
    v_lshlrev_b32 v8, 4, v8
    v_mul_u32_u24 v9, 3456, v5
    s_lshl_b32 s42, s36, 7
    v_add3_u32 v18, v9, v8, s42
    v_xor_b32 v19, 64, v18
    v_add_u32 v19, 26624, v19
    v_add_u32 v20, 53248, v18
    v_add_u32 v21, 53248, v19
    s_mul_i32 s46, s26, 110592
    v_mul_u32_u24 v9, 1280, v5
    v_add_u32 v22, v9, v8
    v_xor_b32 v23, 64, v22
    v_add_u32 v23, 9216, v23
    v_add_u32 v24, 18432, v22
    v_add_u32 v25, 18432, v23
    s_mul_i32 s47, s36, 81920
    s_lshl_b32 s42, s3, 7
    s_add_u32 s47, s47, s42
    s_waitcnt lgkmcnt(0)
    s_mov_b64 s[48:49], s[16:17]
    s_mov_b32 s50, 2211840
    s_mov_b32 s51, 0x20000
    s_mov_b64 s[28:29], s[24:25]
    s_mov_b32 s30, 268435456
    s_mov_b32 s31, 0x20000
    s_mov_b64 s[32:33], s[22:23]
    s_mov_b32 s34, 256
    s_mov_b32 s35, 0x20000
    s_load_dword s38, s[28:29], 0
    s_sub_u32 s56, s4, 4096
    s_subb_u32 s57, s5, 0
    s_mov_b32 s58, 2625536
    s_mov_b32 s59, 0x20000
    s_mov_b64 s[52:53], s[18:19]
    s_mov_b32 s54, 2211840
    s_mov_b32 s55, 0x20000
    s_mov_b64 s[76:77], s[18:19]
    s_mov_b32 s78, 2211840
    s_mov_b32 s79, 0x20000
    s_cmp_ge_u32 s26, 2
    s_cselect_b32 s78, 0, s78
    s_lshl_b32 s62, s2, 7
    s_add_u32 s62, s62, 8257536
    v_bfe_u32 v10, v1, 2, 2
    v_and_b32 v8, 3, v1
    v_lshl_add_u32 v14, v2, 3, v10
    v_lshlrev_b32 v14, 7, v14
    v_lshlrev_b32 v9, 2, v1
    v_and_b32 v9, 0x60, v9
    v_add3_u32 v14, v14, v9, s44
    v_lshl_add_u32 v14, v8, 3, v14
    v_xor_b32 v15, 32, v14
    v_xor_b32 v16, 64, v14
    v_xor_b32 v17, 96, v14
    s_lshl_b32 s40, s26, 6
    s_add_u32 s40, s40, 4096
    v_lshl_add_u32 v26, v2, 4, s40
    s_waitcnt lgkmcnt(0)
    s_add_u32 s38, s38, 0x9e3779b8
    s_or_b32 s38, s38, 1
    s_barrier
    s_add_u32 m0, s44, 0
    s_add_u32 s45, s46, 0
    buffer_load_dwordx4 v18, s[48:51], s45 offen nt lds
    buffer_load_dwordx4 v19, s[48:51], s45 offen offset:1024 nt lds
    buffer_load_dwordx4 v20, s[48:51], s45 offen offset:2048 nt lds
    buffer_load_dwordx4 v21, s[48:51], s45 offen offset:3072 nt lds
    s_add_u32 m0, s44, 4096
    s_add_u32 s45, s46, 442368
    buffer_load_dwordx4 v18, s[48:51], s45 offen nt lds
    buffer_load_dwordx4 v19, s[48:51], s45 offen offset:1024 nt lds
    buffer_load_dwordx4 v20, s[48:51], s45 offen offset:2048 nt lds
    buffer_load_dwordx4 v21, s[48:51], s45 offen offset:3072 nt lds
    s_add_u32 m0, s44, 8192
    s_add_u32 s45, s46, 884736
    buffer_load_dwordx4 v18, s[48:51], s45 offen nt lds
    buffer_load_dwordx4 v19, s[48:51], s45 offen offset:1024 nt lds
    buffer_load_dwordx4 v20, s[48:51], s45 offen offset:2048 nt lds
    buffer_load_dwordx4 v21, s[48:51], s45 offen offset:3072 nt lds
    s_add_u32 m0, s44, 12288
    s_add_u32 s45, s46, 1327104
    buffer_load_dwordx4 v18, s[48:51], s45 offen nt lds
    buffer_load_dwordx4 v19, s[48:51], s45 offen offset:1024 nt lds
    buffer_load_dwordx4 v20, s[48:51], s45 offen offset:2048 nt lds
    buffer_load_dwordx4 v21, s[48:51], s45 offen offset:3072 nt lds
    s_barrier
    s_waitcnt vmcnt(12)
    ds_read_b64_tr_b16 a[0:1], v14 offset:0
    ds_read_b64_tr_b16 a[2:3], v14 offset:512
    ds_read_b64_tr_b16 a[4:5], v15 offset:0
    ds_read_b64_tr_b16 a[6:7], v15 offset:512
    ds_read_b64_tr_b16 a[8:9], v16 offset:0
    ds_read_b64_tr_b16 a[10:11], v16 offset:512
    ds_read_b64_tr_b16 a[12:13], v17 offset:0
    ds_read_b64_tr_b16 a[14:15], v17 offset:512
    s_waitcnt lgkmcnt(0)
    s_add_u32 m0, s44, 0
    s_add_u32 s45, s46, 1769472
    buffer_load_dwordx4 v18, s[48:51], s45 offen nt lds
    buffer_load_dwordx4 v19, s[48:51], s45 offen offset:1024 nt lds
    buffer_load_dwordx4 v20, s[48:51], s45 offen offset:2048 nt lds
    buffer_load_dwordx4 v21, s[48:51], s45 offen offset:3072 nt lds
    s_waitcnt vmcnt(12)
    ds_read_b64_tr_b16 a[16:17], v14 offset:4096
    ds_read_b64_tr_b16 a[18:19], v14 offset:4608
    ds_read_b64_tr_b16 a[20:21], v15 offset:4096
    ds_read_b64_tr_b16 a[22:23], v15 offset:4608
    ds_read_b64_tr_b16 a[24:25], v16 offset:4096
    ds_read_b64_tr_b16 a[26:27], v16 offset:4608
    ds_read_b64_tr_b16 a[28:29], v17 offset:4096
    ds_read_b64_tr_b16 a[30:31], v17 offset:4608
    s_waitcnt lgkmcnt(0)
    s_add_u32 m0, s44, 4096
    s_add_u32 s45, s47, 0
    buffer_load_dwordx4 v22, s[52:55], s45 offen nt lds
    buffer_load_dwordx4 v23, s[52:55], s45 offen offset:1024 nt lds
    buffer_load_dwordx4 v24, s[52:55], s45 offen offset:2048 nt lds
    buffer_load_dwordx4 v25, s[52:55], s45 offen offset:3072 nt lds
    s_waitcnt vmcnt(12)
    ds_read_b64_tr_b16 a[32:33], v14 offset:8192
    ds_read_b64_tr_b16 a[34:35], v14 offset:8704
    ds_read_b64_tr_b16 a[36:37], v15 offset:8192
    ds_read_b64_tr_b16 a[38:39], v15 offset:8704
    ds_read_b64_tr_b16 a[40:41], v16 offset:8192
    ds_read_b64_tr_b16 a[42:43], v16 offset:8704
    ds_read_b64_tr_b16 a[44:45], v17 offset:8192
    ds_read_b64_tr_b16 a[46:47], v17 offset:8704
    s_waitcnt lgkmcnt(0)
    s_add_u32 m0, s44, 8192
    s_add_u32 s45, s47, 40960
    buffer_load_dwordx4 v22, s[52:55], s45 offen nt lds
    buffer_load_dwordx4 v23, s[52:55], s45 offen offset:1024 nt lds
    buffer_load_dwordx4 v24, s[52:55], s45 offen offset:2048 nt lds
    buffer_load_dwordx4 v25, s[52:55], s45 offen offset:3072 nt lds
    s_waitcnt vmcnt(12)
    ds_read_b64_tr_b16 a[48:49], v14 offset:12288
    ds_read_b64_tr_b16 a[50:51], v14 offset:12800
    ds_read_b64_tr_b16 a[52:53], v15 offset:12288
    ds_read_b64_tr_b16 a[54:55], v15 offset:12800
    ds_read_b64_tr_b16 a[56:57], v16 offset:12288
    ds_read_b64_tr_b16 a[58:59], v16 offset:12800
    ds_read_b64_tr_b16 a[60:61], v17 offset:12288
    ds_read_b64_tr_b16 a[62:63], v17 offset:12800
    buffer_load_dwordx4 v[112:115], off, s[28:31], s62 sc1
    s_waitcnt lgkmcnt(0)
    s_add_u32 m0, s44, 12288
    s_add_u32 s45, s47, 512
    buffer_load_dwordx4 v22, s[76:79], s45 offen nt lds
    buffer_load_dwordx4 v23, s[76:79], s45 offen offset:1024 nt lds
    buffer_load_dwordx4 v24, s[76:79], s45 offen offset:2048 nt lds
    buffer_load_dwordx4 v25, s[76:79], s45 offen offset:3072 nt lds
    s_waitcnt vmcnt(13)
    ds_read_b64_tr_b16 a[64:65], v14 offset:0
    ds_read_b64_tr_b16 a[66:67], v14 offset:512
    ds_read_b64_tr_b16 a[68:69], v15 offset:0
    ds_read_b64_tr_b16 a[70:71], v15 offset:512
    ds_read_b64_tr_b16 a[72:73], v16 offset:0
    ds_read_b64_tr_b16 a[74:75], v16 offset:512
    ds_read_b64_tr_b16 a[76:77], v17 offset:0
    ds_read_b64_tr_b16 a[78:79], v17 offset:512
    s_waitcnt lgkmcnt(0)
    s_add_u32 m0, s44, 0
    s_add_u32 s45, s47, 41472
    buffer_load_dwordx4 v22, s[76:79], s45 offen nt lds
    buffer_load_dwordx4 v23, s[76:79], s45 offen offset:1024 nt lds
    buffer_load_dwordx4 v24, s[76:79], s45 offen offset:2048 nt lds
    buffer_load_dwordx4 v25, s[76:79], s45 offen offset:3072 nt lds
    s_waitcnt vmcnt(13)
    ds_read_b64_tr_b16 v[28:29], v14 offset:4096
    ds_read_b64_tr_b16 v[30:31], v14 offset:4608
    ds_read_b64_tr_b16 v[32:33], v15 offset:4096
    ds_read_b64_tr_b16 v[34:35], v15 offset:4608
    ds_read_b64_tr_b16 v[36:37], v16 offset:4096
    ds_read_b64_tr_b16 v[38:39], v16 offset:4608
    ds_read_b64_tr_b16 v[40:41], v17 offset:4096
    ds_read_b64_tr_b16 v[42:43], v17 offset:4608
    s_waitcnt vmcnt(9)
    ds_read_b64_tr_b16 v[44:45], v14 offset:8192
    ds_read_b64_tr_b16 v[46:47], v14 offset:8704
    ds_read_b64_tr_b16 v[48:49], v15 offset:8192
    ds_read_b64_tr_b16 v[50:51], v15 offset:8704
    ds_read_b64_tr_b16 v[52:53], v16 offset:8192
    ds_read_b64_tr_b16 v[54:55], v16 offset:8704
    ds_read_b64_tr_b16 v[56:57], v17 offset:8192
    ds_read_b64_tr_b16 v[58:59], v17 offset:8704
    s_waitcnt vmcnt(8)
Lbc1:
    v_readfirstlane_b32 s40, v112
    v_readfirstlane_b32 s42, v113
    v_readfirstlane_b32 s41, v114
    v_readfirstlane_b32 s43, v115
    s_cmp_eq_u32 s42, s38
    s_cselect_b32 s43, s43, s42
    s_cmp_eq_u32 s43, s38
    s_cbranch_scc1 Lbc_ok1
    s_sub_u32 s39, s39, 1
    s_cbranch_scc1 Lend
    buffer_load_dwordx4 v[112:115], off, s[28:31], s62 sc1
    s_waitcnt vmcnt(0)
    s_branch Lbc1
Lbc_ok1:
    s_and_b32 s40, s40, 0x7ff
    s_sub_u32 s40, 2047, s40
    s_and_b32 s41, s41, 0x7ff
    s_sub_u32 s41, 2047, s41
    v_mov_b32 v4, s40
    v_mov_b32 v5, s41
    s_mov_b32 vcc_lo, 0xaaaaaaaa
    s_mov_b32 vcc_hi, 0xaaaaaaaa
    v_cndmask_b32 v4, v4, v5, vcc
    v_lshlrev_b32 v118, 3, v4
    v_add_u32 v118, 8192000, v118
    v_mul_u32_u24 v4, 1280, v4
    v_add_u32 v4, v4, v26
    v_mov_b32 v92, 0x3f803f80
    v_mov_b32 v93, 0x3f803f80
    v_mov_b32 v94, 0x3f803f80
    v_mov_b32 v95, 0x3f803f80
    v_mov_b32 v96, 0x3f803f80
    v_mov_b32 v97, 0x3f803f80
    v_mov_b32 v98, 0x3f803f80
    v_mov_b32 v99, 0x3f803f80
    v_mov_b32 v100, 0x3f803f80
    v_mov_b32 v101, 0x3f803f80
    v_mov_b32 v102, 0x3f803f80
    v_mov_b32 v103, 0x3f803f80
    v_mov_b32 v104, 0x3f803f80
    v_mov_b32 v105, 0x3f803f80
    v_mov_b32 v106, 0x3f803f80
    v_mov_b32 v107, 0x3f803f80
    v_mov_b32 v108, 0x3f803f80
    v_mov_b32 v109, 0x3f803f80
    v_mov_b32 v110, 0x3f803f80
    v_mov_b32 v111, 0x3f803f80
    s_mov_b32 exec_lo, 0x00030003
    s_mov_b32 exec_hi, 0x00030003
    buffer_load_dwordx4 v[92:95], v4, s[56:59], 0 offen offset:0
    buffer_load_dwordx4 v[96:99], v4, s[56:59], 0 offen offset:256
    buffer_load_dwordx4 v[100:103], v4, s[56:59], 0 offen offset:512
    buffer_load_dwordx4 v[104:107], v4, s[56:59], 0 offen offset:768
    buffer_load_dwordx4 v[108:111], v4, s[56:59], 0 offen offset:1024
    buffer_load_dwordx2 v[116:117], v118, s[28:31], 0 offen sc1
    s_mov_b64 exec, -1
    s_waitcnt vmcnt(10)
    ds_read_b64_tr_b16 v[60:61], v14 offset:12288
    ds_read_b64_tr_b16 v[62:63], v14 offset:12800
    ds_read_b64_tr_b16 v[64:65], v15 offset:12288
    ds_read_b64_tr_b16 v[66:67], v15 offset:12800
    ds_read_b64_tr_b16 v[68:69], v16 offset:12288
    ds_read_b64_tr_b16 v[70:71], v16 offset:12800
    ds_read_b64_tr_b16 v[72:73], v17 offset:12288
    ds_read_b64_tr_b16 v[74:75], v17 offset:12800
    s_waitcnt vmcnt(6)
    ds_read_b64_tr_b16 v[76:77], v14 offset:0
    ds_read_b64_tr_b16 v[78:79], v14 offset:512
    ds_read_b64_tr_b16 v[80:81], v15 offset:0
    ds_read_b64_tr_b16 v[82:83], v15 offset:512
    ds_read_b64_tr_b16 v[84:85], v16 offset:0
    ds_read_b64_tr_b16 v[86:87], v16 offset:512
    ds_read_b64_tr_b16 v[88:89], v17 offset:0
    ds_read_b64_tr_b16 v[90:91], v17 offset:512
Laux_mm:
    s_waitcnt vmcnt(0)
Lxs_chk:
    v_readlane_b32 s40, v117, 0
    v_readlane_b32 s41, v117, 1
    v_readlane_b32 s60, v116, 0
    v_readlane_b32 s61, v116, 1
    s_cmp_eq_u32 s40, s38
    s_cselect_b32 s41, s41, s40
    s_cmp_eq_u32 s41, s38
    s_cbranch_scc1 Lxs_ok
    s_sub_u32 s39, s39, 1
    s_cbranch_scc1 Lend
    buffer_load_dwordx2 v[116:117], v118, s[28:31], 0 offen sc1
    s_waitcnt vmcnt(0)
    s_branch Lxs_chk
Lxs_ok:
    s_waitcnt lgkmcnt(0)
    v_mfma_f32_16x16x32_bf16 v[112:115], a[0:3], v[92:95], 0
    v_mfma_f32_16x16x32_bf16 v[116:119], a[4:7], v[92:95], 0
    v_mfma_f32_16x16x32_bf16 v[120:123], a[8:11], v[92:95], 0
    v_mfma_f32_16x16x32_bf16 v[124:127], a[12:15], v[92:95], 0
    v_mfma_f32_16x16x32_bf16 v[112:115], a[16:19], v[96:99], v[112:115]
    v_mfma_f32_16x16x32_bf16 v[116:119], a[20:23], v[96:99], v[116:119]
    v_mfma_f32_16x16x32_bf16 v[120:123], a[24:27], v[96:99], v[120:123]
    v_mfma_f32_16x16x32_bf16 v[124:127], a[28:31], v[96:99], v[124:127]
    v_mfma_f32_16x16x32_bf16 v[112:115], a[32:35], v[100:103], v[112:115]
    v_mfma_f32_16x16x32_bf16 v[116:119], a[36:39], v[100:103], v[116:119]
    v_mfma_f32_16x16x32_bf16 v[120:123], a[40:43], v[100:103], v[120:123]
    v_mfma_f32_16x16x32_bf16 v[124:127], a[44:47], v[100:103], v[124:127]
    v_mfma_f32_16x16x32_bf16 v[112:115], a[48:51], v[104:107], v[112:115]
    v_mfma_f32_16x16x32_bf16 v[116:119], a[52:55], v[104:107], v[116:119]
    v_mfma_f32_16x16x32_bf16 v[120:123], a[56:59], v[104:107], v[120:123]
    v_mfma_f32_16x16x32_bf16 v[124:127], a[60:63], v[104:107], v[124:127]
    v_mfma_f32_16x16x32_bf16 v[112:115], a[64:67], v[108:111], v[112:115]
    v_mfma_f32_16x16x32_bf16 v[116:119], a[68:71], v[108:111], v[116:119]
    v_mfma_f32_16x16x32_bf16 v[120:123], a[72:75], v[108:111], v[120:123]
    v_mfma_f32_16x16x32_bf16 v[124:127], a[76:79], v[108:111], v[124:127]
    s_mul_i32 s40, s3, 768
    s_add_u32 s40, s40, 133120
    v_lshlrev_b32 v4, 8, v3
    v_lshl_add_u32 v4, v2, 4, v4
    v_add_u32 v4, s40, v4
    v_add_u32 v5, 133120, v12
    s_lshl_b32 s41, s3, 8
    s_add_u32 s41, s41, 139264
    v_lshl_add_u32 v6, v1, 1, s41
    v_and_b32 v7, 1, v1
    v_lshlrev_b32 v7, 7, v7
    v_lshl_add_u32 v7, v2, 4, v7
    v_add_u32 v7, s41, v7
    s_lshl_b32 s42, s60, 16
    s_lshl_b32 s43, s61, 16
    v_rcp_f32 v8, s42
    v_rcp_f32 v9, s43
    s_and_b32 s60, s60, 0xffff0000
    s_and_b32 s61, s61, 0xffff0000
    s_mov_b32 exec_lo, 0x00070007
    s_mov_b32 exec_hi, 0x00070007
    ds_write_b128 v4, v[112:115] offset:0
    ds_write_b128 v4, v[116:119] offset:64
    ds_write_b128 v4, v[120:123] offset:128
    ds_write_b128 v4, v[124:127] offset:192
    s_mov_b64 exec, -1
    s_waitcnt lgkmcnt(0)
    s_barrier
    ds_read2st64_b32 v[92:93], v5 offset0:0 offset1:1
    ds_read2st64_b32 v[94:95], v5 offset0:2 offset1:3
    ds_read2st64_b32 v[96:97], v5 offset0:4 offset1:5
    ds_read2st64_b32 v[98:99], v5 offset0:6 offset1:7
    ds_read2st64_b32 v[100:101], v5 offset0:8 offset1:9
    ds_read2st64_b32 v[102:103], v5 offset0:10 offset1:11
    ds_read2st64_b32 v[116:117], v5 offset0:12 offset1:13
    ds_read2st64_b32 v[118:119], v5 offset0:14 offset1:15
    ds_read2st64_b32 v[120:121], v5 offset0:16 offset1:17
    ds_read2st64_b32 v[122:123], v5 offset0:18 offset1:19
    ds_read2st64_b32 v[124:125], v5 offset0:20 offset1:21
    ds_read2st64_b32 v[126:127], v5 offset0:22 offset1:23
    v_cmp_eq_u32 s[74:75], 1, v2
    v_cmp_eq_u32 s[80:81], 2, v2
    v_cmp_eq_u32 s[82:83], 3, v2
    s_mul_i32 s41, s36, 10
    s_add_u32 s41, s41, s3
    s_lshl_b32 s41, s41, 10
    s_add_u32 s41, s41, 7405568
    s_waitcnt lgkmcnt(0)
    v_add_f32 v92, v92, v95
    v_add_f32 v98, v98, v101
    v_add_f32 v92, v92, v98
    v_add_f32 v93, v93, v96
    v_add_f32 v99, v99, v102
    v_add_f32 v93, v93, v99
    v_add_f32 v94, v94, v97
    v_add_f32 v100, v100, v103
    v_add_f32 v94, v94, v100
    v_add_f32 v116, v116, v119
    v_add_f32 v122, v122, v125
    v_add_f32 v116, v116, v122
    v_add_f32 v117, v117, v120
    v_add_f32 v123, v123, v126
    v_add_f32 v117, v117, v123
    v_add_f32 v118, v118, v121
    v_add_f32 v124, v124, v127
    v_add_f32 v118, v118, v124
    v_fmac_f32 v92, s60, v94
    v_mul_f32 v112, v92, v8
    v_fmac_f32 v93, s61, v94
    v_mul_f32 v113, v93, v9
    v_fmac_f32 v116, s60, v118
    v_mul_f32 v120, v116, v8
    v_fmac_f32 v117, s61, v118
    v_mul_f32 v121, v117, v9
    v_cvt_pk_bf16_f32 v113, v112, v113
    v_lshlrev_b32 v112, 16, v113
    v_and_b32 v113, 0xffff0000, v113
    v_cvt_pk_bf16_f32 v121, v120, v121
    v_lshlrev_b32 v120, 16, v121
    v_and_b32 v121, 0xffff0000, v121
    v_mul_f32 v114, 0xbfb8aa3b, v112
    v_mul_f32 v115, 0xbfb8aa3b, v113
    v_exp_f32 v114, v114
    v_exp_f32 v115, v115
    v_add_f32 v114, 1.0, v114
    v_add_f32 v115, 1.0, v115
    v_rcp_f32 v114, v114
    v_rcp_f32 v115, v115
    v_mul_f32 v114, v114, v112
    v_mul_f32 v115, v115, v113
    v_cvt_pk_bf16_f32 v115, v114, v115
    v_lshlrev_b32 v114, 16, v115
    v_and_b32 v115, 0xffff0000, v115
    v_mul_f32 v114, v114, v120
    v_mul_f32 v115, v115, v121
    v_cvt_pk_bf16_f32 v114, v114, v115
    ds_write_b16 v6, v114
    ds_write_b16_d16_hi v6, v114 offset:128
    ds_read_b128 v[92:95], v7 offset:0
    ds_read_b128 v[96:99], v7 offset:64
    v_mov_b32 v101, s38
    v_mov_b32 v103, s38
    s_waitcnt lgkmcnt(0)
    v_mfma_f32_16x16x32_bf16 v[112:115], v[92:95], v[28:31], 0
    v_mfma_f32_16x16x32_bf16 v[116:119], v[92:95], v[32:35], 0
    v_mfma_f32_16x16x32_bf16 v[120:123], v[92:95], v[36:39], 0
    v_mfma_f32_16x16x32_bf16 v[124:127], v[92:95], v[40:43], 0
    v_mfma_f32_16x16x32_bf16 v[112:115], v[96:99], v[44:47], v[112:115]
    v_mfma_f32_16x16x32_bf16 v[116:119], v[96:99], v[48:51], v[116:119]
    v_mfma_f32_16x16x32_bf16 v[120:123], v[96:99], v[52:55], v[120:123]
    v_mfma_f32_16x16x32_bf16 v[124:127], v[96:99], v[56:59], v[124:127]
    s_nop 5
    v_cndmask_b32 v100, v112, v116, s[74:75]
    v_cndmask_b32 v100, v100, v120, s[80:81]
    v_cndmask_b32 v100, v100, v124, s[82:83]
    v_cndmask_b32 v102, v113, v117, s[74:75]
    v_cndmask_b32 v102, v102, v121, s[80:81]
    v_cndmask_b32 v102, v102, v125, s[82:83]
    buffer_store_dwordx4 v[100:103], v13, s[28:31], s41 offen sc1
    s_sub_u32 s40, s3, 4
    s_cmp_ge_u32 s40, 2
    s_cbranch_scc1 Laux_end
    s_add_u32 s41, s41, 4096
    v_mfma_f32_16x16x32_bf16 v[112:115], v[92:95], v[60:63], 0
    v_mfma_f32_16x16x32_bf16 v[116:119], v[92:95], v[64:67], 0
    v_mfma_f32_16x16x32_bf16 v[120:123], v[92:95], v[68:71], 0
    v_mfma_f32_16x16x32_bf16 v[124:127], v[92:95], v[72:75], 0
    v_mfma_f32_16x16x32_bf16 v[112:115], v[96:99], v[76:79], v[112:115]
    v_mfma_f32_16x16x32_bf16 v[116:119], v[96:99], v[80:83], v[116:119]
    v_mfma_f32_16x16x32_bf16 v[120:123], v[96:99], v[84:87], v[120:123]
    v_mfma_f32_16x16x32_bf16 v[124:127], v[96:99], v[88:91], v[124:127]
    s_nop 5
    v_cndmask_b32 v100, v112, v116, s[74:75]
    v_cndmask_b32 v100, v100, v120, s[80:81]
    v_cndmask_b32 v100, v100, v124, s[82:83]
    v_cndmask_b32 v102, v113, v117, s[74:75]
    v_cndmask_b32 v102, v102, v121, s[80:81]
    v_cndmask_b32 v102, v102, v125, s[82:83]
    buffer_store_dwordx4 v[100:103], v13, s[28:31], s41 offen sc1
Laux_end:
    s_endpgm
Lmst:
    s_cmp_lg_u32 s3, 0
    s_cbranch_scc1 Lend
    s_waitcnt lgkmcnt(0)
    s_mov_b64 s[28:29], s[24:25]
    s_mov_b32 s30, 268435456
    s_mov_b32 s31, 0x20000
    s_mov_b64 s[32:33], s[22:23]
    s_mov_b32 s34, 256
    s_mov_b32 s35, 0x20000
    s_load_dword s38, s[28:29], 0
    s_waitcnt lgkmcnt(0)
    s_add_u32 s38, s38, 0x9e3779b8
    s_or_b32 s38, s38, 1
    s_mov_b64 exec, 1
    s_lshl_b32 s40, s2, 2
    s_add_u32 s40, s40, 8323072
    v_mov_b32 v4, s38
    v_mov_b32 v5, s40
    buffer_store_dword v4, v5, s[28:31], 0 offen sc1
    s_mov_b64 exec, -1
    s_cmp_lg_u32 s36, 32
    s_cbranch_scc1 Lend
Lmst_bc:
Lpt_6:
    s_sub_u32 s39, s39, 1
    s_cbranch_scc1 Lend
    buffer_load_dword v4, v12, s[32:35], 0 offen offset:64 sc1
    v_lshrrev_b32 v5, 1, v12
    v_and_b32 v5, 0x3c, v5
    v_add_u32 v5, 128, v5
    s_waitcnt vmcnt(0)
    ds_bpermute_b32 v5, v5, v4
    v_and_b32 v6, 4, v12
    v_lshlrev_b32 v6, 2, v6
    s_waitcnt lgkmcnt(0)
    v_bfe_u32 v5, v5, v6, 16
    v_cmp_ne_u32 vcc, 0, v4
    v_cmp_ne_u32 s[40:41], 0, v5
    s_nop 0
    s_and_b32 s40, s40, vcc_lo
    s_cmp_eq_u32 s40, -1
    s_cbranch_scc1 Lptd_7
    s_sleep 2
    s_branch Lpt_6
Lptd_7:
    v_lshlrev_b32 v6, 4, v12
    v_and_b32 v7, 63, v5
    v_add_u32 v7, v7, v6
    v_sub_u32 v7, 2047, v7
    v_bfe_u32 v5, v5, 6, 6
    v_add_u32 v5, v5, v6
    v_sub_u32 v5, 2047, v5
    v_and_b32 v6, 0xffff0000, v4
    v_or_b32 v7, v7, v6
    v_lshl_or_b32 v5, v4, 16, v5
    v_cmp_gt_u32 vcc, 128, v12
    s_nop 1
    v_cndmask_b32 v7, 0, v7, vcc
    v_cndmask_b32 v5, 0, v5, vcc
    v_mov_b32 v4, v7
    s_nop 1
    v_max_u32_dpp v4, v4, v4 row_ror:8 row_mask:0xf bank_mask:0xf
    s_nop 1
    v_max_u32_dpp v4, v4, v4 row_ror:4 row_mask:0xf bank_mask:0xf
    s_nop 1
    v_max_u32_dpp v4, v4, v4 row_ror:2 row_mask:0xf bank_mask:0xf
    s_nop 1
    v_max_u32_dpp v4, v4, v4 row_ror:1 row_mask:0xf bank_mask:0xf
    s_nop 0
    v_readlane_b32 s44, v4, 0
    v_readlane_b32 s40, v4, 16
    v_readlane_b32 s41, v4, 32
    v_readlane_b32 s42, v4, 48
    s_max_u32 s44, s44, s40
    s_max_u32 s41, s41, s42
    s_max_u32 s44, s44, s41
    v_cmp_eq_u32 vcc, s44, v7
    s_nop 1
    v_cndmask_b32 v4, v7, v5, vcc
    s_nop 1
    v_max_u32_dpp v4, v4, v4 row_ror:8 row_mask:0xf bank_mask:0xf
    s_nop 1
    v_max_u32_dpp v4, v4, v4 row_ror:4 row_mask:0xf bank_mask:0xf
    s_nop 1
    v_max_u32_dpp v4, v4, v4 row_ror:2 row_mask:0xf bank_mask:0xf
    s_nop 1
    v_max_u32_dpp v4, v4, v4 row_ror:1 row_mask:0xf bank_mask:0xf
    s_nop 0
    v_readlane_b32 s45, v4, 0
    v_readlane_b32 s40, v4, 16
    v_readlane_b32 s41, v4, 32
    v_readlane_b32 s42, v4, 48
    s_max_u32 s45, s45, s40
    s_max_u32 s41, s41, s42
    s_max_u32 s45, s45, s41
    v_mov_b32 v8, s44
    v_mov_b32 v9, s38
    v_mov_b32 v10, s45
    v_mov_b32 v11, s38
    v_lshlrev_b32 v4, 7, v1
    s_mov_b32 s40, 8257536
    buffer_store_dwordx4 v[8:11], v4, s[28:31], s40 offen sc1
    s_add_u32 s40, s40, 8192
    buffer_store_dwordx4 v[8:11], v4, s[28:31], s40 offen sc1
    s_add_u32 s40, s40, 8192
    buffer_store_dwordx4 v[8:11], v4, s[28:31], s40 offen sc1
    s_add_u32 s40, s40, 8192
    buffer_store_dwordx4 v[8:11], v4, s[28:31], s40 offen sc1
    s_add_u32 s40, s40, 8192
    s_mov_b32 s40, 8323072
Lmaster:
    s_sub_u32 s39, s39, 1
    s_cbranch_scc1 Lend
    s_sleep 16
    buffer_load_dwordx4 v[4:7], v13, s[28:31], s40 offen sc1
    s_waitcnt vmcnt(0)
    v_xor_b32 v4, s38, v4
    v_xor_b32 v5, s38, v5
    v_xor_b32 v6, s38, v6
    v_xor_b32 v7, s38, v7
    v_or3_b32 v4, v4, v5, v6
    v_or_b32 v4, v4, v7
    v_cmp_ne_u32 vcc, 0, v4
    s_nop 0
    s_cbranch_vccnz Lmaster
    s_mov_b64 exec, 1
    buffer_store_dword v9, v4, s[28:31], 0 offen sc1
Lend:
    s_endpgm
.section .rodata,"a"
.p2align 6
.amdhsa_kernel recurrent_scan__sliding_local_dilated__moe_arch_mod__prompt_kernel
  .amdhsa_next_free_vgpr 256
  .amdhsa_next_free_sgpr 102
  .amdhsa_accum_offset 128
  .amdhsa_group_segment_fixed_size 0
  .amdhsa_kernarg_size 88
  .amdhsa_user_sgpr_count 2
  .amdhsa_user_sgpr_kernarg_segment_ptr 1
  .amdhsa_system_sgpr_workgroup_id_x 1
  .amdhsa_float_denorm_mode_32 3
.end_amdhsa_kernel
```

```asm
; @launch grid=(256,1,1) block=(512,1,1) lds=163840
.amdgcn_target "amdgcn-amd-amdhsa--gfx950"
.text
.globl recurrent_scan__sliding_local_dilated__moe_arch_mod__prompt_kernel
.p2align 8
.type recurrent_scan__sliding_local_dilated__moe_arch_mod__prompt_kernel,@function
recurrent_scan__sliding_local_dilated__moe_arch_mod__prompt_kernel:
    s_load_dwordx16 s[4:19], s[0:1], 0
    s_load_dwordx4 s[20:23], s[0:1], 64
    s_load_dwordx2 s[24:25], s[0:1], 80
    v_lshrrev_b32 v4, 6, v0
    v_and_b32 v1, 63, v0
    s_cmp_ge_u32 s2, 256
    s_cbranch_scc1 Lend
    v_readfirstlane_b32 s3, v4
    s_getpc_b64 s[40:41]
Lpc:
    s_and_b32 s42, s2, 0xf8
    v_add_u32 v5, s42, v4
    v_and_b32 v6, 1, v0
    v_lshl_add_u32 v5, v5, 1, v6
    v_lshlrev_b32 v5, 7, v5
    v_min_u32 v5, Lend-Lpc, v5
    v_mov_b32 v7, s41
    v_add_co_u32 v6, vcc, s40, v5
    s_nop 1
    v_addc_co_u32 v7, vcc, 0, v7, vcc
    global_load_dword v0, v[6:7], off
    v_lshrrev_b32 v2, 4, v1
    v_and_b32 v3, 15, v1
    v_lshlrev_b32 v12, 2, v1
    v_lshlrev_b32 v13, 4, v1
    s_mov_b32 s39, 200000
    s_and_b32 s40, s2, 7
    s_lshr_b32 s41, s2, 3
    s_and_b32 s42, s40, 1
    s_lshr_b32 s40, s40, 1
    s_add_u32 s43, s42, 4
    s_and_b32 s26, s3, 3
    s_lshr_b32 s27, s3, 2
    s_cmp_lt_u32 s41, s43
    s_cbranch_scc1 Laux
    s_lshr_b32 s37, s40, 1
    s_and_b32 s40, s40, 1
    s_mul_i32 s40, s40, 55
    s_mul_i32 s42, s42, 28
    s_add_u32 s40, s40, s42
    s_add_u32 s40, s40, s41
    s_sub_u32 s40, s40, s43
    s_mul_i32 s36, s40, 13108
    s_lshr_b32 s36, s36, 16
    s_mul_i32 s41, s36, 5
    s_sub_u32 s40, s40, s41
    s_mul_i32 s37, s37, 5
    s_add_u32 s37, s37, s40
    s_add_u32 s46, s37, s36
    s_mul_i32 s40, s46, 13108
    s_lshr_b32 s40, s40, 16
    s_mul_i32 s40, s40, 5
    s_sub_u32 s46, s46, s40
    s_cmp_lg_u32 s3, 0
    s_cbranch_scc1 Lcomp
Lloader:
    s_setprio 3
    v_lshrrev_b32 v5, 3, v1
    v_and_b32 v6, 7, v1
    v_and_b32 v8, 1, v2
    v_lshlrev_b32 v8, 1, v8
    v_xor_b32 v8, v8, v6
    s_lshl_b32 s43, s37, 7
    v_lshl_add_u32 v50, v8, 4, s43
    v_mov_b32 v7, 3840
    v_mad_u32_u24 v28, v5, v7, v50
    v_xor_b32 v29, 64, v28
    v_add_u32 v29, 29696, v29
    v_add_u32 v30, 59392, v28
    v_add_u32 v31, 59392, v29
    v_add_u32 v32, 122880, v28
    v_add_u32 v33, 122880, v29
    v_add_u32 v34, 182272, v28
    v_add_u32 v35, 182272, v29
    s_mul_i32 s42, s36, 96
    s_sub_u32 s42, s42, 16
    v_add_u32 v7, s42, v5
    v_xor_b32 v9, v6, v2
    v_lshlrev_b32 v9, 4, v9
    v_xor_b32 v10, 64, v9
    v_mov_b32 v11, 2047
    v_mov_b32 v8, 1280
    v_add_u32 v36, 0, v7
    v_med3_i32 v36, v36, 0, v11
    v_mad_u32_u24 v36, v36, v8, v9
    v_add_u32 v36, 4096, v36
    v_add_u32 v37, 8, v7
    v_med3_i32 v37, v37, 0, v11
    v_mad_u32_u24 v37, v37, v8, v10
    v_add_u32 v37, 3072, v37
    v_add_u32 v38, 16, v7
    v_med3_i32 v38, v38, 0, v11
    v_mad_u32_u24 v38, v38, v8, v9
    v_add_u32 v38, 2048, v38
    v_add_u32 v39, 24, v7
    v_med3_i32 v39, v39, 0, v11
    v_mad_u32_u24 v39, v39, v8, v10
    v_add_u32 v39, 1024, v39
    v_add_u32 v40, 32, v7
    v_med3_i32 v40, v40, 0, v11
    v_mad_u32_u24 v40, v40, v8, v9
    v_add_u32 v40, 4096, v40
    v_add_u32 v41, 40, v7
    v_med3_i32 v41, v41, 0, v11
    v_mad_u32_u24 v41, v41, v8, v10
    v_add_u32 v41, 3072, v41
    v_add_u32 v42, 48, v7
    v_med3_i32 v42, v42, 0, v11
    v_mad_u32_u24 v42, v42, v8, v9
    v_add_u32 v42, 2048, v42
    v_add_u32 v43, 56, v7
    v_med3_i32 v43, v43, 0, v11
    v_mad_u32_u24 v43, v43, v8, v10
    v_add_u32 v43, 1024, v43
    v_add_u32 v44, 64, v7
    v_med3_i32 v44, v44, 0, v11
    v_mad_u32_u24 v44, v44, v8, v9
    v_add_u32 v44, 4096, v44
    v_add_u32 v45, 72, v7
    v_med3_i32 v45, v45, 0, v11
    v_mad_u32_u24 v45, v45, v8, v10
    v_add_u32 v45, 3072, v45
    v_add_u32 v46, 80, v7
    v_med3_i32 v46, v46, 0, v11
    v_mad_u32_u24 v46, v46, v8, v9
    v_add_u32 v46, 2048, v46
    v_add_u32 v47, 88, v7
    v_med3_i32 v47, v47, 0, v11
    v_mad_u32_u24 v47, v47, v8, v10
    v_add_u32 v47, 1024, v47
    v_add_u32 v48, 96, v7
    v_med3_i32 v48, v48, 0, v11
    v_mad_u32_u24 v48, v48, v8, v9
    v_add_u32 v48, 4096, v48
    v_add_u32 v49, 104, v7
    v_med3_i32 v49, v49, 0, v11
    v_mad_u32_u24 v49, v49, v8, v10
    v_add_u32 v49, 3072, v49
    s_lshl_b32 s82, s46, 1
    s_waitcnt lgkmcnt(0)
    s_sub_u32 s48, s4, 4096
    s_subb_u32 s49, s5, 0
    s_mov_b32 s50, 2625536
    s_mov_b32 s51, 0x20000
    s_mov_b64 s[52:53], s[6:7]
    s_mov_b32 s54, 2457600
    s_mov_b32 s55, 0x20000
    s_add_u32 s56, s6, 1280
    s_addc_u32 s57, s7, 0
    s_mov_b32 s58, 2456320
    s_mov_b32 s59, 0x20000
    s_add_u32 s60, s6, 2560
    s_addc_u32 s61, s7, 0
    s_mov_b32 s62, 2455040
    s_mov_b32 s63, 0x20000
    s_mul_i32 s72, s82, 245760
    s_lshl_b32 s47, s82, 7
    s_mov_b32 m0, 24576
    s_nop 0
    buffer_load_dwordx4 v36, s[48:51], s47 offen lds
    buffer_load_dwordx4 v37, s[48:51], s47 offen offset:1024 lds
    buffer_load_dwordx4 v38, s[48:51], s47 offen offset:2048 lds
    buffer_load_dwordx4 v39, s[48:51], s47 offen offset:3072 lds
    s_mov_b32 m0, 0
    s_nop 0
    buffer_load_dwordx4 v28, s[52:55], s72 offen lds
    buffer_load_dwordx4 v29, s[52:55], s72 offen offset:1024 lds
    buffer_load_dwordx4 v30, s[52:55], s72 offen offset:2048 lds
    buffer_load_dwordx4 v31, s[52:55], s72 offen offset:3072 lds
    s_mov_b32 m0, 28672
    s_nop 0
    buffer_load_dwordx4 v40, s[48:51], s47 offen lds
    buffer_load_dwordx4 v41, s[48:51], s47 offen offset:1024 lds
    buffer_load_dwordx4 v42, s[48:51], s47 offen offset:2048 lds
    buffer_load_dwordx4 v43, s[48:51], s47 offen offset:3072 lds
    s_mov_b32 m0, 8192
    s_nop 0
    buffer_load_dwordx4 v28, s[56:59], s72 offen lds
    buffer_load_dwordx4 v29, s[56:59], s72 offen offset:1024 lds
    buffer_load_dwordx4 v30, s[56:59], s72 offen offset:2048 lds
    buffer_load_dwordx4 v31, s[56:59], s72 offen offset:3072 lds
    s_mov_b32 m0, 32768
    s_nop 0
    buffer_load_dwordx4 v44, s[48:51], s47 offen lds
    buffer_load_dwordx4 v45, s[48:51], s47 offen offset:1024 lds
    buffer_load_dwordx4 v46, s[48:51], s47 offen offset:2048 lds
    buffer_load_dwordx4 v47, s[48:51], s47 offen offset:3072 lds
    s_mov_b32 m0, 16384
    s_nop 0
    buffer_load_dwordx4 v28, s[60:63], s72 offen lds
    buffer_load_dwordx4 v29, s[60:63], s72 offen offset:1024 lds
    buffer_load_dwordx4 v30, s[60:63], s72 offen offset:2048 lds
    buffer_load_dwordx4 v31, s[60:63], s72 offen offset:3072 lds
    s_mov_b32 m0, 36864
    s_nop 0
    buffer_load_dwordx4 v48, s[48:51], s47 offen lds
    buffer_load_dwordx4 v49, s[48:51], s47 offen offset:1024 lds
    s_mov_b32 m0, 4096
    s_nop 0
    buffer_load_dwordx4 v32, s[52:55], s72 offen lds
    buffer_load_dwordx4 v33, s[52:55], s72 offen offset:1024 lds
    buffer_load_dwordx4 v34, s[52:55], s72 offen offset:2048 lds
    buffer_load_dwordx4 v35, s[52:55], s72 offen offset:3072 lds
    s_mov_b32 m0, 12288
    s_nop 0
    buffer_load_dwordx4 v32, s[56:59], s72 offen lds
    buffer_load_dwordx4 v33, s[56:59], s72 offen offset:1024 lds
    buffer_load_dwordx4 v34, s[56:59], s72 offen offset:2048 lds
    buffer_load_dwordx4 v35, s[56:59], s72 offen offset:3072 lds
    s_mov_b32 m0, 20480
    s_nop 0
    buffer_load_dwordx4 v32, s[60:63], s72 offen lds
    buffer_load_dwordx4 v33, s[60:63], s72 offen offset:1024 lds
    buffer_load_dwordx4 v34, s[60:63], s72 offen offset:2048 lds
    buffer_load_dwordx4 v35, s[60:63], s72 offen offset:3072 lds
    s_mov_b32 s84, 0x53864210
    s_mov_b32 s85, 0x97
    s_cmp_eq_u32 s46, 1
    s_cselect_b32 s84, 0x51086342, s84
    s_cselect_b32 s85, 0x97, s85
    s_cmp_eq_u32 s46, 2
    s_cselect_b32 s84, 0x31205864, s84
    s_cselect_b32 s85, 0x97, s85
    s_cmp_eq_u32 s46, 3
    s_cselect_b32 s84, 0x31472086, s84
    s_cselect_b32 s85, 0x95, s85
    s_cmp_eq_u32 s46, 4
    s_cselect_b32 s84, 0x31964208, s84
    s_cselect_b32 s85, 0x75, s85
    s_lshr_b64 s[84:85], s[84:85], 4
    s_and_b32 s82, s84, 15
    s_mov_b64 s[28:29], s[24:25]
    s_mov_b32 s30, 268435456
    s_mov_b32 s31, 0x20000
    s_mov_b64 s[32:33], s[22:23]
    s_mov_b32 s34, 256
    s_mov_b32 s35, 0x20000
    s_load_dword s38, s[28:29], 0
    s_mov_b64 s[64:65], s[8:9]
    s_mov_b32 s66, 819200
    s_mov_b32 s67, 0x20000
    s_mov_b64 s[68:69], s[20:21]
    s_mov_b32 s70, 2621440
    s_mov_b32 s71, 0x20000
    v_mov_b32 v51, 157984
    v_and_b32 v66, 7, v1
    v_max_u32 v66, 1, v66
    v_lshlrev_b32 v66, 2, v66
    v_add_u32 v66, 158016, v66
    s_mul_i32 s73, s82, 245760
    s_lshl_b32 s47, s82, 7
    s_mov_b32 m0, 63616
    s_nop 0
    buffer_load_dwordx4 v36, s[48:51], s47 offen lds
    buffer_load_dwordx4 v37, s[48:51], s47 offen offset:1024 lds
    buffer_load_dwordx4 v38, s[48:51], s47 offen offset:2048 lds
    buffer_load_dwordx4 v39, s[48:51], s47 offen offset:3072 lds
    s_mov_b32 m0, 39040
    s_nop 0
    buffer_load_dwordx4 v28, s[52:55], s73 offen lds
    buffer_load_dwordx4 v29, s[52:55], s73 offen offset:1024 lds
    buffer_load_dwordx4 v30, s[52:55], s73 offen offset:2048 lds
    buffer_load_dwordx4 v31, s[52:55], s73 offen offset:3072 lds
    s_mov_b32 m0, 67712
    s_nop 0
    buffer_load_dwordx4 v40, s[48:51], s47 offen lds
    buffer_load_dwordx4 v41, s[48:51], s47 offen offset:1024 lds
    buffer_load_dwordx4 v42, s[48:51], s47 offen offset:2048 lds
    buffer_load_dwordx4 v43, s[48:51], s47 offen offset:3072 lds
    s_mov_b32 m0, 47232
    s_nop 0
    buffer_load_dwordx4 v28, s[56:59], s73 offen lds
    buffer_load_dwordx4 v29, s[56:59], s73 offen offset:1024 lds
    buffer_load_dwordx4 v30, s[56:59], s73 offen offset:2048 lds
    buffer_load_dwordx4 v31, s[56:59], s73 offen offset:3072 lds
    s_mov_b32 m0, 71808
    s_nop 0
    buffer_load_dwordx4 v44, s[48:51], s47 offen lds
    buffer_load_dwordx4 v45, s[48:51], s47 offen offset:1024 lds
    buffer_load_dwordx4 v46, s[48:51], s47 offen offset:2048 lds
    buffer_load_dwordx4 v47, s[48:51], s47 offen offset:3072 lds
    s_mov_b32 m0, 55424
    s_nop 0
    buffer_load_dwordx4 v28, s[60:63], s73 offen lds
    buffer_load_dwordx4 v29, s[60:63], s73 offen offset:1024 lds
    buffer_load_dwordx4 v30, s[60:63], s73 offen offset:2048 lds
    buffer_load_dwordx4 v31, s[60:63], s73 offen offset:3072 lds
    s_mov_b32 m0, 75904
    s_nop 0
    buffer_load_dwordx4 v48, s[48:51], s47 offen lds
    s_waitcnt vmcnt(55)
    buffer_load_dwordx4 v49, s[48:51], s47 offen offset:1024 lds
    s_mov_b32 m0, 43136
    s_nop 0
    buffer_load_dwordx4 v32, s[52:55], s73 offen lds
    buffer_load_dwordx4 v33, s[52:55], s73 offen offset:1024 lds
    buffer_load_dwordx4 v34, s[52:55], s73 offen offset:2048 lds
    buffer_load_dwordx4 v35, s[52:55], s73 offen offset:3072 lds
    s_mov_b32 m0, 51328
    s_nop 0
    buffer_load_dwordx4 v32, s[56:59], s73 offen lds
    buffer_load_dwordx4 v33, s[56:59], s73 offen offset:1024 lds
    buffer_load_dwordx4 v34, s[56:59], s73 offen offset:2048 lds
    s_waitcnt vmcnt(55)
    buffer_load_dwordx4 v35, s[56:59], s73 offen offset:3072 lds
    s_mov_b32 m0, 59520
    s_nop 0
    buffer_load_dwordx4 v32, s[60:63], s73 offen lds
    buffer_load_dwordx4 v33, s[60:63], s73 offen offset:1024 lds
    buffer_load_dwordx4 v34, s[60:63], s73 offen offset:2048 lds
    buffer_load_dwordx4 v35, s[60:63], s73 offen offset:3072 lds
    s_waitcnt vmcnt(38) lgkmcnt(0)
    s_barrier
    s_add_u32 s38, s38, 0x9e3779b8
    s_or_b32 s38, s38, 1
    s_lshr_b64 s[84:85], s[84:85], 4
    s_and_b32 s82, s84, 15
    s_mul_i32 s74, s82, 245760
    s_lshl_b32 s47, s82, 7
    s_mov_b32 m0, 102656
    s_nop 0
    buffer_load_dwordx4 v36, s[48:51], s47 offen lds
    buffer_load_dwordx4 v37, s[48:51], s47 offen offset:1024 lds
    buffer_load_dwordx4 v38, s[48:51], s47 offen offset:2048 lds
    buffer_load_dwordx4 v39, s[48:51], s47 offen offset:3072 lds
    s_mov_b32 m0, 78080
    s_nop 0
    buffer_load_dwordx4 v28, s[52:55], s74 offen lds
    buffer_load_dwordx4 v29, s[52:55], s74 offen offset:1024 lds
    buffer_load_dwordx4 v30, s[52:55], s74 offen offset:2048 lds
    buffer_load_dwordx4 v31, s[52:55], s74 offen offset:3072 lds
    s_mov_b32 m0, 106752
    s_nop 0
    buffer_load_dwordx4 v40, s[48:51], s47 offen lds
    buffer_load_dwordx4 v41, s[48:51], s47 offen offset:1024 lds
    buffer_load_dwordx4 v42, s[48:51], s47 offen offset:2048 lds
    buffer_load_dwordx4 v43, s[48:51], s47 offen offset:3072 lds
    s_mov_b32 m0, 86272
    s_nop 0
    buffer_load_dwordx4 v28, s[56:59], s74 offen lds
    buffer_load_dwordx4 v29, s[56:59], s74 offen offset:1024 lds
    buffer_load_dwordx4 v30, s[56:59], s74 offen offset:2048 lds
    buffer_load_dwordx4 v31, s[56:59], s74 offen offset:3072 lds
    s_mov_b32 m0, 110848
    s_nop 0
    buffer_load_dwordx4 v44, s[48:51], s47 offen lds
    buffer_load_dwordx4 v45, s[48:51], s47 offen offset:1024 lds
    buffer_load_dwordx4 v46, s[48:51], s47 offen offset:2048 lds
    buffer_load_dwordx4 v47, s[48:51], s47 offen offset:3072 lds
    s_mov_b32 m0, 94464
    s_nop 0
    buffer_load_dwordx4 v28, s[60:63], s74 offen lds
    buffer_load_dwordx4 v29, s[60:63], s74 offen offset:1024 lds
    buffer_load_dwordx4 v30, s[60:63], s74 offen offset:2048 lds
    buffer_load_dwordx4 v31, s[60:63], s74 offen offset:3072 lds
    s_mov_b32 m0, 114944
    s_nop 0
    buffer_load_dwordx4 v48, s[48:51], s47 offen lds
    s_waitcnt vmcnt(55)
    buffer_load_dwordx4 v49, s[48:51], s47 offen offset:1024 lds
    s_mov_b32 m0, 82176
    s_nop 0
    buffer_load_dwordx4 v32, s[52:55], s74 offen lds
    buffer_load_dwordx4 v33, s[52:55], s74 offen offset:1024 lds
    buffer_load_dwordx4 v34, s[52:55], s74 offen offset:2048 lds
    buffer_load_dwordx4 v35, s[52:55], s74 offen offset:3072 lds
    s_mov_b32 m0, 90368
    s_nop 0
    buffer_load_dwordx4 v32, s[56:59], s74 offen lds
    buffer_load_dwordx4 v33, s[56:59], s74 offen offset:1024 lds
    buffer_load_dwordx4 v34, s[56:59], s74 offen offset:2048 lds
    s_waitcnt vmcnt(55)
    buffer_load_dwordx4 v35, s[56:59], s74 offen offset:3072 lds
    s_mov_b32 m0, 98560
    s_nop 0
    buffer_load_dwordx4 v32, s[60:63], s74 offen lds
    buffer_load_dwordx4 v33, s[60:63], s74 offen offset:1024 lds
    buffer_load_dwordx4 v34, s[60:63], s74 offen offset:2048 lds
    buffer_load_dwordx4 v35, s[60:63], s74 offen offset:3072 lds
    s_waitcnt vmcnt(38) lgkmcnt(0)
    s_barrier
    s_lshr_b64 s[84:85], s[84:85], 4
    s_and_b32 s82, s84, 15
    s_mul_i32 s75, s82, 245760
    s_lshl_b32 s47, s82, 7
    s_mov_b32 m0, 141696
    s_nop 0
    buffer_load_dwordx4 v36, s[48:51], s47 offen lds
    buffer_load_dwordx4 v37, s[48:51], s47 offen offset:1024 lds
    buffer_load_dwordx4 v38, s[48:51], s47 offen offset:2048 lds
    buffer_load_dwordx4 v39, s[48:51], s47 offen offset:3072 lds
    s_mov_b32 m0, 117120
    s_nop 0
    buffer_load_dwordx4 v28, s[52:55], s75 offen lds
    buffer_load_dwordx4 v29, s[52:55], s75 offen offset:1024 lds
    buffer_load_dwordx4 v30, s[52:55], s75 offen offset:2048 lds
    buffer_load_dwordx4 v31, s[52:55], s75 offen offset:3072 lds
    s_mov_b32 m0, 145792
    s_nop 0
    buffer_load_dwordx4 v40, s[48:51], s47 offen lds
    buffer_load_dwordx4 v41, s[48:51], s47 offen offset:1024 lds
    buffer_load_dwordx4 v42, s[48:51], s47 offen offset:2048 lds
    buffer_load_dwordx4 v43, s[48:51], s47 offen offset:3072 lds
    s_mov_b32 m0, 125312
    s_nop 0
    buffer_load_dwordx4 v28, s[56:59], s75 offen lds
    buffer_load_dwordx4 v29, s[56:59], s75 offen offset:1024 lds
    buffer_load_dwordx4 v30, s[56:59], s75 offen offset:2048 lds
    buffer_load_dwordx4 v31, s[56:59], s75 offen offset:3072 lds
    s_mov_b32 m0, 149888
    s_nop 0
    buffer_load_dwordx4 v44, s[48:51], s47 offen lds
    buffer_load_dwordx4 v45, s[48:51], s47 offen offset:1024 lds
    buffer_load_dwordx4 v46, s[48:51], s47 offen offset:2048 lds
    buffer_load_dwordx4 v47, s[48:51], s47 offen offset:3072 lds
    s_mov_b32 m0, 133504
    s_nop 0
    buffer_load_dwordx4 v28, s[60:63], s75 offen lds
    buffer_load_dwordx4 v29, s[60:63], s75 offen offset:1024 lds
    buffer_load_dwordx4 v30, s[60:63], s75 offen offset:2048 lds
    buffer_load_dwordx4 v31, s[60:63], s75 offen offset:3072 lds
    s_mov_b32 m0, 153984
    s_nop 0
    buffer_load_dwordx4 v48, s[48:51], s47 offen lds
    s_waitcnt vmcnt(55)
    buffer_load_dwordx4 v49, s[48:51], s47 offen offset:1024 lds
    s_mov_b32 m0, 121216
    s_nop 0
    buffer_load_dwordx4 v32, s[52:55], s75 offen lds
    buffer_load_dwordx4 v33, s[52:55], s75 offen offset:1024 lds
    buffer_load_dwordx4 v34, s[52:55], s75 offen offset:2048 lds
    buffer_load_dwordx4 v35, s[52:55], s75 offen offset:3072 lds
    s_mov_b32 m0, 129408
    s_nop 0
    buffer_load_dwordx4 v32, s[56:59], s75 offen lds
    buffer_load_dwordx4 v33, s[56:59], s75 offen offset:1024 lds
    buffer_load_dwordx4 v34, s[56:59], s75 offen offset:2048 lds
    s_waitcnt vmcnt(55)
    buffer_load_dwordx4 v35, s[56:59], s75 offen offset:3072 lds
    s_mov_b32 m0, 137600
    s_nop 0
    buffer_load_dwordx4 v32, s[60:63], s75 offen lds
    buffer_load_dwordx4 v33, s[60:63], s75 offen offset:1024 lds
    buffer_load_dwordx4 v34, s[60:63], s75 offen offset:2048 lds
    buffer_load_dwordx4 v35, s[60:63], s75 offen offset:3072 lds
    s_waitcnt vmcnt(38) lgkmcnt(0)
    s_barrier
    s_lshr_b64 s[84:85], s[84:85], 4
    s_and_b32 s82, s84, 15
    s_mul_i32 s76, s82, 245760
    s_lshl_b32 s47, s82, 7
    s_mov_b32 m0, 24576
    s_nop 0
    buffer_load_dwordx4 v36, s[48:51], s47 offen lds
    buffer_load_dwordx4 v37, s[48:51], s47 offen offset:1024 lds
    buffer_load_dwordx4 v38, s[48:51], s47 offen offset:2048 lds
    buffer_load_dwordx4 v39, s[48:51], s47 offen offset:3072 lds
    s_mov_b32 m0, 0
    s_nop 0
    buffer_load_dwordx4 v28, s[52:55], s76 offen lds
    buffer_load_dwordx4 v29, s[52:55], s76 offen offset:1024 lds
    buffer_load_dwordx4 v30, s[52:55], s76 offen offset:2048 lds
    buffer_load_dwordx4 v31, s[52:55], s76 offen offset:3072 lds
    s_mov_b32 m0, 28672
    s_nop 0
    buffer_load_dwordx4 v40, s[48:51], s47 offen lds
    buffer_load_dwordx4 v41, s[48:51], s47 offen offset:1024 lds
    buffer_load_dwordx4 v42, s[48:51], s47 offen offset:2048 lds
    buffer_load_dwordx4 v43, s[48:51], s47 offen offset:3072 lds
    s_mov_b32 m0, 8192
    s_nop 0
    buffer_load_dwordx4 v28, s[56:59], s76 offen lds
    buffer_load_dwordx4 v29, s[56:59], s76 offen offset:1024 lds
    buffer_load_dwordx4 v30, s[56:59], s76 offen offset:2048 lds
    buffer_load_dwordx4 v31, s[56:59], s76 offen offset:3072 lds
    s_mov_b32 m0, 32768
    s_nop 0
    buffer_load_dwordx4 v44, s[48:51], s47 offen lds
    buffer_load_dwordx4 v45, s[48:51], s47 offen offset:1024 lds
    buffer_load_dwordx4 v46, s[48:51], s47 offen offset:2048 lds
    buffer_load_dwordx4 v47, s[48:51], s47 offen offset:3072 lds
    s_mov_b32 m0, 16384
    s_nop 0
    buffer_load_dwordx4 v28, s[60:63], s76 offen lds
    buffer_load_dwordx4 v29, s[60:63], s76 offen offset:1024 lds
    buffer_load_dwordx4 v30, s[60:63], s76 offen offset:2048 lds
    buffer_load_dwordx4 v31, s[60:63], s76 offen offset:3072 lds
    s_mov_b32 m0, 36864
    s_nop 0
    buffer_load_dwordx4 v48, s[48:51], s47 offen lds
    s_waitcnt vmcnt(55)
    buffer_load_dwordx4 v49, s[48:51], s47 offen offset:1024 lds
    s_mov_b32 m0, 4096
    s_nop 0
    buffer_load_dwordx4 v32, s[52:55], s76 offen lds
    buffer_load_dwordx4 v33, s[52:55], s76 offen offset:1024 lds
    buffer_load_dwordx4 v34, s[52:55], s76 offen offset:2048 lds
    buffer_load_dwordx4 v35, s[52:55], s76 offen offset:3072 lds
    s_mov_b32 m0, 12288
    s_nop 0
    buffer_load_dwordx4 v32, s[56:59], s76 offen lds
    buffer_load_dwordx4 v33, s[56:59], s76 offen offset:1024 lds
    buffer_load_dwordx4 v34, s[56:59], s76 offen offset:2048 lds
    s_waitcnt vmcnt(55)
    buffer_load_dwordx4 v35, s[56:59], s76 offen offset:3072 lds
    s_mov_b32 m0, 20480
    s_nop 0
    buffer_load_dwordx4 v32, s[60:63], s76 offen lds
    buffer_load_dwordx4 v33, s[60:63], s76 offen offset:1024 lds
    buffer_load_dwordx4 v34, s[60:63], s76 offen offset:2048 lds
    buffer_load_dwordx4 v35, s[60:63], s76 offen offset:3072 lds
    s_waitcnt vmcnt(38) lgkmcnt(0)
    s_barrier
    s_lshr_b64 s[84:85], s[84:85], 4
    s_and_b32 s82, s84, 15
    s_mul_i32 s77, s82, 245760
    s_lshl_b32 s47, s82, 7
    s_mov_b32 m0, 63616
    s_nop 0
    buffer_load_dwordx4 v36, s[48:51], s47 offen lds
    buffer_load_dwordx4 v37, s[48:51], s47 offen offset:1024 lds
    buffer_load_dwordx4 v38, s[48:51], s47 offen offset:2048 lds
    buffer_load_dwordx4 v39, s[48:51], s47 offen offset:3072 lds
    s_mov_b32 m0, 39040
    s_nop 0
    buffer_load_dwordx4 v28, s[52:55], s77 offen lds
    buffer_load_dwordx4 v29, s[52:55], s77 offen offset:1024 lds
    buffer_load_dwordx4 v30, s[52:55], s77 offen offset:2048 lds
    buffer_load_dwordx4 v31, s[52:55], s77 offen offset:3072 lds
    s_mov_b32 m0, 67712
    s_nop 0
    buffer_load_dwordx4 v40, s[48:51], s47 offen lds
    buffer_load_dwordx4 v41, s[48:51], s47 offen offset:1024 lds
    buffer_load_dwordx4 v42, s[48:51], s47 offen offset:2048 lds
    buffer_load_dwordx4 v43, s[48:51], s47 offen offset:3072 lds
    s_mov_b32 m0, 47232
    s_nop 0
    buffer_load_dwordx4 v28, s[56:59], s77 offen lds
    buffer_load_dwordx4 v29, s[56:59], s77 offen offset:1024 lds
    buffer_load_dwordx4 v30, s[56:59], s77 offen offset:2048 lds
    buffer_load_dwordx4 v31, s[56:59], s77 offen offset:3072 lds
    s_mov_b32 m0, 71808
    s_nop 0
    buffer_load_dwordx4 v44, s[48:51], s47 offen lds
    buffer_load_dwordx4 v45, s[48:51], s47 offen offset:1024 lds
    buffer_load_dwordx4 v46, s[48:51], s47 offen offset:2048 lds
    buffer_load_dwordx4 v47, s[48:51], s47 offen offset:3072 lds
    s_mov_b32 m0, 55424
    s_nop 0
    buffer_load_dwordx4 v28, s[60:63], s77 offen lds
    buffer_load_dwordx4 v29, s[60:63], s77 offen offset:1024 lds
    buffer_load_dwordx4 v30, s[60:63], s77 offen offset:2048 lds
    buffer_load_dwordx4 v31, s[60:63], s77 offen offset:3072 lds
    s_mov_b32 m0, 75904
    s_nop 0
    buffer_load_dwordx4 v48, s[48:51], s47 offen lds
    s_waitcnt vmcnt(55)
    buffer_load_dwordx4 v49, s[48:51], s47 offen offset:1024 lds
    s_mov_b32 m0, 43136
    s_nop 0
    buffer_load_dwordx4 v32, s[52:55], s77 offen lds
    buffer_load_dwordx4 v33, s[52:55], s77 offen offset:1024 lds
    buffer_load_dwordx4 v34, s[52:55], s77 offen offset:2048 lds
    buffer_load_dwordx4 v35, s[52:55], s77 offen offset:3072 lds
    s_mov_b32 m0, 51328
    s_nop 0
    buffer_load_dwordx4 v32, s[56:59], s77 offen lds
    buffer_load_dwordx4 v33, s[56:59], s77 offen offset:1024 lds
    buffer_load_dwordx4 v34, s[56:59], s77 offen offset:2048 lds
    s_waitcnt vmcnt(55)
    buffer_load_dwordx4 v35, s[56:59], s77 offen offset:3072 lds
    s_mov_b32 m0, 59520
    s_nop 0
    buffer_load_dwordx4 v32, s[60:63], s77 offen lds
    buffer_load_dwordx4 v33, s[60:63], s77 offen offset:1024 lds
    buffer_load_dwordx4 v34, s[60:63], s77 offen offset:2048 lds
    buffer_load_dwordx4 v35, s[60:63], s77 offen offset:3072 lds
    s_waitcnt vmcnt(38) lgkmcnt(0)
    s_barrier
    s_lshr_b64 s[84:85], s[84:85], 4
    s_and_b32 s82, s84, 15
    s_mul_i32 s78, s82, 245760
    s_lshl_b32 s47, s82, 7
    s_mov_b32 m0, 102656
    s_nop 0
    buffer_load_dwordx4 v36, s[48:51], s47 offen lds
    buffer_load_dwordx4 v37, s[48:51], s47 offen offset:1024 lds
    buffer_load_dwordx4 v38, s[48:51], s47 offen offset:2048 lds
    buffer_load_dwordx4 v39, s[48:51], s47 offen offset:3072 lds
    s_mov_b32 m0, 78080
    s_nop 0
    buffer_load_dwordx4 v28, s[52:55], s78 offen lds
    buffer_load_dwordx4 v29, s[52:55], s78 offen offset:1024 lds
    buffer_load_dwordx4 v30, s[52:55], s78 offen offset:2048 lds
    buffer_load_dwordx4 v31, s[52:55], s78 offen offset:3072 lds
    s_mov_b32 m0, 106752
    s_nop 0
    buffer_load_dwordx4 v40, s[48:51], s47 offen lds
    buffer_load_dwordx4 v41, s[48:51], s47 offen offset:1024 lds
    buffer_load_dwordx4 v42, s[48:51], s47 offen offset:2048 lds
    buffer_load_dwordx4 v43, s[48:51], s47 offen offset:3072 lds
    s_mov_b32 m0, 86272
    s_nop 0
    buffer_load_dwordx4 v28, s[56:59], s78 offen lds
    buffer_load_dwordx4 v29, s[56:59], s78 offen offset:1024 lds
    buffer_load_dwordx4 v30, s[56:59], s78 offen offset:2048 lds
    buffer_load_dwordx4 v31, s[56:59], s78 offen offset:3072 lds
    s_mov_b32 m0, 110848
    s_nop 0
    buffer_load_dwordx4 v44, s[48:51], s47 offen lds
    buffer_load_dwordx4 v45, s[48:51], s47 offen offset:1024 lds
    buffer_load_dwordx4 v46, s[48:51], s47 offen offset:2048 lds
    buffer_load_dwordx4 v47, s[48:51], s47 offen offset:3072 lds
    s_mov_b32 m0, 82176
    s_nop 0
    buffer_load_dwordx4 v32, s[52:55], s78 offen lds
    buffer_load_dwordx4 v33, s[52:55], s78 offen offset:1024 lds
    buffer_load_dwordx4 v34, s[52:55], s78 offen offset:2048 lds
    buffer_load_dwordx4 v35, s[52:55], s78 offen offset:3072 lds
    s_mov_b32 m0, 114944
    s_nop 0
    buffer_load_dwordx4 v48, s[48:51], s47 offen lds
    s_waitcnt vmcnt(55)
    buffer_load_dwordx4 v49, s[48:51], s47 offen offset:1024 lds
    s_mov_b32 m0, 90368
    s_nop 0
    buffer_load_dwordx4 v32, s[56:59], s78 offen lds
    buffer_load_dwordx4 v33, s[56:59], s78 offen offset:1024 lds
    buffer_load_dwordx4 v34, s[56:59], s78 offen offset:2048 lds
    buffer_load_dwordx4 v35, s[56:59], s78 offen offset:3072 lds
    s_waitcnt vmcnt(30) lgkmcnt(0)
    s_barrier
    s_lshr_b64 s[84:85], s[84:85], 4
    s_and_b32 s82, s84, 15
    s_mul_i32 s79, s82, 245760
    s_lshl_b32 s47, s82, 7
    s_mov_b32 m0, 141696
    s_nop 0
    buffer_load_dwordx4 v36, s[48:51], s47 offen lds
    buffer_load_dwordx4 v37, s[48:51], s47 offen offset:1024 lds
    buffer_load_dwordx4 v38, s[48:51], s47 offen offset:2048 lds
    buffer_load_dwordx4 v39, s[48:51], s47 offen offset:3072 lds
    s_mov_b32 m0, 117120
    s_nop 0
    buffer_load_dwordx4 v28, s[52:55], s79 offen lds
    buffer_load_dwordx4 v29, s[52:55], s79 offen offset:1024 lds
    buffer_load_dwordx4 v30, s[52:55], s79 offen offset:2048 lds
    buffer_load_dwordx4 v31, s[52:55], s79 offen offset:3072 lds
    s_mov_b32 m0, 145792
    s_nop 0
    buffer_load_dwordx4 v40, s[48:51], s47 offen lds
    buffer_load_dwordx4 v41, s[48:51], s47 offen offset:1024 lds
    buffer_load_dwordx4 v42, s[48:51], s47 offen offset:2048 lds
    buffer_load_dwordx4 v43, s[48:51], s47 offen offset:3072 lds
    s_mov_b32 m0, 125312
    s_nop 0
    buffer_load_dwordx4 v28, s[56:59], s79 offen lds
    buffer_load_dwordx4 v29, s[56:59], s79 offen offset:1024 lds
    buffer_load_dwordx4 v30, s[56:59], s79 offen offset:2048 lds
    buffer_load_dwordx4 v31, s[56:59], s79 offen offset:3072 lds
    s_mov_b32 m0, 149888
    s_nop 0
    buffer_load_dwordx4 v44, s[48:51], s47 offen lds
    buffer_load_dwordx4 v45, s[48:51], s47 offen offset:1024 lds
    buffer_load_dwordx4 v46, s[48:51], s47 offen offset:2048 lds
    buffer_load_dwordx4 v47, s[48:51], s47 offen offset:3072 lds
    s_mov_b32 m0, 121216
    s_nop 0
    buffer_load_dwordx4 v32, s[52:55], s79 offen lds
    buffer_load_dwordx4 v33, s[52:55], s79 offen offset:1024 lds
    buffer_load_dwordx4 v34, s[52:55], s79 offen offset:2048 lds
    buffer_load_dwordx4 v35, s[52:55], s79 offen offset:3072 lds
    s_mov_b32 m0, 153984
    s_nop 0
    buffer_load_dwordx4 v48, s[48:51], s47 offen lds
    buffer_load_dwordx4 v49, s[48:51], s47 offen offset:1024 lds
    s_mov_b32 m0, 129408
    s_nop 0
    buffer_load_dwordx4 v32, s[56:59], s79 offen lds
    buffer_load_dwordx4 v33, s[56:59], s79 offen offset:1024 lds
    buffer_load_dwordx4 v34, s[56:59], s79 offen offset:2048 lds
    buffer_load_dwordx4 v35, s[56:59], s79 offen offset:3072 lds
    s_waitcnt vmcnt(30) lgkmcnt(0)
    s_barrier
    s_lshr_b64 s[84:85], s[84:85], 4
    s_and_b32 s82, s84, 15
    s_mul_i32 s80, s82, 245760
    s_lshl_b32 s47, s82, 7
    s_mov_b32 m0, 24576
    s_nop 0
    buffer_load_dwordx4 v36, s[48:51], s47 offen lds
    buffer_load_dwordx4 v37, s[48:51], s47 offen offset:1024 lds
    buffer_load_dwordx4 v38, s[48:51], s47 offen offset:2048 lds
    buffer_load_dwordx4 v39, s[48:51], s47 offen offset:3072 lds
    s_mov_b32 m0, 0
    s_nop 0
    buffer_load_dwordx4 v28, s[52:55], s80 offen lds
    buffer_load_dwordx4 v29, s[52:55], s80 offen offset:1024 lds
    buffer_load_dwordx4 v30, s[52:55], s80 offen offset:2048 lds
    buffer_load_dwordx4 v31, s[52:55], s80 offen offset:3072 lds
    s_mov_b32 m0, 28672
    s_nop 0
    buffer_load_dwordx4 v40, s[48:51], s47 offen lds
    buffer_load_dwordx4 v41, s[48:51], s47 offen offset:1024 lds
    buffer_load_dwordx4 v42, s[48:51], s47 offen offset:2048 lds
    buffer_load_dwordx4 v43, s[48:51], s47 offen offset:3072 lds
    s_mov_b32 m0, 8192
    s_nop 0
    buffer_load_dwordx4 v28, s[56:59], s80 offen lds
    buffer_load_dwordx4 v29, s[56:59], s80 offen offset:1024 lds
    buffer_load_dwordx4 v30, s[56:59], s80 offen offset:2048 lds
    buffer_load_dwordx4 v31, s[56:59], s80 offen offset:3072 lds
    s_mov_b32 m0, 32768
    s_nop 0
    buffer_load_dwordx4 v44, s[48:51], s47 offen lds
    buffer_load_dwordx4 v45, s[48:51], s47 offen offset:1024 lds
    buffer_load_dwordx4 v46, s[48:51], s47 offen offset:2048 lds
    buffer_load_dwordx4 v47, s[48:51], s47 offen offset:3072 lds
    s_mov_b32 m0, 4096
    s_nop 0
    buffer_load_dwordx4 v32, s[52:55], s80 offen lds
    buffer_load_dwordx4 v33, s[52:55], s80 offen offset:1024 lds
    buffer_load_dwordx4 v34, s[52:55], s80 offen offset:2048 lds
    buffer_load_dwordx4 v35, s[52:55], s80 offen offset:3072 lds
    s_mov_b32 m0, 36864
    s_nop 0
    buffer_load_dwordx4 v48, s[48:51], s47 offen lds
    buffer_load_dwordx4 v49, s[48:51], s47 offen offset:1024 lds
    s_mov_b32 m0, 12288
    s_nop 0
    buffer_load_dwordx4 v32, s[56:59], s80 offen lds
    buffer_load_dwordx4 v33, s[56:59], s80 offen offset:1024 lds
    buffer_load_dwordx4 v34, s[56:59], s80 offen offset:2048 lds
    buffer_load_dwordx4 v35, s[56:59], s80 offen offset:3072 lds
    s_waitcnt vmcnt(30) lgkmcnt(0)
    s_barrier
    s_lshr_b64 s[84:85], s[84:85], 4
    s_and_b32 s82, s84, 15
    s_mul_i32 s81, s82, 245760
    s_lshl_b32 s47, s82, 7
    s_mov_b32 m0, 63616
    s_nop 0
    buffer_load_dwordx4 v36, s[48:51], s47 offen lds
    buffer_load_dwordx4 v37, s[48:51], s47 offen offset:1024 lds
    buffer_load_dwordx4 v38, s[48:51], s47 offen offset:2048 lds
    buffer_load_dwordx4 v39, s[48:51], s47 offen offset:3072 lds
    s_mov_b32 m0, 39040
    s_nop 0
    buffer_load_dwordx4 v28, s[52:55], s81 offen lds
    buffer_load_dwordx4 v29, s[52:55], s81 offen offset:1024 lds
    buffer_load_dwordx4 v30, s[52:55], s81 offen offset:2048 lds
    buffer_load_dwordx4 v31, s[52:55], s81 offen offset:3072 lds
    s_mov_b32 m0, 67712
    s_nop 0
    buffer_load_dwordx4 v40, s[48:51], s47 offen lds
    buffer_load_dwordx4 v41, s[48:51], s47 offen offset:1024 lds
    buffer_load_dwordx4 v42, s[48:51], s47 offen offset:2048 lds
    buffer_load_dwordx4 v43, s[48:51], s47 offen offset:3072 lds
    s_mov_b32 m0, 47232
    s_nop 0
    buffer_load_dwordx4 v28, s[56:59], s81 offen lds
    buffer_load_dwordx4 v29, s[56:59], s81 offen offset:1024 lds
    buffer_load_dwordx4 v30, s[56:59], s81 offen offset:2048 lds
    buffer_load_dwordx4 v31, s[56:59], s81 offen offset:3072 lds
    s_mov_b32 m0, 71808
    s_nop 0
    buffer_load_dwordx4 v44, s[48:51], s47 offen lds
    buffer_load_dwordx4 v45, s[48:51], s47 offen offset:1024 lds
    buffer_load_dwordx4 v46, s[48:51], s47 offen offset:2048 lds
    buffer_load_dwordx4 v47, s[48:51], s47 offen offset:3072 lds
    s_mov_b32 m0, 43136
    s_nop 0
    buffer_load_dwordx4 v32, s[52:55], s81 offen lds
    buffer_load_dwordx4 v33, s[52:55], s81 offen offset:1024 lds
    buffer_load_dwordx4 v34, s[52:55], s81 offen offset:2048 lds
    buffer_load_dwordx4 v35, s[52:55], s81 offen offset:3072 lds
    s_mov_b32 m0, 75904
    s_nop 0
    buffer_load_dwordx4 v48, s[48:51], s47 offen lds
    buffer_load_dwordx4 v49, s[48:51], s47 offen offset:1024 lds
    s_mov_b32 m0, 51328
    s_nop 0
    buffer_load_dwordx4 v32, s[56:59], s81 offen lds
    buffer_load_dwordx4 v33, s[56:59], s81 offen offset:1024 lds
    buffer_load_dwordx4 v34, s[56:59], s81 offen offset:2048 lds
    buffer_load_dwordx4 v35, s[56:59], s81 offen offset:3072 lds
    s_waitcnt vmcnt(30) lgkmcnt(0)
    s_barrier
    s_lshr_b64 s[84:85], s[84:85], 4
    s_and_b32 s82, s84, 15
    s_mov_b32 m0, 94464
    s_nop 0
    buffer_load_dwordx4 v28, s[60:63], s78 offen lds
    buffer_load_dwordx4 v29, s[60:63], s78 offen offset:1024 lds
    buffer_load_dwordx4 v30, s[60:63], s78 offen offset:2048 lds
    buffer_load_dwordx4 v31, s[60:63], s78 offen offset:3072 lds
    s_mov_b32 m0, 98560
    s_nop 0
    buffer_load_dwordx4 v32, s[60:63], s78 offen lds
    buffer_load_dwordx4 v33, s[60:63], s78 offen offset:1024 lds
    buffer_load_dwordx4 v34, s[60:63], s78 offen offset:2048 lds
    buffer_load_dwordx4 v35, s[60:63], s78 offen offset:3072 lds
    s_mov_b32 m0, 133504
    s_nop 0
    buffer_load_dwordx4 v28, s[60:63], s79 offen lds
    buffer_load_dwordx4 v29, s[60:63], s79 offen offset:1024 lds
    buffer_load_dwordx4 v30, s[60:63], s79 offen offset:2048 lds
    buffer_load_dwordx4 v31, s[60:63], s79 offen offset:3072 lds
    s_waitcnt vmcnt(12) lgkmcnt(0)
    s_barrier
    s_mov_b32 m0, 137600
    s_nop 0
    buffer_load_dwordx4 v32, s[60:63], s79 offen lds
    buffer_load_dwordx4 v33, s[60:63], s79 offen offset:1024 lds
    buffer_load_dwordx4 v34, s[60:63], s79 offen offset:2048 lds
    buffer_load_dwordx4 v35, s[60:63], s79 offen offset:3072 lds
    s_mov_b32 m0, 16384
    s_nop 0
    buffer_load_dwordx4 v28, s[60:63], s80 offen lds
    buffer_load_dwordx4 v29, s[60:63], s80 offen offset:1024 lds
    buffer_load_dwordx4 v30, s[60:63], s80 offen offset:2048 lds
    buffer_load_dwordx4 v31, s[60:63], s80 offen offset:3072 lds
    s_mov_b32 m0, 20480
    s_nop 0
    buffer_load_dwordx4 v32, s[60:63], s80 offen lds
    buffer_load_dwordx4 v33, s[60:63], s80 offen offset:1024 lds
    buffer_load_dwordx4 v34, s[60:63], s80 offen offset:2048 lds
    buffer_load_dwordx4 v35, s[60:63], s80 offen offset:3072 lds
    s_mov_b32 m0, 55424
    s_nop 0
    buffer_load_dwordx4 v28, s[60:63], s81 offen lds
    buffer_load_dwordx4 v29, s[60:63], s81 offen offset:1024 lds
    buffer_load_dwordx4 v30, s[60:63], s81 offen offset:2048 lds
    buffer_load_dwordx4 v31, s[60:63], s81 offen offset:3072 lds
    s_mov_b32 m0, 59520
    s_nop 0
    buffer_load_dwordx4 v32, s[60:63], s81 offen lds
    buffer_load_dwordx4 v33, s[60:63], s81 offen offset:1024 lds
    buffer_load_dwordx4 v34, s[60:63], s81 offen offset:2048 lds
    buffer_load_dwordx4 v35, s[60:63], s81 offen offset:3072 lds
    s_mov_b32 s10, 20480
    v_lshrrev_b32 v52, 5, v1
    v_lshlrev_b32 v52, 3, v52
    v_add_u32 v53, 2, v52
    v_add_u32 v54, 4, v52
    v_add_u32 v55, 6, v52
    v_add_u32 v56, 16, v52
    v_add_u32 v57, 18, v52
    v_add_u32 v58, 20, v52
    v_add_u32 v59, 22, v52
    v_and_b32 v7, 3, v5
    v_mul_u32_u24 v7, 1280, v7
    v_add_u32 v60, v7, v50
    v_xor_b32 v61, 64, v60
    v_add_u32 v61, 4096, v61
    v_add_u32 v62, 8192, v60
    v_add_u32 v63, 8192, v61
    s_mov_b32 s5, 0xbfe10856
    s_mov_b32 s6, 0xaff80255
    s_mov_b32 s7, 0xabfe4015
    s_mov_b32 s8, 0xaa7fd005
    s_mov_b32 s9, 0x6adfb401
    s_cmp_eq_u32 s46, 1
    s_cselect_b32 s5, 0xabfe4015, s5
    s_cselect_b32 s6, 0xaa7fd005, s6
    s_cselect_b32 s7, 0x6adfb401, s7
    s_cselect_b32 s8, 0xbfe10856, s8
    s_cselect_b32 s9, 0xaff80255, s9
    s_cmp_eq_u32 s46, 2
    s_cselect_b32 s5, 0x6adfb401, s5
    s_cselect_b32 s6, 0xbfe10856, s6
    s_cselect_b32 s7, 0xaff80255, s7
    s_cselect_b32 s8, 0xabfe4015, s8
    s_cselect_b32 s9, 0xaa7fd005, s9
    s_cmp_eq_u32 s46, 3
    s_cselect_b32 s5, 0xaff80255, s5
    s_cselect_b32 s6, 0xabfe4015, s6
    s_cselect_b32 s7, 0xaa7fd005, s7
    s_cselect_b32 s8, 0x6adfb401, s8
    s_cselect_b32 s9, 0xbfe10856, s9
    s_cmp_eq_u32 s46, 4
    s_cselect_b32 s5, 0xaa7fd005, s5
    s_cselect_b32 s6, 0x6adfb401, s6
    s_cselect_b32 s7, 0xbfe10856, s7
    s_cselect_b32 s8, 0xaff80255, s8
    s_cselect_b32 s9, 0xabfe4015, s9
    s_mul_i32 s4, s46, 163840
    s_mov_b32 m0, 0
    v_bfe_u32 v64, s5, v52, 2
    v_mad_u32_u24 v64, v64, s10, v60
    buffer_load_dwordx4 v64, s[64:67], s4 offen lds
    v_bfe_u32 v65, s5, v53, 2
    v_mad_u32_u24 v65, v65, s10, v61
    buffer_load_dwordx4 v65, s[64:67], s4 offen offset:1024 lds
    v_bfe_u32 v64, s5, v54, 2
    v_mad_u32_u24 v64, v64, s10, v62
    buffer_load_dwordx4 v64, s[64:67], s4 offen offset:2048 lds
    v_bfe_u32 v65, s5, v55, 2
    v_mad_u32_u24 v65, v65, s10, v63
    buffer_load_dwordx4 v65, s[64:67], s4 offen offset:3072 lds
    s_mov_b32 m0, 4096
    v_bfe_u32 v64, s5, v56, 2
    v_mad_u32_u24 v64, v64, s10, v60
    buffer_load_dwordx4 v64, s[64:67], s4 offen lds
    v_bfe_u32 v65, s5, v57, 2
    v_mad_u32_u24 v65, v65, s10, v61
    buffer_load_dwordx4 v65, s[64:67], s4 offen offset:1024 lds
    v_bfe_u32 v64, s5, v58, 2
    v_mad_u32_u24 v64, v64, s10, v62
    buffer_load_dwordx4 v64, s[64:67], s4 offen offset:2048 lds
    v_bfe_u32 v65, s5, v59, 2
    v_mad_u32_u24 v65, v65, s10, v63
    buffer_load_dwordx4 v65, s[64:67], s4 offen offset:3072 lds
    s_add_u32 s4, s4, 81920
    s_cmp_eq_u32 s4, 819200
    s_cselect_b32 s4, 0, s4
    s_mov_b32 m0, 8192
    v_bfe_u32 v64, s6, v52, 2
    v_mad_u32_u24 v64, v64, s10, v60
    buffer_load_dwordx4 v64, s[64:67], s4 offen lds
    v_bfe_u32 v65, s6, v53, 2
    v_mad_u32_u24 v65, v65, s10, v61
    buffer_load_dwordx4 v65, s[64:67], s4 offen offset:1024 lds
    v_bfe_u32 v64, s6, v54, 2
    v_mad_u32_u24 v64, v64, s10, v62
    buffer_load_dwordx4 v64, s[64:67], s4 offen offset:2048 lds
    v_bfe_u32 v65, s6, v55, 2
    v_mad_u32_u24 v65, v65, s10, v63
    buffer_load_dwordx4 v65, s[64:67], s4 offen offset:3072 lds
    s_mov_b32 m0, 12288
    v_bfe_u32 v64, s6, v56, 2
    v_mad_u32_u24 v64, v64, s10, v60
    buffer_load_dwordx4 v64, s[64:67], s4 offen lds
    v_bfe_u32 v65, s6, v57, 2
    v_mad_u32_u24 v65, v65, s10, v61
    buffer_load_dwordx4 v65, s[64:67], s4 offen offset:1024 lds
    v_bfe_u32 v64, s6, v58, 2
    v_mad_u32_u24 v64, v64, s10, v62
    buffer_load_dwordx4 v64, s[64:67], s4 offen offset:2048 lds
    v_bfe_u32 v65, s6, v59, 2
    v_mad_u32_u24 v65, v65, s10, v63
    buffer_load_dwordx4 v65, s[64:67], s4 offen offset:3072 lds
    s_add_u32 s4, s4, 81920
    s_cmp_eq_u32 s4, 819200
    s_cselect_b32 s4, 0, s4
    s_waitcnt vmcnt(16)
    v_mov_b32 v5, 157980
    v_mov_b32 v6, 1
    s_mov_b64 exec, 1
    ds_add_u32 v5, v6
    s_mov_b64 exec, -1
    v_mov_b32 v5, 157972
    v_mov_b32 v6, 1
    s_mov_b64 exec, 1
    ds_add_u32 v5, v6
    s_mov_b64 exec, -1
    s_mov_b32 m0, 24576
    v_bfe_u32 v64, s7, v52, 2
    v_mad_u32_u24 v64, v64, s10, v60
    buffer_load_dwordx4 v64, s[64:67], s4 offen lds
    v_bfe_u32 v65, s7, v53, 2
    v_mad_u32_u24 v65, v65, s10, v61
    buffer_load_dwordx4 v65, s[64:67], s4 offen offset:1024 lds
    v_bfe_u32 v64, s7, v54, 2
    v_mad_u32_u24 v64, v64, s10, v62
    buffer_load_dwordx4 v64, s[64:67], s4 offen offset:2048 lds
    v_bfe_u32 v65, s7, v55, 2
    v_mad_u32_u24 v65, v65, s10, v63
    buffer_load_dwordx4 v65, s[64:67], s4 offen offset:3072 lds
    s_mov_b32 m0, 28672
    v_bfe_u32 v64, s7, v56, 2
    v_mad_u32_u24 v64, v64, s10, v60
    buffer_load_dwordx4 v64, s[64:67], s4 offen lds
    v_bfe_u32 v65, s7, v57, 2
    v_mad_u32_u24 v65, v65, s10, v61
    buffer_load_dwordx4 v65, s[64:67], s4 offen offset:1024 lds
    v_bfe_u32 v64, s7, v58, 2
    v_mad_u32_u24 v64, v64, s10, v62
    buffer_load_dwordx4 v64, s[64:67], s4 offen offset:2048 lds
    v_bfe_u32 v65, s7, v59, 2
    v_mad_u32_u24 v65, v65, s10, v63
    buffer_load_dwordx4 v65, s[64:67], s4 offen offset:3072 lds
    s_add_u32 s4, s4, 81920
    s_cmp_eq_u32 s4, 819200
    s_cselect_b32 s4, 0, s4
    s_mov_b32 m0, 123136
    v_bfe_u32 v64, s8, v52, 2
    v_mad_u32_u24 v64, v64, s10, v60
    buffer_load_dwordx4 v64, s[64:67], s4 offen lds
    v_bfe_u32 v65, s8, v53, 2
    v_mad_u32_u24 v65, v65, s10, v61
    buffer_load_dwordx4 v65, s[64:67], s4 offen offset:1024 lds
    v_bfe_u32 v64, s8, v54, 2
    v_mad_u32_u24 v64, v64, s10, v62
    buffer_load_dwordx4 v64, s[64:67], s4 offen offset:2048 lds
    v_bfe_u32 v65, s8, v55, 2
    v_mad_u32_u24 v65, v65, s10, v63
    buffer_load_dwordx4 v65, s[64:67], s4 offen offset:3072 lds
    s_mov_b32 m0, 127232
    v_bfe_u32 v64, s8, v56, 2
    v_mad_u32_u24 v64, v64, s10, v60
    buffer_load_dwordx4 v64, s[64:67], s4 offen lds
    v_bfe_u32 v65, s8, v57, 2
    v_mad_u32_u24 v65, v65, s10, v61
    buffer_load_dwordx4 v65, s[64:67], s4 offen offset:1024 lds
    v_bfe_u32 v64, s8, v58, 2
    v_mad_u32_u24 v64, v64, s10, v62
    buffer_load_dwordx4 v64, s[64:67], s4 offen offset:2048 lds
    v_bfe_u32 v65, s8, v59, 2
    v_mad_u32_u24 v65, v65, s10, v63
    buffer_load_dwordx4 v65, s[64:67], s4 offen offset:3072 lds
    s_add_u32 s4, s4, 81920
    s_cmp_eq_u32 s4, 819200
    s_cselect_b32 s4, 0, s4
    s_mov_b32 m0, 80000
    v_bfe_u32 v64, s9, v52, 2
    v_mad_u32_u24 v64, v64, s10, v60
    buffer_load_dwordx4 v64, s[64:67], s4 offen lds
    v_bfe_u32 v65, s9, v53, 2
    v_mad_u32_u24 v65, v65, s10, v61
    buffer_load_dwordx4 v65, s[64:67], s4 offen offset:1024 lds
    v_bfe_u32 v64, s9, v54, 2
    v_mad_u32_u24 v64, v64, s10, v62
    buffer_load_dwordx4 v64, s[64:67], s4 offen offset:2048 lds
    v_bfe_u32 v65, s9, v55, 2
    v_mad_u32_u24 v65, v65, s10, v63
    buffer_load_dwordx4 v65, s[64:67], s4 offen offset:3072 lds
    s_mov_b32 m0, 84096
    v_bfe_u32 v64, s9, v56, 2
    v_mad_u32_u24 v64, v64, s10, v60
    buffer_load_dwordx4 v64, s[64:67], s4 offen lds
    v_bfe_u32 v65, s9, v57, 2
    v_mad_u32_u24 v65, v65, s10, v61
    buffer_load_dwordx4 v65, s[64:67], s4 offen offset:1024 lds
    v_bfe_u32 v64, s9, v58, 2
    v_mad_u32_u24 v64, v64, s10, v62
    buffer_load_dwordx4 v64, s[64:67], s4 offen offset:2048 lds
    v_bfe_u32 v65, s9, v59, 2
    v_mad_u32_u24 v65, v65, s10, v63
    buffer_load_dwordx4 v65, s[64:67], s4 offen offset:3072 lds
    s_add_u32 s4, s4, 81920
    s_cmp_eq_u32 s4, 819200
    s_cselect_b32 s4, 0, s4
    s_waitcnt vmcnt(0)
    v_mov_b32 v7, 157980
    v_mov_b32 v6, 1
    s_mov_b64 exec, 1
    ds_add_u32 v7, v6
    s_mov_b64 exec, -1
Lcw_6:
    s_sub_u32 s39, s39, 1
    s_cbranch_scc1 Lend
    ds_read_b32 v6, v5
    s_waitcnt lgkmcnt(0)
    v_readfirstlane_b32 s42, v6
    s_nop 0
    s_cmp_lt_u32 s42, 8
    s_cbranch_scc1 Lcw_6
    s_lshl_b32 s40, s2, 7
    s_add_u32 s40, s40, 8257536
    v_mov_b32 v69, s40
    buffer_load_dwordx4 v[70:73], v69, s[28:31], 0 offen sc1
    v_mov_b32 v5, 157976
Lcw_7:
    s_sub_u32 s39, s39, 1
    s_cbranch_scc1 Lend
    ds_read_b32 v6, v5
    s_waitcnt lgkmcnt(0)
    v_readfirstlane_b32 s42, v6
    s_nop 0
    s_cmp_lt_u32 s42, 7
    s_cbranch_scc1 Lcw_7
    s_mov_b32 m0, 32768
    v_bfe_u32 v64, s5, v52, 2
    v_mad_u32_u24 v64, v64, s10, v60
    buffer_load_dwordx4 v64, s[64:67], s4 offen lds
    v_bfe_u32 v65, s5, v53, 2
    v_mad_u32_u24 v65, v65, s10, v61
    buffer_load_dwordx4 v65, s[64:67], s4 offen offset:1024 lds
    v_bfe_u32 v64, s5, v54, 2
    v_mad_u32_u24 v64, v64, s10, v62
    buffer_load_dwordx4 v64, s[64:67], s4 offen offset:2048 lds
    v_bfe_u32 v65, s5, v55, 2
    v_mad_u32_u24 v65, v65, s10, v63
    buffer_load_dwordx4 v65, s[64:67], s4 offen offset:3072 lds
    s_mov_b32 m0, 36864
    v_bfe_u32 v64, s5, v56, 2
    v_mad_u32_u24 v64, v64, s10, v60
    buffer_load_dwordx4 v64, s[64:67], s4 offen lds
    v_bfe_u32 v65, s5, v57, 2
    v_mad_u32_u24 v65, v65, s10, v61
    buffer_load_dwordx4 v65, s[64:67], s4 offen offset:1024 lds
    v_bfe_u32 v64, s5, v58, 2
    v_mad_u32_u24 v64, v64, s10, v62
    buffer_load_dwordx4 v64, s[64:67], s4 offen offset:2048 lds
    v_bfe_u32 v65, s5, v59, 2
    v_mad_u32_u24 v65, v65, s10, v63
    buffer_load_dwordx4 v65, s[64:67], s4 offen offset:3072 lds
    s_add_u32 s4, s4, 81920
    s_cmp_eq_u32 s4, 819200
    s_cselect_b32 s4, 0, s4
    s_mov_b32 m0, 40960
    v_bfe_u32 v64, s6, v52, 2
    v_mad_u32_u24 v64, v64, s10, v60
    buffer_load_dwordx4 v64, s[64:67], s4 offen lds
    v_bfe_u32 v65, s6, v53, 2
    v_mad_u32_u24 v65, v65, s10, v61
    buffer_load_dwordx4 v65, s[64:67], s4 offen offset:1024 lds
    v_bfe_u32 v64, s6, v54, 2
    v_mad_u32_u24 v64, v64, s10, v62
    buffer_load_dwordx4 v64, s[64:67], s4 offen offset:2048 lds
    v_bfe_u32 v65, s6, v55, 2
    v_mad_u32_u24 v65, v65, s10, v63
    buffer_load_dwordx4 v65, s[64:67], s4 offen offset:3072 lds
    s_mov_b32 m0, 45056
    v_bfe_u32 v64, s6, v56, 2
    v_mad_u32_u24 v64, v64, s10, v60
    buffer_load_dwordx4 v64, s[64:67], s4 offen lds
    v_bfe_u32 v65, s6, v57, 2
    v_mad_u32_u24 v65, v65, s10, v61
    buffer_load_dwordx4 v65, s[64:67], s4 offen offset:1024 lds
    v_bfe_u32 v64, s6, v58, 2
    v_mad_u32_u24 v64, v64, s10, v62
    buffer_load_dwordx4 v64, s[64:67], s4 offen offset:2048 lds
    v_bfe_u32 v65, s6, v59, 2
    v_mad_u32_u24 v65, v65, s10, v63
    buffer_load_dwordx4 v65, s[64:67], s4 offen offset:3072 lds
    s_add_u32 s4, s4, 81920
    s_cmp_eq_u32 s4, 819200
    s_cselect_b32 s4, 0, s4
    s_mov_b32 m0, 63616
    v_bfe_u32 v64, s7, v52, 2
    v_mad_u32_u24 v64, v64, s10, v60
    buffer_load_dwordx4 v64, s[64:67], s4 offen lds
    v_bfe_u32 v65, s7, v53, 2
    v_mad_u32_u24 v65, v65, s10, v61
    buffer_load_dwordx4 v65, s[64:67], s4 offen offset:1024 lds
    v_bfe_u32 v64, s7, v54, 2
    v_mad_u32_u24 v64, v64, s10, v62
    buffer_load_dwordx4 v64, s[64:67], s4 offen offset:2048 lds
    v_bfe_u32 v65, s7, v55, 2
    v_mad_u32_u24 v65, v65, s10, v63
    buffer_load_dwordx4 v65, s[64:67], s4 offen offset:3072 lds
    s_mov_b32 m0, 67712
    v_bfe_u32 v64, s7, v56, 2
    v_mad_u32_u24 v64, v64, s10, v60
    buffer_load_dwordx4 v64, s[64:67], s4 offen lds
    v_bfe_u32 v65, s7, v57, 2
    v_mad_u32_u24 v65, v65, s10, v61
    buffer_load_dwordx4 v65, s[64:67], s4 offen offset:1024 lds
    v_bfe_u32 v64, s7, v58, 2
    v_mad_u32_u24 v64, v64, s10, v62
    buffer_load_dwordx4 v64, s[64:67], s4 offen offset:2048 lds
    v_bfe_u32 v65, s7, v59, 2
    v_mad_u32_u24 v65, v65, s10, v63
    buffer_load_dwordx4 v65, s[64:67], s4 offen offset:3072 lds
    s_add_u32 s4, s4, 81920
    s_cmp_eq_u32 s4, 819200
    s_cselect_b32 s4, 0, s4
    s_mov_b32 m0, 71808
    v_bfe_u32 v64, s8, v52, 2
    v_mad_u32_u24 v64, v64, s10, v60
    buffer_load_dwordx4 v64, s[64:67], s4 offen lds
    v_bfe_u32 v65, s8, v53, 2
    v_mad_u32_u24 v65, v65, s10, v61
    buffer_load_dwordx4 v65, s[64:67], s4 offen offset:1024 lds
    v_bfe_u32 v64, s8, v54, 2
    v_mad_u32_u24 v64, v64, s10, v62
    buffer_load_dwordx4 v64, s[64:67], s4 offen offset:2048 lds
    v_bfe_u32 v65, s8, v55, 2
    v_mad_u32_u24 v65, v65, s10, v63
    buffer_load_dwordx4 v65, s[64:67], s4 offen offset:3072 lds
    s_mov_b32 m0, 75904
    v_bfe_u32 v64, s8, v56, 2
    v_mad_u32_u24 v64, v64, s10, v60
    buffer_load_dwordx4 v64, s[64:67], s4 offen lds
    v_bfe_u32 v65, s8, v57, 2
    v_mad_u32_u24 v65, v65, s10, v61
    buffer_load_dwordx4 v65, s[64:67], s4 offen offset:1024 lds
    v_bfe_u32 v64, s8, v58, 2
    v_mad_u32_u24 v64, v64, s10, v62
    buffer_load_dwordx4 v64, s[64:67], s4 offen offset:2048 lds
    v_bfe_u32 v65, s8, v59, 2
    v_mad_u32_u24 v65, v65, s10, v63
    buffer_load_dwordx4 v65, s[64:67], s4 offen offset:3072 lds
    s_add_u32 s4, s4, 81920
    s_cmp_eq_u32 s4, 819200
    s_cselect_b32 s4, 0, s4
    s_mov_b32 m0, 49152
    v_bfe_u32 v64, s9, v52, 2
    v_mad_u32_u24 v64, v64, s10, v60
    buffer_load_dwordx4 v64, s[64:67], s4 offen lds
    v_bfe_u32 v65, s9, v53, 2
    v_mad_u32_u24 v65, v65, s10, v61
    buffer_load_dwordx4 v65, s[64:67], s4 offen offset:1024 lds
    v_bfe_u32 v64, s9, v54, 2
    v_mad_u32_u24 v64, v64, s10, v62
    buffer_load_dwordx4 v64, s[64:67], s4 offen offset:2048 lds
    v_bfe_u32 v65, s9, v55, 2
    v_mad_u32_u24 v65, v65, s10, v63
    buffer_load_dwordx4 v65, s[64:67], s4 offen offset:3072 lds
    s_mov_b32 m0, 88192
    v_bfe_u32 v64, s9, v56, 2
    v_mad_u32_u24 v64, v64, s10, v60
    buffer_load_dwordx4 v64, s[64:67], s4 offen lds
    v_bfe_u32 v65, s9, v57, 2
    v_mad_u32_u24 v65, v65, s10, v61
    buffer_load_dwordx4 v65, s[64:67], s4 offen offset:1024 lds
    v_bfe_u32 v64, s9, v58, 2
    v_mad_u32_u24 v64, v64, s10, v62
    buffer_load_dwordx4 v64, s[64:67], s4 offen offset:2048 lds
    v_bfe_u32 v65, s9, v59, 2
    v_mad_u32_u24 v65, v65, s10, v63
    buffer_load_dwordx4 v65, s[64:67], s4 offen offset:3072 lds
    s_add_u32 s4, s4, 81920
    s_cmp_eq_u32 s4, 819200
    s_cselect_b32 s4, 0, s4
    s_waitcnt vmcnt(0)
Lbc:
    v_readfirstlane_b32 s11, v70
    v_readfirstlane_b32 s40, v71
    v_readfirstlane_b32 s12, v72
    v_readfirstlane_b32 s41, v73
    s_cmp_eq_u32 s40, s38
    s_cselect_b32 s41, s41, s40
    s_cmp_eq_u32 s41, s38
    s_cbranch_scc1 Lbc_ok
    s_sub_u32 s39, s39, 1
    s_cbranch_scc1 Lend
    buffer_load_dwordx4 v[70:73], v69, s[28:31], 0 offen sc1
    s_waitcnt vmcnt(0)
    s_branch Lbc
Lbc_ok:
    s_mul_i32 s40, s36, 96
    s_and_b32 s13, s11, 0x7ff
    s_sub_u32 s13, 2047, s13
    s_sub_u32 s41, s13, s40
    s_cmp_lt_u32 s41, 96
    s_cselect_b32 s13, s13, -1
    s_and_b32 s14, s12, 0x7ff
    s_sub_u32 s14, 2047, s14
    s_sub_u32 s41, s14, s40
    s_cmp_lt_u32 s41, 96
    s_cselect_b32 s14, s14, -1
    v_mov_b32 v4, s13
    v_mov_b32 v5, s14
    v_mov_b32 v6, 157960
    ds_write_b64 v6, v[4:5]
    s_and_b32 s41, s13, s14
    s_cmp_eq_u32 s41, -1
    s_cbranch_scc1 Lw0_done
    s_max_i32 s40, s13, 0
    s_mul_i32 s40, s40, 1280
    s_lshl_b32 s41, s37, 7
    s_add_u32 s40, s40, s41
    s_add_u32 s40, s40, 4096
    v_lshlrev_b32 v8, 1, v1
    buffer_load_ushort v124, v8, s[48:51], s40 offen
    s_max_i32 s40, s14, 0
    s_mul_i32 s40, s40, 1280
    s_lshl_b32 s41, s37, 7
    s_add_u32 s40, s40, s41
    s_add_u32 s40, s40, 4096
    v_lshlrev_b32 v8, 1, v1
    buffer_load_ushort v125, v8, s[48:51], s40 offen
    v_min_u32 v7, 26, v1
    v_mul_u32_u24 v7, 10240, v7
Ly_poll:
    s_sub_u32 s39, s39, 1
    s_cbranch_scc1 Lend
    s_lshl_b32 s40, s37, 10
    s_add_u32 s40, s40, 7405568
    buffer_load_dword v4, v7, s[28:31], s40 offen offset:1020 sc1
    s_waitcnt vmcnt(0)
    v_cmp_ne_u32 vcc, s38, v4
    s_nop 0
    s_cbranch_vccnz Ly_poll
    buffer_load_dwordx4 v[16:19], v13, s[28:31], s40 offen sc1
    s_add_u32 s40, s40, 10240
    buffer_load_dwordx4 v[20:23], v13, s[28:31], s40 offen sc1
    s_add_u32 s40, s40, 10240
    buffer_load_dwordx4 v[24:27], v13, s[28:31], s40 offen sc1
    s_add_u32 s40, s40, 10240
    buffer_load_dwordx4 v[28:31], v13, s[28:31], s40 offen sc1
    s_add_u32 s40, s40, 10240
    buffer_load_dwordx4 v[32:35], v13, s[28:31], s40 offen sc1
    s_add_u32 s40, s40, 10240
    buffer_load_dwordx4 v[36:39], v13, s[28:31], s40 offen sc1
    s_add_u32 s40, s40, 10240
    buffer_load_dwordx4 v[40:43], v13, s[28:31], s40 offen sc1
    s_add_u32 s40, s40, 10240
    buffer_load_dwordx4 v[44:47], v13, s[28:31], s40 offen sc1
    s_add_u32 s40, s40, 10240
    buffer_load_dwordx4 v[48:51], v13, s[28:31], s40 offen sc1
    s_add_u32 s40, s40, 10240
    buffer_load_dwordx4 v[52:55], v13, s[28:31], s40 offen sc1
    s_add_u32 s40, s40, 10240
    buffer_load_dwordx4 v[56:59], v13, s[28:31], s40 offen sc1
    s_add_u32 s40, s40, 10240
    buffer_load_dwordx4 v[60:63], v13, s[28:31], s40 offen sc1
    s_add_u32 s40, s40, 10240
    buffer_load_dwordx4 v[64:67], v13, s[28:31], s40 offen sc1
    s_add_u32 s40, s40, 10240
    buffer_load_dwordx4 v[68:71], v13, s[28:31], s40 offen sc1
    s_add_u32 s40, s40, 10240
    buffer_load_dwordx4 v[72:75], v13, s[28:31], s40 offen sc1
    s_add_u32 s40, s40, 10240
    buffer_load_dwordx4 v[76:79], v13, s[28:31], s40 offen sc1
    s_add_u32 s40, s40, 10240
    buffer_load_dwordx4 v[80:83], v13, s[28:31], s40 offen sc1
    s_add_u32 s40, s40, 10240
    buffer_load_dwordx4 v[84:87], v13, s[28:31], s40 offen sc1
    s_add_u32 s40, s40, 10240
    buffer_load_dwordx4 v[88:91], v13, s[28:31], s40 offen sc1
    s_add_u32 s40, s40, 10240
    buffer_load_dwordx4 v[92:95], v13, s[28:31], s40 offen sc1
    s_add_u32 s40, s40, 10240
    buffer_load_dwordx4 v[96:99], v13, s[28:31], s40 offen sc1
    s_add_u32 s40, s40, 10240
    buffer_load_dwordx4 v[100:103], v13, s[28:31], s40 offen sc1
    s_add_u32 s40, s40, 10240
    buffer_load_dwordx4 v[104:107], v13, s[28:31], s40 offen sc1
    s_add_u32 s40, s40, 10240
    buffer_load_dwordx4 v[108:111], v13, s[28:31], s40 offen sc1
    s_add_u32 s40, s40, 10240
    buffer_load_dwordx4 v[112:115], v13, s[28:31], s40 offen sc1
    s_add_u32 s40, s40, 10240
    buffer_load_dwordx4 v[116:119], v13, s[28:31], s40 offen sc1
    s_add_u32 s40, s40, 10240
    buffer_load_dwordx4 v[120:123], v13, s[28:31], s40 offen sc1
    s_add_u32 s40, s40, 10240
    s_waitcnt vmcnt(0)
    v_xor_b32 v4, s38, v17
    v_xor_b32 v5, s38, v19
    v_or_b32 v4, v4, v5
    v_xor_b32 v5, s38, v21
    v_or_b32 v4, v4, v5
    v_xor_b32 v5, s38, v23
    v_or_b32 v4, v4, v5
    v_xor_b32 v5, s38, v25
    v_or_b32 v4, v4, v5
    v_xor_b32 v5, s38, v27
    v_or_b32 v4, v4, v5
    v_xor_b32 v5, s38, v29
    v_or_b32 v4, v4, v5
    v_xor_b32 v5, s38, v31
    v_or_b32 v4, v4, v5
    v_xor_b32 v5, s38, v33
    v_or_b32 v4, v4, v5
    v_xor_b32 v5, s38, v35
    v_or_b32 v4, v4, v5
    v_xor_b32 v5, s38, v37
    v_or_b32 v4, v4, v5
    v_xor_b32 v5, s38, v39
    v_or_b32 v4, v4, v5
    v_xor_b32 v5, s38, v41
    v_or_b32 v4, v4, v5
    v_xor_b32 v5, s38, v43
    v_or_b32 v4, v4, v5
    v_xor_b32 v5, s38, v45
    v_or_b32 v4, v4, v5
    v_xor_b32 v5, s38, v47
    v_or_b32 v4, v4, v5
    v_xor_b32 v5, s38, v49
    v_or_b32 v4, v4, v5
    v_xor_b32 v5, s38, v51
    v_or_b32 v4, v4, v5
    v_xor_b32 v5, s38, v53
    v_or_b32 v4, v4, v5
    v_xor_b32 v5, s38, v55
    v_or_b32 v4, v4, v5
    v_xor_b32 v5, s38, v57
    v_or_b32 v4, v4, v5
    v_xor_b32 v5, s38, v59
    v_or_b32 v4, v4, v5
    v_xor_b32 v5, s38, v61
    v_or_b32 v4, v4, v5
    v_xor_b32 v5, s38, v63
    v_or_b32 v4, v4, v5
    v_xor_b32 v5, s38, v65
    v_or_b32 v4, v4, v5
    v_xor_b32 v5, s38, v67
    v_or_b32 v4, v4, v5
    v_xor_b32 v5, s38, v69
    v_or_b32 v4, v4, v5
    v_xor_b32 v5, s38, v71
    v_or_b32 v4, v4, v5
    v_xor_b32 v5, s38, v73
    v_or_b32 v4, v4, v5
    v_xor_b32 v5, s38, v75
    v_or_b32 v4, v4, v5
    v_xor_b32 v5, s38, v77
    v_or_b32 v4, v4, v5
    v_xor_b32 v5, s38, v79
    v_or_b32 v4, v4, v5
    v_xor_b32 v5, s38, v81
    v_or_b32 v4, v4, v5
    v_xor_b32 v5, s38, v83
    v_or_b32 v4, v4, v5
    v_xor_b32 v5, s38, v85
    v_or_b32 v4, v4, v5
    v_xor_b32 v5, s38, v87
    v_or_b32 v4, v4, v5
    v_xor_b32 v5, s38, v89
    v_or_b32 v4, v4, v5
    v_xor_b32 v5, s38, v91
    v_or_b32 v4, v4, v5
    v_xor_b32 v5, s38, v93
    v_or_b32 v4, v4, v5
    v_xor_b32 v5, s38, v95
    v_or_b32 v4, v4, v5
    v_xor_b32 v5, s38, v97
    v_or_b32 v4, v4, v5
    v_xor_b32 v5, s38, v99
    v_or_b32 v4, v4, v5
    v_xor_b32 v5, s38, v101
    v_or_b32 v4, v4, v5
    v_xor_b32 v5, s38, v103
    v_or_b32 v4, v4, v5
    v_xor_b32 v5, s38, v105
    v_or_b32 v4, v4, v5
    v_xor_b32 v5, s38, v107
    v_or_b32 v4, v4, v5
    v_xor_b32 v5, s38, v109
    v_or_b32 v4, v4, v5
    v_xor_b32 v5, s38, v111
    v_or_b32 v4, v4, v5
    v_xor_b32 v5, s38, v113
    v_or_b32 v4, v4, v5
    v_xor_b32 v5, s38, v115
    v_or_b32 v4, v4, v5
    v_xor_b32 v5, s38, v117
    v_or_b32 v4, v4, v5
    v_xor_b32 v5, s38, v119
    v_or_b32 v4, v4, v5
    v_xor_b32 v5, s38, v121
    v_or_b32 v4, v4, v5
    v_xor_b32 v5, s38, v123
    v_or_b32 v4, v4, v5
    v_cmp_ne_u32 vcc, 0, v4
    s_nop 0
    s_cmp_lg_u64 vcc, 0
    s_cbranch_scc1 Ly_poll
    v_add_f32 v16, v16, v20
    v_add_f32 v18, v18, v22
    v_add_f32 v16, v16, v24
    v_add_f32 v18, v18, v26
    v_add_f32 v16, v16, v28
    v_add_f32 v18, v18, v30
    v_add_f32 v16, v16, v32
    v_add_f32 v18, v18, v34
    v_add_f32 v16, v16, v36
    v_add_f32 v18, v18, v38
    v_add_f32 v16, v16, v40
    v_add_f32 v18, v18, v42
    v_add_f32 v16, v16, v44
    v_add_f32 v18, v18, v46
    v_add_f32 v16, v16, v48
    v_add_f32 v18, v18, v50
    v_add_f32 v16, v16, v52
    v_add_f32 v18, v18, v54
    v_add_f32 v16, v16, v56
    v_add_f32 v18, v18, v58
    v_add_f32 v16, v16, v60
    v_add_f32 v18, v18, v62
    v_add_f32 v16, v16, v64
    v_add_f32 v18, v18, v66
    v_add_f32 v16, v16, v68
    v_add_f32 v18, v18, v70
    v_add_f32 v16, v16, v72
    v_add_f32 v18, v18, v74
    v_add_f32 v16, v16, v76
    v_add_f32 v18, v18, v78
    v_add_f32 v16, v16, v80
    v_add_f32 v18, v18, v82
    v_add_f32 v16, v16, v84
    v_add_f32 v18, v18, v86
    v_add_f32 v16, v16, v88
    v_add_f32 v18, v18, v90
    v_add_f32 v16, v16, v92
    v_add_f32 v18, v18, v94
    v_add_f32 v16, v16, v96
    v_add_f32 v18, v18, v98
    v_add_f32 v16, v16, v100
    v_add_f32 v18, v18, v102
    v_add_f32 v16, v16, v104
    v_add_f32 v18, v18, v106
    v_add_f32 v16, v16, v108
    v_add_f32 v18, v18, v110
    v_add_f32 v16, v16, v112
    v_add_f32 v18, v18, v114
    v_add_f32 v16, v16, v116
    v_add_f32 v18, v18, v118
    v_add_f32 v16, v16, v120
    v_add_f32 v18, v18, v122
    s_lshr_b32 s40, s11, 16
    s_cmp_ge_u32 s40, 0x8000
    s_cselect_b32 s41, 0x8000, -1
    s_xor_b32 s40, s40, s41
    s_lshl_b32 s40, s40, 16
    v_mov_b32 v4, s40
    v_mul_f32 v4, 0xbfb8aa3b, v4
    v_exp_f32 v4, v4
    s_nop 0
    v_add_f32 v4, 1.0, v4
    v_rcp_f32 v4, v4
    s_nop 0
    v_cvt_pk_bf16_f32 v4, v4, v4
    v_lshlrev_b32 v4, 16, v4
    v_cvt_pk_bf16_f32 v16, v16, v16
    v_lshlrev_b32 v16, 16, v16
    v_mul_f32 v16, v16, v4
    v_cvt_pk_bf16_f32 v16, v16, v16
    v_lshlrev_b32 v16, 16, v16
    s_lshr_b32 s40, s12, 16
    s_cmp_ge_u32 s40, 0x8000
    s_cselect_b32 s41, 0x8000, -1
    s_xor_b32 s40, s40, s41
    s_lshl_b32 s40, s40, 16
    v_mov_b32 v4, s40
    v_mul_f32 v4, 0xbfb8aa3b, v4
    v_exp_f32 v4, v4
    s_nop 0
    v_add_f32 v4, 1.0, v4
    v_rcp_f32 v4, v4
    s_nop 0
    v_cvt_pk_bf16_f32 v4, v4, v4
    v_lshlrev_b32 v4, 16, v4
    v_cvt_pk_bf16_f32 v18, v18, v18
    v_lshlrev_b32 v18, 16, v18
    v_mul_f32 v18, v18, v4
    v_cvt_pk_bf16_f32 v18, v18, v18
    v_lshlrev_b32 v18, 16, v18
    s_mul_i32 s40, s36, 96
    s_sub_u32 s40, s13, s40
    s_max_i32 s40, s40, 0
    s_lshl_b32 s40, s40, 2
    s_add_u32 s40, s40, 156288
    v_mov_b32 v4, s40
    ds_read2st64_b32 v[4:5], v4 offset0:0 offset1:2
    v_lshlrev_b32 v124, 16, v124
    s_waitcnt lgkmcnt(0)
    v_add_f32 v20, v124, v4
    v_cvt_pk_bf16_f32 v20, v20, v20
    v_lshlrev_b32 v20, 16, v20
    v_mul_f32 v20, v20, v5
    v_cvt_pk_bf16_f32 v20, v20, v20
    v_lshlrev_b32 v20, 16, v20
    v_add_f32 v20, v20, v16
    v_cvt_pk_bf16_f32 v20, v20, v20
    v_lshlrev_b32 v20, 16, v20
    v_mul_f32 v16, 0xbfb8aa3b, v20
    v_exp_f32 v16, v16
    s_nop 0
    v_add_f32 v16, 1.0, v16
    v_rcp_f32 v16, v16
    s_nop 0
    v_mul_f32 v16, v16, v20
    v_cvt_pk_bf16_f32 v16, v16, v16
    v_lshlrev_b32 v16, 16, v16
    s_mul_i32 s40, s36, 96
    s_sub_u32 s40, s14, s40
    s_max_i32 s40, s40, 0
    s_lshl_b32 s40, s40, 2
    s_add_u32 s40, s40, 156288
    v_mov_b32 v4, s40
    ds_read2st64_b32 v[4:5], v4 offset0:0 offset1:2
    v_lshlrev_b32 v125, 16, v125
    s_waitcnt lgkmcnt(0)
    v_add_f32 v22, v125, v4
    v_cvt_pk_bf16_f32 v22, v22, v22
    v_lshlrev_b32 v22, 16, v22
    v_mul_f32 v22, v22, v5
    v_cvt_pk_bf16_f32 v22, v22, v22
    v_lshlrev_b32 v22, 16, v22
    v_add_f32 v22, v22, v18
    v_cvt_pk_bf16_f32 v22, v22, v22
    v_lshlrev_b32 v22, 16, v22
    v_mul_f32 v18, 0xbfb8aa3b, v22
    v_exp_f32 v18, v18
    s_nop 0
    v_add_f32 v18, 1.0, v18
    v_rcp_f32 v18, v18
    s_nop 0
    v_mul_f32 v18, v18, v22
    v_cvt_pk_bf16_f32 v18, v18, v18
    v_lshlrev_b32 v18, 16, v18
    s_cmp_lg_u32 s13, -1
    s_cselect_b32 s43, 4, 0
    s_cmp_lg_u32 s14, -1
    s_cselect_b32 s40, 4, 0
    s_add_u32 s43, s43, s40
    v_mov_b32 v5, 157956
Lcw_8:
    s_sub_u32 s39, s39, 1
    s_cbranch_scc1 Lend
    ds_read_b32 v6, v5
    s_waitcnt lgkmcnt(0)
    v_readfirstlane_b32 s42, v6
    s_nop 0
    s_cmp_lt_u32 s42, s43
    s_cbranch_scc1 Lcw_8
    v_add_u32 v5, 158208, v12
    ds_read2st64_b32 v[126:127], v5 offset0:0 offset1:1
    s_waitcnt lgkmcnt(0)
    v_fma_f32 v16, v126, v16, v124
    v_cvt_pk_bf16_f32 v16, v16, v16
    s_mul_i32 s40, s13, 1280
    s_lshl_b32 s41, s37, 7
    s_add_u32 s40, s40, s41
    s_cmp_eq_u32 s13, -1
    s_cbranch_scc1 Lrow0
    buffer_store_short v16, v8, s[68:71], s40 offen
Lrow0:
    v_fma_f32 v18, v127, v18, v125
    v_cvt_pk_bf16_f32 v18, v18, v18
    s_mul_i32 s40, s14, 1280
    s_lshl_b32 s41, s37, 7
    s_add_u32 s40, s40, s41
    s_cmp_eq_u32 s14, -1
    s_cbranch_scc1 Lrow1
    buffer_store_short v18, v8, s[68:71], s40 offen
Lrow1:
Lw0_done:
    s_endpgm
Lcomp:
    s_lshl_b32 s47, s26, 1
    s_add_u32 s47, s47, s27
    s_sub_u32 s40, s37, 5
    s_cmp_ge_u32 s37, 5
    s_cselect_b32 s44, s40, s37
    s_mov_b32 s45, 0xbfe10856
    s_cmp_eq_u32 s44, 1
    s_cselect_b32 s45, 0xaff80255, s45
    s_cmp_eq_u32 s44, 2
    s_cselect_b32 s45, 0xabfe4015, s45
    s_cmp_eq_u32 s44, 3
    s_cselect_b32 s45, 0xaa7fd005, s45
    s_cmp_eq_u32 s44, 4
    s_cselect_b32 s45, 0x6adfb401, s45
    s_lshl_b32 s41, s27, 13
    s_cmp_eq_u32 s47, 1
    s_cselect_b32 s41, 0, s41
    v_bfe_u32 v7, v1, 2, 2
    v_and_b32 v8, 3, v1
    v_lshl_add_u32 v18, v2, 3, v7
    v_lshlrev_b32 v18, 7, v18
    v_lshlrev_b32 v19, 2, v1
    v_and_b32 v19, 0x60, v19
    v_lshlrev_b32 v10, 1, v8
    v_add_u32 v9, s41, v18
    v_add_u32 v11, 0, v10
    v_bfe_u32 v11, s45, v11, 2
    v_lshl_add_u32 v11, v11, 2, v8
    v_lshlrev_b32 v11, 3, v11
    v_xad_u32 v20, v11, v19, v9
    v_add_u32 v11, 8, v10
    v_bfe_u32 v11, s45, v11, 2
    v_lshl_add_u32 v11, v11, 2, v8
    v_lshlrev_b32 v11, 3, v11
    v_xad_u32 v21, v11, v19, v9
    v_add_u32 v11, 16, v10
    v_bfe_u32 v11, s45, v11, 2
    v_lshl_add_u32 v11, v11, 2, v8
    v_lshlrev_b32 v11, 3, v11
    v_xad_u32 v22, v11, v19, v9
    v_add_u32 v11, 24, v10
    v_bfe_u32 v11, s45, v11, 2
    v_lshl_add_u32 v11, v11, 2, v8
    v_lshlrev_b32 v11, 3, v11
    v_xad_u32 v23, v11, v19, v9
    v_add_u32 v24, 78080, v20
    v_add_u32 v25, 78080, v21
    v_add_u32 v26, 78080, v22
    v_add_u32 v27, 78080, v23
    v_lshrrev_b32 v10, 1, v3
    v_xor_b32 v9, v10, v2
    v_lshlrev_b32 v9, 4, v9
    v_lshl_add_u32 v9, v3, 7, v9
    s_lshl_b32 s40, s47, 11
    s_xor_b32 s42, s40, 2048
    s_add_u32 s40, s40, 22528
    s_add_u32 s42, s42, 22528
    v_add_u32 v76, s40, v9
    v_add_u32 v78, s42, v9
    s_mul_i32 s43, s26, 6144
    s_add_u32 s43, s43, 98560
    v_add_u32 v125, s43, v13
    s_lshl_b32 s52, s47, 11
    s_add_u32 s52, s52, 139648
    s_waitcnt lgkmcnt(0)
    s_mov_b64 s[28:29], s[24:25]
    s_mov_b32 s30, 268435456
    s_mov_b32 s31, 0x20000
    s_mov_b64 s[32:33], s[22:23]
    s_mov_b32 s34, 256
    s_mov_b32 s35, 0x20000
    s_load_dword s38, s[28:29], 0
    s_cmp_eq_u32 s47, 1
    s_cbranch_scc1 Lhalo
    v_xor_b32 v77, 64, v76
    v_xor_b32 v79, 64, v78
    v_add_u32 v80, 78080, v76
    v_add_u32 v81, 78080, v77
    v_add_u32 v82, 78080, v78
    v_add_u32 v83, 78080, v79
    s_cmp_eq_u32 s27, 0
    s_cselect_b64 vcc, 0, -1
    s_sub_u32 s41, 16384, s41
    v_cndmask_b32 v84, v20, v22, vcc
    v_cndmask_b32 v85, v21, v23, vcc
    v_add_u32 v84, s41, v84
    v_add_u32 v85, s41, v85
    v_add_u32 v86, 78080, v84
    v_add_u32 v87, 78080, v85
    v_lshrrev_b32 v8, 1, v2
    v_xor_b32 v8, v8, v10
    v_lshlrev_b32 v8, 4, v8
    v_lshl_add_u32 v8, v3, 7, v8
    v_and_b32 v7, 1, v2
    v_lshl_add_u32 v124, v7, 3, v8
    s_lshl_b32 s53, s46, 12
    s_mov_b32 s42, 0x84736210
    s_mov_b32 s43, 0x95
    s_cmp_eq_u32 s46, 1
    s_cselect_b32 s42, 0x83712065, s42
    s_cselect_b32 s43, 0x94, s43
    s_cmp_eq_u32 s46, 2
    s_cselect_b32 s42, 0x81307564, s42
    s_cselect_b32 s43, 0x92, s43
    s_cmp_eq_u32 s46, 3
    s_cselect_b32 s42, 0x40857362, s42
    s_cselect_b32 s43, 0x91, s43
    s_cmp_eq_u32 s46, 4
    s_cselect_b32 s42, 0x94837261, s42
    s_cselect_b32 s43, 0x50, s43
    s_lshl_b32 s46, s37, 2
    s_lshr_b64 s[42:43], s[42:43], s46
    s_and_b32 s46, s42, 15
    s_and_b32 s42, s46, 3
    s_mul_i32 s42, s42, 39040
    s_add_u32 s42, s42, s40
    v_add_u32 v4, s42, v124
    v_xor_b32 v5, 32, v4
    v_xor_b32 v6, 64, v4
    v_xor_b32 v7, 0x60, v4
    s_mov_b64 s[48:49], s[20:21]
    s_mov_b32 s50, 2621440
    s_mov_b32 s51, 0x20000
    v_mov_b32 v14, 0x3f803f80
    v_mov_b32 v15, 0x3f803f80
    v_mov_b32 v16, 0x3f803f80
    v_mov_b32 v17, 0x3f803f80
    s_mov_b32 s4, 0xaae00455
    s_cmp_eq_u32 s44, 1
    s_cselect_b32 s4, 0xaaf80155, s4
    s_cmp_eq_u32 s44, 2
    s_cselect_b32 s4, 0xaafe4055, s4
    s_cmp_eq_u32 s44, 3
    s_cselect_b32 s4, 0xaabfd055, s4
    s_cmp_eq_u32 s44, 4
    s_cselect_b32 s4, 0xaaeff455, s4
    v_lshlrev_b32 v10, 1, v2
    v_add_u32 v10, 8, v10
    v_bfe_u32 v10, s4, v10, 2
    v_cmp_eq_u32 s[6:7], 0, v10
    v_cmp_eq_u32 s[8:9], 3, v10
    v_cmp_eq_u32 s[10:11], 1, v10
    v_lshlrev_b32 v10, 1, v2
    v_add_u32 v10, 16, v10
    v_bfe_u32 v10, s4, v10, 2
    v_cmp_eq_u32 s[12:13], 0, v10
    v_cmp_eq_u32 s[14:15], 3, v10
    v_cmp_eq_u32 s[16:17], 2, v10
    s_mov_b32 s4, 0xaaaaaaaa
    s_mov_b32 s5, 0xaaaaaaaa
    s_mov_b32 s18, 0xfff0ffff
    s_mov_b32 s19, 0xf000ff00
    s_mov_b32 s20, 0xffc0fffc
    s_mov_b32 s21, 0xc000fc00
    v_mov_b32 v8, 0xffff
    v_not_b32 v9, v8
    v_cndmask_b32 v8, v8, v9, s[4:5]
    v_cndmask_b32 v118, 0, v8, s[18:19]
    v_cndmask_b32 v119, 0, v8, s[20:21]
    v_xor_b32 v116, v118, v8
    v_xor_b32 v117, v119, v8
    s_cmp_eq_u32 s36, 0
    s_cselect_b32 s40, s47, 0
    s_cmp_eq_u32 s40, 2
    s_cselect_b32 s22, 0xff800000, 0
    s_mul_i32 s40, s36, 6
    s_add_u32 s40, s40, s47
    s_sub_u32 s40, s40, 2
    s_lshl_b32 s24, s40, 7
    s_add_u32 s24, s24, 7340032
    s_mul_i32 s54, s40, 20480
    s_add_u32 s54, s54, 4194304
    s_lshl_b32 s40, s37, 11
    s_add_u32 s23, s40, s54
    s_add_u32 s55, s54, s53
    s_add_u32 s53, s53, 4096
    s_cmp_eq_u32 s53, 20480
    s_cselect_b32 s53, 0, s53
    s_add_u32 s56, s54, s53
    s_add_u32 s53, s53, 4096
    s_cmp_eq_u32 s53, 20480
    s_cselect_b32 s53, 0, s53
    s_add_u32 s57, s54, s53
    s_add_u32 s53, s53, 4096
    s_cmp_eq_u32 s53, 20480
    s_cselect_b32 s53, 0, s53
    s_add_u32 s58, s54, s53
    s_add_u32 s53, s53, 4096
    s_cmp_eq_u32 s53, 20480
    s_cselect_b32 s53, 0, s53
    s_add_u32 s59, s54, s53
    s_add_u32 s53, s53, 4096
    s_cmp_eq_u32 s53, 20480
    s_cselect_b32 s53, 0, s53
    s_mul_i32 s40, s36, 10
    s_add_u32 s40, s40, s37
    s_mul_i32 s60, s40, 6144
    s_lshl_b32 s40, s47, 10
    s_add_u32 s60, s60, s40
    s_add_u32 s60, s60, 1046528
    s_sub_u32 s61, s60, 6144
    s_add_u32 s62, s60, 6144
    s_cmp_eq_u32 s44, 0
    s_cselect_b32 s63, 0, -1
    s_cmp_eq_u32 s44, 4
    s_cselect_b32 s64, 0, -1
    s_lshl_b32 s40, s37, 2
    v_mov_b32 v97, s40
    s_mov_b32 s25, 0x3ea52b5c
    s_lshl_b32 s40, s47, 6
    s_add_u32 s40, s40, 156160
    v_lshl_add_u32 v94, v3, 2, s40
    v_and_b32 v8, 1, v1
    v_lshl_add_u32 v8, v2, 2, v8
    v_lshl_add_u32 v8, v8, 2, s40
    v_subrev_u32 v9, 64, v8
    v_cndmask_b32 v92, v9, v8, s[18:19]
    v_cndmask_b32 v93, v9, v8, s[20:21]
    v_lshlrev_b32 v95, 4, v2
    s_lshl_b32 s40, s27, 8
    s_add_u32 s40, s40, 157184
    v_add_u32 v95, s40, v95
    v_mov_b32 v96, 157968
    v_mov_b32 v100, -1
    v_mov_b32 v101, -1
    v_mov_b32 v102, -1
    v_mov_b32 v103, -1
    v_mov_b32 v127, 157984
    s_lshl_b32 s40, s3, 2
    s_add_u32 s40, s40, 158016
    v_mov_b32 v10, s40
    v_xor_b32 v11, 16, v10
    v_cndmask_b32 v127, v127, v11, s[4:5]
    s_waitcnt lgkmcnt(0)
    s_barrier
    ds_read_b128 a[64:67], v76 offset:0
    ds_read_b128 a[68:71], v78 offset:0
    ds_read_b64_tr_b16 a[80:81], v20 offset:0
    ds_read_b64_tr_b16 a[82:83], v20 offset:512
    ds_read_b64_tr_b16 a[84:85], v21 offset:0
    ds_read_b64_tr_b16 a[86:87], v21 offset:512
    ds_read_b64_tr_b16 a[88:89], v22 offset:0
    ds_read_b64_tr_b16 a[90:91], v22 offset:512
    ds_read_b64_tr_b16 a[92:93], v23 offset:0
    ds_read_b64_tr_b16 a[94:95], v23 offset:512
    ds_read_b64_tr_b16 a[96:97], v84 offset:0
    ds_read_b64_tr_b16 a[98:99], v84 offset:512
    ds_read_b64_tr_b16 a[100:101], v85 offset:0
    ds_read_b64_tr_b16 a[102:103], v85 offset:512
    s_add_u32 s38, s38, 0x9e3779b8
    s_or_b32 s38, s38, 1
    s_cmp_lg_u32 s46, 0
    s_cbranch_scc1 Lxe0
    ds_read_b64 v[108:109], v4
    ds_read_b64 v[110:111], v5
    ds_read_b64 v[112:113], v6
    ds_read_b64 v[114:115], v7
Lxe0:
    s_setprio 1
    s_waitcnt lgkmcnt(10)
    v_mfma_f32_16x16x32_bf16 v[28:31], a[80:83], a[64:67], 0
    ds_read_b128 a[72:75], v77 offset:0
    ds_read_b128 a[76:79], v79 offset:0
    v_mfma_f32_16x16x32_bf16 v[44:47], a[80:83], a[68:71], 0
    ds_read_b64_tr_b16 a[104:105], v20 offset:4096
    s_waitcnt lgkmcnt(11)
    v_mfma_f32_16x16x32_bf16 v[32:35], a[84:87], a[64:67], 0
    ds_read_b64_tr_b16 a[106:107], v20 offset:4608
    v_mfma_f32_16x16x32_bf16 v[48:51], a[84:87], a[68:71], 0
    ds_read_b64_tr_b16 a[108:109], v21 offset:4096
    s_waitcnt lgkmcnt(11)
    v_mfma_f32_16x16x32_bf16 v[36:39], a[88:91], a[64:67], 0
    ds_read_b64_tr_b16 a[110:111], v21 offset:4608
    ds_read_b64_tr_b16 a[112:113], v22 offset:4096
    v_mfma_f32_16x16x32_bf16 v[52:55], a[88:91], a[68:71], 0
    ds_read_b64_tr_b16 a[114:115], v22 offset:4608
    s_setprio 0
    s_waitcnt lgkmcnt(12)
    v_mfma_f32_16x16x32_bf16 v[40:43], a[92:95], a[64:67], 0
    ds_read_b64_tr_b16 a[116:117], v23 offset:4096
    v_mfma_f32_16x16x32_bf16 v[56:59], a[92:95], a[68:71], 0
    ds_read_b64_tr_b16 a[118:119], v23 offset:4608
    s_waitcnt lgkmcnt(12)
    v_mfma_f32_16x16x32_bf16 v[60:63], a[64:67], a[96:99], 0
    ds_read_b64_tr_b16 a[120:121], v84 offset:4096
    v_mfma_f32_16x16x32_bf16 v[68:71], a[68:71], a[96:99], 0
    ds_read_b64_tr_b16 a[122:123], v84 offset:4608
    s_waitcnt lgkmcnt(12)
    v_mfma_f32_16x16x32_bf16 v[64:67], a[64:67], a[100:103], 0
    ds_read_b64_tr_b16 a[124:125], v85 offset:4096
    v_mfma_f32_16x16x32_bf16 v[72:75], a[68:71], a[100:103], 0
    ds_read_b64_tr_b16 a[126:127], v85 offset:4608
    s_barrier
    s_setprio 3
    s_waitcnt lgkmcnt(10)
    v_mfma_f32_16x16x32_bf16 v[28:31], a[104:107], a[72:75], v[28:31]
    ds_read_b128 a[64:67], v76 offset:39040
    ds_read_b128 a[68:71], v78 offset:39040
    v_mfma_f32_16x16x32_bf16 v[44:47], a[104:107], a[76:79], v[44:47]
    ds_read_b64_tr_b16 a[80:81], v20 offset:39040
    s_waitcnt lgkmcnt(11)
    v_mfma_f32_16x16x32_bf16 v[32:35], a[108:111], a[72:75], v[32:35]
    ds_read_b64_tr_b16 a[82:83], v20 offset:39552
    v_mfma_f32_16x16x32_bf16 v[48:51], a[108:111], a[76:79], v[48:51]
    ds_read_b64_tr_b16 a[84:85], v21 offset:39040
    s_waitcnt lgkmcnt(11)
    v_mfma_f32_16x16x32_bf16 v[36:39], a[112:115], a[72:75], v[36:39]
    ds_read_b64_tr_b16 a[86:87], v21 offset:39552
    v_mfma_f32_16x16x32_bf16 v[52:55], a[112:115], a[76:79], v[52:55]
    ds_read_b64_tr_b16 a[88:89], v22 offset:39040
    s_setprio 2
    s_waitcnt lgkmcnt(11)
    v_mfma_f32_16x16x32_bf16 v[40:43], a[116:119], a[72:75], v[40:43]
    ds_read_b64_tr_b16 a[90:91], v22 offset:39552
    ds_read_b64_tr_b16 a[92:93], v23 offset:39040
    v_mfma_f32_16x16x32_bf16 v[56:59], a[116:119], a[76:79], v[56:59]
    ds_read_b64_tr_b16 a[94:95], v23 offset:39552
    s_waitcnt lgkmcnt(12)
    v_mfma_f32_16x16x32_bf16 v[60:63], a[72:75], a[120:123], v[60:63]
    ds_read_b64_tr_b16 a[96:97], v84 offset:39040
    v_mfma_f32_16x16x32_bf16 v[68:71], a[76:79], a[120:123], v[68:71]
    ds_read_b64_tr_b16 a[98:99], v84 offset:39552
    s_waitcnt lgkmcnt(12)
    v_mfma_f32_16x16x32_bf16 v[64:67], a[72:75], a[124:127], v[64:67]
    ds_read_b64_tr_b16 a[100:101], v85 offset:39040
    v_mfma_f32_16x16x32_bf16 v[72:75], a[76:79], a[124:127], v[72:75]
    ds_read_b64_tr_b16 a[102:103], v85 offset:39552
    s_cmp_lg_u32 s46, 1
    s_cbranch_scc1 Lxe1
    ds_read_b64 v[108:109], v4
    ds_read_b64 v[110:111], v5
    ds_read_b64 v[112:113], v6
    ds_read_b64 v[114:115], v7
Lxe1:
    s_setprio 1
    s_waitcnt lgkmcnt(10)
    v_mfma_f32_16x16x32_bf16 v[28:31], a[80:83], a[64:67], v[28:31]
    ds_read_b128 a[72:75], v77 offset:39040
    ds_read_b128 a[76:79], v79 offset:39040
    v_mfma_f32_16x16x32_bf16 v[44:47], a[80:83], a[68:71], v[44:47]
    ds_read_b64_tr_b16 a[104:105], v20 offset:43136
    s_waitcnt lgkmcnt(11)
    v_mfma_f32_16x16x32_bf16 v[32:35], a[84:87], a[64:67], v[32:35]
    ds_read_b64_tr_b16 a[106:107], v20 offset:43648
    v_mfma_f32_16x16x32_bf16 v[48:51], a[84:87], a[68:71], v[48:51]
    ds_read_b64_tr_b16 a[108:109], v21 offset:43136
    s_waitcnt lgkmcnt(11)
    v_mfma_f32_16x16x32_bf16 v[36:39], a[88:91], a[64:67], v[36:39]
    ds_read_b64_tr_b16 a[110:111], v21 offset:43648
    ds_read_b64_tr_b16 a[112:113], v22 offset:43136
    v_mfma_f32_16x16x32_bf16 v[52:55], a[88:91], a[68:71], v[52:55]
    ds_read_b64_tr_b16 a[114:115], v22 offset:43648
    s_setprio 0
    s_waitcnt lgkmcnt(12)
    v_mfma_f32_16x16x32_bf16 v[40:43], a[92:95], a[64:67], v[40:43]
    ds_read_b64_tr_b16 a[116:117], v23 offset:43136
    v_mfma_f32_16x16x32_bf16 v[56:59], a[92:95], a[68:71], v[56:59]
    ds_read_b64_tr_b16 a[118:119], v23 offset:43648
    s_waitcnt lgkmcnt(12)
    v_mfma_f32_16x16x32_bf16 v[60:63], a[64:67], a[96:99], v[60:63]
    ds_read_b64_tr_b16 a[120:121], v84 offset:43136
    v_mfma_f32_16x16x32_bf16 v[68:71], a[68:71], a[96:99], v[68:71]
    ds_read_b64_tr_b16 a[122:123], v84 offset:43648
    s_waitcnt lgkmcnt(12)
    v_mfma_f32_16x16x32_bf16 v[64:67], a[64:67], a[100:103], v[64:67]
    ds_read_b64_tr_b16 a[124:125], v85 offset:43136
    v_mfma_f32_16x16x32_bf16 v[72:75], a[68:71], a[100:103], v[72:75]
    ds_read_b64_tr_b16 a[126:127], v85 offset:43648
    s_barrier
    s_setprio 3
    s_waitcnt lgkmcnt(10)
    v_mfma_f32_16x16x32_bf16 v[28:31], a[104:107], a[72:75], v[28:31]
    ds_read_b128 a[64:67], v80 offset:0
    ds_read_b128 a[68:71], v82 offset:0
    v_mfma_f32_16x16x32_bf16 v[44:47], a[104:107], a[76:79], v[44:47]
    ds_read_b64_tr_b16 a[80:81], v24 offset:0
    s_waitcnt lgkmcnt(11)
    v_mfma_f32_16x16x32_bf16 v[32:35], a[108:111], a[72:75], v[32:35]
    ds_read_b64_tr_b16 a[82:83], v24 offset:512
    v_mfma_f32_16x16x32_bf16 v[48:51], a[108:111], a[76:79], v[48:51]
    ds_read_b64_tr_b16 a[84:85], v25 offset:0
    s_waitcnt lgkmcnt(11)
    v_mfma_f32_16x16x32_bf16 v[36:39], a[112:115], a[72:75], v[36:39]
    ds_read_b64_tr_b16 a[86:87], v25 offset:512
    v_mfma_f32_16x16x32_bf16 v[52:55], a[112:115], a[76:79], v[52:55]
    ds_read_b64_tr_b16 a[88:89], v26 offset:0
    s_setprio 2
    s_waitcnt lgkmcnt(11)
    v_mfma_f32_16x16x32_bf16 v[40:43], a[116:119], a[72:75], v[40:43]
    ds_read_b64_tr_b16 a[90:91], v26 offset:512
    ds_read_b64_tr_b16 a[92:93], v27 offset:0
    v_mfma_f32_16x16x32_bf16 v[56:59], a[116:119], a[76:79], v[56:59]
    ds_read_b64_tr_b16 a[94:95], v27 offset:512
    s_waitcnt lgkmcnt(12)
    v_mfma_f32_16x16x32_bf16 v[60:63], a[72:75], a[120:123], v[60:63]
    ds_read_b64_tr_b16 a[96:97], v86 offset:0
    v_mfma_f32_16x16x32_bf16 v[68:71], a[76:79], a[120:123], v[68:71]
    ds_read_b64_tr_b16 a[98:99], v86 offset:512
    s_waitcnt lgkmcnt(12)
    v_mfma_f32_16x16x32_bf16 v[64:67], a[72:75], a[124:127], v[64:67]
    ds_read_b64_tr_b16 a[100:101], v87 offset:0
    v_mfma_f32_16x16x32_bf16 v[72:75], a[76:79], a[124:127], v[72:75]
    ds_read_b64_tr_b16 a[102:103], v87 offset:512
    buffer_store_dwordx4 v[100:103], v13, s[28:31], s60 offen sc1
    s_cmp_lg_u32 s46, 2
    s_cbranch_scc1 Lxe2
    ds_read_b64 v[108:109], v4
    ds_read_b64 v[110:111], v5
    ds_read_b64 v[112:113], v6
    ds_read_b64 v[114:115], v7
Lxe2:
    s_setprio 1
    s_waitcnt lgkmcnt(10)
    v_mfma_f32_16x16x32_bf16 v[28:31], a[80:83], a[64:67], v[28:31]
    ds_read_b128 a[72:75], v81 offset:0
    ds_read_b128 a[76:79], v83 offset:0
    v_mfma_f32_16x16x32_bf16 v[44:47], a[80:83], a[68:71], v[44:47]
    ds_read_b64_tr_b16 a[104:105], v24 offset:4096
    s_waitcnt lgkmcnt(11)
    v_mfma_f32_16x16x32_bf16 v[32:35], a[84:87], a[64:67], v[32:35]
    ds_read_b64_tr_b16 a[106:107], v24 offset:4608
    v_mfma_f32_16x16x32_bf16 v[48:51], a[84:87], a[68:71], v[48:51]
    ds_read_b64_tr_b16 a[108:109], v25 offset:4096
    s_waitcnt lgkmcnt(11)
    v_mfma_f32_16x16x32_bf16 v[36:39], a[88:91], a[64:67], v[36:39]
    ds_read_b64_tr_b16 a[110:111], v25 offset:4608
    ds_read_b64_tr_b16 a[112:113], v26 offset:4096
    v_mfma_f32_16x16x32_bf16 v[52:55], a[88:91], a[68:71], v[52:55]
    ds_read_b64_tr_b16 a[114:115], v26 offset:4608
    s_setprio 0
    s_waitcnt lgkmcnt(12)
    v_mfma_f32_16x16x32_bf16 v[40:43], a[92:95], a[64:67], v[40:43]
    ds_read_b64_tr_b16 a[116:117], v27 offset:4096
    v_mfma_f32_16x16x32_bf16 v[56:59], a[92:95], a[68:71], v[56:59]
    ds_read_b64_tr_b16 a[118:119], v27 offset:4608
    s_waitcnt lgkmcnt(12)
    v_mfma_f32_16x16x32_bf16 v[60:63], a[64:67], a[96:99], v[60:63]
    ds_read_b64_tr_b16 a[120:121], v86 offset:4096
    v_mfma_f32_16x16x32_bf16 v[68:71], a[68:71], a[96:99], v[68:71]
    ds_read_b64_tr_b16 a[122:123], v86 offset:4608
    s_waitcnt lgkmcnt(12)
    v_mfma_f32_16x16x32_bf16 v[64:67], a[64:67], a[100:103], v[64:67]
    ds_read_b64_tr_b16 a[124:125], v87 offset:4096
    v_mfma_f32_16x16x32_bf16 v[72:75], a[68:71], a[100:103], v[72:75]
    ds_read_b64_tr_b16 a[126:127], v87 offset:4608
    s_barrier
    s_setprio 3
    s_waitcnt lgkmcnt(10)
    v_mfma_f32_16x16x32_bf16 v[28:31], a[104:107], a[72:75], v[28:31]
    ds_read_b128 a[64:67], v80 offset:39040
    ds_read_b128 a[68:71], v82 offset:39040
    v_mfma_f32_16x16x32_bf16 v[44:47], a[104:107], a[76:79], v[44:47]
    ds_read_b64_tr_b16 a[80:81], v24 offset:39040
    s_waitcnt lgkmcnt(11)
    v_mfma_f32_16x16x32_bf16 v[32:35], a[108:111], a[72:75], v[32:35]
    ds_read_b64_tr_b16 a[82:83], v24 offset:39552
    v_mfma_f32_16x16x32_bf16 v[48:51], a[108:111], a[76:79], v[48:51]
    ds_read_b64_tr_b16 a[84:85], v25 offset:39040
    s_waitcnt lgkmcnt(11)
    v_mfma_f32_16x16x32_bf16 v[36:39], a[112:115], a[72:75], v[36:39]
    ds_read_b64_tr_b16 a[86:87], v25 offset:39552
    v_mfma_f32_16x16x32_bf16 v[52:55], a[112:115], a[76:79], v[52:55]
    ds_read_b64_tr_b16 a[88:89], v26 offset:39040
    s_setprio 2
    s_waitcnt lgkmcnt(11)
    v_mfma_f32_16x16x32_bf16 v[40:43], a[116:119], a[72:75], v[40:43]
    ds_read_b64_tr_b16 a[90:91], v26 offset:39552
    ds_read_b64_tr_b16 a[92:93], v27 offset:39040
    v_mfma_f32_16x16x32_bf16 v[56:59], a[116:119], a[76:79], v[56:59]
    ds_read_b64_tr_b16 a[94:95], v27 offset:39552
    s_waitcnt lgkmcnt(12)
    v_mfma_f32_16x16x32_bf16 v[60:63], a[72:75], a[120:123], v[60:63]
    ds_read_b64_tr_b16 a[96:97], v86 offset:39040
    v_mfma_f32_16x16x32_bf16 v[68:71], a[76:79], a[120:123], v[68:71]
    ds_read_b64_tr_b16 a[98:99], v86 offset:39552
    s_waitcnt lgkmcnt(12)
    v_mfma_f32_16x16x32_bf16 v[64:67], a[72:75], a[124:127], v[64:67]
    ds_read_b64_tr_b16 a[100:101], v87 offset:39040
    v_mfma_f32_16x16x32_bf16 v[72:75], a[76:79], a[124:127], v[72:75]
    ds_read_b64_tr_b16 a[102:103], v87 offset:39552
    s_cmp_lg_u32 s46, 3
    s_cbranch_scc1 Lxe3
    ds_read_b64 v[108:109], v4
    ds_read_b64 v[110:111], v5
    ds_read_b64 v[112:113], v6
    ds_read_b64 v[114:115], v7
Lxe3:
    s_setprio 1
    s_waitcnt lgkmcnt(10)
    v_mfma_f32_16x16x32_bf16 v[28:31], a[80:83], a[64:67], v[28:31]
    ds_read_b128 a[72:75], v81 offset:39040
    ds_read_b128 a[76:79], v83 offset:39040
    v_mfma_f32_16x16x32_bf16 v[44:47], a[80:83], a[68:71], v[44:47]
    ds_read_b64_tr_b16 a[104:105], v24 offset:43136
    s_waitcnt lgkmcnt(11)
    v_mfma_f32_16x16x32_bf16 v[32:35], a[84:87], a[64:67], v[32:35]
    ds_read_b64_tr_b16 a[106:107], v24 offset:43648
    v_mfma_f32_16x16x32_bf16 v[48:51], a[84:87], a[68:71], v[48:51]
    ds_read_b64_tr_b16 a[108:109], v25 offset:43136
    s_waitcnt lgkmcnt(11)
    v_mfma_f32_16x16x32_bf16 v[36:39], a[88:91], a[64:67], v[36:39]
    ds_read_b64_tr_b16 a[110:111], v25 offset:43648
    ds_read_b64_tr_b16 a[112:113], v26 offset:43136
    v_mfma_f32_16x16x32_bf16 v[52:55], a[88:91], a[68:71], v[52:55]
    ds_read_b64_tr_b16 a[114:115], v26 offset:43648
    s_setprio 0
    s_waitcnt lgkmcnt(12)
    v_mfma_f32_16x16x32_bf16 v[40:43], a[92:95], a[64:67], v[40:43]
    ds_read_b64_tr_b16 a[116:117], v27 offset:43136
    v_mfma_f32_16x16x32_bf16 v[56:59], a[92:95], a[68:71], v[56:59]
    ds_read_b64_tr_b16 a[118:119], v27 offset:43648
    s_waitcnt lgkmcnt(12)
    v_mfma_f32_16x16x32_bf16 v[60:63], a[64:67], a[96:99], v[60:63]
    ds_read_b64_tr_b16 a[120:121], v86 offset:43136
    v_mfma_f32_16x16x32_bf16 v[68:71], a[68:71], a[96:99], v[68:71]
    ds_read_b64_tr_b16 a[122:123], v86 offset:43648
    s_waitcnt lgkmcnt(12)
    v_mfma_f32_16x16x32_bf16 v[64:67], a[64:67], a[100:103], v[64:67]
    ds_read_b64_tr_b16 a[124:125], v87 offset:43136
    v_mfma_f32_16x16x32_bf16 v[72:75], a[68:71], a[100:103], v[72:75]
    ds_read_b64_tr_b16 a[126:127], v87 offset:43648
    s_barrier
    s_setprio 3
    s_waitcnt lgkmcnt(10)
    v_mfma_f32_16x16x32_bf16 v[28:31], a[104:107], a[72:75], v[28:31]
    ds_read_b128 a[64:67], v76 offset:0
    ds_read_b128 a[68:71], v78 offset:0
    v_mfma_f32_16x16x32_bf16 v[44:47], a[104:107], a[76:79], v[44:47]
    ds_read_b64_tr_b16 a[80:81], v20 offset:0
    s_waitcnt lgkmcnt(11)
    v_mfma_f32_16x16x32_bf16 v[32:35], a[108:111], a[72:75], v[32:35]
    ds_read_b64_tr_b16 a[82:83], v20 offset:512
    v_mfma_f32_16x16x32_bf16 v[48:51], a[108:111], a[76:79], v[48:51]
    ds_read_b64_tr_b16 a[84:85], v21 offset:0
    s_waitcnt lgkmcnt(11)
    v_mfma_f32_16x16x32_bf16 v[36:39], a[112:115], a[72:75], v[36:39]
    ds_read_b64_tr_b16 a[86:87], v21 offset:512
    v_mfma_f32_16x16x32_bf16 v[52:55], a[112:115], a[76:79], v[52:55]
    ds_read_b64_tr_b16 a[88:89], v22 offset:0
    s_setprio 2
    s_waitcnt lgkmcnt(11)
    v_mfma_f32_16x16x32_bf16 v[40:43], a[116:119], a[72:75], v[40:43]
    ds_read_b64_tr_b16 a[90:91], v22 offset:512
    ds_read_b64_tr_b16 a[92:93], v23 offset:0
    v_mfma_f32_16x16x32_bf16 v[56:59], a[116:119], a[76:79], v[56:59]
    ds_read_b64_tr_b16 a[94:95], v23 offset:512
    s_waitcnt lgkmcnt(12)
    v_mfma_f32_16x16x32_bf16 v[60:63], a[72:75], a[120:123], v[60:63]
    ds_read_b64_tr_b16 a[96:97], v84 offset:0
    v_mfma_f32_16x16x32_bf16 v[68:71], a[76:79], a[120:123], v[68:71]
    ds_read_b64_tr_b16 a[98:99], v84 offset:512
    s_waitcnt lgkmcnt(12)
    v_mfma_f32_16x16x32_bf16 v[64:67], a[72:75], a[124:127], v[64:67]
    ds_read_b64_tr_b16 a[100:101], v85 offset:0
    v_mfma_f32_16x16x32_bf16 v[72:75], a[76:79], a[124:127], v[72:75]
    ds_read_b64_tr_b16 a[102:103], v85 offset:512
    buffer_store_dwordx4 v[100:103], v13, s[28:31], s23 offen offset:0 sc1
    s_cmp_lg_u32 s46, 4
    s_cbranch_scc1 Lxe4
    ds_read_b64 v[108:109], v4
    ds_read_b64 v[110:111], v5
    ds_read_b64 v[112:113], v6
    ds_read_b64 v[114:115], v7
Lxe4:
    s_setprio 1
    s_waitcnt lgkmcnt(10)
    v_mfma_f32_16x16x32_bf16 v[28:31], a[80:83], a[64:67], v[28:31]
    ds_read_b128 a[72:75], v77 offset:0
    ds_read_b128 a[76:79], v79 offset:0
    v_mfma_f32_16x16x32_bf16 v[44:47], a[80:83], a[68:71], v[44:47]
    ds_read_b64_tr_b16 a[104:105], v20 offset:4096
    s_waitcnt lgkmcnt(11)
    v_mfma_f32_16x16x32_bf16 v[32:35], a[84:87], a[64:67], v[32:35]
    ds_read_b64_tr_b16 a[106:107], v20 offset:4608
    v_mfma_f32_16x16x32_bf16 v[48:51], a[84:87], a[68:71], v[48:51]
    ds_read_b64_tr_b16 a[108:109], v21 offset:4096
    s_waitcnt lgkmcnt(11)
    v_mfma_f32_16x16x32_bf16 v[36:39], a[88:91], a[64:67], v[36:39]
    ds_read_b64_tr_b16 a[110:111], v21 offset:4608
    ds_read_b64_tr_b16 a[112:113], v22 offset:4096
    v_mfma_f32_16x16x32_bf16 v[52:55], a[88:91], a[68:71], v[52:55]
    ds_read_b64_tr_b16 a[114:115], v22 offset:4608
    s_setprio 0
    s_waitcnt lgkmcnt(12)
    v_mfma_f32_16x16x32_bf16 v[40:43], a[92:95], a[64:67], v[40:43]
    ds_read_b64_tr_b16 a[116:117], v23 offset:4096
    v_mfma_f32_16x16x32_bf16 v[56:59], a[92:95], a[68:71], v[56:59]
    ds_read_b64_tr_b16 a[118:119], v23 offset:4608
    s_waitcnt lgkmcnt(12)
    v_mfma_f32_16x16x32_bf16 v[60:63], a[64:67], a[96:99], v[60:63]
    ds_read_b64_tr_b16 a[120:121], v84 offset:4096
    v_mfma_f32_16x16x32_bf16 v[68:71], a[68:71], a[96:99], v[68:71]
    ds_read_b64_tr_b16 a[122:123], v84 offset:4608
    s_waitcnt lgkmcnt(12)
    v_mfma_f32_16x16x32_bf16 v[64:67], a[64:67], a[100:103], v[64:67]
    ds_read_b64_tr_b16 a[124:125], v85 offset:4096
    v_mfma_f32_16x16x32_bf16 v[72:75], a[68:71], a[100:103], v[72:75]
    ds_read_b64_tr_b16 a[126:127], v85 offset:4608
    s_barrier
    s_setprio 3
    s_waitcnt lgkmcnt(10)
    v_mfma_f32_16x16x32_bf16 v[28:31], a[104:107], a[72:75], v[28:31]
    ds_read_b128 a[64:67], v76 offset:39040
    ds_read_b128 a[68:71], v78 offset:39040
    v_mfma_f32_16x16x32_bf16 v[44:47], a[104:107], a[76:79], v[44:47]
    ds_read_b64_tr_b16 a[80:81], v20 offset:39040
    s_waitcnt lgkmcnt(11)
    v_mfma_f32_16x16x32_bf16 v[32:35], a[108:111], a[72:75], v[32:35]
    ds_read_b64_tr_b16 a[82:83], v20 offset:39552
    v_mfma_f32_16x16x32_bf16 v[48:51], a[108:111], a[76:79], v[48:51]
    ds_read_b64_tr_b16 a[84:85], v21 offset:39040
    s_waitcnt lgkmcnt(11)
    v_mfma_f32_16x16x32_bf16 v[36:39], a[112:115], a[72:75], v[36:39]
    ds_read_b64_tr_b16 a[86:87], v21 offset:39552
    v_mfma_f32_16x16x32_bf16 v[52:55], a[112:115], a[76:79], v[52:55]
    ds_read_b64_tr_b16 a[88:89], v22 offset:39040
    s_setprio 2
    s_waitcnt lgkmcnt(11)
    v_mfma_f32_16x16x32_bf16 v[40:43], a[116:119], a[72:75], v[40:43]
    ds_read_b64_tr_b16 a[90:91], v22 offset:39552
    ds_read_b64_tr_b16 a[92:93], v23 offset:39040
    v_mfma_f32_16x16x32_bf16 v[56:59], a[116:119], a[76:79], v[56:59]
    ds_read_b64_tr_b16 a[94:95], v23 offset:39552
    s_waitcnt lgkmcnt(12)
    v_mfma_f32_16x16x32_bf16 v[60:63], a[72:75], a[120:123], v[60:63]
    ds_read_b64_tr_b16 a[96:97], v84 offset:39040
    v_mfma_f32_16x16x32_bf16 v[68:71], a[76:79], a[120:123], v[68:71]
    ds_read_b64_tr_b16 a[98:99], v84 offset:39552
    s_waitcnt lgkmcnt(12)
    v_mfma_f32_16x16x32_bf16 v[64:67], a[72:75], a[124:127], v[64:67]
    ds_read_b64_tr_b16 a[100:101], v85 offset:39040
    v_mfma_f32_16x16x32_bf16 v[72:75], a[76:79], a[124:127], v[72:75]
    ds_read_b64_tr_b16 a[102:103], v85 offset:39552
    s_cmp_lg_u32 s46, 5
    s_cbranch_scc1 Lxe5
    ds_read_b64 v[108:109], v4
    ds_read_b64 v[110:111], v5
    ds_read_b64 v[112:113], v6
    ds_read_b64 v[114:115], v7
Lxe5:
    s_setprio 1
    s_waitcnt lgkmcnt(10)
    v_mfma_f32_16x16x32_bf16 v[28:31], a[80:83], a[64:67], v[28:31]
    ds_read_b128 a[72:75], v77 offset:39040
    ds_read_b128 a[76:79], v79 offset:39040
    v_mfma_f32_16x16x32_bf16 v[44:47], a[80:83], a[68:71], v[44:47]
    ds_read_b64_tr_b16 a[104:105], v20 offset:43136
    s_waitcnt lgkmcnt(11)
    v_mfma_f32_16x16x32_bf16 v[32:35], a[84:87], a[64:67], v[32:35]
    ds_read_b64_tr_b16 a[106:107], v20 offset:43648
    v_mfma_f32_16x16x32_bf16 v[48:51], a[84:87], a[68:71], v[48:51]
    ds_read_b64_tr_b16 a[108:109], v21 offset:43136
    s_waitcnt lgkmcnt(11)
    v_mfma_f32_16x16x32_bf16 v[36:39], a[88:91], a[64:67], v[36:39]
    ds_read_b64_tr_b16 a[110:111], v21 offset:43648
    ds_read_b64_tr_b16 a[112:113], v22 offset:43136
    v_mfma_f32_16x16x32_bf16 v[52:55], a[88:91], a[68:71], v[52:55]
    ds_read_b64_tr_b16 a[114:115], v22 offset:43648
    s_setprio 0
    s_waitcnt lgkmcnt(12)
    v_mfma_f32_16x16x32_bf16 v[40:43], a[92:95], a[64:67], v[40:43]
    ds_read_b64_tr_b16 a[116:117], v23 offset:43136
    v_mfma_f32_16x16x32_bf16 v[56:59], a[92:95], a[68:71], v[56:59]
    ds_read_b64_tr_b16 a[118:119], v23 offset:43648
    s_waitcnt lgkmcnt(12)
    v_mfma_f32_16x16x32_bf16 v[60:63], a[64:67], a[96:99], v[60:63]
    ds_read_b64_tr_b16 a[120:121], v84 offset:43136
    v_mfma_f32_16x16x32_bf16 v[68:71], a[68:71], a[96:99], v[68:71]
    ds_read_b64_tr_b16 a[122:123], v84 offset:43648
    s_waitcnt lgkmcnt(12)
    v_mfma_f32_16x16x32_bf16 v[64:67], a[64:67], a[100:103], v[64:67]
    ds_read_b64_tr_b16 a[124:125], v85 offset:43136
    v_mfma_f32_16x16x32_bf16 v[72:75], a[68:71], a[100:103], v[72:75]
    ds_read_b64_tr_b16 a[126:127], v85 offset:43648
    s_barrier
    s_setprio 3
    s_waitcnt lgkmcnt(10)
    v_mfma_f32_16x16x32_bf16 v[28:31], a[104:107], a[72:75], v[28:31]
    ds_read_b128 a[0:3], v80 offset:0
    v_mfma_f32_16x16x32_bf16 v[44:47], a[104:107], a[76:79], v[44:47]
    ds_read_b128 a[4:7], v82 offset:0
    s_waitcnt lgkmcnt(10)
    v_mfma_f32_16x16x32_bf16 v[32:35], a[108:111], a[72:75], v[32:35]
    ds_read_b64_tr_b16 a[80:81], v24 offset:0
    v_mfma_f32_16x16x32_bf16 v[48:51], a[108:111], a[76:79], v[48:51]
    ds_read_b64_tr_b16 a[82:83], v24 offset:512
    s_waitcnt lgkmcnt(10)
    v_mfma_f32_16x16x32_bf16 v[36:39], a[112:115], a[72:75], v[36:39]
    ds_read_b64_tr_b16 a[84:85], v25 offset:0
    v_mfma_f32_16x16x32_bf16 v[52:55], a[112:115], a[76:79], v[52:55]
    s_setprio 2
    s_waitcnt lgkmcnt(9)
    v_mfma_f32_16x16x32_bf16 v[40:43], a[116:119], a[72:75], v[40:43]
    ds_read_b64_tr_b16 a[86:87], v25 offset:512
    v_mfma_f32_16x16x32_bf16 v[56:59], a[116:119], a[76:79], v[56:59]
    ds_read_b64_tr_b16 a[88:89], v26 offset:0
    s_waitcnt lgkmcnt(9)
    v_mfma_f32_16x16x32_bf16 v[60:63], a[72:75], a[120:123], v[60:63]
    ds_read_b64_tr_b16 a[90:91], v26 offset:512
    v_mfma_f32_16x16x32_bf16 v[68:71], a[76:79], a[120:123], v[68:71]
    ds_read_b64_tr_b16 a[92:93], v27 offset:0
    s_waitcnt lgkmcnt(9)
    v_mfma_f32_16x16x32_bf16 v[64:67], a[72:75], a[124:127], v[64:67]
    ds_read_b64_tr_b16 a[94:95], v27 offset:512
    v_mfma_f32_16x16x32_bf16 v[72:75], a[76:79], a[124:127], v[72:75]
    buffer_store_dwordx4 v[100:103], v13, s[28:31], s23 offen offset:1024 sc1
    s_cmp_lg_u32 s46, 6
    s_cbranch_scc1 Lxe6
    ds_read_b64 v[108:109], v4
    ds_read_b64 v[110:111], v5
    ds_read_b64 v[112:113], v6
    ds_read_b64 v[114:115], v7
Lxe6:
    s_setprio 1
    s_waitcnt lgkmcnt(6)
    v_mfma_f32_16x16x32_bf16 v[28:31], a[80:83], a[0:3], v[28:31]
    ds_read_b128 a[8:11], v81 offset:0
    ds_read_b128 a[12:15], v83 offset:0
    v_mfma_f32_16x16x32_bf16 v[44:47], a[80:83], a[4:7], v[44:47]
    ds_read_b64_tr_b16 a[104:105], v24 offset:4096
    s_waitcnt lgkmcnt(7)
    v_mfma_f32_16x16x32_bf16 v[32:35], a[84:87], a[0:3], v[32:35]
    ds_read_b64_tr_b16 a[106:107], v24 offset:4608
    ds_read_b64_tr_b16 a[108:109], v25 offset:4096
    v_mfma_f32_16x16x32_bf16 v[48:51], a[84:87], a[4:7], v[48:51]
    ds_read_b64_tr_b16 a[110:111], v25 offset:4608
    s_setprio 0
    s_waitcnt lgkmcnt(8)
    v_mfma_f32_16x16x32_bf16 v[36:39], a[88:91], a[0:3], v[36:39]
    v_mfma_f32_16x16x32_bf16 v[52:55], a[88:91], a[4:7], v[52:55]
    ds_read_b64_tr_b16 a[112:113], v26 offset:4096
    ds_read_b64_tr_b16 a[114:115], v26 offset:4608
    s_waitcnt lgkmcnt(8)
    v_mfma_f32_16x16x32_bf16 v[40:43], a[92:95], a[0:3], v[40:43]
    ds_read_b64_tr_b16 a[116:117], v27 offset:4096
    v_mfma_f32_16x16x32_bf16 v[56:59], a[92:95], a[4:7], v[56:59]
    ds_read_b64_tr_b16 a[118:119], v27 offset:4608
    s_barrier
    s_setprio 3
    s_waitcnt lgkmcnt(6)
    v_mfma_f32_16x16x32_bf16 v[28:31], a[104:107], a[8:11], v[28:31]
    ds_read_b128 a[16:19], v80 offset:39040
    ds_read_b128 a[20:23], v82 offset:39040
    v_mfma_f32_16x16x32_bf16 v[44:47], a[104:107], a[12:15], v[44:47]
    ds_read_b64_tr_b16 a[80:81], v24 offset:39040
    s_waitcnt lgkmcnt(7)
    v_mfma_f32_16x16x32_bf16 v[32:35], a[108:111], a[8:11], v[32:35]
    ds_read_b64_tr_b16 a[82:83], v24 offset:39552
    v_mfma_f32_16x16x32_bf16 v[48:51], a[108:111], a[12:15], v[48:51]
    ds_read_b64_tr_b16 a[84:85], v25 offset:39040
    s_setprio 2
    s_waitcnt lgkmcnt(7)
    v_mfma_f32_16x16x32_bf16 v[36:39], a[112:115], a[8:11], v[36:39]
    ds_read_b64_tr_b16 a[86:87], v25 offset:39552
    ds_read_b64_tr_b16 a[88:89], v26 offset:39040
    v_mfma_f32_16x16x32_bf16 v[52:55], a[112:115], a[12:15], v[52:55]
    ds_read_b64_tr_b16 a[90:91], v26 offset:39552
    s_waitcnt lgkmcnt(8)
    v_mfma_f32_16x16x32_bf16 v[40:43], a[116:119], a[8:11], v[40:43]
    ds_read_b64_tr_b16 a[92:93], v27 offset:39040
    v_mfma_f32_16x16x32_bf16 v[56:59], a[116:119], a[12:15], v[56:59]
    ds_read_b64_tr_b16 a[94:95], v27 offset:39552
    s_cmp_lg_u32 s46, 7
    s_cbranch_scc1 Lxe7
    ds_read_b64 v[108:109], v4
    ds_read_b64 v[110:111], v5
    ds_read_b64 v[112:113], v6
    ds_read_b64 v[114:115], v7
Lxe7:
    s_setprio 1
    s_waitcnt lgkmcnt(6)
    v_mfma_f32_16x16x32_bf16 v[28:31], a[80:83], a[16:19], v[28:31]
    ds_read_b128 a[24:27], v81 offset:39040
    ds_read_b128 a[28:31], v83 offset:39040
    v_mfma_f32_16x16x32_bf16 v[44:47], a[80:83], a[20:23], v[44:47]
    ds_read_b64_tr_b16 a[104:105], v24 offset:43136
    s_waitcnt lgkmcnt(7)
    v_mfma_f32_16x16x32_bf16 v[32:35], a[84:87], a[16:19], v[32:35]
    ds_read_b64_tr_b16 a[106:107], v24 offset:43648
    ds_read_b64_tr_b16 a[108:109], v25 offset:43136
    v_mfma_f32_16x16x32_bf16 v[48:51], a[84:87], a[20:23], v[48:51]
    ds_read_b64_tr_b16 a[110:111], v25 offset:43648
    s_setprio 0
    s_waitcnt lgkmcnt(8)
    v_mfma_f32_16x16x32_bf16 v[36:39], a[88:91], a[16:19], v[36:39]
    v_mfma_f32_16x16x32_bf16 v[52:55], a[88:91], a[20:23], v[52:55]
    ds_read_b64_tr_b16 a[112:113], v26 offset:43136
    ds_read_b64_tr_b16 a[114:115], v26 offset:43648
    s_waitcnt lgkmcnt(8)
    v_mfma_f32_16x16x32_bf16 v[40:43], a[92:95], a[16:19], v[40:43]
    ds_read_b64_tr_b16 a[116:117], v27 offset:43136
    v_mfma_f32_16x16x32_bf16 v[56:59], a[92:95], a[20:23], v[56:59]
    ds_read_b64_tr_b16 a[118:119], v27 offset:43648
    s_barrier
    s_setprio 3
    s_waitcnt lgkmcnt(6)
    v_mfma_f32_16x16x32_bf16 v[28:31], a[104:107], a[24:27], v[28:31]
    ds_read_b128 a[32:35], v76 offset:0
    ds_read_b128 a[36:39], v78 offset:0
    v_mfma_f32_16x16x32_bf16 v[44:47], a[104:107], a[28:31], v[44:47]
    ds_read_b64_tr_b16 a[80:81], v20 offset:0
    s_waitcnt lgkmcnt(7)
    v_mfma_f32_16x16x32_bf16 v[32:35], a[108:111], a[24:27], v[32:35]
    ds_read_b64_tr_b16 a[82:83], v20 offset:512
    v_mfma_f32_16x16x32_bf16 v[48:51], a[108:111], a[28:31], v[48:51]
    ds_read_b64_tr_b16 a[84:85], v21 offset:0
    s_setprio 2
    s_waitcnt lgkmcnt(7)
    v_mfma_f32_16x16x32_bf16 v[36:39], a[112:115], a[24:27], v[36:39]
    ds_read_b64_tr_b16 a[86:87], v21 offset:512
    ds_read_b64_tr_b16 a[88:89], v22 offset:0
    v_mfma_f32_16x16x32_bf16 v[52:55], a[112:115], a[28:31], v[52:55]
    ds_read_b64_tr_b16 a[90:91], v22 offset:512
    s_waitcnt lgkmcnt(8)
    v_mfma_f32_16x16x32_bf16 v[40:43], a[116:119], a[24:27], v[40:43]
    ds_read_b64_tr_b16 a[92:93], v23 offset:0
    v_mfma_f32_16x16x32_bf16 v[56:59], a[116:119], a[28:31], v[56:59]
    ds_read_b64_tr_b16 a[94:95], v23 offset:512
    s_cmp_lg_u32 s46, 8
    s_cbranch_scc1 Lxe8
    ds_read_b64 v[108:109], v4
    ds_read_b64 v[110:111], v5
    ds_read_b64 v[112:113], v6
    ds_read_b64 v[114:115], v7
Lxe8:
    s_setprio 1
    s_waitcnt lgkmcnt(6)
    v_mfma_f32_16x16x32_bf16 v[28:31], a[80:83], a[32:35], v[28:31]
    ds_read_b128 a[40:43], v77 offset:0
    ds_read_b128 a[44:47], v79 offset:0
    v_mfma_f32_16x16x32_bf16 v[44:47], a[80:83], a[36:39], v[44:47]
    ds_read_b64_tr_b16 a[104:105], v20 offset:4096
    s_waitcnt lgkmcnt(7)
    v_mfma_f32_16x16x32_bf16 v[32:35], a[84:87], a[32:35], v[32:35]
    ds_read_b64_tr_b16 a[106:107], v20 offset:4608
    v_mfma_f32_16x16x32_bf16 v[48:51], a[84:87], a[36:39], v[48:51]
    ds_read_b64_tr_b16 a[108:109], v21 offset:4096
    s_setprio 0
    s_waitcnt lgkmcnt(7)
    v_mfma_f32_16x16x32_bf16 v[36:39], a[88:91], a[32:35], v[36:39]
    ds_read_b64_tr_b16 a[110:111], v21 offset:4608
    ds_read_b64_tr_b16 a[112:113], v22 offset:4096
    v_mfma_f32_16x16x32_bf16 v[52:55], a[88:91], a[36:39], v[52:55]
    ds_read_b64_tr_b16 a[114:115], v22 offset:4608
    s_waitcnt lgkmcnt(8)
    v_mfma_f32_16x16x32_bf16 v[40:43], a[92:95], a[32:35], v[40:43]
    ds_read_b64_tr_b16 a[116:117], v23 offset:4096
    v_mfma_f32_16x16x32_bf16 v[56:59], a[92:95], a[36:39], v[56:59]
    ds_read_b64_tr_b16 a[118:119], v23 offset:4608
    s_waitcnt lgkmcnt(0)
    s_barrier
    s_setprio 3
    v_mfma_f32_16x16x32_bf16 v[28:31], a[104:107], a[40:43], v[28:31]
    ds_read_b128 a[48:51], v76 offset:39040
    ds_read_b128 a[52:55], v78 offset:39040
    v_mfma_f32_16x16x32_bf16 v[44:47], a[104:107], a[44:47], v[44:47]
    ds_read_b64_tr_b16 a[80:81], v20 offset:39040
    v_mfma_f32_16x16x32_bf16 v[32:35], a[108:111], a[40:43], v[32:35]
    ds_read_b64_tr_b16 a[82:83], v20 offset:39552
    v_mfma_f32_16x16x32_bf16 v[48:51], a[108:111], a[44:47], v[48:51]
    ds_read_b64_tr_b16 a[84:85], v21 offset:39040
    s_setprio 2
    v_mfma_f32_16x16x32_bf16 v[36:39], a[112:115], a[40:43], v[36:39]
    ds_read_b64_tr_b16 a[86:87], v21 offset:39552
    ds_read_b64_tr_b16 a[88:89], v22 offset:39040
    v_mfma_f32_16x16x32_bf16 v[52:55], a[112:115], a[44:47], v[52:55]
    ds_read_b64_tr_b16 a[90:91], v22 offset:39552
    v_mfma_f32_16x16x32_bf16 v[40:43], a[116:119], a[40:43], v[40:43]
    ds_read_b64_tr_b16 a[92:93], v23 offset:39040
    v_mfma_f32_16x16x32_bf16 v[56:59], a[116:119], a[44:47], v[56:59]
    ds_read_b64_tr_b16 a[94:95], v23 offset:39552
    v_mov_b32 v98, s38
    s_waitcnt vmcnt(0)
    s_mov_b64 exec, 1
    buffer_store_dword v98, v97, s[28:31], s24 offen sc1
    s_mov_b64 exec, -1
    s_cmp_lg_u32 s46, 9
    s_cbranch_scc1 Lxe9
    ds_read_b64 v[108:109], v4
    ds_read_b64 v[110:111], v5
    ds_read_b64 v[112:113], v6
    ds_read_b64 v[114:115], v7
Lxe9:
    s_setprio 1
    s_waitcnt lgkmcnt(6)
    v_mfma_f32_16x16x32_bf16 v[28:31], a[80:83], a[48:51], v[28:31]
    ds_read_b128 a[56:59], v77 offset:39040
    ds_read_b128 a[60:63], v79 offset:39040
    ds_read_b64_tr_b16 a[104:105], v20 offset:43136
    v_mfma_f32_16x16x32_bf16 v[44:47], a[80:83], a[52:55], v[44:47]
    ds_read_b64_tr_b16 a[106:107], v20 offset:43648
    ds_read_b64_tr_b16 a[108:109], v21 offset:43136
    s_waitcnt lgkmcnt(9)
    v_mfma_f32_16x16x32_bf16 v[32:35], a[84:87], a[48:51], v[32:35]
    ds_read_b64_tr_b16 a[110:111], v21 offset:43648
    ds_read_b64_tr_b16 a[112:113], v22 offset:43136
    ds_read_b64_tr_b16 a[114:115], v22 offset:43648
    v_mfma_f32_16x16x32_bf16 v[48:51], a[84:87], a[52:55], v[48:51]
    ds_read_b64_tr_b16 a[116:117], v23 offset:43136
    ds_read_b64_tr_b16 a[118:119], v23 offset:43648
    s_setprio 0
    s_waitcnt lgkmcnt(12)
    v_mfma_f32_16x16x32_bf16 v[36:39], a[88:91], a[48:51], v[36:39]
    ds_read_b32 v120, v94
    ds_read_b32 v121, v94 offset:512
    v_xor_b32 v94, 64, v94
    v_mfma_f32_16x16x32_bf16 v[52:55], a[88:91], a[52:55], v[52:55]
    ds_read_b32 v122, v94
    ds_read_b32 v123, v92 offset:512
    s_waitcnt lgkmcnt(14)
    v_mfma_f32_16x16x32_bf16 v[40:43], a[92:95], a[48:51], v[40:43]
    ds_read_b32 v126, v93 offset:520
    v_mov_b32 v24, v84
    v_mov_b32 v25, v85
    v_mfma_f32_16x16x32_bf16 v[56:59], a[92:95], a[52:55], v[56:59]
    v_mov_b32 v26, v86
    v_mov_b32 v27, v87
    s_waitcnt lgkmcnt(5)
    v_mfma_f32_16x16x32_bf16 v[44:47], a[104:107], a[60:63], v[44:47]
    v_mfma_f32_16x16x32_bf16 v[48:51], a[108:111], a[60:63], v[48:51]
    v_mfma_f32_16x16x32_bf16 v[52:55], a[112:115], a[60:63], v[52:55]
    v_mfma_f32_16x16x32_bf16 v[56:59], a[116:119], a[60:63], v[56:59]
    v_mfma_f32_16x16x32_bf16 v[28:31], a[104:107], a[56:59], v[28:31]
    v_mfma_f32_16x16x32_bf16 v[32:35], a[108:111], a[56:59], v[32:35]
    ds_read_b32 v7, v96
    ds_read_b128 v[76:79], v95 offset:0
    ds_read_b128 v[80:83], v95 offset:64
    ds_read_b128 v[84:87], v95 offset:128
    ds_read_b128 v[88:91], v95 offset:192
    v_mfma_f32_16x16x32_bf16 v[36:39], a[112:115], a[56:59], v[36:39]
    v_mfma_f32_16x16x32_bf16 v[40:43], a[116:119], a[56:59], v[40:43]
    s_waitcnt lgkmcnt(0)
Lqf:
    v_readfirstlane_b32 s42, v7
    s_nop 0
    s_cmp_eq_u32 s42, 0
    s_cbranch_scc1 Lqf_re
    s_cmp_eq_u32 s27, 0
    v_fmac_f32 v44, v76, v122
    v_fmac_f32 v45, v77, v122
    v_fmac_f32 v46, v78, v122
    v_fmac_f32 v47, v79, v122
    v_cvt_pk_bf16_f32 v44, v44, v45
    v_cvt_pk_bf16_f32 v45, v46, v47
    v_fmac_f32 v48, v80, v122
    v_fmac_f32 v49, v81, v122
    v_fmac_f32 v50, v82, v122
    v_fmac_f32 v51, v83, v122
    v_cvt_pk_bf16_f32 v46, v48, v49
    v_cvt_pk_bf16_f32 v47, v50, v51
    v_fmac_f32 v52, v84, v122
    v_fmac_f32 v53, v85, v122
    v_fmac_f32 v54, v86, v122
    v_fmac_f32 v55, v87, v122
    v_cvt_pk_bf16_f32 v48, v52, v53
    v_cvt_pk_bf16_f32 v49, v54, v55
    v_fmac_f32 v56, v88, v122
    v_fmac_f32 v57, v89, v122
    v_fmac_f32 v58, v90, v122
    v_fmac_f32 v59, v91, v122
    v_cvt_pk_bf16_f32 v50, v56, v57
    v_cvt_pk_bf16_f32 v51, v58, v59
    s_cbranch_scc0 Lh1
    ds_write_b128 v125, v[44:47] offset:0
    ds_write_b128 v125, v[48:51] offset:1024
    v_mov_b32 v5, 157972
    v_mov_b32 v6, 1
    s_mov_b64 exec, 1
    ds_add_u32 v5, v6
    s_mov_b64 exec, -1
    v_fmac_f32 v28, v76, v120
    v_fmac_f32 v29, v77, v120
    v_fmac_f32 v30, v78, v120
    v_fmac_f32 v31, v79, v120
    v_cvt_pk_bf16_f32 v28, v28, v29
    v_cvt_pk_bf16_f32 v29, v30, v31
    v_fmac_f32 v32, v80, v120
    v_fmac_f32 v33, v81, v120
    v_fmac_f32 v34, v82, v120
    v_fmac_f32 v35, v83, v120
    v_cvt_pk_bf16_f32 v30, v32, v33
    v_cvt_pk_bf16_f32 v31, v34, v35
    v_fmac_f32 v36, v84, v120
    v_fmac_f32 v37, v85, v120
    v_fmac_f32 v38, v86, v120
    v_fmac_f32 v39, v87, v120
    v_cvt_pk_bf16_f32 v32, v36, v37
    v_cvt_pk_bf16_f32 v33, v38, v39
    v_fmac_f32 v40, v88, v120
    v_fmac_f32 v41, v89, v120
    v_fmac_f32 v42, v90, v120
    v_fmac_f32 v43, v91, v120
    v_cvt_pk_bf16_f32 v34, v40, v41
    v_cvt_pk_bf16_f32 v35, v42, v43
    v_subrev_u32 v4, 6144, v125
    v_mov_b32 v8, s22
    v_mov_b32 v9, s22
    v_mov_b32 v10, s22
    v_mov_b32 v11, s22
Lcw_1:
    s_sub_u32 s39, s39, 1
    s_cbranch_scc1 Lend
    ds_read_b32 v6, v5
    s_waitcnt lgkmcnt(0)
    v_readfirstlane_b32 s42, v6
    s_nop 0
    s_cmp_lt_u32 s42, 8
    s_cbranch_scc1 Lcw_1
    ds_read_b128 v[52:55], v125 offset:2048
    ds_read_b128 v[56:59], v125 offset:3072
    ds_read_b128 v[44:47], v4 offset:4096
    ds_read_b128 v[48:51], v4 offset:5120
    s_branch Lh_join
Lh1:
    ds_write_b128 v125, v[44:47] offset:2048
    ds_write_b128 v125, v[48:51] offset:3072
    v_fmac_f32 v28, v76, v120
    v_fmac_f32 v29, v77, v120
    v_fmac_f32 v30, v78, v120
    v_fmac_f32 v31, v79, v120
    v_cvt_pk_bf16_f32 v52, v28, v29
    v_cvt_pk_bf16_f32 v53, v30, v31
    v_fmac_f32 v32, v80, v120
    v_fmac_f32 v33, v81, v120
    v_fmac_f32 v34, v82, v120
    v_fmac_f32 v35, v83, v120
    v_cvt_pk_bf16_f32 v54, v32, v33
    v_cvt_pk_bf16_f32 v55, v34, v35
    v_fmac_f32 v36, v84, v120
    v_fmac_f32 v37, v85, v120
    v_fmac_f32 v38, v86, v120
    v_fmac_f32 v39, v87, v120
    v_cvt_pk_bf16_f32 v56, v36, v37
    v_cvt_pk_bf16_f32 v57, v38, v39
    v_fmac_f32 v40, v88, v120
    v_fmac_f32 v41, v89, v120
    v_fmac_f32 v42, v90, v120
    v_fmac_f32 v43, v91, v120
    v_cvt_pk_bf16_f32 v58, v40, v41
    v_cvt_pk_bf16_f32 v59, v42, v43
    ds_write_b128 v125, v[52:55] offset:4096
    ds_write_b128 v125, v[56:59] offset:5120
    v_mov_b32 v5, 157972
    v_mov_b32 v6, 1
    s_mov_b64 exec, 1
    ds_add_u32 v5, v6
    s_mov_b64 exec, -1
    v_mov_b32 v8, s22
    v_mov_b32 v9, s22
    v_mov_b32 v10, s22
    v_mov_b32 v11, s22
Lcw_2:
    s_sub_u32 s39, s39, 1
    s_cbranch_scc1 Lend
    ds_read_b32 v6, v5
    s_waitcnt lgkmcnt(0)
    v_readfirstlane_b32 s42, v6
    s_nop 0
    s_cmp_lt_u32 s42, 8
    s_cbranch_scc1 Lcw_2
    ds_read_b128 v[28:31], v125 offset:0
    ds_read_b128 v[32:35], v125 offset:1024
Lh_join:
    buffer_load_dword v20, v12, s[28:31], s24 offen sc1
    ds_read_b64_tr_b16 a[64:65], v26 offset:0
    ds_read_b64_tr_b16 a[66:67], v26 offset:512
    ds_read_b64_tr_b16 a[68:69], v27 offset:0
    ds_read_b64_tr_b16 a[70:71], v27 offset:512
    ds_read_b64_tr_b16 a[72:73], v26 offset:4096
    ds_read_b64_tr_b16 a[74:75], v26 offset:4608
    ds_read_b64_tr_b16 a[76:77], v27 offset:4096
    ds_read_b64_tr_b16 a[78:79], v27 offset:4608
    s_waitcnt lgkmcnt(8)
    s_setprio 2
    v_cndmask_b32 v92, 0, v30, s[6:7]
    v_cndmask_b32 v93, 0, v31, s[6:7]
    v_cndmask_b32 v94, 0, v32, s[12:13]
    v_cndmask_b32 v95, 0, v33, s[12:13]
    v_cndmask_b32 v104, 0, v30, s[8:9]
    v_cndmask_b32 v105, 0, v31, s[8:9]
    v_mfma_f32_16x16x32_bf16 v[76:79], v[46:49], v[92:95], v[8:11]
    v_mfma_f32_16x16x32_bf16 v[80:83], v[54:57], v[92:95], 0
    v_cndmask_b32 v106, 0, v32, s[14:15]
    v_cndmask_b32 v107, 0, v33, s[14:15]
    v_mov_b32 v96, v28
    v_mov_b32 v97, v29
    v_mfma_f32_16x16x32_bf16 v[84:87], v[46:49], v[104:107], v[8:11]
    v_mfma_f32_16x16x32_bf16 v[88:91], v[54:57], v[104:107], 0
    v_cndmask_b32 v98, 0, v30, s[10:11]
    v_cndmask_b32 v99, 0, v31, s[10:11]
    v_cndmask_b32 v100, 0, v32, s[16:17]
    v_cndmask_b32 v101, 0, v33, s[16:17]
    v_mfma_f32_16x16x32_bf16 v[36:39], v[44:47], v[96:99], v[8:11]
    v_mfma_f32_16x16x32_bf16 v[40:43], v[52:55], v[96:99], 0
    v_cndmask_b32 v76, v76, v77, s[4:5]
    v_cndmask_b32 v80, v80, v81, s[4:5]
    v_cndmask_b32 v78, v78, v79, s[4:5]
    v_cndmask_b32 v82, v82, v83, s[4:5]
    v_cndmask_b32 v92, v76, v80, s[18:19]
    v_cndmask_b32 v94, v78, v82, s[20:21]
    v_min_u32 v4, -2, v92
    v_min_u32 v5, -2, v94
    v_cndmask_b32 v84, v84, v85, s[4:5]
    v_cndmask_b32 v88, v88, v89, s[4:5]
    v_cndmask_b32 v86, v86, v87, s[4:5]
    v_cndmask_b32 v90, v90, v91, s[4:5]
    v_cndmask_b32 v104, v84, v88, s[18:19]
    v_cndmask_b32 v106, v86, v90, s[20:21]
    v_min_u32 v6, -2, v104
    v_min_u32 v7, -2, v106
    buffer_store_dwordx4 v[4:7], v13, s[28:31], s60 offen sc1
    s_setprio 0
    ds_read_b64_tr_b16 a[80:81], v26 offset:39040
    ds_read_b64_tr_b16 a[82:83], v26 offset:39552
    ds_read_b64_tr_b16 a[84:85], v27 offset:39040
    ds_read_b64_tr_b16 a[86:87], v27 offset:39552
    ds_read_b64_tr_b16 a[88:89], v26 offset:43136
    ds_read_b64_tr_b16 a[90:91], v26 offset:43648
    ds_read_b64_tr_b16 a[92:93], v27 offset:43136
    ds_read_b64_tr_b16 a[94:95], v27 offset:43648
    ds_read_b64_tr_b16 a[96:97], v24 offset:0
    ds_read_b64_tr_b16 a[98:99], v24 offset:512
    ds_read_b64_tr_b16 a[100:101], v25 offset:0
    ds_read_b64_tr_b16 a[102:103], v25 offset:512
    ds_read_b64_tr_b16 a[104:105], v24 offset:4096
    ds_read_b64_tr_b16 a[106:107], v24 offset:4608
    ds_read_b64_tr_b16 a[108:109], v25 offset:4096
    ds_read_b64_tr_b16 a[110:111], v25 offset:4608
    ds_read_b64_tr_b16 a[112:113], v24 offset:39040
    ds_read_b64_tr_b16 a[114:115], v24 offset:39552
    ds_read_b64_tr_b16 a[116:117], v25 offset:39040
    ds_read_b64_tr_b16 a[118:119], v25 offset:39552
    ds_read_b64_tr_b16 a[120:121], v24 offset:43136
    ds_read_b64_tr_b16 a[122:123], v24 offset:43648
    ds_read_b64_tr_b16 a[124:125], v25 offset:43136
    ds_read_b64_tr_b16 a[126:127], v25 offset:43648
    s_waitcnt lgkmcnt(15)
    v_mfma_f32_16x16x32_bf16 v[60:63], a[0:3], a[64:67], v[60:63]
    v_mov_b32 v102, v34
    v_mov_b32 v103, v35
    v_mul_f32 v4, s25, v121
    v_mfma_f32_16x16x32_bf16 v[68:71], a[4:7], a[64:67], v[68:71]
    v_mfma_f32_16x16x32_bf16 v[76:79], v[48:51], v[100:103], v[8:11]
    v_mfma_f32_16x16x32_bf16 v[80:83], v[56:59], v[100:103], 0
    v_mfma_f32_16x16x32_bf16 v[64:67], a[0:3], a[68:71], v[64:67]
    v_mul_f32 v123, v123, v4
    v_mul_f32 v126, v126, v4
    v_cndmask_b32 v36, v36, v37, s[4:5]
    v_mfma_f32_16x16x32_bf16 v[72:75], a[4:7], a[68:71], v[72:75]
    v_cndmask_b32 v40, v40, v41, s[4:5]
    v_cndmask_b32 v38, v38, v39, s[4:5]
    v_mfma_f32_16x16x32_bf16 v[60:63], a[8:11], a[72:75], v[60:63]
    v_cndmask_b32 v42, v42, v43, s[4:5]
    v_cndmask_b32 v96, v36, v40, s[18:19]
    v_cndmask_b32 v98, v38, v42, s[20:21]
    v_mfma_f32_16x16x32_bf16 v[68:71], a[12:15], a[72:75], v[68:71]
    v_cndmask_b32 v76, v76, v77, s[4:5]
    v_cndmask_b32 v80, v80, v81, s[4:5]
    v_mfma_f32_16x16x32_bf16 v[64:67], a[8:11], a[76:79], v[64:67]
    v_cndmask_b32 v78, v78, v79, s[4:5]
    v_cndmask_b32 v82, v82, v83, s[4:5]
    v_cndmask_b32 v100, v76, v80, s[18:19]
    v_mfma_f32_16x16x32_bf16 v[72:75], a[12:15], a[76:79], v[72:75]
    v_cndmask_b32 v102, v78, v82, s[20:21]
    v_mul_f32 v96, v96, v123
    v_mfma_f32_16x16x32_bf16 v[60:63], a[16:19], a[80:83], v[60:63]
    v_mul_f32 v98, v98, v126
    v_mul_f32 v100, v100, v123
    v_mul_f32 v102, v102, v126
    v_mfma_f32_16x16x32_bf16 v[68:71], a[20:23], a[80:83], v[68:71]
    v_max_f32 v4, v96, v98
    v_max_f32 v5, v100, v102
    v_mfma_f32_16x16x32_bf16 v[64:67], a[16:19], a[84:87], v[64:67]
    v_mov_b32 v6, v4
    v_mov_b32 v7, v5
    s_nop 0
    v_permlane32_swap_b32 v4, v6
    v_mfma_f32_16x16x32_bf16 v[72:75], a[20:23], a[84:87], v[72:75]
    v_permlane32_swap_b32 v5, v7
    v_max_f32 v4, v4, v6
    v_mfma_f32_16x16x32_bf16 v[60:63], a[24:27], a[88:91], v[60:63]
    v_max_f32 v5, v5, v7
    v_mov_b32 v6, v4
    v_mov_b32 v7, v5
    v_mfma_f32_16x16x32_bf16 v[68:71], a[28:31], a[88:91], v[68:71]
    v_permlane16_swap_b32 v4, v6
    v_permlane16_swap_b32 v5, v7
    v_mfma_f32_16x16x32_bf16 v[64:67], a[24:27], a[92:95], v[64:67]
    v_max_f32 v4, v4, v6
    v_max_f32 v5, v5, v7
    v_mfma_f32_16x16x32_bf16 v[72:75], a[28:31], a[92:95], v[72:75]
    v_sub_f32 v96, v96, v4
    v_sub_f32 v98, v98, v4
    s_waitcnt lgkmcnt(12)
    v_mfma_f32_16x16x32_bf16 v[60:63], a[32:35], a[96:99], v[60:63]
    v_sub_f32 v100, v100, v5
    v_sub_f32 v102, v102, v5
    v_exp_f32 v96, v96
    v_mfma_f32_16x16x32_bf16 v[68:71], a[36:39], a[96:99], v[68:71]
    v_exp_f32 v98, v98
    v_exp_f32 v100, v100
    v_mfma_f32_16x16x32_bf16 v[64:67], a[32:35], a[100:103], v[64:67]
    v_exp_f32 v102, v102
    v_cvt_pk_bf16_f32 v96, v96, v96
    v_mfma_f32_16x16x32_bf16 v[72:75], a[36:39], a[100:103], v[72:75]
    v_cvt_pk_bf16_f32 v97, v98, v98
    v_cvt_pk_bf16_f32 v100, v100, v100
    s_waitcnt lgkmcnt(8)
    v_mfma_f32_16x16x32_bf16 v[60:63], a[40:43], a[104:107], v[60:63]
    v_cvt_pk_bf16_f32 v101, v102, v102
    v_and_b32 v98, v96, v118
    v_and_b32 v99, v97, v119
    v_mfma_f32_16x16x32_bf16 v[68:71], a[44:47], a[104:107], v[68:71]
    v_and_b32 v96, v96, v116
    v_and_b32 v97, v97, v117
    v_mfma_f32_16x16x32_bf16 v[64:67], a[40:43], a[108:111], v[64:67]
    v_and_b32 v102, v100, v118
    v_and_b32 v103, v101, v119
    v_mfma_f32_16x16x32_bf16 v[72:75], a[44:47], a[108:111], v[72:75]
    v_and_b32 v100, v100, v116
    v_and_b32 v101, v101, v117
    s_waitcnt lgkmcnt(4)
    v_mfma_f32_16x16x32_bf16 v[60:63], a[48:51], a[112:115], v[60:63]
    s_lshl_b32 s40, s47, 6
    s_add_u32 s40, s40, 156160
    v_lshl_add_u32 v48, v2, 4, s40
    v_xor_b32 v49, 64, v48
    ds_read_b128 v[28:31], v48 offset:0
    v_mfma_f32_16x16x32_bf16 v[68:71], a[52:55], a[112:115], v[68:71]
    ds_read_b128 v[32:35], v48 offset:512
    ds_read_b128 v[36:39], v49 offset:0
    ds_read_b128 v[40:43], v49 offset:512
    s_lshl_b32 s40, s27, 3
    s_add_u32 s40, s40, 157696
    v_mfma_f32_16x16x32_bf16 v[64:67], a[48:51], a[116:119], v[64:67]
    v_lshl_add_u32 v48, v3, 4, s40
    v_mov_b32 v49, 157952
    v_lshl_add_u32 v125, v1, 3, s52
    s_lshl_b32 s40, s27, 10
    v_add_u32 v50, s40, v125
    v_mfma_f32_16x16x32_bf16 v[72:75], a[52:55], a[116:119], v[72:75]
    s_lshl_b32 s41, s27, 12
    s_sub_u32 s41, 2048, s41
    v_add_u32 v51, s41, v50
    v_subrev_u32 v125, 2048, v125
    s_waitcnt vmcnt(1)
Lfl_chk:
    v_cmp_eq_u32 vcc, s38, v20
    s_nop 0
    s_and_b32 s40, vcc_lo, 0x3ff
    s_cmp_lg_u32 s40, 0x3ff
    s_cbranch_scc1 Lfl_re
    buffer_load_dwordx2 v[52:53], v13, s[28:31], s61 offen offset:8 sc1
    buffer_load_dwordx2 v[54:55], v13, s[28:31], s62 offen offset:0 sc1
    s_waitcnt lgkmcnt(4)
    v_mfma_f32_16x16x32_bf16 v[60:63], a[56:59], a[120:123], v[60:63]
    v_mfma_f32_16x16x32_bf16 v[68:71], a[60:63], a[120:123], v[68:71]
    v_mfma_f32_16x16x32_bf16 v[64:67], a[56:59], a[124:127], v[64:67]
    v_mfma_f32_16x16x32_bf16 v[72:75], a[60:63], a[124:127], v[72:75]
    ds_read_b32 v46, v49
    ds_read_b64 v[44:45], v48
    s_waitcnt lgkmcnt(0)
Lcsv:
    v_readfirstlane_b32 s42, v46
    s_nop 0
    s_cmp_eq_u32 s42, 0
    s_cbranch_scc1 Lcsv_re
    v_fmac_f32 v60, v28, v44
    v_fmac_f32 v61, v29, v44
    v_fmac_f32 v62, v30, v44
    v_fmac_f32 v63, v31, v44
    v_mul_f32 v60, v60, v32
    v_mul_f32 v61, v61, v33
    v_mul_f32 v62, v62, v34
    v_mul_f32 v63, v63, v35
    v_cvt_pk_bf16_f32 v60, v60, v61
    v_cvt_pk_bf16_f32 v61, v62, v63
    ds_write_b64 v50, v[60:61] offset:0
    v_fmac_f32 v64, v28, v45
    v_fmac_f32 v65, v29, v45
    v_fmac_f32 v66, v30, v45
    v_fmac_f32 v67, v31, v45
    v_mul_f32 v64, v64, v32
    v_mul_f32 v65, v65, v33
    v_mul_f32 v66, v66, v34
    v_mul_f32 v67, v67, v35
    v_cvt_pk_bf16_f32 v64, v64, v65
    v_cvt_pk_bf16_f32 v65, v66, v67
    ds_write_b64 v50, v[64:65] offset:512
    v_fmac_f32 v68, v36, v44
    v_fmac_f32 v69, v37, v44
    v_fmac_f32 v70, v38, v44
    v_fmac_f32 v71, v39, v44
    v_mul_f32 v68, v68, v40
    v_mul_f32 v69, v69, v41
    v_mul_f32 v70, v70, v42
    v_mul_f32 v71, v71, v43
    v_cvt_pk_bf16_f32 v68, v68, v69
    v_cvt_pk_bf16_f32 v69, v70, v71
    ds_write_b64 v51, v[68:69] offset:0
    v_fmac_f32 v72, v36, v45
    v_fmac_f32 v73, v37, v45
    v_fmac_f32 v74, v38, v45
    v_fmac_f32 v75, v39, v45
    v_mul_f32 v72, v72, v40
    v_mul_f32 v73, v73, v41
    v_mul_f32 v74, v74, v42
    v_mul_f32 v75, v75, v43
    v_cvt_pk_bf16_f32 v72, v72, v73
    v_cvt_pk_bf16_f32 v73, v74, v75
    ds_write_b64 v51, v[72:73] offset:512
    v_mov_b32 v8, 157976
    v_mov_b32 v9, 1
    s_mov_b64 exec, 1
    ds_add_u32 v8, v9
    s_mov_b64 exec, -1
    v_mov_b32 v10, 157980
    v_and_b32 v6, 3, v1
    v_lshl_add_u32 v6, v6, 3, v19
    v_add_u32 v20, v6, v18
    v_xor_b32 v21, 32, v20
    v_xor_b32 v22, 64, v20
    v_xor_b32 v23, 96, v20
    v_add_u32 v24, 63616, v20
    v_add_u32 v25, 63616, v21
    v_add_u32 v26, 63616, v22
    v_add_u32 v27, 63616, v23
Lcw_3:
    s_sub_u32 s39, s39, 1
    s_cbranch_scc1 Lend
    ds_read_b32 v11, v10
    s_waitcnt lgkmcnt(0)
    v_readfirstlane_b32 s42, v11
    s_nop 0
    s_cmp_lt_u32 s42, 2
    s_cbranch_scc1 Lcw_3
    ds_read_b64_tr_b16 a[0:1], v20 offset:0
    ds_read_b64_tr_b16 a[2:3], v20 offset:512
    ds_read_b64_tr_b16 a[4:5], v21 offset:0
    ds_read_b64_tr_b16 a[6:7], v21 offset:512
    ds_read_b64_tr_b16 a[8:9], v22 offset:0
    ds_read_b64_tr_b16 a[10:11], v22 offset:512
    ds_read_b64_tr_b16 a[12:13], v23 offset:0
    ds_read_b64_tr_b16 a[14:15], v23 offset:512
    ds_read_b64_tr_b16 a[16:17], v20 offset:4096
    ds_read_b64_tr_b16 a[18:19], v20 offset:4608
    ds_read_b64_tr_b16 a[20:21], v21 offset:4096
    ds_read_b64_tr_b16 a[22:23], v21 offset:4608
    ds_read_b64_tr_b16 a[24:25], v22 offset:4096
    ds_read_b64_tr_b16 a[26:27], v22 offset:4608
    ds_read_b64_tr_b16 a[28:29], v23 offset:4096
    ds_read_b64_tr_b16 a[30:31], v23 offset:4608
    ds_read_b64_tr_b16 a[32:33], v20 offset:8192
    ds_read_b64_tr_b16 a[34:35], v20 offset:8704
    ds_read_b64_tr_b16 a[36:37], v21 offset:8192
    ds_read_b64_tr_b16 a[38:39], v21 offset:8704
    ds_read_b64_tr_b16 a[40:41], v22 offset:8192
    ds_read_b64_tr_b16 a[42:43], v22 offset:8704
    ds_read_b64_tr_b16 a[44:45], v23 offset:8192
    ds_read_b64_tr_b16 a[46:47], v23 offset:8704
    s_waitcnt vmcnt(0)
Lrx_chk:
    v_and_b32 v52, s63, v52
    v_and_b32 v53, s63, v53
    v_and_b32 v54, s64, v54
    v_and_b32 v55, s64, v55
    v_max3_u32 v4, v52, v53, v54
    v_max_u32 v4, v4, v55
    v_cmp_eq_u32 vcc, -1, v4
    s_nop 0
    s_cbranch_vccnz Lrx_re
    v_add_f32 v92, v92, v52
    v_add_f32 v94, v94, v53
    v_add_f32 v104, v104, v54
    v_add_f32 v106, v106, v55
    s_setprio 2
Lcw_4:
    s_sub_u32 s39, s39, 1
    s_cbranch_scc1 Lend
    ds_read_b32 v9, v8
    s_waitcnt lgkmcnt(0)
    v_readfirstlane_b32 s42, v9
    s_nop 0
    s_cmp_lt_u32 s42, 7
    s_cbranch_scc1 Lcw_4
    ds_read2st64_b64 v[60:63], v125 offset0:0 offset1:4
    ds_read2st64_b64 v[64:67], v125 offset0:1 offset1:5
    ds_read2st64_b64 v[68:71], v125 offset0:2 offset1:6
    ds_read2st64_b64 v[72:75], v125 offset0:3 offset1:7
    v_mul_f32 v92, v92, v123
    v_mul_f32 v94, v94, v126
    v_mul_f32 v104, v104, v123
    v_mul_f32 v106, v106, v126
    v_max_f32 v4, v92, v94
    v_max_f32 v5, v104, v106
    v_mov_b32 v6, v4
    v_mov_b32 v7, v5
    s_nop 0
    v_permlane32_swap_b32 v4, v6
    v_permlane32_swap_b32 v5, v7
    v_max_f32 v4, v4, v6
    v_max_f32 v5, v5, v7
    s_waitcnt lgkmcnt(0)
    v_mov_b32 v6, v4
    v_mfma_f32_16x16x32_bf16 v[80:83], v[14:17], v[96:99], 0
    v_mov_b32 v7, v5
    v_permlane16_swap_b32 v4, v6
    s_nop 0
    v_permlane16_swap_b32 v5, v7
    v_max_f32 v4, v4, v6
    v_mfma_f32_16x16x32_bf16 v[84:87], v[14:17], v[100:103], 0
    v_max_f32 v5, v5, v7
    v_sub_f32 v92, v92, v4
    v_sub_f32 v94, v94, v4
    v_sub_f32 v104, v104, v5
    v_mfma_f32_16x16x32_bf16 v[28:31], v[60:63], v[96:99], 0
    v_sub_f32 v106, v106, v5
    v_exp_f32 v92, v92
    v_exp_f32 v94, v94
    v_exp_f32 v104, v104
    v_exp_f32 v106, v106
    v_mfma_f32_16x16x32_bf16 v[32:35], v[64:67], v[96:99], 0
    v_cvt_pk_bf16_f32 v92, v92, v92
    v_cvt_pk_bf16_f32 v93, v94, v94
    v_cvt_pk_bf16_f32 v104, v104, v104
    v_cvt_pk_bf16_f32 v105, v106, v106
    v_mfma_f32_16x16x32_bf16 v[36:39], v[68:71], v[100:103], 0
    v_and_b32 v94, v92, v118
    v_and_b32 v95, v93, v119
    v_and_b32 v92, v92, v116
    v_and_b32 v93, v93, v117
    v_mfma_f32_16x16x32_bf16 v[40:43], v[72:75], v[100:103], 0
    v_and_b32 v106, v104, v118
    v_and_b32 v107, v105, v119
    v_and_b32 v104, v104, v116
    v_and_b32 v105, v105, v117
    v_mfma_f32_16x16x32_bf16 v[76:79], v[14:17], v[92:95], 0
    v_rcp_f32 v80, v80
    v_rcp_f32 v84, v84
    v_mfma_f32_16x16x32_bf16 v[88:91], v[14:17], v[104:107], 0
    v_mul_f32 v28, v28, v80
    v_mul_f32 v29, v29, v80
    v_mfma_f32_16x16x32_bf16 v[44:47], v[64:67], v[92:95], 0
    v_mul_f32 v30, v30, v80
    v_mfma_f32_16x16x32_bf16 v[48:51], v[68:71], v[92:95], 0
    v_mul_f32 v31, v31, v80
    v_cvt_pk_bf16_f32 v4, v28, v29
    v_mfma_f32_16x16x32_bf16 v[52:55], v[64:67], v[104:107], 0
    v_cvt_pk_bf16_f32 v5, v30, v31
    v_min_u32 v4, -2, v4
    v_mfma_f32_16x16x32_bf16 v[56:59], v[68:71], v[104:107], 0
    v_min_u32 v5, -2, v5
    v_mul_f32 v40, v40, v84
    v_mul_f32 v41, v41, v84
    v_mul_f32 v42, v42, v84
    v_mul_f32 v43, v43, v84
    v_cvt_pk_bf16_f32 v10, v40, v41
    v_cvt_pk_bf16_f32 v11, v42, v43
    v_min_u32 v10, -2, v10
    v_min_u32 v11, -2, v11
    v_rcp_f32 v76, v76
    v_rcp_f32 v88, v88
    v_cndmask_b32 v82, v80, v76, s[6:7]
    v_cndmask_b32 v82, v82, v88, s[8:9]
    v_cndmask_b32 v32, v32, v44, s[6:7]
    v_cndmask_b32 v33, v33, v45, s[6:7]
    v_cndmask_b32 v34, v34, v46, s[6:7]
    v_cndmask_b32 v35, v35, v47, s[6:7]
    v_cndmask_b32 v32, v32, v52, s[8:9]
    v_cndmask_b32 v33, v33, v53, s[8:9]
    v_cndmask_b32 v34, v34, v54, s[8:9]
    v_cndmask_b32 v35, v35, v55, s[8:9]
    v_mul_f32 v32, v32, v82
    v_mul_f32 v33, v33, v82
    v_mul_f32 v34, v34, v82
    v_mul_f32 v35, v35, v82
    v_cvt_pk_bf16_f32 v6, v32, v33
    v_cvt_pk_bf16_f32 v7, v34, v35
    v_min_u32 v6, -2, v6
    v_min_u32 v7, -2, v7
    buffer_store_dwordx4 v[4:7], v13, s[28:31], s23 offen offset:0 sc1
    v_cndmask_b32 v86, v84, v76, s[12:13]
    v_cndmask_b32 v86, v86, v88, s[14:15]
    v_cndmask_b32 v36, v36, v48, s[12:13]
    v_cndmask_b32 v37, v37, v49, s[12:13]
    v_cndmask_b32 v38, v38, v50, s[12:13]
    v_cndmask_b32 v39, v39, v51, s[12:13]
    v_cndmask_b32 v36, v36, v56, s[14:15]
    v_cndmask_b32 v37, v37, v57, s[14:15]
    v_cndmask_b32 v38, v38, v58, s[14:15]
    v_cndmask_b32 v39, v39, v59, s[14:15]
    v_mul_f32 v36, v36, v86
    v_mul_f32 v37, v37, v86
    v_mul_f32 v38, v38, v86
    v_mul_f32 v39, v39, v86
    v_cvt_pk_bf16_f32 v8, v36, v37
    v_cvt_pk_bf16_f32 v9, v38, v39
    v_min_u32 v8, -2, v8
    v_min_u32 v9, -2, v9
    buffer_store_dwordx4 v[8:11], v13, s[28:31], s23 offen offset:1024 sc1
    s_setprio 1
    s_mul_i32 s40, s36, 96
    s_lshl_b32 s41, s47, 4
    s_add_u32 s40, s40, s41
    s_sub_u32 s40, s40, 32
    v_add_u32 v126, s40, v3
    v_lshrrev_b32 v6, 3, v1
    v_add_u32 v6, s40, v6
    v_mul_u32_u24 v6, 1280, v6
    v_and_b32 v7, 7, v1
    v_xor_b32 v7, v7, v2
    v_lshl_add_u32 v122, v7, 4, v6
    v_xor_b32 v123, 64, v122
    v_add_u32 v123, 10240, v123
    s_lshl_b32 s40, s47, 11
    s_add_u32 s40, s40, 102656
    v_add_u32 v124, s40, v124
    v_add_u32 v125, s40, v13
    s_lshl_b32 s24, s37, 7
    v_mov_b32 v10, 157960
    s_mov_b32 s45, 0
    s_mov_b32 s65, 3
    v_lshlrev_b32 v28, 16, v108
    ds_read_b64_tr_b16 a[48:49], v20 offset:12288
    ds_read_b64_tr_b16 a[50:51], v20 offset:12800
    ds_read_b64_tr_b16 a[52:53], v21 offset:12288
    ds_read_b64_tr_b16 a[54:55], v21 offset:12800
    ds_read_b64_tr_b16 a[56:57], v22 offset:12288
    ds_read_b64_tr_b16 a[58:59], v22 offset:12800
    ds_read_b64_tr_b16 a[60:61], v23 offset:12288
    ds_read_b64_tr_b16 a[62:63], v23 offset:12800
    v_and_b32 v29, 0xffff0000, v108
    v_lshlrev_b32 v30, 16, v109
    v_and_b32 v31, 0xffff0000, v109
    v_lshlrev_b32 v32, 16, v110
    v_and_b32 v33, 0xffff0000, v110
    v_lshlrev_b32 v34, 16, v111
    v_and_b32 v35, 0xffff0000, v111
    v_lshlrev_b32 v36, 16, v112
    v_and_b32 v37, 0xffff0000, v112
    v_lshlrev_b32 v38, 16, v113
    v_and_b32 v39, 0xffff0000, v113
    v_lshlrev_b32 v40, 16, v114
    v_and_b32 v41, 0xffff0000, v114
    v_lshlrev_b32 v42, 16, v115
    v_and_b32 v43, 0xffff0000, v115
    v_add_f32 v92, v28, v120
    v_add_f32 v93, v29, v120
    v_add_f32 v94, v30, v120
    v_add_f32 v95, v31, v120
    v_add_f32 v96, v32, v120
    v_add_f32 v97, v33, v120
    v_add_f32 v98, v34, v120
    v_add_f32 v99, v35, v120
    v_add_f32 v100, v36, v120
    v_add_f32 v101, v37, v120
    v_add_f32 v102, v38, v120
    v_add_f32 v103, v39, v120
    v_add_f32 v104, v40, v120
    v_add_f32 v105, v41, v120
    v_add_f32 v106, v42, v120
    v_add_f32 v107, v43, v120
    v_cvt_pk_bf16_f32 v93, v92, v93
    v_cvt_pk_bf16_f32 v95, v94, v95
    v_cvt_pk_bf16_f32 v97, v96, v97
    v_cvt_pk_bf16_f32 v99, v98, v99
    v_cvt_pk_bf16_f32 v101, v100, v101
    v_cvt_pk_bf16_f32 v103, v102, v103
    v_cvt_pk_bf16_f32 v105, v104, v105
    v_cvt_pk_bf16_f32 v107, v106, v107
    v_lshlrev_b32 v92, 16, v93
    ds_read_b64_tr_b16 a[64:65], v20 offset:24576
    ds_read_b64_tr_b16 a[66:67], v20 offset:25088
    ds_read_b64_tr_b16 a[68:69], v21 offset:24576
    ds_read_b64_tr_b16 a[70:71], v21 offset:25088
    ds_read_b64_tr_b16 a[72:73], v22 offset:24576
    ds_read_b64_tr_b16 a[74:75], v22 offset:25088
    ds_read_b64_tr_b16 a[76:77], v23 offset:24576
    ds_read_b64_tr_b16 a[78:79], v23 offset:25088
    v_and_b32 v93, 0xffff0000, v93
    v_lshlrev_b32 v94, 16, v95
    v_and_b32 v95, 0xffff0000, v95
    v_lshlrev_b32 v96, 16, v97
    v_and_b32 v97, 0xffff0000, v97
    v_lshlrev_b32 v98, 16, v99
    v_and_b32 v99, 0xffff0000, v99
    v_lshlrev_b32 v100, 16, v101
    v_and_b32 v101, 0xffff0000, v101
    v_lshlrev_b32 v102, 16, v103
    v_and_b32 v103, 0xffff0000, v103
    v_lshlrev_b32 v104, 16, v105
    v_and_b32 v105, 0xffff0000, v105
    v_lshlrev_b32 v106, 16, v107
    v_and_b32 v107, 0xffff0000, v107
    v_mul_f32 v92, v92, v121
    v_mul_f32 v93, v93, v121
    v_mul_f32 v94, v94, v121
    v_mul_f32 v95, v95, v121
    v_mul_f32 v96, v96, v121
    v_mul_f32 v97, v97, v121
    v_mul_f32 v98, v98, v121
    v_mul_f32 v99, v99, v121
    v_mul_f32 v100, v100, v121
    v_mul_f32 v101, v101, v121
    v_mul_f32 v102, v102, v121
    v_mul_f32 v103, v103, v121
    v_mul_f32 v104, v104, v121
    v_mul_f32 v105, v105, v121
    v_mul_f32 v106, v106, v121
    v_mul_f32 v107, v107, v121
    v_cvt_pk_bf16_f32 v93, v92, v93
    v_cvt_pk_bf16_f32 v95, v94, v95
    v_cvt_pk_bf16_f32 v97, v96, v97
    v_cvt_pk_bf16_f32 v99, v98, v99
    v_cvt_pk_bf16_f32 v101, v100, v101
    v_cvt_pk_bf16_f32 v103, v102, v103
    v_cvt_pk_bf16_f32 v105, v104, v105
    v_cvt_pk_bf16_f32 v107, v106, v107
    v_lshlrev_b32 v92, 16, v93
    ds_read_b64_tr_b16 a[80:81], v20 offset:28672
    ds_read_b64_tr_b16 a[82:83], v20 offset:29184
    ds_read_b64_tr_b16 a[84:85], v21 offset:28672
    ds_read_b64_tr_b16 a[86:87], v21 offset:29184
    ds_read_b64_tr_b16 a[88:89], v22 offset:28672
    ds_read_b64_tr_b16 a[90:91], v22 offset:29184
    ds_read_b64_tr_b16 a[92:93], v23 offset:28672
    ds_read_b64_tr_b16 a[94:95], v23 offset:29184
    v_and_b32 v93, 0xffff0000, v93
    v_lshlrev_b32 v94, 16, v95
    v_and_b32 v95, 0xffff0000, v95
    v_lshlrev_b32 v96, 16, v97
    v_and_b32 v97, 0xffff0000, v97
    v_lshlrev_b32 v98, 16, v99
    v_and_b32 v99, 0xffff0000, v99
    v_lshlrev_b32 v100, 16, v101
    v_and_b32 v101, 0xffff0000, v101
    v_lshlrev_b32 v102, 16, v103
    v_and_b32 v103, 0xffff0000, v103
    v_lshlrev_b32 v104, 16, v105
    v_and_b32 v105, 0xffff0000, v105
    v_lshlrev_b32 v106, 16, v107
    v_and_b32 v107, 0xffff0000, v107
    v_mul_f32 v44, 0xbfb8aa3b, v92
    v_mul_f32 v45, 0xbfb8aa3b, v93
    v_mul_f32 v46, 0xbfb8aa3b, v94
    v_mul_f32 v47, 0xbfb8aa3b, v95
    v_mul_f32 v48, 0xbfb8aa3b, v96
    v_mul_f32 v49, 0xbfb8aa3b, v97
    v_mul_f32 v50, 0xbfb8aa3b, v98
    v_mul_f32 v51, 0xbfb8aa3b, v99
    v_mul_f32 v52, 0xbfb8aa3b, v100
    v_mul_f32 v53, 0xbfb8aa3b, v101
    v_mul_f32 v54, 0xbfb8aa3b, v102
    v_mul_f32 v55, 0xbfb8aa3b, v103
    v_mul_f32 v56, 0xbfb8aa3b, v104
    v_mul_f32 v57, 0xbfb8aa3b, v105
    v_mul_f32 v58, 0xbfb8aa3b, v106
    v_mul_f32 v59, 0xbfb8aa3b, v107
    v_exp_f32 v44, v44
    v_exp_f32 v45, v45
    v_exp_f32 v46, v46
    v_exp_f32 v47, v47
    v_exp_f32 v48, v48
    v_exp_f32 v49, v49
    v_exp_f32 v50, v50
    v_exp_f32 v51, v51
    v_exp_f32 v52, v52
    ds_read_b64_tr_b16 a[96:97], v24 offset:59520
    ds_read_b64_tr_b16 a[98:99], v24 offset:60032
    ds_read_b64_tr_b16 a[100:101], v25 offset:59520
    ds_read_b64_tr_b16 a[102:103], v25 offset:60032
    ds_read_b64_tr_b16 a[104:105], v26 offset:59520
    ds_read_b64_tr_b16 a[106:107], v26 offset:60032
    ds_read_b64_tr_b16 a[108:109], v27 offset:59520
    ds_read_b64_tr_b16 a[110:111], v27 offset:60032
    v_exp_f32 v53, v53
    v_exp_f32 v54, v54
    v_exp_f32 v55, v55
    v_exp_f32 v56, v56
    v_exp_f32 v57, v57
    v_exp_f32 v58, v58
    v_exp_f32 v59, v59
    v_add_f32 v44, 1.0, v44
    v_add_f32 v45, 1.0, v45
    v_add_f32 v46, 1.0, v46
    v_add_f32 v47, 1.0, v47
    v_add_f32 v48, 1.0, v48
    v_add_f32 v49, 1.0, v49
    v_add_f32 v50, 1.0, v50
    v_add_f32 v51, 1.0, v51
    v_add_f32 v52, 1.0, v52
    v_add_f32 v53, 1.0, v53
    v_add_f32 v54, 1.0, v54
    v_add_f32 v55, 1.0, v55
    v_add_f32 v56, 1.0, v56
    v_add_f32 v57, 1.0, v57
    v_add_f32 v58, 1.0, v58
    v_add_f32 v59, 1.0, v59
    v_rcp_f32 v44, v44
    v_rcp_f32 v45, v45
    v_rcp_f32 v46, v46
    v_rcp_f32 v47, v47
    v_rcp_f32 v48, v48
    v_rcp_f32 v49, v49
    v_rcp_f32 v50, v50
    v_rcp_f32 v51, v51
    v_rcp_f32 v52, v52
    v_rcp_f32 v53, v53
    v_rcp_f32 v54, v54
    v_rcp_f32 v55, v55
    v_rcp_f32 v56, v56
    v_rcp_f32 v57, v57
    v_rcp_f32 v58, v58
    v_rcp_f32 v59, v59
    v_mul_f32 v44, v44, v92
    ds_read_b64_tr_b16 a[112:113], v24 offset:63616
    ds_read_b64_tr_b16 a[114:115], v24 offset:64128
    ds_read_b64_tr_b16 a[116:117], v25 offset:63616
    ds_read_b64_tr_b16 a[118:119], v25 offset:64128
    ds_read_b64_tr_b16 a[120:121], v26 offset:63616
    ds_read_b64_tr_b16 a[122:123], v26 offset:64128
    ds_read_b64_tr_b16 a[124:125], v27 offset:63616
    ds_read_b64_tr_b16 a[126:127], v27 offset:64128
    v_mul_f32 v45, v45, v93
    v_mul_f32 v46, v46, v94
    v_mul_f32 v47, v47, v95
    v_mul_f32 v48, v48, v96
    v_mul_f32 v49, v49, v97
    buffer_load_dwordx4 v[60:63], v13, s[28:31], s55 offen offset:0 sc1
    buffer_load_dwordx4 v[64:67], v13, s[28:31], s55 offen offset:1024 sc1
    buffer_load_dwordx4 v[68:71], v13, s[28:31], s55 offen offset:2048 sc1
    buffer_load_dwordx4 v[72:75], v13, s[28:31], s55 offen offset:3072 sc1
    buffer_load_dwordx4 v[76:79], v13, s[28:31], s56 offen offset:0 sc1
    buffer_load_dwordx4 v[80:83], v13, s[28:31], s56 offen offset:1024 sc1
    buffer_load_dwordx4 v[84:87], v13, s[28:31], s56 offen offset:2048 sc1
    buffer_load_dwordx4 v[88:91], v13, s[28:31], s56 offen offset:3072 sc1
    s_setprio 0
    v_mul_f32 v50, v50, v98
    v_mul_f32 v51, v51, v99
    v_mul_f32 v52, v52, v100
    v_mul_f32 v53, v53, v101
    v_mul_f32 v54, v54, v102
    v_mul_f32 v55, v55, v103
    v_mul_f32 v56, v56, v104
    v_mul_f32 v57, v57, v105
    v_mul_f32 v58, v58, v106
    v_mul_f32 v59, v59, v107
    v_cvt_pk_bf16_f32 v45, v44, v45
    v_cvt_pk_bf16_f32 v47, v46, v47
    v_cvt_pk_bf16_f32 v49, v48, v49
    v_cvt_pk_bf16_f32 v51, v50, v51
    v_cvt_pk_bf16_f32 v53, v52, v53
    v_cvt_pk_bf16_f32 v55, v54, v55
    v_cvt_pk_bf16_f32 v57, v56, v57
    v_cvt_pk_bf16_f32 v59, v58, v59
    v_lshlrev_b32 v44, 16, v45
    v_and_b32 v45, 0xffff0000, v45
    v_lshlrev_b32 v46, 16, v47
    v_and_b32 v47, 0xffff0000, v47
    v_lshlrev_b32 v48, 16, v49
    v_and_b32 v49, 0xffff0000, v49
    v_lshlrev_b32 v50, 16, v51
    v_and_b32 v51, 0xffff0000, v51
    v_lshlrev_b32 v52, 16, v53
    v_and_b32 v53, 0xffff0000, v53
    v_lshlrev_b32 v54, 16, v55
    v_and_b32 v55, 0xffff0000, v55
    v_lshlrev_b32 v56, 16, v57
    v_and_b32 v57, 0xffff0000, v57
    v_lshlrev_b32 v58, 16, v59
    v_and_b32 v59, 0xffff0000, v59
Lwo_go:
    s_setprio 3
    buffer_load_dwordx4 v[92:95], v13, s[28:31], s57 offen offset:0 sc1
    buffer_load_dwordx4 v[96:99], v13, s[28:31], s57 offen offset:1024 sc1
    ds_read_b64 v[8:9], v10
    s_waitcnt vmcnt(8)
    v_mfma_f32_16x16x32_bf16 v[108:111], a[0:3], v[60:63], 0
    ds_read_b64_tr_b16 a[0:1], v24 offset:16384
    ds_read_b64_tr_b16 a[2:3], v24 offset:16896
    buffer_load_dwordx4 v[100:103], v13, s[28:31], s57 offen offset:2048 sc1
    v_mfma_f32_16x16x32_bf16 v[112:115], a[4:7], v[60:63], 0
    ds_read_b64_tr_b16 a[4:5], v25 offset:16384
    ds_read_b64_tr_b16 a[6:7], v25 offset:16896
    v_mfma_f32_16x16x32_bf16 v[116:119], a[8:11], v[60:63], 0
    ds_read_b64_tr_b16 a[8:9], v26 offset:16384
    ds_read_b64_tr_b16 a[10:11], v26 offset:16896
    v_mfma_f32_16x16x32_bf16 v[14:17], a[12:15], v[60:63], 0
    ds_read_b64_tr_b16 a[12:13], v27 offset:16384
    ds_read_b64_tr_b16 a[14:15], v27 offset:16896
    v_mfma_f32_16x16x32_bf16 v[108:111], a[16:19], v[64:67], v[108:111]
    ds_read_b64_tr_b16 a[16:17], v24 offset:20480
    ds_read_b64_tr_b16 a[18:19], v24 offset:20992
    buffer_load_dwordx4 v[104:107], v13, s[28:31], s57 offen offset:3072 sc1
    v_mfma_f32_16x16x32_bf16 v[112:115], a[20:23], v[64:67], v[112:115]
    ds_read_b64_tr_b16 a[20:21], v25 offset:20480
    ds_read_b64_tr_b16 a[22:23], v25 offset:20992
    v_mfma_f32_16x16x32_bf16 v[116:119], a[24:27], v[64:67], v[116:119]
    ds_read_b64_tr_b16 a[24:25], v26 offset:20480
    ds_read_b64_tr_b16 a[26:27], v26 offset:20992
    v_mfma_f32_16x16x32_bf16 v[14:17], a[28:31], v[64:67], v[14:17]
    ds_read_b64_tr_b16 a[28:29], v27 offset:20480
    ds_read_b64_tr_b16 a[30:31], v27 offset:20992
    s_waitcnt lgkmcnt(15)
Linfo:
    v_readfirstlane_b32 s43, v8
    s_nop 0
    s_cmp_eq_u32 s43, -2
    s_cbranch_scc1 Linfo_re
    v_cmp_class_f32_e64 vcc, v108, s65
    s_nop 0
    s_cbranch_vccnz Lnan
    s_waitcnt vmcnt(8)
    v_mfma_f32_16x16x32_bf16 v[108:111], a[32:35], v[68:71], v[108:111]
    ds_read_b64_tr_b16 a[32:33], v20 offset:32768
    ds_read_b64_tr_b16 a[34:35], v20 offset:33280
    buffer_load_dwordx4 v[60:63], v13, s[28:31], s58 offen offset:0 sc1
    v_mfma_f32_16x16x32_bf16 v[112:115], a[36:39], v[68:71], v[112:115]
    ds_read_b64_tr_b16 a[36:37], v21 offset:32768
    ds_read_b64_tr_b16 a[38:39], v21 offset:33280
    v_mfma_f32_16x16x32_bf16 v[116:119], a[40:43], v[68:71], v[116:119]
    ds_read_b64_tr_b16 a[40:41], v22 offset:32768
    ds_read_b64_tr_b16 a[42:43], v22 offset:33280
    v_mfma_f32_16x16x32_bf16 v[14:17], a[44:47], v[68:71], v[14:17]
    ds_read_b64_tr_b16 a[44:45], v23 offset:32768
    ds_read_b64_tr_b16 a[46:47], v23 offset:33280
    v_mfma_f32_16x16x32_bf16 v[108:111], a[48:51], v[72:75], v[108:111]
    ds_read_b64_tr_b16 a[48:49], v20 offset:36864
    ds_read_b64_tr_b16 a[50:51], v20 offset:37376
    buffer_load_dwordx4 v[64:67], v13, s[28:31], s58 offen offset:1024 sc1
    v_mfma_f32_16x16x32_bf16 v[112:115], a[52:55], v[72:75], v[112:115]
    ds_read_b64_tr_b16 a[52:53], v21 offset:36864
    ds_read_b64_tr_b16 a[54:55], v21 offset:37376
    v_mfma_f32_16x16x32_bf16 v[116:119], a[56:59], v[72:75], v[116:119]
    ds_read_b64_tr_b16 a[56:57], v22 offset:36864
    ds_read_b64_tr_b16 a[58:59], v22 offset:37376
    v_mfma_f32_16x16x32_bf16 v[14:17], a[60:63], v[72:75], v[14:17]
    ds_read_b64_tr_b16 a[60:61], v23 offset:36864
    ds_read_b64_tr_b16 a[62:63], v23 offset:37376
    v_cmp_class_f32_e64 vcc, v108, s65
    s_nop 0
    s_cbranch_vccnz Lnan
    s_waitcnt vmcnt(8)
    v_mfma_f32_16x16x32_bf16 v[108:111], a[64:67], v[76:79], v[108:111]
    ds_read_b64_tr_b16 a[64:65], v20 offset:40960
    ds_read_b64_tr_b16 a[66:67], v20 offset:41472
    buffer_load_dwordx4 v[68:71], v13, s[28:31], s58 offen offset:2048 sc1
    v_mfma_f32_16x16x32_bf16 v[112:115], a[68:71], v[76:79], v[112:115]
    ds_read_b64_tr_b16 a[68:69], v21 offset:40960
    ds_read_b64_tr_b16 a[70:71], v21 offset:41472
    v_mfma_f32_16x16x32_bf16 v[116:119], a[72:75], v[76:79], v[116:119]
    ds_read_b64_tr_b16 a[72:73], v22 offset:40960
    ds_read_b64_tr_b16 a[74:75], v22 offset:41472
    v_mfma_f32_16x16x32_bf16 v[14:17], a[76:79], v[76:79], v[14:17]
    ds_read_b64_tr_b16 a[76:77], v23 offset:40960
    ds_read_b64_tr_b16 a[78:79], v23 offset:41472
    v_mfma_f32_16x16x32_bf16 v[108:111], a[80:83], v[80:83], v[108:111]
    ds_read_b64_tr_b16 a[80:81], v20 offset:45056
    ds_read_b64_tr_b16 a[82:83], v20 offset:45568
    buffer_load_dwordx4 v[72:75], v13, s[28:31], s58 offen offset:3072 sc1
    v_mfma_f32_16x16x32_bf16 v[112:115], a[84:87], v[80:83], v[112:115]
    ds_read_b64_tr_b16 a[84:85], v21 offset:45056
    ds_read_b64_tr_b16 a[86:87], v21 offset:45568
    v_mfma_f32_16x16x32_bf16 v[116:119], a[88:91], v[80:83], v[116:119]
    ds_read_b64_tr_b16 a[88:89], v22 offset:45056
    ds_read_b64_tr_b16 a[90:91], v22 offset:45568
    v_mfma_f32_16x16x32_bf16 v[14:17], a[92:95], v[80:83], v[14:17]
    ds_read_b64_tr_b16 a[92:93], v23 offset:45056
    ds_read_b64_tr_b16 a[94:95], v23 offset:45568
    s_setprio 2
    v_cmp_class_f32_e64 vcc, v108, s65
    s_nop 0
    s_cbranch_vccnz Lnan
    s_waitcnt vmcnt(8)
    v_mfma_f32_16x16x32_bf16 v[108:111], a[96:99], v[84:87], v[108:111]
    ds_read_b64_tr_b16 a[96:97], v24 offset:0
    ds_read_b64_tr_b16 a[98:99], v24 offset:512
    buffer_load_dwordx4 v[76:79], v13, s[28:31], s59 offen offset:0 sc1
    v_mfma_f32_16x16x32_bf16 v[112:115], a[100:103], v[84:87], v[112:115]
    ds_read_b64_tr_b16 a[100:101], v25 offset:0
    ds_read_b64_tr_b16 a[102:103], v25 offset:512
    v_mfma_f32_16x16x32_bf16 v[116:119], a[104:107], v[84:87], v[116:119]
    ds_read_b64_tr_b16 a[104:105], v26 offset:0
    ds_read_b64_tr_b16 a[106:107], v26 offset:512
    v_mfma_f32_16x16x32_bf16 v[14:17], a[108:111], v[84:87], v[14:17]
    ds_read_b64_tr_b16 a[108:109], v27 offset:0
    ds_read_b64_tr_b16 a[110:111], v27 offset:512
    v_mfma_f32_16x16x32_bf16 v[108:111], a[112:115], v[88:91], v[108:111]
    ds_read_b64_tr_b16 a[112:113], v24 offset:4096
    ds_read_b64_tr_b16 a[114:115], v24 offset:4608
    buffer_load_dwordx4 v[80:83], v13, s[28:31], s59 offen offset:1024 sc1
    v_mfma_f32_16x16x32_bf16 v[112:115], a[116:119], v[88:91], v[112:115]
    ds_read_b64_tr_b16 a[116:117], v25 offset:4096
    ds_read_b64_tr_b16 a[118:119], v25 offset:4608
    v_mfma_f32_16x16x32_bf16 v[116:119], a[120:123], v[88:91], v[116:119]
    ds_read_b64_tr_b16 a[120:121], v26 offset:4096
    ds_read_b64_tr_b16 a[122:123], v26 offset:4608
    v_mfma_f32_16x16x32_bf16 v[14:17], a[124:127], v[88:91], v[14:17]
    ds_read_b64_tr_b16 a[124:125], v27 offset:4096
    ds_read_b64_tr_b16 a[126:127], v27 offset:4608
    v_cmp_class_f32_e64 vcc, v108, s65
    s_nop 0
    s_cbranch_vccnz Lnan
    s_waitcnt vmcnt(8) lgkmcnt(15)
    v_mfma_f32_16x16x32_bf16 v[108:111], a[0:3], v[92:95], v[108:111]
    ds_read_b64_tr_b16 a[0:1], v24 offset:8192
    ds_read_b64_tr_b16 a[2:3], v24 offset:8704
    buffer_load_dwordx4 v[84:87], v13, s[28:31], s59 offen offset:2048 sc1
    v_mfma_f32_16x16x32_bf16 v[112:115], a[4:7], v[92:95], v[112:115]
    ds_read_b64_tr_b16 a[4:5], v25 offset:8192
    ds_read_b64_tr_b16 a[6:7], v25 offset:8704
    v_mfma_f32_16x16x32_bf16 v[116:119], a[8:11], v[92:95], v[116:119]
    ds_read_b64_tr_b16 a[8:9], v26 offset:8192
    ds_read_b64_tr_b16 a[10:11], v26 offset:8704
    v_mfma_f32_16x16x32_bf16 v[14:17], a[12:15], v[92:95], v[14:17]
    ds_read_b64_tr_b16 a[12:13], v27 offset:8192
    ds_read_b64_tr_b16 a[14:15], v27 offset:8704
    v_mfma_f32_16x16x32_bf16 v[108:111], a[16:19], v[96:99], v[108:111]
    ds_read_b64_tr_b16 a[16:17], v24 offset:12288
    ds_read_b64_tr_b16 a[18:19], v24 offset:12800
    buffer_load_dwordx4 v[88:91], v13, s[28:31], s59 offen offset:3072 sc1
    v_mfma_f32_16x16x32_bf16 v[112:115], a[20:23], v[96:99], v[112:115]
    ds_read_b64_tr_b16 a[20:21], v25 offset:12288
    ds_read_b64_tr_b16 a[22:23], v25 offset:12800
    v_mfma_f32_16x16x32_bf16 v[116:119], a[24:27], v[96:99], v[116:119]
    ds_read_b64_tr_b16 a[24:25], v26 offset:12288
    ds_read_b64_tr_b16 a[26:27], v26 offset:12800
    v_mfma_f32_16x16x32_bf16 v[14:17], a[28:31], v[96:99], v[14:17]
    ds_read_b64_tr_b16 a[28:29], v27 offset:12288
    ds_read_b64_tr_b16 a[30:31], v27 offset:12800
    v_cmp_class_f32_e64 vcc, v108, s65
    s_nop 0
    s_cbranch_vccnz Lnan
    s_waitcnt vmcnt(8)
    v_mfma_f32_16x16x32_bf16 v[108:111], a[32:35], v[100:103], v[108:111]
    ds_read_b64_tr_b16 a[32:33], v20 offset:49152
    ds_read_b64_tr_b16 a[34:35], v20 offset:49664
    v_mfma_f32_16x16x32_bf16 v[112:115], a[36:39], v[100:103], v[112:115]
    ds_read_b64_tr_b16 a[36:37], v21 offset:49152
    ds_read_b64_tr_b16 a[38:39], v21 offset:49664
    v_mfma_f32_16x16x32_bf16 v[116:119], a[40:43], v[100:103], v[116:119]
    ds_read_b64_tr_b16 a[40:41], v22 offset:49152
    ds_read_b64_tr_b16 a[42:43], v22 offset:49664
    v_mfma_f32_16x16x32_bf16 v[14:17], a[44:47], v[100:103], v[14:17]
    ds_read_b64_tr_b16 a[44:45], v23 offset:49152
    ds_read_b64_tr_b16 a[46:47], v23 offset:49664
    v_mfma_f32_16x16x32_bf16 v[108:111], a[48:51], v[104:107], v[108:111]
    ds_read_b64_tr_b16 a[48:49], v24 offset:24576
    ds_read_b64_tr_b16 a[50:51], v24 offset:25088
    v_mfma_f32_16x16x32_bf16 v[112:115], a[52:55], v[104:107], v[112:115]
    ds_read_b64_tr_b16 a[52:53], v25 offset:24576
    ds_read_b64_tr_b16 a[54:55], v25 offset:25088
    v_mfma_f32_16x16x32_bf16 v[116:119], a[56:59], v[104:107], v[116:119]
    ds_read_b64_tr_b16 a[56:57], v26 offset:24576
    ds_read_b64_tr_b16 a[58:59], v26 offset:25088
    v_mfma_f32_16x16x32_bf16 v[14:17], a[60:63], v[104:107], v[14:17]
    ds_read_b64_tr_b16 a[60:61], v27 offset:24576
    ds_read_b64_tr_b16 a[62:63], v27 offset:25088
    s_setprio 1
    v_cmp_class_f32_e64 vcc, v108, s65
    s_nop 0
    s_cbranch_vccnz Lnan
    s_waitcnt vmcnt(6)
    v_mfma_f32_16x16x32_bf16 v[108:111], a[64:67], v[60:63], v[108:111]
    v_mfma_f32_16x16x32_bf16 v[112:115], a[68:71], v[60:63], v[112:115]
    v_mfma_f32_16x16x32_bf16 v[116:119], a[72:75], v[60:63], v[116:119]
    v_mfma_f32_16x16x32_bf16 v[14:17], a[76:79], v[60:63], v[14:17]
    v_mfma_f32_16x16x32_bf16 v[108:111], a[80:83], v[64:67], v[108:111]
    v_mfma_f32_16x16x32_bf16 v[112:115], a[84:87], v[64:67], v[112:115]
    v_mfma_f32_16x16x32_bf16 v[116:119], a[88:91], v[64:67], v[116:119]
    v_mfma_f32_16x16x32_bf16 v[14:17], a[92:95], v[64:67], v[14:17]
    s_waitcnt vmcnt(4) lgkmcnt(15)
    v_mfma_f32_16x16x32_bf16 v[108:111], a[96:99], v[68:71], v[108:111]
    v_mfma_f32_16x16x32_bf16 v[112:115], a[100:103], v[68:71], v[112:115]
    v_mfma_f32_16x16x32_bf16 v[116:119], a[104:107], v[68:71], v[116:119]
    v_mfma_f32_16x16x32_bf16 v[14:17], a[108:111], v[68:71], v[14:17]
    v_mfma_f32_16x16x32_bf16 v[108:111], a[112:115], v[72:75], v[108:111]
    v_mfma_f32_16x16x32_bf16 v[112:115], a[116:119], v[72:75], v[112:115]
    v_mfma_f32_16x16x32_bf16 v[116:119], a[120:123], v[72:75], v[116:119]
    v_mfma_f32_16x16x32_bf16 v[14:17], a[124:127], v[72:75], v[14:17]
    s_setprio 0
    s_waitcnt vmcnt(2)
    v_mfma_f32_16x16x32_bf16 v[108:111], a[0:3], v[76:79], v[108:111]
    v_mfma_f32_16x16x32_bf16 v[112:115], a[4:7], v[76:79], v[112:115]
    v_mfma_f32_16x16x32_bf16 v[116:119], a[8:11], v[76:79], v[116:119]
    v_mfma_f32_16x16x32_bf16 v[14:17], a[12:15], v[76:79], v[14:17]
    v_mfma_f32_16x16x32_bf16 v[108:111], a[16:19], v[80:83], v[108:111]
    v_mfma_f32_16x16x32_bf16 v[112:115], a[20:23], v[80:83], v[112:115]
    v_mfma_f32_16x16x32_bf16 v[116:119], a[24:27], v[80:83], v[116:119]
    v_mfma_f32_16x16x32_bf16 v[14:17], a[28:31], v[80:83], v[14:17]
    s_waitcnt vmcnt(0) lgkmcnt(8)
    v_mfma_f32_16x16x32_bf16 v[108:111], a[32:35], v[84:87], v[108:111]
    v_mfma_f32_16x16x32_bf16 v[112:115], a[36:39], v[84:87], v[112:115]
    v_mfma_f32_16x16x32_bf16 v[116:119], a[40:43], v[84:87], v[116:119]
    v_mfma_f32_16x16x32_bf16 v[14:17], a[44:47], v[84:87], v[14:17]
    s_waitcnt lgkmcnt(0)
    v_mfma_f32_16x16x32_bf16 v[108:111], a[48:51], v[88:91], v[108:111]
    v_mfma_f32_16x16x32_bf16 v[112:115], a[52:55], v[88:91], v[112:115]
    v_mfma_f32_16x16x32_bf16 v[116:119], a[56:59], v[88:91], v[116:119]
    v_mfma_f32_16x16x32_bf16 v[14:17], a[60:63], v[88:91], v[14:17]
    v_xor_b32 v60, 32, v124
    v_xor_b32 v61, 64, v124
    v_xor_b32 v62, 96, v124
    v_and_b32 v6, v8, v9
    s_nop 0
    v_readfirstlane_b32 s43, v6
    v_cmp_class_f32_e64 vcc, v108, s65
    s_nop 0
    s_cbranch_vccnz Lnan
    s_cmp_eq_u32 s43, -1
    s_cbranch_scc0 Lfix
Lnofix:
    v_fma_f32 v108, v108, v44, v28
    v_fma_f32 v109, v109, v45, v29
    v_fma_f32 v110, v110, v46, v30
    v_fma_f32 v111, v111, v47, v31
    v_cvt_pk_bf16_f32 v68, v108, v109
    v_cvt_pk_bf16_f32 v69, v110, v111
    ds_write_b64 v124, v[68:69]
    v_fma_f32 v112, v112, v48, v32
    v_fma_f32 v113, v113, v49, v33
    v_fma_f32 v114, v114, v50, v34
    v_fma_f32 v115, v115, v51, v35
    v_cvt_pk_bf16_f32 v70, v112, v113
    v_cvt_pk_bf16_f32 v71, v114, v115
    ds_write_b64 v60, v[70:71]
    v_fma_f32 v116, v116, v52, v36
    v_fma_f32 v117, v117, v53, v37
    v_fma_f32 v118, v118, v54, v38
    v_fma_f32 v119, v119, v55, v39
    v_cvt_pk_bf16_f32 v72, v116, v117
    v_cvt_pk_bf16_f32 v73, v118, v119
    ds_write_b64 v61, v[72:73]
    v_fma_f32 v14, v14, v56, v40
    v_fma_f32 v15, v15, v57, v41
    v_fma_f32 v16, v16, v58, v42
    v_fma_f32 v17, v17, v59, v43
    v_cvt_pk_bf16_f32 v74, v14, v15
    v_cvt_pk_bf16_f32 v75, v16, v17
    ds_write_b64 v62, v[74:75]
    ds_read_b128 v[76:79], v125 offset:0
    ds_read_b128 v[80:83], v125 offset:1024
    s_waitcnt lgkmcnt(1)
    buffer_store_dwordx4 v[76:79], v122, s[48:51], s24 offen
    s_waitcnt lgkmcnt(0)
    buffer_store_dwordx4 v[80:83], v123, s[48:51], s24 offen
    s_endpgm
Lqf_re:
    s_sub_u32 s39, s39, 1
    s_cbranch_scc1 Lend
    ds_read_b32 v7, v96
    ds_read_b128 v[76:79], v95 offset:0
    ds_read_b128 v[80:83], v95 offset:64
    ds_read_b128 v[84:87], v95 offset:128
    ds_read_b128 v[88:91], v95 offset:192
    s_waitcnt lgkmcnt(0)
    s_branch Lqf
Lcsv_re:
    s_sub_u32 s39, s39, 1
    s_cbranch_scc1 Lend
    ds_read_b32 v46, v49
    ds_read_b64 v[44:45], v48
    s_waitcnt lgkmcnt(0)
    s_branch Lcsv
Lrx_re:
    s_sub_u32 s39, s39, 1
    s_cbranch_scc1 Lend
    buffer_load_dwordx2 v[52:53], v13, s[28:31], s61 offen offset:8 sc1
    buffer_load_dwordx2 v[54:55], v13, s[28:31], s62 offen offset:0 sc1
    s_waitcnt vmcnt(0)
    s_branch Lrx_chk
Linfo_re:
    s_sub_u32 s39, s39, 1
    s_cbranch_scc1 Lend
    ds_read_b64 v[8:9], v10
    s_waitcnt lgkmcnt(0)
    s_branch Linfo
Lfl_re:
    s_sub_u32 s39, s39, 1
    s_cbranch_scc1 Lend
    buffer_load_dword v20, v12, s[28:31], s24 offen sc1
    s_waitcnt vmcnt(0)
    s_branch Lfl_chk
Lnan:
    s_add_u32 s45, s45, 1
    s_cmp_eq_u32 s45, 2
    s_cbranch_scc1 Lval0
    v_min_u32 v18, 19, v1
    v_lshlrev_b32 v18, 10, v18
Lprobe:
    s_sub_u32 s39, s39, 1
    s_cbranch_scc1 Lend
    buffer_load_dword v19, v18, s[28:31], s54 offen offset:1020 sc1
    s_waitcnt vmcnt(0)
    v_cmp_eq_u32 vcc, -1, v19
    s_nop 0
    s_cbranch_vccnz Lprobe
    s_branch Lredo
Lval0:
    s_mov_b32 s65, 0
    s_mov_b32 s40, s54
    s_add_u32 s41, s54, 20480
    s_waitcnt vmcnt(0)
Lval:
    s_sub_u32 s39, s39, 1
    s_cbranch_scc1 Lend
    buffer_load_dwordx4 v[60:63], v13, s[28:31], s40 offen sc1
    s_waitcnt vmcnt(0)
    v_max3_u32 v60, v60, v61, v62
    v_max_u32 v60, v60, v63
    v_cmp_eq_u32 vcc, -1, v60
    s_nop 0
    s_cbranch_vccnz Lval
    s_add_u32 s40, s40, 1024
    s_cmp_lt_u32 s40, s41
    s_cbranch_scc1 Lval
Lredo:
    buffer_load_dwordx4 v[60:63], v13, s[28:31], s55 offen offset:0 sc1
    buffer_load_dwordx4 v[64:67], v13, s[28:31], s55 offen offset:1024 sc1
    buffer_load_dwordx4 v[68:71], v13, s[28:31], s55 offen offset:2048 sc1
    buffer_load_dwordx4 v[72:75], v13, s[28:31], s55 offen offset:3072 sc1
    buffer_load_dwordx4 v[76:79], v13, s[28:31], s56 offen offset:0 sc1
    buffer_load_dwordx4 v[80:83], v13, s[28:31], s56 offen offset:1024 sc1
    buffer_load_dwordx4 v[84:87], v13, s[28:31], s56 offen offset:2048 sc1
    buffer_load_dwordx4 v[88:91], v13, s[28:31], s56 offen offset:3072 sc1
    ds_read_b64_tr_b16 a[0:1], v20 offset:0
    ds_read_b64_tr_b16 a[2:3], v20 offset:512
    ds_read_b64_tr_b16 a[4:5], v21 offset:0
    ds_read_b64_tr_b16 a[6:7], v21 offset:512
    ds_read_b64_tr_b16 a[8:9], v22 offset:0
    ds_read_b64_tr_b16 a[10:11], v22 offset:512
    ds_read_b64_tr_b16 a[12:13], v23 offset:0
    ds_read_b64_tr_b16 a[14:15], v23 offset:512
    ds_read_b64_tr_b16 a[16:17], v20 offset:4096
    ds_read_b64_tr_b16 a[18:19], v20 offset:4608
    ds_read_b64_tr_b16 a[20:21], v21 offset:4096
    ds_read_b64_tr_b16 a[22:23], v21 offset:4608
    ds_read_b64_tr_b16 a[24:25], v22 offset:4096
    ds_read_b64_tr_b16 a[26:27], v22 offset:4608
    ds_read_b64_tr_b16 a[28:29], v23 offset:4096
    ds_read_b64_tr_b16 a[30:31], v23 offset:4608
    ds_read_b64_tr_b16 a[32:33], v20 offset:8192
    ds_read_b64_tr_b16 a[34:35], v20 offset:8704
    ds_read_b64_tr_b16 a[36:37], v21 offset:8192
    ds_read_b64_tr_b16 a[38:39], v21 offset:8704
    ds_read_b64_tr_b16 a[40:41], v22 offset:8192
    ds_read_b64_tr_b16 a[42:43], v22 offset:8704
    ds_read_b64_tr_b16 a[44:45], v23 offset:8192
    ds_read_b64_tr_b16 a[46:47], v23 offset:8704
    ds_read_b64_tr_b16 a[48:49], v20 offset:12288
    ds_read_b64_tr_b16 a[50:51], v20 offset:12800
    ds_read_b64_tr_b16 a[52:53], v21 offset:12288
    ds_read_b64_tr_b16 a[54:55], v21 offset:12800
    ds_read_b64_tr_b16 a[56:57], v22 offset:12288
    ds_read_b64_tr_b16 a[58:59], v22 offset:12800
    ds_read_b64_tr_b16 a[60:61], v23 offset:12288
    ds_read_b64_tr_b16 a[62:63], v23 offset:12800
    ds_read_b64_tr_b16 a[64:65], v20 offset:24576
    ds_read_b64_tr_b16 a[66:67], v20 offset:25088
    ds_read_b64_tr_b16 a[68:69], v21 offset:24576
    ds_read_b64_tr_b16 a[70:71], v21 offset:25088
    ds_read_b64_tr_b16 a[72:73], v22 offset:24576
    ds_read_b64_tr_b16 a[74:75], v22 offset:25088
    ds_read_b64_tr_b16 a[76:77], v23 offset:24576
    ds_read_b64_tr_b16 a[78:79], v23 offset:25088
    ds_read_b64_tr_b16 a[80:81], v20 offset:28672
    ds_read_b64_tr_b16 a[82:83], v20 offset:29184
    ds_read_b64_tr_b16 a[84:85], v21 offset:28672
    ds_read_b64_tr_b16 a[86:87], v21 offset:29184
    ds_read_b64_tr_b16 a[88:89], v22 offset:28672
    ds_read_b64_tr_b16 a[90:91], v22 offset:29184
    ds_read_b64_tr_b16 a[92:93], v23 offset:28672
    ds_read_b64_tr_b16 a[94:95], v23 offset:29184
    ds_read_b64_tr_b16 a[96:97], v24 offset:59520
    ds_read_b64_tr_b16 a[98:99], v24 offset:60032
    ds_read_b64_tr_b16 a[100:101], v25 offset:59520
    ds_read_b64_tr_b16 a[102:103], v25 offset:60032
    ds_read_b64_tr_b16 a[104:105], v26 offset:59520
    ds_read_b64_tr_b16 a[106:107], v26 offset:60032
    ds_read_b64_tr_b16 a[108:109], v27 offset:59520
    ds_read_b64_tr_b16 a[110:111], v27 offset:60032
    ds_read_b64_tr_b16 a[112:113], v24 offset:63616
    ds_read_b64_tr_b16 a[114:115], v24 offset:64128
    ds_read_b64_tr_b16 a[116:117], v25 offset:63616
    ds_read_b64_tr_b16 a[118:119], v25 offset:64128
    ds_read_b64_tr_b16 a[120:121], v26 offset:63616
    ds_read_b64_tr_b16 a[122:123], v26 offset:64128
    ds_read_b64_tr_b16 a[124:125], v27 offset:63616
    ds_read_b64_tr_b16 a[126:127], v27 offset:64128
    s_waitcnt lgkmcnt(0)
    s_branch Lwo_go
Lfix:
    v_lshlrev_b32 v6, 4, v2
    v_add_u32 v6, 158208, v6
    v_mov_b32 v10, 157956
    v_mov_b32 v11, 1
    v_sub_u32 v4, v126, v3
    v_lshrrev_b32 v5, 3, v1
    v_add_u32 v4, v4, v5
    v_add_u32 v5, 8, v4
    v_mov_b32 v7, 0x40000000
    v_cmp_eq_u32 vcc, v8, v4
    s_nop 1
    v_cndmask_b32 v122, v122, v7, vcc
    v_cmp_eq_u32 vcc, v8, v5
    s_nop 1
    v_cndmask_b32 v123, v123, v7, vcc
    v_cmp_eq_u32 vcc, v8, v126
    s_nop 0
    s_mov_b64 exec, vcc
    ds_write_b128 v6, v[108:111] offset:0
    ds_write_b128 v6, v[112:115] offset:64
    ds_write_b128 v6, v[116:119] offset:128
    ds_write_b128 v6, v[14:17] offset:192
    ds_add_u32 v10, v11
    s_mov_b64 exec, -1
    v_cmp_eq_u32 vcc, v9, v4
    s_nop 1
    v_cndmask_b32 v122, v122, v7, vcc
    v_cmp_eq_u32 vcc, v9, v5
    s_nop 1
    v_cndmask_b32 v123, v123, v7, vcc
    v_cmp_eq_u32 vcc, v9, v126
    s_nop 0
    s_mov_b64 exec, vcc
    ds_write_b128 v6, v[108:111] offset:256
    ds_write_b128 v6, v[112:115] offset:320
    ds_write_b128 v6, v[116:119] offset:384
    ds_write_b128 v6, v[14:17] offset:448
    ds_add_u32 v10, v11
    s_mov_b64 exec, -1
    s_branch Lnofix
Lhalo:
    s_mov_b32 vcc_lo, 0x00010001
    s_mov_b32 vcc_hi, 0x00010001
    v_mov_b32 v11, 38912
    v_cndmask_b32 v76, v76, v11, vcc
    v_xor_b32 v77, 64, v76
    v_add_u32 v80, 78080, v76
    v_add_u32 v81, 78080, v77
    v_mov_b32 v14, 0x3f803f80
    v_mov_b32 v15, 0x3f803f80
    v_mov_b32 v16, 0x3f803f80
    v_mov_b32 v17, 0x3f803f80
    v_and_b32 v4, 7, v1
    v_lshlrev_b32 v4, 4, v4
    v_mul_u32_u24 v5, 39040, v2
    v_add_u32 v4, v4, v5
    ds_write_b128 v4, v[14:17] offset:38912
    v_mov_b32 v4, 157952
    v_mov_b32 v8, 0
    v_mov_b32 v9, 0
    v_mov_b32 v10, -2
    v_mov_b32 v11, -2
    ds_write_b128 v4, v[8:11]
    v_min_u32 v5, 23, v1
    v_lshl_add_u32 v5, v5, 2, v4
    ds_write_b32 v5, v8 offset:16
    s_mul_i32 s40, s36, 96
    s_sub_u32 s40, s40, 16
    v_add_u32 v96, s40, v1
    v_min_u32 v5, 47, v1
    v_add3_u32 v97, s40, v5, 64
    v_mov_b32 v6, 2047
    v_med3_i32 v96, v96, 0, v6
    v_med3_i32 v97, v97, 0, v6
    v_lshlrev_b32 v96, 3, v96
    v_lshlrev_b32 v97, 3, v97
    s_mov_b32 s53, 8192000
    v_mov_b32 v127, 157984
    s_lshl_b32 s40, s3, 2
    s_add_u32 s40, s40, 158016
    v_mov_b32 v10, s40
    s_waitcnt lgkmcnt(0)
    s_barrier
    s_add_u32 s38, s38, 0x9e3779b8
    s_or_b32 s38, s38, 1
    ds_read_b128 v[108:111], v76 offset:0
    ds_read_b128 v[112:115], v77 offset:0
    ds_read_b64_tr_b16 a[0:1], v20 offset:0
    ds_read_b64_tr_b16 a[2:3], v20 offset:512
    ds_read_b64_tr_b16 a[4:5], v21 offset:0
    ds_read_b64_tr_b16 a[6:7], v21 offset:512
    ds_read_b64_tr_b16 a[8:9], v22 offset:0
    ds_read_b64_tr_b16 a[10:11], v22 offset:512
    ds_read_b64_tr_b16 a[12:13], v23 offset:0
    ds_read_b64_tr_b16 a[14:15], v23 offset:512
    ds_read_b64_tr_b16 a[16:17], v20 offset:8192
    ds_read_b64_tr_b16 a[18:19], v20 offset:8704
    ds_read_b64_tr_b16 a[20:21], v21 offset:8192
    ds_read_b64_tr_b16 a[22:23], v21 offset:8704
    ds_read_b64_tr_b16 a[24:25], v22 offset:8192
    ds_read_b64_tr_b16 a[26:27], v22 offset:8704
    s_waitcnt lgkmcnt(12)
    v_mfma_f32_16x16x32_bf16 v[28:31], a[0:3], v[108:111], 0
    ds_read_b64_tr_b16 a[28:29], v23 offset:8192
    ds_read_b64_tr_b16 a[30:31], v23 offset:8704
    s_waitcnt lgkmcnt(12)
    v_mfma_f32_16x16x32_bf16 v[32:35], a[4:7], v[108:111], 0
    ds_read_b64_tr_b16 a[32:33], v20 offset:16384
    ds_read_b64_tr_b16 a[34:35], v20 offset:16896
    s_waitcnt lgkmcnt(12)
    v_mfma_f32_16x16x32_bf16 v[36:39], a[8:11], v[108:111], 0
    ds_read_b64_tr_b16 a[36:37], v21 offset:16384
    ds_read_b64_tr_b16 a[38:39], v21 offset:16896
    s_waitcnt lgkmcnt(12)
    v_mfma_f32_16x16x32_bf16 v[40:43], a[12:15], v[108:111], 0
    ds_read_b64_tr_b16 a[40:41], v22 offset:16384
    ds_read_b64_tr_b16 a[42:43], v22 offset:16896
    s_waitcnt lgkmcnt(12)
    v_mfma_f32_16x16x32_bf16 v[44:47], a[16:19], v[108:111], 0
    ds_read_b64_tr_b16 a[44:45], v23 offset:16384
    ds_read_b64_tr_b16 a[46:47], v23 offset:16896
    s_waitcnt lgkmcnt(12)
    v_mfma_f32_16x16x32_bf16 v[48:51], a[20:23], v[108:111], 0
    ds_read_b64_tr_b16 a[48:49], v20 offset:4096
    ds_read_b64_tr_b16 a[50:51], v20 offset:4608
    s_waitcnt lgkmcnt(12)
    v_mfma_f32_16x16x32_bf16 v[52:55], a[24:27], v[108:111], 0
    ds_read_b64_tr_b16 a[52:53], v21 offset:4096
    ds_read_b64_tr_b16 a[54:55], v21 offset:4608
    s_waitcnt lgkmcnt(12)
    v_mfma_f32_16x16x32_bf16 v[56:59], a[28:31], v[108:111], 0
    ds_read_b64_tr_b16 a[56:57], v22 offset:4096
    ds_read_b64_tr_b16 a[58:59], v22 offset:4608
    s_waitcnt lgkmcnt(12)
    v_mfma_f32_16x16x32_bf16 v[60:63], v[108:111], a[32:35], 0
    ds_read_b64_tr_b16 a[60:61], v23 offset:4096
    ds_read_b64_tr_b16 a[62:63], v23 offset:4608
    s_waitcnt lgkmcnt(12)
    v_mfma_f32_16x16x32_bf16 v[64:67], v[108:111], a[36:39], 0
    ds_read_b64_tr_b16 a[64:65], v20 offset:12288
    ds_read_b64_tr_b16 a[66:67], v20 offset:12800
    s_waitcnt lgkmcnt(12)
    v_mfma_f32_16x16x32_bf16 v[68:71], v[108:111], a[40:43], 0
    ds_read_b64_tr_b16 a[68:69], v21 offset:12288
    ds_read_b64_tr_b16 a[70:71], v21 offset:12800
    s_waitcnt lgkmcnt(12)
    v_mfma_f32_16x16x32_bf16 v[72:75], v[108:111], a[44:47], 0
    ds_read_b64_tr_b16 a[72:73], v22 offset:12288
    ds_read_b64_tr_b16 a[74:75], v22 offset:12800
    s_waitcnt lgkmcnt(12)
    v_mfma_f32_16x16x32_bf16 v[28:31], a[48:51], v[112:115], v[28:31]
    ds_read_b64_tr_b16 a[76:77], v23 offset:12288
    ds_read_b64_tr_b16 a[78:79], v23 offset:12800
    s_waitcnt lgkmcnt(12)
    v_mfma_f32_16x16x32_bf16 v[32:35], a[52:55], v[112:115], v[32:35]
    ds_read_b64_tr_b16 a[80:81], v20 offset:20480
    ds_read_b64_tr_b16 a[82:83], v20 offset:20992
    s_waitcnt lgkmcnt(12)
    v_mfma_f32_16x16x32_bf16 v[36:39], a[56:59], v[112:115], v[36:39]
    ds_read_b64_tr_b16 a[84:85], v21 offset:20480
    ds_read_b64_tr_b16 a[86:87], v21 offset:20992
    s_waitcnt lgkmcnt(12)
    v_mfma_f32_16x16x32_bf16 v[40:43], a[60:63], v[112:115], v[40:43]
    ds_read_b64_tr_b16 a[88:89], v22 offset:20480
    ds_read_b64_tr_b16 a[90:91], v22 offset:20992
    s_waitcnt lgkmcnt(12)
    v_mfma_f32_16x16x32_bf16 v[44:47], a[64:67], v[112:115], v[44:47]
    ds_read_b64_tr_b16 a[92:93], v23 offset:20480
    ds_read_b64_tr_b16 a[94:95], v23 offset:20992
    s_waitcnt lgkmcnt(12)
    v_mfma_f32_16x16x32_bf16 v[48:51], a[68:71], v[112:115], v[48:51]
    s_waitcnt lgkmcnt(10)
    v_mfma_f32_16x16x32_bf16 v[52:55], a[72:75], v[112:115], v[52:55]
    s_waitcnt lgkmcnt(8)
    v_mfma_f32_16x16x32_bf16 v[56:59], a[76:79], v[112:115], v[56:59]
    s_waitcnt lgkmcnt(6)
    v_mfma_f32_16x16x32_bf16 v[60:63], v[112:115], a[80:83], v[60:63]
    s_waitcnt lgkmcnt(4)
    v_mfma_f32_16x16x32_bf16 v[64:67], v[112:115], a[84:87], v[64:67]
    s_waitcnt lgkmcnt(2)
    v_mfma_f32_16x16x32_bf16 v[68:71], v[112:115], a[88:91], v[68:71]
    s_waitcnt lgkmcnt(0)
    v_mfma_f32_16x16x32_bf16 v[72:75], v[112:115], a[92:95], v[72:75]
    s_barrier
    ds_read_b128 v[108:111], v76 offset:39040
    ds_read_b128 v[112:115], v77 offset:39040
    ds_read_b64_tr_b16 a[0:1], v20 offset:39040
    ds_read_b64_tr_b16 a[2:3], v20 offset:39552
    ds_read_b64_tr_b16 a[4:5], v21 offset:39040
    ds_read_b64_tr_b16 a[6:7], v21 offset:39552
    ds_read_b64_tr_b16 a[8:9], v22 offset:39040
    ds_read_b64_tr_b16 a[10:11], v22 offset:39552
    ds_read_b64_tr_b16 a[12:13], v23 offset:39040
    ds_read_b64_tr_b16 a[14:15], v23 offset:39552
    ds_read_b64_tr_b16 a[16:17], v20 offset:47232
    ds_read_b64_tr_b16 a[18:19], v20 offset:47744
    ds_read_b64_tr_b16 a[20:21], v21 offset:47232
    ds_read_b64_tr_b16 a[22:23], v21 offset:47744
    ds_read_b64_tr_b16 a[24:25], v22 offset:47232
    ds_read_b64_tr_b16 a[26:27], v22 offset:47744
    s_waitcnt lgkmcnt(12)
    v_mfma_f32_16x16x32_bf16 v[28:31], a[0:3], v[108:111], v[28:31]
    ds_read_b64_tr_b16 a[28:29], v23 offset:47232
    ds_read_b64_tr_b16 a[30:31], v23 offset:47744
    s_waitcnt lgkmcnt(12)
    v_mfma_f32_16x16x32_bf16 v[32:35], a[4:7], v[108:111], v[32:35]
    ds_read_b64_tr_b16 a[32:33], v20 offset:55424
    ds_read_b64_tr_b16 a[34:35], v20 offset:55936
    s_waitcnt lgkmcnt(12)
    v_mfma_f32_16x16x32_bf16 v[36:39], a[8:11], v[108:111], v[36:39]
    ds_read_b64_tr_b16 a[36:37], v21 offset:55424
    ds_read_b64_tr_b16 a[38:39], v21 offset:55936
    s_waitcnt lgkmcnt(12)
    v_mfma_f32_16x16x32_bf16 v[40:43], a[12:15], v[108:111], v[40:43]
    ds_read_b64_tr_b16 a[40:41], v22 offset:55424
    ds_read_b64_tr_b16 a[42:43], v22 offset:55936
    s_waitcnt lgkmcnt(12)
    v_mfma_f32_16x16x32_bf16 v[44:47], a[16:19], v[108:111], v[44:47]
    ds_read_b64_tr_b16 a[44:45], v23 offset:55424
    ds_read_b64_tr_b16 a[46:47], v23 offset:55936
    s_waitcnt lgkmcnt(12)
    v_mfma_f32_16x16x32_bf16 v[48:51], a[20:23], v[108:111], v[48:51]
    ds_read_b64_tr_b16 a[48:49], v20 offset:43136
    ds_read_b64_tr_b16 a[50:51], v20 offset:43648
    s_waitcnt lgkmcnt(12)
    v_mfma_f32_16x16x32_bf16 v[52:55], a[24:27], v[108:111], v[52:55]
    ds_read_b64_tr_b16 a[52:53], v21 offset:43136
    ds_read_b64_tr_b16 a[54:55], v21 offset:43648
    s_waitcnt lgkmcnt(12)
    v_mfma_f32_16x16x32_bf16 v[56:59], a[28:31], v[108:111], v[56:59]
    ds_read_b64_tr_b16 a[56:57], v22 offset:43136
    ds_read_b64_tr_b16 a[58:59], v22 offset:43648
    s_waitcnt lgkmcnt(12)
    v_mfma_f32_16x16x32_bf16 v[60:63], v[108:111], a[32:35], v[60:63]
    ds_read_b64_tr_b16 a[60:61], v23 offset:43136
    ds_read_b64_tr_b16 a[62:63], v23 offset:43648
    s_waitcnt lgkmcnt(12)
    v_mfma_f32_16x16x32_bf16 v[64:67], v[108:111], a[36:39], v[64:67]
    ds_read_b64_tr_b16 a[64:65], v20 offset:51328
    ds_read_b64_tr_b16 a[66:67], v20 offset:51840
    s_waitcnt lgkmcnt(12)
    v_mfma_f32_16x16x32_bf16 v[68:71], v[108:111], a[40:43], v[68:71]
    ds_read_b64_tr_b16 a[68:69], v21 offset:51328
    ds_read_b64_tr_b16 a[70:71], v21 offset:51840
    s_waitcnt lgkmcnt(12)
    v_mfma_f32_16x16x32_bf16 v[72:75], v[108:111], a[44:47], v[72:75]
    ds_read_b64_tr_b16 a[72:73], v22 offset:51328
    ds_read_b64_tr_b16 a[74:75], v22 offset:51840
    s_waitcnt lgkmcnt(12)
    v_mfma_f32_16x16x32_bf16 v[28:31], a[48:51], v[112:115], v[28:31]
    ds_read_b64_tr_b16 a[76:77], v23 offset:51328
    ds_read_b64_tr_b16 a[78:79], v23 offset:51840
    s_waitcnt lgkmcnt(12)
    v_mfma_f32_16x16x32_bf16 v[32:35], a[52:55], v[112:115], v[32:35]
    ds_read_b64_tr_b16 a[80:81], v20 offset:59520
    ds_read_b64_tr_b16 a[82:83], v20 offset:60032
    s_waitcnt lgkmcnt(12)
    v_mfma_f32_16x16x32_bf16 v[36:39], a[56:59], v[112:115], v[36:39]
    ds_read_b64_tr_b16 a[84:85], v21 offset:59520
    ds_read_b64_tr_b16 a[86:87], v21 offset:60032
    s_waitcnt lgkmcnt(12)
    v_mfma_f32_16x16x32_bf16 v[40:43], a[60:63], v[112:115], v[40:43]
    ds_read_b64_tr_b16 a[88:89], v22 offset:59520
    ds_read_b64_tr_b16 a[90:91], v22 offset:60032
    s_waitcnt lgkmcnt(12)
    v_mfma_f32_16x16x32_bf16 v[44:47], a[64:67], v[112:115], v[44:47]
    ds_read_b64_tr_b16 a[92:93], v23 offset:59520
    ds_read_b64_tr_b16 a[94:95], v23 offset:60032
    s_waitcnt lgkmcnt(12)
    v_mfma_f32_16x16x32_bf16 v[48:51], a[68:71], v[112:115], v[48:51]
    s_waitcnt lgkmcnt(10)
    v_mfma_f32_16x16x32_bf16 v[52:55], a[72:75], v[112:115], v[52:55]
    s_waitcnt lgkmcnt(8)
    v_mfma_f32_16x16x32_bf16 v[56:59], a[76:79], v[112:115], v[56:59]
    s_waitcnt lgkmcnt(6)
    v_mfma_f32_16x16x32_bf16 v[60:63], v[112:115], a[80:83], v[60:63]
    s_waitcnt lgkmcnt(4)
    v_mfma_f32_16x16x32_bf16 v[64:67], v[112:115], a[84:87], v[64:67]
    s_waitcnt lgkmcnt(2)
    v_mfma_f32_16x16x32_bf16 v[68:71], v[112:115], a[88:91], v[68:71]
    s_waitcnt lgkmcnt(0)
    v_mfma_f32_16x16x32_bf16 v[72:75], v[112:115], a[92:95], v[72:75]
    s_mov_b64 exec, 1
    s_lshl_b32 s40, s2, 2
    s_add_u32 s40, s40, 8323072
    v_mov_b32 v4, s38
    v_mov_b32 v5, s40
    buffer_store_dword v4, v5, s[28:31], 0 offen sc1
    s_mov_b64 exec, -1
    s_barrier
    ds_read_b128 v[108:111], v80 offset:0
    ds_read_b128 v[112:115], v81 offset:0
    ds_read_b64_tr_b16 a[0:1], v24 offset:0
    ds_read_b64_tr_b16 a[2:3], v24 offset:512
    ds_read_b64_tr_b16 a[4:5], v25 offset:0
    ds_read_b64_tr_b16 a[6:7], v25 offset:512
    ds_read_b64_tr_b16 a[8:9], v26 offset:0
    ds_read_b64_tr_b16 a[10:11], v26 offset:512
    ds_read_b64_tr_b16 a[12:13], v27 offset:0
    ds_read_b64_tr_b16 a[14:15], v27 offset:512
    ds_read_b64_tr_b16 a[16:17], v24 offset:8192
    ds_read_b64_tr_b16 a[18:19], v24 offset:8704
    ds_read_b64_tr_b16 a[20:21], v25 offset:8192
    ds_read_b64_tr_b16 a[22:23], v25 offset:8704
    ds_read_b64_tr_b16 a[24:25], v26 offset:8192
    ds_read_b64_tr_b16 a[26:27], v26 offset:8704
    s_waitcnt lgkmcnt(12)
    v_mfma_f32_16x16x32_bf16 v[28:31], a[0:3], v[108:111], v[28:31]
    ds_read_b64_tr_b16 a[28:29], v27 offset:8192
    ds_read_b64_tr_b16 a[30:31], v27 offset:8704
    s_waitcnt lgkmcnt(12)
    v_mfma_f32_16x16x32_bf16 v[32:35], a[4:7], v[108:111], v[32:35]
    ds_read_b64_tr_b16 a[32:33], v24 offset:16384
    ds_read_b64_tr_b16 a[34:35], v24 offset:16896
    s_waitcnt lgkmcnt(12)
    v_mfma_f32_16x16x32_bf16 v[36:39], a[8:11], v[108:111], v[36:39]
    ds_read_b64_tr_b16 a[36:37], v25 offset:16384
    ds_read_b64_tr_b16 a[38:39], v25 offset:16896
    s_waitcnt lgkmcnt(12)
    v_mfma_f32_16x16x32_bf16 v[40:43], a[12:15], v[108:111], v[40:43]
    ds_read_b64_tr_b16 a[40:41], v26 offset:16384
    ds_read_b64_tr_b16 a[42:43], v26 offset:16896
    s_waitcnt lgkmcnt(12)
    v_mfma_f32_16x16x32_bf16 v[44:47], a[16:19], v[108:111], v[44:47]
    ds_read_b64_tr_b16 a[44:45], v27 offset:16384
    ds_read_b64_tr_b16 a[46:47], v27 offset:16896
    s_waitcnt lgkmcnt(12)
    v_mfma_f32_16x16x32_bf16 v[48:51], a[20:23], v[108:111], v[48:51]
    ds_read_b64_tr_b16 a[48:49], v24 offset:4096
    ds_read_b64_tr_b16 a[50:51], v24 offset:4608
    s_waitcnt lgkmcnt(12)
    v_mfma_f32_16x16x32_bf16 v[52:55], a[24:27], v[108:111], v[52:55]
    ds_read_b64_tr_b16 a[52:53], v25 offset:4096
    ds_read_b64_tr_b16 a[54:55], v25 offset:4608
    s_waitcnt lgkmcnt(12)
    v_mfma_f32_16x16x32_bf16 v[56:59], a[28:31], v[108:111], v[56:59]
    ds_read_b64_tr_b16 a[56:57], v26 offset:4096
    ds_read_b64_tr_b16 a[58:59], v26 offset:4608
    s_waitcnt lgkmcnt(12)
    v_mfma_f32_16x16x32_bf16 v[60:63], v[108:111], a[32:35], v[60:63]
    ds_read_b64_tr_b16 a[60:61], v27 offset:4096
    ds_read_b64_tr_b16 a[62:63], v27 offset:4608
    s_waitcnt lgkmcnt(12)
    v_mfma_f32_16x16x32_bf16 v[64:67], v[108:111], a[36:39], v[64:67]
    ds_read_b64_tr_b16 a[64:65], v24 offset:12288
    ds_read_b64_tr_b16 a[66:67], v24 offset:12800
    s_waitcnt lgkmcnt(12)
    v_mfma_f32_16x16x32_bf16 v[68:71], v[108:111], a[40:43], v[68:71]
    ds_read_b64_tr_b16 a[68:69], v25 offset:12288
    ds_read_b64_tr_b16 a[70:71], v25 offset:12800
    s_waitcnt lgkmcnt(12)
    v_mfma_f32_16x16x32_bf16 v[72:75], v[108:111], a[44:47], v[72:75]
    ds_read_b64_tr_b16 a[72:73], v26 offset:12288
    ds_read_b64_tr_b16 a[74:75], v26 offset:12800
    s_waitcnt lgkmcnt(12)
    v_mfma_f32_16x16x32_bf16 v[28:31], a[48:51], v[112:115], v[28:31]
    ds_read_b64_tr_b16 a[76:77], v27 offset:12288
    ds_read_b64_tr_b16 a[78:79], v27 offset:12800
    s_waitcnt lgkmcnt(12)
    v_mfma_f32_16x16x32_bf16 v[32:35], a[52:55], v[112:115], v[32:35]
    ds_read_b64_tr_b16 a[80:81], v24 offset:20480
    ds_read_b64_tr_b16 a[82:83], v24 offset:20992
    s_waitcnt lgkmcnt(12)
    v_mfma_f32_16x16x32_bf16 v[36:39], a[56:59], v[112:115], v[36:39]
    ds_read_b64_tr_b16 a[84:85], v25 offset:20480
    ds_read_b64_tr_b16 a[86:87], v25 offset:20992
    s_waitcnt lgkmcnt(12)
    v_mfma_f32_16x16x32_bf16 v[40:43], a[60:63], v[112:115], v[40:43]
    ds_read_b64_tr_b16 a[88:89], v26 offset:20480
    ds_read_b64_tr_b16 a[90:91], v26 offset:20992
    s_waitcnt lgkmcnt(12)
    v_mfma_f32_16x16x32_bf16 v[44:47], a[64:67], v[112:115], v[44:47]
    ds_read_b64_tr_b16 a[92:93], v27 offset:20480
    ds_read_b64_tr_b16 a[94:95], v27 offset:20992
    s_waitcnt lgkmcnt(12)
    v_mfma_f32_16x16x32_bf16 v[48:51], a[68:71], v[112:115], v[48:51]
    s_waitcnt lgkmcnt(10)
    v_mfma_f32_16x16x32_bf16 v[52:55], a[72:75], v[112:115], v[52:55]
    s_waitcnt lgkmcnt(8)
    v_mfma_f32_16x16x32_bf16 v[56:59], a[76:79], v[112:115], v[56:59]
    s_waitcnt lgkmcnt(6)
    v_mfma_f32_16x16x32_bf16 v[60:63], v[112:115], a[80:83], v[60:63]
    s_waitcnt lgkmcnt(4)
    v_mfma_f32_16x16x32_bf16 v[64:67], v[112:115], a[84:87], v[64:67]
    s_waitcnt lgkmcnt(2)
    v_mfma_f32_16x16x32_bf16 v[68:71], v[112:115], a[88:91], v[68:71]
    s_waitcnt lgkmcnt(0)
    v_mfma_f32_16x16x32_bf16 v[72:75], v[112:115], a[92:95], v[72:75]
    s_barrier
    ds_read_b128 v[108:111], v80 offset:39040
    ds_read_b128 v[112:115], v81 offset:39040
    ds_read_b64_tr_b16 a[0:1], v24 offset:39040
    ds_read_b64_tr_b16 a[2:3], v24 offset:39552
    ds_read_b64_tr_b16 a[4:5], v25 offset:39040
    ds_read_b64_tr_b16 a[6:7], v25 offset:39552
    ds_read_b64_tr_b16 a[8:9], v26 offset:39040
    ds_read_b64_tr_b16 a[10:11], v26 offset:39552
    ds_read_b64_tr_b16 a[12:13], v27 offset:39040
    ds_read_b64_tr_b16 a[14:15], v27 offset:39552
    ds_read_b64_tr_b16 a[16:17], v24 offset:47232
    ds_read_b64_tr_b16 a[18:19], v24 offset:47744
    ds_read_b64_tr_b16 a[20:21], v25 offset:47232
    ds_read_b64_tr_b16 a[22:23], v25 offset:47744
    ds_read_b64_tr_b16 a[24:25], v26 offset:47232
    ds_read_b64_tr_b16 a[26:27], v26 offset:47744
    s_waitcnt lgkmcnt(12)
    v_mfma_f32_16x16x32_bf16 v[28:31], a[0:3], v[108:111], v[28:31]
    ds_read_b64_tr_b16 a[28:29], v27 offset:47232
    ds_read_b64_tr_b16 a[30:31], v27 offset:47744
    s_waitcnt lgkmcnt(12)
    v_mfma_f32_16x16x32_bf16 v[32:35], a[4:7], v[108:111], v[32:35]
    ds_read_b64_tr_b16 a[32:33], v24 offset:55424
    ds_read_b64_tr_b16 a[34:35], v24 offset:55936
    s_waitcnt lgkmcnt(12)
    v_mfma_f32_16x16x32_bf16 v[36:39], a[8:11], v[108:111], v[36:39]
    ds_read_b64_tr_b16 a[36:37], v25 offset:55424
    ds_read_b64_tr_b16 a[38:39], v25 offset:55936
    s_waitcnt lgkmcnt(12)
    v_mfma_f32_16x16x32_bf16 v[40:43], a[12:15], v[108:111], v[40:43]
    ds_read_b64_tr_b16 a[40:41], v26 offset:55424
    ds_read_b64_tr_b16 a[42:43], v26 offset:55936
    s_waitcnt lgkmcnt(12)
    v_mfma_f32_16x16x32_bf16 v[44:47], a[16:19], v[108:111], v[44:47]
    ds_read_b64_tr_b16 a[44:45], v27 offset:55424
    ds_read_b64_tr_b16 a[46:47], v27 offset:55936
    s_waitcnt lgkmcnt(12)
    v_mfma_f32_16x16x32_bf16 v[48:51], a[20:23], v[108:111], v[48:51]
    ds_read_b64_tr_b16 a[48:49], v24 offset:43136
    ds_read_b64_tr_b16 a[50:51], v24 offset:43648
    s_waitcnt lgkmcnt(12)
    v_mfma_f32_16x16x32_bf16 v[52:55], a[24:27], v[108:111], v[52:55]
    ds_read_b64_tr_b16 a[52:53], v25 offset:43136
    ds_read_b64_tr_b16 a[54:55], v25 offset:43648
    s_waitcnt lgkmcnt(12)
    v_mfma_f32_16x16x32_bf16 v[56:59], a[28:31], v[108:111], v[56:59]
    ds_read_b64_tr_b16 a[56:57], v26 offset:43136
    ds_read_b64_tr_b16 a[58:59], v26 offset:43648
    s_waitcnt lgkmcnt(12)
    v_mfma_f32_16x16x32_bf16 v[60:63], v[108:111], a[32:35], v[60:63]
    ds_read_b64_tr_b16 a[60:61], v27 offset:43136
    ds_read_b64_tr_b16 a[62:63], v27 offset:43648
    s_waitcnt lgkmcnt(12)
    v_mfma_f32_16x16x32_bf16 v[64:67], v[108:111], a[36:39], v[64:67]
    ds_read_b64_tr_b16 a[64:65], v24 offset:51328
    ds_read_b64_tr_b16 a[66:67], v24 offset:51840
    s_waitcnt lgkmcnt(12)
    v_mfma_f32_16x16x32_bf16 v[68:71], v[108:111], a[40:43], v[68:71]
    ds_read_b64_tr_b16 a[68:69], v25 offset:51328
    ds_read_b64_tr_b16 a[70:71], v25 offset:51840
    s_waitcnt lgkmcnt(12)
    v_mfma_f32_16x16x32_bf16 v[72:75], v[108:111], a[44:47], v[72:75]
    ds_read_b64_tr_b16 a[72:73], v26 offset:51328
    ds_read_b64_tr_b16 a[74:75], v26 offset:51840
    s_waitcnt lgkmcnt(12)
    v_mfma_f32_16x16x32_bf16 v[28:31], a[48:51], v[112:115], v[28:31]
    ds_read_b64_tr_b16 a[76:77], v27 offset:51328
    ds_read_b64_tr_b16 a[78:79], v27 offset:51840
    s_waitcnt lgkmcnt(12)
    v_mfma_f32_16x16x32_bf16 v[32:35], a[52:55], v[112:115], v[32:35]
    ds_read_b64_tr_b16 a[80:81], v24 offset:59520
    ds_read_b64_tr_b16 a[82:83], v24 offset:60032
    s_waitcnt lgkmcnt(12)
    v_mfma_f32_16x16x32_bf16 v[36:39], a[56:59], v[112:115], v[36:39]
    ds_read_b64_tr_b16 a[84:85], v25 offset:59520
    ds_read_b64_tr_b16 a[86:87], v25 offset:60032
    s_waitcnt lgkmcnt(12)
    v_mfma_f32_16x16x32_bf16 v[40:43], a[60:63], v[112:115], v[40:43]
    ds_read_b64_tr_b16 a[88:89], v26 offset:59520
    ds_read_b64_tr_b16 a[90:91], v26 offset:60032
    s_waitcnt lgkmcnt(12)
    v_mfma_f32_16x16x32_bf16 v[44:47], a[64:67], v[112:115], v[44:47]
    ds_read_b64_tr_b16 a[92:93], v27 offset:59520
    ds_read_b64_tr_b16 a[94:95], v27 offset:60032
    s_waitcnt lgkmcnt(12)
    v_mfma_f32_16x16x32_bf16 v[48:51], a[68:71], v[112:115], v[48:51]
    s_waitcnt lgkmcnt(10)
    v_mfma_f32_16x16x32_bf16 v[52:55], a[72:75], v[112:115], v[52:55]
    s_waitcnt lgkmcnt(8)
    v_mfma_f32_16x16x32_bf16 v[56:59], a[76:79], v[112:115], v[56:59]
    s_waitcnt lgkmcnt(6)
    v_mfma_f32_16x16x32_bf16 v[60:63], v[112:115], a[80:83], v[60:63]
    s_waitcnt lgkmcnt(4)
    v_mfma_f32_16x16x32_bf16 v[64:67], v[112:115], a[84:87], v[64:67]
    s_waitcnt lgkmcnt(2)
    v_mfma_f32_16x16x32_bf16 v[68:71], v[112:115], a[88:91], v[68:71]
    s_waitcnt lgkmcnt(0)
    v_mfma_f32_16x16x32_bf16 v[72:75], v[112:115], a[92:95], v[72:75]
    v_add_u32 v4, 156224, v12
    v_min_u32 v5, 47, v1
    v_lshlrev_b32 v5, 2, v5
    v_add_u32 v5, 156480, v5
    v_lshlrev_b32 v6, 4, v2
    v_add_u32 v6, 157184, v6
    v_mov_b32 v7, 157968
    v_lshlrev_b32 v11, 2, v3
    v_add_u32 v11, 156224, v11
    s_barrier
    ds_read_b128 v[108:111], v76 offset:0
    ds_read_b128 v[112:115], v77 offset:0
    ds_read_b64_tr_b16 a[0:1], v20 offset:0
    ds_read_b64_tr_b16 a[2:3], v20 offset:512
    ds_read_b64_tr_b16 a[4:5], v21 offset:0
    ds_read_b64_tr_b16 a[6:7], v21 offset:512
    ds_read_b64_tr_b16 a[8:9], v22 offset:0
    ds_read_b64_tr_b16 a[10:11], v22 offset:512
    ds_read_b64_tr_b16 a[12:13], v23 offset:0
    ds_read_b64_tr_b16 a[14:15], v23 offset:512
    ds_read_b64_tr_b16 a[16:17], v20 offset:8192
    ds_read_b64_tr_b16 a[18:19], v20 offset:8704
    ds_read_b64_tr_b16 a[20:21], v21 offset:8192
    ds_read_b64_tr_b16 a[22:23], v21 offset:8704
    ds_read_b64_tr_b16 a[24:25], v22 offset:8192
    ds_read_b64_tr_b16 a[26:27], v22 offset:8704
    s_waitcnt lgkmcnt(12)
    v_mfma_f32_16x16x32_bf16 v[28:31], a[0:3], v[108:111], v[28:31]
    ds_read_b64_tr_b16 a[28:29], v23 offset:8192
    ds_read_b64_tr_b16 a[30:31], v23 offset:8704
    s_waitcnt lgkmcnt(12)
    v_mfma_f32_16x16x32_bf16 v[32:35], a[4:7], v[108:111], v[32:35]
    ds_read_b64_tr_b16 a[32:33], v20 offset:16384
    ds_read_b64_tr_b16 a[34:35], v20 offset:16896
    s_waitcnt lgkmcnt(12)
    v_mfma_f32_16x16x32_bf16 v[36:39], a[8:11], v[108:111], v[36:39]
    ds_read_b64_tr_b16 a[36:37], v21 offset:16384
    ds_read_b64_tr_b16 a[38:39], v21 offset:16896
    s_waitcnt lgkmcnt(12)
    v_mfma_f32_16x16x32_bf16 v[40:43], a[12:15], v[108:111], v[40:43]
    ds_read_b64_tr_b16 a[40:41], v22 offset:16384
    ds_read_b64_tr_b16 a[42:43], v22 offset:16896
    s_waitcnt lgkmcnt(12)
    v_mfma_f32_16x16x32_bf16 v[44:47], a[16:19], v[108:111], v[44:47]
    ds_read_b64_tr_b16 a[44:45], v23 offset:16384
    ds_read_b64_tr_b16 a[46:47], v23 offset:16896
    s_waitcnt lgkmcnt(12)
    v_mfma_f32_16x16x32_bf16 v[48:51], a[20:23], v[108:111], v[48:51]
    ds_read_b64_tr_b16 a[48:49], v20 offset:4096
    ds_read_b64_tr_b16 a[50:51], v20 offset:4608
    s_waitcnt lgkmcnt(12)
    v_mfma_f32_16x16x32_bf16 v[52:55], a[24:27], v[108:111], v[52:55]
    ds_read_b64_tr_b16 a[52:53], v21 offset:4096
    ds_read_b64_tr_b16 a[54:55], v21 offset:4608
    s_waitcnt lgkmcnt(12)
    v_mfma_f32_16x16x32_bf16 v[56:59], a[28:31], v[108:111], v[56:59]
    ds_read_b64_tr_b16 a[56:57], v22 offset:4096
    ds_read_b64_tr_b16 a[58:59], v22 offset:4608
    s_waitcnt lgkmcnt(12)
    v_mfma_f32_16x16x32_bf16 v[60:63], v[108:111], a[32:35], v[60:63]
    ds_read_b64_tr_b16 a[60:61], v23 offset:4096
    ds_read_b64_tr_b16 a[62:63], v23 offset:4608
    s_waitcnt lgkmcnt(12)
    v_mfma_f32_16x16x32_bf16 v[64:67], v[108:111], a[36:39], v[64:67]
    ds_read_b64_tr_b16 a[64:65], v20 offset:12288
    ds_read_b64_tr_b16 a[66:67], v20 offset:12800
    s_waitcnt lgkmcnt(12)
    v_mfma_f32_16x16x32_bf16 v[68:71], v[108:111], a[40:43], v[68:71]
    ds_read_b64_tr_b16 a[68:69], v21 offset:12288
    ds_read_b64_tr_b16 a[70:71], v21 offset:12800
    s_waitcnt lgkmcnt(12)
    v_mfma_f32_16x16x32_bf16 v[72:75], v[108:111], a[44:47], v[72:75]
    ds_read_b64_tr_b16 a[72:73], v22 offset:12288
    ds_read_b64_tr_b16 a[74:75], v22 offset:12800
    s_waitcnt lgkmcnt(12)
    v_mfma_f32_16x16x32_bf16 v[28:31], a[48:51], v[112:115], v[28:31]
    ds_read_b64_tr_b16 a[76:77], v23 offset:12288
    ds_read_b64_tr_b16 a[78:79], v23 offset:12800
    s_waitcnt lgkmcnt(12)
    v_mfma_f32_16x16x32_bf16 v[32:35], a[52:55], v[112:115], v[32:35]
    ds_read_b64_tr_b16 a[80:81], v20 offset:20480
    ds_read_b64_tr_b16 a[82:83], v20 offset:20992
    s_waitcnt lgkmcnt(12)
    v_mfma_f32_16x16x32_bf16 v[36:39], a[56:59], v[112:115], v[36:39]
    ds_read_b64_tr_b16 a[84:85], v21 offset:20480
    ds_read_b64_tr_b16 a[86:87], v21 offset:20992
    s_waitcnt lgkmcnt(12)
    v_mfma_f32_16x16x32_bf16 v[40:43], a[60:63], v[112:115], v[40:43]
    ds_read_b64_tr_b16 a[88:89], v22 offset:20480
    ds_read_b64_tr_b16 a[90:91], v22 offset:20992
    s_waitcnt lgkmcnt(12)
    v_mfma_f32_16x16x32_bf16 v[44:47], a[64:67], v[112:115], v[44:47]
    ds_read_b64_tr_b16 a[92:93], v23 offset:20480
    ds_read_b64_tr_b16 a[94:95], v23 offset:20992
    s_waitcnt lgkmcnt(12)
    v_mfma_f32_16x16x32_bf16 v[48:51], a[68:71], v[112:115], v[48:51]
    s_waitcnt lgkmcnt(10)
    v_mfma_f32_16x16x32_bf16 v[52:55], a[72:75], v[112:115], v[52:55]
    s_waitcnt lgkmcnt(8)
    v_mfma_f32_16x16x32_bf16 v[56:59], a[76:79], v[112:115], v[56:59]
    s_waitcnt lgkmcnt(6)
    v_mfma_f32_16x16x32_bf16 v[60:63], v[112:115], a[80:83], v[60:63]
    s_waitcnt lgkmcnt(4)
    v_mfma_f32_16x16x32_bf16 v[64:67], v[112:115], a[84:87], v[64:67]
    s_waitcnt lgkmcnt(2)
    v_mfma_f32_16x16x32_bf16 v[68:71], v[112:115], a[88:91], v[68:71]
    s_waitcnt lgkmcnt(0)
    v_mfma_f32_16x16x32_bf16 v[72:75], v[112:115], a[92:95], v[72:75]
    s_barrier
    ds_read_b128 v[108:111], v76 offset:39040
    ds_read_b128 v[112:115], v77 offset:39040
    ds_read_b64_tr_b16 a[0:1], v20 offset:39040
    ds_read_b64_tr_b16 a[2:3], v20 offset:39552
    ds_read_b64_tr_b16 a[4:5], v21 offset:39040
    ds_read_b64_tr_b16 a[6:7], v21 offset:39552
    ds_read_b64_tr_b16 a[8:9], v22 offset:39040
    ds_read_b64_tr_b16 a[10:11], v22 offset:39552
    ds_read_b64_tr_b16 a[12:13], v23 offset:39040
    ds_read_b64_tr_b16 a[14:15], v23 offset:39552
    ds_read_b64_tr_b16 a[16:17], v20 offset:47232
    ds_read_b64_tr_b16 a[18:19], v20 offset:47744
    ds_read_b64_tr_b16 a[20:21], v21 offset:47232
    ds_read_b64_tr_b16 a[22:23], v21 offset:47744
    ds_read_b64_tr_b16 a[24:25], v22 offset:47232
    ds_read_b64_tr_b16 a[26:27], v22 offset:47744
    s_waitcnt lgkmcnt(12)
    v_mfma_f32_16x16x32_bf16 v[28:31], a[0:3], v[108:111], v[28:31]
    ds_read_b64_tr_b16 a[28:29], v23 offset:47232
    ds_read_b64_tr_b16 a[30:31], v23 offset:47744
    s_waitcnt lgkmcnt(12)
    v_mfma_f32_16x16x32_bf16 v[32:35], a[4:7], v[108:111], v[32:35]
    ds_read_b64_tr_b16 a[32:33], v20 offset:55424
    ds_read_b64_tr_b16 a[34:35], v20 offset:55936
    s_waitcnt lgkmcnt(12)
    v_mfma_f32_16x16x32_bf16 v[36:39], a[8:11], v[108:111], v[36:39]
    ds_read_b64_tr_b16 a[36:37], v21 offset:55424
    ds_read_b64_tr_b16 a[38:39], v21 offset:55936
    s_waitcnt lgkmcnt(12)
    v_mfma_f32_16x16x32_bf16 v[40:43], a[12:15], v[108:111], v[40:43]
    ds_read_b64_tr_b16 a[40:41], v22 offset:55424
    ds_read_b64_tr_b16 a[42:43], v22 offset:55936
    s_waitcnt lgkmcnt(12)
    v_mfma_f32_16x16x32_bf16 v[44:47], a[16:19], v[108:111], v[44:47]
    ds_read_b64_tr_b16 a[44:45], v23 offset:55424
    ds_read_b64_tr_b16 a[46:47], v23 offset:55936
    s_waitcnt lgkmcnt(12)
    v_mfma_f32_16x16x32_bf16 v[48:51], a[20:23], v[108:111], v[48:51]
    ds_read_b64_tr_b16 a[48:49], v20 offset:43136
    ds_read_b64_tr_b16 a[50:51], v20 offset:43648
    s_waitcnt lgkmcnt(12)
    v_mfma_f32_16x16x32_bf16 v[52:55], a[24:27], v[108:111], v[52:55]
    ds_read_b64_tr_b16 a[52:53], v21 offset:43136
    ds_read_b64_tr_b16 a[54:55], v21 offset:43648
    s_waitcnt lgkmcnt(12)
    v_mfma_f32_16x16x32_bf16 v[56:59], a[28:31], v[108:111], v[56:59]
    ds_read_b64_tr_b16 a[56:57], v22 offset:43136
    ds_read_b64_tr_b16 a[58:59], v22 offset:43648
    s_waitcnt lgkmcnt(12)
    v_mfma_f32_16x16x32_bf16 v[60:63], v[108:111], a[32:35], v[60:63]
    ds_read_b64_tr_b16 a[60:61], v23 offset:43136
    ds_read_b64_tr_b16 a[62:63], v23 offset:43648
    s_waitcnt lgkmcnt(12)
    v_mfma_f32_16x16x32_bf16 v[64:67], v[108:111], a[36:39], v[64:67]
    ds_read_b64_tr_b16 a[64:65], v20 offset:51328
    ds_read_b64_tr_b16 a[66:67], v20 offset:51840
    s_waitcnt lgkmcnt(12)
    v_mfma_f32_16x16x32_bf16 v[68:71], v[108:111], a[40:43], v[68:71]
    ds_read_b64_tr_b16 a[68:69], v21 offset:51328
    ds_read_b64_tr_b16 a[70:71], v21 offset:51840
    s_waitcnt lgkmcnt(12)
    v_mfma_f32_16x16x32_bf16 v[72:75], v[108:111], a[44:47], v[72:75]
    ds_read_b64_tr_b16 a[72:73], v22 offset:51328
    ds_read_b64_tr_b16 a[74:75], v22 offset:51840
    s_waitcnt lgkmcnt(12)
    v_mfma_f32_16x16x32_bf16 v[28:31], a[48:51], v[112:115], v[28:31]
    ds_read_b64_tr_b16 a[76:77], v23 offset:51328
    ds_read_b64_tr_b16 a[78:79], v23 offset:51840
    s_waitcnt lgkmcnt(12)
    v_mfma_f32_16x16x32_bf16 v[32:35], a[52:55], v[112:115], v[32:35]
    ds_read_b64_tr_b16 a[80:81], v20 offset:59520
    ds_read_b64_tr_b16 a[82:83], v20 offset:60032
    s_waitcnt lgkmcnt(12)
    v_mfma_f32_16x16x32_bf16 v[36:39], a[56:59], v[112:115], v[36:39]
    ds_read_b64_tr_b16 a[84:85], v21 offset:59520
    ds_read_b64_tr_b16 a[86:87], v21 offset:60032
    s_waitcnt lgkmcnt(12)
    v_mfma_f32_16x16x32_bf16 v[40:43], a[60:63], v[112:115], v[40:43]
    ds_read_b64_tr_b16 a[88:89], v22 offset:59520
    ds_read_b64_tr_b16 a[90:91], v22 offset:60032
    s_waitcnt lgkmcnt(12)
    v_mfma_f32_16x16x32_bf16 v[44:47], a[64:67], v[112:115], v[44:47]
    ds_read_b64_tr_b16 a[92:93], v23 offset:59520
    ds_read_b64_tr_b16 a[94:95], v23 offset:60032
    s_waitcnt lgkmcnt(12)
    v_mfma_f32_16x16x32_bf16 v[48:51], a[68:71], v[112:115], v[48:51]
    s_waitcnt lgkmcnt(10)
    v_mfma_f32_16x16x32_bf16 v[52:55], a[72:75], v[112:115], v[52:55]
    s_waitcnt lgkmcnt(8)
    v_mfma_f32_16x16x32_bf16 v[56:59], a[76:79], v[112:115], v[56:59]
    s_waitcnt lgkmcnt(6)
    v_mfma_f32_16x16x32_bf16 v[60:63], v[112:115], a[80:83], v[60:63]
    s_waitcnt lgkmcnt(4)
    v_mfma_f32_16x16x32_bf16 v[64:67], v[112:115], a[84:87], v[64:67]
    s_waitcnt lgkmcnt(2)
    v_mfma_f32_16x16x32_bf16 v[68:71], v[112:115], a[88:91], v[68:71]
    s_waitcnt lgkmcnt(0)
    v_mfma_f32_16x16x32_bf16 v[72:75], v[112:115], a[92:95], v[72:75]
    s_barrier
    ds_read_b128 a[96:99], v80 offset:0
    ds_read_b128 a[100:103], v81 offset:0
    ds_read_b64_tr_b16 a[0:1], v24 offset:0
    ds_read_b64_tr_b16 a[2:3], v24 offset:512
    ds_read_b64_tr_b16 a[4:5], v25 offset:0
    ds_read_b64_tr_b16 a[6:7], v25 offset:512
    ds_read_b64_tr_b16 a[8:9], v26 offset:0
    ds_read_b64_tr_b16 a[10:11], v26 offset:512
    ds_read_b64_tr_b16 a[12:13], v27 offset:0
    ds_read_b64_tr_b16 a[14:15], v27 offset:512
    ds_read_b64_tr_b16 a[16:17], v24 offset:8192
    ds_read_b64_tr_b16 a[18:19], v24 offset:8704
    ds_read_b64_tr_b16 a[20:21], v25 offset:8192
    ds_read_b64_tr_b16 a[22:23], v25 offset:8704
    ds_read_b64_tr_b16 a[24:25], v26 offset:8192
    ds_read_b64_tr_b16 a[26:27], v26 offset:8704
    s_waitcnt lgkmcnt(12)
    v_mfma_f32_16x16x32_bf16 v[28:31], a[0:3], a[96:99], v[28:31]
    ds_read_b64_tr_b16 a[28:29], v27 offset:8192
    ds_read_b64_tr_b16 a[30:31], v27 offset:8704
    s_waitcnt lgkmcnt(12)
    v_mfma_f32_16x16x32_bf16 v[32:35], a[4:7], a[96:99], v[32:35]
    ds_read_b64_tr_b16 a[48:49], v24 offset:4096
    ds_read_b64_tr_b16 a[50:51], v24 offset:4608
    s_waitcnt lgkmcnt(12)
    v_mfma_f32_16x16x32_bf16 v[36:39], a[8:11], a[96:99], v[36:39]
    ds_read_b64_tr_b16 a[52:53], v25 offset:4096
    ds_read_b64_tr_b16 a[54:55], v25 offset:4608
    s_waitcnt lgkmcnt(12)
    v_mfma_f32_16x16x32_bf16 v[40:43], a[12:15], a[96:99], v[40:43]
    ds_read_b64_tr_b16 a[56:57], v26 offset:4096
    ds_read_b64_tr_b16 a[58:59], v26 offset:4608
    s_waitcnt lgkmcnt(12)
    v_mfma_f32_16x16x32_bf16 v[44:47], a[16:19], a[96:99], v[44:47]
    ds_read_b64_tr_b16 a[60:61], v27 offset:4096
    ds_read_b64_tr_b16 a[62:63], v27 offset:4608
    s_waitcnt lgkmcnt(12)
    v_mfma_f32_16x16x32_bf16 v[48:51], a[20:23], a[96:99], v[48:51]
    ds_read_b64_tr_b16 a[64:65], v24 offset:12288
    ds_read_b64_tr_b16 a[66:67], v24 offset:12800
    s_waitcnt lgkmcnt(12)
    v_mfma_f32_16x16x32_bf16 v[52:55], a[24:27], a[96:99], v[52:55]
    ds_read_b64_tr_b16 a[68:69], v25 offset:12288
    ds_read_b64_tr_b16 a[70:71], v25 offset:12800
    s_waitcnt lgkmcnt(12)
    v_mfma_f32_16x16x32_bf16 v[56:59], a[28:31], a[96:99], v[56:59]
    ds_read_b64_tr_b16 a[72:73], v26 offset:12288
    ds_read_b64_tr_b16 a[74:75], v26 offset:12800
    s_waitcnt lgkmcnt(12)
    v_mfma_f32_16x16x32_bf16 v[28:31], a[48:51], a[100:103], v[28:31]
    ds_read_b64_tr_b16 a[76:77], v27 offset:12288
    ds_read_b64_tr_b16 a[78:79], v27 offset:12800
    s_waitcnt lgkmcnt(12)
    v_mfma_f32_16x16x32_bf16 v[32:35], a[52:55], a[100:103], v[32:35]
    s_waitcnt lgkmcnt(10)
    v_mfma_f32_16x16x32_bf16 v[36:39], a[56:59], a[100:103], v[36:39]
    s_waitcnt lgkmcnt(8)
    v_mfma_f32_16x16x32_bf16 v[40:43], a[60:63], a[100:103], v[40:43]
    s_waitcnt lgkmcnt(6)
    v_mfma_f32_16x16x32_bf16 v[44:47], a[64:67], a[100:103], v[44:47]
    s_waitcnt lgkmcnt(4)
    v_mfma_f32_16x16x32_bf16 v[48:51], a[68:71], a[100:103], v[48:51]
    s_waitcnt lgkmcnt(2)
    v_mfma_f32_16x16x32_bf16 v[52:55], a[72:75], a[100:103], v[52:55]
    s_waitcnt lgkmcnt(0)
    v_mfma_f32_16x16x32_bf16 v[56:59], a[76:79], a[100:103], v[56:59]
    buffer_load_dwordx2 v[92:93], v96, s[28:31], s53 offen sc1
    buffer_load_dwordx2 v[94:95], v97, s[28:31], s53 offen sc1
    s_barrier
    ds_read_b128 a[104:107], v80 offset:39040
    ds_read_b128 a[108:111], v81 offset:39040
    ds_read_b64_tr_b16 a[0:1], v24 offset:39040
    ds_read_b64_tr_b16 a[2:3], v24 offset:39552
    ds_read_b64_tr_b16 a[4:5], v25 offset:39040
    ds_read_b64_tr_b16 a[6:7], v25 offset:39552
    ds_read_b64_tr_b16 a[8:9], v26 offset:39040
    ds_read_b64_tr_b16 a[10:11], v26 offset:39552
    ds_read_b64_tr_b16 a[12:13], v27 offset:39040
    ds_read_b64_tr_b16 a[14:15], v27 offset:39552
    ds_read_b64_tr_b16 a[16:17], v24 offset:47232
    ds_read_b64_tr_b16 a[18:19], v24 offset:47744
    ds_read_b64_tr_b16 a[20:21], v25 offset:47232
    ds_read_b64_tr_b16 a[22:23], v25 offset:47744
    ds_read_b64_tr_b16 a[24:25], v26 offset:47232
    ds_read_b64_tr_b16 a[26:27], v26 offset:47744
    s_waitcnt lgkmcnt(12)
    v_mfma_f32_16x16x32_bf16 v[28:31], a[0:3], a[104:107], v[28:31]
    ds_read_b64_tr_b16 a[28:29], v27 offset:47232
    ds_read_b64_tr_b16 a[30:31], v27 offset:47744
    s_waitcnt lgkmcnt(12)
    v_mfma_f32_16x16x32_bf16 v[32:35], a[4:7], a[104:107], v[32:35]
    ds_read_b64_tr_b16 a[48:49], v24 offset:43136
    ds_read_b64_tr_b16 a[50:51], v24 offset:43648
    s_waitcnt lgkmcnt(12)
    v_mfma_f32_16x16x32_bf16 v[36:39], a[8:11], a[104:107], v[36:39]
    ds_read_b64_tr_b16 a[52:53], v25 offset:43136
    ds_read_b64_tr_b16 a[54:55], v25 offset:43648
    s_waitcnt lgkmcnt(12)
    v_mfma_f32_16x16x32_bf16 v[40:43], a[12:15], a[104:107], v[40:43]
    ds_read_b64_tr_b16 a[56:57], v26 offset:43136
    ds_read_b64_tr_b16 a[58:59], v26 offset:43648
    s_waitcnt lgkmcnt(12)
    v_mfma_f32_16x16x32_bf16 v[44:47], a[16:19], a[104:107], v[44:47]
    ds_read_b64_tr_b16 a[60:61], v27 offset:43136
    ds_read_b64_tr_b16 a[62:63], v27 offset:43648
    s_waitcnt lgkmcnt(12)
    v_mfma_f32_16x16x32_bf16 v[48:51], a[20:23], a[104:107], v[48:51]
    ds_read_b64_tr_b16 a[64:65], v24 offset:51328
    ds_read_b64_tr_b16 a[66:67], v24 offset:51840
    s_waitcnt lgkmcnt(12)
    v_mfma_f32_16x16x32_bf16 v[52:55], a[24:27], a[104:107], v[52:55]
    ds_read_b64_tr_b16 a[68:69], v25 offset:51328
    ds_read_b64_tr_b16 a[70:71], v25 offset:51840
    s_waitcnt lgkmcnt(12)
    v_mfma_f32_16x16x32_bf16 v[56:59], a[28:31], a[104:107], v[56:59]
    ds_read_b64_tr_b16 a[72:73], v26 offset:51328
    ds_read_b64_tr_b16 a[74:75], v26 offset:51840
    s_waitcnt lgkmcnt(12)
    v_mfma_f32_16x16x32_bf16 v[28:31], a[48:51], a[108:111], v[28:31]
    ds_read_b64_tr_b16 a[76:77], v27 offset:51328
    ds_read_b64_tr_b16 a[78:79], v27 offset:51840
    s_waitcnt lgkmcnt(12)
    v_mfma_f32_16x16x32_bf16 v[32:35], a[52:55], a[108:111], v[32:35]
    s_waitcnt lgkmcnt(10)
    v_mfma_f32_16x16x32_bf16 v[36:39], a[56:59], a[108:111], v[36:39]
    s_waitcnt lgkmcnt(8)
    v_mfma_f32_16x16x32_bf16 v[40:43], a[60:63], a[108:111], v[40:43]
    s_waitcnt lgkmcnt(6)
    v_mfma_f32_16x16x32_bf16 v[44:47], a[64:67], a[108:111], v[44:47]
    s_waitcnt lgkmcnt(4)
    v_mfma_f32_16x16x32_bf16 v[48:51], a[68:71], a[108:111], v[48:51]
    s_waitcnt lgkmcnt(2)
    v_mfma_f32_16x16x32_bf16 v[52:55], a[72:75], a[108:111], v[52:55]
    s_waitcnt lgkmcnt(0)
    v_mfma_f32_16x16x32_bf16 v[56:59], a[76:79], a[108:111], v[56:59]
    s_barrier
    ds_read_b128 a[112:115], v76 offset:0
    ds_read_b128 a[116:119], v77 offset:0
    ds_read_b64_tr_b16 a[0:1], v20 offset:0
    ds_read_b64_tr_b16 a[2:3], v20 offset:512
    ds_read_b64_tr_b16 a[4:5], v21 offset:0
    ds_read_b64_tr_b16 a[6:7], v21 offset:512
    ds_read_b64_tr_b16 a[8:9], v22 offset:0
    ds_read_b64_tr_b16 a[10:11], v22 offset:512
    ds_read_b64_tr_b16 a[12:13], v23 offset:0
    ds_read_b64_tr_b16 a[14:15], v23 offset:512
    ds_read_b64_tr_b16 a[16:17], v20 offset:8192
    ds_read_b64_tr_b16 a[18:19], v20 offset:8704
    ds_read_b64_tr_b16 a[20:21], v21 offset:8192
    ds_read_b64_tr_b16 a[22:23], v21 offset:8704
    ds_read_b64_tr_b16 a[24:25], v22 offset:8192
    ds_read_b64_tr_b16 a[26:27], v22 offset:8704
    s_waitcnt lgkmcnt(12)
    v_mfma_f32_16x16x32_bf16 v[28:31], a[0:3], a[112:115], v[28:31]
    ds_read_b64_tr_b16 a[28:29], v23 offset:8192
    ds_read_b64_tr_b16 a[30:31], v23 offset:8704
    s_waitcnt lgkmcnt(12)
    v_mfma_f32_16x16x32_bf16 v[32:35], a[4:7], a[112:115], v[32:35]
    ds_read_b64_tr_b16 a[48:49], v20 offset:4096
    ds_read_b64_tr_b16 a[50:51], v20 offset:4608
    s_waitcnt lgkmcnt(12)
    v_mfma_f32_16x16x32_bf16 v[36:39], a[8:11], a[112:115], v[36:39]
    ds_read_b64_tr_b16 a[52:53], v21 offset:4096
    ds_read_b64_tr_b16 a[54:55], v21 offset:4608
    s_waitcnt lgkmcnt(12)
    v_mfma_f32_16x16x32_bf16 v[40:43], a[12:15], a[112:115], v[40:43]
    ds_read_b64_tr_b16 a[56:57], v22 offset:4096
    ds_read_b64_tr_b16 a[58:59], v22 offset:4608
    s_waitcnt lgkmcnt(12)
    v_mfma_f32_16x16x32_bf16 v[44:47], a[16:19], a[112:115], v[44:47]
    ds_read_b64_tr_b16 a[60:61], v23 offset:4096
    ds_read_b64_tr_b16 a[62:63], v23 offset:4608
    s_waitcnt lgkmcnt(12)
    v_mfma_f32_16x16x32_bf16 v[48:51], a[20:23], a[112:115], v[48:51]
    ds_read_b64_tr_b16 a[64:65], v20 offset:12288
    ds_read_b64_tr_b16 a[66:67], v20 offset:12800
    s_waitcnt lgkmcnt(12)
    v_mfma_f32_16x16x32_bf16 v[52:55], a[24:27], a[112:115], v[52:55]
    ds_read_b64_tr_b16 a[68:69], v21 offset:12288
    ds_read_b64_tr_b16 a[70:71], v21 offset:12800
    s_waitcnt lgkmcnt(12)
    v_mfma_f32_16x16x32_bf16 v[56:59], a[28:31], a[112:115], v[56:59]
    ds_read_b64_tr_b16 a[72:73], v22 offset:12288
    ds_read_b64_tr_b16 a[74:75], v22 offset:12800
    s_waitcnt lgkmcnt(12)
    v_mfma_f32_16x16x32_bf16 v[28:31], a[48:51], a[116:119], v[28:31]
    ds_read_b64_tr_b16 a[76:77], v23 offset:12288
    ds_read_b64_tr_b16 a[78:79], v23 offset:12800
    s_waitcnt lgkmcnt(12)
    v_mfma_f32_16x16x32_bf16 v[32:35], a[52:55], a[116:119], v[32:35]
    s_waitcnt lgkmcnt(10)
    v_mfma_f32_16x16x32_bf16 v[36:39], a[56:59], a[116:119], v[36:39]
    s_waitcnt vmcnt(0)
Lst_chk:
    v_cmp_ne_u32 vcc, s38, v93
    v_cmp_ne_u32 s[40:41], s38, v95
    s_nop 0
    s_or_b64 s[40:41], s[40:41], vcc
    s_cbranch_scc1 Lst_re
    v_lshlrev_b32 v93, 16, v92
    s_waitcnt lgkmcnt(8)
    v_mfma_f32_16x16x32_bf16 v[40:43], a[60:63], a[116:119], v[40:43]
    v_and_b32 v92, 0xffff0000, v92
    v_rcp_f32 v93, v93
    s_waitcnt lgkmcnt(6)
    v_mfma_f32_16x16x32_bf16 v[44:47], a[64:67], a[116:119], v[44:47]
    v_lshlrev_b32 v95, 16, v94
    v_and_b32 v94, 0xffff0000, v94
    s_waitcnt lgkmcnt(4)
    v_mfma_f32_16x16x32_bf16 v[48:51], a[68:71], a[116:119], v[48:51]
    v_rcp_f32 v95, v95
    ds_write2st64_b32 v4, v92, v93 offset0:0 offset1:2
    s_waitcnt lgkmcnt(3)
    v_mfma_f32_16x16x32_bf16 v[52:55], a[72:75], a[116:119], v[52:55]
    ds_write2st64_b32 v5, v94, v95 offset0:0 offset1:2
    ds_read_b32 v120, v11
    s_waitcnt lgkmcnt(3)
    v_mfma_f32_16x16x32_bf16 v[56:59], a[76:79], a[116:119], v[56:59]
    s_waitcnt lgkmcnt(0)
    s_barrier
    ds_read_b128 a[120:123], v76 offset:39040
    ds_read_b128 a[124:127], v77 offset:39040
    ds_read_b64_tr_b16 a[0:1], v20 offset:39040
    ds_read_b64_tr_b16 a[2:3], v20 offset:39552
    ds_read_b64_tr_b16 a[4:5], v21 offset:39040
    ds_read_b64_tr_b16 a[6:7], v21 offset:39552
    ds_read_b64_tr_b16 a[8:9], v22 offset:39040
    ds_read_b64_tr_b16 a[10:11], v22 offset:39552
    ds_read_b64_tr_b16 a[12:13], v23 offset:39040
    ds_read_b64_tr_b16 a[14:15], v23 offset:39552
    ds_read_b64_tr_b16 a[16:17], v20 offset:47232
    ds_read_b64_tr_b16 a[18:19], v20 offset:47744
    ds_read_b64_tr_b16 a[20:21], v21 offset:47232
    ds_read_b64_tr_b16 a[22:23], v21 offset:47744
    ds_read_b64_tr_b16 a[24:25], v22 offset:47232
    ds_read_b64_tr_b16 a[26:27], v22 offset:47744
    s_waitcnt lgkmcnt(12)
    v_mfma_f32_16x16x32_bf16 v[28:31], a[0:3], a[120:123], v[28:31]
    ds_read_b64_tr_b16 a[28:29], v23 offset:47232
    ds_read_b64_tr_b16 a[30:31], v23 offset:47744
    s_waitcnt lgkmcnt(12)
    v_mfma_f32_16x16x32_bf16 v[32:35], a[4:7], a[120:123], v[32:35]
    ds_read_b64_tr_b16 a[48:49], v20 offset:43136
    ds_read_b64_tr_b16 a[50:51], v20 offset:43648
    s_waitcnt lgkmcnt(12)
    v_mfma_f32_16x16x32_bf16 v[36:39], a[8:11], a[120:123], v[36:39]
    ds_read_b64_tr_b16 a[52:53], v21 offset:43136
    ds_read_b64_tr_b16 a[54:55], v21 offset:43648
    s_waitcnt lgkmcnt(12)
    v_mfma_f32_16x16x32_bf16 v[40:43], a[12:15], a[120:123], v[40:43]
    ds_read_b64_tr_b16 a[56:57], v22 offset:43136
    ds_read_b64_tr_b16 a[58:59], v22 offset:43648
    s_waitcnt lgkmcnt(12)
    v_mfma_f32_16x16x32_bf16 v[44:47], a[16:19], a[120:123], v[44:47]
    ds_read_b64_tr_b16 a[60:61], v23 offset:43136
    ds_read_b64_tr_b16 a[62:63], v23 offset:43648
    s_waitcnt lgkmcnt(12)
    v_mfma_f32_16x16x32_bf16 v[48:51], a[20:23], a[120:123], v[48:51]
    ds_read_b64_tr_b16 a[64:65], v20 offset:51328
    ds_read_b64_tr_b16 a[66:67], v20 offset:51840
    s_waitcnt lgkmcnt(12)
    v_mfma_f32_16x16x32_bf16 v[52:55], a[24:27], a[120:123], v[52:55]
    ds_read_b64_tr_b16 a[68:69], v21 offset:51328
    ds_read_b64_tr_b16 a[70:71], v21 offset:51840
    s_waitcnt lgkmcnt(12)
    v_mfma_f32_16x16x32_bf16 v[56:59], a[28:31], a[120:123], v[56:59]
    ds_read_b64_tr_b16 a[72:73], v22 offset:51328
    ds_read_b64_tr_b16 a[74:75], v22 offset:51840
    s_waitcnt lgkmcnt(12)
    v_mfma_f32_16x16x32_bf16 v[28:31], a[48:51], a[124:127], v[28:31]
    ds_read_b64_tr_b16 a[76:77], v23 offset:51328
    ds_read_b64_tr_b16 a[78:79], v23 offset:51840
    s_waitcnt lgkmcnt(12)
    v_mfma_f32_16x16x32_bf16 v[32:35], a[52:55], a[124:127], v[32:35]
    s_waitcnt lgkmcnt(10)
    v_mfma_f32_16x16x32_bf16 v[36:39], a[56:59], a[124:127], v[36:39]
    s_waitcnt lgkmcnt(8)
    v_mfma_f32_16x16x32_bf16 v[40:43], a[60:63], a[124:127], v[40:43]
    s_waitcnt lgkmcnt(6)
    v_mfma_f32_16x16x32_bf16 v[44:47], a[64:67], a[124:127], v[44:47]
    s_waitcnt lgkmcnt(4)
    v_mfma_f32_16x16x32_bf16 v[48:51], a[68:71], a[124:127], v[48:51]
    s_waitcnt lgkmcnt(2)
    v_mfma_f32_16x16x32_bf16 v[52:55], a[72:75], a[124:127], v[52:55]
    s_waitcnt lgkmcnt(0)
    v_mfma_f32_16x16x32_bf16 v[56:59], a[76:79], a[124:127], v[56:59]
    s_mov_b32 exec_lo, 0x00010001
    s_mov_b32 exec_hi, 0x00010001
    ds_write_b128 v6, v[28:31] offset:0
    ds_write_b128 v6, v[32:35] offset:64
    ds_write_b128 v6, v[36:39] offset:128
    ds_write_b128 v6, v[40:43] offset:192
    ds_write_b128 v6, v[44:47] offset:256
    ds_write_b128 v6, v[48:51] offset:320
    ds_write_b128 v6, v[52:55] offset:384
    ds_write_b128 v6, v[56:59] offset:448
    ds_write_b32 v7, v7
    s_mov_b64 exec, -1
    ds_read_b128 v[76:79], v6 offset:256
    ds_read_b128 v[80:83], v6 offset:320
    ds_read_b128 v[84:87], v6 offset:384
    ds_read_b128 v[88:91], v6 offset:448
    s_waitcnt lgkmcnt(0)
    v_fmac_f32 v44, v76, v120
    v_fmac_f32 v45, v77, v120
    v_fmac_f32 v46, v78, v120
    v_fmac_f32 v47, v79, v120
    v_cvt_pk_bf16_f32 v44, v44, v45
    v_cvt_pk_bf16_f32 v45, v46, v47
    v_fmac_f32 v48, v80, v120
    v_fmac_f32 v49, v81, v120
    v_fmac_f32 v50, v82, v120
    v_fmac_f32 v51, v83, v120
    v_cvt_pk_bf16_f32 v46, v48, v49
    v_cvt_pk_bf16_f32 v47, v50, v51
    v_fmac_f32 v52, v84, v120
    v_fmac_f32 v53, v85, v120
    v_fmac_f32 v54, v86, v120
    v_fmac_f32 v55, v87, v120
    v_cvt_pk_bf16_f32 v48, v52, v53
    v_cvt_pk_bf16_f32 v49, v54, v55
    v_fmac_f32 v56, v88, v120
    v_fmac_f32 v57, v89, v120
    v_fmac_f32 v58, v90, v120
    v_fmac_f32 v59, v91, v120
    v_cvt_pk_bf16_f32 v50, v56, v57
    v_cvt_pk_bf16_f32 v51, v58, v59
    ds_write_b128 v125, v[44:47] offset:4096
    ds_write_b128 v125, v[48:51] offset:5120
    v_mov_b32 v5, 157972
    v_mov_b32 v6, 1
    s_mov_b64 exec, 1
    ds_add_u32 v5, v6
    s_mov_b64 exec, -1
    v_mov_b32 v5, 157980
Lcw_5:
    s_sub_u32 s39, s39, 1
    s_cbranch_scc1 Lend
    ds_read_b32 v6, v5
    s_waitcnt lgkmcnt(0)
    v_readfirstlane_b32 s42, v6
    s_nop 0
    s_cmp_lt_u32 s42, 1
    s_cbranch_scc1 Lcw_5
    ds_read_b64_tr_b16 a[0:1], v24 offset:16384
    ds_read_b64_tr_b16 a[2:3], v24 offset:16896
    ds_read_b64_tr_b16 a[4:5], v25 offset:16384
    ds_read_b64_tr_b16 a[6:7], v25 offset:16896
    ds_read_b64_tr_b16 a[8:9], v26 offset:16384
    ds_read_b64_tr_b16 a[10:11], v26 offset:16896
    ds_read_b64_tr_b16 a[12:13], v27 offset:16384
    ds_read_b64_tr_b16 a[14:15], v27 offset:16896
    ds_read_b64_tr_b16 a[16:17], v24 offset:20480
    ds_read_b64_tr_b16 a[18:19], v24 offset:20992
    ds_read_b64_tr_b16 a[20:21], v25 offset:20480
    ds_read_b64_tr_b16 a[22:23], v25 offset:20992
    ds_read_b64_tr_b16 a[24:25], v26 offset:20480
    ds_read_b64_tr_b16 a[26:27], v26 offset:20992
    ds_read_b64_tr_b16 a[28:29], v27 offset:20480
    ds_read_b64_tr_b16 a[30:31], v27 offset:20992
    ds_read_b64_tr_b16 a[32:33], v24 offset:55424
    ds_read_b64_tr_b16 a[34:35], v24 offset:55936
    ds_read_b64_tr_b16 a[36:37], v25 offset:55424
    ds_read_b64_tr_b16 a[38:39], v25 offset:55936
    ds_read_b64_tr_b16 a[40:41], v26 offset:55424
    ds_read_b64_tr_b16 a[42:43], v26 offset:55936
    ds_read_b64_tr_b16 a[44:45], v27 offset:55424
    ds_read_b64_tr_b16 a[46:47], v27 offset:55936
    ds_read_b64_tr_b16 a[48:49], v24 offset:59520
    ds_read_b64_tr_b16 a[50:51], v24 offset:60032
    ds_read_b64_tr_b16 a[52:53], v25 offset:59520
    ds_read_b64_tr_b16 a[54:55], v25 offset:60032
    ds_read_b64_tr_b16 a[56:57], v26 offset:59520
    ds_read_b64_tr_b16 a[58:59], v26 offset:60032
    ds_read_b64_tr_b16 a[60:61], v27 offset:59520
    ds_read_b64_tr_b16 a[62:63], v27 offset:60032
    ds_read_b64_tr_b16 a[64:65], v20 offset:16384
    ds_read_b64_tr_b16 a[66:67], v20 offset:16896
    ds_read_b64_tr_b16 a[68:69], v21 offset:16384
    ds_read_b64_tr_b16 a[70:71], v21 offset:16896
    ds_read_b64_tr_b16 a[72:73], v22 offset:16384
    ds_read_b64_tr_b16 a[74:75], v22 offset:16896
    ds_read_b64_tr_b16 a[76:77], v23 offset:16384
    ds_read_b64_tr_b16 a[78:79], v23 offset:16896
    ds_read_b64_tr_b16 a[80:81], v20 offset:20480
    ds_read_b64_tr_b16 a[82:83], v20 offset:20992
    ds_read_b64_tr_b16 a[84:85], v21 offset:20480
    ds_read_b64_tr_b16 a[86:87], v21 offset:20992
    ds_read_b64_tr_b16 a[88:89], v22 offset:20480
    ds_read_b64_tr_b16 a[90:91], v22 offset:20992
    ds_read_b64_tr_b16 a[92:93], v23 offset:20480
    ds_read_b64_tr_b16 a[94:95], v23 offset:20992
    s_waitcnt lgkmcnt(15)
    v_mfma_f32_16x16x32_bf16 v[60:63], a[96:99], a[0:3], v[60:63]
    v_mfma_f32_16x16x32_bf16 v[64:67], a[96:99], a[4:7], v[64:67]
    v_mfma_f32_16x16x32_bf16 v[68:71], a[96:99], a[8:11], v[68:71]
    v_mfma_f32_16x16x32_bf16 v[72:75], a[96:99], a[12:15], v[72:75]
    ds_read_b64_tr_b16 a[0:1], v20 offset:55424
    ds_read_b64_tr_b16 a[2:3], v20 offset:55936
    ds_read_b64_tr_b16 a[4:5], v21 offset:55424
    ds_read_b64_tr_b16 a[6:7], v21 offset:55936
    ds_read_b64_tr_b16 a[8:9], v22 offset:55424
    ds_read_b64_tr_b16 a[10:11], v22 offset:55936
    ds_read_b64_tr_b16 a[12:13], v23 offset:55424
    ds_read_b64_tr_b16 a[14:15], v23 offset:55936
    v_mfma_f32_16x16x32_bf16 v[60:63], a[100:103], a[16:19], v[60:63]
    v_mfma_f32_16x16x32_bf16 v[64:67], a[100:103], a[20:23], v[64:67]
    v_mfma_f32_16x16x32_bf16 v[68:71], a[100:103], a[24:27], v[68:71]
    v_mfma_f32_16x16x32_bf16 v[72:75], a[100:103], a[28:31], v[72:75]
    ds_read_b64_tr_b16 a[16:17], v20 offset:59520
    ds_read_b64_tr_b16 a[18:19], v20 offset:60032
    ds_read_b64_tr_b16 a[20:21], v21 offset:59520
    ds_read_b64_tr_b16 a[22:23], v21 offset:60032
    ds_read_b64_tr_b16 a[24:25], v22 offset:59520
    ds_read_b64_tr_b16 a[26:27], v22 offset:60032
    ds_read_b64_tr_b16 a[28:29], v23 offset:59520
    ds_read_b64_tr_b16 a[30:31], v23 offset:60032
    v_mfma_f32_16x16x32_bf16 v[60:63], a[104:107], a[32:35], v[60:63]
    v_mfma_f32_16x16x32_bf16 v[64:67], a[104:107], a[36:39], v[64:67]
    v_mfma_f32_16x16x32_bf16 v[68:71], a[104:107], a[40:43], v[68:71]
    v_mfma_f32_16x16x32_bf16 v[72:75], a[104:107], a[44:47], v[72:75]
    v_mfma_f32_16x16x32_bf16 v[60:63], a[108:111], a[48:51], v[60:63]
    v_mfma_f32_16x16x32_bf16 v[64:67], a[108:111], a[52:55], v[64:67]
    v_mfma_f32_16x16x32_bf16 v[68:71], a[108:111], a[56:59], v[68:71]
    v_mfma_f32_16x16x32_bf16 v[72:75], a[108:111], a[60:63], v[72:75]
    s_waitcnt lgkmcnt(15)
    v_mfma_f32_16x16x32_bf16 v[60:63], a[112:115], a[64:67], v[60:63]
    v_mfma_f32_16x16x32_bf16 v[64:67], a[112:115], a[68:71], v[64:67]
    v_mfma_f32_16x16x32_bf16 v[68:71], a[112:115], a[72:75], v[68:71]
    v_mfma_f32_16x16x32_bf16 v[72:75], a[112:115], a[76:79], v[72:75]
    v_mfma_f32_16x16x32_bf16 v[60:63], a[116:119], a[80:83], v[60:63]
    v_mfma_f32_16x16x32_bf16 v[64:67], a[116:119], a[84:87], v[64:67]
    v_mfma_f32_16x16x32_bf16 v[68:71], a[116:119], a[88:91], v[68:71]
    v_mfma_f32_16x16x32_bf16 v[72:75], a[116:119], a[92:95], v[72:75]
    s_waitcnt lgkmcnt(8)
    v_mfma_f32_16x16x32_bf16 v[60:63], a[120:123], a[0:3], v[60:63]
    v_mfma_f32_16x16x32_bf16 v[64:67], a[120:123], a[4:7], v[64:67]
    v_mfma_f32_16x16x32_bf16 v[68:71], a[120:123], a[8:11], v[68:71]
    v_mfma_f32_16x16x32_bf16 v[72:75], a[120:123], a[12:15], v[72:75]
    s_waitcnt lgkmcnt(0)
    v_mfma_f32_16x16x32_bf16 v[60:63], a[124:127], a[16:19], v[60:63]
    v_mfma_f32_16x16x32_bf16 v[64:67], a[124:127], a[20:23], v[64:67]
    v_mfma_f32_16x16x32_bf16 v[68:71], a[124:127], a[24:27], v[68:71]
    v_mfma_f32_16x16x32_bf16 v[72:75], a[124:127], a[28:31], v[72:75]
    v_lshlrev_b32 v5, 4, v3
    v_add_u32 v5, 157696, v5
    v_mov_b32 v6, 157952
    v_lshlrev_b32 v4, 4, v2
    v_add_u32 v4, 156224, v4
    v_lshl_add_u32 v125, v1, 3, s52
    s_mov_b64 exec, 0xffff
    ds_write_b32 v5, v60 offset:0
    ds_write_b32 v5, v64 offset:4
    ds_write_b32 v5, v68 offset:8
    ds_write_b32 v5, v72 offset:12
    ds_write_b32 v6, v6
    s_mov_b64 exec, -1
    ds_read_b128 v[36:39], v5
    ds_read_b128 v[28:31], v4
    ds_read_b128 v[32:35], v4 offset:512
    s_waitcnt lgkmcnt(0)
    v_fmac_f32 v60, v28, v36
    v_fmac_f32 v61, v29, v36
    v_fmac_f32 v62, v30, v36
    v_fmac_f32 v63, v31, v36
    v_mul_f32 v60, v60, v32
    v_mul_f32 v61, v61, v33
    v_mul_f32 v62, v62, v34
    v_mul_f32 v63, v63, v35
    v_cvt_pk_bf16_f32 v60, v60, v61
    v_cvt_pk_bf16_f32 v61, v62, v63
    ds_write_b64 v125, v[60:61] offset:0
    v_fmac_f32 v64, v28, v37
    v_fmac_f32 v65, v29, v37
    v_fmac_f32 v66, v30, v37
    v_fmac_f32 v67, v31, v37
    v_mul_f32 v64, v64, v32
    v_mul_f32 v65, v65, v33
    v_mul_f32 v66, v66, v34
    v_mul_f32 v67, v67, v35
    v_cvt_pk_bf16_f32 v64, v64, v65
    v_cvt_pk_bf16_f32 v65, v66, v67
    ds_write_b64 v125, v[64:65] offset:512
    v_fmac_f32 v68, v28, v38
    v_fmac_f32 v69, v29, v38
    v_fmac_f32 v70, v30, v38
    v_fmac_f32 v71, v31, v38
    v_mul_f32 v68, v68, v32
    v_mul_f32 v69, v69, v33
    v_mul_f32 v70, v70, v34
    v_mul_f32 v71, v71, v35
    v_cvt_pk_bf16_f32 v68, v68, v69
    v_cvt_pk_bf16_f32 v69, v70, v71
    ds_write_b64 v125, v[68:69] offset:1024
    v_fmac_f32 v72, v28, v39
    v_fmac_f32 v73, v29, v39
    v_fmac_f32 v74, v30, v39
    v_fmac_f32 v75, v31, v39
    v_mul_f32 v72, v72, v32
    v_mul_f32 v73, v73, v33
    v_mul_f32 v74, v74, v34
    v_mul_f32 v75, v75, v35
    v_cvt_pk_bf16_f32 v72, v72, v73
    v_cvt_pk_bf16_f32 v73, v74, v75
    ds_write_b64 v125, v[72:73] offset:1536
    v_mov_b32 v8, 157976
    v_mov_b32 v9, 1
    s_mov_b64 exec, 1
    ds_add_u32 v8, v9
    s_mov_b64 exec, -1
    s_endpgm
Lst_re:
    s_sub_u32 s39, s39, 1
    s_cbranch_scc1 Lend
    buffer_load_dwordx2 v[92:93], v96, s[28:31], s53 offen sc1
    buffer_load_dwordx2 v[94:95], v97, s[28:31], s53 offen sc1
    s_waitcnt vmcnt(0)
    s_branch Lst_chk
Laux:
    s_mul_i32 s36, s40, 9
    s_lshl_b32 s42, s42, 2
    s_add_u32 s36, s36, s42
    s_add_u32 s36, s36, s41
    s_cmp_ge_u32 s36, 32
    s_cbranch_scc1 Lmst
    v_lshrrev_b32 v5, 3, v1
    v_and_b32 v6, 7, v1
    s_lshl_b32 s44, s3, 14
    s_cmp_eq_u32 s27, 0
    s_cbranch_scc0 Laux_u
    s_lshl_b32 s40, s36, 6
    s_lshl_b32 s41, s26, 4
    s_add_u32 s40, s40, s41
    v_add_u32 v7, s40, v5
    v_mul_u32_u24 v7, 1280, v7
    v_xor_b32 v8, v6, v2
    v_lshl_add_u32 v92, v8, 4, v7
    v_add_u32 v92, 4096, v92
    v_xor_b32 v93, 64, v92
    v_add_u32 v93, 9216, v93
    v_subrev_u32 v94, 1920, v92
    v_subrev_u32 v95, 1920, v93
    s_waitcnt lgkmcnt(0)
    s_sub_u32 s56, s4, 4096
    s_subb_u32 s57, s5, 0
    s_mov_b32 s58, 2625536
    s_mov_b32 s59, 0x20000
    s_mov_b64 s[64:65], s[12:13]
    s_mov_b32 s66, 1280
    s_mov_b32 s67, 0x20000
    s_mov_b32 m0, 131072
    s_nop 0
    buffer_load_dwordx4 v13, s[64:67], 0 offen lds
    s_mov_b64 exec, 0xffff
    buffer_load_dwordx4 v13, s[64:67], 0 offen offset:1024 lds
    s_mov_b64 exec, -1
    s_add_u32 m0, s44, 0
    s_mov_b32 s45, 0
    buffer_load_dwordx4 v92, s[56:59], s45 offen lds
    buffer_load_dwordx4 v93, s[56:59], s45 offen offset:1024 lds
    buffer_load_dwordx4 v94, s[56:59], s45 offen offset:2048 lds
    buffer_load_dwordx4 v95, s[56:59], s45 offen offset:3072 lds
    s_add_u32 m0, s44, 4096
    s_mov_b32 s45, 256
    buffer_load_dwordx4 v92, s[56:59], s45 offen lds
    buffer_load_dwordx4 v93, s[56:59], s45 offen offset:1024 lds
    buffer_load_dwordx4 v94, s[56:59], s45 offen offset:2048 lds
    buffer_load_dwordx4 v95, s[56:59], s45 offen offset:3072 lds
    s_add_u32 m0, s44, 8192
    s_mov_b32 s45, 512
    buffer_load_dwordx4 v92, s[56:59], s45 offen lds
    buffer_load_dwordx4 v93, s[56:59], s45 offen offset:1024 lds
    buffer_load_dwordx4 v94, s[56:59], s45 offen offset:2048 lds
    buffer_load_dwordx4 v95, s[56:59], s45 offen offset:3072 lds
    s_add_u32 m0, s44, 12288
    s_mov_b32 s45, 768
    buffer_load_dwordx4 v92, s[56:59], s45 offen lds
    buffer_load_dwordx4 v93, s[56:59], s45 offen offset:1024 lds
    buffer_load_dwordx4 v94, s[56:59], s45 offen offset:2048 lds
    buffer_load_dwordx4 v95, s[56:59], s45 offen offset:3072 lds
    s_mov_b64 s[28:29], s[24:25]
    s_mov_b32 s30, 268435456
    s_mov_b32 s31, 0x20000
    s_mov_b64 s[32:33], s[22:23]
    s_mov_b32 s34, 256
    s_mov_b32 s35, 0x20000
    s_load_dword s38, s[28:29], 0
    s_mov_b64 s[48:49], s[14:15]
    s_mov_b32 s50, 2211840
    s_mov_b32 s51, 0x20000
    s_mov_b64 s[52:53], s[18:19]
    s_mov_b32 s54, 2211840
    s_mov_b32 s55, 0x20000
    v_and_b32 v8, 1, v2
    v_lshlrev_b32 v8, 1, v8
    v_xor_b32 v8, v8, v6
    v_lshlrev_b32 v8, 4, v8
    v_mul_u32_u24 v9, 3456, v5
    s_lshl_b32 s42, s36, 7
    v_add3_u32 v18, v9, v8, s42
    v_xor_b32 v19, 64, v18
    v_add_u32 v19, 26624, v19
    v_add_u32 v20, 53248, v18
    v_add_u32 v21, 53248, v19
    s_mul_i32 s46, s26, 110592
    v_mul_u32_u24 v9, 1280, v5
    v_add_u32 v22, v9, v8
    v_xor_b32 v23, 64, v22
    v_add_u32 v23, 9216, v23
    v_add_u32 v24, 18432, v22
    v_add_u32 v25, 18432, v23
    s_mul_i32 s47, s36, 81920
    s_lshl_b32 s42, s3, 7
    s_add_u32 s47, s47, s42
    s_lshl_b32 s62, s2, 7
    s_add_u32 s62, s62, 8257536
    v_mov_b32 v96, 0x3f803f80
    v_mov_b32 v97, 0x3f803f80
    v_mov_b32 v98, 0x3f803f80
    v_mov_b32 v99, 0x3f803f80
    v_lshlrev_b32 v100, 4, v2
    v_add_u32 v100, 131072, v100
    v_lshrrev_b32 v10, 1, v3
    v_xor_b32 v10, v10, v2
    v_lshlrev_b32 v10, 4, v10
    v_lshl_add_u32 v10, v3, 7, v10
    v_add_u32 v102, s44, v10
    v_xor_b32 v103, 64, v102
    s_mov_b32 s68, 0xaaaaaaaa
    s_mov_b32 s69, 0xaaaaaaaa
    s_mov_b32 s70, 0xcccccccc
    s_mov_b32 s71, 0xcccccccc
    v_lshrrev_b32 v101, 2, v3
    v_lshl_add_u32 v101, v101, 4, v3
    v_lshlrev_b32 v101, 2, v101
    v_bfe_u32 v10, v1, 2, 2
    v_and_b32 v8, 3, v1
    v_lshl_add_u32 v14, v2, 3, v10
    v_lshlrev_b32 v14, 7, v14
    v_lshlrev_b32 v9, 2, v1
    v_and_b32 v9, 0x60, v9
    v_add3_u32 v14, v14, v9, s44
    v_lshl_add_u32 v14, v8, 3, v14
    v_xor_b32 v15, 32, v14
    v_xor_b32 v16, 64, v14
    v_xor_b32 v17, 96, v14
    s_lshl_b32 s40, s26, 6
    s_add_u32 s40, s40, 4096
    v_lshl_add_u32 v26, v2, 4, s40
    s_waitcnt lgkmcnt(0)
    s_add_u32 s38, s38, 0x9e3779b8
    s_or_b32 s38, s38, 1
    s_waitcnt vmcnt(12)
    ds_read_b128 a[80:83], v102 offset:0
    ds_read_b128 a[84:87], v100 offset:0
    ds_read_b128 a[88:91], v103 offset:0
    ds_read_b128 a[92:95], v100 offset:64
    ds_read_b128 a[96:99], v102 offset:2048
    ds_read_b128 a[100:103], v100 offset:128
    ds_read_b128 a[104:107], v103 offset:2048
    ds_read_b128 a[108:111], v100 offset:192
    s_waitcnt lgkmcnt(0)
    s_add_u32 m0, s44, 0
    s_mov_b32 s45, 1024
    buffer_load_dwordx4 v92, s[56:59], s45 offen lds
    buffer_load_dwordx4 v93, s[56:59], s45 offen offset:1024 lds
    buffer_load_dwordx4 v94, s[56:59], s45 offen offset:2048 lds
    buffer_load_dwordx4 v95, s[56:59], s45 offen offset:3072 lds
    s_barrier
    v_mfma_f32_16x16x32_bf16 v[116:119], a[80:83], a[80:83], 0
    v_mfma_f32_16x16x32_bf16 v[112:115], v[96:99], a[80:83], 0
    v_mfma_f32_16x16x32_bf16 v[120:123], a[84:87], a[80:83], 0
    v_mfma_f32_16x16x32_bf16 v[124:127], a[84:87], v[96:99], 0
    v_mfma_f32_16x16x32_bf16 v[116:119], a[88:91], a[88:91], v[116:119]
    v_mfma_f32_16x16x32_bf16 v[112:115], v[96:99], a[88:91], v[112:115]
    v_mfma_f32_16x16x32_bf16 v[120:123], a[92:95], a[88:91], v[120:123]
    v_mfma_f32_16x16x32_bf16 v[124:127], a[92:95], v[96:99], v[124:127]
    v_mfma_f32_16x16x32_bf16 v[116:119], a[96:99], a[96:99], v[116:119]
    v_mfma_f32_16x16x32_bf16 v[112:115], v[96:99], a[96:99], v[112:115]
    v_mfma_f32_16x16x32_bf16 v[120:123], a[100:103], a[96:99], v[120:123]
    v_mfma_f32_16x16x32_bf16 v[124:127], a[100:103], v[96:99], v[124:127]
    v_mfma_f32_16x16x32_bf16 v[116:119], a[104:107], a[104:107], v[116:119]
    v_mfma_f32_16x16x32_bf16 v[112:115], v[96:99], a[104:107], v[112:115]
    v_mfma_f32_16x16x32_bf16 v[120:123], a[108:111], a[104:107], v[120:123]
    v_mfma_f32_16x16x32_bf16 v[124:127], a[108:111], v[96:99], v[124:127]
    s_waitcnt vmcnt(12)
    ds_read_b128 a[80:83], v102 offset:4096
    ds_read_b128 a[84:87], v100 offset:256
    ds_read_b128 a[88:91], v103 offset:4096
    ds_read_b128 a[92:95], v100 offset:320
    ds_read_b128 a[96:99], v102 offset:6144
    ds_read_b128 a[100:103], v100 offset:384
    ds_read_b128 a[104:107], v103 offset:6144
    ds_read_b128 a[108:111], v100 offset:448
    s_waitcnt lgkmcnt(0)
    v_mfma_f32_16x16x32_bf16 v[116:119], a[80:83], a[80:83], v[116:119]
    v_mfma_f32_16x16x32_bf16 v[112:115], v[96:99], a[80:83], v[112:115]
    v_mfma_f32_16x16x32_bf16 v[120:123], a[84:87], a[80:83], v[120:123]
    v_mfma_f32_16x16x32_bf16 v[124:127], a[84:87], v[96:99], v[124:127]
    v_mfma_f32_16x16x32_bf16 v[116:119], a[88:91], a[88:91], v[116:119]
    v_mfma_f32_16x16x32_bf16 v[112:115], v[96:99], a[88:91], v[112:115]
    v_mfma_f32_16x16x32_bf16 v[120:123], a[92:95], a[88:91], v[120:123]
    v_mfma_f32_16x16x32_bf16 v[124:127], a[92:95], v[96:99], v[124:127]
    v_mfma_f32_16x16x32_bf16 v[116:119], a[96:99], a[96:99], v[116:119]
    v_mfma_f32_16x16x32_bf16 v[112:115], v[96:99], a[96:99], v[112:115]
    v_mfma_f32_16x16x32_bf16 v[120:123], a[100:103], a[96:99], v[120:123]
    v_mfma_f32_16x16x32_bf16 v[124:127], a[100:103], v[96:99], v[124:127]
    v_mfma_f32_16x16x32_bf16 v[116:119], a[104:107], a[104:107], v[116:119]
    v_mfma_f32_16x16x32_bf16 v[112:115], v[96:99], a[104:107], v[112:115]
    v_mfma_f32_16x16x32_bf16 v[120:123], a[108:111], a[104:107], v[120:123]
    v_mfma_f32_16x16x32_bf16 v[124:127], a[108:111], v[96:99], v[124:127]
    s_waitcnt vmcnt(8)
    ds_read_b128 a[80:83], v102 offset:8192
    ds_read_b128 a[84:87], v100 offset:512
    ds_read_b128 a[88:91], v103 offset:8192
    ds_read_b128 a[92:95], v100 offset:576
    ds_read_b128 a[96:99], v102 offset:10240
    ds_read_b128 a[100:103], v100 offset:640
    ds_read_b128 a[104:107], v103 offset:10240
    ds_read_b128 a[108:111], v100 offset:704
    s_waitcnt lgkmcnt(0)
    v_mfma_f32_16x16x32_bf16 v[116:119], a[80:83], a[80:83], v[116:119]
    v_mfma_f32_16x16x32_bf16 v[112:115], v[96:99], a[80:83], v[112:115]
    v_mfma_f32_16x16x32_bf16 v[120:123], a[84:87], a[80:83], v[120:123]
    v_mfma_f32_16x16x32_bf16 v[124:127], a[84:87], v[96:99], v[124:127]
    v_mfma_f32_16x16x32_bf16 v[116:119], a[88:91], a[88:91], v[116:119]
    v_mfma_f32_16x16x32_bf16 v[112:115], v[96:99], a[88:91], v[112:115]
    v_mfma_f32_16x16x32_bf16 v[120:123], a[92:95], a[88:91], v[120:123]
    v_mfma_f32_16x16x32_bf16 v[124:127], a[92:95], v[96:99], v[124:127]
    v_mfma_f32_16x16x32_bf16 v[116:119], a[96:99], a[96:99], v[116:119]
    v_mfma_f32_16x16x32_bf16 v[112:115], v[96:99], a[96:99], v[112:115]
    v_mfma_f32_16x16x32_bf16 v[120:123], a[100:103], a[96:99], v[120:123]
    v_mfma_f32_16x16x32_bf16 v[124:127], a[100:103], v[96:99], v[124:127]
    v_mfma_f32_16x16x32_bf16 v[116:119], a[104:107], a[104:107], v[116:119]
    v_mfma_f32_16x16x32_bf16 v[112:115], v[96:99], a[104:107], v[112:115]
    v_mfma_f32_16x16x32_bf16 v[120:123], a[108:111], a[104:107], v[120:123]
    v_mfma_f32_16x16x32_bf16 v[124:127], a[108:111], v[96:99], v[124:127]
    s_waitcnt vmcnt(4)
    ds_read_b128 a[80:83], v102 offset:12288
    ds_read_b128 a[84:87], v100 offset:768
    ds_read_b128 a[88:91], v103 offset:12288
    ds_read_b128 a[92:95], v100 offset:832
    ds_read_b128 a[96:99], v102 offset:14336
    ds_read_b128 a[100:103], v100 offset:896
    ds_read_b128 a[104:107], v103 offset:14336
    ds_read_b128 a[108:111], v100 offset:960
    s_waitcnt lgkmcnt(0)
    v_mfma_f32_16x16x32_bf16 v[116:119], a[80:83], a[80:83], v[116:119]
    v_mfma_f32_16x16x32_bf16 v[112:115], v[96:99], a[80:83], v[112:115]
    v_mfma_f32_16x16x32_bf16 v[120:123], a[84:87], a[80:83], v[120:123]
    v_mfma_f32_16x16x32_bf16 v[124:127], a[84:87], v[96:99], v[124:127]
    v_mfma_f32_16x16x32_bf16 v[116:119], a[88:91], a[88:91], v[116:119]
    v_mfma_f32_16x16x32_bf16 v[112:115], v[96:99], a[88:91], v[112:115]
    v_mfma_f32_16x16x32_bf16 v[120:123], a[92:95], a[88:91], v[120:123]
    v_mfma_f32_16x16x32_bf16 v[124:127], a[92:95], v[96:99], v[124:127]
    v_mfma_f32_16x16x32_bf16 v[116:119], a[96:99], a[96:99], v[116:119]
    v_mfma_f32_16x16x32_bf16 v[112:115], v[96:99], a[96:99], v[112:115]
    v_mfma_f32_16x16x32_bf16 v[120:123], a[100:103], a[96:99], v[120:123]
    v_mfma_f32_16x16x32_bf16 v[124:127], a[100:103], v[96:99], v[124:127]
    v_mfma_f32_16x16x32_bf16 v[116:119], a[104:107], a[104:107], v[116:119]
    v_mfma_f32_16x16x32_bf16 v[112:115], v[96:99], a[104:107], v[112:115]
    v_mfma_f32_16x16x32_bf16 v[120:123], a[108:111], a[104:107], v[120:123]
    v_mfma_f32_16x16x32_bf16 v[124:127], a[108:111], v[96:99], v[124:127]
    s_waitcnt vmcnt(0)
    ds_read_b128 a[80:83], v102 offset:0
    ds_read_b128 a[84:87], v100 offset:1024
    ds_read_b128 a[88:91], v103 offset:0
    ds_read_b128 a[92:95], v100 offset:1088
    ds_read_b128 a[96:99], v102 offset:2048
    ds_read_b128 a[100:103], v100 offset:1152
    ds_read_b128 a[104:107], v103 offset:2048
    ds_read_b128 a[108:111], v100 offset:1216
    s_waitcnt lgkmcnt(0)
    v_mfma_f32_16x16x32_bf16 v[116:119], a[80:83], a[80:83], v[116:119]
    v_mfma_f32_16x16x32_bf16 v[112:115], v[96:99], a[80:83], v[112:115]
    v_mfma_f32_16x16x32_bf16 v[120:123], a[84:87], a[80:83], v[120:123]
    v_mfma_f32_16x16x32_bf16 v[124:127], a[84:87], v[96:99], v[124:127]
    v_mfma_f32_16x16x32_bf16 v[116:119], a[88:91], a[88:91], v[116:119]
    v_mfma_f32_16x16x32_bf16 v[112:115], v[96:99], a[88:91], v[112:115]
    v_mfma_f32_16x16x32_bf16 v[120:123], a[92:95], a[88:91], v[120:123]
    v_mfma_f32_16x16x32_bf16 v[124:127], a[92:95], v[96:99], v[124:127]
    v_mfma_f32_16x16x32_bf16 v[116:119], a[96:99], a[96:99], v[116:119]
    v_mfma_f32_16x16x32_bf16 v[112:115], v[96:99], a[96:99], v[112:115]
    v_mfma_f32_16x16x32_bf16 v[120:123], a[100:103], a[96:99], v[120:123]
    v_mfma_f32_16x16x32_bf16 v[124:127], a[100:103], v[96:99], v[124:127]
    v_mfma_f32_16x16x32_bf16 v[116:119], a[104:107], a[104:107], v[116:119]
    v_mfma_f32_16x16x32_bf16 v[112:115], v[96:99], a[104:107], v[112:115]
    v_mfma_f32_16x16x32_bf16 v[120:123], a[108:111], a[104:107], v[120:123]
    v_mfma_f32_16x16x32_bf16 v[124:127], a[108:111], v[96:99], v[124:127]
    s_nop 4
    v_cndmask_b32 v4, v116, v117, s[68:69]
    v_cndmask_b32 v5, v118, v119, s[68:69]
    v_cndmask_b32 v4, v4, v5, s[70:71]
    ds_bpermute_b32 v4, v101, v4
    v_mul_f32 v5, 0xbacccccd, v112
    v_cvt_pk_bf16_f32 v104, v5, v5
    v_lshlrev_b32 v104, 16, v104
    v_mul_f32 v5, v5, v5
    v_mov_b32 v6, 0x3acccccd
    s_waitcnt lgkmcnt(0)
    v_fma_f32 v4, v4, v6, -v5
    v_max_f32 v4, 0, v4
    v_cvt_pk_bf16_f32 v4, v4, v4
    v_lshlrev_b32 v4, 16, v4
    v_add_f32 v4, 0x3727c5ac, v4
    v_cvt_pk_bf16_f32 v4, v4, v4
    v_lshlrev_b32 v4, 16, v4
    v_sqrt_f32 v4, v4
    s_nop 0
    v_cvt_pk_bf16_f32 v4, v4, v4
    v_lshlrev_b32 v4, 16, v4
    v_rcp_f32 v105, v4
    v_lshrrev_b32 v8, 16, v4
    v_or_b32 v8, v8, v104
    v_mov_b32 v9, s38
    s_lshl_b32 s40, s36, 9
    s_lshl_b32 s41, s26, 7
    s_add_u32 s40, s40, s41
    s_add_u32 s40, s40, 8192000
    v_lshlrev_b32 v10, 3, v1
    s_mov_b64 exec, 0xffff
    buffer_store_dwordx2 v[8:9], v10, s[28:31], s40 offen sc1
    s_mov_b64 exec, -1
    v_fma_f32 v4, v104, v124, v120
    v_mul_f32 v4, v4, v105
    v_cvt_pk_bf16_f32 v4, v4, v4
    v_ashrrev_i32 v5, 31, v4
    v_or_b32 v5, 0x80000000, v5
    v_xor_b32 v4, v4, v5
    v_and_b32 v4, 0xffff0000, v4
    v_max_u32 v4, 0x10000, v4
    s_lshl_b32 s40, s26, 4
    v_add_u32 v5, s40, v3
    v_sub_u32 v6, 63, v5
    v_or_b32 v4, v4, v6
    v_lshlrev_b32 v5, 2, v5
    v_add_u32 v5, 132608, v5
    ds_write_b32 v5, v4
    s_waitcnt lgkmcnt(0)
    s_barrier
    s_cmp_lg_u32 s26, 0
    s_cbranch_scc1 Lpub_done
    s_setprio 3
    v_add_u32 v5, 132608, v12
    ds_read_b32 v6, v5
    s_waitcnt lgkmcnt(0)
    v_mov_b32 v4, v6
    s_nop 1
    v_max_u32_dpp v4, v4, v4 row_ror:8 row_mask:0xf bank_mask:0xf
    s_nop 1
    v_max_u32_dpp v4, v4, v4 row_ror:4 row_mask:0xf bank_mask:0xf
    s_nop 1
    v_max_u32_dpp v4, v4, v4 row_ror:2 row_mask:0xf bank_mask:0xf
    s_nop 1
    v_max_u32_dpp v4, v4, v4 row_ror:1 row_mask:0xf bank_mask:0xf
    s_nop 0
    v_readlane_b32 s63, v4, 0
    v_readlane_b32 s40, v4, 16
    v_readlane_b32 s41, v4, 32
    v_readlane_b32 s42, v4, 48
    s_max_u32 s63, s63, s40
    s_max_u32 s41, s41, s42
    s_max_u32 s63, s63, s41
    v_cmp_eq_u32 vcc, s63, v6
    s_nop 1
    v_cndmask_b32 v4, v6, 0, vcc
    s_nop 1
    v_max_u32_dpp v4, v4, v4 row_ror:8 row_mask:0xf bank_mask:0xf
    s_nop 1
    v_max_u32_dpp v4, v4, v4 row_ror:4 row_mask:0xf bank_mask:0xf
    s_nop 1
    v_max_u32_dpp v4, v4, v4 row_ror:2 row_mask:0xf bank_mask:0xf
    s_nop 1
    v_max_u32_dpp v4, v4, v4 row_ror:1 row_mask:0xf bank_mask:0xf
    s_nop 0
    v_readlane_b32 s72, v4, 0
    v_readlane_b32 s40, v4, 16
    v_readlane_b32 s41, v4, 32
    v_readlane_b32 s42, v4, 48
    s_max_u32 s72, s72, s40
    s_max_u32 s41, s41, s42
    s_max_u32 s72, s72, s41
    s_and_b32 s40, s63, 0xffff0000
    s_lshr_b32 s41, s72, 16
    s_or_b32 s40, s40, s41
    s_and_b32 s41, s63, 63
    s_and_b32 s42, s72, 63
    s_lshl_b32 s42, s42, 6
    s_or_b32 s41, s41, s42
    s_xor_b32 s41, s41, 0x8fff
    s_lshl_b32 s42, s36, 2
    s_lshl_b32 s43, s36, 1
    v_mov_b32 v4, s40
    v_mov_b32 v5, s41
    v_mov_b32 v6, s42
    v_mov_b32 v7, s43
    s_mov_b64 exec, 1
    buffer_store_dword v4, v6, s[32:35], 0 offen offset:64 sc1
    buffer_store_short v5, v7, s[32:35], 0 offen offset:192 sc1
    s_mov_b64 exec, -1
    s_mov_b64 exec, 1
    s_lshl_b32 s40, s2, 2
    s_add_u32 s40, s40, 8323072
    v_mov_b32 v4, s38
    v_mov_b32 v5, s40
    buffer_store_dword v4, v5, s[28:31], 0 offen sc1
    s_mov_b64 exec, -1
Lpub_done:
    s_cmp_ge_u32 s36, 27
    s_cbranch_scc1 Lend
    s_add_u32 m0, s44, 4096
    s_add_u32 s45, s46, 0
    buffer_load_dwordx4 v18, s[48:51], s45 offen nt lds
    buffer_load_dwordx4 v19, s[48:51], s45 offen offset:1024 nt lds
    buffer_load_dwordx4 v20, s[48:51], s45 offen offset:2048 nt lds
    buffer_load_dwordx4 v21, s[48:51], s45 offen offset:3072 nt lds
    s_add_u32 m0, s44, 8192
    s_add_u32 s45, s46, 442368
    buffer_load_dwordx4 v18, s[48:51], s45 offen nt lds
    buffer_load_dwordx4 v19, s[48:51], s45 offen offset:1024 nt lds
    buffer_load_dwordx4 v20, s[48:51], s45 offen offset:2048 nt lds
    buffer_load_dwordx4 v21, s[48:51], s45 offen offset:3072 nt lds
    s_add_u32 m0, s44, 12288
    s_add_u32 s45, s46, 884736
    buffer_load_dwordx4 v18, s[48:51], s45 offen nt lds
    buffer_load_dwordx4 v19, s[48:51], s45 offen offset:1024 nt lds
    buffer_load_dwordx4 v20, s[48:51], s45 offen offset:2048 nt lds
    buffer_load_dwordx4 v21, s[48:51], s45 offen offset:3072 nt lds
    s_add_u32 m0, s44, 0
    s_add_u32 s45, s46, 1327104
    buffer_load_dwordx4 v18, s[48:51], s45 offen nt lds
    buffer_load_dwordx4 v19, s[48:51], s45 offen offset:1024 nt lds
    buffer_load_dwordx4 v20, s[48:51], s45 offen offset:2048 nt lds
    buffer_load_dwordx4 v21, s[48:51], s45 offen offset:3072 nt lds
    s_waitcnt vmcnt(12)
    ds_read_b64_tr_b16 a[0:1], v14 offset:4096
    ds_read_b64_tr_b16 a[2:3], v14 offset:4608
    ds_read_b64_tr_b16 a[4:5], v15 offset:4096
    ds_read_b64_tr_b16 a[6:7], v15 offset:4608
    ds_read_b64_tr_b16 a[8:9], v16 offset:4096
    ds_read_b64_tr_b16 a[10:11], v16 offset:4608
    ds_read_b64_tr_b16 a[12:13], v17 offset:4096
    ds_read_b64_tr_b16 a[14:15], v17 offset:4608
    s_waitcnt lgkmcnt(0)
    s_add_u32 m0, s44, 4096
    s_add_u32 s45, s46, 1769472
    buffer_load_dwordx4 v18, s[48:51], s45 offen nt lds
    buffer_load_dwordx4 v19, s[48:51], s45 offen offset:1024 nt lds
    buffer_load_dwordx4 v20, s[48:51], s45 offen offset:2048 nt lds
    buffer_load_dwordx4 v21, s[48:51], s45 offen offset:3072 nt lds
    s_waitcnt vmcnt(12)
    ds_read_b64_tr_b16 a[16:17], v14 offset:8192
    ds_read_b64_tr_b16 a[18:19], v14 offset:8704
    ds_read_b64_tr_b16 a[20:21], v15 offset:8192
    ds_read_b64_tr_b16 a[22:23], v15 offset:8704
    ds_read_b64_tr_b16 a[24:25], v16 offset:8192
    ds_read_b64_tr_b16 a[26:27], v16 offset:8704
    ds_read_b64_tr_b16 a[28:29], v17 offset:8192
    ds_read_b64_tr_b16 a[30:31], v17 offset:8704
    buffer_load_dwordx4 v[112:115], off, s[28:31], s62 sc1
    s_waitcnt lgkmcnt(0)
    s_add_u32 m0, s44, 8192
    s_add_u32 s45, s47, 0
    buffer_load_dwordx4 v22, s[52:55], s45 offen nt lds
    buffer_load_dwordx4 v23, s[52:55], s45 offen offset:1024 nt lds
    buffer_load_dwordx4 v24, s[52:55], s45 offen offset:2048 nt lds
    buffer_load_dwordx4 v25, s[52:55], s45 offen offset:3072 nt lds
    s_waitcnt vmcnt(13)
    ds_read_b64_tr_b16 a[32:33], v14 offset:12288
    ds_read_b64_tr_b16 a[34:35], v14 offset:12800
    ds_read_b64_tr_b16 a[36:37], v15 offset:12288
    ds_read_b64_tr_b16 a[38:39], v15 offset:12800
    ds_read_b64_tr_b16 a[40:41], v16 offset:12288
    ds_read_b64_tr_b16 a[42:43], v16 offset:12800
    ds_read_b64_tr_b16 a[44:45], v17 offset:12288
    ds_read_b64_tr_b16 a[46:47], v17 offset:12800
    s_waitcnt lgkmcnt(0)
    s_add_u32 m0, s44, 12288
    s_add_u32 s45, s47, 40960
    buffer_load_dwordx4 v22, s[52:55], s45 offen nt lds
    buffer_load_dwordx4 v23, s[52:55], s45 offen offset:1024 nt lds
    buffer_load_dwordx4 v24, s[52:55], s45 offen offset:2048 nt lds
    buffer_load_dwordx4 v25, s[52:55], s45 offen offset:3072 nt lds
    s_waitcnt vmcnt(13)
    ds_read_b64_tr_b16 a[48:49], v14 offset:0
    ds_read_b64_tr_b16 a[50:51], v14 offset:512
    ds_read_b64_tr_b16 a[52:53], v15 offset:0
    ds_read_b64_tr_b16 a[54:55], v15 offset:512
    ds_read_b64_tr_b16 a[56:57], v16 offset:0
    ds_read_b64_tr_b16 a[58:59], v16 offset:512
    ds_read_b64_tr_b16 a[60:61], v17 offset:0
    ds_read_b64_tr_b16 a[62:63], v17 offset:512
    s_waitcnt vmcnt(9)
    ds_read_b64_tr_b16 a[64:65], v14 offset:4096
    ds_read_b64_tr_b16 a[66:67], v14 offset:4608
    ds_read_b64_tr_b16 a[68:69], v15 offset:4096
    ds_read_b64_tr_b16 a[70:71], v15 offset:4608
    ds_read_b64_tr_b16 a[72:73], v16 offset:4096
    ds_read_b64_tr_b16 a[74:75], v16 offset:4608
    ds_read_b64_tr_b16 a[76:77], v17 offset:4096
    ds_read_b64_tr_b16 a[78:79], v17 offset:4608
    s_waitcnt vmcnt(8)
Lbc0:
    v_readfirstlane_b32 s40, v112
    v_readfirstlane_b32 s42, v113
    v_readfirstlane_b32 s41, v114
    v_readfirstlane_b32 s43, v115
    s_cmp_eq_u32 s42, s38
    s_cselect_b32 s43, s43, s42
    s_cmp_eq_u32 s43, s38
    s_cbranch_scc1 Lbc_ok0
    s_sub_u32 s39, s39, 1
    s_cbranch_scc1 Lend
    buffer_load_dwordx4 v[112:115], off, s[28:31], s62 sc1
    s_waitcnt vmcnt(0)
    s_branch Lbc0
Lbc_ok0:
    s_and_b32 s40, s40, 0x7ff
    s_sub_u32 s40, 2047, s40
    s_and_b32 s41, s41, 0x7ff
    s_sub_u32 s41, 2047, s41
    v_mov_b32 v4, s40
    v_mov_b32 v5, s41
    s_mov_b32 vcc_lo, 0xaaaaaaaa
    s_mov_b32 vcc_hi, 0xaaaaaaaa
    v_cndmask_b32 v4, v4, v5, vcc
    v_lshlrev_b32 v118, 3, v4
    v_add_u32 v118, 8192000, v118
    v_mul_u32_u24 v4, 1280, v4
    v_add_u32 v4, v4, v26
    v_mov_b32 v92, 0x3f803f80
    v_mov_b32 v93, 0x3f803f80
    v_mov_b32 v94, 0x3f803f80
    v_mov_b32 v95, 0x3f803f80
    v_mov_b32 v96, 0x3f803f80
    v_mov_b32 v97, 0x3f803f80
    v_mov_b32 v98, 0x3f803f80
    v_mov_b32 v99, 0x3f803f80
    v_mov_b32 v100, 0x3f803f80
    v_mov_b32 v101, 0x3f803f80
    v_mov_b32 v102, 0x3f803f80
    v_mov_b32 v103, 0x3f803f80
    v_mov_b32 v104, 0x3f803f80
    v_mov_b32 v105, 0x3f803f80
    v_mov_b32 v106, 0x3f803f80
    v_mov_b32 v107, 0x3f803f80
    v_mov_b32 v108, 0x3f803f80
    v_mov_b32 v109, 0x3f803f80
    v_mov_b32 v110, 0x3f803f80
    v_mov_b32 v111, 0x3f803f80
    s_mov_b32 exec_lo, 0x00030003
    s_mov_b32 exec_hi, 0x00030003
    buffer_load_dwordx4 v[92:95], v4, s[56:59], 0 offen offset:0
    buffer_load_dwordx4 v[96:99], v4, s[56:59], 0 offen offset:256
    buffer_load_dwordx4 v[100:103], v4, s[56:59], 0 offen offset:512
    buffer_load_dwordx4 v[104:107], v4, s[56:59], 0 offen offset:768
    buffer_load_dwordx4 v[108:111], v4, s[56:59], 0 offen offset:1024
    buffer_load_dwordx2 v[116:117], v118, s[28:31], 0 offen sc1
    s_mov_b64 exec, -1
    s_waitcnt vmcnt(10)
    ds_read_b64_tr_b16 v[28:29], v14 offset:8192
    ds_read_b64_tr_b16 v[30:31], v14 offset:8704
    ds_read_b64_tr_b16 v[32:33], v15 offset:8192
    ds_read_b64_tr_b16 v[34:35], v15 offset:8704
    ds_read_b64_tr_b16 v[36:37], v16 offset:8192
    ds_read_b64_tr_b16 v[38:39], v16 offset:8704
    ds_read_b64_tr_b16 v[40:41], v17 offset:8192
    ds_read_b64_tr_b16 v[42:43], v17 offset:8704
    s_waitcnt vmcnt(6)
    ds_read_b64_tr_b16 v[44:45], v14 offset:12288
    ds_read_b64_tr_b16 v[46:47], v14 offset:12800
    ds_read_b64_tr_b16 v[48:49], v15 offset:12288
    ds_read_b64_tr_b16 v[50:51], v15 offset:12800
    ds_read_b64_tr_b16 v[52:53], v16 offset:12288
    ds_read_b64_tr_b16 v[54:55], v16 offset:12800
    ds_read_b64_tr_b16 v[56:57], v17 offset:12288
    ds_read_b64_tr_b16 v[58:59], v17 offset:12800
    s_branch Laux_mm
Laux_u:
    s_cmp_ge_u32 s36, 27
    s_cbranch_scc1 Lend
    v_and_b32 v8, 1, v2
    v_lshlrev_b32 v8, 1, v8
    v_xor_b32 v8, v8, v6
    v_lshlrev_b32 v8, 4, v8
    v_mul_u32_u24 v9, 3456, v5
    s_lshl_b32 s42, s36, 7
    v_add3_u32 v18, v9, v8, s42
    v_xor_b32 v19, 64, v18
    v_add_u32 v19, 26624, v19
    v_add_u32 v20, 53248, v18
    v_add_u32 v21, 53248, v19
    s_mul_i32 s46, s26, 110592
    v_mul_u32_u24 v9, 1280, v5
    v_add_u32 v22, v9, v8
    v_xor_b32 v23, 64, v22
    v_add_u32 v23, 9216, v23
    v_add_u32 v24, 18432, v22
    v_add_u32 v25, 18432, v23
    s_mul_i32 s47, s36, 81920
    s_lshl_b32 s42, s3, 7
    s_add_u32 s47, s47, s42
    s_waitcnt lgkmcnt(0)
    s_mov_b64 s[48:49], s[16:17]
    s_mov_b32 s50, 2211840
    s_mov_b32 s51, 0x20000
    s_mov_b64 s[28:29], s[24:25]
    s_mov_b32 s30, 268435456
    s_mov_b32 s31, 0x20000
    s_mov_b64 s[32:33], s[22:23]
    s_mov_b32 s34, 256
    s_mov_b32 s35, 0x20000
    s_load_dword s38, s[28:29], 0
    s_sub_u32 s56, s4, 4096
    s_subb_u32 s57, s5, 0
    s_mov_b32 s58, 2625536
    s_mov_b32 s59, 0x20000
    s_mov_b64 s[52:53], s[18:19]
    s_mov_b32 s54, 2211840
    s_mov_b32 s55, 0x20000
    s_mov_b64 s[76:77], s[18:19]
    s_mov_b32 s78, 2211840
    s_mov_b32 s79, 0x20000
    s_cmp_ge_u32 s26, 2
    s_cselect_b32 s78, 0, s78
    s_lshl_b32 s62, s2, 7
    s_add_u32 s62, s62, 8257536
    v_bfe_u32 v10, v1, 2, 2
    v_and_b32 v8, 3, v1
    v_lshl_add_u32 v14, v2, 3, v10
    v_lshlrev_b32 v14, 7, v14
    v_lshlrev_b32 v9, 2, v1
    v_and_b32 v9, 0x60, v9
    v_add3_u32 v14, v14, v9, s44
    v_lshl_add_u32 v14, v8, 3, v14
    v_xor_b32 v15, 32, v14
    v_xor_b32 v16, 64, v14
    v_xor_b32 v17, 96, v14
    s_lshl_b32 s40, s26, 6
    s_add_u32 s40, s40, 4096
    v_lshl_add_u32 v26, v2, 4, s40
    s_waitcnt lgkmcnt(0)
    s_add_u32 s38, s38, 0x9e3779b8
    s_or_b32 s38, s38, 1
    s_barrier
    s_add_u32 m0, s44, 0
    s_add_u32 s45, s46, 0
    buffer_load_dwordx4 v18, s[48:51], s45 offen nt lds
    buffer_load_dwordx4 v19, s[48:51], s45 offen offset:1024 nt lds
    buffer_load_dwordx4 v20, s[48:51], s45 offen offset:2048 nt lds
    buffer_load_dwordx4 v21, s[48:51], s45 offen offset:3072 nt lds
    s_add_u32 m0, s44, 4096
    s_add_u32 s45, s46, 442368
    buffer_load_dwordx4 v18, s[48:51], s45 offen nt lds
    buffer_load_dwordx4 v19, s[48:51], s45 offen offset:1024 nt lds
    buffer_load_dwordx4 v20, s[48:51], s45 offen offset:2048 nt lds
    buffer_load_dwordx4 v21, s[48:51], s45 offen offset:3072 nt lds
    s_add_u32 m0, s44, 8192
    s_add_u32 s45, s46, 884736
    buffer_load_dwordx4 v18, s[48:51], s45 offen nt lds
    buffer_load_dwordx4 v19, s[48:51], s45 offen offset:1024 nt lds
    buffer_load_dwordx4 v20, s[48:51], s45 offen offset:2048 nt lds
    buffer_load_dwordx4 v21, s[48:51], s45 offen offset:3072 nt lds
    s_add_u32 m0, s44, 12288
    s_add_u32 s45, s46, 1327104
    buffer_load_dwordx4 v18, s[48:51], s45 offen nt lds
    buffer_load_dwordx4 v19, s[48:51], s45 offen offset:1024 nt lds
    buffer_load_dwordx4 v20, s[48:51], s45 offen offset:2048 nt lds
    buffer_load_dwordx4 v21, s[48:51], s45 offen offset:3072 nt lds
    s_barrier
    s_waitcnt vmcnt(12)
    ds_read_b64_tr_b16 a[0:1], v14 offset:0
    ds_read_b64_tr_b16 a[2:3], v14 offset:512
    ds_read_b64_tr_b16 a[4:5], v15 offset:0
    ds_read_b64_tr_b16 a[6:7], v15 offset:512
    ds_read_b64_tr_b16 a[8:9], v16 offset:0
    ds_read_b64_tr_b16 a[10:11], v16 offset:512
    ds_read_b64_tr_b16 a[12:13], v17 offset:0
    ds_read_b64_tr_b16 a[14:15], v17 offset:512
    s_waitcnt lgkmcnt(0)
    s_add_u32 m0, s44, 0
    s_add_u32 s45, s46, 1769472
    buffer_load_dwordx4 v18, s[48:51], s45 offen nt lds
    buffer_load_dwordx4 v19, s[48:51], s45 offen offset:1024 nt lds
    buffer_load_dwordx4 v20, s[48:51], s45 offen offset:2048 nt lds
    buffer_load_dwordx4 v21, s[48:51], s45 offen offset:3072 nt lds
    s_waitcnt vmcnt(12)
    ds_read_b64_tr_b16 a[16:17], v14 offset:4096
    ds_read_b64_tr_b16 a[18:19], v14 offset:4608
    ds_read_b64_tr_b16 a[20:21], v15 offset:4096
    ds_read_b64_tr_b16 a[22:23], v15 offset:4608
    ds_read_b64_tr_b16 a[24:25], v16 offset:4096
    ds_read_b64_tr_b16 a[26:27], v16 offset:4608
    ds_read_b64_tr_b16 a[28:29], v17 offset:4096
    ds_read_b64_tr_b16 a[30:31], v17 offset:4608
    s_waitcnt lgkmcnt(0)
    s_add_u32 m0, s44, 4096
    s_add_u32 s45, s47, 0
    buffer_load_dwordx4 v22, s[52:55], s45 offen nt lds
    buffer_load_dwordx4 v23, s[52:55], s45 offen offset:1024 nt lds
    buffer_load_dwordx4 v24, s[52:55], s45 offen offset:2048 nt lds
    buffer_load_dwordx4 v25, s[52:55], s45 offen offset:3072 nt lds
    s_waitcnt vmcnt(12)
    ds_read_b64_tr_b16 a[32:33], v14 offset:8192
    ds_read_b64_tr_b16 a[34:35], v14 offset:8704
    ds_read_b64_tr_b16 a[36:37], v15 offset:8192
    ds_read_b64_tr_b16 a[38:39], v15 offset:8704
    ds_read_b64_tr_b16 a[40:41], v16 offset:8192
    ds_read_b64_tr_b16 a[42:43], v16 offset:8704
    ds_read_b64_tr_b16 a[44:45], v17 offset:8192
    ds_read_b64_tr_b16 a[46:47], v17 offset:8704
    s_waitcnt lgkmcnt(0)
    s_add_u32 m0, s44, 8192
    s_add_u32 s45, s47, 40960
    buffer_load_dwordx4 v22, s[52:55], s45 offen nt lds
    buffer_load_dwordx4 v23, s[52:55], s45 offen offset:1024 nt lds
    buffer_load_dwordx4 v24, s[52:55], s45 offen offset:2048 nt lds
    buffer_load_dwordx4 v25, s[52:55], s45 offen offset:3072 nt lds
    s_waitcnt vmcnt(12)
    ds_read_b64_tr_b16 a[48:49], v14 offset:12288
    ds_read_b64_tr_b16 a[50:51], v14 offset:12800
    ds_read_b64_tr_b16 a[52:53], v15 offset:12288
    ds_read_b64_tr_b16 a[54:55], v15 offset:12800
    ds_read_b64_tr_b16 a[56:57], v16 offset:12288
    ds_read_b64_tr_b16 a[58:59], v16 offset:12800
    ds_read_b64_tr_b16 a[60:61], v17 offset:12288
    ds_read_b64_tr_b16 a[62:63], v17 offset:12800
    buffer_load_dwordx4 v[112:115], off, s[28:31], s62 sc1
    s_waitcnt lgkmcnt(0)
    s_add_u32 m0, s44, 12288
    s_add_u32 s45, s47, 512
    buffer_load_dwordx4 v22, s[76:79], s45 offen nt lds
    buffer_load_dwordx4 v23, s[76:79], s45 offen offset:1024 nt lds
    buffer_load_dwordx4 v24, s[76:79], s45 offen offset:2048 nt lds
    buffer_load_dwordx4 v25, s[76:79], s45 offen offset:3072 nt lds
    s_waitcnt vmcnt(13)
    ds_read_b64_tr_b16 a[64:65], v14 offset:0
    ds_read_b64_tr_b16 a[66:67], v14 offset:512
    ds_read_b64_tr_b16 a[68:69], v15 offset:0
    ds_read_b64_tr_b16 a[70:71], v15 offset:512
    ds_read_b64_tr_b16 a[72:73], v16 offset:0
    ds_read_b64_tr_b16 a[74:75], v16 offset:512
    ds_read_b64_tr_b16 a[76:77], v17 offset:0
    ds_read_b64_tr_b16 a[78:79], v17 offset:512
    s_waitcnt lgkmcnt(0)
    s_add_u32 m0, s44, 0
    s_add_u32 s45, s47, 41472
    buffer_load_dwordx4 v22, s[76:79], s45 offen nt lds
    buffer_load_dwordx4 v23, s[76:79], s45 offen offset:1024 nt lds
    buffer_load_dwordx4 v24, s[76:79], s45 offen offset:2048 nt lds
    buffer_load_dwordx4 v25, s[76:79], s45 offen offset:3072 nt lds
    s_waitcnt vmcnt(13)
    ds_read_b64_tr_b16 v[28:29], v14 offset:4096
    ds_read_b64_tr_b16 v[30:31], v14 offset:4608
    ds_read_b64_tr_b16 v[32:33], v15 offset:4096
    ds_read_b64_tr_b16 v[34:35], v15 offset:4608
    ds_read_b64_tr_b16 v[36:37], v16 offset:4096
    ds_read_b64_tr_b16 v[38:39], v16 offset:4608
    ds_read_b64_tr_b16 v[40:41], v17 offset:4096
    ds_read_b64_tr_b16 v[42:43], v17 offset:4608
    s_waitcnt vmcnt(9)
    ds_read_b64_tr_b16 v[44:45], v14 offset:8192
    ds_read_b64_tr_b16 v[46:47], v14 offset:8704
    ds_read_b64_tr_b16 v[48:49], v15 offset:8192
    ds_read_b64_tr_b16 v[50:51], v15 offset:8704
    ds_read_b64_tr_b16 v[52:53], v16 offset:8192
    ds_read_b64_tr_b16 v[54:55], v16 offset:8704
    ds_read_b64_tr_b16 v[56:57], v17 offset:8192
    ds_read_b64_tr_b16 v[58:59], v17 offset:8704
    s_waitcnt vmcnt(8)
Lbc1:
    v_readfirstlane_b32 s40, v112
    v_readfirstlane_b32 s42, v113
    v_readfirstlane_b32 s41, v114
    v_readfirstlane_b32 s43, v115
    s_cmp_eq_u32 s42, s38
    s_cselect_b32 s43, s43, s42
    s_cmp_eq_u32 s43, s38
    s_cbranch_scc1 Lbc_ok1
    s_sub_u32 s39, s39, 1
    s_cbranch_scc1 Lend
    buffer_load_dwordx4 v[112:115], off, s[28:31], s62 sc1
    s_waitcnt vmcnt(0)
    s_branch Lbc1
Lbc_ok1:
    s_and_b32 s40, s40, 0x7ff
    s_sub_u32 s40, 2047, s40
    s_and_b32 s41, s41, 0x7ff
    s_sub_u32 s41, 2047, s41
    v_mov_b32 v4, s40
    v_mov_b32 v5, s41
    s_mov_b32 vcc_lo, 0xaaaaaaaa
    s_mov_b32 vcc_hi, 0xaaaaaaaa
    v_cndmask_b32 v4, v4, v5, vcc
    v_lshlrev_b32 v118, 3, v4
    v_add_u32 v118, 8192000, v118
    v_mul_u32_u24 v4, 1280, v4
    v_add_u32 v4, v4, v26
    v_mov_b32 v92, 0x3f803f80
    v_mov_b32 v93, 0x3f803f80
    v_mov_b32 v94, 0x3f803f80
    v_mov_b32 v95, 0x3f803f80
    v_mov_b32 v96, 0x3f803f80
    v_mov_b32 v97, 0x3f803f80
    v_mov_b32 v98, 0x3f803f80
    v_mov_b32 v99, 0x3f803f80
    v_mov_b32 v100, 0x3f803f80
    v_mov_b32 v101, 0x3f803f80
    v_mov_b32 v102, 0x3f803f80
    v_mov_b32 v103, 0x3f803f80
    v_mov_b32 v104, 0x3f803f80
    v_mov_b32 v105, 0x3f803f80
    v_mov_b32 v106, 0x3f803f80
    v_mov_b32 v107, 0x3f803f80
    v_mov_b32 v108, 0x3f803f80
    v_mov_b32 v109, 0x3f803f80
    v_mov_b32 v110, 0x3f803f80
    v_mov_b32 v111, 0x3f803f80
    s_mov_b32 exec_lo, 0x00030003
    s_mov_b32 exec_hi, 0x00030003
    buffer_load_dwordx4 v[92:95], v4, s[56:59], 0 offen offset:0
    buffer_load_dwordx4 v[96:99], v4, s[56:59], 0 offen offset:256
    buffer_load_dwordx4 v[100:103], v4, s[56:59], 0 offen offset:512
    buffer_load_dwordx4 v[104:107], v4, s[56:59], 0 offen offset:768
    buffer_load_dwordx4 v[108:111], v4, s[56:59], 0 offen offset:1024
    buffer_load_dwordx2 v[116:117], v118, s[28:31], 0 offen sc1
    s_mov_b64 exec, -1
    s_waitcnt vmcnt(10)
    ds_read_b64_tr_b16 v[60:61], v14 offset:12288
    ds_read_b64_tr_b16 v[62:63], v14 offset:12800
    ds_read_b64_tr_b16 v[64:65], v15 offset:12288
    ds_read_b64_tr_b16 v[66:67], v15 offset:12800
    ds_read_b64_tr_b16 v[68:69], v16 offset:12288
    ds_read_b64_tr_b16 v[70:71], v16 offset:12800
    ds_read_b64_tr_b16 v[72:73], v17 offset:12288
    ds_read_b64_tr_b16 v[74:75], v17 offset:12800
    s_waitcnt vmcnt(6)
    ds_read_b64_tr_b16 v[76:77], v14 offset:0
    ds_read_b64_tr_b16 v[78:79], v14 offset:512
    ds_read_b64_tr_b16 v[80:81], v15 offset:0
    ds_read_b64_tr_b16 v[82:83], v15 offset:512
    ds_read_b64_tr_b16 v[84:85], v16 offset:0
    ds_read_b64_tr_b16 v[86:87], v16 offset:512
    ds_read_b64_tr_b16 v[88:89], v17 offset:0
    ds_read_b64_tr_b16 v[90:91], v17 offset:512
Laux_mm:
    s_waitcnt vmcnt(0)
Lxs_chk:
    v_readlane_b32 s40, v117, 0
    v_readlane_b32 s41, v117, 1
    v_readlane_b32 s60, v116, 0
    v_readlane_b32 s61, v116, 1
    s_cmp_eq_u32 s40, s38
    s_cselect_b32 s41, s41, s40
    s_cmp_eq_u32 s41, s38
    s_cbranch_scc1 Lxs_ok
    s_sub_u32 s39, s39, 1
    s_cbranch_scc1 Lend
    buffer_load_dwordx2 v[116:117], v118, s[28:31], 0 offen sc1
    s_waitcnt vmcnt(0)
    s_branch Lxs_chk
Lxs_ok:
    s_waitcnt lgkmcnt(0)
    v_mfma_f32_16x16x32_bf16 v[112:115], a[0:3], v[92:95], 0
    v_mfma_f32_16x16x32_bf16 v[116:119], a[4:7], v[92:95], 0
    v_mfma_f32_16x16x32_bf16 v[120:123], a[8:11], v[92:95], 0
    v_mfma_f32_16x16x32_bf16 v[124:127], a[12:15], v[92:95], 0
    v_mfma_f32_16x16x32_bf16 v[112:115], a[16:19], v[96:99], v[112:115]
    v_mfma_f32_16x16x32_bf16 v[116:119], a[20:23], v[96:99], v[116:119]
    v_mfma_f32_16x16x32_bf16 v[120:123], a[24:27], v[96:99], v[120:123]
    v_mfma_f32_16x16x32_bf16 v[124:127], a[28:31], v[96:99], v[124:127]
    v_mfma_f32_16x16x32_bf16 v[112:115], a[32:35], v[100:103], v[112:115]
    v_mfma_f32_16x16x32_bf16 v[116:119], a[36:39], v[100:103], v[116:119]
    v_mfma_f32_16x16x32_bf16 v[120:123], a[40:43], v[100:103], v[120:123]
    v_mfma_f32_16x16x32_bf16 v[124:127], a[44:47], v[100:103], v[124:127]
    v_mfma_f32_16x16x32_bf16 v[112:115], a[48:51], v[104:107], v[112:115]
    v_mfma_f32_16x16x32_bf16 v[116:119], a[52:55], v[104:107], v[116:119]
    v_mfma_f32_16x16x32_bf16 v[120:123], a[56:59], v[104:107], v[120:123]
    v_mfma_f32_16x16x32_bf16 v[124:127], a[60:63], v[104:107], v[124:127]
    v_mfma_f32_16x16x32_bf16 v[112:115], a[64:67], v[108:111], v[112:115]
    v_mfma_f32_16x16x32_bf16 v[116:119], a[68:71], v[108:111], v[116:119]
    v_mfma_f32_16x16x32_bf16 v[120:123], a[72:75], v[108:111], v[120:123]
    v_mfma_f32_16x16x32_bf16 v[124:127], a[76:79], v[108:111], v[124:127]
    s_mul_i32 s40, s3, 768
    s_add_u32 s40, s40, 133120
    v_lshlrev_b32 v4, 8, v3
    v_lshl_add_u32 v4, v2, 4, v4
    v_add_u32 v4, s40, v4
    v_add_u32 v5, 133120, v12
    s_lshl_b32 s41, s3, 8
    s_add_u32 s41, s41, 139264
    v_lshl_add_u32 v6, v1, 1, s41
    v_and_b32 v7, 1, v1
    v_lshlrev_b32 v7, 7, v7
    v_lshl_add_u32 v7, v2, 4, v7
    v_add_u32 v7, s41, v7
    s_lshl_b32 s42, s60, 16
    s_lshl_b32 s43, s61, 16
    v_rcp_f32 v8, s42
    v_rcp_f32 v9, s43
    s_and_b32 s60, s60, 0xffff0000
    s_and_b32 s61, s61, 0xffff0000
    s_mov_b32 exec_lo, 0x00070007
    s_mov_b32 exec_hi, 0x00070007
    ds_write_b128 v4, v[112:115] offset:0
    ds_write_b128 v4, v[116:119] offset:64
    ds_write_b128 v4, v[120:123] offset:128
    ds_write_b128 v4, v[124:127] offset:192
    s_mov_b64 exec, -1
    s_waitcnt lgkmcnt(0)
    s_barrier
    ds_read2st64_b32 v[92:93], v5 offset0:0 offset1:1
    ds_read2st64_b32 v[94:95], v5 offset0:2 offset1:3
    ds_read2st64_b32 v[96:97], v5 offset0:4 offset1:5
    ds_read2st64_b32 v[98:99], v5 offset0:6 offset1:7
    ds_read2st64_b32 v[100:101], v5 offset0:8 offset1:9
    ds_read2st64_b32 v[102:103], v5 offset0:10 offset1:11
    ds_read2st64_b32 v[116:117], v5 offset0:12 offset1:13
    ds_read2st64_b32 v[118:119], v5 offset0:14 offset1:15
    ds_read2st64_b32 v[120:121], v5 offset0:16 offset1:17
    ds_read2st64_b32 v[122:123], v5 offset0:18 offset1:19
    ds_read2st64_b32 v[124:125], v5 offset0:20 offset1:21
    ds_read2st64_b32 v[126:127], v5 offset0:22 offset1:23
    v_cmp_eq_u32 s[74:75], 1, v2
    v_cmp_eq_u32 s[80:81], 2, v2
    v_cmp_eq_u32 s[82:83], 3, v2
    s_mul_i32 s41, s36, 10
    s_add_u32 s41, s41, s3
    s_lshl_b32 s41, s41, 10
    s_add_u32 s41, s41, 7405568
    s_waitcnt lgkmcnt(0)
    v_add_f32 v92, v92, v95
    v_add_f32 v98, v98, v101
    v_add_f32 v92, v92, v98
    v_add_f32 v93, v93, v96
    v_add_f32 v99, v99, v102
    v_add_f32 v93, v93, v99
    v_add_f32 v94, v94, v97
    v_add_f32 v100, v100, v103
    v_add_f32 v94, v94, v100
    v_add_f32 v116, v116, v119
    v_add_f32 v122, v122, v125
    v_add_f32 v116, v116, v122
    v_add_f32 v117, v117, v120
    v_add_f32 v123, v123, v126
    v_add_f32 v117, v117, v123
    v_add_f32 v118, v118, v121
    v_add_f32 v124, v124, v127
    v_add_f32 v118, v118, v124
    v_fmac_f32 v92, s60, v94
    v_mul_f32 v112, v92, v8
    v_fmac_f32 v93, s61, v94
    v_mul_f32 v113, v93, v9
    v_fmac_f32 v116, s60, v118
    v_mul_f32 v120, v116, v8
    v_fmac_f32 v117, s61, v118
    v_mul_f32 v121, v117, v9
    v_cvt_pk_bf16_f32 v113, v112, v113
    v_lshlrev_b32 v112, 16, v113
    v_and_b32 v113, 0xffff0000, v113
    v_cvt_pk_bf16_f32 v121, v120, v121
    v_lshlrev_b32 v120, 16, v121
    v_and_b32 v121, 0xffff0000, v121
    v_mul_f32 v114, 0xbfb8aa3b, v112
    v_mul_f32 v115, 0xbfb8aa3b, v113
    v_exp_f32 v114, v114
    v_exp_f32 v115, v115
    v_add_f32 v114, 1.0, v114
    v_add_f32 v115, 1.0, v115
    v_rcp_f32 v114, v114
    v_rcp_f32 v115, v115
    v_mul_f32 v114, v114, v112
    v_mul_f32 v115, v115, v113
    v_cvt_pk_bf16_f32 v115, v114, v115
    v_lshlrev_b32 v114, 16, v115
    v_and_b32 v115, 0xffff0000, v115
    v_mul_f32 v114, v114, v120
    v_mul_f32 v115, v115, v121
    v_cvt_pk_bf16_f32 v114, v114, v115
    ds_write_b16 v6, v114
    ds_write_b16_d16_hi v6, v114 offset:128
    ds_read_b128 v[92:95], v7 offset:0
    ds_read_b128 v[96:99], v7 offset:64
    v_mov_b32 v101, s38
    v_mov_b32 v103, s38
    s_waitcnt lgkmcnt(0)
    v_mfma_f32_16x16x32_bf16 v[112:115], v[92:95], v[28:31], 0
    v_mfma_f32_16x16x32_bf16 v[116:119], v[92:95], v[32:35], 0
    v_mfma_f32_16x16x32_bf16 v[120:123], v[92:95], v[36:39], 0
    v_mfma_f32_16x16x32_bf16 v[124:127], v[92:95], v[40:43], 0
    v_mfma_f32_16x16x32_bf16 v[112:115], v[96:99], v[44:47], v[112:115]
    v_mfma_f32_16x16x32_bf16 v[116:119], v[96:99], v[48:51], v[116:119]
    v_mfma_f32_16x16x32_bf16 v[120:123], v[96:99], v[52:55], v[120:123]
    v_mfma_f32_16x16x32_bf16 v[124:127], v[96:99], v[56:59], v[124:127]
    s_nop 5
    v_cndmask_b32 v100, v112, v116, s[74:75]
    v_cndmask_b32 v100, v100, v120, s[80:81]
    v_cndmask_b32 v100, v100, v124, s[82:83]
    v_cndmask_b32 v102, v113, v117, s[74:75]
    v_cndmask_b32 v102, v102, v121, s[80:81]
    v_cndmask_b32 v102, v102, v125, s[82:83]
    buffer_store_dwordx4 v[100:103], v13, s[28:31], s41 offen sc1
    s_sub_u32 s40, s3, 4
    s_cmp_ge_u32 s40, 2
    s_cbranch_scc1 Laux_end
    s_add_u32 s41, s41, 4096
    v_mfma_f32_16x16x32_bf16 v[112:115], v[92:95], v[60:63], 0
    v_mfma_f32_16x16x32_bf16 v[116:119], v[92:95], v[64:67], 0
    v_mfma_f32_16x16x32_bf16 v[120:123], v[92:95], v[68:71], 0
    v_mfma_f32_16x16x32_bf16 v[124:127], v[92:95], v[72:75], 0
    v_mfma_f32_16x16x32_bf16 v[112:115], v[96:99], v[76:79], v[112:115]
    v_mfma_f32_16x16x32_bf16 v[116:119], v[96:99], v[80:83], v[116:119]
    v_mfma_f32_16x16x32_bf16 v[120:123], v[96:99], v[84:87], v[120:123]
    v_mfma_f32_16x16x32_bf16 v[124:127], v[96:99], v[88:91], v[124:127]
    s_nop 5
    v_cndmask_b32 v100, v112, v116, s[74:75]
    v_cndmask_b32 v100, v100, v120, s[80:81]
    v_cndmask_b32 v100, v100, v124, s[82:83]
    v_cndmask_b32 v102, v113, v117, s[74:75]
    v_cndmask_b32 v102, v102, v121, s[80:81]
    v_cndmask_b32 v102, v102, v125, s[82:83]
    buffer_store_dwordx4 v[100:103], v13, s[28:31], s41 offen sc1
Laux_end:
    s_endpgm
Lmst:
    s_cmp_lg_u32 s3, 0
    s_cbranch_scc1 Lend
    s_waitcnt lgkmcnt(0)
    s_mov_b64 s[28:29], s[24:25]
    s_mov_b32 s30, 268435456
    s_mov_b32 s31, 0x20000
    s_mov_b64 s[32:33], s[22:23]
    s_mov_b32 s34, 256
    s_mov_b32 s35, 0x20000
    s_load_dword s38, s[28:29], 0
    s_waitcnt lgkmcnt(0)
    s_add_u32 s38, s38, 0x9e3779b8
    s_or_b32 s38, s38, 1
    s_mov_b64 exec, 1
    s_lshl_b32 s40, s2, 2
    s_add_u32 s40, s40, 8323072
    v_mov_b32 v4, s38
    v_mov_b32 v5, s40
    buffer_store_dword v4, v5, s[28:31], 0 offen sc1
    s_mov_b64 exec, -1
    s_cmp_lg_u32 s36, 32
    s_cbranch_scc1 Lend
Lmst_bc:
Lpt_9:
    s_sub_u32 s39, s39, 1
    s_cbranch_scc1 Lend
    buffer_load_dword v4, v12, s[32:35], 0 offen offset:64 sc1
    v_lshrrev_b32 v5, 1, v12
    v_and_b32 v5, 0x3c, v5
    v_add_u32 v5, 128, v5
    s_waitcnt vmcnt(0)
    ds_bpermute_b32 v5, v5, v4
    v_and_b32 v6, 4, v12
    v_lshlrev_b32 v6, 2, v6
    s_waitcnt lgkmcnt(0)
    v_bfe_u32 v5, v5, v6, 16
    v_cmp_ne_u32 vcc, 0, v4
    v_cmp_ne_u32 s[40:41], 0, v5
    s_nop 0
    s_and_b32 s40, s40, vcc_lo
    s_cmp_eq_u32 s40, -1
    s_cbranch_scc1 Lptd_10
    s_sleep 2
    s_branch Lpt_9
Lptd_10:
    v_lshlrev_b32 v6, 4, v12
    v_and_b32 v7, 63, v5
    v_add_u32 v7, v7, v6
    v_sub_u32 v7, 2047, v7
    v_bfe_u32 v5, v5, 6, 6
    v_add_u32 v5, v5, v6
    v_sub_u32 v5, 2047, v5
    v_and_b32 v6, 0xffff0000, v4
    v_or_b32 v7, v7, v6
    v_lshl_or_b32 v5, v4, 16, v5
    v_cmp_gt_u32 vcc, 128, v12
    s_nop 1
    v_cndmask_b32 v7, 0, v7, vcc
    v_cndmask_b32 v5, 0, v5, vcc
    v_mov_b32 v4, v7
    s_nop 1
    v_max_u32_dpp v4, v4, v4 row_ror:8 row_mask:0xf bank_mask:0xf
    s_nop 1
    v_max_u32_dpp v4, v4, v4 row_ror:4 row_mask:0xf bank_mask:0xf
    s_nop 1
    v_max_u32_dpp v4, v4, v4 row_ror:2 row_mask:0xf bank_mask:0xf
    s_nop 1
    v_max_u32_dpp v4, v4, v4 row_ror:1 row_mask:0xf bank_mask:0xf
    s_nop 0
    v_readlane_b32 s44, v4, 0
    v_readlane_b32 s40, v4, 16
    v_readlane_b32 s41, v4, 32
    v_readlane_b32 s42, v4, 48
    s_max_u32 s44, s44, s40
    s_max_u32 s41, s41, s42
    s_max_u32 s44, s44, s41
    v_cmp_eq_u32 vcc, s44, v7
    s_nop 1
    v_cndmask_b32 v4, v7, v5, vcc
    s_nop 1
    v_max_u32_dpp v4, v4, v4 row_ror:8 row_mask:0xf bank_mask:0xf
    s_nop 1
    v_max_u32_dpp v4, v4, v4 row_ror:4 row_mask:0xf bank_mask:0xf
    s_nop 1
    v_max_u32_dpp v4, v4, v4 row_ror:2 row_mask:0xf bank_mask:0xf
    s_nop 1
    v_max_u32_dpp v4, v4, v4 row_ror:1 row_mask:0xf bank_mask:0xf
    s_nop 0
    v_readlane_b32 s45, v4, 0
    v_readlane_b32 s40, v4, 16
    v_readlane_b32 s41, v4, 32
    v_readlane_b32 s42, v4, 48
    s_max_u32 s45, s45, s40
    s_max_u32 s41, s41, s42
    s_max_u32 s45, s45, s41
    v_mov_b32 v8, s44
    v_mov_b32 v9, s38
    v_mov_b32 v10, s45
    v_mov_b32 v11, s38
    v_lshlrev_b32 v4, 7, v1
    s_mov_b32 s40, 8257536
    buffer_store_dwordx4 v[8:11], v4, s[28:31], s40 offen sc1
    s_add_u32 s40, s40, 8192
    buffer_store_dwordx4 v[8:11], v4, s[28:31], s40 offen sc1
    s_add_u32 s40, s40, 8192
    buffer_store_dwordx4 v[8:11], v4, s[28:31], s40 offen sc1
    s_add_u32 s40, s40, 8192
    buffer_store_dwordx4 v[8:11], v4, s[28:31], s40 offen sc1
    s_add_u32 s40, s40, 8192
    s_mov_b32 s40, 8323072
Lmaster:
    s_sub_u32 s39, s39, 1
    s_cbranch_scc1 Lend
    s_sleep 16
    buffer_load_dwordx4 v[4:7], v13, s[28:31], s40 offen sc1
    s_waitcnt vmcnt(0)
    v_xor_b32 v4, s38, v4
    v_xor_b32 v5, s38, v5
    v_xor_b32 v6, s38, v6
    v_xor_b32 v7, s38, v7
    v_or3_b32 v4, v4, v5, v6
    v_or_b32 v4, v4, v7
    v_cmp_ne_u32 vcc, 0, v4
    s_nop 0
    s_cbranch_vccnz Lmaster
    s_mov_b64 exec, 1
    buffer_store_dword v9, v4, s[28:31], 0 offen sc1
Lend:
    s_endpgm
.section .rodata,"a"
.p2align 6
.amdhsa_kernel recurrent_scan__sliding_local_dilated__moe_arch_mod__prompt_kernel
  .amdhsa_next_free_vgpr 256
  .amdhsa_next_free_sgpr 102
  .amdhsa_accum_offset 128
  .amdhsa_group_segment_fixed_size 0
  .amdhsa_kernarg_size 88
  .amdhsa_user_sgpr_count 2
  .amdhsa_user_sgpr_kernarg_segment_ptr 1
  .amdhsa_system_sgpr_workgroup_id_x 1
  .amdhsa_float_denorm_mode_32 3
.end_amdhsa_kernel
```

```asm
; @launch grid=(256,1,1) block=(512,1,1) lds=163840
.amdgcn_target "amdgcn-amd-amdhsa--gfx950"
.text
.globl recurrent_scan__sliding_local_dilated__moe_arch_mod__prompt_kernel
.p2align 8
.type recurrent_scan__sliding_local_dilated__moe_arch_mod__prompt_kernel,@function
recurrent_scan__sliding_local_dilated__moe_arch_mod__prompt_kernel:
    s_load_dwordx16 s[4:19], s[0:1], 0
    s_load_dwordx4 s[20:23], s[0:1], 64
    s_load_dwordx2 s[24:25], s[0:1], 80
    v_lshrrev_b32 v4, 6, v0
    v_and_b32 v1, 63, v0
    s_cmp_ge_u32 s2, 256
    s_cbranch_scc1 Lend
    v_readfirstlane_b32 s3, v4
    s_getpc_b64 s[36:37]
Lpc:
    s_and_b32 s38, s2, 0xf8
    v_add_u32 v5, s38, v4
    v_and_b32 v6, 1, v0
    v_lshl_add_u32 v5, v5, 1, v6
    v_lshlrev_b32 v5, 7, v5
    v_min_u32 v5, Lend-Lpc, v5
    v_mov_b32 v7, s37
    v_add_co_u32 v6, vcc, s36, v5
    s_nop 1
    v_addc_co_u32 v7, vcc, 0, v7, vcc
    global_load_dword v0, v[6:7], off
    v_lshrrev_b32 v2, 4, v1
    v_and_b32 v3, 15, v1
    v_lshlrev_b32 v12, 2, v1
    v_lshlrev_b32 v13, 4, v1
    s_mov_b32 s35, 200000
    s_and_b32 s36, s2, 7
    s_lshr_b32 s37, s2, 3
    s_and_b32 s38, s36, 1
    s_lshr_b32 s36, s36, 1
    s_add_u32 s39, s38, 4
    s_and_b32 s26, s3, 3
    s_lshr_b32 s27, s3, 2
    s_cmp_lt_u32 s37, s39
    s_cbranch_scc1 Laux
    s_lshr_b32 s33, s36, 1
    s_and_b32 s36, s36, 1
    s_mul_i32 s36, s36, 55
    s_mul_i32 s38, s38, 28
    s_add_u32 s36, s36, s38
    s_add_u32 s36, s36, s37
    s_sub_u32 s36, s36, s39
    s_mul_i32 s32, s36, 13108
    s_lshr_b32 s32, s32, 16
    s_mul_i32 s37, s32, 5
    s_sub_u32 s36, s36, s37
    s_mul_i32 s33, s33, 5
    s_add_u32 s33, s33, s36
    s_add_u32 s42, s33, s32
    s_mul_i32 s36, s42, 13108
    s_lshr_b32 s36, s36, 16
    s_mul_i32 s36, s36, 5
    s_sub_u32 s42, s42, s36
    s_cmp_lg_u32 s3, 0
    s_cbranch_scc1 Lcomp
Lloader:
    s_setprio 3
    v_lshrrev_b32 v5, 3, v1
    v_and_b32 v6, 7, v1
    v_and_b32 v8, 1, v2
    v_lshlrev_b32 v8, 1, v8
    v_xor_b32 v8, v8, v6
    s_lshl_b32 s39, s33, 7
    v_lshl_add_u32 v50, v8, 4, s39
    v_mov_b32 v7, 3840
    v_mad_u32_u24 v28, v5, v7, v50
    v_xor_b32 v29, 64, v28
    v_add_u32 v29, 29696, v29
    v_add_u32 v30, 59392, v28
    v_add_u32 v31, 59392, v29
    v_add_u32 v32, 122880, v28
    v_add_u32 v33, 122880, v29
    v_add_u32 v34, 182272, v28
    v_add_u32 v35, 182272, v29
    s_lshl_b32 s78, s42, 2
    s_lshr_b32 s78, 0x86420, s78
    s_and_b32 s78, s78, 15
    s_mul_i32 s68, s78, 245760
    s_lshl_b32 s43, s78, 7
    s_mul_i32 s38, s32, 96
    s_sub_u32 s38, s38, 16
    v_add_u32 v7, s38, v5
    v_xor_b32 v9, v6, v2
    v_lshlrev_b32 v9, 4, v9
    v_xor_b32 v10, 64, v9
    v_mov_b32 v11, 2047
    v_mov_b32 v8, 1280
    v_add_u32 v36, 0, v7
    v_med3_i32 v36, v36, 0, v11
    v_mad_u32_u24 v36, v36, v8, v9
    v_add_u32 v36, 4096, v36
    v_add_u32 v37, 8, v7
    v_med3_i32 v37, v37, 0, v11
    v_mad_u32_u24 v37, v37, v8, v10
    v_add_u32 v37, 3072, v37
    v_add_u32 v38, 16, v7
    v_med3_i32 v38, v38, 0, v11
    v_mad_u32_u24 v38, v38, v8, v9
    v_add_u32 v38, 2048, v38
    v_add_u32 v39, 24, v7
    v_med3_i32 v39, v39, 0, v11
    v_mad_u32_u24 v39, v39, v8, v10
    v_add_u32 v39, 1024, v39
    s_waitcnt lgkmcnt(0)
    s_mov_b64 s[48:49], s[6:7]
    s_mov_b32 s50, 2457600
    s_mov_b32 s51, 0x20000
    s_add_u32 s52, s6, 1280
    s_addc_u32 s53, s7, 0
    s_mov_b32 s54, 2456320
    s_mov_b32 s55, 0x20000
    s_add_u32 s56, s6, 2560
    s_addc_u32 s57, s7, 0
    s_mov_b32 s58, 2455040
    s_mov_b32 s59, 0x20000
    s_mov_b32 m0, 0
    v_add_u32 v40, 32, v7
    v_med3_i32 v40, v40, 0, v11
    buffer_load_dwordx4 v28, s[48:51], s68 offen lds
    v_mad_u32_u24 v40, v40, v8, v9
    buffer_load_dwordx4 v29, s[48:51], s68 offen offset:1024 lds
    v_add_u32 v40, 4096, v40
    v_add_u32 v41, 40, v7
    buffer_load_dwordx4 v30, s[48:51], s68 offen offset:2048 lds
    v_med3_i32 v41, v41, 0, v11
    buffer_load_dwordx4 v31, s[48:51], s68 offen offset:3072 lds
    v_mad_u32_u24 v41, v41, v8, v10
    s_mov_b32 m0, 8192
    v_add_u32 v41, 3072, v41
    v_add_u32 v42, 48, v7
    buffer_load_dwordx4 v28, s[52:55], s68 offen lds
    v_med3_i32 v42, v42, 0, v11
    buffer_load_dwordx4 v29, s[52:55], s68 offen offset:1024 lds
    v_mad_u32_u24 v42, v42, v8, v9
    buffer_load_dwordx4 v30, s[52:55], s68 offen offset:2048 lds
    v_add_u32 v42, 2048, v42
    v_add_u32 v43, 56, v7
    buffer_load_dwordx4 v31, s[52:55], s68 offen offset:3072 lds
    v_med3_i32 v43, v43, 0, v11
    s_mov_b32 m0, 16384
    v_mad_u32_u24 v43, v43, v8, v10
    v_add_u32 v43, 1024, v43
    buffer_load_dwordx4 v28, s[56:59], s68 offen lds
    v_add_u32 v44, 64, v7
    buffer_load_dwordx4 v29, s[56:59], s68 offen offset:1024 lds
    v_med3_i32 v44, v44, 0, v11
    buffer_load_dwordx4 v30, s[56:59], s68 offen offset:2048 lds
    v_mad_u32_u24 v44, v44, v8, v9
    v_add_u32 v44, 4096, v44
    buffer_load_dwordx4 v31, s[56:59], s68 offen offset:3072 lds
    v_add_u32 v45, 72, v7
    s_mov_b32 m0, 4096
    v_med3_i32 v45, v45, 0, v11
    buffer_load_dwordx4 v32, s[48:51], s68 offen lds
    v_mad_u32_u24 v45, v45, v8, v10
    v_add_u32 v45, 3072, v45
    buffer_load_dwordx4 v33, s[48:51], s68 offen offset:1024 lds
    v_add_u32 v46, 80, v7
    buffer_load_dwordx4 v34, s[48:51], s68 offen offset:2048 lds
    v_med3_i32 v46, v46, 0, v11
    buffer_load_dwordx4 v35, s[48:51], s68 offen offset:3072 lds
    v_mad_u32_u24 v46, v46, v8, v9
    v_add_u32 v46, 2048, v46
    s_mov_b32 m0, 12288
    v_add_u32 v47, 88, v7
    buffer_load_dwordx4 v32, s[52:55], s68 offen lds
    v_med3_i32 v47, v47, 0, v11
    v_mad_u32_u24 v47, v47, v8, v10
    buffer_load_dwordx4 v33, s[52:55], s68 offen offset:1024 lds
    v_add_u32 v47, 1024, v47
    buffer_load_dwordx4 v34, s[52:55], s68 offen offset:2048 lds
    v_add_u32 v48, 96, v7
    buffer_load_dwordx4 v35, s[52:55], s68 offen offset:3072 lds
    v_med3_i32 v48, v48, 0, v11
    v_mad_u32_u24 v48, v48, v8, v9
    s_mov_b32 m0, 20480
    v_add_u32 v48, 4096, v48
    buffer_load_dwordx4 v32, s[56:59], s68 offen lds
    v_add_u32 v49, 104, v7
    buffer_load_dwordx4 v33, s[56:59], s68 offen offset:1024 lds
    v_med3_i32 v49, v49, 0, v11
    v_mad_u32_u24 v49, v49, v8, v10
    buffer_load_dwordx4 v34, s[56:59], s68 offen offset:2048 lds
    v_add_u32 v49, 3072, v49
    buffer_load_dwordx4 v35, s[56:59], s68 offen offset:3072 lds
    s_sub_u32 s44, s4, 4096
    s_subb_u32 s45, s5, 0
    s_mov_b32 s46, 2625536
    s_mov_b32 s47, 0x20000
    s_mov_b32 m0, 24576
    s_nop 0
    buffer_load_dwordx4 v36, s[44:47], s43 offen lds
    buffer_load_dwordx4 v37, s[44:47], s43 offen offset:1024 lds
    buffer_load_dwordx4 v38, s[44:47], s43 offen offset:2048 lds
    buffer_load_dwordx4 v39, s[44:47], s43 offen offset:3072 lds
    s_mov_b32 m0, 28672
    s_nop 0
    buffer_load_dwordx4 v40, s[44:47], s43 offen lds
    buffer_load_dwordx4 v41, s[44:47], s43 offen offset:1024 lds
    buffer_load_dwordx4 v42, s[44:47], s43 offen offset:2048 lds
    buffer_load_dwordx4 v43, s[44:47], s43 offen offset:3072 lds
    s_mov_b32 m0, 32768
    s_nop 0
    buffer_load_dwordx4 v44, s[44:47], s43 offen lds
    buffer_load_dwordx4 v45, s[44:47], s43 offen offset:1024 lds
    buffer_load_dwordx4 v46, s[44:47], s43 offen offset:2048 lds
    buffer_load_dwordx4 v47, s[44:47], s43 offen offset:3072 lds
    s_mov_b32 m0, 36864
    s_nop 0
    buffer_load_dwordx4 v48, s[44:47], s43 offen lds
    buffer_load_dwordx4 v49, s[44:47], s43 offen offset:1024 lds
    s_mov_b32 s80, 0x53864210
    s_mov_b32 s81, 0x97
    s_cmp_eq_u32 s42, 1
    s_cselect_b32 s80, 0x51086342, s80
    s_cselect_b32 s81, 0x97, s81
    s_cmp_eq_u32 s42, 2
    s_cselect_b32 s80, 0x31205864, s80
    s_cselect_b32 s81, 0x97, s81
    s_cmp_eq_u32 s42, 3
    s_cselect_b32 s80, 0x31472086, s80
    s_cselect_b32 s81, 0x95, s81
    s_cmp_eq_u32 s42, 4
    s_cselect_b32 s80, 0x31964208, s80
    s_cselect_b32 s81, 0x75, s81
    s_lshr_b64 s[80:81], s[80:81], 4
    s_and_b32 s78, s80, 15
    s_mov_b64 s[28:29], s[24:25]
    s_mov_b32 s30, 268435456
    s_mov_b32 s31, 0x20000
    s_load_dword s34, s[28:29], 0
    s_mov_b64 s[60:61], s[8:9]
    s_mov_b32 s62, 819200
    s_mov_b32 s63, 0x20000
    s_mov_b64 s[64:65], s[20:21]
    s_mov_b32 s66, 2621440
    s_mov_b32 s67, 0x20000
    v_mov_b32 v51, 157984
    v_and_b32 v66, 7, v1
    v_max_u32 v66, 1, v66
    v_lshlrev_b32 v66, 2, v66
    v_add_u32 v66, 158016, v66
    s_mul_i32 s69, s78, 245760
    s_lshl_b32 s43, s78, 7
    s_mov_b32 m0, 63616
    s_nop 0
    buffer_load_dwordx4 v36, s[44:47], s43 offen lds
    buffer_load_dwordx4 v37, s[44:47], s43 offen offset:1024 lds
    buffer_load_dwordx4 v38, s[44:47], s43 offen offset:2048 lds
    buffer_load_dwordx4 v39, s[44:47], s43 offen offset:3072 lds
    s_mov_b32 m0, 39040
    s_nop 0
    buffer_load_dwordx4 v28, s[48:51], s69 offen lds
    buffer_load_dwordx4 v29, s[48:51], s69 offen offset:1024 lds
    buffer_load_dwordx4 v30, s[48:51], s69 offen offset:2048 lds
    buffer_load_dwordx4 v31, s[48:51], s69 offen offset:3072 lds
    s_mov_b32 m0, 67712
    s_nop 0
    buffer_load_dwordx4 v40, s[44:47], s43 offen lds
    buffer_load_dwordx4 v41, s[44:47], s43 offen offset:1024 lds
    buffer_load_dwordx4 v42, s[44:47], s43 offen offset:2048 lds
    buffer_load_dwordx4 v43, s[44:47], s43 offen offset:3072 lds
    s_mov_b32 m0, 47232
    s_nop 0
    buffer_load_dwordx4 v28, s[52:55], s69 offen lds
    buffer_load_dwordx4 v29, s[52:55], s69 offen offset:1024 lds
    buffer_load_dwordx4 v30, s[52:55], s69 offen offset:2048 lds
    buffer_load_dwordx4 v31, s[52:55], s69 offen offset:3072 lds
    s_mov_b32 m0, 71808
    s_nop 0
    buffer_load_dwordx4 v44, s[44:47], s43 offen lds
    buffer_load_dwordx4 v45, s[44:47], s43 offen offset:1024 lds
    buffer_load_dwordx4 v46, s[44:47], s43 offen offset:2048 lds
    buffer_load_dwordx4 v47, s[44:47], s43 offen offset:3072 lds
    s_mov_b32 m0, 55424
    s_nop 0
    buffer_load_dwordx4 v28, s[56:59], s69 offen lds
    buffer_load_dwordx4 v29, s[56:59], s69 offen offset:1024 lds
    buffer_load_dwordx4 v30, s[56:59], s69 offen offset:2048 lds
    buffer_load_dwordx4 v31, s[56:59], s69 offen offset:3072 lds
    s_mov_b32 m0, 75904
    s_nop 0
    buffer_load_dwordx4 v48, s[44:47], s43 offen lds
    s_waitcnt vmcnt(55)
    buffer_load_dwordx4 v49, s[44:47], s43 offen offset:1024 lds
    s_mov_b32 m0, 43136
    s_nop 0
    buffer_load_dwordx4 v32, s[48:51], s69 offen lds
    buffer_load_dwordx4 v33, s[48:51], s69 offen offset:1024 lds
    buffer_load_dwordx4 v34, s[48:51], s69 offen offset:2048 lds
    buffer_load_dwordx4 v35, s[48:51], s69 offen offset:3072 lds
    s_mov_b32 m0, 51328
    s_nop 0
    buffer_load_dwordx4 v32, s[52:55], s69 offen lds
    buffer_load_dwordx4 v33, s[52:55], s69 offen offset:1024 lds
    buffer_load_dwordx4 v34, s[52:55], s69 offen offset:2048 lds
    s_waitcnt vmcnt(55)
    buffer_load_dwordx4 v35, s[52:55], s69 offen offset:3072 lds
    s_mov_b32 m0, 59520
    s_nop 0
    buffer_load_dwordx4 v32, s[56:59], s69 offen lds
    buffer_load_dwordx4 v33, s[56:59], s69 offen offset:1024 lds
    buffer_load_dwordx4 v34, s[56:59], s69 offen offset:2048 lds
    buffer_load_dwordx4 v35, s[56:59], s69 offen offset:3072 lds
    s_waitcnt vmcnt(38) lgkmcnt(0)
    s_barrier
    s_add_u32 s34, s34, 0x9e3779b8
    s_or_b32 s34, s34, 1
    s_lshr_b64 s[80:81], s[80:81], 4
    s_and_b32 s78, s80, 15
    s_mul_i32 s70, s78, 245760
    s_lshl_b32 s43, s78, 7
    s_mov_b32 m0, 102656
    s_nop 0
    buffer_load_dwordx4 v36, s[44:47], s43 offen lds
    buffer_load_dwordx4 v37, s[44:47], s43 offen offset:1024 lds
    buffer_load_dwordx4 v38, s[44:47], s43 offen offset:2048 lds
    buffer_load_dwordx4 v39, s[44:47], s43 offen offset:3072 lds
    s_mov_b32 m0, 78080
    s_nop 0
    buffer_load_dwordx4 v28, s[48:51], s70 offen lds
    buffer_load_dwordx4 v29, s[48:51], s70 offen offset:1024 lds
    buffer_load_dwordx4 v30, s[48:51], s70 offen offset:2048 lds
    buffer_load_dwordx4 v31, s[48:51], s70 offen offset:3072 lds
    s_mov_b32 m0, 106752
    s_nop 0
    buffer_load_dwordx4 v40, s[44:47], s43 offen lds
    buffer_load_dwordx4 v41, s[44:47], s43 offen offset:1024 lds
    buffer_load_dwordx4 v42, s[44:47], s43 offen offset:2048 lds
    buffer_load_dwordx4 v43, s[44:47], s43 offen offset:3072 lds
    s_mov_b32 m0, 86272
    s_nop 0
    buffer_load_dwordx4 v28, s[52:55], s70 offen lds
    buffer_load_dwordx4 v29, s[52:55], s70 offen offset:1024 lds
    buffer_load_dwordx4 v30, s[52:55], s70 offen offset:2048 lds
    buffer_load_dwordx4 v31, s[52:55], s70 offen offset:3072 lds
    s_mov_b32 m0, 110848
    s_nop 0
    buffer_load_dwordx4 v44, s[44:47], s43 offen lds
    buffer_load_dwordx4 v45, s[44:47], s43 offen offset:1024 lds
    buffer_load_dwordx4 v46, s[44:47], s43 offen offset:2048 lds
    buffer_load_dwordx4 v47, s[44:47], s43 offen offset:3072 lds
    s_mov_b32 m0, 94464
    s_nop 0
    buffer_load_dwordx4 v28, s[56:59], s70 offen lds
    buffer_load_dwordx4 v29, s[56:59], s70 offen offset:1024 lds
    buffer_load_dwordx4 v30, s[56:59], s70 offen offset:2048 lds
    buffer_load_dwordx4 v31, s[56:59], s70 offen offset:3072 lds
    s_mov_b32 m0, 114944
    s_nop 0
    buffer_load_dwordx4 v48, s[44:47], s43 offen lds
    s_waitcnt vmcnt(55)
    buffer_load_dwordx4 v49, s[44:47], s43 offen offset:1024 lds
    s_mov_b32 m0, 82176
    s_nop 0
    buffer_load_dwordx4 v32, s[48:51], s70 offen lds
    buffer_load_dwordx4 v33, s[48:51], s70 offen offset:1024 lds
    buffer_load_dwordx4 v34, s[48:51], s70 offen offset:2048 lds
    buffer_load_dwordx4 v35, s[48:51], s70 offen offset:3072 lds
    s_mov_b32 m0, 90368
    s_nop 0
    buffer_load_dwordx4 v32, s[52:55], s70 offen lds
    buffer_load_dwordx4 v33, s[52:55], s70 offen offset:1024 lds
    buffer_load_dwordx4 v34, s[52:55], s70 offen offset:2048 lds
    s_waitcnt vmcnt(55)
    buffer_load_dwordx4 v35, s[52:55], s70 offen offset:3072 lds
    s_mov_b32 m0, 98560
    s_nop 0
    buffer_load_dwordx4 v32, s[56:59], s70 offen lds
    buffer_load_dwordx4 v33, s[56:59], s70 offen offset:1024 lds
    buffer_load_dwordx4 v34, s[56:59], s70 offen offset:2048 lds
    buffer_load_dwordx4 v35, s[56:59], s70 offen offset:3072 lds
    s_waitcnt vmcnt(38) lgkmcnt(0)
    s_barrier
    s_lshr_b64 s[80:81], s[80:81], 4
    s_and_b32 s78, s80, 15
    s_mul_i32 s71, s78, 245760
    s_lshl_b32 s43, s78, 7
    s_mov_b32 m0, 141696
    s_nop 0
    buffer_load_dwordx4 v36, s[44:47], s43 offen lds
    buffer_load_dwordx4 v37, s[44:47], s43 offen offset:1024 lds
    buffer_load_dwordx4 v38, s[44:47], s43 offen offset:2048 lds
    buffer_load_dwordx4 v39, s[44:47], s43 offen offset:3072 lds
    s_mov_b32 m0, 117120
    s_nop 0
    buffer_load_dwordx4 v28, s[48:51], s71 offen lds
    buffer_load_dwordx4 v29, s[48:51], s71 offen offset:1024 lds
    buffer_load_dwordx4 v30, s[48:51], s71 offen offset:2048 lds
    buffer_load_dwordx4 v31, s[48:51], s71 offen offset:3072 lds
    s_mov_b32 m0, 145792
    s_nop 0
    buffer_load_dwordx4 v40, s[44:47], s43 offen lds
    buffer_load_dwordx4 v41, s[44:47], s43 offen offset:1024 lds
    buffer_load_dwordx4 v42, s[44:47], s43 offen offset:2048 lds
    buffer_load_dwordx4 v43, s[44:47], s43 offen offset:3072 lds
    s_mov_b32 m0, 125312
    s_nop 0
    buffer_load_dwordx4 v28, s[52:55], s71 offen lds
    buffer_load_dwordx4 v29, s[52:55], s71 offen offset:1024 lds
    buffer_load_dwordx4 v30, s[52:55], s71 offen offset:2048 lds
    buffer_load_dwordx4 v31, s[52:55], s71 offen offset:3072 lds
    s_mov_b32 m0, 149888
    s_nop 0
    buffer_load_dwordx4 v44, s[44:47], s43 offen lds
    buffer_load_dwordx4 v45, s[44:47], s43 offen offset:1024 lds
    buffer_load_dwordx4 v46, s[44:47], s43 offen offset:2048 lds
    buffer_load_dwordx4 v47, s[44:47], s43 offen offset:3072 lds
    s_mov_b32 m0, 133504
    s_nop 0
    buffer_load_dwordx4 v28, s[56:59], s71 offen lds
    buffer_load_dwordx4 v29, s[56:59], s71 offen offset:1024 lds
    buffer_load_dwordx4 v30, s[56:59], s71 offen offset:2048 lds
    buffer_load_dwordx4 v31, s[56:59], s71 offen offset:3072 lds
    s_mov_b32 m0, 153984
    s_nop 0
    buffer_load_dwordx4 v48, s[44:47], s43 offen lds
    s_waitcnt vmcnt(55)
    buffer_load_dwordx4 v49, s[44:47], s43 offen offset:1024 lds
    s_mov_b32 m0, 121216
    s_nop 0
    buffer_load_dwordx4 v32, s[48:51], s71 offen lds
    buffer_load_dwordx4 v33, s[48:51], s71 offen offset:1024 lds
    buffer_load_dwordx4 v34, s[48:51], s71 offen offset:2048 lds
    buffer_load_dwordx4 v35, s[48:51], s71 offen offset:3072 lds
    s_mov_b32 m0, 129408
    s_nop 0
    buffer_load_dwordx4 v32, s[52:55], s71 offen lds
    buffer_load_dwordx4 v33, s[52:55], s71 offen offset:1024 lds
    buffer_load_dwordx4 v34, s[52:55], s71 offen offset:2048 lds
    s_waitcnt vmcnt(55)
    buffer_load_dwordx4 v35, s[52:55], s71 offen offset:3072 lds
    s_mov_b32 m0, 137600
    s_nop 0
    buffer_load_dwordx4 v32, s[56:59], s71 offen lds
    buffer_load_dwordx4 v33, s[56:59], s71 offen offset:1024 lds
    buffer_load_dwordx4 v34, s[56:59], s71 offen offset:2048 lds
    buffer_load_dwordx4 v35, s[56:59], s71 offen offset:3072 lds
    s_waitcnt vmcnt(38) lgkmcnt(0)
    s_barrier
    s_lshr_b64 s[80:81], s[80:81], 4
    s_and_b32 s78, s80, 15
    s_mul_i32 s72, s78, 245760
    s_lshl_b32 s43, s78, 7
    s_mov_b32 m0, 24576
    s_nop 0
    buffer_load_dwordx4 v36, s[44:47], s43 offen lds
    buffer_load_dwordx4 v37, s[44:47], s43 offen offset:1024 lds
    buffer_load_dwordx4 v38, s[44:47], s43 offen offset:2048 lds
    buffer_load_dwordx4 v39, s[44:47], s43 offen offset:3072 lds
    s_mov_b32 m0, 0
    s_nop 0
    buffer_load_dwordx4 v28, s[48:51], s72 offen lds
    buffer_load_dwordx4 v29, s[48:51], s72 offen offset:1024 lds
    buffer_load_dwordx4 v30, s[48:51], s72 offen offset:2048 lds
    buffer_load_dwordx4 v31, s[48:51], s72 offen offset:3072 lds
    s_mov_b32 m0, 28672
    s_nop 0
    buffer_load_dwordx4 v40, s[44:47], s43 offen lds
    buffer_load_dwordx4 v41, s[44:47], s43 offen offset:1024 lds
    buffer_load_dwordx4 v42, s[44:47], s43 offen offset:2048 lds
    buffer_load_dwordx4 v43, s[44:47], s43 offen offset:3072 lds
    s_mov_b32 m0, 8192
    s_nop 0
    buffer_load_dwordx4 v28, s[52:55], s72 offen lds
    buffer_load_dwordx4 v29, s[52:55], s72 offen offset:1024 lds
    buffer_load_dwordx4 v30, s[52:55], s72 offen offset:2048 lds
    buffer_load_dwordx4 v31, s[52:55], s72 offen offset:3072 lds
    s_mov_b32 m0, 32768
    s_nop 0
    buffer_load_dwordx4 v44, s[44:47], s43 offen lds
    buffer_load_dwordx4 v45, s[44:47], s43 offen offset:1024 lds
    buffer_load_dwordx4 v46, s[44:47], s43 offen offset:2048 lds
    buffer_load_dwordx4 v47, s[44:47], s43 offen offset:3072 lds
    s_mov_b32 m0, 16384
    s_nop 0
    buffer_load_dwordx4 v28, s[56:59], s72 offen lds
    buffer_load_dwordx4 v29, s[56:59], s72 offen offset:1024 lds
    buffer_load_dwordx4 v30, s[56:59], s72 offen offset:2048 lds
    buffer_load_dwordx4 v31, s[56:59], s72 offen offset:3072 lds
    s_mov_b32 m0, 36864
    s_nop 0
    buffer_load_dwordx4 v48, s[44:47], s43 offen lds
    s_waitcnt vmcnt(55)
    buffer_load_dwordx4 v49, s[44:47], s43 offen offset:1024 lds
    s_mov_b32 m0, 4096
    s_nop 0
    buffer_load_dwordx4 v32, s[48:51], s72 offen lds
    buffer_load_dwordx4 v33, s[48:51], s72 offen offset:1024 lds
    buffer_load_dwordx4 v34, s[48:51], s72 offen offset:2048 lds
    buffer_load_dwordx4 v35, s[48:51], s72 offen offset:3072 lds
    s_mov_b32 m0, 12288
    s_nop 0
    buffer_load_dwordx4 v32, s[52:55], s72 offen lds
    buffer_load_dwordx4 v33, s[52:55], s72 offen offset:1024 lds
    buffer_load_dwordx4 v34, s[52:55], s72 offen offset:2048 lds
    s_waitcnt vmcnt(55)
    buffer_load_dwordx4 v35, s[52:55], s72 offen offset:3072 lds
    s_mov_b32 m0, 20480
    s_nop 0
    buffer_load_dwordx4 v32, s[56:59], s72 offen lds
    buffer_load_dwordx4 v33, s[56:59], s72 offen offset:1024 lds
    buffer_load_dwordx4 v34, s[56:59], s72 offen offset:2048 lds
    buffer_load_dwordx4 v35, s[56:59], s72 offen offset:3072 lds
    s_waitcnt vmcnt(38) lgkmcnt(0)
    s_barrier
    s_lshr_b64 s[80:81], s[80:81], 4
    s_and_b32 s78, s80, 15
    s_mul_i32 s73, s78, 245760
    s_lshl_b32 s43, s78, 7
    s_mov_b32 m0, 63616
    s_nop 0
    buffer_load_dwordx4 v36, s[44:47], s43 offen lds
    buffer_load_dwordx4 v37, s[44:47], s43 offen offset:1024 lds
    buffer_load_dwordx4 v38, s[44:47], s43 offen offset:2048 lds
    buffer_load_dwordx4 v39, s[44:47], s43 offen offset:3072 lds
    s_mov_b32 m0, 39040
    s_nop 0
    buffer_load_dwordx4 v28, s[48:51], s73 offen lds
    buffer_load_dwordx4 v29, s[48:51], s73 offen offset:1024 lds
    buffer_load_dwordx4 v30, s[48:51], s73 offen offset:2048 lds
    buffer_load_dwordx4 v31, s[48:51], s73 offen offset:3072 lds
    s_mov_b32 m0, 67712
    s_nop 0
    buffer_load_dwordx4 v40, s[44:47], s43 offen lds
    buffer_load_dwordx4 v41, s[44:47], s43 offen offset:1024 lds
    buffer_load_dwordx4 v42, s[44:47], s43 offen offset:2048 lds
    buffer_load_dwordx4 v43, s[44:47], s43 offen offset:3072 lds
    s_mov_b32 m0, 47232
    s_nop 0
    buffer_load_dwordx4 v28, s[52:55], s73 offen lds
    buffer_load_dwordx4 v29, s[52:55], s73 offen offset:1024 lds
    buffer_load_dwordx4 v30, s[52:55], s73 offen offset:2048 lds
    buffer_load_dwordx4 v31, s[52:55], s73 offen offset:3072 lds
    s_mov_b32 m0, 71808
    s_nop 0
    buffer_load_dwordx4 v44, s[44:47], s43 offen lds
    buffer_load_dwordx4 v45, s[44:47], s43 offen offset:1024 lds
    buffer_load_dwordx4 v46, s[44:47], s43 offen offset:2048 lds
    buffer_load_dwordx4 v47, s[44:47], s43 offen offset:3072 lds
    s_mov_b32 m0, 55424
    s_nop 0
    buffer_load_dwordx4 v28, s[56:59], s73 offen lds
    buffer_load_dwordx4 v29, s[56:59], s73 offen offset:1024 lds
    buffer_load_dwordx4 v30, s[56:59], s73 offen offset:2048 lds
    buffer_load_dwordx4 v31, s[56:59], s73 offen offset:3072 lds
    s_mov_b32 m0, 75904
    s_nop 0
    buffer_load_dwordx4 v48, s[44:47], s43 offen lds
    s_waitcnt vmcnt(55)
    buffer_load_dwordx4 v49, s[44:47], s43 offen offset:1024 lds
    s_mov_b32 m0, 43136
    s_nop 0
    buffer_load_dwordx4 v32, s[48:51], s73 offen lds
    buffer_load_dwordx4 v33, s[48:51], s73 offen offset:1024 lds
    buffer_load_dwordx4 v34, s[48:51], s73 offen offset:2048 lds
    buffer_load_dwordx4 v35, s[48:51], s73 offen offset:3072 lds
    s_mov_b32 m0, 51328
    s_nop 0
    buffer_load_dwordx4 v32, s[52:55], s73 offen lds
    buffer_load_dwordx4 v33, s[52:55], s73 offen offset:1024 lds
    buffer_load_dwordx4 v34, s[52:55], s73 offen offset:2048 lds
    s_waitcnt vmcnt(55)
    buffer_load_dwordx4 v35, s[52:55], s73 offen offset:3072 lds
    s_mov_b32 m0, 59520
    s_nop 0
    buffer_load_dwordx4 v32, s[56:59], s73 offen lds
    buffer_load_dwordx4 v33, s[56:59], s73 offen offset:1024 lds
    buffer_load_dwordx4 v34, s[56:59], s73 offen offset:2048 lds
    buffer_load_dwordx4 v35, s[56:59], s73 offen offset:3072 lds
    s_waitcnt vmcnt(38) lgkmcnt(0)
    s_barrier
    s_lshr_b64 s[80:81], s[80:81], 4
    s_and_b32 s78, s80, 15
    s_mul_i32 s74, s78, 245760
    s_lshl_b32 s43, s78, 7
    s_mov_b32 m0, 102656
    s_nop 0
    buffer_load_dwordx4 v36, s[44:47], s43 offen lds
    buffer_load_dwordx4 v37, s[44:47], s43 offen offset:1024 lds
    buffer_load_dwordx4 v38, s[44:47], s43 offen offset:2048 lds
    buffer_load_dwordx4 v39, s[44:47], s43 offen offset:3072 lds
    s_mov_b32 m0, 78080
    s_nop 0
    buffer_load_dwordx4 v28, s[48:51], s74 offen lds
    buffer_load_dwordx4 v29, s[48:51], s74 offen offset:1024 lds
    buffer_load_dwordx4 v30, s[48:51], s74 offen offset:2048 lds
    buffer_load_dwordx4 v31, s[48:51], s74 offen offset:3072 lds
    s_mov_b32 m0, 106752
    s_nop 0
    buffer_load_dwordx4 v40, s[44:47], s43 offen lds
    buffer_load_dwordx4 v41, s[44:47], s43 offen offset:1024 lds
    buffer_load_dwordx4 v42, s[44:47], s43 offen offset:2048 lds
    buffer_load_dwordx4 v43, s[44:47], s43 offen offset:3072 lds
    s_mov_b32 m0, 86272
    s_nop 0
    buffer_load_dwordx4 v28, s[52:55], s74 offen lds
    buffer_load_dwordx4 v29, s[52:55], s74 offen offset:1024 lds
    buffer_load_dwordx4 v30, s[52:55], s74 offen offset:2048 lds
    buffer_load_dwordx4 v31, s[52:55], s74 offen offset:3072 lds
    s_mov_b32 m0, 110848
    s_nop 0
    buffer_load_dwordx4 v44, s[44:47], s43 offen lds
    buffer_load_dwordx4 v45, s[44:47], s43 offen offset:1024 lds
    buffer_load_dwordx4 v46, s[44:47], s43 offen offset:2048 lds
    buffer_load_dwordx4 v47, s[44:47], s43 offen offset:3072 lds
    s_mov_b32 m0, 82176
    s_nop 0
    buffer_load_dwordx4 v32, s[48:51], s74 offen lds
    buffer_load_dwordx4 v33, s[48:51], s74 offen offset:1024 lds
    buffer_load_dwordx4 v34, s[48:51], s74 offen offset:2048 lds
    buffer_load_dwordx4 v35, s[48:51], s74 offen offset:3072 lds
    s_mov_b32 m0, 114944
    s_nop 0
    buffer_load_dwordx4 v48, s[44:47], s43 offen lds
    s_waitcnt vmcnt(55)
    buffer_load_dwordx4 v49, s[44:47], s43 offen offset:1024 lds
    s_mov_b32 m0, 90368
    s_nop 0
    buffer_load_dwordx4 v32, s[52:55], s74 offen lds
    buffer_load_dwordx4 v33, s[52:55], s74 offen offset:1024 lds
    buffer_load_dwordx4 v34, s[52:55], s74 offen offset:2048 lds
    buffer_load_dwordx4 v35, s[52:55], s74 offen offset:3072 lds
    s_waitcnt vmcnt(30) lgkmcnt(0)
    s_barrier
    s_lshr_b64 s[80:81], s[80:81], 4
    s_and_b32 s78, s80, 15
    s_mul_i32 s75, s78, 245760
    s_lshl_b32 s43, s78, 7
    s_mov_b32 m0, 141696
    s_nop 0
    buffer_load_dwordx4 v36, s[44:47], s43 offen lds
    buffer_load_dwordx4 v37, s[44:47], s43 offen offset:1024 lds
    buffer_load_dwordx4 v38, s[44:47], s43 offen offset:2048 lds
    buffer_load_dwordx4 v39, s[44:47], s43 offen offset:3072 lds
    s_mov_b32 m0, 117120
    s_nop 0
    buffer_load_dwordx4 v28, s[48:51], s75 offen lds
    buffer_load_dwordx4 v29, s[48:51], s75 offen offset:1024 lds
    buffer_load_dwordx4 v30, s[48:51], s75 offen offset:2048 lds
    buffer_load_dwordx4 v31, s[48:51], s75 offen offset:3072 lds
    s_mov_b32 m0, 145792
    s_nop 0
    buffer_load_dwordx4 v40, s[44:47], s43 offen lds
    buffer_load_dwordx4 v41, s[44:47], s43 offen offset:1024 lds
    buffer_load_dwordx4 v42, s[44:47], s43 offen offset:2048 lds
    buffer_load_dwordx4 v43, s[44:47], s43 offen offset:3072 lds
    s_mov_b32 m0, 125312
    s_nop 0
    buffer_load_dwordx4 v28, s[52:55], s75 offen lds
    buffer_load_dwordx4 v29, s[52:55], s75 offen offset:1024 lds
    buffer_load_dwordx4 v30, s[52:55], s75 offen offset:2048 lds
    buffer_load_dwordx4 v31, s[52:55], s75 offen offset:3072 lds
    s_mov_b32 m0, 149888
    s_nop 0
    buffer_load_dwordx4 v44, s[44:47], s43 offen lds
    buffer_load_dwordx4 v45, s[44:47], s43 offen offset:1024 lds
    buffer_load_dwordx4 v46, s[44:47], s43 offen offset:2048 lds
    buffer_load_dwordx4 v47, s[44:47], s43 offen offset:3072 lds
    s_mov_b32 m0, 121216
    s_nop 0
    buffer_load_dwordx4 v32, s[48:51], s75 offen lds
    buffer_load_dwordx4 v33, s[48:51], s75 offen offset:1024 lds
    buffer_load_dwordx4 v34, s[48:51], s75 offen offset:2048 lds
    buffer_load_dwordx4 v35, s[48:51], s75 offen offset:3072 lds
    s_mov_b32 m0, 153984
    s_nop 0
    buffer_load_dwordx4 v48, s[44:47], s43 offen lds
    buffer_load_dwordx4 v49, s[44:47], s43 offen offset:1024 lds
    s_mov_b32 m0, 129408
    s_nop 0
    buffer_load_dwordx4 v32, s[52:55], s75 offen lds
    buffer_load_dwordx4 v33, s[52:55], s75 offen offset:1024 lds
    buffer_load_dwordx4 v34, s[52:55], s75 offen offset:2048 lds
    buffer_load_dwordx4 v35, s[52:55], s75 offen offset:3072 lds
    s_waitcnt vmcnt(30) lgkmcnt(0)
    s_barrier
    s_lshr_b64 s[80:81], s[80:81], 4
    s_and_b32 s78, s80, 15
    s_mul_i32 s76, s78, 245760
    s_lshl_b32 s43, s78, 7
    s_mov_b32 m0, 24576
    s_nop 0
    buffer_load_dwordx4 v36, s[44:47], s43 offen lds
    buffer_load_dwordx4 v37, s[44:47], s43 offen offset:1024 lds
    buffer_load_dwordx4 v38, s[44:47], s43 offen offset:2048 lds
    buffer_load_dwordx4 v39, s[44:47], s43 offen offset:3072 lds
    s_mov_b32 m0, 0
    s_nop 0
    buffer_load_dwordx4 v28, s[48:51], s76 offen lds
    buffer_load_dwordx4 v29, s[48:51], s76 offen offset:1024 lds
    buffer_load_dwordx4 v30, s[48:51], s76 offen offset:2048 lds
    buffer_load_dwordx4 v31, s[48:51], s76 offen offset:3072 lds
    s_mov_b32 m0, 28672
    s_nop 0
    buffer_load_dwordx4 v40, s[44:47], s43 offen lds
    buffer_load_dwordx4 v41, s[44:47], s43 offen offset:1024 lds
    buffer_load_dwordx4 v42, s[44:47], s43 offen offset:2048 lds
    buffer_load_dwordx4 v43, s[44:47], s43 offen offset:3072 lds
    s_mov_b32 m0, 8192
    s_nop 0
    buffer_load_dwordx4 v28, s[52:55], s76 offen lds
    buffer_load_dwordx4 v29, s[52:55], s76 offen offset:1024 lds
    buffer_load_dwordx4 v30, s[52:55], s76 offen offset:2048 lds
    buffer_load_dwordx4 v31, s[52:55], s76 offen offset:3072 lds
    s_mov_b32 m0, 32768
    s_nop 0
    buffer_load_dwordx4 v44, s[44:47], s43 offen lds
    buffer_load_dwordx4 v45, s[44:47], s43 offen offset:1024 lds
    buffer_load_dwordx4 v46, s[44:47], s43 offen offset:2048 lds
    buffer_load_dwordx4 v47, s[44:47], s43 offen offset:3072 lds
    s_mov_b32 m0, 4096
    s_nop 0
    buffer_load_dwordx4 v32, s[48:51], s76 offen lds
    buffer_load_dwordx4 v33, s[48:51], s76 offen offset:1024 lds
    buffer_load_dwordx4 v34, s[48:51], s76 offen offset:2048 lds
    buffer_load_dwordx4 v35, s[48:51], s76 offen offset:3072 lds
    s_mov_b32 m0, 36864
    s_nop 0
    buffer_load_dwordx4 v48, s[44:47], s43 offen lds
    buffer_load_dwordx4 v49, s[44:47], s43 offen offset:1024 lds
    s_mov_b32 m0, 12288
    s_nop 0
    buffer_load_dwordx4 v32, s[52:55], s76 offen lds
    buffer_load_dwordx4 v33, s[52:55], s76 offen offset:1024 lds
    buffer_load_dwordx4 v34, s[52:55], s76 offen offset:2048 lds
    buffer_load_dwordx4 v35, s[52:55], s76 offen offset:3072 lds
    s_waitcnt vmcnt(30) lgkmcnt(0)
    s_barrier
    s_lshr_b64 s[80:81], s[80:81], 4
    s_and_b32 s78, s80, 15
    s_mul_i32 s77, s78, 245760
    s_lshl_b32 s43, s78, 7
    s_mov_b32 m0, 63616
    s_nop 0
    buffer_load_dwordx4 v36, s[44:47], s43 offen lds
    buffer_load_dwordx4 v37, s[44:47], s43 offen offset:1024 lds
    buffer_load_dwordx4 v38, s[44:47], s43 offen offset:2048 lds
    buffer_load_dwordx4 v39, s[44:47], s43 offen offset:3072 lds
    s_mov_b32 m0, 39040
    s_nop 0
    buffer_load_dwordx4 v28, s[48:51], s77 offen lds
    buffer_load_dwordx4 v29, s[48:51], s77 offen offset:1024 lds
    buffer_load_dwordx4 v30, s[48:51], s77 offen offset:2048 lds
    buffer_load_dwordx4 v31, s[48:51], s77 offen offset:3072 lds
    s_mov_b32 m0, 67712
    s_nop 0
    buffer_load_dwordx4 v40, s[44:47], s43 offen lds
    buffer_load_dwordx4 v41, s[44:47], s43 offen offset:1024 lds
    buffer_load_dwordx4 v42, s[44:47], s43 offen offset:2048 lds
    buffer_load_dwordx4 v43, s[44:47], s43 offen offset:3072 lds
    s_mov_b32 m0, 47232
    s_nop 0
    buffer_load_dwordx4 v28, s[52:55], s77 offen lds
    buffer_load_dwordx4 v29, s[52:55], s77 offen offset:1024 lds
    buffer_load_dwordx4 v30, s[52:55], s77 offen offset:2048 lds
    buffer_load_dwordx4 v31, s[52:55], s77 offen offset:3072 lds
    s_mov_b32 m0, 71808
    s_nop 0
    buffer_load_dwordx4 v44, s[44:47], s43 offen lds
    buffer_load_dwordx4 v45, s[44:47], s43 offen offset:1024 lds
    buffer_load_dwordx4 v46, s[44:47], s43 offen offset:2048 lds
    buffer_load_dwordx4 v47, s[44:47], s43 offen offset:3072 lds
    s_mov_b32 m0, 43136
    s_nop 0
    buffer_load_dwordx4 v32, s[48:51], s77 offen lds
    buffer_load_dwordx4 v33, s[48:51], s77 offen offset:1024 lds
    buffer_load_dwordx4 v34, s[48:51], s77 offen offset:2048 lds
    buffer_load_dwordx4 v35, s[48:51], s77 offen offset:3072 lds
    s_mov_b32 m0, 75904
    s_nop 0
    buffer_load_dwordx4 v48, s[44:47], s43 offen lds
    buffer_load_dwordx4 v49, s[44:47], s43 offen offset:1024 lds
    s_mov_b32 m0, 51328
    s_nop 0
    buffer_load_dwordx4 v32, s[52:55], s77 offen lds
    buffer_load_dwordx4 v33, s[52:55], s77 offen offset:1024 lds
    buffer_load_dwordx4 v34, s[52:55], s77 offen offset:2048 lds
    buffer_load_dwordx4 v35, s[52:55], s77 offen offset:3072 lds
    s_waitcnt vmcnt(30) lgkmcnt(0)
    s_barrier
    s_lshr_b64 s[80:81], s[80:81], 4
    s_and_b32 s78, s80, 15
    s_mov_b32 m0, 94464
    s_nop 0
    buffer_load_dwordx4 v28, s[56:59], s74 offen lds
    buffer_load_dwordx4 v29, s[56:59], s74 offen offset:1024 lds
    buffer_load_dwordx4 v30, s[56:59], s74 offen offset:2048 lds
    buffer_load_dwordx4 v31, s[56:59], s74 offen offset:3072 lds
    s_mov_b32 m0, 98560
    s_nop 0
    buffer_load_dwordx4 v32, s[56:59], s74 offen lds
    buffer_load_dwordx4 v33, s[56:59], s74 offen offset:1024 lds
    buffer_load_dwordx4 v34, s[56:59], s74 offen offset:2048 lds
    buffer_load_dwordx4 v35, s[56:59], s74 offen offset:3072 lds
    s_mov_b32 m0, 133504
    s_nop 0
    buffer_load_dwordx4 v28, s[56:59], s75 offen lds
    buffer_load_dwordx4 v29, s[56:59], s75 offen offset:1024 lds
    buffer_load_dwordx4 v30, s[56:59], s75 offen offset:2048 lds
    buffer_load_dwordx4 v31, s[56:59], s75 offen offset:3072 lds
    s_waitcnt vmcnt(12) lgkmcnt(0)
    s_barrier
    s_mov_b32 m0, 137600
    s_nop 0
    buffer_load_dwordx4 v32, s[56:59], s75 offen lds
    buffer_load_dwordx4 v33, s[56:59], s75 offen offset:1024 lds
    buffer_load_dwordx4 v34, s[56:59], s75 offen offset:2048 lds
    buffer_load_dwordx4 v35, s[56:59], s75 offen offset:3072 lds
    s_mov_b32 m0, 16384
    s_nop 0
    buffer_load_dwordx4 v28, s[56:59], s76 offen lds
    buffer_load_dwordx4 v29, s[56:59], s76 offen offset:1024 lds
    buffer_load_dwordx4 v30, s[56:59], s76 offen offset:2048 lds
    buffer_load_dwordx4 v31, s[56:59], s76 offen offset:3072 lds
    s_mov_b32 m0, 20480
    s_nop 0
    buffer_load_dwordx4 v32, s[56:59], s76 offen lds
    buffer_load_dwordx4 v33, s[56:59], s76 offen offset:1024 lds
    buffer_load_dwordx4 v34, s[56:59], s76 offen offset:2048 lds
    buffer_load_dwordx4 v35, s[56:59], s76 offen offset:3072 lds
    s_mov_b32 m0, 55424
    s_nop 0
    buffer_load_dwordx4 v28, s[56:59], s77 offen lds
    buffer_load_dwordx4 v29, s[56:59], s77 offen offset:1024 lds
    buffer_load_dwordx4 v30, s[56:59], s77 offen offset:2048 lds
    buffer_load_dwordx4 v31, s[56:59], s77 offen offset:3072 lds
    s_mov_b32 m0, 59520
    s_nop 0
    buffer_load_dwordx4 v32, s[56:59], s77 offen lds
    buffer_load_dwordx4 v33, s[56:59], s77 offen offset:1024 lds
    buffer_load_dwordx4 v34, s[56:59], s77 offen offset:2048 lds
    buffer_load_dwordx4 v35, s[56:59], s77 offen offset:3072 lds
    s_mov_b32 s10, 20480
    v_lshrrev_b32 v52, 5, v1
    v_lshlrev_b32 v52, 3, v52
    v_add_u32 v53, 2, v52
    v_add_u32 v54, 4, v52
    v_add_u32 v55, 6, v52
    v_add_u32 v56, 16, v52
    v_add_u32 v57, 18, v52
    v_add_u32 v58, 20, v52
    v_add_u32 v59, 22, v52
    v_and_b32 v7, 3, v5
    v_mul_u32_u24 v7, 1280, v7
    v_add_u32 v60, v7, v50
    v_xor_b32 v61, 64, v60
    v_add_u32 v61, 4096, v61
    v_add_u32 v62, 8192, v60
    v_add_u32 v63, 8192, v61
    s_mov_b32 s5, 0xbfe10856
    s_mov_b32 s6, 0xaff80255
    s_mov_b32 s7, 0xabfe4015
    s_mov_b32 s8, 0xaa7fd005
    s_mov_b32 s9, 0x6adfb401
    s_cmp_eq_u32 s42, 1
    s_cselect_b32 s5, 0xabfe4015, s5
    s_cselect_b32 s6, 0xaa7fd005, s6
    s_cselect_b32 s7, 0x6adfb401, s7
    s_cselect_b32 s8, 0xbfe10856, s8
    s_cselect_b32 s9, 0xaff80255, s9
    s_cmp_eq_u32 s42, 2
    s_cselect_b32 s5, 0x6adfb401, s5
    s_cselect_b32 s6, 0xbfe10856, s6
    s_cselect_b32 s7, 0xaff80255, s7
    s_cselect_b32 s8, 0xabfe4015, s8
    s_cselect_b32 s9, 0xaa7fd005, s9
    s_cmp_eq_u32 s42, 3
    s_cselect_b32 s5, 0xaff80255, s5
    s_cselect_b32 s6, 0xabfe4015, s6
    s_cselect_b32 s7, 0xaa7fd005, s7
    s_cselect_b32 s8, 0x6adfb401, s8
    s_cselect_b32 s9, 0xbfe10856, s9
    s_cmp_eq_u32 s42, 4
    s_cselect_b32 s5, 0xaa7fd005, s5
    s_cselect_b32 s6, 0x6adfb401, s6
    s_cselect_b32 s7, 0xbfe10856, s7
    s_cselect_b32 s8, 0xaff80255, s8
    s_cselect_b32 s9, 0xabfe4015, s9
    s_mul_i32 s4, s42, 163840
    s_mov_b32 m0, 0
    v_bfe_u32 v64, s5, v52, 2
    v_mad_u32_u24 v64, v64, s10, v60
    buffer_load_dwordx4 v64, s[60:63], s4 offen lds
    v_bfe_u32 v65, s5, v53, 2
    v_mad_u32_u24 v65, v65, s10, v61
    buffer_load_dwordx4 v65, s[60:63], s4 offen offset:1024 lds
    v_bfe_u32 v64, s5, v54, 2
    v_mad_u32_u24 v64, v64, s10, v62
    buffer_load_dwordx4 v64, s[60:63], s4 offen offset:2048 lds
    v_bfe_u32 v65, s5, v55, 2
    v_mad_u32_u24 v65, v65, s10, v63
    buffer_load_dwordx4 v65, s[60:63], s4 offen offset:3072 lds
    s_mov_b32 m0, 4096
    v_bfe_u32 v64, s5, v56, 2
    v_mad_u32_u24 v64, v64, s10, v60
    buffer_load_dwordx4 v64, s[60:63], s4 offen lds
    v_bfe_u32 v65, s5, v57, 2
    v_mad_u32_u24 v65, v65, s10, v61
    buffer_load_dwordx4 v65, s[60:63], s4 offen offset:1024 lds
    v_bfe_u32 v64, s5, v58, 2
    v_mad_u32_u24 v64, v64, s10, v62
    buffer_load_dwordx4 v64, s[60:63], s4 offen offset:2048 lds
    v_bfe_u32 v65, s5, v59, 2
    v_mad_u32_u24 v65, v65, s10, v63
    buffer_load_dwordx4 v65, s[60:63], s4 offen offset:3072 lds
    s_add_u32 s4, s4, 81920
    s_cmp_eq_u32 s4, 819200
    s_cselect_b32 s4, 0, s4
    s_mov_b32 m0, 8192
    v_bfe_u32 v64, s6, v52, 2
    v_mad_u32_u24 v64, v64, s10, v60
    buffer_load_dwordx4 v64, s[60:63], s4 offen lds
    v_bfe_u32 v65, s6, v53, 2
    v_mad_u32_u24 v65, v65, s10, v61
    buffer_load_dwordx4 v65, s[60:63], s4 offen offset:1024 lds
    v_bfe_u32 v64, s6, v54, 2
    v_mad_u32_u24 v64, v64, s10, v62
    buffer_load_dwordx4 v64, s[60:63], s4 offen offset:2048 lds
    v_bfe_u32 v65, s6, v55, 2
    v_mad_u32_u24 v65, v65, s10, v63
    buffer_load_dwordx4 v65, s[60:63], s4 offen offset:3072 lds
    s_mov_b32 m0, 12288
    v_bfe_u32 v64, s6, v56, 2
    v_mad_u32_u24 v64, v64, s10, v60
    buffer_load_dwordx4 v64, s[60:63], s4 offen lds
    v_bfe_u32 v65, s6, v57, 2
    v_mad_u32_u24 v65, v65, s10, v61
    buffer_load_dwordx4 v65, s[60:63], s4 offen offset:1024 lds
    v_bfe_u32 v64, s6, v58, 2
    v_mad_u32_u24 v64, v64, s10, v62
    buffer_load_dwordx4 v64, s[60:63], s4 offen offset:2048 lds
    v_bfe_u32 v65, s6, v59, 2
    v_mad_u32_u24 v65, v65, s10, v63
    buffer_load_dwordx4 v65, s[60:63], s4 offen offset:3072 lds
    s_add_u32 s4, s4, 81920
    s_cmp_eq_u32 s4, 819200
    s_cselect_b32 s4, 0, s4
    s_waitcnt vmcnt(16)
    v_mov_b32 v5, 157980
    v_mov_b32 v6, 1
    s_mov_b64 exec, 1
    ds_add_u32 v5, v6
    s_mov_b64 exec, -1
    v_mov_b32 v5, 157972
    v_mov_b32 v6, 1
    s_mov_b64 exec, 1
    ds_add_u32 v5, v6
    s_mov_b64 exec, -1
    s_mov_b32 m0, 24576
    v_bfe_u32 v64, s7, v52, 2
    v_mad_u32_u24 v64, v64, s10, v60
    buffer_load_dwordx4 v64, s[60:63], s4 offen lds
    v_bfe_u32 v65, s7, v53, 2
    v_mad_u32_u24 v65, v65, s10, v61
    buffer_load_dwordx4 v65, s[60:63], s4 offen offset:1024 lds
    v_bfe_u32 v64, s7, v54, 2
    v_mad_u32_u24 v64, v64, s10, v62
    buffer_load_dwordx4 v64, s[60:63], s4 offen offset:2048 lds
    v_bfe_u32 v65, s7, v55, 2
    v_mad_u32_u24 v65, v65, s10, v63
    buffer_load_dwordx4 v65, s[60:63], s4 offen offset:3072 lds
    s_mov_b32 m0, 28672
    v_bfe_u32 v64, s7, v56, 2
    v_mad_u32_u24 v64, v64, s10, v60
    buffer_load_dwordx4 v64, s[60:63], s4 offen lds
    v_bfe_u32 v65, s7, v57, 2
    v_mad_u32_u24 v65, v65, s10, v61
    buffer_load_dwordx4 v65, s[60:63], s4 offen offset:1024 lds
    v_bfe_u32 v64, s7, v58, 2
    v_mad_u32_u24 v64, v64, s10, v62
    buffer_load_dwordx4 v64, s[60:63], s4 offen offset:2048 lds
    v_bfe_u32 v65, s7, v59, 2
    v_mad_u32_u24 v65, v65, s10, v63
    buffer_load_dwordx4 v65, s[60:63], s4 offen offset:3072 lds
    s_add_u32 s4, s4, 81920
    s_cmp_eq_u32 s4, 819200
    s_cselect_b32 s4, 0, s4
    s_mov_b32 m0, 123136
    v_bfe_u32 v64, s8, v52, 2
    v_mad_u32_u24 v64, v64, s10, v60
    buffer_load_dwordx4 v64, s[60:63], s4 offen lds
    v_bfe_u32 v65, s8, v53, 2
    v_mad_u32_u24 v65, v65, s10, v61
    buffer_load_dwordx4 v65, s[60:63], s4 offen offset:1024 lds
    v_bfe_u32 v64, s8, v54, 2
    v_mad_u32_u24 v64, v64, s10, v62
    buffer_load_dwordx4 v64, s[60:63], s4 offen offset:2048 lds
    v_bfe_u32 v65, s8, v55, 2
    v_mad_u32_u24 v65, v65, s10, v63
    buffer_load_dwordx4 v65, s[60:63], s4 offen offset:3072 lds
    s_mov_b32 m0, 127232
    v_bfe_u32 v64, s8, v56, 2
    v_mad_u32_u24 v64, v64, s10, v60
    buffer_load_dwordx4 v64, s[60:63], s4 offen lds
    v_bfe_u32 v65, s8, v57, 2
    v_mad_u32_u24 v65, v65, s10, v61
    buffer_load_dwordx4 v65, s[60:63], s4 offen offset:1024 lds
    v_bfe_u32 v64, s8, v58, 2
    v_mad_u32_u24 v64, v64, s10, v62
    buffer_load_dwordx4 v64, s[60:63], s4 offen offset:2048 lds
    v_bfe_u32 v65, s8, v59, 2
    v_mad_u32_u24 v65, v65, s10, v63
    buffer_load_dwordx4 v65, s[60:63], s4 offen offset:3072 lds
    s_add_u32 s4, s4, 81920
    s_cmp_eq_u32 s4, 819200
    s_cselect_b32 s4, 0, s4
    s_mov_b32 m0, 80000
    v_bfe_u32 v64, s9, v52, 2
    v_mad_u32_u24 v64, v64, s10, v60
    buffer_load_dwordx4 v64, s[60:63], s4 offen lds
    v_bfe_u32 v65, s9, v53, 2
    v_mad_u32_u24 v65, v65, s10, v61
    buffer_load_dwordx4 v65, s[60:63], s4 offen offset:1024 lds
    v_bfe_u32 v64, s9, v54, 2
    v_mad_u32_u24 v64, v64, s10, v62
    buffer_load_dwordx4 v64, s[60:63], s4 offen offset:2048 lds
    v_bfe_u32 v65, s9, v55, 2
    v_mad_u32_u24 v65, v65, s10, v63
    buffer_load_dwordx4 v65, s[60:63], s4 offen offset:3072 lds
    s_mov_b32 m0, 84096
    v_bfe_u32 v64, s9, v56, 2
    v_mad_u32_u24 v64, v64, s10, v60
    buffer_load_dwordx4 v64, s[60:63], s4 offen lds
    v_bfe_u32 v65, s9, v57, 2
    v_mad_u32_u24 v65, v65, s10, v61
    buffer_load_dwordx4 v65, s[60:63], s4 offen offset:1024 lds
    v_bfe_u32 v64, s9, v58, 2
    v_mad_u32_u24 v64, v64, s10, v62
    buffer_load_dwordx4 v64, s[60:63], s4 offen offset:2048 lds
    v_bfe_u32 v65, s9, v59, 2
    v_mad_u32_u24 v65, v65, s10, v63
    buffer_load_dwordx4 v65, s[60:63], s4 offen offset:3072 lds
    s_add_u32 s4, s4, 81920
    s_cmp_eq_u32 s4, 819200
    s_cselect_b32 s4, 0, s4
    s_waitcnt vmcnt(0)
    v_mov_b32 v7, 157980
    v_mov_b32 v6, 1
    s_mov_b64 exec, 1
    ds_add_u32 v7, v6
    s_mov_b64 exec, -1
Lcw_6:
    s_sub_u32 s35, s35, 1
    s_cbranch_scc1 Lend
    ds_read_b32 v6, v5
    s_waitcnt lgkmcnt(0)
    v_readfirstlane_b32 s38, v6
    s_nop 0
    s_cmp_lt_u32 s38, 8
    s_cbranch_scc1 Lcw_6
    s_lshl_b32 s36, s32, 7
    s_add_u32 s36, s36, 8257536
    v_mov_b32 v69, s36
    buffer_load_dwordx4 v[70:73], v69, s[28:31], 0 offen sc1
    v_mov_b32 v5, 157976
Lcw_7:
    s_sub_u32 s35, s35, 1
    s_cbranch_scc1 Lend
    ds_read_b32 v6, v5
    s_waitcnt lgkmcnt(0)
    v_readfirstlane_b32 s38, v6
    s_nop 0
    s_cmp_lt_u32 s38, 7
    s_cbranch_scc1 Lcw_7
    s_mov_b32 m0, 32768
    v_bfe_u32 v64, s5, v52, 2
    v_mad_u32_u24 v64, v64, s10, v60
    buffer_load_dwordx4 v64, s[60:63], s4 offen lds
    v_bfe_u32 v65, s5, v53, 2
    v_mad_u32_u24 v65, v65, s10, v61
    buffer_load_dwordx4 v65, s[60:63], s4 offen offset:1024 lds
    v_bfe_u32 v64, s5, v54, 2
    v_mad_u32_u24 v64, v64, s10, v62
    buffer_load_dwordx4 v64, s[60:63], s4 offen offset:2048 lds
    v_bfe_u32 v65, s5, v55, 2
    v_mad_u32_u24 v65, v65, s10, v63
    buffer_load_dwordx4 v65, s[60:63], s4 offen offset:3072 lds
    s_mov_b32 m0, 36864
    v_bfe_u32 v64, s5, v56, 2
    v_mad_u32_u24 v64, v64, s10, v60
    buffer_load_dwordx4 v64, s[60:63], s4 offen lds
    v_bfe_u32 v65, s5, v57, 2
    v_mad_u32_u24 v65, v65, s10, v61
    buffer_load_dwordx4 v65, s[60:63], s4 offen offset:1024 lds
    v_bfe_u32 v64, s5, v58, 2
    v_mad_u32_u24 v64, v64, s10, v62
    buffer_load_dwordx4 v64, s[60:63], s4 offen offset:2048 lds
    v_bfe_u32 v65, s5, v59, 2
    v_mad_u32_u24 v65, v65, s10, v63
    buffer_load_dwordx4 v65, s[60:63], s4 offen offset:3072 lds
    s_add_u32 s4, s4, 81920
    s_cmp_eq_u32 s4, 819200
    s_cselect_b32 s4, 0, s4
    s_mov_b32 m0, 40960
    v_bfe_u32 v64, s6, v52, 2
    v_mad_u32_u24 v64, v64, s10, v60
    buffer_load_dwordx4 v64, s[60:63], s4 offen lds
    v_bfe_u32 v65, s6, v53, 2
    v_mad_u32_u24 v65, v65, s10, v61
    buffer_load_dwordx4 v65, s[60:63], s4 offen offset:1024 lds
    v_bfe_u32 v64, s6, v54, 2
    v_mad_u32_u24 v64, v64, s10, v62
    buffer_load_dwordx4 v64, s[60:63], s4 offen offset:2048 lds
    v_bfe_u32 v65, s6, v55, 2
    v_mad_u32_u24 v65, v65, s10, v63
    buffer_load_dwordx4 v65, s[60:63], s4 offen offset:3072 lds
    s_mov_b32 m0, 45056
    v_bfe_u32 v64, s6, v56, 2
    v_mad_u32_u24 v64, v64, s10, v60
    buffer_load_dwordx4 v64, s[60:63], s4 offen lds
    v_bfe_u32 v65, s6, v57, 2
    v_mad_u32_u24 v65, v65, s10, v61
    buffer_load_dwordx4 v65, s[60:63], s4 offen offset:1024 lds
    v_bfe_u32 v64, s6, v58, 2
    v_mad_u32_u24 v64, v64, s10, v62
    buffer_load_dwordx4 v64, s[60:63], s4 offen offset:2048 lds
    v_bfe_u32 v65, s6, v59, 2
    v_mad_u32_u24 v65, v65, s10, v63
    buffer_load_dwordx4 v65, s[60:63], s4 offen offset:3072 lds
    s_add_u32 s4, s4, 81920
    s_cmp_eq_u32 s4, 819200
    s_cselect_b32 s4, 0, s4
    s_mov_b32 m0, 63616
    v_bfe_u32 v64, s7, v52, 2
    v_mad_u32_u24 v64, v64, s10, v60
    buffer_load_dwordx4 v64, s[60:63], s4 offen lds
    v_bfe_u32 v65, s7, v53, 2
    v_mad_u32_u24 v65, v65, s10, v61
    buffer_load_dwordx4 v65, s[60:63], s4 offen offset:1024 lds
    v_bfe_u32 v64, s7, v54, 2
    v_mad_u32_u24 v64, v64, s10, v62
    buffer_load_dwordx4 v64, s[60:63], s4 offen offset:2048 lds
    v_bfe_u32 v65, s7, v55, 2
    v_mad_u32_u24 v65, v65, s10, v63
    buffer_load_dwordx4 v65, s[60:63], s4 offen offset:3072 lds
    s_mov_b32 m0, 67712
    v_bfe_u32 v64, s7, v56, 2
    v_mad_u32_u24 v64, v64, s10, v60
    buffer_load_dwordx4 v64, s[60:63], s4 offen lds
    v_bfe_u32 v65, s7, v57, 2
    v_mad_u32_u24 v65, v65, s10, v61
    buffer_load_dwordx4 v65, s[60:63], s4 offen offset:1024 lds
    v_bfe_u32 v64, s7, v58, 2
    v_mad_u32_u24 v64, v64, s10, v62
    buffer_load_dwordx4 v64, s[60:63], s4 offen offset:2048 lds
    v_bfe_u32 v65, s7, v59, 2
    v_mad_u32_u24 v65, v65, s10, v63
    buffer_load_dwordx4 v65, s[60:63], s4 offen offset:3072 lds
    s_add_u32 s4, s4, 81920
    s_cmp_eq_u32 s4, 819200
    s_cselect_b32 s4, 0, s4
    s_mov_b32 m0, 71808
    v_bfe_u32 v64, s8, v52, 2
    v_mad_u32_u24 v64, v64, s10, v60
    buffer_load_dwordx4 v64, s[60:63], s4 offen lds
    v_bfe_u32 v65, s8, v53, 2
    v_mad_u32_u24 v65, v65, s10, v61
    buffer_load_dwordx4 v65, s[60:63], s4 offen offset:1024 lds
    v_bfe_u32 v64, s8, v54, 2
    v_mad_u32_u24 v64, v64, s10, v62
    buffer_load_dwordx4 v64, s[60:63], s4 offen offset:2048 lds
    v_bfe_u32 v65, s8, v55, 2
    v_mad_u32_u24 v65, v65, s10, v63
    buffer_load_dwordx4 v65, s[60:63], s4 offen offset:3072 lds
    s_mov_b32 m0, 75904
    v_bfe_u32 v64, s8, v56, 2
    v_mad_u32_u24 v64, v64, s10, v60
    buffer_load_dwordx4 v64, s[60:63], s4 offen lds
    v_bfe_u32 v65, s8, v57, 2
    v_mad_u32_u24 v65, v65, s10, v61
    buffer_load_dwordx4 v65, s[60:63], s4 offen offset:1024 lds
    v_bfe_u32 v64, s8, v58, 2
    v_mad_u32_u24 v64, v64, s10, v62
    buffer_load_dwordx4 v64, s[60:63], s4 offen offset:2048 lds
    v_bfe_u32 v65, s8, v59, 2
    v_mad_u32_u24 v65, v65, s10, v63
    buffer_load_dwordx4 v65, s[60:63], s4 offen offset:3072 lds
    s_add_u32 s4, s4, 81920
    s_cmp_eq_u32 s4, 819200
    s_cselect_b32 s4, 0, s4
    s_mov_b32 m0, 49152
    v_bfe_u32 v64, s9, v52, 2
    v_mad_u32_u24 v64, v64, s10, v60
    buffer_load_dwordx4 v64, s[60:63], s4 offen lds
    v_bfe_u32 v65, s9, v53, 2
    v_mad_u32_u24 v65, v65, s10, v61
    buffer_load_dwordx4 v65, s[60:63], s4 offen offset:1024 lds
    v_bfe_u32 v64, s9, v54, 2
    v_mad_u32_u24 v64, v64, s10, v62
    buffer_load_dwordx4 v64, s[60:63], s4 offen offset:2048 lds
    v_bfe_u32 v65, s9, v55, 2
    v_mad_u32_u24 v65, v65, s10, v63
    buffer_load_dwordx4 v65, s[60:63], s4 offen offset:3072 lds
    s_mov_b32 m0, 88192
    v_bfe_u32 v64, s9, v56, 2
    v_mad_u32_u24 v64, v64, s10, v60
    buffer_load_dwordx4 v64, s[60:63], s4 offen lds
    v_bfe_u32 v65, s9, v57, 2
    v_mad_u32_u24 v65, v65, s10, v61
    buffer_load_dwordx4 v65, s[60:63], s4 offen offset:1024 lds
    v_bfe_u32 v64, s9, v58, 2
    v_mad_u32_u24 v64, v64, s10, v62
    buffer_load_dwordx4 v64, s[60:63], s4 offen offset:2048 lds
    v_bfe_u32 v65, s9, v59, 2
    v_mad_u32_u24 v65, v65, s10, v63
    buffer_load_dwordx4 v65, s[60:63], s4 offen offset:3072 lds
    s_add_u32 s4, s4, 81920
    s_cmp_eq_u32 s4, 819200
    s_cselect_b32 s4, 0, s4
    s_waitcnt vmcnt(0)
Lbc:
    v_readfirstlane_b32 s11, v70
    v_readfirstlane_b32 s36, v71
    v_readfirstlane_b32 s12, v72
    v_readfirstlane_b32 s37, v73
    s_cmp_eq_u32 s36, s34
    s_cselect_b32 s37, s37, s36
    s_cmp_eq_u32 s37, s34
    s_cbranch_scc1 Lbc_ok
    s_sub_u32 s35, s35, 1
    s_cbranch_scc1 Lend
    buffer_load_dwordx4 v[70:73], v69, s[28:31], 0 offen sc1
    s_waitcnt vmcnt(0)
    s_branch Lbc
Lbc_ok:
    s_mul_i32 s36, s32, 96
    s_and_b32 s13, s11, 0x7ff
    s_sub_u32 s13, 2047, s13
    s_sub_u32 s37, s13, s36
    s_cmp_lt_u32 s37, 96
    s_cselect_b32 s13, s13, -1
    s_and_b32 s14, s12, 0x7ff
    s_sub_u32 s14, 2047, s14
    s_sub_u32 s37, s14, s36
    s_cmp_lt_u32 s37, 96
    s_cselect_b32 s14, s14, -1
    v_mov_b32 v4, s13
    v_mov_b32 v5, s14
    v_mov_b32 v6, 157960
    ds_write_b64 v6, v[4:5]
    s_and_b32 s37, s13, s14
    s_cmp_eq_u32 s37, -1
    s_cbranch_scc1 Lw0_done
    s_max_i32 s36, s13, 0
    s_mul_i32 s36, s36, 1280
    s_lshl_b32 s37, s33, 7
    s_add_u32 s36, s36, s37
    s_add_u32 s36, s36, 4096
    v_lshlrev_b32 v8, 1, v1
    buffer_load_ushort v124, v8, s[44:47], s36 offen
    s_max_i32 s36, s14, 0
    s_mul_i32 s36, s36, 1280
    s_lshl_b32 s37, s33, 7
    s_add_u32 s36, s36, s37
    s_add_u32 s36, s36, 4096
    v_lshlrev_b32 v8, 1, v1
    buffer_load_ushort v125, v8, s[44:47], s36 offen
    v_min_u32 v7, 26, v1
    v_mul_u32_u24 v7, 10240, v7
Ly_poll:
    s_sub_u32 s35, s35, 1
    s_cbranch_scc1 Lend
    s_sleep 20
    s_lshl_b32 s36, s33, 10
    s_add_u32 s36, s36, 7405568
    buffer_load_dword v4, v7, s[28:31], s36 offen offset:1020 sc1
    s_waitcnt vmcnt(0)
    v_cmp_ne_u32 vcc, s34, v4
    s_nop 0
    s_cbranch_vccnz Ly_poll
    buffer_load_dwordx4 v[16:19], v13, s[28:31], s36 offen sc1
    s_add_u32 s36, s36, 10240
    buffer_load_dwordx4 v[20:23], v13, s[28:31], s36 offen sc1
    s_add_u32 s36, s36, 10240
    buffer_load_dwordx4 v[24:27], v13, s[28:31], s36 offen sc1
    s_add_u32 s36, s36, 10240
    buffer_load_dwordx4 v[28:31], v13, s[28:31], s36 offen sc1
    s_add_u32 s36, s36, 10240
    buffer_load_dwordx4 v[32:35], v13, s[28:31], s36 offen sc1
    s_add_u32 s36, s36, 10240
    buffer_load_dwordx4 v[36:39], v13, s[28:31], s36 offen sc1
    s_add_u32 s36, s36, 10240
    buffer_load_dwordx4 v[40:43], v13, s[28:31], s36 offen sc1
    s_add_u32 s36, s36, 10240
    buffer_load_dwordx4 v[44:47], v13, s[28:31], s36 offen sc1
    s_add_u32 s36, s36, 10240
    buffer_load_dwordx4 v[48:51], v13, s[28:31], s36 offen sc1
    s_add_u32 s36, s36, 10240
    buffer_load_dwordx4 v[52:55], v13, s[28:31], s36 offen sc1
    s_add_u32 s36, s36, 10240
    buffer_load_dwordx4 v[56:59], v13, s[28:31], s36 offen sc1
    s_add_u32 s36, s36, 10240
    buffer_load_dwordx4 v[60:63], v13, s[28:31], s36 offen sc1
    s_add_u32 s36, s36, 10240
    buffer_load_dwordx4 v[64:67], v13, s[28:31], s36 offen sc1
    s_add_u32 s36, s36, 10240
    buffer_load_dwordx4 v[68:71], v13, s[28:31], s36 offen sc1
    s_add_u32 s36, s36, 10240
    buffer_load_dwordx4 v[72:75], v13, s[28:31], s36 offen sc1
    s_add_u32 s36, s36, 10240
    buffer_load_dwordx4 v[76:79], v13, s[28:31], s36 offen sc1
    s_add_u32 s36, s36, 10240
    buffer_load_dwordx4 v[80:83], v13, s[28:31], s36 offen sc1
    s_add_u32 s36, s36, 10240
    buffer_load_dwordx4 v[84:87], v13, s[28:31], s36 offen sc1
    s_add_u32 s36, s36, 10240
    buffer_load_dwordx4 v[88:91], v13, s[28:31], s36 offen sc1
    s_add_u32 s36, s36, 10240
    buffer_load_dwordx4 v[92:95], v13, s[28:31], s36 offen sc1
    s_add_u32 s36, s36, 10240
    buffer_load_dwordx4 v[96:99], v13, s[28:31], s36 offen sc1
    s_add_u32 s36, s36, 10240
    buffer_load_dwordx4 v[100:103], v13, s[28:31], s36 offen sc1
    s_add_u32 s36, s36, 10240
    buffer_load_dwordx4 v[104:107], v13, s[28:31], s36 offen sc1
    s_add_u32 s36, s36, 10240
    buffer_load_dwordx4 v[108:111], v13, s[28:31], s36 offen sc1
    s_add_u32 s36, s36, 10240
    buffer_load_dwordx4 v[112:115], v13, s[28:31], s36 offen sc1
    s_add_u32 s36, s36, 10240
    buffer_load_dwordx4 v[116:119], v13, s[28:31], s36 offen sc1
    s_add_u32 s36, s36, 10240
    buffer_load_dwordx4 v[120:123], v13, s[28:31], s36 offen sc1
    s_add_u32 s36, s36, 10240
    s_waitcnt vmcnt(0)
    v_xor_b32 v4, s34, v17
    v_xor_b32 v5, s34, v19
    v_or_b32 v4, v4, v5
    v_xor_b32 v5, s34, v21
    v_or_b32 v4, v4, v5
    v_xor_b32 v5, s34, v23
    v_or_b32 v4, v4, v5
    v_xor_b32 v5, s34, v25
    v_or_b32 v4, v4, v5
    v_xor_b32 v5, s34, v27
    v_or_b32 v4, v4, v5
    v_xor_b32 v5, s34, v29
    v_or_b32 v4, v4, v5
    v_xor_b32 v5, s34, v31
    v_or_b32 v4, v4, v5
    v_xor_b32 v5, s34, v33
    v_or_b32 v4, v4, v5
    v_xor_b32 v5, s34, v35
    v_or_b32 v4, v4, v5
    v_xor_b32 v5, s34, v37
    v_or_b32 v4, v4, v5
    v_xor_b32 v5, s34, v39
    v_or_b32 v4, v4, v5
    v_xor_b32 v5, s34, v41
    v_or_b32 v4, v4, v5
    v_xor_b32 v5, s34, v43
    v_or_b32 v4, v4, v5
    v_xor_b32 v5, s34, v45
    v_or_b32 v4, v4, v5
    v_xor_b32 v5, s34, v47
    v_or_b32 v4, v4, v5
    v_xor_b32 v5, s34, v49
    v_or_b32 v4, v4, v5
    v_xor_b32 v5, s34, v51
    v_or_b32 v4, v4, v5
    v_xor_b32 v5, s34, v53
    v_or_b32 v4, v4, v5
    v_xor_b32 v5, s34, v55
    v_or_b32 v4, v4, v5
    v_xor_b32 v5, s34, v57
    v_or_b32 v4, v4, v5
    v_xor_b32 v5, s34, v59
    v_or_b32 v4, v4, v5
    v_xor_b32 v5, s34, v61
    v_or_b32 v4, v4, v5
    v_xor_b32 v5, s34, v63
    v_or_b32 v4, v4, v5
    v_xor_b32 v5, s34, v65
    v_or_b32 v4, v4, v5
    v_xor_b32 v5, s34, v67
    v_or_b32 v4, v4, v5
    v_xor_b32 v5, s34, v69
    v_or_b32 v4, v4, v5
    v_xor_b32 v5, s34, v71
    v_or_b32 v4, v4, v5
    v_xor_b32 v5, s34, v73
    v_or_b32 v4, v4, v5
    v_xor_b32 v5, s34, v75
    v_or_b32 v4, v4, v5
    v_xor_b32 v5, s34, v77
    v_or_b32 v4, v4, v5
    v_xor_b32 v5, s34, v79
    v_or_b32 v4, v4, v5
    v_xor_b32 v5, s34, v81
    v_or_b32 v4, v4, v5
    v_xor_b32 v5, s34, v83
    v_or_b32 v4, v4, v5
    v_xor_b32 v5, s34, v85
    v_or_b32 v4, v4, v5
    v_xor_b32 v5, s34, v87
    v_or_b32 v4, v4, v5
    v_xor_b32 v5, s34, v89
    v_or_b32 v4, v4, v5
    v_xor_b32 v5, s34, v91
    v_or_b32 v4, v4, v5
    v_xor_b32 v5, s34, v93
    v_or_b32 v4, v4, v5
    v_xor_b32 v5, s34, v95
    v_or_b32 v4, v4, v5
    v_xor_b32 v5, s34, v97
    v_or_b32 v4, v4, v5
    v_xor_b32 v5, s34, v99
    v_or_b32 v4, v4, v5
    v_xor_b32 v5, s34, v101
    v_or_b32 v4, v4, v5
    v_xor_b32 v5, s34, v103
    v_or_b32 v4, v4, v5
    v_xor_b32 v5, s34, v105
    v_or_b32 v4, v4, v5
    v_xor_b32 v5, s34, v107
    v_or_b32 v4, v4, v5
    v_xor_b32 v5, s34, v109
    v_or_b32 v4, v4, v5
    v_xor_b32 v5, s34, v111
    v_or_b32 v4, v4, v5
    v_xor_b32 v5, s34, v113
    v_or_b32 v4, v4, v5
    v_xor_b32 v5, s34, v115
    v_or_b32 v4, v4, v5
    v_xor_b32 v5, s34, v117
    v_or_b32 v4, v4, v5
    v_xor_b32 v5, s34, v119
    v_or_b32 v4, v4, v5
    v_xor_b32 v5, s34, v121
    v_or_b32 v4, v4, v5
    v_xor_b32 v5, s34, v123
    v_or_b32 v4, v4, v5
    v_cmp_ne_u32 vcc, 0, v4
    s_nop 0
    s_cmp_lg_u64 vcc, 0
    s_cbranch_scc1 Ly_poll
    v_add_f32 v16, v16, v20
    v_add_f32 v18, v18, v22
    v_add_f32 v16, v16, v24
    v_add_f32 v18, v18, v26
    v_add_f32 v16, v16, v28
    v_add_f32 v18, v18, v30
    v_add_f32 v16, v16, v32
    v_add_f32 v18, v18, v34
    v_add_f32 v16, v16, v36
    v_add_f32 v18, v18, v38
    v_add_f32 v16, v16, v40
    v_add_f32 v18, v18, v42
    v_add_f32 v16, v16, v44
    v_add_f32 v18, v18, v46
    v_add_f32 v16, v16, v48
    v_add_f32 v18, v18, v50
    v_add_f32 v16, v16, v52
    v_add_f32 v18, v18, v54
    v_add_f32 v16, v16, v56
    v_add_f32 v18, v18, v58
    v_add_f32 v16, v16, v60
    v_add_f32 v18, v18, v62
    v_add_f32 v16, v16, v64
    v_add_f32 v18, v18, v66
    v_add_f32 v16, v16, v68
    v_add_f32 v18, v18, v70
    v_add_f32 v16, v16, v72
    v_add_f32 v18, v18, v74
    v_add_f32 v16, v16, v76
    v_add_f32 v18, v18, v78
    v_add_f32 v16, v16, v80
    v_add_f32 v18, v18, v82
    v_add_f32 v16, v16, v84
    v_add_f32 v18, v18, v86
    v_add_f32 v16, v16, v88
    v_add_f32 v18, v18, v90
    v_add_f32 v16, v16, v92
    v_add_f32 v18, v18, v94
    v_add_f32 v16, v16, v96
    v_add_f32 v18, v18, v98
    v_add_f32 v16, v16, v100
    v_add_f32 v18, v18, v102
    v_add_f32 v16, v16, v104
    v_add_f32 v18, v18, v106
    v_add_f32 v16, v16, v108
    v_add_f32 v18, v18, v110
    v_add_f32 v16, v16, v112
    v_add_f32 v18, v18, v114
    v_add_f32 v16, v16, v116
    v_add_f32 v18, v18, v118
    v_add_f32 v16, v16, v120
    v_add_f32 v18, v18, v122
    s_lshr_b32 s36, s11, 16
    s_cmp_ge_u32 s36, 0x8000
    s_cselect_b32 s37, 0x8000, -1
    s_xor_b32 s36, s36, s37
    s_lshl_b32 s36, s36, 16
    v_mov_b32 v4, s36
    v_mul_f32 v4, 0xbfb8aa3b, v4
    v_exp_f32 v4, v4
    s_nop 0
    v_add_f32 v4, 1.0, v4
    v_rcp_f32 v4, v4
    s_nop 0
    v_cvt_pk_bf16_f32 v4, v4, v4
    v_lshlrev_b32 v4, 16, v4
    v_cvt_pk_bf16_f32 v16, v16, v16
    v_lshlrev_b32 v16, 16, v16
    v_mul_f32 v16, v16, v4
    v_cvt_pk_bf16_f32 v16, v16, v16
    v_lshlrev_b32 v16, 16, v16
    s_lshr_b32 s36, s12, 16
    s_cmp_ge_u32 s36, 0x8000
    s_cselect_b32 s37, 0x8000, -1
    s_xor_b32 s36, s36, s37
    s_lshl_b32 s36, s36, 16
    v_mov_b32 v4, s36
    v_mul_f32 v4, 0xbfb8aa3b, v4
    v_exp_f32 v4, v4
    s_nop 0
    v_add_f32 v4, 1.0, v4
    v_rcp_f32 v4, v4
    s_nop 0
    v_cvt_pk_bf16_f32 v4, v4, v4
    v_lshlrev_b32 v4, 16, v4
    v_cvt_pk_bf16_f32 v18, v18, v18
    v_lshlrev_b32 v18, 16, v18
    v_mul_f32 v18, v18, v4
    v_cvt_pk_bf16_f32 v18, v18, v18
    v_lshlrev_b32 v18, 16, v18
    s_mul_i32 s36, s32, 96
    s_sub_u32 s36, s13, s36
    s_max_i32 s36, s36, 0
    s_lshl_b32 s36, s36, 2
    s_add_u32 s36, s36, 156288
    v_mov_b32 v4, s36
    ds_read2st64_b32 v[4:5], v4 offset0:0 offset1:2
    v_lshlrev_b32 v124, 16, v124
    s_waitcnt lgkmcnt(0)
    v_add_f32 v20, v124, v4
    v_cvt_pk_bf16_f32 v20, v20, v20
    v_lshlrev_b32 v20, 16, v20
    v_mul_f32 v20, v20, v5
    v_cvt_pk_bf16_f32 v20, v20, v20
    v_lshlrev_b32 v20, 16, v20
    v_add_f32 v20, v20, v16
    v_cvt_pk_bf16_f32 v20, v20, v20
    v_lshlrev_b32 v20, 16, v20
    v_mul_f32 v16, 0xbfb8aa3b, v20
    v_exp_f32 v16, v16
    s_nop 0
    v_add_f32 v16, 1.0, v16
    v_rcp_f32 v16, v16
    s_nop 0
    v_mul_f32 v16, v16, v20
    v_cvt_pk_bf16_f32 v16, v16, v16
    v_lshlrev_b32 v16, 16, v16
    s_mul_i32 s36, s32, 96
    s_sub_u32 s36, s14, s36
    s_max_i32 s36, s36, 0
    s_lshl_b32 s36, s36, 2
    s_add_u32 s36, s36, 156288
    v_mov_b32 v4, s36
    ds_read2st64_b32 v[4:5], v4 offset0:0 offset1:2
    v_lshlrev_b32 v125, 16, v125
    s_waitcnt lgkmcnt(0)
    v_add_f32 v22, v125, v4
    v_cvt_pk_bf16_f32 v22, v22, v22
    v_lshlrev_b32 v22, 16, v22
    v_mul_f32 v22, v22, v5
    v_cvt_pk_bf16_f32 v22, v22, v22
    v_lshlrev_b32 v22, 16, v22
    v_add_f32 v22, v22, v18
    v_cvt_pk_bf16_f32 v22, v22, v22
    v_lshlrev_b32 v22, 16, v22
    v_mul_f32 v18, 0xbfb8aa3b, v22
    v_exp_f32 v18, v18
    s_nop 0
    v_add_f32 v18, 1.0, v18
    v_rcp_f32 v18, v18
    s_nop 0
    v_mul_f32 v18, v18, v22
    v_cvt_pk_bf16_f32 v18, v18, v18
    v_lshlrev_b32 v18, 16, v18
    s_cmp_lg_u32 s13, -1
    s_cselect_b32 s39, 4, 0
    s_cmp_lg_u32 s14, -1
    s_cselect_b32 s36, 4, 0
    s_add_u32 s39, s39, s36
    v_mov_b32 v5, 157956
Lcw_8:
    s_sub_u32 s35, s35, 1
    s_cbranch_scc1 Lend
    ds_read_b32 v6, v5
    s_waitcnt lgkmcnt(0)
    v_readfirstlane_b32 s38, v6
    s_nop 0
    s_cmp_lt_u32 s38, s39
    s_cbranch_scc1 Lcw_8
    v_add_u32 v5, 158208, v12
    ds_read2st64_b32 v[126:127], v5 offset0:0 offset1:1
    s_waitcnt lgkmcnt(0)
    v_fma_f32 v16, v126, v16, v124
    v_cvt_pk_bf16_f32 v16, v16, v16
    s_mul_i32 s36, s13, 1280
    s_lshl_b32 s37, s33, 7
    s_add_u32 s36, s36, s37
    s_cmp_eq_u32 s13, -1
    s_cbranch_scc1 Lrow0
    buffer_store_short v16, v8, s[64:67], s36 offen
Lrow0:
    v_fma_f32 v18, v127, v18, v125
    v_cvt_pk_bf16_f32 v18, v18, v18
    s_mul_i32 s36, s14, 1280
    s_lshl_b32 s37, s33, 7
    s_add_u32 s36, s36, s37
    s_cmp_eq_u32 s14, -1
    s_cbranch_scc1 Lrow1
    buffer_store_short v18, v8, s[64:67], s36 offen
Lrow1:
Lw0_done:
    s_endpgm
Lcomp:
    s_lshl_b32 s43, s26, 1
    s_add_u32 s43, s43, s27
    s_sub_u32 s36, s33, 5
    s_cmp_ge_u32 s33, 5
    s_cselect_b32 s40, s36, s33
    s_mov_b32 s41, 0xbfe10856
    s_cmp_eq_u32 s40, 1
    s_cselect_b32 s41, 0xaff80255, s41
    s_cmp_eq_u32 s40, 2
    s_cselect_b32 s41, 0xabfe4015, s41
    s_cmp_eq_u32 s40, 3
    s_cselect_b32 s41, 0xaa7fd005, s41
    s_cmp_eq_u32 s40, 4
    s_cselect_b32 s41, 0x6adfb401, s41
    s_lshl_b32 s37, s27, 13
    s_cmp_eq_u32 s43, 1
    s_cselect_b32 s37, 0, s37
    v_bfe_u32 v7, v1, 2, 2
    v_and_b32 v8, 3, v1
    v_lshl_add_u32 v18, v2, 3, v7
    v_lshlrev_b32 v18, 7, v18
    v_lshlrev_b32 v19, 2, v1
    v_and_b32 v19, 0x60, v19
    v_lshlrev_b32 v10, 1, v8
    v_add_u32 v9, s37, v18
    v_add_u32 v11, 0, v10
    v_bfe_u32 v11, s41, v11, 2
    v_lshl_add_u32 v11, v11, 2, v8
    v_lshlrev_b32 v11, 3, v11
    v_xad_u32 v20, v11, v19, v9
    v_add_u32 v11, 8, v10
    v_bfe_u32 v11, s41, v11, 2
    v_lshl_add_u32 v11, v11, 2, v8
    v_lshlrev_b32 v11, 3, v11
    v_xad_u32 v21, v11, v19, v9
    v_add_u32 v11, 16, v10
    v_bfe_u32 v11, s41, v11, 2
    v_lshl_add_u32 v11, v11, 2, v8
    v_lshlrev_b32 v11, 3, v11
    v_xad_u32 v22, v11, v19, v9
    v_add_u32 v11, 24, v10
    v_bfe_u32 v11, s41, v11, 2
    v_lshl_add_u32 v11, v11, 2, v8
    v_lshlrev_b32 v11, 3, v11
    v_xad_u32 v23, v11, v19, v9
    v_add_u32 v24, 78080, v20
    v_add_u32 v25, 78080, v21
    v_add_u32 v26, 78080, v22
    v_add_u32 v27, 78080, v23
    v_lshrrev_b32 v10, 1, v3
    v_xor_b32 v9, v10, v2
    v_lshlrev_b32 v9, 4, v9
    v_lshl_add_u32 v9, v3, 7, v9
    s_lshl_b32 s36, s43, 11
    s_xor_b32 s38, s36, 2048
    s_add_u32 s36, s36, 22528
    s_add_u32 s38, s38, 22528
    v_add_u32 v76, s36, v9
    v_add_u32 v78, s38, v9
    s_mul_i32 s39, s26, 6144
    s_add_u32 s39, s39, 98560
    v_add_u32 v125, s39, v13
    s_lshl_b32 s48, s43, 11
    s_add_u32 s48, s48, 139648
    s_waitcnt lgkmcnt(0)
    s_mov_b64 s[28:29], s[24:25]
    s_mov_b32 s30, 268435456
    s_mov_b32 s31, 0x20000
    s_load_dword s34, s[28:29], 0
    s_cmp_eq_u32 s43, 1
    s_cbranch_scc1 Lhalo
    v_xor_b32 v77, 64, v76
    v_xor_b32 v79, 64, v78
    v_add_u32 v80, 78080, v76
    v_add_u32 v81, 78080, v77
    v_add_u32 v82, 78080, v78
    v_add_u32 v83, 78080, v79
    s_cmp_eq_u32 s27, 0
    s_cselect_b64 vcc, 0, -1
    s_sub_u32 s37, 16384, s37
    v_cndmask_b32 v84, v20, v22, vcc
    v_cndmask_b32 v85, v21, v23, vcc
    v_add_u32 v84, s37, v84
    v_add_u32 v85, s37, v85
    v_add_u32 v86, 78080, v84
    v_add_u32 v87, 78080, v85
    v_lshrrev_b32 v8, 1, v2
    v_xor_b32 v8, v8, v10
    v_lshlrev_b32 v8, 4, v8
    v_lshl_add_u32 v8, v3, 7, v8
    v_and_b32 v7, 1, v2
    v_lshl_add_u32 v124, v7, 3, v8
    s_lshl_b32 s49, s42, 12
    s_mov_b32 s38, 0x84736210
    s_mov_b32 s39, 0x95
    s_cmp_eq_u32 s42, 1
    s_cselect_b32 s38, 0x83712065, s38
    s_cselect_b32 s39, 0x94, s39
    s_cmp_eq_u32 s42, 2
    s_cselect_b32 s38, 0x81307564, s38
    s_cselect_b32 s39, 0x92, s39
    s_cmp_eq_u32 s42, 3
    s_cselect_b32 s38, 0x40857362, s38
    s_cselect_b32 s39, 0x91, s39
    s_cmp_eq_u32 s42, 4
    s_cselect_b32 s38, 0x94837261, s38
    s_cselect_b32 s39, 0x50, s39
    s_lshl_b32 s42, s33, 2
    s_lshr_b64 s[38:39], s[38:39], s42
    s_and_b32 s42, s38, 15
    s_and_b32 s38, s42, 3
    s_mul_i32 s38, s38, 39040
    s_add_u32 s38, s38, s36
    v_add_u32 v4, s38, v124
    v_xor_b32 v5, 32, v4
    v_xor_b32 v6, 64, v4
    v_xor_b32 v7, 0x60, v4
    s_mov_b64 s[44:45], s[20:21]
    s_mov_b32 s46, 2621440
    s_mov_b32 s47, 0x20000
    v_mov_b32 v14, 0x3f803f80
    v_mov_b32 v15, 0x3f803f80
    v_mov_b32 v16, 0x3f803f80
    v_mov_b32 v17, 0x3f803f80
    s_mov_b32 s4, 0xaae00455
    s_cmp_eq_u32 s40, 1
    s_cselect_b32 s4, 0xaaf80155, s4
    s_cmp_eq_u32 s40, 2
    s_cselect_b32 s4, 0xaafe4055, s4
    s_cmp_eq_u32 s40, 3
    s_cselect_b32 s4, 0xaabfd055, s4
    s_cmp_eq_u32 s40, 4
    s_cselect_b32 s4, 0xaaeff455, s4
    v_lshlrev_b32 v10, 1, v2
    v_add_u32 v10, 8, v10
    v_bfe_u32 v10, s4, v10, 2
    v_cmp_eq_u32 s[6:7], 0, v10
    v_cmp_eq_u32 s[8:9], 3, v10
    v_cmp_eq_u32 s[10:11], 1, v10
    v_lshlrev_b32 v10, 1, v2
    v_add_u32 v10, 16, v10
    v_bfe_u32 v10, s4, v10, 2
    v_cmp_eq_u32 s[12:13], 0, v10
    v_cmp_eq_u32 s[14:15], 3, v10
    v_cmp_eq_u32 s[16:17], 2, v10
    s_mov_b32 s4, 0xaaaaaaaa
    s_mov_b32 s5, 0xaaaaaaaa
    s_mov_b32 s18, 0xfff0ffff
    s_mov_b32 s19, 0xf000ff00
    s_mov_b32 s20, 0xffc0fffc
    s_mov_b32 s21, 0xc000fc00
    v_mov_b32 v8, 0xffff
    v_not_b32 v9, v8
    v_cndmask_b32 v8, v8, v9, s[4:5]
    v_cndmask_b32 v118, 0, v8, s[18:19]
    v_cndmask_b32 v119, 0, v8, s[20:21]
    v_xor_b32 v116, v118, v8
    v_xor_b32 v117, v119, v8
    s_cmp_eq_u32 s32, 0
    s_cselect_b32 s36, s43, 0
    s_cmp_eq_u32 s36, 2
    s_cselect_b32 s22, 0xff800000, 0
    s_mul_i32 s36, s32, 6
    s_add_u32 s36, s36, s43
    s_sub_u32 s36, s36, 2
    s_lshl_b32 s24, s36, 7
    s_add_u32 s24, s24, 7340032
    s_mul_i32 s50, s36, 20480
    s_add_u32 s50, s50, 4194304
    s_lshl_b32 s36, s33, 11
    s_add_u32 s23, s36, s50
    s_add_u32 s51, s50, s49
    s_add_u32 s49, s49, 4096
    s_cmp_eq_u32 s49, 20480
    s_cselect_b32 s49, 0, s49
    s_add_u32 s52, s50, s49
    s_add_u32 s49, s49, 4096
    s_cmp_eq_u32 s49, 20480
    s_cselect_b32 s49, 0, s49
    s_add_u32 s53, s50, s49
    s_add_u32 s49, s49, 4096
    s_cmp_eq_u32 s49, 20480
    s_cselect_b32 s49, 0, s49
    s_add_u32 s54, s50, s49
    s_add_u32 s49, s49, 4096
    s_cmp_eq_u32 s49, 20480
    s_cselect_b32 s49, 0, s49
    s_add_u32 s55, s50, s49
    s_add_u32 s49, s49, 4096
    s_cmp_eq_u32 s49, 20480
    s_cselect_b32 s49, 0, s49
    s_mul_i32 s36, s32, 10
    s_add_u32 s36, s36, s33
    s_mul_i32 s56, s36, 6144
    s_lshl_b32 s36, s43, 10
    s_add_u32 s56, s56, s36
    s_add_u32 s56, s56, 1046528
    s_sub_u32 s57, s56, 6144
    s_add_u32 s58, s56, 6144
    s_cmp_eq_u32 s40, 0
    s_cselect_b32 s59, 0, -1
    s_cmp_eq_u32 s40, 4
    s_cselect_b32 s60, 0, -1
    s_lshl_b32 s36, s33, 2
    v_mov_b32 v97, s36
    s_mov_b32 s25, 0x3ea52b5c
    s_lshl_b32 s36, s43, 6
    s_add_u32 s36, s36, 156160
    v_lshl_add_u32 v94, v3, 2, s36
    v_and_b32 v8, 1, v1
    v_lshl_add_u32 v8, v2, 2, v8
    v_lshl_add_u32 v8, v8, 2, s36
    v_subrev_u32 v9, 64, v8
    v_cndmask_b32 v92, v9, v8, s[18:19]
    v_cndmask_b32 v93, v9, v8, s[20:21]
    v_lshlrev_b32 v95, 4, v2
    s_lshl_b32 s36, s27, 8
    s_add_u32 s36, s36, 157184
    v_add_u32 v95, s36, v95
    v_mov_b32 v96, 157968
    v_mov_b32 v100, -1
    v_mov_b32 v101, -1
    v_mov_b32 v102, -1
    v_mov_b32 v103, -1
    v_mov_b32 v127, 157984
    s_lshl_b32 s36, s3, 2
    s_add_u32 s36, s36, 158016
    v_mov_b32 v10, s36
    v_xor_b32 v11, 16, v10
    v_cndmask_b32 v127, v127, v11, s[4:5]
    s_waitcnt lgkmcnt(0)
    s_barrier
    ds_read_b128 a[64:67], v76 offset:0
    ds_read_b128 a[68:71], v78 offset:0
    ds_read_b64_tr_b16 a[80:81], v20 offset:0
    ds_read_b64_tr_b16 a[82:83], v20 offset:512
    ds_read_b64_tr_b16 a[84:85], v21 offset:0
    ds_read_b64_tr_b16 a[86:87], v21 offset:512
    ds_read_b64_tr_b16 a[88:89], v22 offset:0
    ds_read_b64_tr_b16 a[90:91], v22 offset:512
    ds_read_b64_tr_b16 a[92:93], v23 offset:0
    ds_read_b64_tr_b16 a[94:95], v23 offset:512
    ds_read_b64_tr_b16 a[96:97], v84 offset:0
    ds_read_b64_tr_b16 a[98:99], v84 offset:512
    ds_read_b64_tr_b16 a[100:101], v85 offset:0
    ds_read_b64_tr_b16 a[102:103], v85 offset:512
    s_add_u32 s34, s34, 0x9e3779b8
    s_or_b32 s34, s34, 1
    s_cmp_eq_u32 s42, 0
    s_cbranch_scc1 Lxe0
Lxe0_b:
    s_setprio 1
    s_waitcnt lgkmcnt(10)
    v_mfma_f32_16x16x32_bf16 v[28:31], a[80:83], a[64:67], 0
    ds_read_b128 a[72:75], v77 offset:0
    ds_read_b128 a[76:79], v79 offset:0
    v_mfma_f32_16x16x32_bf16 v[44:47], a[80:83], a[68:71], 0
    ds_read_b64_tr_b16 a[104:105], v20 offset:4096
    s_waitcnt lgkmcnt(11)
    v_mfma_f32_16x16x32_bf16 v[32:35], a[84:87], a[64:67], 0
    ds_read_b64_tr_b16 a[106:107], v20 offset:4608
    v_mfma_f32_16x16x32_bf16 v[48:51], a[84:87], a[68:71], 0
    ds_read_b64_tr_b16 a[108:109], v21 offset:4096
    s_waitcnt lgkmcnt(11)
    v_mfma_f32_16x16x32_bf16 v[36:39], a[88:91], a[64:67], 0
    ds_read_b64_tr_b16 a[110:111], v21 offset:4608
    ds_read_b64_tr_b16 a[112:113], v22 offset:4096
    v_mfma_f32_16x16x32_bf16 v[52:55], a[88:91], a[68:71], 0
    ds_read_b64_tr_b16 a[114:115], v22 offset:4608
    s_setprio 0
    s_waitcnt lgkmcnt(12)
    v_mfma_f32_16x16x32_bf16 v[40:43], a[92:95], a[64:67], 0
    ds_read_b64_tr_b16 a[116:117], v23 offset:4096
    v_mfma_f32_16x16x32_bf16 v[56:59], a[92:95], a[68:71], 0
    ds_read_b64_tr_b16 a[118:119], v23 offset:4608
    s_waitcnt lgkmcnt(12)
    v_mfma_f32_16x16x32_bf16 v[60:63], a[64:67], a[96:99], 0
    ds_read_b64_tr_b16 a[120:121], v84 offset:4096
    v_mfma_f32_16x16x32_bf16 v[68:71], a[68:71], a[96:99], 0
    ds_read_b64_tr_b16 a[122:123], v84 offset:4608
    s_waitcnt lgkmcnt(12)
    v_mfma_f32_16x16x32_bf16 v[64:67], a[64:67], a[100:103], 0
    ds_read_b64_tr_b16 a[124:125], v85 offset:4096
    v_mfma_f32_16x16x32_bf16 v[72:75], a[68:71], a[100:103], 0
    ds_read_b64_tr_b16 a[126:127], v85 offset:4608
    s_barrier
    s_setprio 3
    s_waitcnt lgkmcnt(10)
    v_mfma_f32_16x16x32_bf16 v[28:31], a[104:107], a[72:75], v[28:31]
    ds_read_b128 a[64:67], v76 offset:39040
    ds_read_b128 a[68:71], v78 offset:39040
    v_mfma_f32_16x16x32_bf16 v[44:47], a[104:107], a[76:79], v[44:47]
    ds_read_b64_tr_b16 a[80:81], v20 offset:39040
    s_waitcnt lgkmcnt(11)
    v_mfma_f32_16x16x32_bf16 v[32:35], a[108:111], a[72:75], v[32:35]
    ds_read_b64_tr_b16 a[82:83], v20 offset:39552
    v_mfma_f32_16x16x32_bf16 v[48:51], a[108:111], a[76:79], v[48:51]
    ds_read_b64_tr_b16 a[84:85], v21 offset:39040
    s_waitcnt lgkmcnt(11)
    v_mfma_f32_16x16x32_bf16 v[36:39], a[112:115], a[72:75], v[36:39]
    ds_read_b64_tr_b16 a[86:87], v21 offset:39552
    v_mfma_f32_16x16x32_bf16 v[52:55], a[112:115], a[76:79], v[52:55]
    ds_read_b64_tr_b16 a[88:89], v22 offset:39040
    s_setprio 2
    s_waitcnt lgkmcnt(11)
    v_mfma_f32_16x16x32_bf16 v[40:43], a[116:119], a[72:75], v[40:43]
    ds_read_b64_tr_b16 a[90:91], v22 offset:39552
    ds_read_b64_tr_b16 a[92:93], v23 offset:39040
    v_mfma_f32_16x16x32_bf16 v[56:59], a[116:119], a[76:79], v[56:59]
    ds_read_b64_tr_b16 a[94:95], v23 offset:39552
    s_waitcnt lgkmcnt(12)
    v_mfma_f32_16x16x32_bf16 v[60:63], a[72:75], a[120:123], v[60:63]
    ds_read_b64_tr_b16 a[96:97], v84 offset:39040
    v_mfma_f32_16x16x32_bf16 v[68:71], a[76:79], a[120:123], v[68:71]
    ds_read_b64_tr_b16 a[98:99], v84 offset:39552
    s_waitcnt lgkmcnt(12)
    v_mfma_f32_16x16x32_bf16 v[64:67], a[72:75], a[124:127], v[64:67]
    ds_read_b64_tr_b16 a[100:101], v85 offset:39040
    v_mfma_f32_16x16x32_bf16 v[72:75], a[76:79], a[124:127], v[72:75]
    ds_read_b64_tr_b16 a[102:103], v85 offset:39552
    s_cmp_eq_u32 s42, 1
    s_cbranch_scc1 Lxe1
Lxe1_b:
    s_setprio 1
    s_waitcnt lgkmcnt(10)
    v_mfma_f32_16x16x32_bf16 v[28:31], a[80:83], a[64:67], v[28:31]
    ds_read_b128 a[72:75], v77 offset:39040
    ds_read_b128 a[76:79], v79 offset:39040
    v_mfma_f32_16x16x32_bf16 v[44:47], a[80:83], a[68:71], v[44:47]
    ds_read_b64_tr_b16 a[104:105], v20 offset:43136
    s_waitcnt lgkmcnt(11)
    v_mfma_f32_16x16x32_bf16 v[32:35], a[84:87], a[64:67], v[32:35]
    ds_read_b64_tr_b16 a[106:107], v20 offset:43648
    v_mfma_f32_16x16x32_bf16 v[48:51], a[84:87], a[68:71], v[48:51]
    ds_read_b64_tr_b16 a[108:109], v21 offset:43136
    s_waitcnt lgkmcnt(11)
    v_mfma_f32_16x16x32_bf16 v[36:39], a[88:91], a[64:67], v[36:39]
    ds_read_b64_tr_b16 a[110:111], v21 offset:43648
    ds_read_b64_tr_b16 a[112:113], v22 offset:43136
    v_mfma_f32_16x16x32_bf16 v[52:55], a[88:91], a[68:71], v[52:55]
    ds_read_b64_tr_b16 a[114:115], v22 offset:43648
    s_setprio 0
    s_waitcnt lgkmcnt(12)
    v_mfma_f32_16x16x32_bf16 v[40:43], a[92:95], a[64:67], v[40:43]
    ds_read_b64_tr_b16 a[116:117], v23 offset:43136
    v_mfma_f32_16x16x32_bf16 v[56:59], a[92:95], a[68:71], v[56:59]
    ds_read_b64_tr_b16 a[118:119], v23 offset:43648
    s_waitcnt lgkmcnt(12)
    v_mfma_f32_16x16x32_bf16 v[60:63], a[64:67], a[96:99], v[60:63]
    ds_read_b64_tr_b16 a[120:121], v84 offset:43136
    v_mfma_f32_16x16x32_bf16 v[68:71], a[68:71], a[96:99], v[68:71]
    ds_read_b64_tr_b16 a[122:123], v84 offset:43648
    s_waitcnt lgkmcnt(12)
    v_mfma_f32_16x16x32_bf16 v[64:67], a[64:67], a[100:103], v[64:67]
    ds_read_b64_tr_b16 a[124:125], v85 offset:43136
    v_mfma_f32_16x16x32_bf16 v[72:75], a[68:71], a[100:103], v[72:75]
    ds_read_b64_tr_b16 a[126:127], v85 offset:43648
    s_barrier
    s_setprio 3
    s_waitcnt lgkmcnt(10)
    v_mfma_f32_16x16x32_bf16 v[28:31], a[104:107], a[72:75], v[28:31]
    ds_read_b128 a[64:67], v80 offset:0
    ds_read_b128 a[68:71], v82 offset:0
    v_mfma_f32_16x16x32_bf16 v[44:47], a[104:107], a[76:79], v[44:47]
    ds_read_b64_tr_b16 a[80:81], v24 offset:0
    s_waitcnt lgkmcnt(11)
    v_mfma_f32_16x16x32_bf16 v[32:35], a[108:111], a[72:75], v[32:35]
    ds_read_b64_tr_b16 a[82:83], v24 offset:512
    v_mfma_f32_16x16x32_bf16 v[48:51], a[108:111], a[76:79], v[48:51]
    ds_read_b64_tr_b16 a[84:85], v25 offset:0
    s_waitcnt lgkmcnt(11)
    v_mfma_f32_16x16x32_bf16 v[36:39], a[112:115], a[72:75], v[36:39]
    ds_read_b64_tr_b16 a[86:87], v25 offset:512
    v_mfma_f32_16x16x32_bf16 v[52:55], a[112:115], a[76:79], v[52:55]
    ds_read_b64_tr_b16 a[88:89], v26 offset:0
    s_setprio 2
    s_waitcnt lgkmcnt(11)
    v_mfma_f32_16x16x32_bf16 v[40:43], a[116:119], a[72:75], v[40:43]
    ds_read_b64_tr_b16 a[90:91], v26 offset:512
    ds_read_b64_tr_b16 a[92:93], v27 offset:0
    v_mfma_f32_16x16x32_bf16 v[56:59], a[116:119], a[76:79], v[56:59]
    ds_read_b64_tr_b16 a[94:95], v27 offset:512
    s_waitcnt lgkmcnt(12)
    v_mfma_f32_16x16x32_bf16 v[60:63], a[72:75], a[120:123], v[60:63]
    ds_read_b64_tr_b16 a[96:97], v86 offset:0
    v_mfma_f32_16x16x32_bf16 v[68:71], a[76:79], a[120:123], v[68:71]
    ds_read_b64_tr_b16 a[98:99], v86 offset:512
    s_waitcnt lgkmcnt(12)
    v_mfma_f32_16x16x32_bf16 v[64:67], a[72:75], a[124:127], v[64:67]
    ds_read_b64_tr_b16 a[100:101], v87 offset:0
    v_mfma_f32_16x16x32_bf16 v[72:75], a[76:79], a[124:127], v[72:75]
    ds_read_b64_tr_b16 a[102:103], v87 offset:512
    buffer_store_dwordx4 v[100:103], v13, s[28:31], s56 offen sc1
    s_cmp_eq_u32 s42, 2
    s_cbranch_scc1 Lxe2
Lxe2_b:
    s_setprio 1
    s_waitcnt lgkmcnt(10)
    v_mfma_f32_16x16x32_bf16 v[28:31], a[80:83], a[64:67], v[28:31]
    ds_read_b128 a[72:75], v81 offset:0
    ds_read_b128 a[76:79], v83 offset:0
    v_mfma_f32_16x16x32_bf16 v[44:47], a[80:83], a[68:71], v[44:47]
    ds_read_b64_tr_b16 a[104:105], v24 offset:4096
    s_waitcnt lgkmcnt(11)
    v_mfma_f32_16x16x32_bf16 v[32:35], a[84:87], a[64:67], v[32:35]
    ds_read_b64_tr_b16 a[106:107], v24 offset:4608
    v_mfma_f32_16x16x32_bf16 v[48:51], a[84:87], a[68:71], v[48:51]
    ds_read_b64_tr_b16 a[108:109], v25 offset:4096
    s_waitcnt lgkmcnt(11)
    v_mfma_f32_16x16x32_bf16 v[36:39], a[88:91], a[64:67], v[36:39]
    ds_read_b64_tr_b16 a[110:111], v25 offset:4608
    ds_read_b64_tr_b16 a[112:113], v26 offset:4096
    v_mfma_f32_16x16x32_bf16 v[52:55], a[88:91], a[68:71], v[52:55]
    ds_read_b64_tr_b16 a[114:115], v26 offset:4608
    s_setprio 0
    s_waitcnt lgkmcnt(12)
    v_mfma_f32_16x16x32_bf16 v[40:43], a[92:95], a[64:67], v[40:43]
    ds_read_b64_tr_b16 a[116:117], v27 offset:4096
    v_mfma_f32_16x16x32_bf16 v[56:59], a[92:95], a[68:71], v[56:59]
    ds_read_b64_tr_b16 a[118:119], v27 offset:4608
    s_waitcnt lgkmcnt(12)
    v_mfma_f32_16x16x32_bf16 v[60:63], a[64:67], a[96:99], v[60:63]
    ds_read_b64_tr_b16 a[120:121], v86 offset:4096
    v_mfma_f32_16x16x32_bf16 v[68:71], a[68:71], a[96:99], v[68:71]
    ds_read_b64_tr_b16 a[122:123], v86 offset:4608
    s_waitcnt lgkmcnt(12)
    v_mfma_f32_16x16x32_bf16 v[64:67], a[64:67], a[100:103], v[64:67]
    ds_read_b64_tr_b16 a[124:125], v87 offset:4096
    v_mfma_f32_16x16x32_bf16 v[72:75], a[68:71], a[100:103], v[72:75]
    ds_read_b64_tr_b16 a[126:127], v87 offset:4608
    s_barrier
    s_setprio 3
    s_waitcnt lgkmcnt(10)
    v_mfma_f32_16x16x32_bf16 v[28:31], a[104:107], a[72:75], v[28:31]
    ds_read_b128 a[64:67], v80 offset:39040
    ds_read_b128 a[68:71], v82 offset:39040
    v_mfma_f32_16x16x32_bf16 v[44:47], a[104:107], a[76:79], v[44:47]
    ds_read_b64_tr_b16 a[80:81], v24 offset:39040
    s_waitcnt lgkmcnt(11)
    v_mfma_f32_16x16x32_bf16 v[32:35], a[108:111], a[72:75], v[32:35]
    ds_read_b64_tr_b16 a[82:83], v24 offset:39552
    v_mfma_f32_16x16x32_bf16 v[48:51], a[108:111], a[76:79], v[48:51]
    ds_read_b64_tr_b16 a[84:85], v25 offset:39040
    s_waitcnt lgkmcnt(11)
    v_mfma_f32_16x16x32_bf16 v[36:39], a[112:115], a[72:75], v[36:39]
    ds_read_b64_tr_b16 a[86:87], v25 offset:39552
    v_mfma_f32_16x16x32_bf16 v[52:55], a[112:115], a[76:79], v[52:55]
    ds_read_b64_tr_b16 a[88:89], v26 offset:39040
    s_setprio 2
    s_waitcnt lgkmcnt(11)
    v_mfma_f32_16x16x32_bf16 v[40:43], a[116:119], a[72:75], v[40:43]
    ds_read_b64_tr_b16 a[90:91], v26 offset:39552
    ds_read_b64_tr_b16 a[92:93], v27 offset:39040
    v_mfma_f32_16x16x32_bf16 v[56:59], a[116:119], a[76:79], v[56:59]
    ds_read_b64_tr_b16 a[94:95], v27 offset:39552
    s_waitcnt lgkmcnt(12)
    v_mfma_f32_16x16x32_bf16 v[60:63], a[72:75], a[120:123], v[60:63]
    ds_read_b64_tr_b16 a[96:97], v86 offset:39040
    v_mfma_f32_16x16x32_bf16 v[68:71], a[76:79], a[120:123], v[68:71]
    ds_read_b64_tr_b16 a[98:99], v86 offset:39552
    s_waitcnt lgkmcnt(12)
    v_mfma_f32_16x16x32_bf16 v[64:67], a[72:75], a[124:127], v[64:67]
    ds_read_b64_tr_b16 a[100:101], v87 offset:39040
    v_mfma_f32_16x16x32_bf16 v[72:75], a[76:79], a[124:127], v[72:75]
    ds_read_b64_tr_b16 a[102:103], v87 offset:39552
    s_cmp_eq_u32 s42, 3
    s_cbranch_scc1 Lxe3
Lxe3_b:
    s_setprio 1
    s_waitcnt lgkmcnt(10)
    v_mfma_f32_16x16x32_bf16 v[28:31], a[80:83], a[64:67], v[28:31]
    ds_read_b128 a[72:75], v81 offset:39040
    ds_read_b128 a[76:79], v83 offset:39040
    v_mfma_f32_16x16x32_bf16 v[44:47], a[80:83], a[68:71], v[44:47]
    ds_read_b64_tr_b16 a[104:105], v24 offset:43136
    s_waitcnt lgkmcnt(11)
    v_mfma_f32_16x16x32_bf16 v[32:35], a[84:87], a[64:67], v[32:35]
    ds_read_b64_tr_b16 a[106:107], v24 offset:43648
    v_mfma_f32_16x16x32_bf16 v[48:51], a[84:87], a[68:71], v[48:51]
    ds_read_b64_tr_b16 a[108:109], v25 offset:43136
    s_waitcnt lgkmcnt(11)
    v_mfma_f32_16x16x32_bf16 v[36:39], a[88:91], a[64:67], v[36:39]
    ds_read_b64_tr_b16 a[110:111], v25 offset:43648
    ds_read_b64_tr_b16 a[112:113], v26 offset:43136
    v_mfma_f32_16x16x32_bf16 v[52:55], a[88:91], a[68:71], v[52:55]
    ds_read_b64_tr_b16 a[114:115], v26 offset:43648
    s_setprio 0
    s_waitcnt lgkmcnt(12)
    v_mfma_f32_16x16x32_bf16 v[40:43], a[92:95], a[64:67], v[40:43]
    ds_read_b64_tr_b16 a[116:117], v27 offset:43136
    v_mfma_f32_16x16x32_bf16 v[56:59], a[92:95], a[68:71], v[56:59]
    ds_read_b64_tr_b16 a[118:119], v27 offset:43648
    s_waitcnt lgkmcnt(12)
    v_mfma_f32_16x16x32_bf16 v[60:63], a[64:67], a[96:99], v[60:63]
    ds_read_b64_tr_b16 a[120:121], v86 offset:43136
    v_mfma_f32_16x16x32_bf16 v[68:71], a[68:71], a[96:99], v[68:71]
    ds_read_b64_tr_b16 a[122:123], v86 offset:43648
    s_waitcnt lgkmcnt(12)
    v_mfma_f32_16x16x32_bf16 v[64:67], a[64:67], a[100:103], v[64:67]
    ds_read_b64_tr_b16 a[124:125], v87 offset:43136
    v_mfma_f32_16x16x32_bf16 v[72:75], a[68:71], a[100:103], v[72:75]
    ds_read_b64_tr_b16 a[126:127], v87 offset:43648
    s_barrier
    s_setprio 3
    s_waitcnt lgkmcnt(10)
    v_mfma_f32_16x16x32_bf16 v[28:31], a[104:107], a[72:75], v[28:31]
    ds_read_b128 a[64:67], v76 offset:0
    ds_read_b128 a[68:71], v78 offset:0
    v_mfma_f32_16x16x32_bf16 v[44:47], a[104:107], a[76:79], v[44:47]
    ds_read_b64_tr_b16 a[80:81], v20 offset:0
    s_waitcnt lgkmcnt(11)
    v_mfma_f32_16x16x32_bf16 v[32:35], a[108:111], a[72:75], v[32:35]
    ds_read_b64_tr_b16 a[82:83], v20 offset:512
    v_mfma_f32_16x16x32_bf16 v[48:51], a[108:111], a[76:79], v[48:51]
    ds_read_b64_tr_b16 a[84:85], v21 offset:0
    s_waitcnt lgkmcnt(11)
    v_mfma_f32_16x16x32_bf16 v[36:39], a[112:115], a[72:75], v[36:39]
    ds_read_b64_tr_b16 a[86:87], v21 offset:512
    v_mfma_f32_16x16x32_bf16 v[52:55], a[112:115], a[76:79], v[52:55]
    ds_read_b64_tr_b16 a[88:89], v22 offset:0
    s_setprio 2
    s_waitcnt lgkmcnt(11)
    v_mfma_f32_16x16x32_bf16 v[40:43], a[116:119], a[72:75], v[40:43]
    ds_read_b64_tr_b16 a[90:91], v22 offset:512
    ds_read_b64_tr_b16 a[92:93], v23 offset:0
    v_mfma_f32_16x16x32_bf16 v[56:59], a[116:119], a[76:79], v[56:59]
    ds_read_b64_tr_b16 a[94:95], v23 offset:512
    s_waitcnt lgkmcnt(12)
    v_mfma_f32_16x16x32_bf16 v[60:63], a[72:75], a[120:123], v[60:63]
    ds_read_b64_tr_b16 a[96:97], v84 offset:0
    v_mfma_f32_16x16x32_bf16 v[68:71], a[76:79], a[120:123], v[68:71]
    ds_read_b64_tr_b16 a[98:99], v84 offset:512
    s_waitcnt lgkmcnt(12)
    v_mfma_f32_16x16x32_bf16 v[64:67], a[72:75], a[124:127], v[64:67]
    ds_read_b64_tr_b16 a[100:101], v85 offset:0
    v_mfma_f32_16x16x32_bf16 v[72:75], a[76:79], a[124:127], v[72:75]
    ds_read_b64_tr_b16 a[102:103], v85 offset:512
    buffer_store_dwordx4 v[100:103], v13, s[28:31], s23 offen offset:0 sc1
    s_cmp_eq_u32 s42, 4
    s_cbranch_scc1 Lxe4
Lxe4_b:
    s_setprio 1
    s_waitcnt lgkmcnt(10)
    v_mfma_f32_16x16x32_bf16 v[28:31], a[80:83], a[64:67], v[28:31]
    ds_read_b128 a[72:75], v77 offset:0
    ds_read_b128 a[76:79], v79 offset:0
    v_mfma_f32_16x16x32_bf16 v[44:47], a[80:83], a[68:71], v[44:47]
    ds_read_b64_tr_b16 a[104:105], v20 offset:4096
    s_waitcnt lgkmcnt(11)
    v_mfma_f32_16x16x32_bf16 v[32:35], a[84:87], a[64:67], v[32:35]
    ds_read_b64_tr_b16 a[106:107], v20 offset:4608
    v_mfma_f32_16x16x32_bf16 v[48:51], a[84:87], a[68:71], v[48:51]
    ds_read_b64_tr_b16 a[108:109], v21 offset:4096
    s_waitcnt lgkmcnt(11)
    v_mfma_f32_16x16x32_bf16 v[36:39], a[88:91], a[64:67], v[36:39]
    ds_read_b64_tr_b16 a[110:111], v21 offset:4608
    ds_read_b64_tr_b16 a[112:113], v22 offset:4096
    v_mfma_f32_16x16x32_bf16 v[52:55], a[88:91], a[68:71], v[52:55]
    ds_read_b64_tr_b16 a[114:115], v22 offset:4608
    s_setprio 0
    s_waitcnt lgkmcnt(12)
    v_mfma_f32_16x16x32_bf16 v[40:43], a[92:95], a[64:67], v[40:43]
    ds_read_b64_tr_b16 a[116:117], v23 offset:4096
    v_mfma_f32_16x16x32_bf16 v[56:59], a[92:95], a[68:71], v[56:59]
    ds_read_b64_tr_b16 a[118:119], v23 offset:4608
    s_waitcnt lgkmcnt(12)
    v_mfma_f32_16x16x32_bf16 v[60:63], a[64:67], a[96:99], v[60:63]
    ds_read_b64_tr_b16 a[120:121], v84 offset:4096
    v_mfma_f32_16x16x32_bf16 v[68:71], a[68:71], a[96:99], v[68:71]
    ds_read_b64_tr_b16 a[122:123], v84 offset:4608
    s_waitcnt lgkmcnt(12)
    v_mfma_f32_16x16x32_bf16 v[64:67], a[64:67], a[100:103], v[64:67]
    ds_read_b64_tr_b16 a[124:125], v85 offset:4096
    v_mfma_f32_16x16x32_bf16 v[72:75], a[68:71], a[100:103], v[72:75]
    ds_read_b64_tr_b16 a[126:127], v85 offset:4608
    s_barrier
    s_setprio 3
    s_waitcnt lgkmcnt(10)
    v_mfma_f32_16x16x32_bf16 v[28:31], a[104:107], a[72:75], v[28:31]
    ds_read_b128 a[64:67], v76 offset:39040
    ds_read_b128 a[68:71], v78 offset:39040
    v_mfma_f32_16x16x32_bf16 v[44:47], a[104:107], a[76:79], v[44:47]
    ds_read_b64_tr_b16 a[80:81], v20 offset:39040
    s_waitcnt lgkmcnt(11)
    v_mfma_f32_16x16x32_bf16 v[32:35], a[108:111], a[72:75], v[32:35]
    ds_read_b64_tr_b16 a[82:83], v20 offset:39552
    v_mfma_f32_16x16x32_bf16 v[48:51], a[108:111], a[76:79], v[48:51]
    ds_read_b64_tr_b16 a[84:85], v21 offset:39040
    s_waitcnt lgkmcnt(11)
    v_mfma_f32_16x16x32_bf16 v[36:39], a[112:115], a[72:75], v[36:39]
    ds_read_b64_tr_b16 a[86:87], v21 offset:39552
    v_mfma_f32_16x16x32_bf16 v[52:55], a[112:115], a[76:79], v[52:55]
    ds_read_b64_tr_b16 a[88:89], v22 offset:39040
    s_setprio 2
    s_waitcnt lgkmcnt(11)
    v_mfma_f32_16x16x32_bf16 v[40:43], a[116:119], a[72:75], v[40:43]
    ds_read_b64_tr_b16 a[90:91], v22 offset:39552
    ds_read_b64_tr_b16 a[92:93], v23 offset:39040
    v_mfma_f32_16x16x32_bf16 v[56:59], a[116:119], a[76:79], v[56:59]
    ds_read_b64_tr_b16 a[94:95], v23 offset:39552
    s_waitcnt lgkmcnt(12)
    v_mfma_f32_16x16x32_bf16 v[60:63], a[72:75], a[120:123], v[60:63]
    ds_read_b64_tr_b16 a[96:97], v84 offset:39040
    v_mfma_f32_16x16x32_bf16 v[68:71], a[76:79], a[120:123], v[68:71]
    ds_read_b64_tr_b16 a[98:99], v84 offset:39552
    s_waitcnt lgkmcnt(12)
    v_mfma_f32_16x16x32_bf16 v[64:67], a[72:75], a[124:127], v[64:67]
    ds_read_b64_tr_b16 a[100:101], v85 offset:39040
    v_mfma_f32_16x16x32_bf16 v[72:75], a[76:79], a[124:127], v[72:75]
    ds_read_b64_tr_b16 a[102:103], v85 offset:39552
    s_cmp_eq_u32 s42, 5
    s_cbranch_scc1 Lxe5
Lxe5_b:
    s_setprio 1
    s_waitcnt lgkmcnt(10)
    v_mfma_f32_16x16x32_bf16 v[28:31], a[80:83], a[64:67], v[28:31]
    ds_read_b128 a[72:75], v77 offset:39040
    ds_read_b128 a[76:79], v79 offset:39040
    v_mfma_f32_16x16x32_bf16 v[44:47], a[80:83], a[68:71], v[44:47]
    ds_read_b64_tr_b16 a[104:105], v20 offset:43136
    s_waitcnt lgkmcnt(11)
    v_mfma_f32_16x16x32_bf16 v[32:35], a[84:87], a[64:67], v[32:35]
    ds_read_b64_tr_b16 a[106:107], v20 offset:43648
    v_mfma_f32_16x16x32_bf16 v[48:51], a[84:87], a[68:71], v[48:51]
    ds_read_b64_tr_b16 a[108:109], v21 offset:43136
    s_waitcnt lgkmcnt(11)
    v_mfma_f32_16x16x32_bf16 v[36:39], a[88:91], a[64:67], v[36:39]
    ds_read_b64_tr_b16 a[110:111], v21 offset:43648
    ds_read_b64_tr_b16 a[112:113], v22 offset:43136
    v_mfma_f32_16x16x32_bf16 v[52:55], a[88:91], a[68:71], v[52:55]
    ds_read_b64_tr_b16 a[114:115], v22 offset:43648
    s_setprio 0
    s_waitcnt lgkmcnt(12)
    v_mfma_f32_16x16x32_bf16 v[40:43], a[92:95], a[64:67], v[40:43]
    ds_read_b64_tr_b16 a[116:117], v23 offset:43136
    v_mfma_f32_16x16x32_bf16 v[56:59], a[92:95], a[68:71], v[56:59]
    ds_read_b64_tr_b16 a[118:119], v23 offset:43648
    s_waitcnt lgkmcnt(12)
    v_mfma_f32_16x16x32_bf16 v[60:63], a[64:67], a[96:99], v[60:63]
    ds_read_b64_tr_b16 a[120:121], v84 offset:43136
    v_mfma_f32_16x16x32_bf16 v[68:71], a[68:71], a[96:99], v[68:71]
    ds_read_b64_tr_b16 a[122:123], v84 offset:43648
    s_waitcnt lgkmcnt(12)
    v_mfma_f32_16x16x32_bf16 v[64:67], a[64:67], a[100:103], v[64:67]
    ds_read_b64_tr_b16 a[124:125], v85 offset:43136
    v_mfma_f32_16x16x32_bf16 v[72:75], a[68:71], a[100:103], v[72:75]
    ds_read_b64_tr_b16 a[126:127], v85 offset:43648
    s_barrier
    s_setprio 3
    s_waitcnt lgkmcnt(10)
    v_mfma_f32_16x16x32_bf16 v[28:31], a[104:107], a[72:75], v[28:31]
    ds_read_b128 a[0:3], v80 offset:0
    v_mfma_f32_16x16x32_bf16 v[44:47], a[104:107], a[76:79], v[44:47]
    ds_read_b128 a[4:7], v82 offset:0
    s_waitcnt lgkmcnt(10)
    v_mfma_f32_16x16x32_bf16 v[32:35], a[108:111], a[72:75], v[32:35]
    ds_read_b64_tr_b16 a[80:81], v24 offset:0
    v_mfma_f32_16x16x32_bf16 v[48:51], a[108:111], a[76:79], v[48:51]
    ds_read_b64_tr_b16 a[82:83], v24 offset:512
    s_waitcnt lgkmcnt(10)
    v_mfma_f32_16x16x32_bf16 v[36:39], a[112:115], a[72:75], v[36:39]
    ds_read_b64_tr_b16 a[84:85], v25 offset:0
    v_mfma_f32_16x16x32_bf16 v[52:55], a[112:115], a[76:79], v[52:55]
    s_setprio 2
    s_waitcnt lgkmcnt(9)
    v_mfma_f32_16x16x32_bf16 v[40:43], a[116:119], a[72:75], v[40:43]
    ds_read_b64_tr_b16 a[86:87], v25 offset:512
    v_mfma_f32_16x16x32_bf16 v[56:59], a[116:119], a[76:79], v[56:59]
    ds_read_b64_tr_b16 a[88:89], v26 offset:0
    s_waitcnt lgkmcnt(9)
    v_mfma_f32_16x16x32_bf16 v[60:63], a[72:75], a[120:123], v[60:63]
    ds_read_b64_tr_b16 a[90:91], v26 offset:512
    v_mfma_f32_16x16x32_bf16 v[68:71], a[76:79], a[120:123], v[68:71]
    ds_read_b64_tr_b16 a[92:93], v27 offset:0
    s_waitcnt lgkmcnt(9)
    v_mfma_f32_16x16x32_bf16 v[64:67], a[72:75], a[124:127], v[64:67]
    ds_read_b64_tr_b16 a[94:95], v27 offset:512
    v_mfma_f32_16x16x32_bf16 v[72:75], a[76:79], a[124:127], v[72:75]
    buffer_store_dwordx4 v[100:103], v13, s[28:31], s23 offen offset:1024 sc1
    s_cmp_eq_u32 s42, 6
    s_cbranch_scc1 Lxe6
Lxe6_b:
    s_setprio 1
    s_waitcnt lgkmcnt(6)
    v_mfma_f32_16x16x32_bf16 v[28:31], a[80:83], a[0:3], v[28:31]
    ds_read_b128 a[8:11], v81 offset:0
    ds_read_b128 a[12:15], v83 offset:0
    v_mfma_f32_16x16x32_bf16 v[44:47], a[80:83], a[4:7], v[44:47]
    ds_read_b64_tr_b16 a[104:105], v24 offset:4096
    s_waitcnt lgkmcnt(7)
    v_mfma_f32_16x16x32_bf16 v[32:35], a[84:87], a[0:3], v[32:35]
    ds_read_b64_tr_b16 a[106:107], v24 offset:4608
    ds_read_b64_tr_b16 a[108:109], v25 offset:4096
    v_mfma_f32_16x16x32_bf16 v[48:51], a[84:87], a[4:7], v[48:51]
    ds_read_b64_tr_b16 a[110:111], v25 offset:4608
    s_setprio 0
    s_waitcnt lgkmcnt(8)
    v_mfma_f32_16x16x32_bf16 v[36:39], a[88:91], a[0:3], v[36:39]
    v_mfma_f32_16x16x32_bf16 v[52:55], a[88:91], a[4:7], v[52:55]
    ds_read_b64_tr_b16 a[112:113], v26 offset:4096
    ds_read_b64_tr_b16 a[114:115], v26 offset:4608
    s_waitcnt lgkmcnt(8)
    v_mfma_f32_16x16x32_bf16 v[40:43], a[92:95], a[0:3], v[40:43]
    ds_read_b64_tr_b16 a[116:117], v27 offset:4096
    v_mfma_f32_16x16x32_bf16 v[56:59], a[92:95], a[4:7], v[56:59]
    ds_read_b64_tr_b16 a[118:119], v27 offset:4608
    s_barrier
    s_setprio 3
    s_waitcnt lgkmcnt(6)
    v_mfma_f32_16x16x32_bf16 v[28:31], a[104:107], a[8:11], v[28:31]
    ds_read_b128 a[16:19], v80 offset:39040
    ds_read_b128 a[20:23], v82 offset:39040
    v_mfma_f32_16x16x32_bf16 v[44:47], a[104:107], a[12:15], v[44:47]
    ds_read_b64_tr_b16 a[80:81], v24 offset:39040
    s_waitcnt lgkmcnt(7)
    v_mfma_f32_16x16x32_bf16 v[32:35], a[108:111], a[8:11], v[32:35]
    ds_read_b64_tr_b16 a[82:83], v24 offset:39552
    v_mfma_f32_16x16x32_bf16 v[48:51], a[108:111], a[12:15], v[48:51]
    ds_read_b64_tr_b16 a[84:85], v25 offset:39040
    s_setprio 2
    s_waitcnt lgkmcnt(7)
    v_mfma_f32_16x16x32_bf16 v[36:39], a[112:115], a[8:11], v[36:39]
    ds_read_b64_tr_b16 a[86:87], v25 offset:39552
    ds_read_b64_tr_b16 a[88:89], v26 offset:39040
    v_mfma_f32_16x16x32_bf16 v[52:55], a[112:115], a[12:15], v[52:55]
    ds_read_b64_tr_b16 a[90:91], v26 offset:39552
    s_waitcnt lgkmcnt(8)
    v_mfma_f32_16x16x32_bf16 v[40:43], a[116:119], a[8:11], v[40:43]
    ds_read_b64_tr_b16 a[92:93], v27 offset:39040
    v_mfma_f32_16x16x32_bf16 v[56:59], a[116:119], a[12:15], v[56:59]
    ds_read_b64_tr_b16 a[94:95], v27 offset:39552
    s_cmp_eq_u32 s42, 7
    s_cbranch_scc1 Lxe7
Lxe7_b:
    s_setprio 1
    s_waitcnt lgkmcnt(6)
    v_mfma_f32_16x16x32_bf16 v[28:31], a[80:83], a[16:19], v[28:31]
    ds_read_b128 a[24:27], v81 offset:39040
    ds_read_b128 a[28:31], v83 offset:39040
    v_mfma_f32_16x16x32_bf16 v[44:47], a[80:83], a[20:23], v[44:47]
    ds_read_b64_tr_b16 a[104:105], v24 offset:43136
    s_waitcnt lgkmcnt(7)
    v_mfma_f32_16x16x32_bf16 v[32:35], a[84:87], a[16:19], v[32:35]
    ds_read_b64_tr_b16 a[106:107], v24 offset:43648
    ds_read_b64_tr_b16 a[108:109], v25 offset:43136
    v_mfma_f32_16x16x32_bf16 v[48:51], a[84:87], a[20:23], v[48:51]
    ds_read_b64_tr_b16 a[110:111], v25 offset:43648
    s_setprio 0
    s_waitcnt lgkmcnt(8)
    v_mfma_f32_16x16x32_bf16 v[36:39], a[88:91], a[16:19], v[36:39]
    v_mfma_f32_16x16x32_bf16 v[52:55], a[88:91], a[20:23], v[52:55]
    ds_read_b64_tr_b16 a[112:113], v26 offset:43136
    ds_read_b64_tr_b16 a[114:115], v26 offset:43648
    s_waitcnt lgkmcnt(8)
    v_mfma_f32_16x16x32_bf16 v[40:43], a[92:95], a[16:19], v[40:43]
    ds_read_b64_tr_b16 a[116:117], v27 offset:43136
    v_mfma_f32_16x16x32_bf16 v[56:59], a[92:95], a[20:23], v[56:59]
    ds_read_b64_tr_b16 a[118:119], v27 offset:43648
    s_barrier
    s_setprio 3
    s_waitcnt lgkmcnt(6)
    v_mfma_f32_16x16x32_bf16 v[28:31], a[104:107], a[24:27], v[28:31]
    ds_read_b128 a[32:35], v76 offset:0
    ds_read_b128 a[36:39], v78 offset:0
    v_mfma_f32_16x16x32_bf16 v[44:47], a[104:107], a[28:31], v[44:47]
    ds_read_b64_tr_b16 a[80:81], v20 offset:0
    s_waitcnt lgkmcnt(7)
    v_mfma_f32_16x16x32_bf16 v[32:35], a[108:111], a[24:27], v[32:35]
    ds_read_b64_tr_b16 a[82:83], v20 offset:512
    v_mfma_f32_16x16x32_bf16 v[48:51], a[108:111], a[28:31], v[48:51]
    ds_read_b64_tr_b16 a[84:85], v21 offset:0
    s_setprio 2
    s_waitcnt lgkmcnt(7)
    v_mfma_f32_16x16x32_bf16 v[36:39], a[112:115], a[24:27], v[36:39]
    ds_read_b64_tr_b16 a[86:87], v21 offset:512
    ds_read_b64_tr_b16 a[88:89], v22 offset:0
    v_mfma_f32_16x16x32_bf16 v[52:55], a[112:115], a[28:31], v[52:55]
    ds_read_b64_tr_b16 a[90:91], v22 offset:512
    s_waitcnt lgkmcnt(8)
    v_mfma_f32_16x16x32_bf16 v[40:43], a[116:119], a[24:27], v[40:43]
    ds_read_b64_tr_b16 a[92:93], v23 offset:0
    v_mfma_f32_16x16x32_bf16 v[56:59], a[116:119], a[28:31], v[56:59]
    ds_read_b64_tr_b16 a[94:95], v23 offset:512
    s_cmp_eq_u32 s42, 8
    s_cbranch_scc1 Lxe8
Lxe8_b:
    s_setprio 1
    s_waitcnt lgkmcnt(6)
    v_mfma_f32_16x16x32_bf16 v[28:31], a[80:83], a[32:35], v[28:31]
    ds_read_b128 a[40:43], v77 offset:0
    ds_read_b128 a[44:47], v79 offset:0
    v_mfma_f32_16x16x32_bf16 v[44:47], a[80:83], a[36:39], v[44:47]
    ds_read_b64_tr_b16 a[104:105], v20 offset:4096
    s_waitcnt lgkmcnt(7)
    v_mfma_f32_16x16x32_bf16 v[32:35], a[84:87], a[32:35], v[32:35]
    ds_read_b64_tr_b16 a[106:107], v20 offset:4608
    v_mfma_f32_16x16x32_bf16 v[48:51], a[84:87], a[36:39], v[48:51]
    ds_read_b64_tr_b16 a[108:109], v21 offset:4096
    s_setprio 0
    s_waitcnt lgkmcnt(7)
    v_mfma_f32_16x16x32_bf16 v[36:39], a[88:91], a[32:35], v[36:39]
    ds_read_b64_tr_b16 a[110:111], v21 offset:4608
    ds_read_b64_tr_b16 a[112:113], v22 offset:4096
    v_mfma_f32_16x16x32_bf16 v[52:55], a[88:91], a[36:39], v[52:55]
    ds_read_b64_tr_b16 a[114:115], v22 offset:4608
    s_waitcnt lgkmcnt(8)
    v_mfma_f32_16x16x32_bf16 v[40:43], a[92:95], a[32:35], v[40:43]
    ds_read_b64_tr_b16 a[116:117], v23 offset:4096
    v_mfma_f32_16x16x32_bf16 v[56:59], a[92:95], a[36:39], v[56:59]
    ds_read_b64_tr_b16 a[118:119], v23 offset:4608
    s_waitcnt lgkmcnt(0)
    s_barrier
    s_setprio 3
    v_mfma_f32_16x16x32_bf16 v[28:31], a[104:107], a[40:43], v[28:31]
    ds_read_b128 a[48:51], v76 offset:39040
    ds_read_b128 a[52:55], v78 offset:39040
    v_mfma_f32_16x16x32_bf16 v[44:47], a[104:107], a[44:47], v[44:47]
    ds_read_b64_tr_b16 a[80:81], v20 offset:39040
    v_mfma_f32_16x16x32_bf16 v[32:35], a[108:111], a[40:43], v[32:35]
    ds_read_b64_tr_b16 a[82:83], v20 offset:39552
    v_mfma_f32_16x16x32_bf16 v[48:51], a[108:111], a[44:47], v[48:51]
    ds_read_b64_tr_b16 a[84:85], v21 offset:39040
    s_setprio 2
    v_mfma_f32_16x16x32_bf16 v[36:39], a[112:115], a[40:43], v[36:39]
    ds_read_b64_tr_b16 a[86:87], v21 offset:39552
    ds_read_b64_tr_b16 a[88:89], v22 offset:39040
    v_mfma_f32_16x16x32_bf16 v[52:55], a[112:115], a[44:47], v[52:55]
    ds_read_b64_tr_b16 a[90:91], v22 offset:39552
    v_mfma_f32_16x16x32_bf16 v[40:43], a[116:119], a[40:43], v[40:43]
    ds_read_b64_tr_b16 a[92:93], v23 offset:39040
    v_mfma_f32_16x16x32_bf16 v[56:59], a[116:119], a[44:47], v[56:59]
    ds_read_b64_tr_b16 a[94:95], v23 offset:39552
    v_mov_b32 v98, s34
    s_waitcnt vmcnt(0)
    s_mov_b64 exec, 1
    buffer_store_dword v98, v97, s[28:31], s24 offen sc1
    s_mov_b64 exec, -1
    s_cmp_eq_u32 s42, 9
    s_cbranch_scc1 Lxe9
Lxe9_b:
    s_setprio 1
    s_waitcnt lgkmcnt(6)
    v_mfma_f32_16x16x32_bf16 v[28:31], a[80:83], a[48:51], v[28:31]
    ds_read_b128 a[56:59], v77 offset:39040
    ds_read_b128 a[60:63], v79 offset:39040
    ds_read_b64_tr_b16 a[104:105], v20 offset:43136
    v_mfma_f32_16x16x32_bf16 v[44:47], a[80:83], a[52:55], v[44:47]
    ds_read_b64_tr_b16 a[106:107], v20 offset:43648
    ds_read_b64_tr_b16 a[108:109], v21 offset:43136
    s_waitcnt lgkmcnt(9)
    v_mfma_f32_16x16x32_bf16 v[32:35], a[84:87], a[48:51], v[32:35]
    ds_read_b64_tr_b16 a[110:111], v21 offset:43648
    ds_read_b64_tr_b16 a[112:113], v22 offset:43136
    ds_read_b64_tr_b16 a[114:115], v22 offset:43648
    v_mfma_f32_16x16x32_bf16 v[48:51], a[84:87], a[52:55], v[48:51]
    ds_read_b64_tr_b16 a[116:117], v23 offset:43136
    ds_read_b64_tr_b16 a[118:119], v23 offset:43648
    s_setprio 0
    s_waitcnt lgkmcnt(12)
    v_mfma_f32_16x16x32_bf16 v[36:39], a[88:91], a[48:51], v[36:39]
    ds_read_b32 v120, v94
    ds_read_b32 v121, v94 offset:512
    v_xor_b32 v94, 64, v94
    v_mfma_f32_16x16x32_bf16 v[52:55], a[88:91], a[52:55], v[52:55]
    ds_read_b32 v122, v94
    ds_read_b32 v123, v92 offset:512
    s_waitcnt lgkmcnt(14)
    v_mfma_f32_16x16x32_bf16 v[40:43], a[92:95], a[48:51], v[40:43]
    ds_read_b32 v126, v93 offset:520
    v_mov_b32 v24, v84
    v_mov_b32 v25, v85
    v_mfma_f32_16x16x32_bf16 v[56:59], a[92:95], a[52:55], v[56:59]
    v_mov_b32 v26, v86
    v_mov_b32 v27, v87
    s_waitcnt lgkmcnt(5)
    v_mfma_f32_16x16x32_bf16 v[44:47], a[104:107], a[60:63], v[44:47]
    v_mfma_f32_16x16x32_bf16 v[48:51], a[108:111], a[60:63], v[48:51]
    v_mfma_f32_16x16x32_bf16 v[52:55], a[112:115], a[60:63], v[52:55]
    v_mfma_f32_16x16x32_bf16 v[56:59], a[116:119], a[60:63], v[56:59]
    v_mfma_f32_16x16x32_bf16 v[28:31], a[104:107], a[56:59], v[28:31]
    v_mfma_f32_16x16x32_bf16 v[32:35], a[108:111], a[56:59], v[32:35]
    ds_read_b32 v7, v96
    ds_read_b128 v[76:79], v95 offset:0
    ds_read_b128 v[80:83], v95 offset:64
    ds_read_b128 v[84:87], v95 offset:128
    ds_read_b128 v[88:91], v95 offset:192
    v_mfma_f32_16x16x32_bf16 v[36:39], a[112:115], a[56:59], v[36:39]
    v_mfma_f32_16x16x32_bf16 v[40:43], a[116:119], a[56:59], v[40:43]
    s_waitcnt lgkmcnt(0)
Lqf:
    v_readfirstlane_b32 s38, v7
    s_nop 0
    s_cmp_eq_u32 s38, 0
    s_cbranch_scc1 Lqf_re
    s_cmp_eq_u32 s27, 0
    v_fmac_f32 v44, v76, v122
    v_fmac_f32 v45, v77, v122
    v_fmac_f32 v46, v78, v122
    v_fmac_f32 v47, v79, v122
    v_cvt_pk_bf16_f32 v44, v44, v45
    v_cvt_pk_bf16_f32 v45, v46, v47
    v_fmac_f32 v48, v80, v122
    v_fmac_f32 v49, v81, v122
    v_fmac_f32 v50, v82, v122
    v_fmac_f32 v51, v83, v122
    v_cvt_pk_bf16_f32 v46, v48, v49
    v_cvt_pk_bf16_f32 v47, v50, v51
    v_fmac_f32 v52, v84, v122
    v_fmac_f32 v53, v85, v122
    v_fmac_f32 v54, v86, v122
    v_fmac_f32 v55, v87, v122
    v_cvt_pk_bf16_f32 v48, v52, v53
    v_cvt_pk_bf16_f32 v49, v54, v55
    v_fmac_f32 v56, v88, v122
    v_fmac_f32 v57, v89, v122
    v_fmac_f32 v58, v90, v122
    v_fmac_f32 v59, v91, v122
    v_cvt_pk_bf16_f32 v50, v56, v57
    v_cvt_pk_bf16_f32 v51, v58, v59
    s_cbranch_scc0 Lh1
    ds_write_b128 v125, v[44:47] offset:0
    ds_write_b128 v125, v[48:51] offset:1024
    v_mov_b32 v5, 157972
    v_mov_b32 v6, 1
    s_mov_b64 exec, 1
    ds_add_u32 v5, v6
    s_mov_b64 exec, -1
    v_fmac_f32 v28, v76, v120
    v_fmac_f32 v29, v77, v120
    v_fmac_f32 v30, v78, v120
    v_fmac_f32 v31, v79, v120
    v_cvt_pk_bf16_f32 v28, v28, v29
    v_cvt_pk_bf16_f32 v29, v30, v31
    v_fmac_f32 v32, v80, v120
    v_fmac_f32 v33, v81, v120
    v_fmac_f32 v34, v82, v120
    v_fmac_f32 v35, v83, v120
    v_cvt_pk_bf16_f32 v30, v32, v33
    v_cvt_pk_bf16_f32 v31, v34, v35
    v_fmac_f32 v36, v84, v120
    v_fmac_f32 v37, v85, v120
    v_fmac_f32 v38, v86, v120
    v_fmac_f32 v39, v87, v120
    v_cvt_pk_bf16_f32 v32, v36, v37
    v_cvt_pk_bf16_f32 v33, v38, v39
    v_fmac_f32 v40, v88, v120
    v_fmac_f32 v41, v89, v120
    v_fmac_f32 v42, v90, v120
    v_fmac_f32 v43, v91, v120
    v_cvt_pk_bf16_f32 v34, v40, v41
    v_cvt_pk_bf16_f32 v35, v42, v43
    v_subrev_u32 v4, 6144, v125
    v_mov_b32 v8, s22
    v_mov_b32 v9, s22
    v_mov_b32 v10, s22
    v_mov_b32 v11, s22
Lcw_1:
    s_sub_u32 s35, s35, 1
    s_cbranch_scc1 Lend
    ds_read_b32 v6, v5
    s_waitcnt lgkmcnt(0)
    v_readfirstlane_b32 s38, v6
    s_nop 0
    s_cmp_lt_u32 s38, 8
    s_cbranch_scc1 Lcw_1
    ds_read_b128 v[52:55], v125 offset:2048
    ds_read_b128 v[56:59], v125 offset:3072
    ds_read_b128 v[44:47], v4 offset:4096
    ds_read_b128 v[48:51], v4 offset:5120
    s_branch Lh_join
Lh1:
    ds_write_b128 v125, v[44:47] offset:2048
    ds_write_b128 v125, v[48:51] offset:3072
    v_fmac_f32 v28, v76, v120
    v_fmac_f32 v29, v77, v120
    v_fmac_f32 v30, v78, v120
    v_fmac_f32 v31, v79, v120
    v_cvt_pk_bf16_f32 v52, v28, v29
    v_cvt_pk_bf16_f32 v53, v30, v31
    v_fmac_f32 v32, v80, v120
    v_fmac_f32 v33, v81, v120
    v_fmac_f32 v34, v82, v120
    v_fmac_f32 v35, v83, v120
    v_cvt_pk_bf16_f32 v54, v32, v33
    v_cvt_pk_bf16_f32 v55, v34, v35
    v_fmac_f32 v36, v84, v120
    v_fmac_f32 v37, v85, v120
    v_fmac_f32 v38, v86, v120
    v_fmac_f32 v39, v87, v120
    v_cvt_pk_bf16_f32 v56, v36, v37
    v_cvt_pk_bf16_f32 v57, v38, v39
    v_fmac_f32 v40, v88, v120
    v_fmac_f32 v41, v89, v120
    v_fmac_f32 v42, v90, v120
    v_fmac_f32 v43, v91, v120
    v_cvt_pk_bf16_f32 v58, v40, v41
    v_cvt_pk_bf16_f32 v59, v42, v43
    ds_write_b128 v125, v[52:55] offset:4096
    ds_write_b128 v125, v[56:59] offset:5120
    v_mov_b32 v5, 157972
    v_mov_b32 v6, 1
    s_mov_b64 exec, 1
    ds_add_u32 v5, v6
    s_mov_b64 exec, -1
    v_mov_b32 v8, s22
    v_mov_b32 v9, s22
    v_mov_b32 v10, s22
    v_mov_b32 v11, s22
Lcw_2:
    s_sub_u32 s35, s35, 1
    s_cbranch_scc1 Lend
    ds_read_b32 v6, v5
    s_waitcnt lgkmcnt(0)
    v_readfirstlane_b32 s38, v6
    s_nop 0
    s_cmp_lt_u32 s38, 8
    s_cbranch_scc1 Lcw_2
    ds_read_b128 v[28:31], v125 offset:0
    ds_read_b128 v[32:35], v125 offset:1024
Lh_join:
    buffer_load_dword v20, v12, s[28:31], s24 offen sc1
    ds_read_b64_tr_b16 a[64:65], v26 offset:0
    ds_read_b64_tr_b16 a[66:67], v26 offset:512
    ds_read_b64_tr_b16 a[68:69], v27 offset:0
    ds_read_b64_tr_b16 a[70:71], v27 offset:512
    ds_read_b64_tr_b16 a[72:73], v26 offset:4096
    ds_read_b64_tr_b16 a[74:75], v26 offset:4608
    ds_read_b64_tr_b16 a[76:77], v27 offset:4096
    ds_read_b64_tr_b16 a[78:79], v27 offset:4608
    s_waitcnt lgkmcnt(8)
    s_setprio 2
    v_cndmask_b32 v92, 0, v30, s[6:7]
    v_cndmask_b32 v93, 0, v31, s[6:7]
    v_cndmask_b32 v94, 0, v32, s[12:13]
    v_cndmask_b32 v95, 0, v33, s[12:13]
    v_cndmask_b32 v104, 0, v30, s[8:9]
    v_cndmask_b32 v105, 0, v31, s[8:9]
    v_mfma_f32_16x16x32_bf16 v[76:79], v[46:49], v[92:95], v[8:11]
    v_mfma_f32_16x16x32_bf16 v[80:83], v[54:57], v[92:95], 0
    v_cndmask_b32 v106, 0, v32, s[14:15]
    v_cndmask_b32 v107, 0, v33, s[14:15]
    v_mov_b32 v96, v28
    v_mov_b32 v97, v29
    v_mfma_f32_16x16x32_bf16 v[84:87], v[46:49], v[104:107], v[8:11]
    v_mfma_f32_16x16x32_bf16 v[88:91], v[54:57], v[104:107], 0
    v_cndmask_b32 v98, 0, v30, s[10:11]
    v_cndmask_b32 v99, 0, v31, s[10:11]
    v_cndmask_b32 v100, 0, v32, s[16:17]
    v_cndmask_b32 v101, 0, v33, s[16:17]
    v_mfma_f32_16x16x32_bf16 v[36:39], v[44:47], v[96:99], v[8:11]
    v_mfma_f32_16x16x32_bf16 v[40:43], v[52:55], v[96:99], 0
    v_cndmask_b32 v76, v76, v77, s[4:5]
    v_cndmask_b32 v80, v80, v81, s[4:5]
    v_cndmask_b32 v78, v78, v79, s[4:5]
    v_cndmask_b32 v82, v82, v83, s[4:5]
    v_cndmask_b32 v92, v76, v80, s[18:19]
    v_cndmask_b32 v94, v78, v82, s[20:21]
    v_min_u32 v4, -2, v92
    v_min_u32 v5, -2, v94
    v_cndmask_b32 v84, v84, v85, s[4:5]
    v_cndmask_b32 v88, v88, v89, s[4:5]
    v_cndmask_b32 v86, v86, v87, s[4:5]
    v_cndmask_b32 v90, v90, v91, s[4:5]
    v_cndmask_b32 v104, v84, v88, s[18:19]
    v_cndmask_b32 v106, v86, v90, s[20:21]
    v_min_u32 v6, -2, v104
    v_min_u32 v7, -2, v106
    buffer_store_dwordx4 v[4:7], v13, s[28:31], s56 offen sc1
    s_setprio 0
    ds_read_b64_tr_b16 a[80:81], v26 offset:39040
    ds_read_b64_tr_b16 a[82:83], v26 offset:39552
    ds_read_b64_tr_b16 a[84:85], v27 offset:39040
    ds_read_b64_tr_b16 a[86:87], v27 offset:39552
    ds_read_b64_tr_b16 a[88:89], v26 offset:43136
    ds_read_b64_tr_b16 a[90:91], v26 offset:43648
    ds_read_b64_tr_b16 a[92:93], v27 offset:43136
    ds_read_b64_tr_b16 a[94:95], v27 offset:43648
    ds_read_b64_tr_b16 a[96:97], v24 offset:0
    ds_read_b64_tr_b16 a[98:99], v24 offset:512
    ds_read_b64_tr_b16 a[100:101], v25 offset:0
    ds_read_b64_tr_b16 a[102:103], v25 offset:512
    ds_read_b64_tr_b16 a[104:105], v24 offset:4096
    ds_read_b64_tr_b16 a[106:107], v24 offset:4608
    ds_read_b64_tr_b16 a[108:109], v25 offset:4096
    ds_read_b64_tr_b16 a[110:111], v25 offset:4608
    ds_read_b64_tr_b16 a[112:113], v24 offset:39040
    ds_read_b64_tr_b16 a[114:115], v24 offset:39552
    ds_read_b64_tr_b16 a[116:117], v25 offset:39040
    ds_read_b64_tr_b16 a[118:119], v25 offset:39552
    ds_read_b64_tr_b16 a[120:121], v24 offset:43136
    ds_read_b64_tr_b16 a[122:123], v24 offset:43648
    ds_read_b64_tr_b16 a[124:125], v25 offset:43136
    ds_read_b64_tr_b16 a[126:127], v25 offset:43648
    s_waitcnt lgkmcnt(15)
    v_mfma_f32_16x16x32_bf16 v[60:63], a[0:3], a[64:67], v[60:63]
    v_mov_b32 v102, v34
    v_mov_b32 v103, v35
    v_mul_f32 v4, s25, v121
    v_mfma_f32_16x16x32_bf16 v[68:71], a[4:7], a[64:67], v[68:71]
    v_mfma_f32_16x16x32_bf16 v[76:79], v[48:51], v[100:103], v[8:11]
    v_mfma_f32_16x16x32_bf16 v[80:83], v[56:59], v[100:103], 0
    v_mfma_f32_16x16x32_bf16 v[64:67], a[0:3], a[68:71], v[64:67]
    v_mul_f32 v123, v123, v4
    v_mul_f32 v126, v126, v4
    v_cndmask_b32 v36, v36, v37, s[4:5]
    v_mfma_f32_16x16x32_bf16 v[72:75], a[4:7], a[68:71], v[72:75]
    v_cndmask_b32 v40, v40, v41, s[4:5]
    v_cndmask_b32 v38, v38, v39, s[4:5]
    v_mfma_f32_16x16x32_bf16 v[60:63], a[8:11], a[72:75], v[60:63]
    v_cndmask_b32 v42, v42, v43, s[4:5]
    v_cndmask_b32 v96, v36, v40, s[18:19]
    v_cndmask_b32 v98, v38, v42, s[20:21]
    v_mfma_f32_16x16x32_bf16 v[68:71], a[12:15], a[72:75], v[68:71]
    v_cndmask_b32 v76, v76, v77, s[4:5]
    v_cndmask_b32 v80, v80, v81, s[4:5]
    v_mfma_f32_16x16x32_bf16 v[64:67], a[8:11], a[76:79], v[64:67]
    v_cndmask_b32 v78, v78, v79, s[4:5]
    v_cndmask_b32 v82, v82, v83, s[4:5]
    v_cndmask_b32 v100, v76, v80, s[18:19]
    v_mfma_f32_16x16x32_bf16 v[72:75], a[12:15], a[76:79], v[72:75]
    v_cndmask_b32 v102, v78, v82, s[20:21]
    v_mul_f32 v96, v96, v123
    v_mfma_f32_16x16x32_bf16 v[60:63], a[16:19], a[80:83], v[60:63]
    v_mul_f32 v98, v98, v126
    v_mul_f32 v100, v100, v123
    v_mul_f32 v102, v102, v126
    v_mfma_f32_16x16x32_bf16 v[68:71], a[20:23], a[80:83], v[68:71]
    v_max_f32 v4, v96, v98
    v_max_f32 v5, v100, v102
    v_mfma_f32_16x16x32_bf16 v[64:67], a[16:19], a[84:87], v[64:67]
    v_mov_b32 v6, v4
    v_mov_b32 v7, v5
    s_nop 0
    v_permlane32_swap_b32 v4, v6
    v_mfma_f32_16x16x32_bf16 v[72:75], a[20:23], a[84:87], v[72:75]
    v_permlane32_swap_b32 v5, v7
    v_max_f32 v4, v4, v6
    v_mfma_f32_16x16x32_bf16 v[60:63], a[24:27], a[88:91], v[60:63]
    v_max_f32 v5, v5, v7
    v_mov_b32 v6, v4
    v_mov_b32 v7, v5
    v_mfma_f32_16x16x32_bf16 v[68:71], a[28:31], a[88:91], v[68:71]
    v_permlane16_swap_b32 v4, v6
    v_permlane16_swap_b32 v5, v7
    v_mfma_f32_16x16x32_bf16 v[64:67], a[24:27], a[92:95], v[64:67]
    v_max_f32 v4, v4, v6
    v_max_f32 v5, v5, v7
    v_mfma_f32_16x16x32_bf16 v[72:75], a[28:31], a[92:95], v[72:75]
    v_sub_f32 v96, v96, v4
    v_sub_f32 v98, v98, v4
    s_waitcnt lgkmcnt(12)
    v_mfma_f32_16x16x32_bf16 v[60:63], a[32:35], a[96:99], v[60:63]
    v_sub_f32 v100, v100, v5
    v_sub_f32 v102, v102, v5
    v_exp_f32 v96, v96
    v_mfma_f32_16x16x32_bf16 v[68:71], a[36:39], a[96:99], v[68:71]
    v_exp_f32 v98, v98
    v_exp_f32 v100, v100
    v_mfma_f32_16x16x32_bf16 v[64:67], a[32:35], a[100:103], v[64:67]
    v_exp_f32 v102, v102
    v_cvt_pk_bf16_f32 v96, v96, v96
    v_mfma_f32_16x16x32_bf16 v[72:75], a[36:39], a[100:103], v[72:75]
    v_cvt_pk_bf16_f32 v97, v98, v98
    v_cvt_pk_bf16_f32 v100, v100, v100
    s_waitcnt lgkmcnt(8)
    v_mfma_f32_16x16x32_bf16 v[60:63], a[40:43], a[104:107], v[60:63]
    v_cvt_pk_bf16_f32 v101, v102, v102
    v_and_b32 v98, v96, v118
    v_and_b32 v99, v97, v119
    v_mfma_f32_16x16x32_bf16 v[68:71], a[44:47], a[104:107], v[68:71]
    v_and_b32 v96, v96, v116
    v_and_b32 v97, v97, v117
    v_mfma_f32_16x16x32_bf16 v[64:67], a[40:43], a[108:111], v[64:67]
    v_and_b32 v102, v100, v118
    v_and_b32 v103, v101, v119
    v_mfma_f32_16x16x32_bf16 v[72:75], a[44:47], a[108:111], v[72:75]
    v_and_b32 v100, v100, v116
    v_and_b32 v101, v101, v117
    s_waitcnt lgkmcnt(4)
    v_mfma_f32_16x16x32_bf16 v[60:63], a[48:51], a[112:115], v[60:63]
    s_lshl_b32 s36, s43, 6
    s_add_u32 s36, s36, 156160
    v_lshl_add_u32 v48, v2, 4, s36
    v_xor_b32 v49, 64, v48
    ds_read_b128 v[28:31], v48 offset:0
    v_mfma_f32_16x16x32_bf16 v[68:71], a[52:55], a[112:115], v[68:71]
    ds_read_b128 v[32:35], v48 offset:512
    ds_read_b128 v[36:39], v49 offset:0
    ds_read_b128 v[40:43], v49 offset:512
    s_lshl_b32 s36, s27, 3
    s_add_u32 s36, s36, 157696
    v_mfma_f32_16x16x32_bf16 v[64:67], a[48:51], a[116:119], v[64:67]
    v_lshl_add_u32 v48, v3, 4, s36
    v_mov_b32 v49, 157952
    v_lshl_add_u32 v125, v1, 3, s48
    s_lshl_b32 s36, s27, 10
    v_add_u32 v50, s36, v125
    v_mfma_f32_16x16x32_bf16 v[72:75], a[52:55], a[116:119], v[72:75]
    s_lshl_b32 s37, s27, 12
    s_sub_u32 s37, 2048, s37
    v_add_u32 v51, s37, v50
    v_subrev_u32 v125, 2048, v125
    s_waitcnt vmcnt(1)
Lfl_chk:
    v_cmp_eq_u32 vcc, s34, v20
    s_nop 0
    s_and_b32 s36, vcc_lo, 0x3ff
    s_cmp_lg_u32 s36, 0x3ff
    s_cbranch_scc1 Lfl_re
    buffer_load_dwordx2 v[52:53], v13, s[28:31], s57 offen offset:8 sc1
    buffer_load_dwordx2 v[54:55], v13, s[28:31], s58 offen offset:0 sc1
    s_waitcnt lgkmcnt(4)
    v_mfma_f32_16x16x32_bf16 v[60:63], a[56:59], a[120:123], v[60:63]
    v_mfma_f32_16x16x32_bf16 v[68:71], a[60:63], a[120:123], v[68:71]
    v_mfma_f32_16x16x32_bf16 v[64:67], a[56:59], a[124:127], v[64:67]
    v_mfma_f32_16x16x32_bf16 v[72:75], a[60:63], a[124:127], v[72:75]
    ds_read_b32 v46, v49
    ds_read_b64 v[44:45], v48
    s_waitcnt lgkmcnt(0)
Lcsv:
    v_readfirstlane_b32 s38, v46
    s_nop 0
    s_cmp_eq_u32 s38, 0
    s_cbranch_scc1 Lcsv_re
    v_fmac_f32 v60, v28, v44
    v_fmac_f32 v61, v29, v44
    v_fmac_f32 v62, v30, v44
    v_fmac_f32 v63, v31, v44
    v_mul_f32 v60, v60, v32
    v_mul_f32 v61, v61, v33
    v_mul_f32 v62, v62, v34
    v_mul_f32 v63, v63, v35
    v_cvt_pk_bf16_f32 v60, v60, v61
    v_cvt_pk_bf16_f32 v61, v62, v63
    ds_write_b64 v50, v[60:61] offset:0
    v_fmac_f32 v64, v28, v45
    v_fmac_f32 v65, v29, v45
    v_fmac_f32 v66, v30, v45
    v_fmac_f32 v67, v31, v45
    v_mul_f32 v64, v64, v32
    v_mul_f32 v65, v65, v33
    v_mul_f32 v66, v66, v34
    v_mul_f32 v67, v67, v35
    v_cvt_pk_bf16_f32 v64, v64, v65
    v_cvt_pk_bf16_f32 v65, v66, v67
    ds_write_b64 v50, v[64:65] offset:512
    v_fmac_f32 v68, v36, v44
    v_fmac_f32 v69, v37, v44
    v_fmac_f32 v70, v38, v44
    v_fmac_f32 v71, v39, v44
    v_mul_f32 v68, v68, v40
    v_mul_f32 v69, v69, v41
    v_mul_f32 v70, v70, v42
    v_mul_f32 v71, v71, v43
    v_cvt_pk_bf16_f32 v68, v68, v69
    v_cvt_pk_bf16_f32 v69, v70, v71
    ds_write_b64 v51, v[68:69] offset:0
    v_fmac_f32 v72, v36, v45
    v_fmac_f32 v73, v37, v45
    v_fmac_f32 v74, v38, v45
    v_fmac_f32 v75, v39, v45
    v_mul_f32 v72, v72, v40
    v_mul_f32 v73, v73, v41
    v_mul_f32 v74, v74, v42
    v_mul_f32 v75, v75, v43
    v_cvt_pk_bf16_f32 v72, v72, v73
    v_cvt_pk_bf16_f32 v73, v74, v75
    ds_write_b64 v51, v[72:73] offset:512
    v_mov_b32 v8, 157976
    v_mov_b32 v9, 1
    s_mov_b64 exec, 1
    ds_add_u32 v8, v9
    s_mov_b64 exec, -1
    s_waitcnt vmcnt(0)
Lrx_chk:
    v_and_b32 v52, s59, v52
    v_and_b32 v53, s59, v53
    v_and_b32 v54, s60, v54
    v_and_b32 v55, s60, v55
    v_max3_u32 v4, v52, v53, v54
    v_max_u32 v4, v4, v55
    v_cmp_eq_u32 vcc, -1, v4
    s_nop 0
    s_cbranch_vccnz Lrx_re
    v_add_f32 v92, v92, v52
    v_add_f32 v94, v94, v53
    v_add_f32 v104, v104, v54
    v_add_f32 v106, v106, v55
    s_setprio 2
Lcw_4:
    s_sub_u32 s35, s35, 1
    s_cbranch_scc1 Lend
    ds_read_b32 v9, v8
    s_waitcnt lgkmcnt(0)
    v_readfirstlane_b32 s38, v9
    s_nop 0
    s_cmp_lt_u32 s38, 7
    s_cbranch_scc1 Lcw_4
    ds_read2st64_b64 v[60:63], v125 offset0:0 offset1:4
    ds_read2st64_b64 v[64:67], v125 offset0:1 offset1:5
    ds_read2st64_b64 v[68:71], v125 offset0:2 offset1:6
    ds_read2st64_b64 v[72:75], v125 offset0:3 offset1:7
    v_mul_f32 v92, v92, v123
    v_mul_f32 v94, v94, v126
    v_mul_f32 v104, v104, v123
    v_mul_f32 v106, v106, v126
    v_max_f32 v4, v92, v94
    v_max_f32 v5, v104, v106
    v_mov_b32 v6, v4
    v_mov_b32 v7, v5
    s_nop 0
    v_permlane32_swap_b32 v4, v6
    v_permlane32_swap_b32 v5, v7
    v_max_f32 v4, v4, v6
    v_max_f32 v5, v5, v7
    s_waitcnt lgkmcnt(0)
    v_mov_b32 v6, v4
    v_mfma_f32_16x16x32_bf16 v[80:83], v[14:17], v[96:99], 0
    v_mov_b32 v7, v5
    v_permlane16_swap_b32 v4, v6
    s_nop 0
    v_permlane16_swap_b32 v5, v7
    v_max_f32 v4, v4, v6
    v_mfma_f32_16x16x32_bf16 v[84:87], v[14:17], v[100:103], 0
    v_max_f32 v5, v5, v7
    v_sub_f32 v92, v92, v4
    v_sub_f32 v94, v94, v4
    v_sub_f32 v104, v104, v5
    v_mfma_f32_16x16x32_bf16 v[28:31], v[60:63], v[96:99], 0
    v_sub_f32 v106, v106, v5
    v_exp_f32 v92, v92
    v_exp_f32 v94, v94
    v_exp_f32 v104, v104
    v_exp_f32 v106, v106
    v_mfma_f32_16x16x32_bf16 v[32:35], v[64:67], v[96:99], 0
    v_cvt_pk_bf16_f32 v92, v92, v92
    v_cvt_pk_bf16_f32 v93, v94, v94
    v_cvt_pk_bf16_f32 v104, v104, v104
    v_cvt_pk_bf16_f32 v105, v106, v106
    v_mfma_f32_16x16x32_bf16 v[36:39], v[68:71], v[100:103], 0
    v_and_b32 v94, v92, v118
    v_and_b32 v95, v93, v119
    v_and_b32 v92, v92, v116
    v_and_b32 v93, v93, v117
    v_mfma_f32_16x16x32_bf16 v[40:43], v[72:75], v[100:103], 0
    v_and_b32 v106, v104, v118
    v_and_b32 v107, v105, v119
    v_and_b32 v104, v104, v116
    v_and_b32 v105, v105, v117
    v_mfma_f32_16x16x32_bf16 v[76:79], v[14:17], v[92:95], 0
    v_rcp_f32 v80, v80
    v_rcp_f32 v84, v84
    v_mfma_f32_16x16x32_bf16 v[88:91], v[14:17], v[104:107], 0
    v_mul_f32 v28, v28, v80
    v_mul_f32 v29, v29, v80
    v_mfma_f32_16x16x32_bf16 v[44:47], v[64:67], v[92:95], 0
    v_mul_f32 v30, v30, v80
    v_mfma_f32_16x16x32_bf16 v[48:51], v[68:71], v[92:95], 0
    v_mul_f32 v31, v31, v80
    v_cvt_pk_bf16_f32 v4, v28, v29
    v_mfma_f32_16x16x32_bf16 v[52:55], v[64:67], v[104:107], 0
    v_cvt_pk_bf16_f32 v5, v30, v31
    v_min_u32 v4, -2, v4
    v_mfma_f32_16x16x32_bf16 v[56:59], v[68:71], v[104:107], 0
    v_min_u32 v5, -2, v5
    v_mul_f32 v40, v40, v84
    v_mul_f32 v41, v41, v84
    v_mul_f32 v42, v42, v84
    v_mul_f32 v43, v43, v84
    v_cvt_pk_bf16_f32 v10, v40, v41
    v_cvt_pk_bf16_f32 v11, v42, v43
    v_min_u32 v10, -2, v10
    v_min_u32 v11, -2, v11
    v_rcp_f32 v76, v76
    v_rcp_f32 v88, v88
    v_cndmask_b32 v82, v80, v76, s[6:7]
    v_cndmask_b32 v82, v82, v88, s[8:9]
    v_cndmask_b32 v32, v32, v44, s[6:7]
    v_cndmask_b32 v33, v33, v45, s[6:7]
    v_cndmask_b32 v34, v34, v46, s[6:7]
    v_cndmask_b32 v35, v35, v47, s[6:7]
    v_cndmask_b32 v32, v32, v52, s[8:9]
    v_cndmask_b32 v33, v33, v53, s[8:9]
    v_cndmask_b32 v34, v34, v54, s[8:9]
    v_cndmask_b32 v35, v35, v55, s[8:9]
    v_mul_f32 v32, v32, v82
    v_mul_f32 v33, v33, v82
    v_mul_f32 v34, v34, v82
    v_mul_f32 v35, v35, v82
    v_cvt_pk_bf16_f32 v6, v32, v33
    v_cvt_pk_bf16_f32 v7, v34, v35
    v_min_u32 v6, -2, v6
    v_min_u32 v7, -2, v7
    buffer_store_dwordx4 v[4:7], v13, s[28:31], s23 offen offset:0 sc1
    v_cndmask_b32 v86, v84, v76, s[12:13]
    v_cndmask_b32 v86, v86, v88, s[14:15]
    v_cndmask_b32 v36, v36, v48, s[12:13]
    v_cndmask_b32 v37, v37, v49, s[12:13]
    v_cndmask_b32 v38, v38, v50, s[12:13]
    v_cndmask_b32 v39, v39, v51, s[12:13]
    v_cndmask_b32 v36, v36, v56, s[14:15]
    v_cndmask_b32 v37, v37, v57, s[14:15]
    v_cndmask_b32 v38, v38, v58, s[14:15]
    v_cndmask_b32 v39, v39, v59, s[14:15]
    v_mul_f32 v36, v36, v86
    v_mul_f32 v37, v37, v86
    v_mul_f32 v38, v38, v86
    v_mul_f32 v39, v39, v86
    v_cvt_pk_bf16_f32 v8, v36, v37
    v_cvt_pk_bf16_f32 v9, v38, v39
    v_min_u32 v8, -2, v8
    v_min_u32 v9, -2, v9
    buffer_store_dwordx4 v[8:11], v13, s[28:31], s23 offen offset:1024 sc1
    s_setprio 1
    s_nop 0
    v_mov_b32 v10, 157980
    v_and_b32 v6, 3, v1
    v_lshl_add_u32 v6, v6, 3, v19
    v_add_u32 v20, v6, v18
    v_xor_b32 v21, 32, v20
    v_xor_b32 v22, 64, v20
    v_xor_b32 v23, 96, v20
    v_add_u32 v24, 63616, v20
    v_add_u32 v25, 63616, v21
    v_add_u32 v26, 63616, v22
    v_add_u32 v27, 63616, v23
Lcw_3:
    s_sub_u32 s35, s35, 1
    s_cbranch_scc1 Lend
    ds_read_b32 v11, v10
    s_waitcnt lgkmcnt(0)
    v_readfirstlane_b32 s38, v11
    s_nop 0
    s_cmp_lt_u32 s38, 2
    s_cbranch_scc1 Lcw_3
    s_mul_i32 s36, s32, 96
    s_lshl_b32 s37, s43, 4
    s_add_u32 s36, s36, s37
    s_sub_u32 s36, s36, 32
    v_add_u32 v126, s36, v3
    v_lshrrev_b32 v6, 3, v1
    v_add_u32 v6, s36, v6
    v_mul_u32_u24 v6, 1280, v6
    v_and_b32 v7, 7, v1
    v_xor_b32 v7, v7, v2
    v_lshl_add_u32 v122, v7, 4, v6
    v_xor_b32 v123, 64, v122
    v_add_u32 v123, 10240, v123
    s_lshl_b32 s36, s43, 11
    s_add_u32 s36, s36, 102656
    v_add_u32 v124, s36, v124
    v_add_u32 v125, s36, v13
    s_lshl_b32 s24, s33, 7
    v_mov_b32 v10, 157960
    s_mov_b32 s41, 0
    s_mov_b32 s61, 3
    v_lshlrev_b32 v28, 16, v108
    ds_read_b64_tr_b16 a[0:1], v20 offset:0
    ds_read_b64_tr_b16 a[2:3], v20 offset:512
    ds_read_b64_tr_b16 a[4:5], v21 offset:0
    ds_read_b64_tr_b16 a[6:7], v21 offset:512
    ds_read_b64_tr_b16 a[8:9], v22 offset:0
    ds_read_b64_tr_b16 a[10:11], v22 offset:512
    ds_read_b64_tr_b16 a[12:13], v23 offset:0
    ds_read_b64_tr_b16 a[14:15], v23 offset:512
    v_and_b32 v29, 0xffff0000, v108
    v_lshlrev_b32 v30, 16, v109
    v_and_b32 v31, 0xffff0000, v109
    v_lshlrev_b32 v32, 16, v110
    v_and_b32 v33, 0xffff0000, v110
    v_lshlrev_b32 v34, 16, v111
    v_and_b32 v35, 0xffff0000, v111
    v_lshlrev_b32 v36, 16, v112
    v_and_b32 v37, 0xffff0000, v112
    v_lshlrev_b32 v38, 16, v113
    v_and_b32 v39, 0xffff0000, v113
    v_lshlrev_b32 v40, 16, v114
    v_and_b32 v41, 0xffff0000, v114
    v_lshlrev_b32 v42, 16, v115
    ds_read_b64_tr_b16 a[16:17], v20 offset:4096
    ds_read_b64_tr_b16 a[18:19], v20 offset:4608
    ds_read_b64_tr_b16 a[20:21], v21 offset:4096
    ds_read_b64_tr_b16 a[22:23], v21 offset:4608
    ds_read_b64_tr_b16 a[24:25], v22 offset:4096
    ds_read_b64_tr_b16 a[26:27], v22 offset:4608
    ds_read_b64_tr_b16 a[28:29], v23 offset:4096
    ds_read_b64_tr_b16 a[30:31], v23 offset:4608
    v_and_b32 v43, 0xffff0000, v115
    v_mul_f32 v4, v120, v121
    v_mul_f32 v5, 0xbfb8aa3b, v121
    v_mul_f32 v6, 0xbfb8aa3b, v4
    v_fma_f32 v44, v28, v5, v6
    v_fma_f32 v45, v29, v5, v6
    v_fma_f32 v46, v30, v5, v6
    v_fma_f32 v47, v31, v5, v6
    v_fma_f32 v48, v32, v5, v6
    v_fma_f32 v49, v33, v5, v6
    v_fma_f32 v50, v34, v5, v6
    v_fma_f32 v51, v35, v5, v6
    v_fma_f32 v52, v36, v5, v6
    v_fma_f32 v53, v37, v5, v6
    ds_read_b64_tr_b16 a[32:33], v20 offset:8192
    ds_read_b64_tr_b16 a[34:35], v20 offset:8704
    ds_read_b64_tr_b16 a[36:37], v21 offset:8192
    ds_read_b64_tr_b16 a[38:39], v21 offset:8704
    ds_read_b64_tr_b16 a[40:41], v22 offset:8192
    ds_read_b64_tr_b16 a[42:43], v22 offset:8704
    ds_read_b64_tr_b16 a[44:45], v23 offset:8192
    ds_read_b64_tr_b16 a[46:47], v23 offset:8704
    v_fma_f32 v54, v38, v5, v6
    v_fma_f32 v55, v39, v5, v6
    v_fma_f32 v56, v40, v5, v6
    v_fma_f32 v57, v41, v5, v6
    v_fma_f32 v58, v42, v5, v6
    v_fma_f32 v59, v43, v5, v6
    v_exp_f32 v44, v44
    v_exp_f32 v45, v45
    v_exp_f32 v46, v46
    v_exp_f32 v47, v47
    v_exp_f32 v48, v48
    v_exp_f32 v49, v49
    v_exp_f32 v50, v50
    v_exp_f32 v51, v51
    v_exp_f32 v52, v52
    ds_read_b64_tr_b16 a[48:49], v20 offset:12288
    ds_read_b64_tr_b16 a[50:51], v20 offset:12800
    ds_read_b64_tr_b16 a[52:53], v21 offset:12288
    ds_read_b64_tr_b16 a[54:55], v21 offset:12800
    ds_read_b64_tr_b16 a[56:57], v22 offset:12288
    ds_read_b64_tr_b16 a[58:59], v22 offset:12800
    ds_read_b64_tr_b16 a[60:61], v23 offset:12288
    ds_read_b64_tr_b16 a[62:63], v23 offset:12800
    v_exp_f32 v53, v53
    v_exp_f32 v54, v54
    v_exp_f32 v55, v55
    v_exp_f32 v56, v56
    v_exp_f32 v57, v57
    v_exp_f32 v58, v58
    v_exp_f32 v59, v59
    v_fma_f32 v92, v28, v121, v4
    v_fma_f32 v93, v29, v121, v4
    v_fma_f32 v94, v30, v121, v4
    v_fma_f32 v95, v31, v121, v4
    v_fma_f32 v96, v32, v121, v4
    v_fma_f32 v97, v33, v121, v4
    v_fma_f32 v98, v34, v121, v4
    ds_read_b64_tr_b16 a[64:65], v20 offset:24576
    ds_read_b64_tr_b16 a[66:67], v20 offset:25088
    ds_read_b64_tr_b16 a[68:69], v21 offset:24576
    ds_read_b64_tr_b16 a[70:71], v21 offset:25088
    ds_read_b64_tr_b16 a[72:73], v22 offset:24576
    ds_read_b64_tr_b16 a[74:75], v22 offset:25088
    ds_read_b64_tr_b16 a[76:77], v23 offset:24576
    ds_read_b64_tr_b16 a[78:79], v23 offset:25088
    v_fma_f32 v99, v35, v121, v4
    v_fma_f32 v100, v36, v121, v4
    v_fma_f32 v101, v37, v121, v4
    v_fma_f32 v102, v38, v121, v4
    v_fma_f32 v103, v39, v121, v4
    v_fma_f32 v104, v40, v121, v4
    v_fma_f32 v105, v41, v121, v4
    v_fma_f32 v106, v42, v121, v4
    v_fma_f32 v107, v43, v121, v4
    v_add_f32 v44, 1.0, v44
    v_add_f32 v45, 1.0, v45
    v_add_f32 v46, 1.0, v46
    v_add_f32 v47, 1.0, v47
    v_add_f32 v48, 1.0, v48
    ds_read_b64_tr_b16 a[80:81], v20 offset:28672
    ds_read_b64_tr_b16 a[82:83], v20 offset:29184
    ds_read_b64_tr_b16 a[84:85], v21 offset:28672
    ds_read_b64_tr_b16 a[86:87], v21 offset:29184
    ds_read_b64_tr_b16 a[88:89], v22 offset:28672
    ds_read_b64_tr_b16 a[90:91], v22 offset:29184
    ds_read_b64_tr_b16 a[92:93], v23 offset:28672
    ds_read_b64_tr_b16 a[94:95], v23 offset:29184
    v_add_f32 v49, 1.0, v49
    v_add_f32 v50, 1.0, v50
    v_add_f32 v51, 1.0, v51
    v_add_f32 v52, 1.0, v52
    v_add_f32 v53, 1.0, v53
    v_add_f32 v54, 1.0, v54
    v_add_f32 v55, 1.0, v55
    v_add_f32 v56, 1.0, v56
    v_add_f32 v57, 1.0, v57
    v_add_f32 v58, 1.0, v58
    v_add_f32 v59, 1.0, v59
    v_rcp_f32 v44, v44
    v_rcp_f32 v45, v45
    v_rcp_f32 v46, v46
    v_rcp_f32 v47, v47
    ds_read_b64_tr_b16 a[96:97], v24 offset:59520
    ds_read_b64_tr_b16 a[98:99], v24 offset:60032
    ds_read_b64_tr_b16 a[100:101], v25 offset:59520
    ds_read_b64_tr_b16 a[102:103], v25 offset:60032
    ds_read_b64_tr_b16 a[104:105], v26 offset:59520
    ds_read_b64_tr_b16 a[106:107], v26 offset:60032
    ds_read_b64_tr_b16 a[108:109], v27 offset:59520
    ds_read_b64_tr_b16 a[110:111], v27 offset:60032
    v_rcp_f32 v48, v48
    v_rcp_f32 v49, v49
    v_rcp_f32 v50, v50
    v_rcp_f32 v51, v51
    v_rcp_f32 v52, v52
    v_rcp_f32 v53, v53
    v_rcp_f32 v54, v54
    v_rcp_f32 v55, v55
    v_rcp_f32 v56, v56
    v_rcp_f32 v57, v57
    v_rcp_f32 v58, v58
    v_rcp_f32 v59, v59
    v_mul_f32 v44, v44, v92
    v_mul_f32 v45, v45, v93
    ds_read_b64_tr_b16 a[112:113], v24 offset:63616
    ds_read_b64_tr_b16 a[114:115], v24 offset:64128
    ds_read_b64_tr_b16 a[116:117], v25 offset:63616
    ds_read_b64_tr_b16 a[118:119], v25 offset:64128
    ds_read_b64_tr_b16 a[120:121], v26 offset:63616
    ds_read_b64_tr_b16 a[122:123], v26 offset:64128
    ds_read_b64_tr_b16 a[124:125], v27 offset:63616
    ds_read_b64_tr_b16 a[126:127], v27 offset:64128
    v_mul_f32 v46, v46, v94
    v_mul_f32 v47, v47, v95
    v_mul_f32 v48, v48, v96
    v_mul_f32 v49, v49, v97
    v_mul_f32 v50, v50, v98
    v_mul_f32 v51, v51, v99
    v_mul_f32 v52, v52, v100
    v_mul_f32 v53, v53, v101
    v_mul_f32 v54, v54, v102
    v_mul_f32 v55, v55, v103
    v_mul_f32 v56, v56, v104
    v_mul_f32 v57, v57, v105
    v_mul_f32 v58, v58, v106
    v_mul_f32 v59, v59, v107
    buffer_load_dwordx4 v[60:63], v13, s[28:31], s51 offen offset:0 sc1
    buffer_load_dwordx4 v[64:67], v13, s[28:31], s51 offen offset:1024 sc1
    buffer_load_dwordx4 v[68:71], v13, s[28:31], s51 offen offset:2048 sc1
    buffer_load_dwordx4 v[72:75], v13, s[28:31], s51 offen offset:3072 sc1
    buffer_load_dwordx4 v[76:79], v13, s[28:31], s52 offen offset:0 sc1
    buffer_load_dwordx4 v[80:83], v13, s[28:31], s52 offen offset:1024 sc1
    buffer_load_dwordx4 v[84:87], v13, s[28:31], s52 offen offset:2048 sc1
    buffer_load_dwordx4 v[88:91], v13, s[28:31], s52 offen offset:3072 sc1
    s_setprio 0
Lwo_go:
    s_setprio 3
    buffer_load_dwordx4 v[92:95], v13, s[28:31], s53 offen offset:0 sc1
    buffer_load_dwordx4 v[96:99], v13, s[28:31], s53 offen offset:1024 sc1
    ds_read_b64 v[8:9], v10
    s_waitcnt vmcnt(8) lgkmcnt(15)
    v_mfma_f32_16x16x32_bf16 v[108:111], a[0:3], v[60:63], 0
    ds_read_b64_tr_b16 a[0:1], v24 offset:16384
    ds_read_b64_tr_b16 a[2:3], v24 offset:16896
    buffer_load_dwordx4 v[100:103], v13, s[28:31], s53 offen offset:2048 sc1
    v_mfma_f32_16x16x32_bf16 v[112:115], a[4:7], v[60:63], 0
    ds_read_b64_tr_b16 a[4:5], v25 offset:16384
    ds_read_b64_tr_b16 a[6:7], v25 offset:16896
    v_mfma_f32_16x16x32_bf16 v[116:119], a[8:11], v[60:63], 0
    ds_read_b64_tr_b16 a[8:9], v26 offset:16384
    ds_read_b64_tr_b16 a[10:11], v26 offset:16896
    v_mfma_f32_16x16x32_bf16 v[14:17], a[12:15], v[60:63], 0
    ds_read_b64_tr_b16 a[12:13], v27 offset:16384
    ds_read_b64_tr_b16 a[14:15], v27 offset:16896
    v_mfma_f32_16x16x32_bf16 v[108:111], a[16:19], v[64:67], v[108:111]
    ds_read_b64_tr_b16 a[16:17], v24 offset:20480
    ds_read_b64_tr_b16 a[18:19], v24 offset:20992
    buffer_load_dwordx4 v[104:107], v13, s[28:31], s53 offen offset:3072 sc1
    v_mfma_f32_16x16x32_bf16 v[112:115], a[20:23], v[64:67], v[112:115]
    ds_read_b64_tr_b16 a[20:21], v25 offset:20480
    ds_read_b64_tr_b16 a[22:23], v25 offset:20992
    v_mfma_f32_16x16x32_bf16 v[116:119], a[24:27], v[64:67], v[116:119]
    ds_read_b64_tr_b16 a[24:25], v26 offset:20480
    ds_read_b64_tr_b16 a[26:27], v26 offset:20992
    v_mfma_f32_16x16x32_bf16 v[14:17], a[28:31], v[64:67], v[14:17]
    ds_read_b64_tr_b16 a[28:29], v27 offset:20480
    ds_read_b64_tr_b16 a[30:31], v27 offset:20992
    s_waitcnt lgkmcnt(15)
Linfo:
    v_readfirstlane_b32 s39, v8
    s_nop 0
    s_cmp_eq_u32 s39, -2
    s_cbranch_scc1 Linfo_re
    v_cmp_class_f32_e64 vcc, v108, s61
    s_nop 0
    s_cbranch_vccnz Lnan
    s_waitcnt vmcnt(8)
    v_mfma_f32_16x16x32_bf16 v[108:111], a[32:35], v[68:71], v[108:111]
    ds_read_b64_tr_b16 a[32:33], v20 offset:32768
    ds_read_b64_tr_b16 a[34:35], v20 offset:33280
    buffer_load_dwordx4 v[60:63], v13, s[28:31], s54 offen offset:0 sc1
    v_mfma_f32_16x16x32_bf16 v[112:115], a[36:39], v[68:71], v[112:115]
    ds_read_b64_tr_b16 a[36:37], v21 offset:32768
    ds_read_b64_tr_b16 a[38:39], v21 offset:33280
    v_mfma_f32_16x16x32_bf16 v[116:119], a[40:43], v[68:71], v[116:119]
    ds_read_b64_tr_b16 a[40:41], v22 offset:32768
    ds_read_b64_tr_b16 a[42:43], v22 offset:33280
    v_mfma_f32_16x16x32_bf16 v[14:17], a[44:47], v[68:71], v[14:17]
    ds_read_b64_tr_b16 a[44:45], v23 offset:32768
    ds_read_b64_tr_b16 a[46:47], v23 offset:33280
    v_mfma_f32_16x16x32_bf16 v[108:111], a[48:51], v[72:75], v[108:111]
    ds_read_b64_tr_b16 a[48:49], v20 offset:36864
    ds_read_b64_tr_b16 a[50:51], v20 offset:37376
    buffer_load_dwordx4 v[64:67], v13, s[28:31], s54 offen offset:1024 sc1
    v_mfma_f32_16x16x32_bf16 v[112:115], a[52:55], v[72:75], v[112:115]
    ds_read_b64_tr_b16 a[52:53], v21 offset:36864
    ds_read_b64_tr_b16 a[54:55], v21 offset:37376
    v_mfma_f32_16x16x32_bf16 v[116:119], a[56:59], v[72:75], v[116:119]
    ds_read_b64_tr_b16 a[56:57], v22 offset:36864
    ds_read_b64_tr_b16 a[58:59], v22 offset:37376
    v_mfma_f32_16x16x32_bf16 v[14:17], a[60:63], v[72:75], v[14:17]
    ds_read_b64_tr_b16 a[60:61], v23 offset:36864
    ds_read_b64_tr_b16 a[62:63], v23 offset:37376
    v_cmp_class_f32_e64 vcc, v108, s61
    s_nop 0
    s_cbranch_vccnz Lnan
    s_waitcnt vmcnt(8)
    v_mfma_f32_16x16x32_bf16 v[108:111], a[64:67], v[76:79], v[108:111]
    ds_read_b64_tr_b16 a[64:65], v20 offset:40960
    ds_read_b64_tr_b16 a[66:67], v20 offset:41472
    buffer_load_dwordx4 v[68:71], v13, s[28:31], s54 offen offset:2048 sc1
    v_mfma_f32_16x16x32_bf16 v[112:115], a[68:71], v[76:79], v[112:115]
    ds_read_b64_tr_b16 a[68:69], v21 offset:40960
    ds_read_b64_tr_b16 a[70:71], v21 offset:41472
    v_mfma_f32_16x16x32_bf16 v[116:119], a[72:75], v[76:79], v[116:119]
    ds_read_b64_tr_b16 a[72:73], v22 offset:40960
    ds_read_b64_tr_b16 a[74:75], v22 offset:41472
    v_mfma_f32_16x16x32_bf16 v[14:17], a[76:79], v[76:79], v[14:17]
    ds_read_b64_tr_b16 a[76:77], v23 offset:40960
    ds_read_b64_tr_b16 a[78:79], v23 offset:41472
    v_mfma_f32_16x16x32_bf16 v[108:111], a[80:83], v[80:83], v[108:111]
    ds_read_b64_tr_b16 a[80:81], v20 offset:45056
    ds_read_b64_tr_b16 a[82:83], v20 offset:45568
    buffer_load_dwordx4 v[72:75], v13, s[28:31], s54 offen offset:3072 sc1
    v_mfma_f32_16x16x32_bf16 v[112:115], a[84:87], v[80:83], v[112:115]
    ds_read_b64_tr_b16 a[84:85], v21 offset:45056
    ds_read_b64_tr_b16 a[86:87], v21 offset:45568
    v_mfma_f32_16x16x32_bf16 v[116:119], a[88:91], v[80:83], v[116:119]
    ds_read_b64_tr_b16 a[88:89], v22 offset:45056
    ds_read_b64_tr_b16 a[90:91], v22 offset:45568
    v_mfma_f32_16x16x32_bf16 v[14:17], a[92:95], v[80:83], v[14:17]
    ds_read_b64_tr_b16 a[92:93], v23 offset:45056
    ds_read_b64_tr_b16 a[94:95], v23 offset:45568
    s_setprio 2
    v_cmp_class_f32_e64 vcc, v108, s61
    s_nop 0
    s_cbranch_vccnz Lnan
    s_waitcnt vmcnt(8)
    v_mfma_f32_16x16x32_bf16 v[108:111], a[96:99], v[84:87], v[108:111]
    ds_read_b64_tr_b16 a[96:97], v24 offset:0
    ds_read_b64_tr_b16 a[98:99], v24 offset:512
    buffer_load_dwordx4 v[76:79], v13, s[28:31], s55 offen offset:0 sc1
    v_mfma_f32_16x16x32_bf16 v[112:115], a[100:103], v[84:87], v[112:115]
    ds_read_b64_tr_b16 a[100:101], v25 offset:0
    ds_read_b64_tr_b16 a[102:103], v25 offset:512
    v_mfma_f32_16x16x32_bf16 v[116:119], a[104:107], v[84:87], v[116:119]
    ds_read_b64_tr_b16 a[104:105], v26 offset:0
    ds_read_b64_tr_b16 a[106:107], v26 offset:512
    v_mfma_f32_16x16x32_bf16 v[14:17], a[108:111], v[84:87], v[14:17]
    ds_read_b64_tr_b16 a[108:109], v27 offset:0
    ds_read_b64_tr_b16 a[110:111], v27 offset:512
    v_mfma_f32_16x16x32_bf16 v[108:111], a[112:115], v[88:91], v[108:111]
    ds_read_b64_tr_b16 a[112:113], v24 offset:4096
    ds_read_b64_tr_b16 a[114:115], v24 offset:4608
    buffer_load_dwordx4 v[80:83], v13, s[28:31], s55 offen offset:1024 sc1
    v_mfma_f32_16x16x32_bf16 v[112:115], a[116:119], v[88:91], v[112:115]
    ds_read_b64_tr_b16 a[116:117], v25 offset:4096
    ds_read_b64_tr_b16 a[118:119], v25 offset:4608
    v_mfma_f32_16x16x32_bf16 v[116:119], a[120:123], v[88:91], v[116:119]
    ds_read_b64_tr_b16 a[120:121], v26 offset:4096
    ds_read_b64_tr_b16 a[122:123], v26 offset:4608
    v_mfma_f32_16x16x32_bf16 v[14:17], a[124:127], v[88:91], v[14:17]
    ds_read_b64_tr_b16 a[124:125], v27 offset:4096
    ds_read_b64_tr_b16 a[126:127], v27 offset:4608
    v_cmp_class_f32_e64 vcc, v108, s61
    s_nop 0
    s_cbranch_vccnz Lnan
    s_waitcnt vmcnt(8) lgkmcnt(15)
    v_mfma_f32_16x16x32_bf16 v[108:111], a[0:3], v[92:95], v[108:111]
    ds_read_b64_tr_b16 a[0:1], v24 offset:8192
    ds_read_b64_tr_b16 a[2:3], v24 offset:8704
    buffer_load_dwordx4 v[84:87], v13, s[28:31], s55 offen offset:2048 sc1
    v_mfma_f32_16x16x32_bf16 v[112:115], a[4:7], v[92:95], v[112:115]
    ds_read_b64_tr_b16 a[4:5], v25 offset:8192
    ds_read_b64_tr_b16 a[6:7], v25 offset:8704
    v_mfma_f32_16x16x32_bf16 v[116:119], a[8:11], v[92:95], v[116:119]
    ds_read_b64_tr_b16 a[8:9], v26 offset:8192
    ds_read_b64_tr_b16 a[10:11], v26 offset:8704
    v_mfma_f32_16x16x32_bf16 v[14:17], a[12:15], v[92:95], v[14:17]
    ds_read_b64_tr_b16 a[12:13], v27 offset:8192
    ds_read_b64_tr_b16 a[14:15], v27 offset:8704
    v_mfma_f32_16x16x32_bf16 v[108:111], a[16:19], v[96:99], v[108:111]
    ds_read_b64_tr_b16 a[16:17], v24 offset:12288
    ds_read_b64_tr_b16 a[18:19], v24 offset:12800
    buffer_load_dwordx4 v[88:91], v13, s[28:31], s55 offen offset:3072 sc1
    v_mfma_f32_16x16x32_bf16 v[112:115], a[20:23], v[96:99], v[112:115]
    ds_read_b64_tr_b16 a[20:21], v25 offset:12288
    ds_read_b64_tr_b16 a[22:23], v25 offset:12800
    v_mfma_f32_16x16x32_bf16 v[116:119], a[24:27], v[96:99], v[116:119]
    ds_read_b64_tr_b16 a[24:25], v26 offset:12288
    ds_read_b64_tr_b16 a[26:27], v26 offset:12800
    v_mfma_f32_16x16x32_bf16 v[14:17], a[28:31], v[96:99], v[14:17]
    ds_read_b64_tr_b16 a[28:29], v27 offset:12288
    ds_read_b64_tr_b16 a[30:31], v27 offset:12800
    v_cmp_class_f32_e64 vcc, v108, s61
    s_nop 0
    s_cbranch_vccnz Lnan
    s_waitcnt vmcnt(8)
    v_mfma_f32_16x16x32_bf16 v[108:111], a[32:35], v[100:103], v[108:111]
    ds_read_b64_tr_b16 a[32:33], v20 offset:49152
    ds_read_b64_tr_b16 a[34:35], v20 offset:49664
    v_mfma_f32_16x16x32_bf16 v[112:115], a[36:39], v[100:103], v[112:115]
    ds_read_b64_tr_b16 a[36:37], v21 offset:49152
    ds_read_b64_tr_b16 a[38:39], v21 offset:49664
    v_mfma_f32_16x16x32_bf16 v[116:119], a[40:43], v[100:103], v[116:119]
    ds_read_b64_tr_b16 a[40:41], v22 offset:49152
    ds_read_b64_tr_b16 a[42:43], v22 offset:49664
    v_mfma_f32_16x16x32_bf16 v[14:17], a[44:47], v[100:103], v[14:17]
    ds_read_b64_tr_b16 a[44:45], v23 offset:49152
    ds_read_b64_tr_b16 a[46:47], v23 offset:49664
    v_mfma_f32_16x16x32_bf16 v[108:111], a[48:51], v[104:107], v[108:111]
    ds_read_b64_tr_b16 a[48:49], v24 offset:24576
    ds_read_b64_tr_b16 a[50:51], v24 offset:25088
    v_mfma_f32_16x16x32_bf16 v[112:115], a[52:55], v[104:107], v[112:115]
    ds_read_b64_tr_b16 a[52:53], v25 offset:24576
    ds_read_b64_tr_b16 a[54:55], v25 offset:25088
    v_mfma_f32_16x16x32_bf16 v[116:119], a[56:59], v[104:107], v[116:119]
    ds_read_b64_tr_b16 a[56:57], v26 offset:24576
    ds_read_b64_tr_b16 a[58:59], v26 offset:25088
    v_mfma_f32_16x16x32_bf16 v[14:17], a[60:63], v[104:107], v[14:17]
    ds_read_b64_tr_b16 a[60:61], v27 offset:24576
    ds_read_b64_tr_b16 a[62:63], v27 offset:25088
    s_setprio 1
    v_cmp_class_f32_e64 vcc, v108, s61
    s_nop 0
    s_cbranch_vccnz Lnan
    s_waitcnt vmcnt(6)
    v_mfma_f32_16x16x32_bf16 v[108:111], a[64:67], v[60:63], v[108:111]
    v_mfma_f32_16x16x32_bf16 v[112:115], a[68:71], v[60:63], v[112:115]
    v_mfma_f32_16x16x32_bf16 v[116:119], a[72:75], v[60:63], v[116:119]
    v_mfma_f32_16x16x32_bf16 v[14:17], a[76:79], v[60:63], v[14:17]
    v_mfma_f32_16x16x32_bf16 v[108:111], a[80:83], v[64:67], v[108:111]
    v_mfma_f32_16x16x32_bf16 v[112:115], a[84:87], v[64:67], v[112:115]
    v_mfma_f32_16x16x32_bf16 v[116:119], a[88:91], v[64:67], v[116:119]
    v_mfma_f32_16x16x32_bf16 v[14:17], a[92:95], v[64:67], v[14:17]
    s_waitcnt vmcnt(4) lgkmcnt(15)
    v_mfma_f32_16x16x32_bf16 v[108:111], a[96:99], v[68:71], v[108:111]
    v_mfma_f32_16x16x32_bf16 v[112:115], a[100:103], v[68:71], v[112:115]
    v_mfma_f32_16x16x32_bf16 v[116:119], a[104:107], v[68:71], v[116:119]
    v_mfma_f32_16x16x32_bf16 v[14:17], a[108:111], v[68:71], v[14:17]
    v_mfma_f32_16x16x32_bf16 v[108:111], a[112:115], v[72:75], v[108:111]
    v_mfma_f32_16x16x32_bf16 v[112:115], a[116:119], v[72:75], v[112:115]
    v_mfma_f32_16x16x32_bf16 v[116:119], a[120:123], v[72:75], v[116:119]
    v_mfma_f32_16x16x32_bf16 v[14:17], a[124:127], v[72:75], v[14:17]
    s_setprio 0
    s_waitcnt vmcnt(2)
    v_mfma_f32_16x16x32_bf16 v[108:111], a[0:3], v[76:79], v[108:111]
    v_mfma_f32_16x16x32_bf16 v[112:115], a[4:7], v[76:79], v[112:115]
    v_mfma_f32_16x16x32_bf16 v[116:119], a[8:11], v[76:79], v[116:119]
    v_mfma_f32_16x16x32_bf16 v[14:17], a[12:15], v[76:79], v[14:17]
    v_mfma_f32_16x16x32_bf16 v[108:111], a[16:19], v[80:83], v[108:111]
    v_mfma_f32_16x16x32_bf16 v[112:115], a[20:23], v[80:83], v[112:115]
    v_mfma_f32_16x16x32_bf16 v[116:119], a[24:27], v[80:83], v[116:119]
    v_mfma_f32_16x16x32_bf16 v[14:17], a[28:31], v[80:83], v[14:17]
    s_waitcnt vmcnt(0) lgkmcnt(8)
    v_mfma_f32_16x16x32_bf16 v[108:111], a[32:35], v[84:87], v[108:111]
    v_mfma_f32_16x16x32_bf16 v[112:115], a[36:39], v[84:87], v[112:115]
    v_mfma_f32_16x16x32_bf16 v[116:119], a[40:43], v[84:87], v[116:119]
    v_mfma_f32_16x16x32_bf16 v[14:17], a[44:47], v[84:87], v[14:17]
    s_waitcnt lgkmcnt(0)
    v_mfma_f32_16x16x32_bf16 v[108:111], a[48:51], v[88:91], v[108:111]
    v_mfma_f32_16x16x32_bf16 v[112:115], a[52:55], v[88:91], v[112:115]
    v_mfma_f32_16x16x32_bf16 v[116:119], a[56:59], v[88:91], v[116:119]
    v_mfma_f32_16x16x32_bf16 v[14:17], a[60:63], v[88:91], v[14:17]
    v_xor_b32 v60, 32, v124
    v_xor_b32 v61, 64, v124
    v_xor_b32 v62, 96, v124
    v_and_b32 v6, v8, v9
    s_nop 0
    v_readfirstlane_b32 s39, v6
    v_cmp_class_f32_e64 vcc, v108, s61
    s_nop 0
    s_cbranch_vccnz Lnan
    s_cmp_eq_u32 s39, -1
    s_cbranch_scc0 Lfix
Lnofix:
    v_fma_f32 v108, v108, v44, v28
    v_fma_f32 v109, v109, v45, v29
    v_fma_f32 v110, v110, v46, v30
    v_fma_f32 v111, v111, v47, v31
    v_cvt_pk_bf16_f32 v68, v108, v109
    v_cvt_pk_bf16_f32 v69, v110, v111
    ds_write_b64 v124, v[68:69]
    v_fma_f32 v112, v112, v48, v32
    v_fma_f32 v113, v113, v49, v33
    v_fma_f32 v114, v114, v50, v34
    v_fma_f32 v115, v115, v51, v35
    v_cvt_pk_bf16_f32 v70, v112, v113
    v_cvt_pk_bf16_f32 v71, v114, v115
    ds_write_b64 v60, v[70:71]
    v_fma_f32 v116, v116, v52, v36
    v_fma_f32 v117, v117, v53, v37
    v_fma_f32 v118, v118, v54, v38
    v_fma_f32 v119, v119, v55, v39
    v_cvt_pk_bf16_f32 v72, v116, v117
    v_cvt_pk_bf16_f32 v73, v118, v119
    ds_write_b64 v61, v[72:73]
    v_fma_f32 v14, v14, v56, v40
    v_fma_f32 v15, v15, v57, v41
    v_fma_f32 v16, v16, v58, v42
    v_fma_f32 v17, v17, v59, v43
    v_cvt_pk_bf16_f32 v74, v14, v15
    v_cvt_pk_bf16_f32 v75, v16, v17
    ds_write_b64 v62, v[74:75]
    ds_read_b128 v[76:79], v125 offset:0
    ds_read_b128 v[80:83], v125 offset:1024
    s_waitcnt lgkmcnt(1)
    buffer_store_dwordx4 v[76:79], v122, s[44:47], s24 offen
    s_waitcnt lgkmcnt(0)
    buffer_store_dwordx4 v[80:83], v123, s[44:47], s24 offen
    s_endpgm
Lqf_re:
    s_sub_u32 s35, s35, 1
    s_cbranch_scc1 Lend
    ds_read_b32 v7, v96
    ds_read_b128 v[76:79], v95 offset:0
    ds_read_b128 v[80:83], v95 offset:64
    ds_read_b128 v[84:87], v95 offset:128
    ds_read_b128 v[88:91], v95 offset:192
    s_waitcnt lgkmcnt(0)
    s_branch Lqf
Lcsv_re:
    s_sub_u32 s35, s35, 1
    s_cbranch_scc1 Lend
    ds_read_b32 v46, v49
    ds_read_b64 v[44:45], v48
    s_waitcnt lgkmcnt(0)
    s_branch Lcsv
Lrx_re:
    s_sub_u32 s35, s35, 1
    s_cbranch_scc1 Lend
    buffer_load_dwordx2 v[52:53], v13, s[28:31], s57 offen offset:8 sc1
    buffer_load_dwordx2 v[54:55], v13, s[28:31], s58 offen offset:0 sc1
    s_waitcnt vmcnt(0)
    s_branch Lrx_chk
Linfo_re:
    s_sub_u32 s35, s35, 1
    s_cbranch_scc1 Lend
    ds_read_b64 v[8:9], v10
    s_waitcnt lgkmcnt(0)
    s_branch Linfo
Lfl_re:
    s_sub_u32 s35, s35, 1
    s_cbranch_scc1 Lend
    buffer_load_dword v20, v12, s[28:31], s24 offen sc1
    s_waitcnt vmcnt(0)
    s_branch Lfl_chk
Lxe0:
    ds_read_b64 v[108:109], v4
    ds_read_b64 v[110:111], v5
    ds_read_b64 v[112:113], v6
    ds_read_b64 v[114:115], v7
    s_branch Lxe0_b
Lxe1:
    ds_read_b64 v[108:109], v4
    ds_read_b64 v[110:111], v5
    ds_read_b64 v[112:113], v6
    ds_read_b64 v[114:115], v7
    s_branch Lxe1_b
Lxe2:
    ds_read_b64 v[108:109], v4
    ds_read_b64 v[110:111], v5
    ds_read_b64 v[112:113], v6
    ds_read_b64 v[114:115], v7
    s_branch Lxe2_b
Lxe3:
    ds_read_b64 v[108:109], v4
    ds_read_b64 v[110:111], v5
    ds_read_b64 v[112:113], v6
    ds_read_b64 v[114:115], v7
    s_branch Lxe3_b
Lxe4:
    ds_read_b64 v[108:109], v4
    ds_read_b64 v[110:111], v5
    ds_read_b64 v[112:113], v6
    ds_read_b64 v[114:115], v7
    s_branch Lxe4_b
Lxe5:
    ds_read_b64 v[108:109], v4
    ds_read_b64 v[110:111], v5
    ds_read_b64 v[112:113], v6
    ds_read_b64 v[114:115], v7
    s_branch Lxe5_b
Lxe6:
    ds_read_b64 v[108:109], v4
    ds_read_b64 v[110:111], v5
    ds_read_b64 v[112:113], v6
    ds_read_b64 v[114:115], v7
    s_branch Lxe6_b
Lxe7:
    ds_read_b64 v[108:109], v4
    ds_read_b64 v[110:111], v5
    ds_read_b64 v[112:113], v6
    ds_read_b64 v[114:115], v7
    s_branch Lxe7_b
Lxe8:
    ds_read_b64 v[108:109], v4
    ds_read_b64 v[110:111], v5
    ds_read_b64 v[112:113], v6
    ds_read_b64 v[114:115], v7
    s_branch Lxe8_b
Lxe9:
    ds_read_b64 v[108:109], v4
    ds_read_b64 v[110:111], v5
    ds_read_b64 v[112:113], v6
    ds_read_b64 v[114:115], v7
    s_branch Lxe9_b
Lnan:
    s_add_u32 s41, s41, 1
    s_cmp_eq_u32 s41, 2
    s_cbranch_scc1 Lval0
    v_min_u32 v18, 19, v1
    v_lshlrev_b32 v18, 10, v18
Lprobe:
    s_sub_u32 s35, s35, 1
    s_cbranch_scc1 Lend
    buffer_load_dword v19, v18, s[28:31], s50 offen offset:1020 sc1
    s_waitcnt vmcnt(0)
    v_cmp_eq_u32 vcc, -1, v19
    s_nop 0
    s_cbranch_vccnz Lprobe
    s_branch Lredo
Lval0:
    s_mov_b32 s61, 0
    s_mov_b32 s36, s50
    s_add_u32 s37, s50, 20480
    s_waitcnt vmcnt(0)
Lval:
    s_sub_u32 s35, s35, 1
    s_cbranch_scc1 Lend
    buffer_load_dwordx4 v[60:63], v13, s[28:31], s36 offen sc1
    s_waitcnt vmcnt(0)
    v_max3_u32 v60, v60, v61, v62
    v_max_u32 v60, v60, v63
    v_cmp_eq_u32 vcc, -1, v60
    s_nop 0
    s_cbranch_vccnz Lval
    s_add_u32 s36, s36, 1024
    s_cmp_lt_u32 s36, s37
    s_cbranch_scc1 Lval
Lredo:
    buffer_load_dwordx4 v[60:63], v13, s[28:31], s51 offen offset:0 sc1
    buffer_load_dwordx4 v[64:67], v13, s[28:31], s51 offen offset:1024 sc1
    buffer_load_dwordx4 v[68:71], v13, s[28:31], s51 offen offset:2048 sc1
    buffer_load_dwordx4 v[72:75], v13, s[28:31], s51 offen offset:3072 sc1
    buffer_load_dwordx4 v[76:79], v13, s[28:31], s52 offen offset:0 sc1
    buffer_load_dwordx4 v[80:83], v13, s[28:31], s52 offen offset:1024 sc1
    buffer_load_dwordx4 v[84:87], v13, s[28:31], s52 offen offset:2048 sc1
    buffer_load_dwordx4 v[88:91], v13, s[28:31], s52 offen offset:3072 sc1
    ds_read_b64_tr_b16 a[0:1], v20 offset:0
    ds_read_b64_tr_b16 a[2:3], v20 offset:512
    ds_read_b64_tr_b16 a[4:5], v21 offset:0
    ds_read_b64_tr_b16 a[6:7], v21 offset:512
    ds_read_b64_tr_b16 a[8:9], v22 offset:0
    ds_read_b64_tr_b16 a[10:11], v22 offset:512
    ds_read_b64_tr_b16 a[12:13], v23 offset:0
    ds_read_b64_tr_b16 a[14:15], v23 offset:512
    ds_read_b64_tr_b16 a[16:17], v20 offset:4096
    ds_read_b64_tr_b16 a[18:19], v20 offset:4608
    ds_read_b64_tr_b16 a[20:21], v21 offset:4096
    ds_read_b64_tr_b16 a[22:23], v21 offset:4608
    ds_read_b64_tr_b16 a[24:25], v22 offset:4096
    ds_read_b64_tr_b16 a[26:27], v22 offset:4608
    ds_read_b64_tr_b16 a[28:29], v23 offset:4096
    ds_read_b64_tr_b16 a[30:31], v23 offset:4608
    ds_read_b64_tr_b16 a[32:33], v20 offset:8192
    ds_read_b64_tr_b16 a[34:35], v20 offset:8704
    ds_read_b64_tr_b16 a[36:37], v21 offset:8192
    ds_read_b64_tr_b16 a[38:39], v21 offset:8704
    ds_read_b64_tr_b16 a[40:41], v22 offset:8192
    ds_read_b64_tr_b16 a[42:43], v22 offset:8704
    ds_read_b64_tr_b16 a[44:45], v23 offset:8192
    ds_read_b64_tr_b16 a[46:47], v23 offset:8704
    ds_read_b64_tr_b16 a[48:49], v20 offset:12288
    ds_read_b64_tr_b16 a[50:51], v20 offset:12800
    ds_read_b64_tr_b16 a[52:53], v21 offset:12288
    ds_read_b64_tr_b16 a[54:55], v21 offset:12800
    ds_read_b64_tr_b16 a[56:57], v22 offset:12288
    ds_read_b64_tr_b16 a[58:59], v22 offset:12800
    ds_read_b64_tr_b16 a[60:61], v23 offset:12288
    ds_read_b64_tr_b16 a[62:63], v23 offset:12800
    ds_read_b64_tr_b16 a[64:65], v20 offset:24576
    ds_read_b64_tr_b16 a[66:67], v20 offset:25088
    ds_read_b64_tr_b16 a[68:69], v21 offset:24576
    ds_read_b64_tr_b16 a[70:71], v21 offset:25088
    ds_read_b64_tr_b16 a[72:73], v22 offset:24576
    ds_read_b64_tr_b16 a[74:75], v22 offset:25088
    ds_read_b64_tr_b16 a[76:77], v23 offset:24576
    ds_read_b64_tr_b16 a[78:79], v23 offset:25088
    ds_read_b64_tr_b16 a[80:81], v20 offset:28672
    ds_read_b64_tr_b16 a[82:83], v20 offset:29184
    ds_read_b64_tr_b16 a[84:85], v21 offset:28672
    ds_read_b64_tr_b16 a[86:87], v21 offset:29184
    ds_read_b64_tr_b16 a[88:89], v22 offset:28672
    ds_read_b64_tr_b16 a[90:91], v22 offset:29184
    ds_read_b64_tr_b16 a[92:93], v23 offset:28672
    ds_read_b64_tr_b16 a[94:95], v23 offset:29184
    ds_read_b64_tr_b16 a[96:97], v24 offset:59520
    ds_read_b64_tr_b16 a[98:99], v24 offset:60032
    ds_read_b64_tr_b16 a[100:101], v25 offset:59520
    ds_read_b64_tr_b16 a[102:103], v25 offset:60032
    ds_read_b64_tr_b16 a[104:105], v26 offset:59520
    ds_read_b64_tr_b16 a[106:107], v26 offset:60032
    ds_read_b64_tr_b16 a[108:109], v27 offset:59520
    ds_read_b64_tr_b16 a[110:111], v27 offset:60032
    ds_read_b64_tr_b16 a[112:113], v24 offset:63616
    ds_read_b64_tr_b16 a[114:115], v24 offset:64128
    ds_read_b64_tr_b16 a[116:117], v25 offset:63616
    ds_read_b64_tr_b16 a[118:119], v25 offset:64128
    ds_read_b64_tr_b16 a[120:121], v26 offset:63616
    ds_read_b64_tr_b16 a[122:123], v26 offset:64128
    ds_read_b64_tr_b16 a[124:125], v27 offset:63616
    ds_read_b64_tr_b16 a[126:127], v27 offset:64128
    s_waitcnt lgkmcnt(0)
    s_branch Lwo_go
Lfix:
    v_lshlrev_b32 v6, 4, v2
    v_add_u32 v6, 158208, v6
    v_mov_b32 v10, 157956
    v_mov_b32 v11, 1
    v_sub_u32 v4, v126, v3
    v_lshrrev_b32 v5, 3, v1
    v_add_u32 v4, v4, v5
    v_add_u32 v5, 8, v4
    v_mov_b32 v7, 0x40000000
    v_cmp_eq_u32 vcc, v8, v4
    s_nop 1
    v_cndmask_b32 v122, v122, v7, vcc
    v_cmp_eq_u32 vcc, v8, v5
    s_nop 1
    v_cndmask_b32 v123, v123, v7, vcc
    v_cmp_eq_u32 vcc, v8, v126
    s_nop 0
    s_mov_b64 exec, vcc
    ds_write_b128 v6, v[108:111] offset:0
    ds_write_b128 v6, v[112:115] offset:64
    ds_write_b128 v6, v[116:119] offset:128
    ds_write_b128 v6, v[14:17] offset:192
    ds_add_u32 v10, v11
    s_mov_b64 exec, -1
    v_cmp_eq_u32 vcc, v9, v4
    s_nop 1
    v_cndmask_b32 v122, v122, v7, vcc
    v_cmp_eq_u32 vcc, v9, v5
    s_nop 1
    v_cndmask_b32 v123, v123, v7, vcc
    v_cmp_eq_u32 vcc, v9, v126
    s_nop 0
    s_mov_b64 exec, vcc
    ds_write_b128 v6, v[108:111] offset:256
    ds_write_b128 v6, v[112:115] offset:320
    ds_write_b128 v6, v[116:119] offset:384
    ds_write_b128 v6, v[14:17] offset:448
    ds_add_u32 v10, v11
    s_mov_b64 exec, -1
    s_branch Lnofix
Lhalo:
    s_mov_b32 vcc_lo, 0x00010001
    s_mov_b32 vcc_hi, 0x00010001
    v_mov_b32 v11, 38912
    v_cndmask_b32 v76, v76, v11, vcc
    v_xor_b32 v77, 64, v76
    v_add_u32 v80, 78080, v76
    v_add_u32 v81, 78080, v77
    v_mov_b32 v14, 0x3f803f80
    v_mov_b32 v15, 0x3f803f80
    v_mov_b32 v16, 0x3f803f80
    v_mov_b32 v17, 0x3f803f80
    v_and_b32 v4, 7, v1
    v_lshlrev_b32 v4, 4, v4
    v_mul_u32_u24 v5, 39040, v2
    v_add_u32 v4, v4, v5
    ds_write_b128 v4, v[14:17] offset:38912
    v_mov_b32 v4, 157952
    v_mov_b32 v8, 0
    v_mov_b32 v9, 0
    v_mov_b32 v10, -2
    v_mov_b32 v11, -2
    ds_write_b128 v4, v[8:11]
    v_min_u32 v5, 23, v1
    v_lshl_add_u32 v5, v5, 2, v4
    ds_write_b32 v5, v8 offset:16
    s_mul_i32 s36, s32, 96
    s_sub_u32 s36, s36, 16
    v_add_u32 v96, s36, v1
    v_min_u32 v5, 47, v1
    v_add3_u32 v97, s36, v5, 64
    v_mov_b32 v6, 2047
    v_med3_i32 v96, v96, 0, v6
    v_med3_i32 v97, v97, 0, v6
    v_lshlrev_b32 v96, 3, v96
    v_lshlrev_b32 v97, 3, v97
    s_mov_b32 s49, 8192000
    v_mov_b32 v127, 157984
    s_lshl_b32 s36, s3, 2
    s_add_u32 s36, s36, 158016
    v_mov_b32 v10, s36
    s_waitcnt lgkmcnt(0)
    s_barrier
    s_add_u32 s34, s34, 0x9e3779b8
    s_or_b32 s34, s34, 1
    ds_read_b128 v[108:111], v76 offset:0
    ds_read_b128 v[112:115], v77 offset:0
    ds_read_b64_tr_b16 a[0:1], v20 offset:0
    ds_read_b64_tr_b16 a[2:3], v20 offset:512
    ds_read_b64_tr_b16 a[4:5], v21 offset:0
    ds_read_b64_tr_b16 a[6:7], v21 offset:512
    ds_read_b64_tr_b16 a[8:9], v22 offset:0
    ds_read_b64_tr_b16 a[10:11], v22 offset:512
    ds_read_b64_tr_b16 a[12:13], v23 offset:0
    ds_read_b64_tr_b16 a[14:15], v23 offset:512
    ds_read_b64_tr_b16 a[16:17], v20 offset:8192
    ds_read_b64_tr_b16 a[18:19], v20 offset:8704
    ds_read_b64_tr_b16 a[20:21], v21 offset:8192
    ds_read_b64_tr_b16 a[22:23], v21 offset:8704
    ds_read_b64_tr_b16 a[24:25], v22 offset:8192
    ds_read_b64_tr_b16 a[26:27], v22 offset:8704
    s_waitcnt lgkmcnt(12)
    v_mfma_f32_16x16x32_bf16 v[28:31], a[0:3], v[108:111], 0
    ds_read_b64_tr_b16 a[28:29], v23 offset:8192
    ds_read_b64_tr_b16 a[30:31], v23 offset:8704
    s_waitcnt lgkmcnt(12)
    v_mfma_f32_16x16x32_bf16 v[32:35], a[4:7], v[108:111], 0
    ds_read_b64_tr_b16 a[32:33], v20 offset:16384
    ds_read_b64_tr_b16 a[34:35], v20 offset:16896
    s_waitcnt lgkmcnt(12)
    v_mfma_f32_16x16x32_bf16 v[36:39], a[8:11], v[108:111], 0
    ds_read_b64_tr_b16 a[36:37], v21 offset:16384
    ds_read_b64_tr_b16 a[38:39], v21 offset:16896
    s_waitcnt lgkmcnt(12)
    v_mfma_f32_16x16x32_bf16 v[40:43], a[12:15], v[108:111], 0
    ds_read_b64_tr_b16 a[40:41], v22 offset:16384
    ds_read_b64_tr_b16 a[42:43], v22 offset:16896
    s_waitcnt lgkmcnt(12)
    v_mfma_f32_16x16x32_bf16 v[44:47], a[16:19], v[108:111], 0
    ds_read_b64_tr_b16 a[44:45], v23 offset:16384
    ds_read_b64_tr_b16 a[46:47], v23 offset:16896
    s_waitcnt lgkmcnt(12)
    v_mfma_f32_16x16x32_bf16 v[48:51], a[20:23], v[108:111], 0
    ds_read_b64_tr_b16 a[48:49], v20 offset:4096
    ds_read_b64_tr_b16 a[50:51], v20 offset:4608
    s_waitcnt lgkmcnt(12)
    v_mfma_f32_16x16x32_bf16 v[52:55], a[24:27], v[108:111], 0
    ds_read_b64_tr_b16 a[52:53], v21 offset:4096
    ds_read_b64_tr_b16 a[54:55], v21 offset:4608
    s_waitcnt lgkmcnt(12)
    v_mfma_f32_16x16x32_bf16 v[56:59], a[28:31], v[108:111], 0
    ds_read_b64_tr_b16 a[56:57], v22 offset:4096
    ds_read_b64_tr_b16 a[58:59], v22 offset:4608
    s_waitcnt lgkmcnt(12)
    v_mfma_f32_16x16x32_bf16 v[60:63], v[108:111], a[32:35], 0
    ds_read_b64_tr_b16 a[60:61], v23 offset:4096
    ds_read_b64_tr_b16 a[62:63], v23 offset:4608
    s_waitcnt lgkmcnt(12)
    v_mfma_f32_16x16x32_bf16 v[64:67], v[108:111], a[36:39], 0
    ds_read_b64_tr_b16 a[64:65], v20 offset:12288
    ds_read_b64_tr_b16 a[66:67], v20 offset:12800
    s_waitcnt lgkmcnt(12)
    v_mfma_f32_16x16x32_bf16 v[68:71], v[108:111], a[40:43], 0
    ds_read_b64_tr_b16 a[68:69], v21 offset:12288
    ds_read_b64_tr_b16 a[70:71], v21 offset:12800
    s_waitcnt lgkmcnt(12)
    v_mfma_f32_16x16x32_bf16 v[72:75], v[108:111], a[44:47], 0
    ds_read_b64_tr_b16 a[72:73], v22 offset:12288
    ds_read_b64_tr_b16 a[74:75], v22 offset:12800
    s_waitcnt lgkmcnt(12)
    v_mfma_f32_16x16x32_bf16 v[28:31], a[48:51], v[112:115], v[28:31]
    ds_read_b64_tr_b16 a[76:77], v23 offset:12288
    ds_read_b64_tr_b16 a[78:79], v23 offset:12800
    s_waitcnt lgkmcnt(12)
    v_mfma_f32_16x16x32_bf16 v[32:35], a[52:55], v[112:115], v[32:35]
    ds_read_b64_tr_b16 a[80:81], v20 offset:20480
    ds_read_b64_tr_b16 a[82:83], v20 offset:20992
    s_waitcnt lgkmcnt(12)
    v_mfma_f32_16x16x32_bf16 v[36:39], a[56:59], v[112:115], v[36:39]
    ds_read_b64_tr_b16 a[84:85], v21 offset:20480
    ds_read_b64_tr_b16 a[86:87], v21 offset:20992
    s_waitcnt lgkmcnt(12)
    v_mfma_f32_16x16x32_bf16 v[40:43], a[60:63], v[112:115], v[40:43]
    ds_read_b64_tr_b16 a[88:89], v22 offset:20480
    ds_read_b64_tr_b16 a[90:91], v22 offset:20992
    s_waitcnt lgkmcnt(12)
    v_mfma_f32_16x16x32_bf16 v[44:47], a[64:67], v[112:115], v[44:47]
    ds_read_b64_tr_b16 a[92:93], v23 offset:20480
    ds_read_b64_tr_b16 a[94:95], v23 offset:20992
    s_waitcnt lgkmcnt(12)
    v_mfma_f32_16x16x32_bf16 v[48:51], a[68:71], v[112:115], v[48:51]
    s_waitcnt lgkmcnt(10)
    v_mfma_f32_16x16x32_bf16 v[52:55], a[72:75], v[112:115], v[52:55]
    s_waitcnt lgkmcnt(8)
    v_mfma_f32_16x16x32_bf16 v[56:59], a[76:79], v[112:115], v[56:59]
    s_waitcnt lgkmcnt(6)
    v_mfma_f32_16x16x32_bf16 v[60:63], v[112:115], a[80:83], v[60:63]
    s_waitcnt lgkmcnt(4)
    v_mfma_f32_16x16x32_bf16 v[64:67], v[112:115], a[84:87], v[64:67]
    s_waitcnt lgkmcnt(2)
    v_mfma_f32_16x16x32_bf16 v[68:71], v[112:115], a[88:91], v[68:71]
    s_waitcnt lgkmcnt(0)
    v_mfma_f32_16x16x32_bf16 v[72:75], v[112:115], a[92:95], v[72:75]
    s_barrier
    ds_read_b128 v[108:111], v76 offset:39040
    ds_read_b128 v[112:115], v77 offset:39040
    ds_read_b64_tr_b16 a[0:1], v20 offset:39040
    ds_read_b64_tr_b16 a[2:3], v20 offset:39552
    ds_read_b64_tr_b16 a[4:5], v21 offset:39040
    ds_read_b64_tr_b16 a[6:7], v21 offset:39552
    ds_read_b64_tr_b16 a[8:9], v22 offset:39040
    ds_read_b64_tr_b16 a[10:11], v22 offset:39552
    ds_read_b64_tr_b16 a[12:13], v23 offset:39040
    ds_read_b64_tr_b16 a[14:15], v23 offset:39552
    ds_read_b64_tr_b16 a[16:17], v20 offset:47232
    ds_read_b64_tr_b16 a[18:19], v20 offset:47744
    ds_read_b64_tr_b16 a[20:21], v21 offset:47232
    ds_read_b64_tr_b16 a[22:23], v21 offset:47744
    ds_read_b64_tr_b16 a[24:25], v22 offset:47232
    ds_read_b64_tr_b16 a[26:27], v22 offset:47744
    s_waitcnt lgkmcnt(12)
    v_mfma_f32_16x16x32_bf16 v[28:31], a[0:3], v[108:111], v[28:31]
    ds_read_b64_tr_b16 a[28:29], v23 offset:47232
    ds_read_b64_tr_b16 a[30:31], v23 offset:47744
    s_waitcnt lgkmcnt(12)
    v_mfma_f32_16x16x32_bf16 v[32:35], a[4:7], v[108:111], v[32:35]
    ds_read_b64_tr_b16 a[32:33], v20 offset:55424
    ds_read_b64_tr_b16 a[34:35], v20 offset:55936
    s_waitcnt lgkmcnt(12)
    v_mfma_f32_16x16x32_bf16 v[36:39], a[8:11], v[108:111], v[36:39]
    ds_read_b64_tr_b16 a[36:37], v21 offset:55424
    ds_read_b64_tr_b16 a[38:39], v21 offset:55936
    s_waitcnt lgkmcnt(12)
    v_mfma_f32_16x16x32_bf16 v[40:43], a[12:15], v[108:111], v[40:43]
    ds_read_b64_tr_b16 a[40:41], v22 offset:55424
    ds_read_b64_tr_b16 a[42:43], v22 offset:55936
    s_waitcnt lgkmcnt(12)
    v_mfma_f32_16x16x32_bf16 v[44:47], a[16:19], v[108:111], v[44:47]
    ds_read_b64_tr_b16 a[44:45], v23 offset:55424
    ds_read_b64_tr_b16 a[46:47], v23 offset:55936
    s_waitcnt lgkmcnt(12)
    v_mfma_f32_16x16x32_bf16 v[48:51], a[20:23], v[108:111], v[48:51]
    ds_read_b64_tr_b16 a[48:49], v20 offset:43136
    ds_read_b64_tr_b16 a[50:51], v20 offset:43648
    s_waitcnt lgkmcnt(12)
    v_mfma_f32_16x16x32_bf16 v[52:55], a[24:27], v[108:111], v[52:55]
    ds_read_b64_tr_b16 a[52:53], v21 offset:43136
    ds_read_b64_tr_b16 a[54:55], v21 offset:43648
    s_waitcnt lgkmcnt(12)
    v_mfma_f32_16x16x32_bf16 v[56:59], a[28:31], v[108:111], v[56:59]
    ds_read_b64_tr_b16 a[56:57], v22 offset:43136
    ds_read_b64_tr_b16 a[58:59], v22 offset:43648
    s_waitcnt lgkmcnt(12)
    v_mfma_f32_16x16x32_bf16 v[60:63], v[108:111], a[32:35], v[60:63]
    ds_read_b64_tr_b16 a[60:61], v23 offset:43136
    ds_read_b64_tr_b16 a[62:63], v23 offset:43648
    s_waitcnt lgkmcnt(12)
    v_mfma_f32_16x16x32_bf16 v[64:67], v[108:111], a[36:39], v[64:67]
    ds_read_b64_tr_b16 a[64:65], v20 offset:51328
    ds_read_b64_tr_b16 a[66:67], v20 offset:51840
    s_waitcnt lgkmcnt(12)
    v_mfma_f32_16x16x32_bf16 v[68:71], v[108:111], a[40:43], v[68:71]
    ds_read_b64_tr_b16 a[68:69], v21 offset:51328
    ds_read_b64_tr_b16 a[70:71], v21 offset:51840
    s_waitcnt lgkmcnt(12)
    v_mfma_f32_16x16x32_bf16 v[72:75], v[108:111], a[44:47], v[72:75]
    ds_read_b64_tr_b16 a[72:73], v22 offset:51328
    ds_read_b64_tr_b16 a[74:75], v22 offset:51840
    s_waitcnt lgkmcnt(12)
    v_mfma_f32_16x16x32_bf16 v[28:31], a[48:51], v[112:115], v[28:31]
    ds_read_b64_tr_b16 a[76:77], v23 offset:51328
    ds_read_b64_tr_b16 a[78:79], v23 offset:51840
    s_waitcnt lgkmcnt(12)
    v_mfma_f32_16x16x32_bf16 v[32:35], a[52:55], v[112:115], v[32:35]
    ds_read_b64_tr_b16 a[80:81], v20 offset:59520
    ds_read_b64_tr_b16 a[82:83], v20 offset:60032
    s_waitcnt lgkmcnt(12)
    v_mfma_f32_16x16x32_bf16 v[36:39], a[56:59], v[112:115], v[36:39]
    ds_read_b64_tr_b16 a[84:85], v21 offset:59520
    ds_read_b64_tr_b16 a[86:87], v21 offset:60032
    s_waitcnt lgkmcnt(12)
    v_mfma_f32_16x16x32_bf16 v[40:43], a[60:63], v[112:115], v[40:43]
    ds_read_b64_tr_b16 a[88:89], v22 offset:59520
    ds_read_b64_tr_b16 a[90:91], v22 offset:60032
    s_waitcnt lgkmcnt(12)
    v_mfma_f32_16x16x32_bf16 v[44:47], a[64:67], v[112:115], v[44:47]
    ds_read_b64_tr_b16 a[92:93], v23 offset:59520
    ds_read_b64_tr_b16 a[94:95], v23 offset:60032
    s_waitcnt lgkmcnt(12)
    v_mfma_f32_16x16x32_bf16 v[48:51], a[68:71], v[112:115], v[48:51]
    s_waitcnt lgkmcnt(10)
    v_mfma_f32_16x16x32_bf16 v[52:55], a[72:75], v[112:115], v[52:55]
    s_waitcnt lgkmcnt(8)
    v_mfma_f32_16x16x32_bf16 v[56:59], a[76:79], v[112:115], v[56:59]
    s_waitcnt lgkmcnt(6)
    v_mfma_f32_16x16x32_bf16 v[60:63], v[112:115], a[80:83], v[60:63]
    s_waitcnt lgkmcnt(4)
    v_mfma_f32_16x16x32_bf16 v[64:67], v[112:115], a[84:87], v[64:67]
    s_waitcnt lgkmcnt(2)
    v_mfma_f32_16x16x32_bf16 v[68:71], v[112:115], a[88:91], v[68:71]
    s_waitcnt lgkmcnt(0)
    v_mfma_f32_16x16x32_bf16 v[72:75], v[112:115], a[92:95], v[72:75]
    s_mov_b64 exec, 1
    s_lshl_b32 s36, s2, 2
    s_add_u32 s36, s36, 8323072
    v_mov_b32 v4, s34
    v_mov_b32 v5, s36
    buffer_store_dword v4, v5, s[28:31], 0 offen sc1
    s_mov_b64 exec, -1
    s_barrier
    ds_read_b128 v[108:111], v80 offset:0
    ds_read_b128 v[112:115], v81 offset:0
    ds_read_b64_tr_b16 a[0:1], v24 offset:0
    ds_read_b64_tr_b16 a[2:3], v24 offset:512
    ds_read_b64_tr_b16 a[4:5], v25 offset:0
    ds_read_b64_tr_b16 a[6:7], v25 offset:512
    ds_read_b64_tr_b16 a[8:9], v26 offset:0
    ds_read_b64_tr_b16 a[10:11], v26 offset:512
    ds_read_b64_tr_b16 a[12:13], v27 offset:0
    ds_read_b64_tr_b16 a[14:15], v27 offset:512
    ds_read_b64_tr_b16 a[16:17], v24 offset:8192
    ds_read_b64_tr_b16 a[18:19], v24 offset:8704
    ds_read_b64_tr_b16 a[20:21], v25 offset:8192
    ds_read_b64_tr_b16 a[22:23], v25 offset:8704
    ds_read_b64_tr_b16 a[24:25], v26 offset:8192
    ds_read_b64_tr_b16 a[26:27], v26 offset:8704
    s_waitcnt lgkmcnt(12)
    v_mfma_f32_16x16x32_bf16 v[28:31], a[0:3], v[108:111], v[28:31]
    ds_read_b64_tr_b16 a[28:29], v27 offset:8192
    ds_read_b64_tr_b16 a[30:31], v27 offset:8704
    s_waitcnt lgkmcnt(12)
    v_mfma_f32_16x16x32_bf16 v[32:35], a[4:7], v[108:111], v[32:35]
    ds_read_b64_tr_b16 a[32:33], v24 offset:16384
    ds_read_b64_tr_b16 a[34:35], v24 offset:16896
    s_waitcnt lgkmcnt(12)
    v_mfma_f32_16x16x32_bf16 v[36:39], a[8:11], v[108:111], v[36:39]
    ds_read_b64_tr_b16 a[36:37], v25 offset:16384
    ds_read_b64_tr_b16 a[38:39], v25 offset:16896
    s_waitcnt lgkmcnt(12)
    v_mfma_f32_16x16x32_bf16 v[40:43], a[12:15], v[108:111], v[40:43]
    ds_read_b64_tr_b16 a[40:41], v26 offset:16384
    ds_read_b64_tr_b16 a[42:43], v26 offset:16896
    s_waitcnt lgkmcnt(12)
    v_mfma_f32_16x16x32_bf16 v[44:47], a[16:19], v[108:111], v[44:47]
    ds_read_b64_tr_b16 a[44:45], v27 offset:16384
    ds_read_b64_tr_b16 a[46:47], v27 offset:16896
    s_waitcnt lgkmcnt(12)
    v_mfma_f32_16x16x32_bf16 v[48:51], a[20:23], v[108:111], v[48:51]
    ds_read_b64_tr_b16 a[48:49], v24 offset:4096
    ds_read_b64_tr_b16 a[50:51], v24 offset:4608
    s_waitcnt lgkmcnt(12)
    v_mfma_f32_16x16x32_bf16 v[52:55], a[24:27], v[108:111], v[52:55]
    ds_read_b64_tr_b16 a[52:53], v25 offset:4096
    ds_read_b64_tr_b16 a[54:55], v25 offset:4608
    s_waitcnt lgkmcnt(12)
    v_mfma_f32_16x16x32_bf16 v[56:59], a[28:31], v[108:111], v[56:59]
    ds_read_b64_tr_b16 a[56:57], v26 offset:4096
    ds_read_b64_tr_b16 a[58:59], v26 offset:4608
    s_waitcnt lgkmcnt(12)
    v_mfma_f32_16x16x32_bf16 v[60:63], v[108:111], a[32:35], v[60:63]
    ds_read_b64_tr_b16 a[60:61], v27 offset:4096
    ds_read_b64_tr_b16 a[62:63], v27 offset:4608
    s_waitcnt lgkmcnt(12)
    v_mfma_f32_16x16x32_bf16 v[64:67], v[108:111], a[36:39], v[64:67]
    ds_read_b64_tr_b16 a[64:65], v24 offset:12288
    ds_read_b64_tr_b16 a[66:67], v24 offset:12800
    s_waitcnt lgkmcnt(12)
    v_mfma_f32_16x16x32_bf16 v[68:71], v[108:111], a[40:43], v[68:71]
    ds_read_b64_tr_b16 a[68:69], v25 offset:12288
    ds_read_b64_tr_b16 a[70:71], v25 offset:12800
    s_waitcnt lgkmcnt(12)
    v_mfma_f32_16x16x32_bf16 v[72:75], v[108:111], a[44:47], v[72:75]
    ds_read_b64_tr_b16 a[72:73], v26 offset:12288
    ds_read_b64_tr_b16 a[74:75], v26 offset:12800
    s_waitcnt lgkmcnt(12)
    v_mfma_f32_16x16x32_bf16 v[28:31], a[48:51], v[112:115], v[28:31]
    ds_read_b64_tr_b16 a[76:77], v27 offset:12288
    ds_read_b64_tr_b16 a[78:79], v27 offset:12800
    s_waitcnt lgkmcnt(12)
    v_mfma_f32_16x16x32_bf16 v[32:35], a[52:55], v[112:115], v[32:35]
    ds_read_b64_tr_b16 a[80:81], v24 offset:20480
    ds_read_b64_tr_b16 a[82:83], v24 offset:20992
    s_waitcnt lgkmcnt(12)
    v_mfma_f32_16x16x32_bf16 v[36:39], a[56:59], v[112:115], v[36:39]
    ds_read_b64_tr_b16 a[84:85], v25 offset:20480
    ds_read_b64_tr_b16 a[86:87], v25 offset:20992
    s_waitcnt lgkmcnt(12)
    v_mfma_f32_16x16x32_bf16 v[40:43], a[60:63], v[112:115], v[40:43]
    ds_read_b64_tr_b16 a[88:89], v26 offset:20480
    ds_read_b64_tr_b16 a[90:91], v26 offset:20992
    s_waitcnt lgkmcnt(12)
    v_mfma_f32_16x16x32_bf16 v[44:47], a[64:67], v[112:115], v[44:47]
    ds_read_b64_tr_b16 a[92:93], v27 offset:20480
    ds_read_b64_tr_b16 a[94:95], v27 offset:20992
    s_waitcnt lgkmcnt(12)
    v_mfma_f32_16x16x32_bf16 v[48:51], a[68:71], v[112:115], v[48:51]
    s_waitcnt lgkmcnt(10)
    v_mfma_f32_16x16x32_bf16 v[52:55], a[72:75], v[112:115], v[52:55]
    s_waitcnt lgkmcnt(8)
    v_mfma_f32_16x16x32_bf16 v[56:59], a[76:79], v[112:115], v[56:59]
    s_waitcnt lgkmcnt(6)
    v_mfma_f32_16x16x32_bf16 v[60:63], v[112:115], a[80:83], v[60:63]
    s_waitcnt lgkmcnt(4)
    v_mfma_f32_16x16x32_bf16 v[64:67], v[112:115], a[84:87], v[64:67]
    s_waitcnt lgkmcnt(2)
    v_mfma_f32_16x16x32_bf16 v[68:71], v[112:115], a[88:91], v[68:71]
    s_waitcnt lgkmcnt(0)
    v_mfma_f32_16x16x32_bf16 v[72:75], v[112:115], a[92:95], v[72:75]
    s_barrier
    ds_read_b128 v[108:111], v80 offset:39040
    ds_read_b128 v[112:115], v81 offset:39040
    ds_read_b64_tr_b16 a[0:1], v24 offset:39040
    ds_read_b64_tr_b16 a[2:3], v24 offset:39552
    ds_read_b64_tr_b16 a[4:5], v25 offset:39040
    ds_read_b64_tr_b16 a[6:7], v25 offset:39552
    ds_read_b64_tr_b16 a[8:9], v26 offset:39040
    ds_read_b64_tr_b16 a[10:11], v26 offset:39552
    ds_read_b64_tr_b16 a[12:13], v27 offset:39040
    ds_read_b64_tr_b16 a[14:15], v27 offset:39552
    ds_read_b64_tr_b16 a[16:17], v24 offset:47232
    ds_read_b64_tr_b16 a[18:19], v24 offset:47744
    ds_read_b64_tr_b16 a[20:21], v25 offset:47232
    ds_read_b64_tr_b16 a[22:23], v25 offset:47744
    ds_read_b64_tr_b16 a[24:25], v26 offset:47232
    ds_read_b64_tr_b16 a[26:27], v26 offset:47744
    s_waitcnt lgkmcnt(12)
    v_mfma_f32_16x16x32_bf16 v[28:31], a[0:3], v[108:111], v[28:31]
    ds_read_b64_tr_b16 a[28:29], v27 offset:47232
    ds_read_b64_tr_b16 a[30:31], v27 offset:47744
    s_waitcnt lgkmcnt(12)
    v_mfma_f32_16x16x32_bf16 v[32:35], a[4:7], v[108:111], v[32:35]
    ds_read_b64_tr_b16 a[32:33], v24 offset:55424
    ds_read_b64_tr_b16 a[34:35], v24 offset:55936
    s_waitcnt lgkmcnt(12)
    v_mfma_f32_16x16x32_bf16 v[36:39], a[8:11], v[108:111], v[36:39]
    ds_read_b64_tr_b16 a[36:37], v25 offset:55424
    ds_read_b64_tr_b16 a[38:39], v25 offset:55936
    s_waitcnt lgkmcnt(12)
    v_mfma_f32_16x16x32_bf16 v[40:43], a[12:15], v[108:111], v[40:43]
    ds_read_b64_tr_b16 a[40:41], v26 offset:55424
    ds_read_b64_tr_b16 a[42:43], v26 offset:55936
    s_waitcnt lgkmcnt(12)
    v_mfma_f32_16x16x32_bf16 v[44:47], a[16:19], v[108:111], v[44:47]
    ds_read_b64_tr_b16 a[44:45], v27 offset:55424
    ds_read_b64_tr_b16 a[46:47], v27 offset:55936
    s_waitcnt lgkmcnt(12)
    v_mfma_f32_16x16x32_bf16 v[48:51], a[20:23], v[108:111], v[48:51]
    ds_read_b64_tr_b16 a[48:49], v24 offset:43136
    ds_read_b64_tr_b16 a[50:51], v24 offset:43648
    s_waitcnt lgkmcnt(12)
    v_mfma_f32_16x16x32_bf16 v[52:55], a[24:27], v[108:111], v[52:55]
    ds_read_b64_tr_b16 a[52:53], v25 offset:43136
    ds_read_b64_tr_b16 a[54:55], v25 offset:43648
    s_waitcnt lgkmcnt(12)
    v_mfma_f32_16x16x32_bf16 v[56:59], a[28:31], v[108:111], v[56:59]
    ds_read_b64_tr_b16 a[56:57], v26 offset:43136
    ds_read_b64_tr_b16 a[58:59], v26 offset:43648
    s_waitcnt lgkmcnt(12)
    v_mfma_f32_16x16x32_bf16 v[60:63], v[108:111], a[32:35], v[60:63]
    ds_read_b64_tr_b16 a[60:61], v27 offset:43136
    ds_read_b64_tr_b16 a[62:63], v27 offset:43648
    s_waitcnt lgkmcnt(12)
    v_mfma_f32_16x16x32_bf16 v[64:67], v[108:111], a[36:39], v[64:67]
    ds_read_b64_tr_b16 a[64:65], v24 offset:51328
    ds_read_b64_tr_b16 a[66:67], v24 offset:51840
    s_waitcnt lgkmcnt(12)
    v_mfma_f32_16x16x32_bf16 v[68:71], v[108:111], a[40:43], v[68:71]
    ds_read_b64_tr_b16 a[68:69], v25 offset:51328
    ds_read_b64_tr_b16 a[70:71], v25 offset:51840
    s_waitcnt lgkmcnt(12)
    v_mfma_f32_16x16x32_bf16 v[72:75], v[108:111], a[44:47], v[72:75]
    ds_read_b64_tr_b16 a[72:73], v26 offset:51328
    ds_read_b64_tr_b16 a[74:75], v26 offset:51840
    s_waitcnt lgkmcnt(12)
    v_mfma_f32_16x16x32_bf16 v[28:31], a[48:51], v[112:115], v[28:31]
    ds_read_b64_tr_b16 a[76:77], v27 offset:51328
    ds_read_b64_tr_b16 a[78:79], v27 offset:51840
    s_waitcnt lgkmcnt(12)
    v_mfma_f32_16x16x32_bf16 v[32:35], a[52:55], v[112:115], v[32:35]
    ds_read_b64_tr_b16 a[80:81], v24 offset:59520
    ds_read_b64_tr_b16 a[82:83], v24 offset:60032
    s_waitcnt lgkmcnt(12)
    v_mfma_f32_16x16x32_bf16 v[36:39], a[56:59], v[112:115], v[36:39]
    ds_read_b64_tr_b16 a[84:85], v25 offset:59520
    ds_read_b64_tr_b16 a[86:87], v25 offset:60032
    s_waitcnt lgkmcnt(12)
    v_mfma_f32_16x16x32_bf16 v[40:43], a[60:63], v[112:115], v[40:43]
    ds_read_b64_tr_b16 a[88:89], v26 offset:59520
    ds_read_b64_tr_b16 a[90:91], v26 offset:60032
    s_waitcnt lgkmcnt(12)
    v_mfma_f32_16x16x32_bf16 v[44:47], a[64:67], v[112:115], v[44:47]
    ds_read_b64_tr_b16 a[92:93], v27 offset:59520
    ds_read_b64_tr_b16 a[94:95], v27 offset:60032
    s_waitcnt lgkmcnt(12)
    v_mfma_f32_16x16x32_bf16 v[48:51], a[68:71], v[112:115], v[48:51]
    s_waitcnt lgkmcnt(10)
    v_mfma_f32_16x16x32_bf16 v[52:55], a[72:75], v[112:115], v[52:55]
    s_waitcnt lgkmcnt(8)
    v_mfma_f32_16x16x32_bf16 v[56:59], a[76:79], v[112:115], v[56:59]
    s_waitcnt lgkmcnt(6)
    v_mfma_f32_16x16x32_bf16 v[60:63], v[112:115], a[80:83], v[60:63]
    s_waitcnt lgkmcnt(4)
    v_mfma_f32_16x16x32_bf16 v[64:67], v[112:115], a[84:87], v[64:67]
    s_waitcnt lgkmcnt(2)
    v_mfma_f32_16x16x32_bf16 v[68:71], v[112:115], a[88:91], v[68:71]
    s_waitcnt lgkmcnt(0)
    v_mfma_f32_16x16x32_bf16 v[72:75], v[112:115], a[92:95], v[72:75]
    v_add_u32 v4, 156224, v12
    v_min_u32 v5, 47, v1
    v_lshlrev_b32 v5, 2, v5
    v_add_u32 v5, 156480, v5
    v_lshlrev_b32 v6, 4, v2
    v_add_u32 v6, 157184, v6
    v_mov_b32 v7, 157968
    v_lshlrev_b32 v11, 2, v3
    v_add_u32 v11, 156224, v11
    s_barrier
    ds_read_b128 v[108:111], v76 offset:0
    ds_read_b128 v[112:115], v77 offset:0
    ds_read_b64_tr_b16 a[0:1], v20 offset:0
    ds_read_b64_tr_b16 a[2:3], v20 offset:512
    ds_read_b64_tr_b16 a[4:5], v21 offset:0
    ds_read_b64_tr_b16 a[6:7], v21 offset:512
    ds_read_b64_tr_b16 a[8:9], v22 offset:0
    ds_read_b64_tr_b16 a[10:11], v22 offset:512
    ds_read_b64_tr_b16 a[12:13], v23 offset:0
    ds_read_b64_tr_b16 a[14:15], v23 offset:512
    ds_read_b64_tr_b16 a[16:17], v20 offset:8192
    ds_read_b64_tr_b16 a[18:19], v20 offset:8704
    ds_read_b64_tr_b16 a[20:21], v21 offset:8192
    ds_read_b64_tr_b16 a[22:23], v21 offset:8704
    ds_read_b64_tr_b16 a[24:25], v22 offset:8192
    ds_read_b64_tr_b16 a[26:27], v22 offset:8704
    s_waitcnt lgkmcnt(12)
    v_mfma_f32_16x16x32_bf16 v[28:31], a[0:3], v[108:111], v[28:31]
    ds_read_b64_tr_b16 a[28:29], v23 offset:8192
    ds_read_b64_tr_b16 a[30:31], v23 offset:8704
    s_waitcnt lgkmcnt(12)
    v_mfma_f32_16x16x32_bf16 v[32:35], a[4:7], v[108:111], v[32:35]
    ds_read_b64_tr_b16 a[32:33], v20 offset:16384
    ds_read_b64_tr_b16 a[34:35], v20 offset:16896
    s_waitcnt lgkmcnt(12)
    v_mfma_f32_16x16x32_bf16 v[36:39], a[8:11], v[108:111], v[36:39]
    ds_read_b64_tr_b16 a[36:37], v21 offset:16384
    ds_read_b64_tr_b16 a[38:39], v21 offset:16896
    s_waitcnt lgkmcnt(12)
    v_mfma_f32_16x16x32_bf16 v[40:43], a[12:15], v[108:111], v[40:43]
    ds_read_b64_tr_b16 a[40:41], v22 offset:16384
    ds_read_b64_tr_b16 a[42:43], v22 offset:16896
    s_waitcnt lgkmcnt(12)
    v_mfma_f32_16x16x32_bf16 v[44:47], a[16:19], v[108:111], v[44:47]
    ds_read_b64_tr_b16 a[44:45], v23 offset:16384
    ds_read_b64_tr_b16 a[46:47], v23 offset:16896
    s_waitcnt lgkmcnt(12)
    v_mfma_f32_16x16x32_bf16 v[48:51], a[20:23], v[108:111], v[48:51]
    ds_read_b64_tr_b16 a[48:49], v20 offset:4096
    ds_read_b64_tr_b16 a[50:51], v20 offset:4608
    s_waitcnt lgkmcnt(12)
    v_mfma_f32_16x16x32_bf16 v[52:55], a[24:27], v[108:111], v[52:55]
    ds_read_b64_tr_b16 a[52:53], v21 offset:4096
    ds_read_b64_tr_b16 a[54:55], v21 offset:4608
    s_waitcnt lgkmcnt(12)
    v_mfma_f32_16x16x32_bf16 v[56:59], a[28:31], v[108:111], v[56:59]
    ds_read_b64_tr_b16 a[56:57], v22 offset:4096
    ds_read_b64_tr_b16 a[58:59], v22 offset:4608
    s_waitcnt lgkmcnt(12)
    v_mfma_f32_16x16x32_bf16 v[60:63], v[108:111], a[32:35], v[60:63]
    ds_read_b64_tr_b16 a[60:61], v23 offset:4096
    ds_read_b64_tr_b16 a[62:63], v23 offset:4608
    s_waitcnt lgkmcnt(12)
    v_mfma_f32_16x16x32_bf16 v[64:67], v[108:111], a[36:39], v[64:67]
    ds_read_b64_tr_b16 a[64:65], v20 offset:12288
    ds_read_b64_tr_b16 a[66:67], v20 offset:12800
    s_waitcnt lgkmcnt(12)
    v_mfma_f32_16x16x32_bf16 v[68:71], v[108:111], a[40:43], v[68:71]
    ds_read_b64_tr_b16 a[68:69], v21 offset:12288
    ds_read_b64_tr_b16 a[70:71], v21 offset:12800
    s_waitcnt lgkmcnt(12)
    v_mfma_f32_16x16x32_bf16 v[72:75], v[108:111], a[44:47], v[72:75]
    ds_read_b64_tr_b16 a[72:73], v22 offset:12288
    ds_read_b64_tr_b16 a[74:75], v22 offset:12800
    s_waitcnt lgkmcnt(12)
    v_mfma_f32_16x16x32_bf16 v[28:31], a[48:51], v[112:115], v[28:31]
    ds_read_b64_tr_b16 a[76:77], v23 offset:12288
    ds_read_b64_tr_b16 a[78:79], v23 offset:12800
    s_waitcnt lgkmcnt(12)
    v_mfma_f32_16x16x32_bf16 v[32:35], a[52:55], v[112:115], v[32:35]
    ds_read_b64_tr_b16 a[80:81], v20 offset:20480
    ds_read_b64_tr_b16 a[82:83], v20 offset:20992
    s_waitcnt lgkmcnt(12)
    v_mfma_f32_16x16x32_bf16 v[36:39], a[56:59], v[112:115], v[36:39]
    ds_read_b64_tr_b16 a[84:85], v21 offset:20480
    ds_read_b64_tr_b16 a[86:87], v21 offset:20992
    s_waitcnt lgkmcnt(12)
    v_mfma_f32_16x16x32_bf16 v[40:43], a[60:63], v[112:115], v[40:43]
    ds_read_b64_tr_b16 a[88:89], v22 offset:20480
    ds_read_b64_tr_b16 a[90:91], v22 offset:20992
    s_waitcnt lgkmcnt(12)
    v_mfma_f32_16x16x32_bf16 v[44:47], a[64:67], v[112:115], v[44:47]
    ds_read_b64_tr_b16 a[92:93], v23 offset:20480
    ds_read_b64_tr_b16 a[94:95], v23 offset:20992
    s_waitcnt lgkmcnt(12)
    v_mfma_f32_16x16x32_bf16 v[48:51], a[68:71], v[112:115], v[48:51]
    s_waitcnt lgkmcnt(10)
    v_mfma_f32_16x16x32_bf16 v[52:55], a[72:75], v[112:115], v[52:55]
    s_waitcnt lgkmcnt(8)
    v_mfma_f32_16x16x32_bf16 v[56:59], a[76:79], v[112:115], v[56:59]
    s_waitcnt lgkmcnt(6)
    v_mfma_f32_16x16x32_bf16 v[60:63], v[112:115], a[80:83], v[60:63]
    s_waitcnt lgkmcnt(4)
    v_mfma_f32_16x16x32_bf16 v[64:67], v[112:115], a[84:87], v[64:67]
    s_waitcnt lgkmcnt(2)
    v_mfma_f32_16x16x32_bf16 v[68:71], v[112:115], a[88:91], v[68:71]
    s_waitcnt lgkmcnt(0)
    v_mfma_f32_16x16x32_bf16 v[72:75], v[112:115], a[92:95], v[72:75]
    s_barrier
    ds_read_b128 v[108:111], v76 offset:39040
    ds_read_b128 v[112:115], v77 offset:39040
    ds_read_b64_tr_b16 a[0:1], v20 offset:39040
    ds_read_b64_tr_b16 a[2:3], v20 offset:39552
    ds_read_b64_tr_b16 a[4:5], v21 offset:39040
    ds_read_b64_tr_b16 a[6:7], v21 offset:39552
    ds_read_b64_tr_b16 a[8:9], v22 offset:39040
    ds_read_b64_tr_b16 a[10:11], v22 offset:39552
    ds_read_b64_tr_b16 a[12:13], v23 offset:39040
    ds_read_b64_tr_b16 a[14:15], v23 offset:39552
    ds_read_b64_tr_b16 a[16:17], v20 offset:47232
    ds_read_b64_tr_b16 a[18:19], v20 offset:47744
    ds_read_b64_tr_b16 a[20:21], v21 offset:47232
    ds_read_b64_tr_b16 a[22:23], v21 offset:47744
    ds_read_b64_tr_b16 a[24:25], v22 offset:47232
    ds_read_b64_tr_b16 a[26:27], v22 offset:47744
    s_waitcnt lgkmcnt(12)
    v_mfma_f32_16x16x32_bf16 v[28:31], a[0:3], v[108:111], v[28:31]
    ds_read_b64_tr_b16 a[28:29], v23 offset:47232
    ds_read_b64_tr_b16 a[30:31], v23 offset:47744
    s_waitcnt lgkmcnt(12)
    v_mfma_f32_16x16x32_bf16 v[32:35], a[4:7], v[108:111], v[32:35]
    ds_read_b64_tr_b16 a[32:33], v20 offset:55424
    ds_read_b64_tr_b16 a[34:35], v20 offset:55936
    s_waitcnt lgkmcnt(12)
    v_mfma_f32_16x16x32_bf16 v[36:39], a[8:11], v[108:111], v[36:39]
    ds_read_b64_tr_b16 a[36:37], v21 offset:55424
    ds_read_b64_tr_b16 a[38:39], v21 offset:55936
    s_waitcnt lgkmcnt(12)
    v_mfma_f32_16x16x32_bf16 v[40:43], a[12:15], v[108:111], v[40:43]
    ds_read_b64_tr_b16 a[40:41], v22 offset:55424
    ds_read_b64_tr_b16 a[42:43], v22 offset:55936
    s_waitcnt lgkmcnt(12)
    v_mfma_f32_16x16x32_bf16 v[44:47], a[16:19], v[108:111], v[44:47]
    ds_read_b64_tr_b16 a[44:45], v23 offset:55424
    ds_read_b64_tr_b16 a[46:47], v23 offset:55936
    s_waitcnt lgkmcnt(12)
    v_mfma_f32_16x16x32_bf16 v[48:51], a[20:23], v[108:111], v[48:51]
    ds_read_b64_tr_b16 a[48:49], v20 offset:43136
    ds_read_b64_tr_b16 a[50:51], v20 offset:43648
    s_waitcnt lgkmcnt(12)
    v_mfma_f32_16x16x32_bf16 v[52:55], a[24:27], v[108:111], v[52:55]
    ds_read_b64_tr_b16 a[52:53], v21 offset:43136
    ds_read_b64_tr_b16 a[54:55], v21 offset:43648
    s_waitcnt lgkmcnt(12)
    v_mfma_f32_16x16x32_bf16 v[56:59], a[28:31], v[108:111], v[56:59]
    ds_read_b64_tr_b16 a[56:57], v22 offset:43136
    ds_read_b64_tr_b16 a[58:59], v22 offset:43648
    s_waitcnt lgkmcnt(12)
    v_mfma_f32_16x16x32_bf16 v[60:63], v[108:111], a[32:35], v[60:63]
    ds_read_b64_tr_b16 a[60:61], v23 offset:43136
    ds_read_b64_tr_b16 a[62:63], v23 offset:43648
    s_waitcnt lgkmcnt(12)
    v_mfma_f32_16x16x32_bf16 v[64:67], v[108:111], a[36:39], v[64:67]
    ds_read_b64_tr_b16 a[64:65], v20 offset:51328
    ds_read_b64_tr_b16 a[66:67], v20 offset:51840
    s_waitcnt lgkmcnt(12)
    v_mfma_f32_16x16x32_bf16 v[68:71], v[108:111], a[40:43], v[68:71]
    ds_read_b64_tr_b16 a[68:69], v21 offset:51328
    ds_read_b64_tr_b16 a[70:71], v21 offset:51840
    s_waitcnt lgkmcnt(12)
    v_mfma_f32_16x16x32_bf16 v[72:75], v[108:111], a[44:47], v[72:75]
    ds_read_b64_tr_b16 a[72:73], v22 offset:51328
    ds_read_b64_tr_b16 a[74:75], v22 offset:51840
    s_waitcnt lgkmcnt(12)
    v_mfma_f32_16x16x32_bf16 v[28:31], a[48:51], v[112:115], v[28:31]
    ds_read_b64_tr_b16 a[76:77], v23 offset:51328
    ds_read_b64_tr_b16 a[78:79], v23 offset:51840
    s_waitcnt lgkmcnt(12)
    v_mfma_f32_16x16x32_bf16 v[32:35], a[52:55], v[112:115], v[32:35]
    ds_read_b64_tr_b16 a[80:81], v20 offset:59520
    ds_read_b64_tr_b16 a[82:83], v20 offset:60032
    s_waitcnt lgkmcnt(12)
    v_mfma_f32_16x16x32_bf16 v[36:39], a[56:59], v[112:115], v[36:39]
    ds_read_b64_tr_b16 a[84:85], v21 offset:59520
    ds_read_b64_tr_b16 a[86:87], v21 offset:60032
    s_waitcnt lgkmcnt(12)
    v_mfma_f32_16x16x32_bf16 v[40:43], a[60:63], v[112:115], v[40:43]
    ds_read_b64_tr_b16 a[88:89], v22 offset:59520
    ds_read_b64_tr_b16 a[90:91], v22 offset:60032
    s_waitcnt lgkmcnt(12)
    v_mfma_f32_16x16x32_bf16 v[44:47], a[64:67], v[112:115], v[44:47]
    ds_read_b64_tr_b16 a[92:93], v23 offset:59520
    ds_read_b64_tr_b16 a[94:95], v23 offset:60032
    s_waitcnt lgkmcnt(12)
    v_mfma_f32_16x16x32_bf16 v[48:51], a[68:71], v[112:115], v[48:51]
    s_waitcnt lgkmcnt(10)
    v_mfma_f32_16x16x32_bf16 v[52:55], a[72:75], v[112:115], v[52:55]
    s_waitcnt lgkmcnt(8)
    v_mfma_f32_16x16x32_bf16 v[56:59], a[76:79], v[112:115], v[56:59]
    s_waitcnt lgkmcnt(6)
    v_mfma_f32_16x16x32_bf16 v[60:63], v[112:115], a[80:83], v[60:63]
    s_waitcnt lgkmcnt(4)
    v_mfma_f32_16x16x32_bf16 v[64:67], v[112:115], a[84:87], v[64:67]
    s_waitcnt lgkmcnt(2)
    v_mfma_f32_16x16x32_bf16 v[68:71], v[112:115], a[88:91], v[68:71]
    s_waitcnt lgkmcnt(0)
    v_mfma_f32_16x16x32_bf16 v[72:75], v[112:115], a[92:95], v[72:75]
    s_barrier
    ds_read_b128 a[96:99], v80 offset:0
    ds_read_b128 a[100:103], v81 offset:0
    ds_read_b64_tr_b16 a[0:1], v24 offset:0
    ds_read_b64_tr_b16 a[2:3], v24 offset:512
    ds_read_b64_tr_b16 a[4:5], v25 offset:0
    ds_read_b64_tr_b16 a[6:7], v25 offset:512
    ds_read_b64_tr_b16 a[8:9], v26 offset:0
    ds_read_b64_tr_b16 a[10:11], v26 offset:512
    ds_read_b64_tr_b16 a[12:13], v27 offset:0
    ds_read_b64_tr_b16 a[14:15], v27 offset:512
    ds_read_b64_tr_b16 a[16:17], v24 offset:8192
    ds_read_b64_tr_b16 a[18:19], v24 offset:8704
    ds_read_b64_tr_b16 a[20:21], v25 offset:8192
    ds_read_b64_tr_b16 a[22:23], v25 offset:8704
    ds_read_b64_tr_b16 a[24:25], v26 offset:8192
    ds_read_b64_tr_b16 a[26:27], v26 offset:8704
    s_waitcnt lgkmcnt(12)
    v_mfma_f32_16x16x32_bf16 v[28:31], a[0:3], a[96:99], v[28:31]
    ds_read_b64_tr_b16 a[28:29], v27 offset:8192
    ds_read_b64_tr_b16 a[30:31], v27 offset:8704
    s_waitcnt lgkmcnt(12)
    v_mfma_f32_16x16x32_bf16 v[32:35], a[4:7], a[96:99], v[32:35]
    ds_read_b64_tr_b16 a[48:49], v24 offset:4096
    ds_read_b64_tr_b16 a[50:51], v24 offset:4608
    s_waitcnt lgkmcnt(12)
    v_mfma_f32_16x16x32_bf16 v[36:39], a[8:11], a[96:99], v[36:39]
    ds_read_b64_tr_b16 a[52:53], v25 offset:4096
    ds_read_b64_tr_b16 a[54:55], v25 offset:4608
    s_waitcnt lgkmcnt(12)
    v_mfma_f32_16x16x32_bf16 v[40:43], a[12:15], a[96:99], v[40:43]
    ds_read_b64_tr_b16 a[56:57], v26 offset:4096
    ds_read_b64_tr_b16 a[58:59], v26 offset:4608
    s_waitcnt lgkmcnt(12)
    v_mfma_f32_16x16x32_bf16 v[44:47], a[16:19], a[96:99], v[44:47]
    ds_read_b64_tr_b16 a[60:61], v27 offset:4096
    ds_read_b64_tr_b16 a[62:63], v27 offset:4608
    s_waitcnt lgkmcnt(12)
    v_mfma_f32_16x16x32_bf16 v[48:51], a[20:23], a[96:99], v[48:51]
    ds_read_b64_tr_b16 a[64:65], v24 offset:12288
    ds_read_b64_tr_b16 a[66:67], v24 offset:12800
    s_waitcnt lgkmcnt(12)
    v_mfma_f32_16x16x32_bf16 v[52:55], a[24:27], a[96:99], v[52:55]
    ds_read_b64_tr_b16 a[68:69], v25 offset:12288
    ds_read_b64_tr_b16 a[70:71], v25 offset:12800
    s_waitcnt lgkmcnt(12)
    v_mfma_f32_16x16x32_bf16 v[56:59], a[28:31], a[96:99], v[56:59]
    ds_read_b64_tr_b16 a[72:73], v26 offset:12288
    ds_read_b64_tr_b16 a[74:75], v26 offset:12800
    s_waitcnt lgkmcnt(12)
    v_mfma_f32_16x16x32_bf16 v[28:31], a[48:51], a[100:103], v[28:31]
    ds_read_b64_tr_b16 a[76:77], v27 offset:12288
    ds_read_b64_tr_b16 a[78:79], v27 offset:12800
    s_waitcnt lgkmcnt(12)
    v_mfma_f32_16x16x32_bf16 v[32:35], a[52:55], a[100:103], v[32:35]
    s_waitcnt lgkmcnt(10)
    v_mfma_f32_16x16x32_bf16 v[36:39], a[56:59], a[100:103], v[36:39]
    s_waitcnt lgkmcnt(8)
    v_mfma_f32_16x16x32_bf16 v[40:43], a[60:63], a[100:103], v[40:43]
    s_waitcnt lgkmcnt(6)
    v_mfma_f32_16x16x32_bf16 v[44:47], a[64:67], a[100:103], v[44:47]
    s_waitcnt lgkmcnt(4)
    v_mfma_f32_16x16x32_bf16 v[48:51], a[68:71], a[100:103], v[48:51]
    s_waitcnt lgkmcnt(2)
    v_mfma_f32_16x16x32_bf16 v[52:55], a[72:75], a[100:103], v[52:55]
    s_waitcnt lgkmcnt(0)
    v_mfma_f32_16x16x32_bf16 v[56:59], a[76:79], a[100:103], v[56:59]
    buffer_load_dwordx2 v[92:93], v96, s[28:31], s49 offen sc1
    buffer_load_dwordx2 v[94:95], v97, s[28:31], s49 offen sc1
    s_barrier
    ds_read_b128 a[104:107], v80 offset:39040
    ds_read_b128 a[108:111], v81 offset:39040
    ds_read_b64_tr_b16 a[0:1], v24 offset:39040
    ds_read_b64_tr_b16 a[2:3], v24 offset:39552
    ds_read_b64_tr_b16 a[4:5], v25 offset:39040
    ds_read_b64_tr_b16 a[6:7], v25 offset:39552
    ds_read_b64_tr_b16 a[8:9], v26 offset:39040
    ds_read_b64_tr_b16 a[10:11], v26 offset:39552
    ds_read_b64_tr_b16 a[12:13], v27 offset:39040
    ds_read_b64_tr_b16 a[14:15], v27 offset:39552
    ds_read_b64_tr_b16 a[16:17], v24 offset:47232
    ds_read_b64_tr_b16 a[18:19], v24 offset:47744
    ds_read_b64_tr_b16 a[20:21], v25 offset:47232
    ds_read_b64_tr_b16 a[22:23], v25 offset:47744
    ds_read_b64_tr_b16 a[24:25], v26 offset:47232
    ds_read_b64_tr_b16 a[26:27], v26 offset:47744
    s_waitcnt lgkmcnt(12)
    v_mfma_f32_16x16x32_bf16 v[28:31], a[0:3], a[104:107], v[28:31]
    ds_read_b64_tr_b16 a[28:29], v27 offset:47232
    ds_read_b64_tr_b16 a[30:31], v27 offset:47744
    s_waitcnt lgkmcnt(12)
    v_mfma_f32_16x16x32_bf16 v[32:35], a[4:7], a[104:107], v[32:35]
    ds_read_b64_tr_b16 a[48:49], v24 offset:43136
    ds_read_b64_tr_b16 a[50:51], v24 offset:43648
    s_waitcnt lgkmcnt(12)
    v_mfma_f32_16x16x32_bf16 v[36:39], a[8:11], a[104:107], v[36:39]
    ds_read_b64_tr_b16 a[52:53], v25 offset:43136
    ds_read_b64_tr_b16 a[54:55], v25 offset:43648
    s_waitcnt lgkmcnt(12)
    v_mfma_f32_16x16x32_bf16 v[40:43], a[12:15], a[104:107], v[40:43]
    ds_read_b64_tr_b16 a[56:57], v26 offset:43136
    ds_read_b64_tr_b16 a[58:59], v26 offset:43648
    s_waitcnt lgkmcnt(12)
    v_mfma_f32_16x16x32_bf16 v[44:47], a[16:19], a[104:107], v[44:47]
    ds_read_b64_tr_b16 a[60:61], v27 offset:43136
    ds_read_b64_tr_b16 a[62:63], v27 offset:43648
    s_waitcnt lgkmcnt(12)
    v_mfma_f32_16x16x32_bf16 v[48:51], a[20:23], a[104:107], v[48:51]
    ds_read_b64_tr_b16 a[64:65], v24 offset:51328
    ds_read_b64_tr_b16 a[66:67], v24 offset:51840
    s_waitcnt lgkmcnt(12)
    v_mfma_f32_16x16x32_bf16 v[52:55], a[24:27], a[104:107], v[52:55]
    ds_read_b64_tr_b16 a[68:69], v25 offset:51328
    ds_read_b64_tr_b16 a[70:71], v25 offset:51840
    s_waitcnt lgkmcnt(12)
    v_mfma_f32_16x16x32_bf16 v[56:59], a[28:31], a[104:107], v[56:59]
    ds_read_b64_tr_b16 a[72:73], v26 offset:51328
    ds_read_b64_tr_b16 a[74:75], v26 offset:51840
    s_waitcnt lgkmcnt(12)
    v_mfma_f32_16x16x32_bf16 v[28:31], a[48:51], a[108:111], v[28:31]
    ds_read_b64_tr_b16 a[76:77], v27 offset:51328
    ds_read_b64_tr_b16 a[78:79], v27 offset:51840
    s_waitcnt lgkmcnt(12)
    v_mfma_f32_16x16x32_bf16 v[32:35], a[52:55], a[108:111], v[32:35]
    s_waitcnt lgkmcnt(10)
    v_mfma_f32_16x16x32_bf16 v[36:39], a[56:59], a[108:111], v[36:39]
    s_waitcnt lgkmcnt(8)
    v_mfma_f32_16x16x32_bf16 v[40:43], a[60:63], a[108:111], v[40:43]
    s_waitcnt lgkmcnt(6)
    v_mfma_f32_16x16x32_bf16 v[44:47], a[64:67], a[108:111], v[44:47]
    s_waitcnt lgkmcnt(4)
    v_mfma_f32_16x16x32_bf16 v[48:51], a[68:71], a[108:111], v[48:51]
    s_waitcnt lgkmcnt(2)
    v_mfma_f32_16x16x32_bf16 v[52:55], a[72:75], a[108:111], v[52:55]
    s_waitcnt lgkmcnt(0)
    v_mfma_f32_16x16x32_bf16 v[56:59], a[76:79], a[108:111], v[56:59]
    s_barrier
    ds_read_b128 a[112:115], v76 offset:0
    ds_read_b128 a[116:119], v77 offset:0
    ds_read_b64_tr_b16 a[0:1], v20 offset:0
    ds_read_b64_tr_b16 a[2:3], v20 offset:512
    ds_read_b64_tr_b16 a[4:5], v21 offset:0
    ds_read_b64_tr_b16 a[6:7], v21 offset:512
    ds_read_b64_tr_b16 a[8:9], v22 offset:0
    ds_read_b64_tr_b16 a[10:11], v22 offset:512
    ds_read_b64_tr_b16 a[12:13], v23 offset:0
    ds_read_b64_tr_b16 a[14:15], v23 offset:512
    ds_read_b64_tr_b16 a[16:17], v20 offset:8192
    ds_read_b64_tr_b16 a[18:19], v20 offset:8704
    ds_read_b64_tr_b16 a[20:21], v21 offset:8192
    ds_read_b64_tr_b16 a[22:23], v21 offset:8704
    ds_read_b64_tr_b16 a[24:25], v22 offset:8192
    ds_read_b64_tr_b16 a[26:27], v22 offset:8704
    s_waitcnt lgkmcnt(12)
    v_mfma_f32_16x16x32_bf16 v[28:31], a[0:3], a[112:115], v[28:31]
    ds_read_b64_tr_b16 a[28:29], v23 offset:8192
    ds_read_b64_tr_b16 a[30:31], v23 offset:8704
    s_waitcnt lgkmcnt(12)
    v_mfma_f32_16x16x32_bf16 v[32:35], a[4:7], a[112:115], v[32:35]
    ds_read_b64_tr_b16 a[48:49], v20 offset:4096
    ds_read_b64_tr_b16 a[50:51], v20 offset:4608
    s_waitcnt lgkmcnt(12)
    v_mfma_f32_16x16x32_bf16 v[36:39], a[8:11], a[112:115], v[36:39]
    ds_read_b64_tr_b16 a[52:53], v21 offset:4096
    ds_read_b64_tr_b16 a[54:55], v21 offset:4608
    s_waitcnt lgkmcnt(12)
    v_mfma_f32_16x16x32_bf16 v[40:43], a[12:15], a[112:115], v[40:43]
    ds_read_b64_tr_b16 a[56:57], v22 offset:4096
    ds_read_b64_tr_b16 a[58:59], v22 offset:4608
    s_waitcnt lgkmcnt(12)
    v_mfma_f32_16x16x32_bf16 v[44:47], a[16:19], a[112:115], v[44:47]
    ds_read_b64_tr_b16 a[60:61], v23 offset:4096
    ds_read_b64_tr_b16 a[62:63], v23 offset:4608
    s_waitcnt lgkmcnt(12)
    v_mfma_f32_16x16x32_bf16 v[48:51], a[20:23], a[112:115], v[48:51]
    ds_read_b64_tr_b16 a[64:65], v20 offset:12288
    ds_read_b64_tr_b16 a[66:67], v20 offset:12800
    s_waitcnt lgkmcnt(12)
    v_mfma_f32_16x16x32_bf16 v[52:55], a[24:27], a[112:115], v[52:55]
    ds_read_b64_tr_b16 a[68:69], v21 offset:12288
    ds_read_b64_tr_b16 a[70:71], v21 offset:12800
    s_waitcnt lgkmcnt(12)
    v_mfma_f32_16x16x32_bf16 v[56:59], a[28:31], a[112:115], v[56:59]
    ds_read_b64_tr_b16 a[72:73], v22 offset:12288
    ds_read_b64_tr_b16 a[74:75], v22 offset:12800
    s_waitcnt lgkmcnt(12)
    v_mfma_f32_16x16x32_bf16 v[28:31], a[48:51], a[116:119], v[28:31]
    ds_read_b64_tr_b16 a[76:77], v23 offset:12288
    ds_read_b64_tr_b16 a[78:79], v23 offset:12800
    s_waitcnt lgkmcnt(12)
    v_mfma_f32_16x16x32_bf16 v[32:35], a[52:55], a[116:119], v[32:35]
    s_waitcnt lgkmcnt(10)
    v_mfma_f32_16x16x32_bf16 v[36:39], a[56:59], a[116:119], v[36:39]
    s_waitcnt vmcnt(0)
Lst_chk:
    v_cmp_ne_u32 vcc, s34, v93
    v_cmp_ne_u32 s[36:37], s34, v95
    s_nop 0
    s_or_b64 s[36:37], s[36:37], vcc
    s_cbranch_scc1 Lst_re
    v_lshlrev_b32 v93, 16, v92
    s_waitcnt lgkmcnt(8)
    v_mfma_f32_16x16x32_bf16 v[40:43], a[60:63], a[116:119], v[40:43]
    v_and_b32 v92, 0xffff0000, v92
    v_rcp_f32 v93, v93
    s_waitcnt lgkmcnt(6)
    v_mfma_f32_16x16x32_bf16 v[44:47], a[64:67], a[116:119], v[44:47]
    v_lshlrev_b32 v95, 16, v94
    v_and_b32 v94, 0xffff0000, v94
    s_waitcnt lgkmcnt(4)
    v_mfma_f32_16x16x32_bf16 v[48:51], a[68:71], a[116:119], v[48:51]
    v_rcp_f32 v95, v95
    ds_write2st64_b32 v4, v92, v93 offset0:0 offset1:2
    s_waitcnt lgkmcnt(3)
    v_mfma_f32_16x16x32_bf16 v[52:55], a[72:75], a[116:119], v[52:55]
    ds_write2st64_b32 v5, v94, v95 offset0:0 offset1:2
    ds_read_b32 v120, v11
    s_waitcnt lgkmcnt(3)
    v_mfma_f32_16x16x32_bf16 v[56:59], a[76:79], a[116:119], v[56:59]
    s_waitcnt lgkmcnt(0)
    s_barrier
    ds_read_b128 a[120:123], v76 offset:39040
    ds_read_b128 a[124:127], v77 offset:39040
    ds_read_b64_tr_b16 a[0:1], v20 offset:39040
    ds_read_b64_tr_b16 a[2:3], v20 offset:39552
    ds_read_b64_tr_b16 a[4:5], v21 offset:39040
    ds_read_b64_tr_b16 a[6:7], v21 offset:39552
    ds_read_b64_tr_b16 a[8:9], v22 offset:39040
    ds_read_b64_tr_b16 a[10:11], v22 offset:39552
    ds_read_b64_tr_b16 a[12:13], v23 offset:39040
    ds_read_b64_tr_b16 a[14:15], v23 offset:39552
    ds_read_b64_tr_b16 a[16:17], v20 offset:47232
    ds_read_b64_tr_b16 a[18:19], v20 offset:47744
    ds_read_b64_tr_b16 a[20:21], v21 offset:47232
    ds_read_b64_tr_b16 a[22:23], v21 offset:47744
    ds_read_b64_tr_b16 a[24:25], v22 offset:47232
    ds_read_b64_tr_b16 a[26:27], v22 offset:47744
    s_waitcnt lgkmcnt(12)
    v_mfma_f32_16x16x32_bf16 v[28:31], a[0:3], a[120:123], v[28:31]
    ds_read_b64_tr_b16 a[28:29], v23 offset:47232
    ds_read_b64_tr_b16 a[30:31], v23 offset:47744
    s_waitcnt lgkmcnt(12)
    v_mfma_f32_16x16x32_bf16 v[32:35], a[4:7], a[120:123], v[32:35]
    ds_read_b64_tr_b16 a[48:49], v20 offset:43136
    ds_read_b64_tr_b16 a[50:51], v20 offset:43648
    s_waitcnt lgkmcnt(12)
    v_mfma_f32_16x16x32_bf16 v[36:39], a[8:11], a[120:123], v[36:39]
    ds_read_b64_tr_b16 a[52:53], v21 offset:43136
    ds_read_b64_tr_b16 a[54:55], v21 offset:43648
    s_waitcnt lgkmcnt(12)
    v_mfma_f32_16x16x32_bf16 v[40:43], a[12:15], a[120:123], v[40:43]
    ds_read_b64_tr_b16 a[56:57], v22 offset:43136
    ds_read_b64_tr_b16 a[58:59], v22 offset:43648
    s_waitcnt lgkmcnt(12)
    v_mfma_f32_16x16x32_bf16 v[44:47], a[16:19], a[120:123], v[44:47]
    ds_read_b64_tr_b16 a[60:61], v23 offset:43136
    ds_read_b64_tr_b16 a[62:63], v23 offset:43648
    s_waitcnt lgkmcnt(12)
    v_mfma_f32_16x16x32_bf16 v[48:51], a[20:23], a[120:123], v[48:51]
    ds_read_b64_tr_b16 a[64:65], v20 offset:51328
    ds_read_b64_tr_b16 a[66:67], v20 offset:51840
    s_waitcnt lgkmcnt(12)
    v_mfma_f32_16x16x32_bf16 v[52:55], a[24:27], a[120:123], v[52:55]
    ds_read_b64_tr_b16 a[68:69], v21 offset:51328
    ds_read_b64_tr_b16 a[70:71], v21 offset:51840
    s_waitcnt lgkmcnt(12)
    v_mfma_f32_16x16x32_bf16 v[56:59], a[28:31], a[120:123], v[56:59]
    ds_read_b64_tr_b16 a[72:73], v22 offset:51328
    ds_read_b64_tr_b16 a[74:75], v22 offset:51840
    s_waitcnt lgkmcnt(12)
    v_mfma_f32_16x16x32_bf16 v[28:31], a[48:51], a[124:127], v[28:31]
    ds_read_b64_tr_b16 a[76:77], v23 offset:51328
    ds_read_b64_tr_b16 a[78:79], v23 offset:51840
    s_waitcnt lgkmcnt(12)
    v_mfma_f32_16x16x32_bf16 v[32:35], a[52:55], a[124:127], v[32:35]
    s_waitcnt lgkmcnt(10)
    v_mfma_f32_16x16x32_bf16 v[36:39], a[56:59], a[124:127], v[36:39]
    s_waitcnt lgkmcnt(8)
    v_mfma_f32_16x16x32_bf16 v[40:43], a[60:63], a[124:127], v[40:43]
    s_waitcnt lgkmcnt(6)
    v_mfma_f32_16x16x32_bf16 v[44:47], a[64:67], a[124:127], v[44:47]
    s_waitcnt lgkmcnt(4)
    v_mfma_f32_16x16x32_bf16 v[48:51], a[68:71], a[124:127], v[48:51]
    s_waitcnt lgkmcnt(2)
    v_mfma_f32_16x16x32_bf16 v[52:55], a[72:75], a[124:127], v[52:55]
    s_waitcnt lgkmcnt(0)
    v_mfma_f32_16x16x32_bf16 v[56:59], a[76:79], a[124:127], v[56:59]
    s_mov_b32 exec_lo, 0x00010001
    s_mov_b32 exec_hi, 0x00010001
    ds_write_b128 v6, v[28:31] offset:0
    ds_write_b128 v6, v[32:35] offset:64
    ds_write_b128 v6, v[36:39] offset:128
    ds_write_b128 v6, v[40:43] offset:192
    ds_write_b128 v6, v[44:47] offset:256
    ds_write_b128 v6, v[48:51] offset:320
    ds_write_b128 v6, v[52:55] offset:384
    ds_write_b128 v6, v[56:59] offset:448
    ds_write_b32 v7, v7
    s_mov_b64 exec, -1
    ds_read_b128 v[76:79], v6 offset:256
    ds_read_b128 v[80:83], v6 offset:320
    ds_read_b128 v[84:87], v6 offset:384
    ds_read_b128 v[88:91], v6 offset:448
    s_waitcnt lgkmcnt(0)
    v_fmac_f32 v44, v76, v120
    v_fmac_f32 v45, v77, v120
    v_fmac_f32 v46, v78, v120
    v_fmac_f32 v47, v79, v120
    v_cvt_pk_bf16_f32 v44, v44, v45
    v_cvt_pk_bf16_f32 v45, v46, v47
    v_fmac_f32 v48, v80, v120
    v_fmac_f32 v49, v81, v120
    v_fmac_f32 v50, v82, v120
    v_fmac_f32 v51, v83, v120
    v_cvt_pk_bf16_f32 v46, v48, v49
    v_cvt_pk_bf16_f32 v47, v50, v51
    v_fmac_f32 v52, v84, v120
    v_fmac_f32 v53, v85, v120
    v_fmac_f32 v54, v86, v120
    v_fmac_f32 v55, v87, v120
    v_cvt_pk_bf16_f32 v48, v52, v53
    v_cvt_pk_bf16_f32 v49, v54, v55
    v_fmac_f32 v56, v88, v120
    v_fmac_f32 v57, v89, v120
    v_fmac_f32 v58, v90, v120
    v_fmac_f32 v59, v91, v120
    v_cvt_pk_bf16_f32 v50, v56, v57
    v_cvt_pk_bf16_f32 v51, v58, v59
    ds_write_b128 v125, v[44:47] offset:4096
    ds_write_b128 v125, v[48:51] offset:5120
    v_mov_b32 v5, 157972
    v_mov_b32 v6, 1
    s_mov_b64 exec, 1
    ds_add_u32 v5, v6
    s_mov_b64 exec, -1
    v_mov_b32 v5, 157980
Lcw_5:
    s_sub_u32 s35, s35, 1
    s_cbranch_scc1 Lend
    ds_read_b32 v6, v5
    s_waitcnt lgkmcnt(0)
    v_readfirstlane_b32 s38, v6
    s_nop 0
    s_cmp_lt_u32 s38, 1
    s_cbranch_scc1 Lcw_5
    ds_read_b64_tr_b16 a[0:1], v24 offset:16384
    ds_read_b64_tr_b16 a[2:3], v24 offset:16896
    ds_read_b64_tr_b16 a[4:5], v25 offset:16384
    ds_read_b64_tr_b16 a[6:7], v25 offset:16896
    ds_read_b64_tr_b16 a[8:9], v26 offset:16384
    ds_read_b64_tr_b16 a[10:11], v26 offset:16896
    ds_read_b64_tr_b16 a[12:13], v27 offset:16384
    ds_read_b64_tr_b16 a[14:15], v27 offset:16896
    ds_read_b64_tr_b16 a[16:17], v24 offset:20480
    ds_read_b64_tr_b16 a[18:19], v24 offset:20992
    ds_read_b64_tr_b16 a[20:21], v25 offset:20480
    ds_read_b64_tr_b16 a[22:23], v25 offset:20992
    ds_read_b64_tr_b16 a[24:25], v26 offset:20480
    ds_read_b64_tr_b16 a[26:27], v26 offset:20992
    ds_read_b64_tr_b16 a[28:29], v27 offset:20480
    ds_read_b64_tr_b16 a[30:31], v27 offset:20992
    ds_read_b64_tr_b16 a[32:33], v24 offset:55424
    ds_read_b64_tr_b16 a[34:35], v24 offset:55936
    ds_read_b64_tr_b16 a[36:37], v25 offset:55424
    ds_read_b64_tr_b16 a[38:39], v25 offset:55936
    ds_read_b64_tr_b16 a[40:41], v26 offset:55424
    ds_read_b64_tr_b16 a[42:43], v26 offset:55936
    ds_read_b64_tr_b16 a[44:45], v27 offset:55424
    ds_read_b64_tr_b16 a[46:47], v27 offset:55936
    ds_read_b64_tr_b16 a[48:49], v24 offset:59520
    ds_read_b64_tr_b16 a[50:51], v24 offset:60032
    ds_read_b64_tr_b16 a[52:53], v25 offset:59520
    ds_read_b64_tr_b16 a[54:55], v25 offset:60032
    ds_read_b64_tr_b16 a[56:57], v26 offset:59520
    ds_read_b64_tr_b16 a[58:59], v26 offset:60032
    ds_read_b64_tr_b16 a[60:61], v27 offset:59520
    ds_read_b64_tr_b16 a[62:63], v27 offset:60032
    ds_read_b64_tr_b16 a[64:65], v20 offset:16384
    ds_read_b64_tr_b16 a[66:67], v20 offset:16896
    ds_read_b64_tr_b16 a[68:69], v21 offset:16384
    ds_read_b64_tr_b16 a[70:71], v21 offset:16896
    ds_read_b64_tr_b16 a[72:73], v22 offset:16384
    ds_read_b64_tr_b16 a[74:75], v22 offset:16896
    ds_read_b64_tr_b16 a[76:77], v23 offset:16384
    ds_read_b64_tr_b16 a[78:79], v23 offset:16896
    ds_read_b64_tr_b16 a[80:81], v20 offset:20480
    ds_read_b64_tr_b16 a[82:83], v20 offset:20992
    ds_read_b64_tr_b16 a[84:85], v21 offset:20480
    ds_read_b64_tr_b16 a[86:87], v21 offset:20992
    ds_read_b64_tr_b16 a[88:89], v22 offset:20480
    ds_read_b64_tr_b16 a[90:91], v22 offset:20992
    ds_read_b64_tr_b16 a[92:93], v23 offset:20480
    ds_read_b64_tr_b16 a[94:95], v23 offset:20992
    s_waitcnt lgkmcnt(15)
    v_mfma_f32_16x16x32_bf16 v[60:63], a[96:99], a[0:3], v[60:63]
    v_mfma_f32_16x16x32_bf16 v[64:67], a[96:99], a[4:7], v[64:67]
    v_mfma_f32_16x16x32_bf16 v[68:71], a[96:99], a[8:11], v[68:71]
    v_mfma_f32_16x16x32_bf16 v[72:75], a[96:99], a[12:15], v[72:75]
    ds_read_b64_tr_b16 a[0:1], v20 offset:55424
    ds_read_b64_tr_b16 a[2:3], v20 offset:55936
    ds_read_b64_tr_b16 a[4:5], v21 offset:55424
    ds_read_b64_tr_b16 a[6:7], v21 offset:55936
    ds_read_b64_tr_b16 a[8:9], v22 offset:55424
    ds_read_b64_tr_b16 a[10:11], v22 offset:55936
    ds_read_b64_tr_b16 a[12:13], v23 offset:55424
    ds_read_b64_tr_b16 a[14:15], v23 offset:55936
    v_mfma_f32_16x16x32_bf16 v[60:63], a[100:103], a[16:19], v[60:63]
    v_mfma_f32_16x16x32_bf16 v[64:67], a[100:103], a[20:23], v[64:67]
    v_mfma_f32_16x16x32_bf16 v[68:71], a[100:103], a[24:27], v[68:71]
    v_mfma_f32_16x16x32_bf16 v[72:75], a[100:103], a[28:31], v[72:75]
    ds_read_b64_tr_b16 a[16:17], v20 offset:59520
    ds_read_b64_tr_b16 a[18:19], v20 offset:60032
    ds_read_b64_tr_b16 a[20:21], v21 offset:59520
    ds_read_b64_tr_b16 a[22:23], v21 offset:60032
    ds_read_b64_tr_b16 a[24:25], v22 offset:59520
    ds_read_b64_tr_b16 a[26:27], v22 offset:60032
    ds_read_b64_tr_b16 a[28:29], v23 offset:59520
    ds_read_b64_tr_b16 a[30:31], v23 offset:60032
    v_mfma_f32_16x16x32_bf16 v[60:63], a[104:107], a[32:35], v[60:63]
    v_mfma_f32_16x16x32_bf16 v[64:67], a[104:107], a[36:39], v[64:67]
    v_mfma_f32_16x16x32_bf16 v[68:71], a[104:107], a[40:43], v[68:71]
    v_mfma_f32_16x16x32_bf16 v[72:75], a[104:107], a[44:47], v[72:75]
    v_mfma_f32_16x16x32_bf16 v[60:63], a[108:111], a[48:51], v[60:63]
    v_mfma_f32_16x16x32_bf16 v[64:67], a[108:111], a[52:55], v[64:67]
    v_mfma_f32_16x16x32_bf16 v[68:71], a[108:111], a[56:59], v[68:71]
    v_mfma_f32_16x16x32_bf16 v[72:75], a[108:111], a[60:63], v[72:75]
    s_waitcnt lgkmcnt(15)
    v_mfma_f32_16x16x32_bf16 v[60:63], a[112:115], a[64:67], v[60:63]
    v_mfma_f32_16x16x32_bf16 v[64:67], a[112:115], a[68:71], v[64:67]
    v_mfma_f32_16x16x32_bf16 v[68:71], a[112:115], a[72:75], v[68:71]
    v_mfma_f32_16x16x32_bf16 v[72:75], a[112:115], a[76:79], v[72:75]
    v_mfma_f32_16x16x32_bf16 v[60:63], a[116:119], a[80:83], v[60:63]
    v_mfma_f32_16x16x32_bf16 v[64:67], a[116:119], a[84:87], v[64:67]
    v_mfma_f32_16x16x32_bf16 v[68:71], a[116:119], a[88:91], v[68:71]
    v_mfma_f32_16x16x32_bf16 v[72:75], a[116:119], a[92:95], v[72:75]
    s_waitcnt lgkmcnt(8)
    v_mfma_f32_16x16x32_bf16 v[60:63], a[120:123], a[0:3], v[60:63]
    v_mfma_f32_16x16x32_bf16 v[64:67], a[120:123], a[4:7], v[64:67]
    v_mfma_f32_16x16x32_bf16 v[68:71], a[120:123], a[8:11], v[68:71]
    v_mfma_f32_16x16x32_bf16 v[72:75], a[120:123], a[12:15], v[72:75]
    s_waitcnt lgkmcnt(0)
    v_mfma_f32_16x16x32_bf16 v[60:63], a[124:127], a[16:19], v[60:63]
    v_mfma_f32_16x16x32_bf16 v[64:67], a[124:127], a[20:23], v[64:67]
    v_mfma_f32_16x16x32_bf16 v[68:71], a[124:127], a[24:27], v[68:71]
    v_mfma_f32_16x16x32_bf16 v[72:75], a[124:127], a[28:31], v[72:75]
    v_lshlrev_b32 v5, 4, v3
    v_add_u32 v5, 157696, v5
    v_mov_b32 v6, 157952
    v_lshlrev_b32 v4, 4, v2
    v_add_u32 v4, 156224, v4
    v_lshl_add_u32 v125, v1, 3, s48
    s_mov_b64 exec, 0xffff
    ds_write_b32 v5, v60 offset:0
    ds_write_b32 v5, v64 offset:4
    ds_write_b32 v5, v68 offset:8
    ds_write_b32 v5, v72 offset:12
    ds_write_b32 v6, v6
    s_mov_b64 exec, -1
    ds_read_b128 v[36:39], v5
    ds_read_b128 v[28:31], v4
    ds_read_b128 v[32:35], v4 offset:512
    s_waitcnt lgkmcnt(0)
    v_fmac_f32 v60, v28, v36
    v_fmac_f32 v61, v29, v36
    v_fmac_f32 v62, v30, v36
    v_fmac_f32 v63, v31, v36
    v_mul_f32 v60, v60, v32
    v_mul_f32 v61, v61, v33
    v_mul_f32 v62, v62, v34
    v_mul_f32 v63, v63, v35
    v_cvt_pk_bf16_f32 v60, v60, v61
    v_cvt_pk_bf16_f32 v61, v62, v63
    ds_write_b64 v125, v[60:61] offset:0
    v_fmac_f32 v64, v28, v37
    v_fmac_f32 v65, v29, v37
    v_fmac_f32 v66, v30, v37
    v_fmac_f32 v67, v31, v37
    v_mul_f32 v64, v64, v32
    v_mul_f32 v65, v65, v33
    v_mul_f32 v66, v66, v34
    v_mul_f32 v67, v67, v35
    v_cvt_pk_bf16_f32 v64, v64, v65
    v_cvt_pk_bf16_f32 v65, v66, v67
    ds_write_b64 v125, v[64:65] offset:512
    v_fmac_f32 v68, v28, v38
    v_fmac_f32 v69, v29, v38
    v_fmac_f32 v70, v30, v38
    v_fmac_f32 v71, v31, v38
    v_mul_f32 v68, v68, v32
    v_mul_f32 v69, v69, v33
    v_mul_f32 v70, v70, v34
    v_mul_f32 v71, v71, v35
    v_cvt_pk_bf16_f32 v68, v68, v69
    v_cvt_pk_bf16_f32 v69, v70, v71
    ds_write_b64 v125, v[68:69] offset:1024
    v_fmac_f32 v72, v28, v39
    v_fmac_f32 v73, v29, v39
    v_fmac_f32 v74, v30, v39
    v_fmac_f32 v75, v31, v39
    v_mul_f32 v72, v72, v32
    v_mul_f32 v73, v73, v33
    v_mul_f32 v74, v74, v34
    v_mul_f32 v75, v75, v35
    v_cvt_pk_bf16_f32 v72, v72, v73
    v_cvt_pk_bf16_f32 v73, v74, v75
    ds_write_b64 v125, v[72:73] offset:1536
    v_mov_b32 v8, 157976
    v_mov_b32 v9, 1
    s_mov_b64 exec, 1
    ds_add_u32 v8, v9
    s_mov_b64 exec, -1
    s_endpgm
Lst_re:
    s_sub_u32 s35, s35, 1
    s_cbranch_scc1 Lend
    buffer_load_dwordx2 v[92:93], v96, s[28:31], s49 offen sc1
    buffer_load_dwordx2 v[94:95], v97, s[28:31], s49 offen sc1
    s_waitcnt vmcnt(0)
    s_branch Lst_chk
Laux:
    s_lshl_b32 s32, s37, 3
    s_lshl_b32 s39, s38, 2
    s_add_u32 s32, s32, s36
    s_cmp_lt_u32 s37, 4
    s_cselect_b32 s39, s39, 0
    s_add_u32 s32, s32, s39
    s_and_b32 s33, s2, 3
    s_lshl_b32 s33, s33, 3
    s_and_b32 s39, s2, 4
    s_add_u32 s33, s33, s39
    s_add_u32 s33, s33, s37
    s_cmp_ge_u32 s32, 32
    s_cbranch_scc1 Lmst
    v_lshrrev_b32 v5, 3, v1
    v_and_b32 v6, 7, v1
    s_lshl_b32 s40, s3, 14
    s_cmp_eq_u32 s27, 0
    s_cbranch_scc0 Laux_u
    s_lshl_b32 s36, s33, 6
    s_lshl_b32 s37, s26, 4
    s_add_u32 s36, s36, s37
    v_add_u32 v7, s36, v5
    v_mul_u32_u24 v7, 1280, v7
    v_xor_b32 v8, v6, v2
    v_lshl_add_u32 v92, v8, 4, v7
    v_add_u32 v92, 4096, v92
    v_xor_b32 v93, 64, v92
    v_add_u32 v93, 9216, v93
    v_subrev_u32 v94, 1920, v92
    v_subrev_u32 v95, 1920, v93
    s_waitcnt lgkmcnt(0)
    s_sub_u32 s52, s4, 4096
    s_subb_u32 s53, s5, 0
    s_mov_b32 s54, 2625536
    s_mov_b32 s55, 0x20000
    s_mov_b64 s[60:61], s[12:13]
    s_mov_b32 s62, 1280
    s_mov_b32 s63, 0x20000
    s_mov_b32 m0, 131072
    s_nop 0
    buffer_load_dwordx4 v13, s[60:63], 0 offen lds
    s_mov_b64 exec, 0xffff
    buffer_load_dwordx4 v13, s[60:63], 0 offen offset:1024 lds
    s_mov_b64 exec, -1
    s_add_u32 m0, s40, 0
    s_mov_b32 s41, 0
    buffer_load_dwordx4 v92, s[52:55], s41 offen lds
    buffer_load_dwordx4 v93, s[52:55], s41 offen offset:1024 lds
    buffer_load_dwordx4 v94, s[52:55], s41 offen offset:2048 lds
    buffer_load_dwordx4 v95, s[52:55], s41 offen offset:3072 lds
    s_add_u32 m0, s40, 4096
    s_mov_b32 s41, 256
    buffer_load_dwordx4 v92, s[52:55], s41 offen lds
    buffer_load_dwordx4 v93, s[52:55], s41 offen offset:1024 lds
    buffer_load_dwordx4 v94, s[52:55], s41 offen offset:2048 lds
    buffer_load_dwordx4 v95, s[52:55], s41 offen offset:3072 lds
    s_add_u32 m0, s40, 8192
    s_mov_b32 s41, 512
    buffer_load_dwordx4 v92, s[52:55], s41 offen lds
    buffer_load_dwordx4 v93, s[52:55], s41 offen offset:1024 lds
    buffer_load_dwordx4 v94, s[52:55], s41 offen offset:2048 lds
    buffer_load_dwordx4 v95, s[52:55], s41 offen offset:3072 lds
    s_add_u32 m0, s40, 12288
    s_mov_b32 s41, 768
    buffer_load_dwordx4 v92, s[52:55], s41 offen lds
    buffer_load_dwordx4 v93, s[52:55], s41 offen offset:1024 lds
    buffer_load_dwordx4 v94, s[52:55], s41 offen offset:2048 lds
    buffer_load_dwordx4 v95, s[52:55], s41 offen offset:3072 lds
    s_mov_b64 s[28:29], s[24:25]
    s_mov_b32 s30, 268435456
    s_mov_b32 s31, 0x20000
    s_load_dword s34, s[28:29], 0
    s_mov_b64 s[44:45], s[14:15]
    s_mov_b32 s46, 2211840
    s_mov_b32 s47, 0x20000
    s_mov_b64 s[48:49], s[18:19]
    s_mov_b32 s50, 2211840
    s_mov_b32 s51, 0x20000
    v_and_b32 v8, 1, v2
    v_lshlrev_b32 v8, 1, v8
    v_xor_b32 v8, v8, v6
    v_lshlrev_b32 v8, 4, v8
    v_mul_u32_u24 v9, 3456, v5
    s_lshl_b32 s38, s32, 7
    v_add3_u32 v18, v9, v8, s38
    v_xor_b32 v19, 64, v18
    v_add_u32 v19, 26624, v19
    v_add_u32 v20, 53248, v18
    v_add_u32 v21, 53248, v19
    s_mul_i32 s42, s26, 110592
    v_mul_u32_u24 v9, 1280, v5
    v_add_u32 v22, v9, v8
    v_xor_b32 v23, 64, v22
    v_add_u32 v23, 9216, v23
    v_add_u32 v24, 18432, v22
    v_add_u32 v25, 18432, v23
    s_mul_i32 s43, s32, 81920
    s_lshl_b32 s38, s3, 7
    s_add_u32 s43, s43, s38
    v_mov_b32 v96, 0x3f803f80
    v_mov_b32 v97, 0x3f803f80
    v_mov_b32 v98, 0x3f803f80
    v_mov_b32 v99, 0x3f803f80
    v_lshlrev_b32 v100, 4, v2
    v_add_u32 v100, 131072, v100
    v_lshrrev_b32 v10, 1, v3
    v_xor_b32 v10, v10, v2
    v_lshlrev_b32 v10, 4, v10
    v_lshl_add_u32 v10, v3, 7, v10
    v_add_u32 v102, s40, v10
    v_xor_b32 v103, 64, v102
    s_mov_b32 s58, 0xaaaaaaaa
    s_mov_b32 s59, 0xaaaaaaaa
    s_mov_b32 s64, 0xcccccccc
    s_mov_b32 s65, 0xcccccccc
    v_lshrrev_b32 v101, 2, v3
    v_lshl_add_u32 v101, v101, 4, v3
    v_lshlrev_b32 v101, 2, v101
    s_lshl_b32 s36, s26, 4
    v_add_u32 v10, s36, v3
    s_lshl_b32 s37, s33, 6
    s_sub_u32 s37, 2047, s37
    v_sub_u32 v106, s37, v10
    v_lshlrev_b32 v107, 2, v10
    v_add_u32 v107, 132608, v107
    s_lshl_b32 s36, s33, 9
    s_add_u32 s36, s36, 8192000
    v_lshl_add_u32 v108, v10, 3, s36
    v_bfe_u32 v10, v1, 2, 2
    v_and_b32 v8, 3, v1
    v_lshl_add_u32 v14, v2, 3, v10
    v_lshlrev_b32 v14, 7, v14
    v_lshlrev_b32 v9, 2, v1
    v_and_b32 v9, 0x60, v9
    v_add3_u32 v14, v14, v9, s40
    v_lshl_add_u32 v14, v8, 3, v14
    v_xor_b32 v15, 32, v14
    v_xor_b32 v16, 64, v14
    v_xor_b32 v17, 96, v14
    s_lshl_b32 s36, s26, 6
    s_add_u32 s36, s36, 141312
    v_lshl_add_u32 v26, v2, 4, s36
    v_min_u32 v8, 2, v3
    v_mul_u32_u24 v8, 1536, v8
    v_add_u32 v26, v26, v8
    v_add_u32 v4, 132864, v12
    v_mov_b32 v5, 0
    ds_write_b32 v4, v5
    s_waitcnt lgkmcnt(0)
    s_add_u32 s34, s34, 0x9e3779b8
    s_or_b32 s34, s34, 1
    s_waitcnt vmcnt(12)
    ds_read_b128 a[80:83], v102 offset:0
    ds_read_b128 a[84:87], v100 offset:0
    ds_read_b128 a[88:91], v103 offset:0
    ds_read_b128 a[92:95], v100 offset:64
    ds_read_b128 a[96:99], v102 offset:2048
    ds_read_b128 a[100:103], v100 offset:128
    ds_read_b128 a[104:107], v103 offset:2048
    ds_read_b128 a[108:111], v100 offset:192
    s_waitcnt lgkmcnt(0)
    s_add_u32 m0, s40, 0
    s_mov_b32 s41, 1024
    buffer_load_dwordx4 v92, s[52:55], s41 offen lds
    buffer_load_dwordx4 v93, s[52:55], s41 offen offset:1024 lds
    buffer_load_dwordx4 v94, s[52:55], s41 offen offset:2048 lds
    buffer_load_dwordx4 v95, s[52:55], s41 offen offset:3072 lds
    s_barrier
    v_mfma_f32_16x16x32_bf16 v[116:119], a[80:83], a[80:83], 0
    v_mfma_f32_16x16x32_bf16 v[112:115], v[96:99], a[80:83], 0
    v_mfma_f32_16x16x32_bf16 v[120:123], a[84:87], a[80:83], 0
    v_mfma_f32_16x16x32_bf16 v[124:127], a[84:87], v[96:99], 0
    v_mfma_f32_16x16x32_bf16 v[116:119], a[88:91], a[88:91], v[116:119]
    v_mfma_f32_16x16x32_bf16 v[112:115], v[96:99], a[88:91], v[112:115]
    v_mfma_f32_16x16x32_bf16 v[120:123], a[92:95], a[88:91], v[120:123]
    v_mfma_f32_16x16x32_bf16 v[124:127], a[92:95], v[96:99], v[124:127]
    v_mfma_f32_16x16x32_bf16 v[116:119], a[96:99], a[96:99], v[116:119]
    v_mfma_f32_16x16x32_bf16 v[112:115], v[96:99], a[96:99], v[112:115]
    v_mfma_f32_16x16x32_bf16 v[120:123], a[100:103], a[96:99], v[120:123]
    v_mfma_f32_16x16x32_bf16 v[124:127], a[100:103], v[96:99], v[124:127]
    v_mfma_f32_16x16x32_bf16 v[116:119], a[104:107], a[104:107], v[116:119]
    v_mfma_f32_16x16x32_bf16 v[112:115], v[96:99], a[104:107], v[112:115]
    v_mfma_f32_16x16x32_bf16 v[120:123], a[108:111], a[104:107], v[120:123]
    v_mfma_f32_16x16x32_bf16 v[124:127], a[108:111], v[96:99], v[124:127]
    s_waitcnt vmcnt(12)
    ds_read_b128 a[80:83], v102 offset:4096
    ds_read_b128 a[84:87], v100 offset:256
    ds_read_b128 a[88:91], v103 offset:4096
    ds_read_b128 a[92:95], v100 offset:320
    ds_read_b128 a[96:99], v102 offset:6144
    ds_read_b128 a[100:103], v100 offset:384
    ds_read_b128 a[104:107], v103 offset:6144
    ds_read_b128 a[108:111], v100 offset:448
    s_waitcnt lgkmcnt(0)
    v_mfma_f32_16x16x32_bf16 v[116:119], a[80:83], a[80:83], v[116:119]
    v_mfma_f32_16x16x32_bf16 v[112:115], v[96:99], a[80:83], v[112:115]
    v_mfma_f32_16x16x32_bf16 v[120:123], a[84:87], a[80:83], v[120:123]
    v_mfma_f32_16x16x32_bf16 v[124:127], a[84:87], v[96:99], v[124:127]
    v_mfma_f32_16x16x32_bf16 v[116:119], a[88:91], a[88:91], v[116:119]
    v_mfma_f32_16x16x32_bf16 v[112:115], v[96:99], a[88:91], v[112:115]
    v_mfma_f32_16x16x32_bf16 v[120:123], a[92:95], a[88:91], v[120:123]
    v_mfma_f32_16x16x32_bf16 v[124:127], a[92:95], v[96:99], v[124:127]
    v_mfma_f32_16x16x32_bf16 v[116:119], a[96:99], a[96:99], v[116:119]
    v_mfma_f32_16x16x32_bf16 v[112:115], v[96:99], a[96:99], v[112:115]
    v_mfma_f32_16x16x32_bf16 v[120:123], a[100:103], a[96:99], v[120:123]
    v_mfma_f32_16x16x32_bf16 v[124:127], a[100:103], v[96:99], v[124:127]
    v_mfma_f32_16x16x32_bf16 v[116:119], a[104:107], a[104:107], v[116:119]
    v_mfma_f32_16x16x32_bf16 v[112:115], v[96:99], a[104:107], v[112:115]
    v_mfma_f32_16x16x32_bf16 v[120:123], a[108:111], a[104:107], v[120:123]
    v_mfma_f32_16x16x32_bf16 v[124:127], a[108:111], v[96:99], v[124:127]
    s_waitcnt vmcnt(8)
    ds_read_b128 a[80:83], v102 offset:8192
    ds_read_b128 a[84:87], v100 offset:512
    ds_read_b128 a[88:91], v103 offset:8192
    ds_read_b128 a[92:95], v100 offset:576
    ds_read_b128 a[96:99], v102 offset:10240
    ds_read_b128 a[100:103], v100 offset:640
    ds_read_b128 a[104:107], v103 offset:10240
    ds_read_b128 a[108:111], v100 offset:704
    s_waitcnt lgkmcnt(0)
    v_mfma_f32_16x16x32_bf16 v[116:119], a[80:83], a[80:83], v[116:119]
    v_mfma_f32_16x16x32_bf16 v[112:115], v[96:99], a[80:83], v[112:115]
    v_mfma_f32_16x16x32_bf16 v[120:123], a[84:87], a[80:83], v[120:123]
    v_mfma_f32_16x16x32_bf16 v[124:127], a[84:87], v[96:99], v[124:127]
    v_mfma_f32_16x16x32_bf16 v[116:119], a[88:91], a[88:91], v[116:119]
    v_mfma_f32_16x16x32_bf16 v[112:115], v[96:99], a[88:91], v[112:115]
    v_mfma_f32_16x16x32_bf16 v[120:123], a[92:95], a[88:91], v[120:123]
    v_mfma_f32_16x16x32_bf16 v[124:127], a[92:95], v[96:99], v[124:127]
    v_mfma_f32_16x16x32_bf16 v[116:119], a[96:99], a[96:99], v[116:119]
    v_mfma_f32_16x16x32_bf16 v[112:115], v[96:99], a[96:99], v[112:115]
    v_mfma_f32_16x16x32_bf16 v[120:123], a[100:103], a[96:99], v[120:123]
    v_mfma_f32_16x16x32_bf16 v[124:127], a[100:103], v[96:99], v[124:127]
    v_mfma_f32_16x16x32_bf16 v[116:119], a[104:107], a[104:107], v[116:119]
    v_mfma_f32_16x16x32_bf16 v[112:115], v[96:99], a[104:107], v[112:115]
    v_mfma_f32_16x16x32_bf16 v[120:123], a[108:111], a[104:107], v[120:123]
    v_mfma_f32_16x16x32_bf16 v[124:127], a[108:111], v[96:99], v[124:127]
    s_waitcnt vmcnt(4)
    ds_read_b128 a[80:83], v102 offset:12288
    ds_read_b128 a[84:87], v100 offset:768
    ds_read_b128 a[88:91], v103 offset:12288
    ds_read_b128 a[92:95], v100 offset:832
    ds_read_b128 a[96:99], v102 offset:14336
    ds_read_b128 a[100:103], v100 offset:896
    ds_read_b128 a[104:107], v103 offset:14336
    ds_read_b128 a[108:111], v100 offset:960
    s_waitcnt lgkmcnt(0)
    v_mfma_f32_16x16x32_bf16 v[116:119], a[80:83], a[80:83], v[116:119]
    v_mfma_f32_16x16x32_bf16 v[112:115], v[96:99], a[80:83], v[112:115]
    v_mfma_f32_16x16x32_bf16 v[120:123], a[84:87], a[80:83], v[120:123]
    v_mfma_f32_16x16x32_bf16 v[124:127], a[84:87], v[96:99], v[124:127]
    v_mfma_f32_16x16x32_bf16 v[116:119], a[88:91], a[88:91], v[116:119]
    v_mfma_f32_16x16x32_bf16 v[112:115], v[96:99], a[88:91], v[112:115]
    v_mfma_f32_16x16x32_bf16 v[120:123], a[92:95], a[88:91], v[120:123]
    v_mfma_f32_16x16x32_bf16 v[124:127], a[92:95], v[96:99], v[124:127]
    v_mfma_f32_16x16x32_bf16 v[116:119], a[96:99], a[96:99], v[116:119]
    v_mfma_f32_16x16x32_bf16 v[112:115], v[96:99], a[96:99], v[112:115]
    v_mfma_f32_16x16x32_bf16 v[120:123], a[100:103], a[96:99], v[120:123]
    v_mfma_f32_16x16x32_bf16 v[124:127], a[100:103], v[96:99], v[124:127]
    v_mfma_f32_16x16x32_bf16 v[116:119], a[104:107], a[104:107], v[116:119]
    v_mfma_f32_16x16x32_bf16 v[112:115], v[96:99], a[104:107], v[112:115]
    v_mfma_f32_16x16x32_bf16 v[120:123], a[108:111], a[104:107], v[120:123]
    v_mfma_f32_16x16x32_bf16 v[124:127], a[108:111], v[96:99], v[124:127]
    s_waitcnt vmcnt(0)
    ds_read_b128 a[80:83], v102 offset:0
    ds_read_b128 a[84:87], v100 offset:1024
    ds_read_b128 a[88:91], v103 offset:0
    ds_read_b128 a[92:95], v100 offset:1088
    ds_read_b128 a[96:99], v102 offset:2048
    ds_read_b128 a[100:103], v100 offset:1152
    ds_read_b128 a[104:107], v103 offset:2048
    ds_read_b128 a[108:111], v100 offset:1216
    s_waitcnt lgkmcnt(0)
    v_mfma_f32_16x16x32_bf16 v[116:119], a[80:83], a[80:83], v[116:119]
    v_mfma_f32_16x16x32_bf16 v[112:115], v[96:99], a[80:83], v[112:115]
    v_mfma_f32_16x16x32_bf16 v[120:123], a[84:87], a[80:83], v[120:123]
    v_mfma_f32_16x16x32_bf16 v[124:127], a[84:87], v[96:99], v[124:127]
    v_mfma_f32_16x16x32_bf16 v[116:119], a[88:91], a[88:91], v[116:119]
    v_mfma_f32_16x16x32_bf16 v[112:115], v[96:99], a[88:91], v[112:115]
    v_mfma_f32_16x16x32_bf16 v[120:123], a[92:95], a[88:91], v[120:123]
    v_mfma_f32_16x16x32_bf16 v[124:127], a[92:95], v[96:99], v[124:127]
    v_mfma_f32_16x16x32_bf16 v[116:119], a[96:99], a[96:99], v[116:119]
    v_mfma_f32_16x16x32_bf16 v[112:115], v[96:99], a[96:99], v[112:115]
    v_mfma_f32_16x16x32_bf16 v[120:123], a[100:103], a[96:99], v[120:123]
    v_mfma_f32_16x16x32_bf16 v[124:127], a[100:103], v[96:99], v[124:127]
    v_mfma_f32_16x16x32_bf16 v[116:119], a[104:107], a[104:107], v[116:119]
    v_mfma_f32_16x16x32_bf16 v[112:115], v[96:99], a[104:107], v[112:115]
    v_mfma_f32_16x16x32_bf16 v[120:123], a[108:111], a[104:107], v[120:123]
    v_mfma_f32_16x16x32_bf16 v[124:127], a[108:111], v[96:99], v[124:127]
    s_nop 4
    v_cndmask_b32 v4, v116, v117, s[58:59]
    v_cndmask_b32 v5, v118, v119, s[58:59]
    v_cndmask_b32 v4, v4, v5, s[64:65]
    ds_bpermute_b32 v4, v101, v4
    v_mul_f32 v5, 0xbacccccd, v112
    v_cvt_pk_bf16_f32 v104, v5, v5
    v_lshlrev_b32 v104, 16, v104
    v_mul_f32 v5, v5, v5
    v_mov_b32 v6, 0x3acccccd
    s_waitcnt lgkmcnt(0)
    v_fma_f32 v4, v4, v6, -v5
    v_max_f32 v4, 0, v4
    v_cvt_pk_bf16_f32 v4, v4, v4
    v_lshlrev_b32 v4, 16, v4
    v_add_f32 v4, 0x3727c5ac, v4
    v_cvt_pk_bf16_f32 v4, v4, v4
    v_lshlrev_b32 v4, 16, v4
    v_sqrt_f32 v4, v4
    s_nop 0
    v_cvt_pk_bf16_f32 v4, v4, v4
    v_lshlrev_b32 v4, 16, v4
    v_rcp_f32 v105, v4
    v_lshrrev_b32 v8, 16, v4
    v_fma_f32 v4, v104, v124, v120
    v_mul_f32 v4, v4, v105
    v_cvt_pk_bf16_f32 v4, v4, v4
    v_ashrrev_i32 v5, 31, v4
    v_or_b32 v5, 0x80000000, v5
    v_xor_b32 v4, v4, v5
    v_and_b32 v4, 0xffff0000, v4
    v_or_b32 v4, v4, v106
    ds_write_b32 v107, v4
    v_mov_b32 v11, 132864
    v_mov_b32 v7, 1
    s_mov_b64 exec, 1
    ds_add_u32 v11, v7
    s_mov_b64 exec, -1
    v_or_b32 v8, v8, v104
    v_mov_b32 v9, s34
    s_mov_b64 exec, 0xffff
    buffer_store_dwordx2 v[8:9], v108, s[28:31], 0 offen sc1
    s_mov_b64 exec, -1
    s_cmp_lg_u32 s26, 0
    s_cbranch_scc1 Lpub_done
    s_setprio 3
Lcw_9:
    s_sub_u32 s35, s35, 1
    s_cbranch_scc1 Lend
    ds_read_b32 v7, v11
    s_waitcnt lgkmcnt(0)
    v_readfirstlane_b32 s38, v7
    s_nop 0
    s_cmp_lt_u32 s38, 4
    s_cbranch_scc1 Lcw_9
    v_add_u32 v5, 132608, v12
    ds_read_b32 v6, v5
    s_waitcnt lgkmcnt(0)
    v_mov_b32 v4, v6
    s_nop 1
    v_max_u32_dpp v4, v4, v4 row_ror:8 row_mask:0xf bank_mask:0xf
    s_nop 1
    v_max_u32_dpp v4, v4, v4 row_ror:4 row_mask:0xf bank_mask:0xf
    s_nop 1
    v_max_u32_dpp v4, v4, v4 row_ror:2 row_mask:0xf bank_mask:0xf
    s_nop 1
    v_max_u32_dpp v4, v4, v4 row_ror:1 row_mask:0xf bank_mask:0xf
    s_nop 0
    v_readlane_b32 s66, v4, 0
    v_readlane_b32 s36, v4, 16
    v_readlane_b32 s37, v4, 32
    v_readlane_b32 s38, v4, 48
    s_max_u32 s66, s66, s36
    s_max_u32 s37, s37, s38
    s_max_u32 s66, s66, s37
    v_cmp_eq_u32 vcc, s66, v6
    s_nop 1
    v_cndmask_b32 v4, v6, 0, vcc
    s_nop 1
    v_max_u32_dpp v4, v4, v4 row_ror:8 row_mask:0xf bank_mask:0xf
    s_nop 1
    v_max_u32_dpp v4, v4, v4 row_ror:4 row_mask:0xf bank_mask:0xf
    s_nop 1
    v_max_u32_dpp v4, v4, v4 row_ror:2 row_mask:0xf bank_mask:0xf
    s_nop 1
    v_max_u32_dpp v4, v4, v4 row_ror:1 row_mask:0xf bank_mask:0xf
    s_nop 0
    v_readlane_b32 s67, v4, 0
    v_readlane_b32 s36, v4, 16
    v_readlane_b32 s37, v4, 32
    v_readlane_b32 s38, v4, 48
    s_max_u32 s67, s67, s36
    s_max_u32 s37, s37, s38
    s_max_u32 s67, s67, s37
    v_mov_b32 v112, s66
    v_mov_b32 v113, s34
    v_mov_b32 v114, s67
    v_mov_b32 v115, s34
    s_lshl_b32 s36, s32, 7
    s_add_u32 s36, s36, 8126464
    s_mov_b64 exec, 0xff
    buffer_store_dwordx4 v[112:115], v13, s[28:31], s36 offen sc1
    s_mov_b64 exec, -1
    v_mov_b32 v11, 132864
    v_mov_b32 v7, 1
    s_mov_b64 exec, 1
    ds_add_u32 v11, v7
    s_mov_b64 exec, -1
    s_mov_b64 exec, 1
    s_lshl_b32 s36, s2, 2
    s_add_u32 s36, s36, 8323072
    v_mov_b32 v4, s34
    v_mov_b32 v5, s36
    buffer_store_dword v4, v5, s[28:31], 0 offen sc1
    s_mov_b64 exec, -1
    s_setprio 0
Lpub_done:
Lcw_10:
    s_sub_u32 s35, s35, 1
    s_cbranch_scc1 Lend
    ds_read_b32 v7, v11
    s_waitcnt lgkmcnt(0)
    v_readfirstlane_b32 s38, v7
    s_nop 0
    s_cmp_lt_u32 s38, 5
    s_cbranch_scc1 Lcw_10
    s_cmp_ge_u32 s32, 27
    s_cbranch_scc1 Lhelp_r
    s_add_u32 m0, s40, 0
    s_add_u32 s41, s42, 0
    buffer_load_dwordx4 v18, s[44:47], s41 offen nt lds
    buffer_load_dwordx4 v19, s[44:47], s41 offen offset:1024 nt lds
    buffer_load_dwordx4 v20, s[44:47], s41 offen offset:2048 nt lds
    buffer_load_dwordx4 v21, s[44:47], s41 offen offset:3072 nt lds
    s_add_u32 m0, s40, 4096
    s_add_u32 s41, s42, 442368
    buffer_load_dwordx4 v18, s[44:47], s41 offen nt lds
    buffer_load_dwordx4 v19, s[44:47], s41 offen offset:1024 nt lds
    buffer_load_dwordx4 v20, s[44:47], s41 offen offset:2048 nt lds
    buffer_load_dwordx4 v21, s[44:47], s41 offen offset:3072 nt lds
    s_add_u32 m0, s40, 8192
    s_add_u32 s41, s42, 884736
    buffer_load_dwordx4 v18, s[44:47], s41 offen nt lds
    buffer_load_dwordx4 v19, s[44:47], s41 offen offset:1024 nt lds
    buffer_load_dwordx4 v20, s[44:47], s41 offen offset:2048 nt lds
    buffer_load_dwordx4 v21, s[44:47], s41 offen offset:3072 nt lds
    s_add_u32 m0, s40, 12288
    s_add_u32 s41, s42, 1327104
    buffer_load_dwordx4 v18, s[44:47], s41 offen nt lds
    buffer_load_dwordx4 v19, s[44:47], s41 offen offset:1024 nt lds
    buffer_load_dwordx4 v20, s[44:47], s41 offen offset:2048 nt lds
    buffer_load_dwordx4 v21, s[44:47], s41 offen offset:3072 nt lds
    s_waitcnt vmcnt(12)
    ds_read_b64_tr_b16 a[0:1], v14 offset:0
    ds_read_b64_tr_b16 a[2:3], v14 offset:512
    ds_read_b64_tr_b16 a[4:5], v15 offset:0
    ds_read_b64_tr_b16 a[6:7], v15 offset:512
    ds_read_b64_tr_b16 a[8:9], v16 offset:0
    ds_read_b64_tr_b16 a[10:11], v16 offset:512
    ds_read_b64_tr_b16 a[12:13], v17 offset:0
    ds_read_b64_tr_b16 a[14:15], v17 offset:512
    s_waitcnt lgkmcnt(0)
    s_add_u32 m0, s40, 0
    s_add_u32 s41, s42, 1769472
    buffer_load_dwordx4 v18, s[44:47], s41 offen nt lds
    buffer_load_dwordx4 v19, s[44:47], s41 offen offset:1024 nt lds
    buffer_load_dwordx4 v20, s[44:47], s41 offen offset:2048 nt lds
    buffer_load_dwordx4 v21, s[44:47], s41 offen offset:3072 nt lds
    v_mov_b32 v11, 132864
    v_mov_b32 v7, 1
    s_mov_b64 exec, 1
    ds_add_u32 v11, v7
    s_mov_b64 exec, -1
    s_waitcnt vmcnt(12)
    ds_read_b64_tr_b16 a[16:17], v14 offset:4096
    ds_read_b64_tr_b16 a[18:19], v14 offset:4608
    ds_read_b64_tr_b16 a[20:21], v15 offset:4096
    ds_read_b64_tr_b16 a[22:23], v15 offset:4608
    ds_read_b64_tr_b16 a[24:25], v16 offset:4096
    ds_read_b64_tr_b16 a[26:27], v16 offset:4608
    ds_read_b64_tr_b16 a[28:29], v17 offset:4096
    ds_read_b64_tr_b16 a[30:31], v17 offset:4608
    s_waitcnt lgkmcnt(0)
    s_add_u32 m0, s40, 4096
    s_add_u32 s41, s43, 0
    buffer_load_dwordx4 v22, s[48:51], s41 offen nt lds
    buffer_load_dwordx4 v23, s[48:51], s41 offen offset:1024 nt lds
    buffer_load_dwordx4 v24, s[48:51], s41 offen offset:2048 nt lds
    buffer_load_dwordx4 v25, s[48:51], s41 offen offset:3072 nt lds
    s_waitcnt vmcnt(12)
    ds_read_b64_tr_b16 a[32:33], v14 offset:8192
    ds_read_b64_tr_b16 a[34:35], v14 offset:8704
    ds_read_b64_tr_b16 a[36:37], v15 offset:8192
    ds_read_b64_tr_b16 a[38:39], v15 offset:8704
    ds_read_b64_tr_b16 a[40:41], v16 offset:8192
    ds_read_b64_tr_b16 a[42:43], v16 offset:8704
    ds_read_b64_tr_b16 a[44:45], v17 offset:8192
    ds_read_b64_tr_b16 a[46:47], v17 offset:8704
    s_waitcnt lgkmcnt(0)
    s_add_u32 m0, s40, 8192
    s_add_u32 s41, s43, 40960
    buffer_load_dwordx4 v22, s[48:51], s41 offen nt lds
    buffer_load_dwordx4 v23, s[48:51], s41 offen offset:1024 nt lds
    buffer_load_dwordx4 v24, s[48:51], s41 offen offset:2048 nt lds
    buffer_load_dwordx4 v25, s[48:51], s41 offen offset:3072 nt lds
    s_waitcnt vmcnt(12)
    ds_read_b64_tr_b16 a[48:49], v14 offset:12288
    ds_read_b64_tr_b16 a[50:51], v14 offset:12800
    ds_read_b64_tr_b16 a[52:53], v15 offset:12288
    ds_read_b64_tr_b16 a[54:55], v15 offset:12800
    ds_read_b64_tr_b16 a[56:57], v16 offset:12288
    ds_read_b64_tr_b16 a[58:59], v16 offset:12800
    ds_read_b64_tr_b16 a[60:61], v17 offset:12288
    ds_read_b64_tr_b16 a[62:63], v17 offset:12800
    s_waitcnt vmcnt(8)
    ds_read_b64_tr_b16 a[64:65], v14 offset:0
    ds_read_b64_tr_b16 a[66:67], v14 offset:512
    ds_read_b64_tr_b16 a[68:69], v15 offset:0
    ds_read_b64_tr_b16 a[70:71], v15 offset:512
    ds_read_b64_tr_b16 a[72:73], v16 offset:0
    ds_read_b64_tr_b16 a[74:75], v16 offset:512
    ds_read_b64_tr_b16 a[76:77], v17 offset:0
    ds_read_b64_tr_b16 a[78:79], v17 offset:512
    s_branch Laux_mm
Laux_u:
    s_cmp_ge_u32 s32, 27
    s_cbranch_scc1 Lend
    v_and_b32 v8, 1, v2
    v_lshlrev_b32 v8, 1, v8
    v_xor_b32 v8, v8, v6
    v_lshlrev_b32 v8, 4, v8
    v_mul_u32_u24 v9, 3456, v5
    s_lshl_b32 s38, s32, 7
    v_add3_u32 v18, v9, v8, s38
    v_xor_b32 v19, 64, v18
    v_add_u32 v19, 26624, v19
    v_add_u32 v20, 53248, v18
    v_add_u32 v21, 53248, v19
    s_mul_i32 s42, s26, 110592
    v_mul_u32_u24 v9, 1280, v5
    v_add_u32 v22, v9, v8
    v_xor_b32 v23, 64, v22
    v_add_u32 v23, 9216, v23
    v_add_u32 v24, 18432, v22
    v_add_u32 v25, 18432, v23
    s_mul_i32 s43, s32, 81920
    s_lshl_b32 s38, s3, 7
    s_add_u32 s43, s43, s38
    s_waitcnt lgkmcnt(0)
    s_mov_b64 s[44:45], s[16:17]
    s_mov_b32 s46, 2211840
    s_mov_b32 s47, 0x20000
    s_mov_b64 s[28:29], s[24:25]
    s_mov_b32 s30, 268435456
    s_mov_b32 s31, 0x20000
    s_load_dword s34, s[28:29], 0
    s_mov_b64 s[52:53], s[4:5]
    s_mov_b32 s54, 2621440
    s_mov_b32 s55, 0x20000
    s_mov_b64 s[48:49], s[18:19]
    s_mov_b32 s50, 2211840
    s_mov_b32 s51, 0x20000
    s_mov_b64 s[68:69], s[18:19]
    s_mov_b32 s70, 2211840
    s_mov_b32 s71, 0x20000
    s_cmp_ge_u32 s26, 2
    s_cselect_b32 s70, 0, s70
    v_bfe_u32 v10, v1, 2, 2
    v_and_b32 v8, 3, v1
    v_lshl_add_u32 v14, v2, 3, v10
    v_lshlrev_b32 v14, 7, v14
    v_lshlrev_b32 v9, 2, v1
    v_and_b32 v9, 0x60, v9
    v_add3_u32 v14, v14, v9, s40
    v_lshl_add_u32 v14, v8, 3, v14
    v_xor_b32 v15, 32, v14
    v_xor_b32 v16, 64, v14
    v_xor_b32 v17, 96, v14
    s_lshl_b32 s36, s26, 6
    s_add_u32 s36, s36, 141312
    v_lshl_add_u32 v26, v2, 4, s36
    v_min_u32 v8, 2, v3
    v_mul_u32_u24 v8, 1536, v8
    v_add_u32 v26, v26, v8
    s_waitcnt lgkmcnt(0)
    s_add_u32 s34, s34, 0x9e3779b8
    s_or_b32 s34, s34, 1
    s_cmp_lg_u32 s3, 7
    s_cbranch_scc1 Lnop7
    s_setprio 3
Lnop7:
    s_barrier
    s_add_u32 m0, s40, 0
    s_add_u32 s41, s42, 0
    buffer_load_dwordx4 v18, s[44:47], s41 offen nt lds
    buffer_load_dwordx4 v19, s[44:47], s41 offen offset:1024 nt lds
    buffer_load_dwordx4 v20, s[44:47], s41 offen offset:2048 nt lds
    buffer_load_dwordx4 v21, s[44:47], s41 offen offset:3072 nt lds
    s_add_u32 m0, s40, 4096
    s_add_u32 s41, s42, 442368
    buffer_load_dwordx4 v18, s[44:47], s41 offen nt lds
    buffer_load_dwordx4 v19, s[44:47], s41 offen offset:1024 nt lds
    buffer_load_dwordx4 v20, s[44:47], s41 offen offset:2048 nt lds
    buffer_load_dwordx4 v21, s[44:47], s41 offen offset:3072 nt lds
    s_add_u32 m0, s40, 8192
    s_add_u32 s41, s42, 884736
    buffer_load_dwordx4 v18, s[44:47], s41 offen nt lds
    buffer_load_dwordx4 v19, s[44:47], s41 offen offset:1024 nt lds
    buffer_load_dwordx4 v20, s[44:47], s41 offen offset:2048 nt lds
    buffer_load_dwordx4 v21, s[44:47], s41 offen offset:3072 nt lds
    s_add_u32 m0, s40, 12288
    s_add_u32 s41, s42, 1327104
    buffer_load_dwordx4 v18, s[44:47], s41 offen nt lds
    buffer_load_dwordx4 v19, s[44:47], s41 offen offset:1024 nt lds
    buffer_load_dwordx4 v20, s[44:47], s41 offen offset:2048 nt lds
    buffer_load_dwordx4 v21, s[44:47], s41 offen offset:3072 nt lds
    v_mov_b32 v11, 132864
Lcw_11:
    s_sub_u32 s35, s35, 1
    s_cbranch_scc1 Lend
    s_sleep 4
    ds_read_b32 v7, v11
    s_waitcnt lgkmcnt(0)
    v_readfirstlane_b32 s38, v7
    s_nop 0
    s_cmp_lt_u32 s38, 5
    s_cbranch_scc1 Lcw_11
    s_waitcnt vmcnt(12)
    ds_read_b64_tr_b16 a[0:1], v14 offset:0
    ds_read_b64_tr_b16 a[2:3], v14 offset:512
    ds_read_b64_tr_b16 a[4:5], v15 offset:0
    ds_read_b64_tr_b16 a[6:7], v15 offset:512
    ds_read_b64_tr_b16 a[8:9], v16 offset:0
    ds_read_b64_tr_b16 a[10:11], v16 offset:512
    ds_read_b64_tr_b16 a[12:13], v17 offset:0
    ds_read_b64_tr_b16 a[14:15], v17 offset:512
    s_waitcnt lgkmcnt(0)
    s_add_u32 m0, s40, 0
    s_add_u32 s41, s42, 1769472
    buffer_load_dwordx4 v18, s[44:47], s41 offen nt lds
    buffer_load_dwordx4 v19, s[44:47], s41 offen offset:1024 nt lds
    buffer_load_dwordx4 v20, s[44:47], s41 offen offset:2048 nt lds
    buffer_load_dwordx4 v21, s[44:47], s41 offen offset:3072 nt lds
    s_waitcnt vmcnt(12)
    ds_read_b64_tr_b16 a[16:17], v14 offset:4096
    ds_read_b64_tr_b16 a[18:19], v14 offset:4608
    ds_read_b64_tr_b16 a[20:21], v15 offset:4096
    ds_read_b64_tr_b16 a[22:23], v15 offset:4608
    ds_read_b64_tr_b16 a[24:25], v16 offset:4096
    ds_read_b64_tr_b16 a[26:27], v16 offset:4608
    ds_read_b64_tr_b16 a[28:29], v17 offset:4096
    ds_read_b64_tr_b16 a[30:31], v17 offset:4608
    s_waitcnt vmcnt(8)
    ds_read_b64_tr_b16 a[32:33], v14 offset:8192
    ds_read_b64_tr_b16 a[34:35], v14 offset:8704
    ds_read_b64_tr_b16 a[36:37], v15 offset:8192
    ds_read_b64_tr_b16 a[38:39], v15 offset:8704
    ds_read_b64_tr_b16 a[40:41], v16 offset:8192
    ds_read_b64_tr_b16 a[42:43], v16 offset:8704
    ds_read_b64_tr_b16 a[44:45], v17 offset:8192
    ds_read_b64_tr_b16 a[46:47], v17 offset:8704
    s_waitcnt vmcnt(4)
    ds_read_b64_tr_b16 a[48:49], v14 offset:12288
    ds_read_b64_tr_b16 a[50:51], v14 offset:12800
    ds_read_b64_tr_b16 a[52:53], v15 offset:12288
    ds_read_b64_tr_b16 a[54:55], v15 offset:12800
    ds_read_b64_tr_b16 a[56:57], v16 offset:12288
    ds_read_b64_tr_b16 a[58:59], v16 offset:12800
    ds_read_b64_tr_b16 a[60:61], v17 offset:12288
    ds_read_b64_tr_b16 a[62:63], v17 offset:12800
    s_waitcnt vmcnt(0)
    ds_read_b64_tr_b16 a[64:65], v14 offset:0
    ds_read_b64_tr_b16 a[66:67], v14 offset:512
    ds_read_b64_tr_b16 a[68:69], v15 offset:0
    ds_read_b64_tr_b16 a[70:71], v15 offset:512
    ds_read_b64_tr_b16 a[72:73], v16 offset:0
    ds_read_b64_tr_b16 a[74:75], v16 offset:512
    ds_read_b64_tr_b16 a[76:77], v17 offset:0
    ds_read_b64_tr_b16 a[78:79], v17 offset:512
    s_cmp_lg_u32 s3, 7
    s_cbranch_scc1 Lnofx
    v_mov_b32 v92, 0x3f803f80
    v_mov_b32 v93, 0x3f803f80
    v_mov_b32 v94, 0x3f803f80
    v_mov_b32 v95, 0x3f803f80
    v_add_u32 v4, 144384, v13
    ds_write_b128 v4, v[92:95]
    ds_write_b128 v4, v[92:95] offset:1024
    v_and_b32 v120, 31, v1
    v_lshlrev_b32 v120, 7, v120
    v_add_u32 v120, 8126464, v120
Lpt_12:
    s_sub_u32 s35, s35, 1
    s_cbranch_scc1 Lend
    s_sleep 2
    buffer_load_dwordx4 v[124:127], v120, s[28:31], 0 offen sc1
    s_waitcnt vmcnt(0)
    v_cmp_ne_u32 vcc, s34, v125
    v_cmp_ne_u32 s[36:37], s34, v127
    s_nop 0
    s_or_b64 s[36:37], s[36:37], vcc
    s_cbranch_scc1 Lpt_12
    v_mov_b32 v120, v124
    s_nop 1
    v_max_u32_dpp v120, v120, v120 row_ror:8 row_mask:0xf bank_mask:0xf
    s_nop 1
    v_max_u32_dpp v120, v120, v120 row_ror:4 row_mask:0xf bank_mask:0xf
    s_nop 1
    v_max_u32_dpp v120, v120, v120 row_ror:2 row_mask:0xf bank_mask:0xf
    s_nop 1
    v_max_u32_dpp v120, v120, v120 row_ror:1 row_mask:0xf bank_mask:0xf
    s_nop 0
    v_readlane_b32 s56, v120, 0
    v_readlane_b32 s36, v120, 16
    v_readlane_b32 s37, v120, 32
    v_readlane_b32 s38, v120, 48
    s_max_u32 s56, s56, s36
    s_max_u32 s37, s37, s38
    s_max_u32 s56, s56, s37
    v_cmp_eq_u32 vcc, s56, v124
    s_nop 1
    v_cndmask_b32 v120, v124, v126, vcc
    s_nop 1
    v_max_u32_dpp v120, v120, v120 row_ror:8 row_mask:0xf bank_mask:0xf
    s_nop 1
    v_max_u32_dpp v120, v120, v120 row_ror:4 row_mask:0xf bank_mask:0xf
    s_nop 1
    v_max_u32_dpp v120, v120, v120 row_ror:2 row_mask:0xf bank_mask:0xf
    s_nop 1
    v_max_u32_dpp v120, v120, v120 row_ror:1 row_mask:0xf bank_mask:0xf
    s_nop 0
    v_readlane_b32 s57, v120, 0
    v_readlane_b32 s36, v120, 16
    v_readlane_b32 s37, v120, 32
    v_readlane_b32 s38, v120, 48
    s_max_u32 s57, s57, s36
    s_max_u32 s37, s37, s38
    s_max_u32 s57, s57, s37
    s_and_b32 s36, s56, 0x7ff
    s_sub_u32 s36, 2047, s36
    s_and_b32 s37, s57, 0x7ff
    s_sub_u32 s37, 2047, s37
    s_mul_i32 s38, s36, 1280
    s_mul_i32 s39, s37, 1280
    s_mov_b32 m0, 141312
    v_mov_b32 v4, s36
    buffer_load_dwordx4 v13, s[52:55], s38 offen lds
    s_mov_b32 m0, 142848
    v_mov_b32 v5, s37
    buffer_load_dwordx4 v13, s[52:55], s39 offen lds
    s_mov_b64 exec, 0xffff
    buffer_load_dwordx4 v13, s[52:55], s39 offen offset:1024 lds
    s_mov_b32 m0, 141312
    s_mov_b32 vcc_lo, 0xaaaaaaaa
    buffer_load_dwordx4 v13, s[52:55], s38 offen offset:1024 lds
    s_mov_b64 exec, 3
    v_cndmask_b32 v4, v4, v5, vcc
    v_lshlrev_b32 v118, 3, v4
    v_add_u32 v118, 8192000, v118
    v_add_u32 v9, 132872, v12
Lxs_chk:
    s_sub_u32 s35, s35, 1
    s_cbranch_scc1 Lend
    buffer_load_dwordx2 v[116:117], v118, s[28:31], 0 offen sc1
    s_waitcnt vmcnt(0)
    v_cmp_ne_u32 vcc, s34, v117
    s_nop 0
    s_cbranch_vccnz Lxs_chk
    ds_write_b32 v9, v116
    s_mov_b64 exec, -1
    v_mov_b32 v10, 132868
    v_mov_b32 v7, 1
    s_mov_b64 exec, 1
    ds_add_u32 v10, v7
    s_mov_b64 exec, -1
Lnofx:
Lcw_13:
    s_sub_u32 s35, s35, 1
    s_cbranch_scc1 Lend
    s_sleep 2
    ds_read_b32 v7, v11
    s_waitcnt lgkmcnt(0)
    v_readfirstlane_b32 s38, v7
    s_nop 0
    s_cmp_lt_u32 s38, 9
    s_cbranch_scc1 Lcw_13
    s_add_u32 m0, s40, 4096
    s_add_u32 s41, s43, 0
    buffer_load_dwordx4 v22, s[48:51], s41 offen nt lds
    buffer_load_dwordx4 v23, s[48:51], s41 offen offset:1024 nt lds
    buffer_load_dwordx4 v24, s[48:51], s41 offen offset:2048 nt lds
    buffer_load_dwordx4 v25, s[48:51], s41 offen offset:3072 nt lds
    s_add_u32 m0, s40, 8192
    s_add_u32 s41, s43, 40960
    buffer_load_dwordx4 v22, s[48:51], s41 offen nt lds
    buffer_load_dwordx4 v23, s[48:51], s41 offen offset:1024 nt lds
    buffer_load_dwordx4 v24, s[48:51], s41 offen offset:2048 nt lds
    buffer_load_dwordx4 v25, s[48:51], s41 offen offset:3072 nt lds
    s_add_u32 m0, s40, 12288
    s_add_u32 s41, s43, 512
    buffer_load_dwordx4 v22, s[68:71], s41 offen nt lds
    buffer_load_dwordx4 v23, s[68:71], s41 offen offset:1024 nt lds
    buffer_load_dwordx4 v24, s[68:71], s41 offen offset:2048 nt lds
    buffer_load_dwordx4 v25, s[68:71], s41 offen offset:3072 nt lds
    s_add_u32 m0, s40, 0
    s_add_u32 s41, s43, 41472
    buffer_load_dwordx4 v22, s[68:71], s41 offen nt lds
    buffer_load_dwordx4 v23, s[68:71], s41 offen offset:1024 nt lds
    buffer_load_dwordx4 v24, s[68:71], s41 offen offset:2048 nt lds
    buffer_load_dwordx4 v25, s[68:71], s41 offen offset:3072 nt lds
Laux_mm:
    v_mov_b32 v10, 132868
Lcw_14:
    s_sub_u32 s35, s35, 1
    s_cbranch_scc1 Lend
    s_sleep 1
    ds_read_b32 v7, v10
    s_waitcnt lgkmcnt(0)
    v_readfirstlane_b32 s38, v7
    s_nop 0
    s_cmp_lt_u32 s38, 1
    s_cbranch_scc1 Lcw_14
    ds_read_b128 v[92:95], v26 offset:0
    ds_read_b128 v[96:99], v26 offset:256
    ds_read_b128 v[100:103], v26 offset:512
    ds_read_b128 v[104:107], v26 offset:768
    ds_read_b128 v[108:111], v26 offset:1024
    ds_read_b64 v[116:117], v10 offset:4
    s_waitcnt lgkmcnt(0)
    v_readfirstlane_b32 s56, v116
    v_readfirstlane_b32 s57, v117
    v_mfma_f32_16x16x32_bf16 v[112:115], a[0:3], v[92:95], 0
    v_mfma_f32_16x16x32_bf16 v[116:119], a[4:7], v[92:95], 0
    v_mfma_f32_16x16x32_bf16 v[120:123], a[8:11], v[92:95], 0
    v_mfma_f32_16x16x32_bf16 v[124:127], a[12:15], v[92:95], 0
    v_mfma_f32_16x16x32_bf16 v[112:115], a[16:19], v[96:99], v[112:115]
    v_mfma_f32_16x16x32_bf16 v[116:119], a[20:23], v[96:99], v[116:119]
    v_mfma_f32_16x16x32_bf16 v[120:123], a[24:27], v[96:99], v[120:123]
    v_mfma_f32_16x16x32_bf16 v[124:127], a[28:31], v[96:99], v[124:127]
    v_mfma_f32_16x16x32_bf16 v[112:115], a[32:35], v[100:103], v[112:115]
    v_mfma_f32_16x16x32_bf16 v[116:119], a[36:39], v[100:103], v[116:119]
    v_mfma_f32_16x16x32_bf16 v[120:123], a[40:43], v[100:103], v[120:123]
    v_mfma_f32_16x16x32_bf16 v[124:127], a[44:47], v[100:103], v[124:127]
    v_mfma_f32_16x16x32_bf16 v[112:115], a[48:51], v[104:107], v[112:115]
    v_mfma_f32_16x16x32_bf16 v[116:119], a[52:55], v[104:107], v[116:119]
    v_mfma_f32_16x16x32_bf16 v[120:123], a[56:59], v[104:107], v[120:123]
    v_mfma_f32_16x16x32_bf16 v[124:127], a[60:63], v[104:107], v[124:127]
    v_mfma_f32_16x16x32_bf16 v[112:115], a[64:67], v[108:111], v[112:115]
    v_mfma_f32_16x16x32_bf16 v[116:119], a[68:71], v[108:111], v[116:119]
    v_mfma_f32_16x16x32_bf16 v[120:123], a[72:75], v[108:111], v[120:123]
    v_mfma_f32_16x16x32_bf16 v[124:127], a[76:79], v[108:111], v[124:127]
    s_mul_i32 s36, s3, 768
    s_add_u32 s36, s36, 133120
    v_lshlrev_b32 v4, 8, v3
    v_lshl_add_u32 v4, v2, 4, v4
    v_add_u32 v4, s36, v4
    v_add_u32 v5, 133120, v12
    s_lshl_b32 s37, s3, 8
    s_add_u32 s37, s37, 139264
    v_lshl_add_u32 v6, v1, 1, s37
    v_and_b32 v7, 1, v1
    v_lshlrev_b32 v7, 7, v7
    v_lshl_add_u32 v7, v2, 4, v7
    v_add_u32 v7, s37, v7
    s_lshl_b32 s38, s56, 16
    s_lshl_b32 s39, s57, 16
    v_rcp_f32 v8, s38
    v_rcp_f32 v9, s39
    s_and_b32 s56, s56, 0xffff0000
    s_and_b32 s57, s57, 0xffff0000
    s_mov_b32 exec_lo, 0x00070007
    s_mov_b32 exec_hi, 0x00070007
    ds_write_b128 v4, v[112:115] offset:0
    ds_write_b128 v4, v[116:119] offset:64
    ds_write_b128 v4, v[120:123] offset:128
    ds_write_b128 v4, v[124:127] offset:192
    s_mov_b64 exec, -1
    s_waitcnt lgkmcnt(0)
    s_barrier
    ds_read2st64_b32 v[92:93], v5 offset0:0 offset1:1
    ds_read2st64_b32 v[94:95], v5 offset0:2 offset1:3
    ds_read2st64_b32 v[96:97], v5 offset0:4 offset1:5
    ds_read2st64_b32 v[98:99], v5 offset0:6 offset1:7
    ds_read2st64_b32 v[100:101], v5 offset0:8 offset1:9
    ds_read2st64_b32 v[102:103], v5 offset0:10 offset1:11
    ds_read2st64_b32 v[116:117], v5 offset0:12 offset1:13
    ds_read2st64_b32 v[118:119], v5 offset0:14 offset1:15
    ds_read2st64_b32 v[120:121], v5 offset0:16 offset1:17
    ds_read2st64_b32 v[122:123], v5 offset0:18 offset1:19
    ds_read2st64_b32 v[124:125], v5 offset0:20 offset1:21
    ds_read2st64_b32 v[126:127], v5 offset0:22 offset1:23
    v_cmp_eq_u32 s[72:73], 1, v2
    v_cmp_eq_u32 s[74:75], 2, v2
    v_cmp_eq_u32 s[76:77], 3, v2
    s_mul_i32 s37, s32, 10
    s_add_u32 s37, s37, s3
    s_lshl_b32 s37, s37, 10
    s_add_u32 s37, s37, 7405568
    s_waitcnt lgkmcnt(0)
    v_add_f32 v92, v92, v95
    v_add_f32 v98, v98, v101
    v_add_f32 v92, v92, v98
    v_add_f32 v93, v93, v96
    v_add_f32 v99, v99, v102
    v_add_f32 v93, v93, v99
    v_add_f32 v94, v94, v97
    v_add_f32 v100, v100, v103
    v_add_f32 v94, v94, v100
    v_add_f32 v116, v116, v119
    v_add_f32 v122, v122, v125
    v_add_f32 v116, v116, v122
    v_add_f32 v117, v117, v120
    v_add_f32 v123, v123, v126
    v_add_f32 v117, v117, v123
    v_add_f32 v118, v118, v121
    v_add_f32 v124, v124, v127
    v_add_f32 v118, v118, v124
    v_fmac_f32 v92, s56, v94
    v_mul_f32 v112, v92, v8
    v_fmac_f32 v93, s57, v94
    v_mul_f32 v113, v93, v9
    v_fmac_f32 v116, s56, v118
    v_mul_f32 v120, v116, v8
    v_fmac_f32 v117, s57, v118
    v_mul_f32 v121, v117, v9
    v_cvt_pk_bf16_f32 v113, v112, v113
    v_lshlrev_b32 v112, 16, v113
    v_and_b32 v113, 0xffff0000, v113
    v_cvt_pk_bf16_f32 v121, v120, v121
    v_lshlrev_b32 v120, 16, v121
    v_and_b32 v121, 0xffff0000, v121
    v_mul_f32 v114, 0xbfb8aa3b, v112
    v_mul_f32 v115, 0xbfb8aa3b, v113
    v_exp_f32 v114, v114
    v_exp_f32 v115, v115
    v_add_f32 v114, 1.0, v114
    v_add_f32 v115, 1.0, v115
    v_rcp_f32 v114, v114
    v_rcp_f32 v115, v115
    v_mul_f32 v114, v114, v112
    v_mul_f32 v115, v115, v113
    v_cvt_pk_bf16_f32 v115, v114, v115
    v_lshlrev_b32 v114, 16, v115
    v_and_b32 v115, 0xffff0000, v115
    v_mul_f32 v114, v114, v120
    v_mul_f32 v115, v115, v121
    v_cvt_pk_bf16_f32 v114, v114, v115
    ds_write_b16 v6, v114
    ds_write_b16_d16_hi v6, v114 offset:128
    ds_read_b128 v[92:95], v7 offset:0
    ds_read_b128 v[96:99], v7 offset:64
    v_mov_b32 v101, s34
    v_mov_b32 v103, s34
    s_waitcnt vmcnt(0)
    ds_read_b64_tr_b16 v[28:29], v14 offset:4096
    ds_read_b64_tr_b16 v[30:31], v14 offset:4608
    ds_read_b64_tr_b16 v[32:33], v15 offset:4096
    ds_read_b64_tr_b16 v[34:35], v15 offset:4608
    ds_read_b64_tr_b16 v[36:37], v16 offset:4096
    ds_read_b64_tr_b16 v[38:39], v16 offset:4608
    ds_read_b64_tr_b16 v[40:41], v17 offset:4096
    ds_read_b64_tr_b16 v[42:43], v17 offset:4608
    ds_read_b64_tr_b16 v[44:45], v14 offset:8192
    ds_read_b64_tr_b16 v[46:47], v14 offset:8704
    ds_read_b64_tr_b16 v[48:49], v15 offset:8192
    ds_read_b64_tr_b16 v[50:51], v15 offset:8704
    ds_read_b64_tr_b16 v[52:53], v16 offset:8192
    ds_read_b64_tr_b16 v[54:55], v16 offset:8704
    ds_read_b64_tr_b16 v[56:57], v17 offset:8192
    ds_read_b64_tr_b16 v[58:59], v17 offset:8704
    s_waitcnt lgkmcnt(0)
    v_mfma_f32_16x16x32_bf16 v[112:115], v[92:95], v[28:31], 0
    v_mfma_f32_16x16x32_bf16 v[116:119], v[92:95], v[32:35], 0
    v_mfma_f32_16x16x32_bf16 v[120:123], v[92:95], v[36:39], 0
    v_mfma_f32_16x16x32_bf16 v[124:127], v[92:95], v[40:43], 0
    v_mfma_f32_16x16x32_bf16 v[112:115], v[96:99], v[44:47], v[112:115]
    v_mfma_f32_16x16x32_bf16 v[116:119], v[96:99], v[48:51], v[116:119]
    v_mfma_f32_16x16x32_bf16 v[120:123], v[96:99], v[52:55], v[120:123]
    v_mfma_f32_16x16x32_bf16 v[124:127], v[96:99], v[56:59], v[124:127]
    s_nop 5
    v_cndmask_b32 v100, v112, v116, s[72:73]
    v_cndmask_b32 v100, v100, v120, s[74:75]
    v_cndmask_b32 v100, v100, v124, s[76:77]
    v_cndmask_b32 v102, v113, v117, s[72:73]
    v_cndmask_b32 v102, v102, v121, s[74:75]
    v_cndmask_b32 v102, v102, v125, s[76:77]
    buffer_store_dwordx4 v[100:103], v13, s[28:31], s37 offen sc1
    s_sub_u32 s36, s3, 4
    s_cmp_ge_u32 s36, 2
    s_cbranch_scc1 Laux_end
    s_add_u32 s37, s37, 4096
    ds_read_b64_tr_b16 v[60:61], v14 offset:12288
    ds_read_b64_tr_b16 v[62:63], v14 offset:12800
    ds_read_b64_tr_b16 v[64:65], v15 offset:12288
    ds_read_b64_tr_b16 v[66:67], v15 offset:12800
    ds_read_b64_tr_b16 v[68:69], v16 offset:12288
    ds_read_b64_tr_b16 v[70:71], v16 offset:12800
    ds_read_b64_tr_b16 v[72:73], v17 offset:12288
    ds_read_b64_tr_b16 v[74:75], v17 offset:12800
    ds_read_b64_tr_b16 v[76:77], v14 offset:0
    ds_read_b64_tr_b16 v[78:79], v14 offset:512
    ds_read_b64_tr_b16 v[80:81], v15 offset:0
    ds_read_b64_tr_b16 v[82:83], v15 offset:512
    ds_read_b64_tr_b16 v[84:85], v16 offset:0
    ds_read_b64_tr_b16 v[86:87], v16 offset:512
    ds_read_b64_tr_b16 v[88:89], v17 offset:0
    ds_read_b64_tr_b16 v[90:91], v17 offset:512
    s_waitcnt lgkmcnt(0)
    v_mfma_f32_16x16x32_bf16 v[112:115], v[92:95], v[60:63], 0
    v_mfma_f32_16x16x32_bf16 v[116:119], v[92:95], v[64:67], 0
    v_mfma_f32_16x16x32_bf16 v[120:123], v[92:95], v[68:71], 0
    v_mfma_f32_16x16x32_bf16 v[124:127], v[92:95], v[72:75], 0
    v_mfma_f32_16x16x32_bf16 v[112:115], v[96:99], v[76:79], v[112:115]
    v_mfma_f32_16x16x32_bf16 v[116:119], v[96:99], v[80:83], v[116:119]
    v_mfma_f32_16x16x32_bf16 v[120:123], v[96:99], v[84:87], v[120:123]
    v_mfma_f32_16x16x32_bf16 v[124:127], v[96:99], v[88:91], v[124:127]
    s_nop 5
    v_cndmask_b32 v100, v112, v116, s[72:73]
    v_cndmask_b32 v100, v100, v120, s[74:75]
    v_cndmask_b32 v100, v100, v124, s[76:77]
    v_cndmask_b32 v102, v113, v117, s[72:73]
    v_cndmask_b32 v102, v102, v121, s[74:75]
    v_cndmask_b32 v102, v102, v125, s[76:77]
    buffer_store_dwordx4 v[100:103], v13, s[28:31], s37 offen sc1
Laux_end:
    s_endpgm
Lmst:
    s_cmp_lg_u32 s3, 0
    s_cbranch_scc1 Lhelp_i
    s_waitcnt lgkmcnt(0)
    s_mov_b64 s[28:29], s[24:25]
    s_mov_b32 s30, 268435456
    s_mov_b32 s31, 0x20000
    s_load_dword s34, s[28:29], 0
    s_waitcnt lgkmcnt(0)
    s_add_u32 s34, s34, 0x9e3779b8
    s_or_b32 s34, s34, 1
    s_mov_b64 exec, 1
    s_lshl_b32 s36, s2, 2
    s_add_u32 s36, s36, 8323072
    v_mov_b32 v4, s34
    v_mov_b32 v5, s36
    buffer_store_dword v4, v5, s[28:31], 0 offen sc1
    s_mov_b64 exec, -1
    s_cmp_lg_u32 s32, 32
    s_cbranch_scc1 Lend
Lmst_bc:
    v_and_b32 v4, 31, v1
    v_lshlrev_b32 v4, 7, v4
    v_add_u32 v4, 8126464, v4
Lpt_15:
    s_sub_u32 s35, s35, 1
    s_cbranch_scc1 Lend
    s_sleep 8
    buffer_load_dwordx4 v[8:11], v4, s[28:31], 0 offen sc1
    s_waitcnt vmcnt(0)
    v_cmp_ne_u32 vcc, s34, v9
    v_cmp_ne_u32 s[36:37], s34, v11
    s_nop 0
    s_or_b64 s[36:37], s[36:37], vcc
    s_cbranch_scc1 Lpt_15
    v_mov_b32 v4, v8
    s_nop 1
    v_max_u32_dpp v4, v4, v4 row_ror:8 row_mask:0xf bank_mask:0xf
    s_nop 1
    v_max_u32_dpp v4, v4, v4 row_ror:4 row_mask:0xf bank_mask:0xf
    s_nop 1
    v_max_u32_dpp v4, v4, v4 row_ror:2 row_mask:0xf bank_mask:0xf
    s_nop 1
    v_max_u32_dpp v4, v4, v4 row_ror:1 row_mask:0xf bank_mask:0xf
    s_nop 0
    v_readlane_b32 s40, v4, 0
    v_readlane_b32 s36, v4, 16
    v_readlane_b32 s37, v4, 32
    v_readlane_b32 s38, v4, 48
    s_max_u32 s40, s40, s36
    s_max_u32 s37, s37, s38
    s_max_u32 s40, s40, s37
    v_cmp_eq_u32 vcc, s40, v8
    s_nop 1
    v_cndmask_b32 v4, v8, v10, vcc
    s_nop 1
    v_max_u32_dpp v4, v4, v4 row_ror:8 row_mask:0xf bank_mask:0xf
    s_nop 1
    v_max_u32_dpp v4, v4, v4 row_ror:4 row_mask:0xf bank_mask:0xf
    s_nop 1
    v_max_u32_dpp v4, v4, v4 row_ror:2 row_mask:0xf bank_mask:0xf
    s_nop 1
    v_max_u32_dpp v4, v4, v4 row_ror:1 row_mask:0xf bank_mask:0xf
    s_nop 0
    v_readlane_b32 s41, v4, 0
    v_readlane_b32 s36, v4, 16
    v_readlane_b32 s37, v4, 32
    v_readlane_b32 s38, v4, 48
    s_max_u32 s41, s41, s36
    s_max_u32 s37, s37, s38
    s_max_u32 s41, s41, s37
    v_mov_b32 v8, s40
    v_mov_b32 v9, s34
    v_mov_b32 v10, s41
    v_mov_b32 v11, s34
    s_mov_b32 s36, 8257536
    buffer_store_dwordx4 v[8:11], v13, s[28:31], s36 offen offset:0 sc1
    buffer_store_dwordx4 v[8:11], v13, s[28:31], s36 offen offset:1024 sc1
    buffer_store_dwordx4 v[8:11], v13, s[28:31], s36 offen offset:2048 sc1
    s_mov_b32 s36, 8323072
Lmaster:
    s_sub_u32 s35, s35, 1
    s_cbranch_scc1 Lend
    s_sleep 16
    buffer_load_dwordx4 v[4:7], v13, s[28:31], s36 offen sc1
    s_waitcnt vmcnt(0)
    v_xor_b32 v4, s34, v4
    v_xor_b32 v5, s34, v5
    v_xor_b32 v6, s34, v6
    v_xor_b32 v7, s34, v7
    v_or3_b32 v4, v4, v5, v6
    v_or_b32 v4, v4, v7
    v_cmp_ne_u32 vcc, 0, v4
    s_nop 0
    s_cbranch_vccnz Lmaster
    s_mov_b64 exec, 1
    buffer_store_dword v9, v4, s[28:31], 0 offen sc1
    s_endpgm
Lhelp_r:
    s_add_u32 s72, s32, 0
    s_mov_b32 s73, 5
    s_mov_b32 s37, 4
    s_branch Lhelp
Lhelp_i:
    s_cmp_eq_u32 s32, 32
    s_cbranch_scc1 Lend
    s_cmp_eq_u32 s27, 0
    s_cbranch_scc1 Lend
    s_sub_u32 s72, s32, 33
    s_mov_b32 s73, 3
    s_mov_b32 s37, 9
Lhelp:
    s_lshl_b32 s38, s26, 6
    v_add_u32 v4, s38, v1
    v_mul_u32_u24 v4, 1280, v4
    s_waitcnt lgkmcnt(0)
    s_mov_b64 s[68:69], s[18:19]
    s_mov_b32 s70, 2211840
    s_mov_b32 s71, 0x20000
Lhelp2:
    s_mul_i32 s38, s72, 9363
    s_lshr_b32 s38, s38, 16
    s_mul_i32 s39, s38, 7
    s_sub_u32 s39, s72, s39
    s_mul_i32 s39, s39, 327680
    s_lshl_b32 s38, s38, 7
    s_sub_u32 s39, s39, s38
    s_add_u32 s39, s39, 1152
    v_add_u32 v6, s39, v4
    buffer_load_dword v5, v6, s[68:71], 0 offen
    s_add_u32 s72, s72, s73
    s_sub_u32 s37, s37, 1
    s_cmp_lg_u32 s37, 0
    s_cbranch_scc1 Lhelp2
Lend:
    s_endpgm
.section .rodata,"a"
.p2align 6
.amdhsa_kernel recurrent_scan__sliding_local_dilated__moe_arch_mod__prompt_kernel
  .amdhsa_next_free_vgpr 256
  .amdhsa_next_free_sgpr 102
  .amdhsa_accum_offset 128
  .amdhsa_group_segment_fixed_size 0
  .amdhsa_kernarg_size 88
  .amdhsa_user_sgpr_count 2
  .amdhsa_user_sgpr_kernarg_segment_ptr 1
  .amdhsa_system_sgpr_workgroup_id_x 1
  .amdhsa_float_denorm_mode_32 3
.end_amdhsa_kernel
```

```asm
; @launch grid=(256,1,1) block=(512,1,1) lds=163840
.amdgcn_target "amdgcn-amd-amdhsa--gfx950"
.text
.globl recurrent_scan__sliding_local_dilated__moe_arch_mod__prompt_kernel
.p2align 8
.type recurrent_scan__sliding_local_dilated__moe_arch_mod__prompt_kernel,@function
recurrent_scan__sliding_local_dilated__moe_arch_mod__prompt_kernel:
    s_load_dwordx16 s[4:19], s[0:1], 0
    s_load_dwordx4 s[20:23], s[0:1], 64
    s_load_dwordx2 s[24:25], s[0:1], 80
    v_lshrrev_b32 v4, 6, v0
    v_and_b32 v1, 63, v0
    s_cmp_ge_u32 s2, 256
    s_cbranch_scc1 Lend
    v_readfirstlane_b32 s3, v4
    s_getpc_b64 s[36:37]
Lpc:
    s_and_b32 s38, s2, 0xf8
    v_add_u32 v5, s38, v4
    v_and_b32 v6, 1, v0
    v_lshl_add_u32 v5, v5, 1, v6
    v_lshlrev_b32 v5, 7, v5
    v_min_u32 v5, Lend-Lpc, v5
    v_mov_b32 v7, s37
    v_add_co_u32 v6, vcc, s36, v5
    s_nop 1
    v_addc_co_u32 v7, vcc, 0, v7, vcc
    global_load_dword v0, v[6:7], off
    v_lshrrev_b32 v2, 4, v1
    v_and_b32 v3, 15, v1
    v_lshlrev_b32 v12, 2, v1
    v_lshlrev_b32 v13, 4, v1
    s_mov_b32 s35, 200000
    s_and_b32 s36, s2, 7
    s_lshr_b32 s37, s2, 3
    s_and_b32 s38, s36, 1
    s_lshr_b32 s36, s36, 1
    s_add_u32 s39, s38, 4
    s_and_b32 s26, s3, 3
    s_lshr_b32 s27, s3, 2
    s_cmp_lt_u32 s37, s39
    s_cbranch_scc1 Laux
    s_lshr_b32 s33, s36, 1
    s_and_b32 s36, s36, 1
    s_mul_i32 s36, s36, 55
    s_mul_i32 s38, s38, 28
    s_add_u32 s36, s36, s38
    s_add_u32 s36, s36, s37
    s_sub_u32 s36, s36, s39
    s_mul_i32 s32, s36, 13108
    s_lshr_b32 s32, s32, 16
    s_mul_i32 s37, s32, 5
    s_sub_u32 s36, s36, s37
    s_mul_i32 s33, s33, 5
    s_add_u32 s33, s33, s36
    s_add_u32 s42, s33, s32
    s_mul_i32 s36, s42, 13108
    s_lshr_b32 s36, s36, 16
    s_mul_i32 s36, s36, 5
    s_sub_u32 s42, s42, s36
    s_cmp_lg_u32 s3, 0
    s_cbranch_scc1 Lcomp
Lloader:
    s_setprio 3
    v_lshrrev_b32 v5, 3, v1
    v_and_b32 v6, 7, v1
    v_and_b32 v8, 1, v2
    v_lshlrev_b32 v8, 1, v8
    v_xor_b32 v8, v8, v6
    s_lshl_b32 s39, s33, 7
    v_lshl_add_u32 v50, v8, 4, s39
    v_mov_b32 v7, 3840
    v_mad_u32_u24 v28, v5, v7, v50
    v_xor_b32 v29, 64, v28
    v_add_u32 v29, 29696, v29
    v_add_u32 v30, 59392, v28
    v_add_u32 v31, 59392, v29
    v_add_u32 v32, 122880, v28
    v_add_u32 v33, 122880, v29
    v_add_u32 v34, 182272, v28
    v_add_u32 v35, 182272, v29
    s_lshl_b32 s78, s42, 2
    s_lshr_b32 s78, 0x86420, s78
    s_and_b32 s78, s78, 15
    s_mul_i32 s68, s78, 245760
    s_lshl_b32 s43, s78, 7
    s_mul_i32 s38, s32, 96
    s_sub_u32 s38, s38, 16
    v_add_u32 v7, s38, v5
    v_xor_b32 v9, v6, v2
    v_lshlrev_b32 v9, 4, v9
    v_xor_b32 v10, 64, v9
    v_mov_b32 v11, 2047
    v_mov_b32 v8, 1280
    v_add_u32 v36, 0, v7
    v_med3_i32 v36, v36, 0, v11
    v_mad_u32_u24 v36, v36, v8, v9
    v_add_u32 v36, 4096, v36
    v_add_u32 v37, 8, v7
    v_med3_i32 v37, v37, 0, v11
    v_mad_u32_u24 v37, v37, v8, v10
    v_add_u32 v37, 3072, v37
    v_add_u32 v38, 16, v7
    v_med3_i32 v38, v38, 0, v11
    v_mad_u32_u24 v38, v38, v8, v9
    v_add_u32 v38, 2048, v38
    v_add_u32 v39, 24, v7
    v_med3_i32 v39, v39, 0, v11
    v_mad_u32_u24 v39, v39, v8, v10
    v_add_u32 v39, 1024, v39
    s_waitcnt lgkmcnt(0)
    s_mov_b64 s[48:49], s[6:7]
    s_mov_b32 s50, 2457600
    s_mov_b32 s51, 0x20000
    s_add_u32 s52, s6, 1280
    s_addc_u32 s53, s7, 0
    s_mov_b32 s54, 2456320
    s_mov_b32 s55, 0x20000
    s_add_u32 s56, s6, 2560
    s_addc_u32 s57, s7, 0
    s_mov_b32 s58, 2455040
    s_mov_b32 s59, 0x20000
    s_mov_b32 m0, 0
    v_add_u32 v40, 32, v7
    v_med3_i32 v40, v40, 0, v11
    buffer_load_dwordx4 v28, s[48:51], s68 offen lds
    v_mad_u32_u24 v40, v40, v8, v9
    buffer_load_dwordx4 v29, s[48:51], s68 offen offset:1024 lds
    v_add_u32 v40, 4096, v40
    v_add_u32 v41, 40, v7
    buffer_load_dwordx4 v30, s[48:51], s68 offen offset:2048 lds
    v_med3_i32 v41, v41, 0, v11
    buffer_load_dwordx4 v31, s[48:51], s68 offen offset:3072 lds
    v_mad_u32_u24 v41, v41, v8, v10
    s_mov_b32 m0, 8192
    v_add_u32 v41, 3072, v41
    v_add_u32 v42, 48, v7
    buffer_load_dwordx4 v28, s[52:55], s68 offen lds
    v_med3_i32 v42, v42, 0, v11
    buffer_load_dwordx4 v29, s[52:55], s68 offen offset:1024 lds
    v_mad_u32_u24 v42, v42, v8, v9
    buffer_load_dwordx4 v30, s[52:55], s68 offen offset:2048 lds
    v_add_u32 v42, 2048, v42
    v_add_u32 v43, 56, v7
    buffer_load_dwordx4 v31, s[52:55], s68 offen offset:3072 lds
    v_med3_i32 v43, v43, 0, v11
    s_mov_b32 m0, 16384
    v_mad_u32_u24 v43, v43, v8, v10
    v_add_u32 v43, 1024, v43
    buffer_load_dwordx4 v28, s[56:59], s68 offen lds
    v_add_u32 v44, 64, v7
    buffer_load_dwordx4 v29, s[56:59], s68 offen offset:1024 lds
    v_med3_i32 v44, v44, 0, v11
    buffer_load_dwordx4 v30, s[56:59], s68 offen offset:2048 lds
    v_mad_u32_u24 v44, v44, v8, v9
    v_add_u32 v44, 4096, v44
    buffer_load_dwordx4 v31, s[56:59], s68 offen offset:3072 lds
    v_add_u32 v45, 72, v7
    s_mov_b32 m0, 4096
    v_med3_i32 v45, v45, 0, v11
    buffer_load_dwordx4 v32, s[48:51], s68 offen lds
    v_mad_u32_u24 v45, v45, v8, v10
    v_add_u32 v45, 3072, v45
    buffer_load_dwordx4 v33, s[48:51], s68 offen offset:1024 lds
    v_add_u32 v46, 80, v7
    buffer_load_dwordx4 v34, s[48:51], s68 offen offset:2048 lds
    v_med3_i32 v46, v46, 0, v11
    buffer_load_dwordx4 v35, s[48:51], s68 offen offset:3072 lds
    v_mad_u32_u24 v46, v46, v8, v9
    v_add_u32 v46, 2048, v46
    s_mov_b32 m0, 12288
    v_add_u32 v47, 88, v7
    buffer_load_dwordx4 v32, s[52:55], s68 offen lds
    v_med3_i32 v47, v47, 0, v11
    v_mad_u32_u24 v47, v47, v8, v10
    buffer_load_dwordx4 v33, s[52:55], s68 offen offset:1024 lds
    v_add_u32 v47, 1024, v47
    buffer_load_dwordx4 v34, s[52:55], s68 offen offset:2048 lds
    v_add_u32 v48, 96, v7
    buffer_load_dwordx4 v35, s[52:55], s68 offen offset:3072 lds
    v_med3_i32 v48, v48, 0, v11
    v_mad_u32_u24 v48, v48, v8, v9
    s_mov_b32 m0, 20480
    v_add_u32 v48, 4096, v48
    buffer_load_dwordx4 v32, s[56:59], s68 offen lds
    v_add_u32 v49, 104, v7
    buffer_load_dwordx4 v33, s[56:59], s68 offen offset:1024 lds
    v_med3_i32 v49, v49, 0, v11
    v_mad_u32_u24 v49, v49, v8, v10
    buffer_load_dwordx4 v34, s[56:59], s68 offen offset:2048 lds
    v_add_u32 v49, 3072, v49
    buffer_load_dwordx4 v35, s[56:59], s68 offen offset:3072 lds
    s_sub_u32 s44, s4, 4096
    s_subb_u32 s45, s5, 0
    s_mov_b32 s46, 2625536
    s_mov_b32 s47, 0x20000
    s_mov_b32 m0, 24576
    s_nop 0
    buffer_load_dwordx4 v36, s[44:47], s43 offen lds
    buffer_load_dwordx4 v37, s[44:47], s43 offen offset:1024 lds
    buffer_load_dwordx4 v38, s[44:47], s43 offen offset:2048 lds
    buffer_load_dwordx4 v39, s[44:47], s43 offen offset:3072 lds
    s_mov_b32 m0, 28672
    s_nop 0
    buffer_load_dwordx4 v40, s[44:47], s43 offen lds
    buffer_load_dwordx4 v41, s[44:47], s43 offen offset:1024 lds
    buffer_load_dwordx4 v42, s[44:47], s43 offen offset:2048 lds
    buffer_load_dwordx4 v43, s[44:47], s43 offen offset:3072 lds
    s_mov_b32 m0, 32768
    s_nop 0
    buffer_load_dwordx4 v44, s[44:47], s43 offen lds
    buffer_load_dwordx4 v45, s[44:47], s43 offen offset:1024 lds
    buffer_load_dwordx4 v46, s[44:47], s43 offen offset:2048 lds
    buffer_load_dwordx4 v47, s[44:47], s43 offen offset:3072 lds
    s_mov_b32 m0, 36864
    s_nop 0
    buffer_load_dwordx4 v48, s[44:47], s43 offen lds
    buffer_load_dwordx4 v49, s[44:47], s43 offen offset:1024 lds
    s_mov_b32 s80, 0x53864210
    s_mov_b32 s81, 0x97
    s_cmp_eq_u32 s42, 1
    s_cselect_b32 s80, 0x51086342, s80
    s_cselect_b32 s81, 0x97, s81
    s_cmp_eq_u32 s42, 2
    s_cselect_b32 s80, 0x31205864, s80
    s_cselect_b32 s81, 0x97, s81
    s_cmp_eq_u32 s42, 3
    s_cselect_b32 s80, 0x31472086, s80
    s_cselect_b32 s81, 0x95, s81
    s_cmp_eq_u32 s42, 4
    s_cselect_b32 s80, 0x31964208, s80
    s_cselect_b32 s81, 0x75, s81
    s_lshr_b64 s[80:81], s[80:81], 4
    s_and_b32 s78, s80, 15
    s_mov_b64 s[28:29], s[24:25]
    s_mov_b32 s30, 268435456
    s_mov_b32 s31, 0x20000
    s_load_dword s34, s[28:29], 0
    s_mov_b64 s[60:61], s[8:9]
    s_mov_b32 s62, 819200
    s_mov_b32 s63, 0x20000
    s_mov_b64 s[64:65], s[20:21]
    s_mov_b32 s66, 2621440
    s_mov_b32 s67, 0x20000
    v_mov_b32 v51, 157984
    v_and_b32 v66, 7, v1
    v_max_u32 v66, 1, v66
    v_lshlrev_b32 v66, 2, v66
    v_add_u32 v66, 158016, v66
    s_mul_i32 s69, s78, 245760
    s_lshl_b32 s43, s78, 7
    s_mov_b32 m0, 63616
    s_nop 0
    buffer_load_dwordx4 v36, s[44:47], s43 offen lds
    buffer_load_dwordx4 v37, s[44:47], s43 offen offset:1024 lds
    buffer_load_dwordx4 v38, s[44:47], s43 offen offset:2048 lds
    buffer_load_dwordx4 v39, s[44:47], s43 offen offset:3072 lds
    s_mov_b32 m0, 39040
    s_nop 0
    buffer_load_dwordx4 v28, s[48:51], s69 offen lds
    buffer_load_dwordx4 v29, s[48:51], s69 offen offset:1024 lds
    buffer_load_dwordx4 v30, s[48:51], s69 offen offset:2048 lds
    buffer_load_dwordx4 v31, s[48:51], s69 offen offset:3072 lds
    s_mov_b32 m0, 67712
    s_nop 0
    buffer_load_dwordx4 v40, s[44:47], s43 offen lds
    buffer_load_dwordx4 v41, s[44:47], s43 offen offset:1024 lds
    buffer_load_dwordx4 v42, s[44:47], s43 offen offset:2048 lds
    buffer_load_dwordx4 v43, s[44:47], s43 offen offset:3072 lds
    s_mov_b32 m0, 47232
    s_nop 0
    buffer_load_dwordx4 v28, s[52:55], s69 offen lds
    buffer_load_dwordx4 v29, s[52:55], s69 offen offset:1024 lds
    buffer_load_dwordx4 v30, s[52:55], s69 offen offset:2048 lds
    buffer_load_dwordx4 v31, s[52:55], s69 offen offset:3072 lds
    s_mov_b32 m0, 71808
    s_nop 0
    buffer_load_dwordx4 v44, s[44:47], s43 offen lds
    buffer_load_dwordx4 v45, s[44:47], s43 offen offset:1024 lds
    buffer_load_dwordx4 v46, s[44:47], s43 offen offset:2048 lds
    buffer_load_dwordx4 v47, s[44:47], s43 offen offset:3072 lds
    s_mov_b32 m0, 55424
    s_nop 0
    buffer_load_dwordx4 v28, s[56:59], s69 offen lds
    buffer_load_dwordx4 v29, s[56:59], s69 offen offset:1024 lds
    buffer_load_dwordx4 v30, s[56:59], s69 offen offset:2048 lds
    buffer_load_dwordx4 v31, s[56:59], s69 offen offset:3072 lds
    s_mov_b32 m0, 75904
    s_nop 0
    buffer_load_dwordx4 v48, s[44:47], s43 offen lds
    s_waitcnt vmcnt(55)
    buffer_load_dwordx4 v49, s[44:47], s43 offen offset:1024 lds
    s_mov_b32 m0, 43136
    s_nop 0
    buffer_load_dwordx4 v32, s[48:51], s69 offen lds
    buffer_load_dwordx4 v33, s[48:51], s69 offen offset:1024 lds
    buffer_load_dwordx4 v34, s[48:51], s69 offen offset:2048 lds
    buffer_load_dwordx4 v35, s[48:51], s69 offen offset:3072 lds
    s_mov_b32 m0, 51328
    s_nop 0
    buffer_load_dwordx4 v32, s[52:55], s69 offen lds
    buffer_load_dwordx4 v33, s[52:55], s69 offen offset:1024 lds
    buffer_load_dwordx4 v34, s[52:55], s69 offen offset:2048 lds
    s_waitcnt vmcnt(55)
    buffer_load_dwordx4 v35, s[52:55], s69 offen offset:3072 lds
    s_mov_b32 m0, 59520
    s_nop 0
    buffer_load_dwordx4 v32, s[56:59], s69 offen lds
    buffer_load_dwordx4 v33, s[56:59], s69 offen offset:1024 lds
    buffer_load_dwordx4 v34, s[56:59], s69 offen offset:2048 lds
    buffer_load_dwordx4 v35, s[56:59], s69 offen offset:3072 lds
    s_waitcnt vmcnt(38) lgkmcnt(0)
    s_barrier
    s_add_u32 s34, s34, 0x9e3779b8
    s_or_b32 s34, s34, 1
    s_lshr_b64 s[80:81], s[80:81], 4
    s_and_b32 s78, s80, 15
    s_mul_i32 s70, s78, 245760
    s_lshl_b32 s43, s78, 7
    s_mov_b32 m0, 102656
    s_nop 0
    buffer_load_dwordx4 v36, s[44:47], s43 offen lds
    buffer_load_dwordx4 v37, s[44:47], s43 offen offset:1024 lds
    buffer_load_dwordx4 v38, s[44:47], s43 offen offset:2048 lds
    buffer_load_dwordx4 v39, s[44:47], s43 offen offset:3072 lds
    s_mov_b32 m0, 78080
    s_nop 0
    buffer_load_dwordx4 v28, s[48:51], s70 offen lds
    buffer_load_dwordx4 v29, s[48:51], s70 offen offset:1024 lds
    buffer_load_dwordx4 v30, s[48:51], s70 offen offset:2048 lds
    buffer_load_dwordx4 v31, s[48:51], s70 offen offset:3072 lds
    s_mov_b32 m0, 106752
    s_nop 0
    buffer_load_dwordx4 v40, s[44:47], s43 offen lds
    buffer_load_dwordx4 v41, s[44:47], s43 offen offset:1024 lds
    buffer_load_dwordx4 v42, s[44:47], s43 offen offset:2048 lds
    buffer_load_dwordx4 v43, s[44:47], s43 offen offset:3072 lds
    s_mov_b32 m0, 86272
    s_nop 0
    buffer_load_dwordx4 v28, s[52:55], s70 offen lds
    buffer_load_dwordx4 v29, s[52:55], s70 offen offset:1024 lds
    buffer_load_dwordx4 v30, s[52:55], s70 offen offset:2048 lds
    buffer_load_dwordx4 v31, s[52:55], s70 offen offset:3072 lds
    s_mov_b32 m0, 110848
    s_nop 0
    buffer_load_dwordx4 v44, s[44:47], s43 offen lds
    buffer_load_dwordx4 v45, s[44:47], s43 offen offset:1024 lds
    buffer_load_dwordx4 v46, s[44:47], s43 offen offset:2048 lds
    buffer_load_dwordx4 v47, s[44:47], s43 offen offset:3072 lds
    s_mov_b32 m0, 94464
    s_nop 0
    buffer_load_dwordx4 v28, s[56:59], s70 offen lds
    buffer_load_dwordx4 v29, s[56:59], s70 offen offset:1024 lds
    buffer_load_dwordx4 v30, s[56:59], s70 offen offset:2048 lds
    buffer_load_dwordx4 v31, s[56:59], s70 offen offset:3072 lds
    s_mov_b32 m0, 114944
    s_nop 0
    buffer_load_dwordx4 v48, s[44:47], s43 offen lds
    s_waitcnt vmcnt(55)
    buffer_load_dwordx4 v49, s[44:47], s43 offen offset:1024 lds
    s_mov_b32 m0, 82176
    s_nop 0
    buffer_load_dwordx4 v32, s[48:51], s70 offen lds
    buffer_load_dwordx4 v33, s[48:51], s70 offen offset:1024 lds
    buffer_load_dwordx4 v34, s[48:51], s70 offen offset:2048 lds
    buffer_load_dwordx4 v35, s[48:51], s70 offen offset:3072 lds
    s_mov_b32 m0, 90368
    s_nop 0
    buffer_load_dwordx4 v32, s[52:55], s70 offen lds
    buffer_load_dwordx4 v33, s[52:55], s70 offen offset:1024 lds
    buffer_load_dwordx4 v34, s[52:55], s70 offen offset:2048 lds
    s_waitcnt vmcnt(55)
    buffer_load_dwordx4 v35, s[52:55], s70 offen offset:3072 lds
    s_mov_b32 m0, 98560
    s_nop 0
    buffer_load_dwordx4 v32, s[56:59], s70 offen lds
    buffer_load_dwordx4 v33, s[56:59], s70 offen offset:1024 lds
    buffer_load_dwordx4 v34, s[56:59], s70 offen offset:2048 lds
    buffer_load_dwordx4 v35, s[56:59], s70 offen offset:3072 lds
    s_waitcnt vmcnt(38) lgkmcnt(0)
    s_barrier
    s_lshr_b64 s[80:81], s[80:81], 4
    s_and_b32 s78, s80, 15
    s_mul_i32 s71, s78, 245760
    s_lshl_b32 s43, s78, 7
    s_mov_b32 m0, 141696
    s_nop 0
    buffer_load_dwordx4 v36, s[44:47], s43 offen lds
    buffer_load_dwordx4 v37, s[44:47], s43 offen offset:1024 lds
    buffer_load_dwordx4 v38, s[44:47], s43 offen offset:2048 lds
    buffer_load_dwordx4 v39, s[44:47], s43 offen offset:3072 lds
    s_mov_b32 m0, 117120
    s_nop 0
    buffer_load_dwordx4 v28, s[48:51], s71 offen lds
    buffer_load_dwordx4 v29, s[48:51], s71 offen offset:1024 lds
    buffer_load_dwordx4 v30, s[48:51], s71 offen offset:2048 lds
    buffer_load_dwordx4 v31, s[48:51], s71 offen offset:3072 lds
    s_mov_b32 m0, 145792
    s_nop 0
    buffer_load_dwordx4 v40, s[44:47], s43 offen lds
    buffer_load_dwordx4 v41, s[44:47], s43 offen offset:1024 lds
    buffer_load_dwordx4 v42, s[44:47], s43 offen offset:2048 lds
    buffer_load_dwordx4 v43, s[44:47], s43 offen offset:3072 lds
    s_mov_b32 m0, 125312
    s_nop 0
    buffer_load_dwordx4 v28, s[52:55], s71 offen lds
    buffer_load_dwordx4 v29, s[52:55], s71 offen offset:1024 lds
    buffer_load_dwordx4 v30, s[52:55], s71 offen offset:2048 lds
    buffer_load_dwordx4 v31, s[52:55], s71 offen offset:3072 lds
    s_mov_b32 m0, 149888
    s_nop 0
    buffer_load_dwordx4 v44, s[44:47], s43 offen lds
    buffer_load_dwordx4 v45, s[44:47], s43 offen offset:1024 lds
    buffer_load_dwordx4 v46, s[44:47], s43 offen offset:2048 lds
    buffer_load_dwordx4 v47, s[44:47], s43 offen offset:3072 lds
    s_mov_b32 m0, 133504
    s_nop 0
    buffer_load_dwordx4 v28, s[56:59], s71 offen lds
    buffer_load_dwordx4 v29, s[56:59], s71 offen offset:1024 lds
    buffer_load_dwordx4 v30, s[56:59], s71 offen offset:2048 lds
    buffer_load_dwordx4 v31, s[56:59], s71 offen offset:3072 lds
    s_mov_b32 m0, 153984
    s_nop 0
    buffer_load_dwordx4 v48, s[44:47], s43 offen lds
    s_waitcnt vmcnt(55)
    buffer_load_dwordx4 v49, s[44:47], s43 offen offset:1024 lds
    s_mov_b32 m0, 121216
    s_nop 0
    buffer_load_dwordx4 v32, s[48:51], s71 offen lds
    buffer_load_dwordx4 v33, s[48:51], s71 offen offset:1024 lds
    buffer_load_dwordx4 v34, s[48:51], s71 offen offset:2048 lds
    buffer_load_dwordx4 v35, s[48:51], s71 offen offset:3072 lds
    s_mov_b32 m0, 129408
    s_nop 0
    buffer_load_dwordx4 v32, s[52:55], s71 offen lds
    buffer_load_dwordx4 v33, s[52:55], s71 offen offset:1024 lds
    buffer_load_dwordx4 v34, s[52:55], s71 offen offset:2048 lds
    s_waitcnt vmcnt(55)
    buffer_load_dwordx4 v35, s[52:55], s71 offen offset:3072 lds
    s_mov_b32 m0, 137600
    s_nop 0
    buffer_load_dwordx4 v32, s[56:59], s71 offen lds
    buffer_load_dwordx4 v33, s[56:59], s71 offen offset:1024 lds
    buffer_load_dwordx4 v34, s[56:59], s71 offen offset:2048 lds
    buffer_load_dwordx4 v35, s[56:59], s71 offen offset:3072 lds
    s_waitcnt vmcnt(38) lgkmcnt(0)
    s_barrier
    s_lshr_b64 s[80:81], s[80:81], 4
    s_and_b32 s78, s80, 15
    s_mul_i32 s72, s78, 245760
    s_lshl_b32 s43, s78, 7
    s_mov_b32 m0, 24576
    s_nop 0
    buffer_load_dwordx4 v36, s[44:47], s43 offen lds
    buffer_load_dwordx4 v37, s[44:47], s43 offen offset:1024 lds
    buffer_load_dwordx4 v38, s[44:47], s43 offen offset:2048 lds
    buffer_load_dwordx4 v39, s[44:47], s43 offen offset:3072 lds
    s_mov_b32 m0, 0
    s_nop 0
    buffer_load_dwordx4 v28, s[48:51], s72 offen lds
    buffer_load_dwordx4 v29, s[48:51], s72 offen offset:1024 lds
    buffer_load_dwordx4 v30, s[48:51], s72 offen offset:2048 lds
    buffer_load_dwordx4 v31, s[48:51], s72 offen offset:3072 lds
    s_mov_b32 m0, 28672
    s_nop 0
    buffer_load_dwordx4 v40, s[44:47], s43 offen lds
    buffer_load_dwordx4 v41, s[44:47], s43 offen offset:1024 lds
    buffer_load_dwordx4 v42, s[44:47], s43 offen offset:2048 lds
    buffer_load_dwordx4 v43, s[44:47], s43 offen offset:3072 lds
    s_mov_b32 m0, 8192
    s_nop 0
    buffer_load_dwordx4 v28, s[52:55], s72 offen lds
    buffer_load_dwordx4 v29, s[52:55], s72 offen offset:1024 lds
    buffer_load_dwordx4 v30, s[52:55], s72 offen offset:2048 lds
    buffer_load_dwordx4 v31, s[52:55], s72 offen offset:3072 lds
    s_mov_b32 m0, 32768
    s_nop 0
    buffer_load_dwordx4 v44, s[44:47], s43 offen lds
    buffer_load_dwordx4 v45, s[44:47], s43 offen offset:1024 lds
    buffer_load_dwordx4 v46, s[44:47], s43 offen offset:2048 lds
    buffer_load_dwordx4 v47, s[44:47], s43 offen offset:3072 lds
    s_mov_b32 m0, 16384
    s_nop 0
    buffer_load_dwordx4 v28, s[56:59], s72 offen lds
    buffer_load_dwordx4 v29, s[56:59], s72 offen offset:1024 lds
    buffer_load_dwordx4 v30, s[56:59], s72 offen offset:2048 lds
    buffer_load_dwordx4 v31, s[56:59], s72 offen offset:3072 lds
    s_mov_b32 m0, 36864
    s_nop 0
    buffer_load_dwordx4 v48, s[44:47], s43 offen lds
    s_waitcnt vmcnt(55)
    buffer_load_dwordx4 v49, s[44:47], s43 offen offset:1024 lds
    s_mov_b32 m0, 4096
    s_nop 0
    buffer_load_dwordx4 v32, s[48:51], s72 offen lds
    buffer_load_dwordx4 v33, s[48:51], s72 offen offset:1024 lds
    buffer_load_dwordx4 v34, s[48:51], s72 offen offset:2048 lds
    buffer_load_dwordx4 v35, s[48:51], s72 offen offset:3072 lds
    s_mov_b32 m0, 12288
    s_nop 0
    buffer_load_dwordx4 v32, s[52:55], s72 offen lds
    buffer_load_dwordx4 v33, s[52:55], s72 offen offset:1024 lds
    buffer_load_dwordx4 v34, s[52:55], s72 offen offset:2048 lds
    s_waitcnt vmcnt(55)
    buffer_load_dwordx4 v35, s[52:55], s72 offen offset:3072 lds
    s_mov_b32 m0, 20480
    s_nop 0
    buffer_load_dwordx4 v32, s[56:59], s72 offen lds
    buffer_load_dwordx4 v33, s[56:59], s72 offen offset:1024 lds
    buffer_load_dwordx4 v34, s[56:59], s72 offen offset:2048 lds
    buffer_load_dwordx4 v35, s[56:59], s72 offen offset:3072 lds
    s_waitcnt vmcnt(38) lgkmcnt(0)
    s_barrier
    s_lshr_b64 s[80:81], s[80:81], 4
    s_and_b32 s78, s80, 15
    s_mul_i32 s73, s78, 245760
    s_lshl_b32 s43, s78, 7
    s_mov_b32 m0, 63616
    s_nop 0
    buffer_load_dwordx4 v36, s[44:47], s43 offen lds
    buffer_load_dwordx4 v37, s[44:47], s43 offen offset:1024 lds
    buffer_load_dwordx4 v38, s[44:47], s43 offen offset:2048 lds
    buffer_load_dwordx4 v39, s[44:47], s43 offen offset:3072 lds
    s_mov_b32 m0, 39040
    s_nop 0
    buffer_load_dwordx4 v28, s[48:51], s73 offen lds
    buffer_load_dwordx4 v29, s[48:51], s73 offen offset:1024 lds
    buffer_load_dwordx4 v30, s[48:51], s73 offen offset:2048 lds
    buffer_load_dwordx4 v31, s[48:51], s73 offen offset:3072 lds
    s_mov_b32 m0, 67712
    s_nop 0
    buffer_load_dwordx4 v40, s[44:47], s43 offen lds
    buffer_load_dwordx4 v41, s[44:47], s43 offen offset:1024 lds
    buffer_load_dwordx4 v42, s[44:47], s43 offen offset:2048 lds
    buffer_load_dwordx4 v43, s[44:47], s43 offen offset:3072 lds
    s_mov_b32 m0, 47232
    s_nop 0
    buffer_load_dwordx4 v28, s[52:55], s73 offen lds
    buffer_load_dwordx4 v29, s[52:55], s73 offen offset:1024 lds
    buffer_load_dwordx4 v30, s[52:55], s73 offen offset:2048 lds
    buffer_load_dwordx4 v31, s[52:55], s73 offen offset:3072 lds
    s_mov_b32 m0, 71808
    s_nop 0
    buffer_load_dwordx4 v44, s[44:47], s43 offen lds
    buffer_load_dwordx4 v45, s[44:47], s43 offen offset:1024 lds
    buffer_load_dwordx4 v46, s[44:47], s43 offen offset:2048 lds
    buffer_load_dwordx4 v47, s[44:47], s43 offen offset:3072 lds
    s_mov_b32 m0, 55424
    s_nop 0
    buffer_load_dwordx4 v28, s[56:59], s73 offen lds
    buffer_load_dwordx4 v29, s[56:59], s73 offen offset:1024 lds
    buffer_load_dwordx4 v30, s[56:59], s73 offen offset:2048 lds
    buffer_load_dwordx4 v31, s[56:59], s73 offen offset:3072 lds
    s_mov_b32 m0, 75904
    s_nop 0
    buffer_load_dwordx4 v48, s[44:47], s43 offen lds
    s_waitcnt vmcnt(55)
    buffer_load_dwordx4 v49, s[44:47], s43 offen offset:1024 lds
    s_mov_b32 m0, 43136
    s_nop 0
    buffer_load_dwordx4 v32, s[48:51], s73 offen lds
    buffer_load_dwordx4 v33, s[48:51], s73 offen offset:1024 lds
    buffer_load_dwordx4 v34, s[48:51], s73 offen offset:2048 lds
    buffer_load_dwordx4 v35, s[48:51], s73 offen offset:3072 lds
    s_mov_b32 m0, 51328
    s_nop 0
    buffer_load_dwordx4 v32, s[52:55], s73 offen lds
    buffer_load_dwordx4 v33, s[52:55], s73 offen offset:1024 lds
    buffer_load_dwordx4 v34, s[52:55], s73 offen offset:2048 lds
    s_waitcnt vmcnt(55)
    buffer_load_dwordx4 v35, s[52:55], s73 offen offset:3072 lds
    s_mov_b32 m0, 59520
    s_nop 0
    buffer_load_dwordx4 v32, s[56:59], s73 offen lds
    buffer_load_dwordx4 v33, s[56:59], s73 offen offset:1024 lds
    buffer_load_dwordx4 v34, s[56:59], s73 offen offset:2048 lds
    buffer_load_dwordx4 v35, s[56:59], s73 offen offset:3072 lds
    s_waitcnt vmcnt(38) lgkmcnt(0)
    s_barrier
    s_lshr_b64 s[80:81], s[80:81], 4
    s_and_b32 s78, s80, 15
    s_mul_i32 s74, s78, 245760
    s_lshl_b32 s43, s78, 7
    s_mov_b32 m0, 102656
    s_nop 0
    buffer_load_dwordx4 v36, s[44:47], s43 offen lds
    buffer_load_dwordx4 v37, s[44:47], s43 offen offset:1024 lds
    buffer_load_dwordx4 v38, s[44:47], s43 offen offset:2048 lds
    buffer_load_dwordx4 v39, s[44:47], s43 offen offset:3072 lds
    s_mov_b32 m0, 78080
    s_nop 0
    buffer_load_dwordx4 v28, s[48:51], s74 offen lds
    buffer_load_dwordx4 v29, s[48:51], s74 offen offset:1024 lds
    buffer_load_dwordx4 v30, s[48:51], s74 offen offset:2048 lds
    buffer_load_dwordx4 v31, s[48:51], s74 offen offset:3072 lds
    s_mov_b32 m0, 106752
    s_nop 0
    buffer_load_dwordx4 v40, s[44:47], s43 offen lds
    buffer_load_dwordx4 v41, s[44:47], s43 offen offset:1024 lds
    buffer_load_dwordx4 v42, s[44:47], s43 offen offset:2048 lds
    buffer_load_dwordx4 v43, s[44:47], s43 offen offset:3072 lds
    s_mov_b32 m0, 86272
    s_nop 0
    buffer_load_dwordx4 v28, s[52:55], s74 offen lds
    buffer_load_dwordx4 v29, s[52:55], s74 offen offset:1024 lds
    buffer_load_dwordx4 v30, s[52:55], s74 offen offset:2048 lds
    buffer_load_dwordx4 v31, s[52:55], s74 offen offset:3072 lds
    s_mov_b32 m0, 110848
    s_nop 0
    buffer_load_dwordx4 v44, s[44:47], s43 offen lds
    buffer_load_dwordx4 v45, s[44:47], s43 offen offset:1024 lds
    buffer_load_dwordx4 v46, s[44:47], s43 offen offset:2048 lds
    buffer_load_dwordx4 v47, s[44:47], s43 offen offset:3072 lds
    s_mov_b32 m0, 82176
    s_nop 0
    buffer_load_dwordx4 v32, s[48:51], s74 offen lds
    buffer_load_dwordx4 v33, s[48:51], s74 offen offset:1024 lds
    buffer_load_dwordx4 v34, s[48:51], s74 offen offset:2048 lds
    buffer_load_dwordx4 v35, s[48:51], s74 offen offset:3072 lds
    s_mov_b32 m0, 114944
    s_nop 0
    buffer_load_dwordx4 v48, s[44:47], s43 offen lds
    s_waitcnt vmcnt(55)
    buffer_load_dwordx4 v49, s[44:47], s43 offen offset:1024 lds
    s_mov_b32 m0, 90368
    s_nop 0
    buffer_load_dwordx4 v32, s[52:55], s74 offen lds
    buffer_load_dwordx4 v33, s[52:55], s74 offen offset:1024 lds
    buffer_load_dwordx4 v34, s[52:55], s74 offen offset:2048 lds
    buffer_load_dwordx4 v35, s[52:55], s74 offen offset:3072 lds
    s_waitcnt vmcnt(30) lgkmcnt(0)
    s_barrier
    s_lshr_b64 s[80:81], s[80:81], 4
    s_and_b32 s78, s80, 15
    s_mul_i32 s75, s78, 245760
    s_lshl_b32 s43, s78, 7
    s_mov_b32 m0, 141696
    s_nop 0
    buffer_load_dwordx4 v36, s[44:47], s43 offen lds
    buffer_load_dwordx4 v37, s[44:47], s43 offen offset:1024 lds
    buffer_load_dwordx4 v38, s[44:47], s43 offen offset:2048 lds
    buffer_load_dwordx4 v39, s[44:47], s43 offen offset:3072 lds
    s_mov_b32 m0, 117120
    s_nop 0
    buffer_load_dwordx4 v28, s[48:51], s75 offen lds
    buffer_load_dwordx4 v29, s[48:51], s75 offen offset:1024 lds
    buffer_load_dwordx4 v30, s[48:51], s75 offen offset:2048 lds
    buffer_load_dwordx4 v31, s[48:51], s75 offen offset:3072 lds
    s_mov_b32 m0, 145792
    s_nop 0
    buffer_load_dwordx4 v40, s[44:47], s43 offen lds
    buffer_load_dwordx4 v41, s[44:47], s43 offen offset:1024 lds
    buffer_load_dwordx4 v42, s[44:47], s43 offen offset:2048 lds
    buffer_load_dwordx4 v43, s[44:47], s43 offen offset:3072 lds
    s_mov_b32 m0, 125312
    s_nop 0
    buffer_load_dwordx4 v28, s[52:55], s75 offen lds
    buffer_load_dwordx4 v29, s[52:55], s75 offen offset:1024 lds
    buffer_load_dwordx4 v30, s[52:55], s75 offen offset:2048 lds
    buffer_load_dwordx4 v31, s[52:55], s75 offen offset:3072 lds
    s_mov_b32 m0, 149888
    s_nop 0
    buffer_load_dwordx4 v44, s[44:47], s43 offen lds
    buffer_load_dwordx4 v45, s[44:47], s43 offen offset:1024 lds
    buffer_load_dwordx4 v46, s[44:47], s43 offen offset:2048 lds
    buffer_load_dwordx4 v47, s[44:47], s43 offen offset:3072 lds
    s_mov_b32 m0, 121216
    s_nop 0
    buffer_load_dwordx4 v32, s[48:51], s75 offen lds
    buffer_load_dwordx4 v33, s[48:51], s75 offen offset:1024 lds
    buffer_load_dwordx4 v34, s[48:51], s75 offen offset:2048 lds
    buffer_load_dwordx4 v35, s[48:51], s75 offen offset:3072 lds
    s_mov_b32 m0, 153984
    s_nop 0
    buffer_load_dwordx4 v48, s[44:47], s43 offen lds
    buffer_load_dwordx4 v49, s[44:47], s43 offen offset:1024 lds
    s_mov_b32 m0, 129408
    s_nop 0
    buffer_load_dwordx4 v32, s[52:55], s75 offen lds
    buffer_load_dwordx4 v33, s[52:55], s75 offen offset:1024 lds
    buffer_load_dwordx4 v34, s[52:55], s75 offen offset:2048 lds
    buffer_load_dwordx4 v35, s[52:55], s75 offen offset:3072 lds
    s_waitcnt vmcnt(30) lgkmcnt(0)
    s_barrier
    s_lshr_b64 s[80:81], s[80:81], 4
    s_and_b32 s78, s80, 15
    s_mul_i32 s76, s78, 245760
    s_lshl_b32 s43, s78, 7
    s_mov_b32 m0, 24576
    s_nop 0
    buffer_load_dwordx4 v36, s[44:47], s43 offen lds
    buffer_load_dwordx4 v37, s[44:47], s43 offen offset:1024 lds
    buffer_load_dwordx4 v38, s[44:47], s43 offen offset:2048 lds
    buffer_load_dwordx4 v39, s[44:47], s43 offen offset:3072 lds
    s_mov_b32 m0, 0
    s_nop 0
    buffer_load_dwordx4 v28, s[48:51], s76 offen lds
    buffer_load_dwordx4 v29, s[48:51], s76 offen offset:1024 lds
    buffer_load_dwordx4 v30, s[48:51], s76 offen offset:2048 lds
    buffer_load_dwordx4 v31, s[48:51], s76 offen offset:3072 lds
    s_mov_b32 m0, 28672
    s_nop 0
    buffer_load_dwordx4 v40, s[44:47], s43 offen lds
    buffer_load_dwordx4 v41, s[44:47], s43 offen offset:1024 lds
    buffer_load_dwordx4 v42, s[44:47], s43 offen offset:2048 lds
    buffer_load_dwordx4 v43, s[44:47], s43 offen offset:3072 lds
    s_mov_b32 m0, 8192
    s_nop 0
    buffer_load_dwordx4 v28, s[52:55], s76 offen lds
    buffer_load_dwordx4 v29, s[52:55], s76 offen offset:1024 lds
    buffer_load_dwordx4 v30, s[52:55], s76 offen offset:2048 lds
    buffer_load_dwordx4 v31, s[52:55], s76 offen offset:3072 lds
    s_mov_b32 m0, 32768
    s_nop 0
    buffer_load_dwordx4 v44, s[44:47], s43 offen lds
    buffer_load_dwordx4 v45, s[44:47], s43 offen offset:1024 lds
    buffer_load_dwordx4 v46, s[44:47], s43 offen offset:2048 lds
    buffer_load_dwordx4 v47, s[44:47], s43 offen offset:3072 lds
    s_mov_b32 m0, 4096
    s_nop 0
    buffer_load_dwordx4 v32, s[48:51], s76 offen lds
    buffer_load_dwordx4 v33, s[48:51], s76 offen offset:1024 lds
    buffer_load_dwordx4 v34, s[48:51], s76 offen offset:2048 lds
    buffer_load_dwordx4 v35, s[48:51], s76 offen offset:3072 lds
    s_mov_b32 m0, 36864
    s_nop 0
    buffer_load_dwordx4 v48, s[44:47], s43 offen lds
    buffer_load_dwordx4 v49, s[44:47], s43 offen offset:1024 lds
    s_mov_b32 m0, 12288
    s_nop 0
    buffer_load_dwordx4 v32, s[52:55], s76 offen lds
    buffer_load_dwordx4 v33, s[52:55], s76 offen offset:1024 lds
    buffer_load_dwordx4 v34, s[52:55], s76 offen offset:2048 lds
    buffer_load_dwordx4 v35, s[52:55], s76 offen offset:3072 lds
    s_waitcnt vmcnt(30) lgkmcnt(0)
    s_barrier
    s_lshr_b64 s[80:81], s[80:81], 4
    s_and_b32 s78, s80, 15
    s_mul_i32 s77, s78, 245760
    s_lshl_b32 s43, s78, 7
    s_mov_b32 m0, 63616
    s_nop 0
    buffer_load_dwordx4 v36, s[44:47], s43 offen lds
    buffer_load_dwordx4 v37, s[44:47], s43 offen offset:1024 lds
    buffer_load_dwordx4 v38, s[44:47], s43 offen offset:2048 lds
    buffer_load_dwordx4 v39, s[44:47], s43 offen offset:3072 lds
    s_mov_b32 m0, 39040
    s_nop 0
    buffer_load_dwordx4 v28, s[48:51], s77 offen lds
    buffer_load_dwordx4 v29, s[48:51], s77 offen offset:1024 lds
    buffer_load_dwordx4 v30, s[48:51], s77 offen offset:2048 lds
    buffer_load_dwordx4 v31, s[48:51], s77 offen offset:3072 lds
    s_mov_b32 m0, 67712
    s_nop 0
    buffer_load_dwordx4 v40, s[44:47], s43 offen lds
    buffer_load_dwordx4 v41, s[44:47], s43 offen offset:1024 lds
    buffer_load_dwordx4 v42, s[44:47], s43 offen offset:2048 lds
    buffer_load_dwordx4 v43, s[44:47], s43 offen offset:3072 lds
    s_mov_b32 m0, 47232
    s_nop 0
    buffer_load_dwordx4 v28, s[52:55], s77 offen lds
    buffer_load_dwordx4 v29, s[52:55], s77 offen offset:1024 lds
    buffer_load_dwordx4 v30, s[52:55], s77 offen offset:2048 lds
    buffer_load_dwordx4 v31, s[52:55], s77 offen offset:3072 lds
    s_mov_b32 m0, 71808
    s_nop 0
    buffer_load_dwordx4 v44, s[44:47], s43 offen lds
    buffer_load_dwordx4 v45, s[44:47], s43 offen offset:1024 lds
    buffer_load_dwordx4 v46, s[44:47], s43 offen offset:2048 lds
    buffer_load_dwordx4 v47, s[44:47], s43 offen offset:3072 lds
    s_mov_b32 m0, 43136
    s_nop 0
    buffer_load_dwordx4 v32, s[48:51], s77 offen lds
    buffer_load_dwordx4 v33, s[48:51], s77 offen offset:1024 lds
    buffer_load_dwordx4 v34, s[48:51], s77 offen offset:2048 lds
    buffer_load_dwordx4 v35, s[48:51], s77 offen offset:3072 lds
    s_mov_b32 m0, 75904
    s_nop 0
    buffer_load_dwordx4 v48, s[44:47], s43 offen lds
    buffer_load_dwordx4 v49, s[44:47], s43 offen offset:1024 lds
    s_mov_b32 m0, 51328
    s_nop 0
    buffer_load_dwordx4 v32, s[52:55], s77 offen lds
    buffer_load_dwordx4 v33, s[52:55], s77 offen offset:1024 lds
    buffer_load_dwordx4 v34, s[52:55], s77 offen offset:2048 lds
    buffer_load_dwordx4 v35, s[52:55], s77 offen offset:3072 lds
    s_waitcnt vmcnt(30) lgkmcnt(0)
    s_barrier
    s_lshr_b64 s[80:81], s[80:81], 4
    s_and_b32 s78, s80, 15
    s_mov_b32 m0, 94464
    s_nop 0
    buffer_load_dwordx4 v28, s[56:59], s74 offen lds
    buffer_load_dwordx4 v29, s[56:59], s74 offen offset:1024 lds
    buffer_load_dwordx4 v30, s[56:59], s74 offen offset:2048 lds
    buffer_load_dwordx4 v31, s[56:59], s74 offen offset:3072 lds
    s_mov_b32 m0, 98560
    s_nop 0
    buffer_load_dwordx4 v32, s[56:59], s74 offen lds
    buffer_load_dwordx4 v33, s[56:59], s74 offen offset:1024 lds
    buffer_load_dwordx4 v34, s[56:59], s74 offen offset:2048 lds
    buffer_load_dwordx4 v35, s[56:59], s74 offen offset:3072 lds
    s_mov_b32 m0, 133504
    s_nop 0
    buffer_load_dwordx4 v28, s[56:59], s75 offen lds
    buffer_load_dwordx4 v29, s[56:59], s75 offen offset:1024 lds
    buffer_load_dwordx4 v30, s[56:59], s75 offen offset:2048 lds
    buffer_load_dwordx4 v31, s[56:59], s75 offen offset:3072 lds
    s_waitcnt vmcnt(12) lgkmcnt(0)
    s_barrier
    s_mov_b32 m0, 137600
    s_nop 0
    buffer_load_dwordx4 v32, s[56:59], s75 offen lds
    buffer_load_dwordx4 v33, s[56:59], s75 offen offset:1024 lds
    buffer_load_dwordx4 v34, s[56:59], s75 offen offset:2048 lds
    buffer_load_dwordx4 v35, s[56:59], s75 offen offset:3072 lds
    s_mov_b32 m0, 16384
    s_nop 0
    buffer_load_dwordx4 v28, s[56:59], s76 offen lds
    buffer_load_dwordx4 v29, s[56:59], s76 offen offset:1024 lds
    buffer_load_dwordx4 v30, s[56:59], s76 offen offset:2048 lds
    buffer_load_dwordx4 v31, s[56:59], s76 offen offset:3072 lds
    s_mov_b32 m0, 20480
    s_nop 0
    buffer_load_dwordx4 v32, s[56:59], s76 offen lds
    buffer_load_dwordx4 v33, s[56:59], s76 offen offset:1024 lds
    buffer_load_dwordx4 v34, s[56:59], s76 offen offset:2048 lds
    buffer_load_dwordx4 v35, s[56:59], s76 offen offset:3072 lds
    s_mov_b32 m0, 55424
    s_nop 0
    buffer_load_dwordx4 v28, s[56:59], s77 offen lds
    buffer_load_dwordx4 v29, s[56:59], s77 offen offset:1024 lds
    buffer_load_dwordx4 v30, s[56:59], s77 offen offset:2048 lds
    buffer_load_dwordx4 v31, s[56:59], s77 offen offset:3072 lds
    s_mov_b32 m0, 59520
    s_nop 0
    buffer_load_dwordx4 v32, s[56:59], s77 offen lds
    buffer_load_dwordx4 v33, s[56:59], s77 offen offset:1024 lds
    buffer_load_dwordx4 v34, s[56:59], s77 offen offset:2048 lds
    buffer_load_dwordx4 v35, s[56:59], s77 offen offset:3072 lds
    s_mov_b32 s10, 20480
    v_lshrrev_b32 v52, 5, v1
    v_lshlrev_b32 v52, 3, v52
    v_add_u32 v53, 2, v52
    v_add_u32 v54, 4, v52
    v_add_u32 v55, 6, v52
    v_add_u32 v56, 16, v52
    v_add_u32 v57, 18, v52
    v_add_u32 v58, 20, v52
    v_add_u32 v59, 22, v52
    v_and_b32 v7, 3, v5
    v_mul_u32_u24 v7, 1280, v7
    v_add_u32 v60, v7, v50
    v_xor_b32 v61, 64, v60
    v_add_u32 v61, 4096, v61
    v_add_u32 v62, 8192, v60
    v_add_u32 v63, 8192, v61
    s_mov_b32 s5, 0xbfe10856
    s_mov_b32 s6, 0xaff80255
    s_mov_b32 s7, 0xabfe4015
    s_mov_b32 s8, 0xaa7fd005
    s_mov_b32 s9, 0x6adfb401
    s_cmp_eq_u32 s42, 1
    s_cselect_b32 s5, 0xabfe4015, s5
    s_cselect_b32 s6, 0xaa7fd005, s6
    s_cselect_b32 s7, 0x6adfb401, s7
    s_cselect_b32 s8, 0xbfe10856, s8
    s_cselect_b32 s9, 0xaff80255, s9
    s_cmp_eq_u32 s42, 2
    s_cselect_b32 s5, 0x6adfb401, s5
    s_cselect_b32 s6, 0xbfe10856, s6
    s_cselect_b32 s7, 0xaff80255, s7
    s_cselect_b32 s8, 0xabfe4015, s8
    s_cselect_b32 s9, 0xaa7fd005, s9
    s_cmp_eq_u32 s42, 3
    s_cselect_b32 s5, 0xaff80255, s5
    s_cselect_b32 s6, 0xabfe4015, s6
    s_cselect_b32 s7, 0xaa7fd005, s7
    s_cselect_b32 s8, 0x6adfb401, s8
    s_cselect_b32 s9, 0xbfe10856, s9
    s_cmp_eq_u32 s42, 4
    s_cselect_b32 s5, 0xaa7fd005, s5
    s_cselect_b32 s6, 0x6adfb401, s6
    s_cselect_b32 s7, 0xbfe10856, s7
    s_cselect_b32 s8, 0xaff80255, s8
    s_cselect_b32 s9, 0xabfe4015, s9
    s_mul_i32 s4, s42, 163840
    s_mov_b32 m0, 0
    v_bfe_u32 v64, s5, v52, 2
    v_mad_u32_u24 v64, v64, s10, v60
    buffer_load_dwordx4 v64, s[60:63], s4 offen lds
    v_bfe_u32 v65, s5, v53, 2
    v_mad_u32_u24 v65, v65, s10, v61
    buffer_load_dwordx4 v65, s[60:63], s4 offen offset:1024 lds
    v_bfe_u32 v64, s5, v54, 2
    v_mad_u32_u24 v64, v64, s10, v62
    buffer_load_dwordx4 v64, s[60:63], s4 offen offset:2048 lds
    v_bfe_u32 v65, s5, v55, 2
    v_mad_u32_u24 v65, v65, s10, v63
    buffer_load_dwordx4 v65, s[60:63], s4 offen offset:3072 lds
    s_mov_b32 m0, 4096
    v_bfe_u32 v64, s5, v56, 2
    v_mad_u32_u24 v64, v64, s10, v60
    buffer_load_dwordx4 v64, s[60:63], s4 offen lds
    v_bfe_u32 v65, s5, v57, 2
    v_mad_u32_u24 v65, v65, s10, v61
    buffer_load_dwordx4 v65, s[60:63], s4 offen offset:1024 lds
    v_bfe_u32 v64, s5, v58, 2
    v_mad_u32_u24 v64, v64, s10, v62
    buffer_load_dwordx4 v64, s[60:63], s4 offen offset:2048 lds
    v_bfe_u32 v65, s5, v59, 2
    v_mad_u32_u24 v65, v65, s10, v63
    buffer_load_dwordx4 v65, s[60:63], s4 offen offset:3072 lds
    s_add_u32 s4, s4, 81920
    s_cmp_eq_u32 s4, 819200
    s_cselect_b32 s4, 0, s4
    s_mov_b32 m0, 8192
    v_bfe_u32 v64, s6, v52, 2
    v_mad_u32_u24 v64, v64, s10, v60
    buffer_load_dwordx4 v64, s[60:63], s4 offen lds
    v_bfe_u32 v65, s6, v53, 2
    v_mad_u32_u24 v65, v65, s10, v61
    buffer_load_dwordx4 v65, s[60:63], s4 offen offset:1024 lds
    v_bfe_u32 v64, s6, v54, 2
    v_mad_u32_u24 v64, v64, s10, v62
    buffer_load_dwordx4 v64, s[60:63], s4 offen offset:2048 lds
    v_bfe_u32 v65, s6, v55, 2
    v_mad_u32_u24 v65, v65, s10, v63
    buffer_load_dwordx4 v65, s[60:63], s4 offen offset:3072 lds
    s_mov_b32 m0, 12288
    v_bfe_u32 v64, s6, v56, 2
    v_mad_u32_u24 v64, v64, s10, v60
    buffer_load_dwordx4 v64, s[60:63], s4 offen lds
    v_bfe_u32 v65, s6, v57, 2
    v_mad_u32_u24 v65, v65, s10, v61
    buffer_load_dwordx4 v65, s[60:63], s4 offen offset:1024 lds
    v_bfe_u32 v64, s6, v58, 2
    v_mad_u32_u24 v64, v64, s10, v62
    buffer_load_dwordx4 v64, s[60:63], s4 offen offset:2048 lds
    v_bfe_u32 v65, s6, v59, 2
    v_mad_u32_u24 v65, v65, s10, v63
    buffer_load_dwordx4 v65, s[60:63], s4 offen offset:3072 lds
    s_add_u32 s4, s4, 81920
    s_cmp_eq_u32 s4, 819200
    s_cselect_b32 s4, 0, s4
    s_waitcnt vmcnt(16)
    v_mov_b32 v5, 157980
    v_mov_b32 v6, 1
    s_mov_b64 exec, 1
    ds_add_u32 v5, v6
    s_mov_b64 exec, -1
    v_mov_b32 v5, 157972
    v_mov_b32 v6, 1
    s_mov_b64 exec, 1
    ds_add_u32 v5, v6
    s_mov_b64 exec, -1
    s_mov_b32 m0, 24576
    v_bfe_u32 v64, s7, v52, 2
    v_mad_u32_u24 v64, v64, s10, v60
    buffer_load_dwordx4 v64, s[60:63], s4 offen lds
    v_bfe_u32 v65, s7, v53, 2
    v_mad_u32_u24 v65, v65, s10, v61
    buffer_load_dwordx4 v65, s[60:63], s4 offen offset:1024 lds
    v_bfe_u32 v64, s7, v54, 2
    v_mad_u32_u24 v64, v64, s10, v62
    buffer_load_dwordx4 v64, s[60:63], s4 offen offset:2048 lds
    v_bfe_u32 v65, s7, v55, 2
    v_mad_u32_u24 v65, v65, s10, v63
    buffer_load_dwordx4 v65, s[60:63], s4 offen offset:3072 lds
    s_mov_b32 m0, 28672
    v_bfe_u32 v64, s7, v56, 2
    v_mad_u32_u24 v64, v64, s10, v60
    buffer_load_dwordx4 v64, s[60:63], s4 offen lds
    v_bfe_u32 v65, s7, v57, 2
    v_mad_u32_u24 v65, v65, s10, v61
    buffer_load_dwordx4 v65, s[60:63], s4 offen offset:1024 lds
    v_bfe_u32 v64, s7, v58, 2
    v_mad_u32_u24 v64, v64, s10, v62
    buffer_load_dwordx4 v64, s[60:63], s4 offen offset:2048 lds
    v_bfe_u32 v65, s7, v59, 2
    v_mad_u32_u24 v65, v65, s10, v63
    buffer_load_dwordx4 v65, s[60:63], s4 offen offset:3072 lds
    s_add_u32 s4, s4, 81920
    s_cmp_eq_u32 s4, 819200
    s_cselect_b32 s4, 0, s4
    s_mov_b32 m0, 123136
    v_bfe_u32 v64, s8, v52, 2
    v_mad_u32_u24 v64, v64, s10, v60
    buffer_load_dwordx4 v64, s[60:63], s4 offen lds
    v_bfe_u32 v65, s8, v53, 2
    v_mad_u32_u24 v65, v65, s10, v61
    buffer_load_dwordx4 v65, s[60:63], s4 offen offset:1024 lds
    v_bfe_u32 v64, s8, v54, 2
    v_mad_u32_u24 v64, v64, s10, v62
    buffer_load_dwordx4 v64, s[60:63], s4 offen offset:2048 lds
    v_bfe_u32 v65, s8, v55, 2
    v_mad_u32_u24 v65, v65, s10, v63
    buffer_load_dwordx4 v65, s[60:63], s4 offen offset:3072 lds
    s_mov_b32 m0, 127232
    v_bfe_u32 v64, s8, v56, 2
    v_mad_u32_u24 v64, v64, s10, v60
    buffer_load_dwordx4 v64, s[60:63], s4 offen lds
    v_bfe_u32 v65, s8, v57, 2
    v_mad_u32_u24 v65, v65, s10, v61
    buffer_load_dwordx4 v65, s[60:63], s4 offen offset:1024 lds
    v_bfe_u32 v64, s8, v58, 2
    v_mad_u32_u24 v64, v64, s10, v62
    buffer_load_dwordx4 v64, s[60:63], s4 offen offset:2048 lds
    v_bfe_u32 v65, s8, v59, 2
    v_mad_u32_u24 v65, v65, s10, v63
    buffer_load_dwordx4 v65, s[60:63], s4 offen offset:3072 lds
    s_add_u32 s4, s4, 81920
    s_cmp_eq_u32 s4, 819200
    s_cselect_b32 s4, 0, s4
    s_mov_b32 m0, 80000
    v_bfe_u32 v64, s9, v52, 2
    v_mad_u32_u24 v64, v64, s10, v60
    buffer_load_dwordx4 v64, s[60:63], s4 offen lds
    v_bfe_u32 v65, s9, v53, 2
    v_mad_u32_u24 v65, v65, s10, v61
    buffer_load_dwordx4 v65, s[60:63], s4 offen offset:1024 lds
    v_bfe_u32 v64, s9, v54, 2
    v_mad_u32_u24 v64, v64, s10, v62
    buffer_load_dwordx4 v64, s[60:63], s4 offen offset:2048 lds
    v_bfe_u32 v65, s9, v55, 2
    v_mad_u32_u24 v65, v65, s10, v63
    buffer_load_dwordx4 v65, s[60:63], s4 offen offset:3072 lds
    s_mov_b32 m0, 84096
    v_bfe_u32 v64, s9, v56, 2
    v_mad_u32_u24 v64, v64, s10, v60
    buffer_load_dwordx4 v64, s[60:63], s4 offen lds
    v_bfe_u32 v65, s9, v57, 2
    v_mad_u32_u24 v65, v65, s10, v61
    buffer_load_dwordx4 v65, s[60:63], s4 offen offset:1024 lds
    v_bfe_u32 v64, s9, v58, 2
    v_mad_u32_u24 v64, v64, s10, v62
    buffer_load_dwordx4 v64, s[60:63], s4 offen offset:2048 lds
    v_bfe_u32 v65, s9, v59, 2
    v_mad_u32_u24 v65, v65, s10, v63
    buffer_load_dwordx4 v65, s[60:63], s4 offen offset:3072 lds
    s_add_u32 s4, s4, 81920
    s_cmp_eq_u32 s4, 819200
    s_cselect_b32 s4, 0, s4
    s_waitcnt vmcnt(0)
    v_mov_b32 v7, 157980
    v_mov_b32 v6, 1
    s_mov_b64 exec, 1
    ds_add_u32 v7, v6
    s_mov_b64 exec, -1
Lcw_6:
    s_sub_u32 s35, s35, 1
    s_cbranch_scc1 Lend
    ds_read_b32 v6, v5
    s_waitcnt lgkmcnt(0)
    v_readfirstlane_b32 s38, v6
    s_nop 0
    s_cmp_lt_u32 s38, 8
    s_cbranch_scc1 Lcw_6
    s_lshl_b32 s36, s32, 7
    s_add_u32 s36, s36, 8257536
    v_mov_b32 v69, s36
    buffer_load_dwordx4 v[70:73], v69, s[28:31], 0 offen sc1
    v_mov_b32 v5, 157976
Lcw_7:
    s_sub_u32 s35, s35, 1
    s_cbranch_scc1 Lend
    ds_read_b32 v6, v5
    s_waitcnt lgkmcnt(0)
    v_readfirstlane_b32 s38, v6
    s_nop 0
    s_cmp_lt_u32 s38, 7
    s_cbranch_scc1 Lcw_7
    s_mov_b32 m0, 32768
    v_bfe_u32 v64, s5, v52, 2
    v_mad_u32_u24 v64, v64, s10, v60
    buffer_load_dwordx4 v64, s[60:63], s4 offen lds
    v_bfe_u32 v65, s5, v53, 2
    v_mad_u32_u24 v65, v65, s10, v61
    buffer_load_dwordx4 v65, s[60:63], s4 offen offset:1024 lds
    v_bfe_u32 v64, s5, v54, 2
    v_mad_u32_u24 v64, v64, s10, v62
    buffer_load_dwordx4 v64, s[60:63], s4 offen offset:2048 lds
    v_bfe_u32 v65, s5, v55, 2
    v_mad_u32_u24 v65, v65, s10, v63
    buffer_load_dwordx4 v65, s[60:63], s4 offen offset:3072 lds
    s_mov_b32 m0, 36864
    v_bfe_u32 v64, s5, v56, 2
    v_mad_u32_u24 v64, v64, s10, v60
    buffer_load_dwordx4 v64, s[60:63], s4 offen lds
    v_bfe_u32 v65, s5, v57, 2
    v_mad_u32_u24 v65, v65, s10, v61
    buffer_load_dwordx4 v65, s[60:63], s4 offen offset:1024 lds
    v_bfe_u32 v64, s5, v58, 2
    v_mad_u32_u24 v64, v64, s10, v62
    buffer_load_dwordx4 v64, s[60:63], s4 offen offset:2048 lds
    v_bfe_u32 v65, s5, v59, 2
    v_mad_u32_u24 v65, v65, s10, v63
    buffer_load_dwordx4 v65, s[60:63], s4 offen offset:3072 lds
    s_add_u32 s4, s4, 81920
    s_cmp_eq_u32 s4, 819200
    s_cselect_b32 s4, 0, s4
    s_mov_b32 m0, 40960
    v_bfe_u32 v64, s6, v52, 2
    v_mad_u32_u24 v64, v64, s10, v60
    buffer_load_dwordx4 v64, s[60:63], s4 offen lds
    v_bfe_u32 v65, s6, v53, 2
    v_mad_u32_u24 v65, v65, s10, v61
    buffer_load_dwordx4 v65, s[60:63], s4 offen offset:1024 lds
    v_bfe_u32 v64, s6, v54, 2
    v_mad_u32_u24 v64, v64, s10, v62
    buffer_load_dwordx4 v64, s[60:63], s4 offen offset:2048 lds
    v_bfe_u32 v65, s6, v55, 2
    v_mad_u32_u24 v65, v65, s10, v63
    buffer_load_dwordx4 v65, s[60:63], s4 offen offset:3072 lds
    s_mov_b32 m0, 45056
    v_bfe_u32 v64, s6, v56, 2
    v_mad_u32_u24 v64, v64, s10, v60
    buffer_load_dwordx4 v64, s[60:63], s4 offen lds
    v_bfe_u32 v65, s6, v57, 2
    v_mad_u32_u24 v65, v65, s10, v61
    buffer_load_dwordx4 v65, s[60:63], s4 offen offset:1024 lds
    v_bfe_u32 v64, s6, v58, 2
    v_mad_u32_u24 v64, v64, s10, v62
    buffer_load_dwordx4 v64, s[60:63], s4 offen offset:2048 lds
    v_bfe_u32 v65, s6, v59, 2
    v_mad_u32_u24 v65, v65, s10, v63
    buffer_load_dwordx4 v65, s[60:63], s4 offen offset:3072 lds
    s_add_u32 s4, s4, 81920
    s_cmp_eq_u32 s4, 819200
    s_cselect_b32 s4, 0, s4
    s_mov_b32 m0, 63616
    v_bfe_u32 v64, s7, v52, 2
    v_mad_u32_u24 v64, v64, s10, v60
    buffer_load_dwordx4 v64, s[60:63], s4 offen lds
    v_bfe_u32 v65, s7, v53, 2
    v_mad_u32_u24 v65, v65, s10, v61
    buffer_load_dwordx4 v65, s[60:63], s4 offen offset:1024 lds
    v_bfe_u32 v64, s7, v54, 2
    v_mad_u32_u24 v64, v64, s10, v62
    buffer_load_dwordx4 v64, s[60:63], s4 offen offset:2048 lds
    v_bfe_u32 v65, s7, v55, 2
    v_mad_u32_u24 v65, v65, s10, v63
    buffer_load_dwordx4 v65, s[60:63], s4 offen offset:3072 lds
    s_mov_b32 m0, 67712
    v_bfe_u32 v64, s7, v56, 2
    v_mad_u32_u24 v64, v64, s10, v60
    buffer_load_dwordx4 v64, s[60:63], s4 offen lds
    v_bfe_u32 v65, s7, v57, 2
    v_mad_u32_u24 v65, v65, s10, v61
    buffer_load_dwordx4 v65, s[60:63], s4 offen offset:1024 lds
    v_bfe_u32 v64, s7, v58, 2
    v_mad_u32_u24 v64, v64, s10, v62
    buffer_load_dwordx4 v64, s[60:63], s4 offen offset:2048 lds
    v_bfe_u32 v65, s7, v59, 2
    v_mad_u32_u24 v65, v65, s10, v63
    buffer_load_dwordx4 v65, s[60:63], s4 offen offset:3072 lds
    s_add_u32 s4, s4, 81920
    s_cmp_eq_u32 s4, 819200
    s_cselect_b32 s4, 0, s4
    s_mov_b32 m0, 71808
    v_bfe_u32 v64, s8, v52, 2
    v_mad_u32_u24 v64, v64, s10, v60
    buffer_load_dwordx4 v64, s[60:63], s4 offen lds
    v_bfe_u32 v65, s8, v53, 2
    v_mad_u32_u24 v65, v65, s10, v61
    buffer_load_dwordx4 v65, s[60:63], s4 offen offset:1024 lds
    v_bfe_u32 v64, s8, v54, 2
    v_mad_u32_u24 v64, v64, s10, v62
    buffer_load_dwordx4 v64, s[60:63], s4 offen offset:2048 lds
    v_bfe_u32 v65, s8, v55, 2
    v_mad_u32_u24 v65, v65, s10, v63
    buffer_load_dwordx4 v65, s[60:63], s4 offen offset:3072 lds
    s_mov_b32 m0, 75904
    v_bfe_u32 v64, s8, v56, 2
    v_mad_u32_u24 v64, v64, s10, v60
    buffer_load_dwordx4 v64, s[60:63], s4 offen lds
    v_bfe_u32 v65, s8, v57, 2
    v_mad_u32_u24 v65, v65, s10, v61
    buffer_load_dwordx4 v65, s[60:63], s4 offen offset:1024 lds
    v_bfe_u32 v64, s8, v58, 2
    v_mad_u32_u24 v64, v64, s10, v62
    buffer_load_dwordx4 v64, s[60:63], s4 offen offset:2048 lds
    v_bfe_u32 v65, s8, v59, 2
    v_mad_u32_u24 v65, v65, s10, v63
    buffer_load_dwordx4 v65, s[60:63], s4 offen offset:3072 lds
    s_add_u32 s4, s4, 81920
    s_cmp_eq_u32 s4, 819200
    s_cselect_b32 s4, 0, s4
    s_mov_b32 m0, 49152
    v_bfe_u32 v64, s9, v52, 2
    v_mad_u32_u24 v64, v64, s10, v60
    buffer_load_dwordx4 v64, s[60:63], s4 offen lds
    v_bfe_u32 v65, s9, v53, 2
    v_mad_u32_u24 v65, v65, s10, v61
    buffer_load_dwordx4 v65, s[60:63], s4 offen offset:1024 lds
    v_bfe_u32 v64, s9, v54, 2
    v_mad_u32_u24 v64, v64, s10, v62
    buffer_load_dwordx4 v64, s[60:63], s4 offen offset:2048 lds
    v_bfe_u32 v65, s9, v55, 2
    v_mad_u32_u24 v65, v65, s10, v63
    buffer_load_dwordx4 v65, s[60:63], s4 offen offset:3072 lds
    s_mov_b32 m0, 88192
    v_bfe_u32 v64, s9, v56, 2
    v_mad_u32_u24 v64, v64, s10, v60
    buffer_load_dwordx4 v64, s[60:63], s4 offen lds
    v_bfe_u32 v65, s9, v57, 2
    v_mad_u32_u24 v65, v65, s10, v61
    buffer_load_dwordx4 v65, s[60:63], s4 offen offset:1024 lds
    v_bfe_u32 v64, s9, v58, 2
    v_mad_u32_u24 v64, v64, s10, v62
    buffer_load_dwordx4 v64, s[60:63], s4 offen offset:2048 lds
    v_bfe_u32 v65, s9, v59, 2
    v_mad_u32_u24 v65, v65, s10, v63
    buffer_load_dwordx4 v65, s[60:63], s4 offen offset:3072 lds
    s_add_u32 s4, s4, 81920
    s_cmp_eq_u32 s4, 819200
    s_cselect_b32 s4, 0, s4
    s_waitcnt vmcnt(0)
Lbc:
    v_readfirstlane_b32 s11, v70
    v_readfirstlane_b32 s36, v71
    v_readfirstlane_b32 s12, v72
    v_readfirstlane_b32 s37, v73
    s_cmp_eq_u32 s36, s34
    s_cselect_b32 s37, s37, s36
    s_cmp_eq_u32 s37, s34
    s_cbranch_scc1 Lbc_ok
    s_sub_u32 s35, s35, 1
    s_cbranch_scc1 Lend
    buffer_load_dwordx4 v[70:73], v69, s[28:31], 0 offen sc1
    s_waitcnt vmcnt(0)
    s_branch Lbc
Lbc_ok:
    s_mul_i32 s36, s32, 96
    s_and_b32 s13, s11, 0x7ff
    s_sub_u32 s13, 2047, s13
    s_sub_u32 s37, s13, s36
    s_cmp_lt_u32 s37, 96
    s_cselect_b32 s13, s13, -1
    s_and_b32 s14, s12, 0x7ff
    s_sub_u32 s14, 2047, s14
    s_sub_u32 s37, s14, s36
    s_cmp_lt_u32 s37, 96
    s_cselect_b32 s14, s14, -1
    v_mov_b32 v4, s13
    v_mov_b32 v5, s14
    v_mov_b32 v6, 157960
    ds_write_b64 v6, v[4:5]
    s_and_b32 s37, s13, s14
    s_cmp_eq_u32 s37, -1
    s_cbranch_scc1 Lw0_done
    s_max_i32 s36, s13, 0
    s_mul_i32 s36, s36, 1280
    s_lshl_b32 s37, s33, 7
    s_add_u32 s36, s36, s37
    s_add_u32 s36, s36, 4096
    v_lshlrev_b32 v8, 1, v1
    buffer_load_ushort v124, v8, s[44:47], s36 offen
    s_max_i32 s36, s14, 0
    s_mul_i32 s36, s36, 1280
    s_lshl_b32 s37, s33, 7
    s_add_u32 s36, s36, s37
    s_add_u32 s36, s36, 4096
    v_lshlrev_b32 v8, 1, v1
    buffer_load_ushort v125, v8, s[44:47], s36 offen
    v_min_u32 v7, 26, v1
    v_mul_u32_u24 v7, 10240, v7
Ly_poll:
    s_sub_u32 s35, s35, 1
    s_cbranch_scc1 Lend
    s_sleep 20
    s_lshl_b32 s36, s33, 10
    s_add_u32 s36, s36, 7405568
    buffer_load_dword v4, v7, s[28:31], s36 offen offset:1020 sc1
    s_waitcnt vmcnt(0)
    v_cmp_ne_u32 vcc, s34, v4
    s_nop 0
    s_cbranch_vccnz Ly_poll
    buffer_load_dwordx4 v[16:19], v13, s[28:31], s36 offen sc1
    s_add_u32 s36, s36, 10240
    buffer_load_dwordx4 v[20:23], v13, s[28:31], s36 offen sc1
    s_add_u32 s36, s36, 10240
    buffer_load_dwordx4 v[24:27], v13, s[28:31], s36 offen sc1
    s_add_u32 s36, s36, 10240
    buffer_load_dwordx4 v[28:31], v13, s[28:31], s36 offen sc1
    s_add_u32 s36, s36, 10240
    buffer_load_dwordx4 v[32:35], v13, s[28:31], s36 offen sc1
    s_add_u32 s36, s36, 10240
    buffer_load_dwordx4 v[36:39], v13, s[28:31], s36 offen sc1
    s_add_u32 s36, s36, 10240
    buffer_load_dwordx4 v[40:43], v13, s[28:31], s36 offen sc1
    s_add_u32 s36, s36, 10240
    buffer_load_dwordx4 v[44:47], v13, s[28:31], s36 offen sc1
    s_add_u32 s36, s36, 10240
    buffer_load_dwordx4 v[48:51], v13, s[28:31], s36 offen sc1
    s_add_u32 s36, s36, 10240
    buffer_load_dwordx4 v[52:55], v13, s[28:31], s36 offen sc1
    s_add_u32 s36, s36, 10240
    buffer_load_dwordx4 v[56:59], v13, s[28:31], s36 offen sc1
    s_add_u32 s36, s36, 10240
    buffer_load_dwordx4 v[60:63], v13, s[28:31], s36 offen sc1
    s_add_u32 s36, s36, 10240
    buffer_load_dwordx4 v[64:67], v13, s[28:31], s36 offen sc1
    s_add_u32 s36, s36, 10240
    buffer_load_dwordx4 v[68:71], v13, s[28:31], s36 offen sc1
    s_add_u32 s36, s36, 10240
    buffer_load_dwordx4 v[72:75], v13, s[28:31], s36 offen sc1
    s_add_u32 s36, s36, 10240
    buffer_load_dwordx4 v[76:79], v13, s[28:31], s36 offen sc1
    s_add_u32 s36, s36, 10240
    buffer_load_dwordx4 v[80:83], v13, s[28:31], s36 offen sc1
    s_add_u32 s36, s36, 10240
    buffer_load_dwordx4 v[84:87], v13, s[28:31], s36 offen sc1
    s_add_u32 s36, s36, 10240
    buffer_load_dwordx4 v[88:91], v13, s[28:31], s36 offen sc1
    s_add_u32 s36, s36, 10240
    buffer_load_dwordx4 v[92:95], v13, s[28:31], s36 offen sc1
    s_add_u32 s36, s36, 10240
    buffer_load_dwordx4 v[96:99], v13, s[28:31], s36 offen sc1
    s_add_u32 s36, s36, 10240
    buffer_load_dwordx4 v[100:103], v13, s[28:31], s36 offen sc1
    s_add_u32 s36, s36, 10240
    buffer_load_dwordx4 v[104:107], v13, s[28:31], s36 offen sc1
    s_add_u32 s36, s36, 10240
    buffer_load_dwordx4 v[108:111], v13, s[28:31], s36 offen sc1
    s_add_u32 s36, s36, 10240
    buffer_load_dwordx4 v[112:115], v13, s[28:31], s36 offen sc1
    s_add_u32 s36, s36, 10240
    buffer_load_dwordx4 v[116:119], v13, s[28:31], s36 offen sc1
    s_add_u32 s36, s36, 10240
    buffer_load_dwordx4 v[120:123], v13, s[28:31], s36 offen sc1
    s_add_u32 s36, s36, 10240
    s_waitcnt vmcnt(0)
    v_xor_b32 v4, s34, v17
    v_xor_b32 v5, s34, v19
    v_or_b32 v4, v4, v5
    v_xor_b32 v5, s34, v21
    v_or_b32 v4, v4, v5
    v_xor_b32 v5, s34, v23
    v_or_b32 v4, v4, v5
    v_xor_b32 v5, s34, v25
    v_or_b32 v4, v4, v5
    v_xor_b32 v5, s34, v27
    v_or_b32 v4, v4, v5
    v_xor_b32 v5, s34, v29
    v_or_b32 v4, v4, v5
    v_xor_b32 v5, s34, v31
    v_or_b32 v4, v4, v5
    v_xor_b32 v5, s34, v33
    v_or_b32 v4, v4, v5
    v_xor_b32 v5, s34, v35
    v_or_b32 v4, v4, v5
    v_xor_b32 v5, s34, v37
    v_or_b32 v4, v4, v5
    v_xor_b32 v5, s34, v39
    v_or_b32 v4, v4, v5
    v_xor_b32 v5, s34, v41
    v_or_b32 v4, v4, v5
    v_xor_b32 v5, s34, v43
    v_or_b32 v4, v4, v5
    v_xor_b32 v5, s34, v45
    v_or_b32 v4, v4, v5
    v_xor_b32 v5, s34, v47
    v_or_b32 v4, v4, v5
    v_xor_b32 v5, s34, v49
    v_or_b32 v4, v4, v5
    v_xor_b32 v5, s34, v51
    v_or_b32 v4, v4, v5
    v_xor_b32 v5, s34, v53
    v_or_b32 v4, v4, v5
    v_xor_b32 v5, s34, v55
    v_or_b32 v4, v4, v5
    v_xor_b32 v5, s34, v57
    v_or_b32 v4, v4, v5
    v_xor_b32 v5, s34, v59
    v_or_b32 v4, v4, v5
    v_xor_b32 v5, s34, v61
    v_or_b32 v4, v4, v5
    v_xor_b32 v5, s34, v63
    v_or_b32 v4, v4, v5
    v_xor_b32 v5, s34, v65
    v_or_b32 v4, v4, v5
    v_xor_b32 v5, s34, v67
    v_or_b32 v4, v4, v5
    v_xor_b32 v5, s34, v69
    v_or_b32 v4, v4, v5
    v_xor_b32 v5, s34, v71
    v_or_b32 v4, v4, v5
    v_xor_b32 v5, s34, v73
    v_or_b32 v4, v4, v5
    v_xor_b32 v5, s34, v75
    v_or_b32 v4, v4, v5
    v_xor_b32 v5, s34, v77
    v_or_b32 v4, v4, v5
    v_xor_b32 v5, s34, v79
    v_or_b32 v4, v4, v5
    v_xor_b32 v5, s34, v81
    v_or_b32 v4, v4, v5
    v_xor_b32 v5, s34, v83
    v_or_b32 v4, v4, v5
    v_xor_b32 v5, s34, v85
    v_or_b32 v4, v4, v5
    v_xor_b32 v5, s34, v87
    v_or_b32 v4, v4, v5
    v_xor_b32 v5, s34, v89
    v_or_b32 v4, v4, v5
    v_xor_b32 v5, s34, v91
    v_or_b32 v4, v4, v5
    v_xor_b32 v5, s34, v93
    v_or_b32 v4, v4, v5
    v_xor_b32 v5, s34, v95
    v_or_b32 v4, v4, v5
    v_xor_b32 v5, s34, v97
    v_or_b32 v4, v4, v5
    v_xor_b32 v5, s34, v99
    v_or_b32 v4, v4, v5
    v_xor_b32 v5, s34, v101
    v_or_b32 v4, v4, v5
    v_xor_b32 v5, s34, v103
    v_or_b32 v4, v4, v5
    v_xor_b32 v5, s34, v105
    v_or_b32 v4, v4, v5
    v_xor_b32 v5, s34, v107
    v_or_b32 v4, v4, v5
    v_xor_b32 v5, s34, v109
    v_or_b32 v4, v4, v5
    v_xor_b32 v5, s34, v111
    v_or_b32 v4, v4, v5
    v_xor_b32 v5, s34, v113
    v_or_b32 v4, v4, v5
    v_xor_b32 v5, s34, v115
    v_or_b32 v4, v4, v5
    v_xor_b32 v5, s34, v117
    v_or_b32 v4, v4, v5
    v_xor_b32 v5, s34, v119
    v_or_b32 v4, v4, v5
    v_xor_b32 v5, s34, v121
    v_or_b32 v4, v4, v5
    v_xor_b32 v5, s34, v123
    v_or_b32 v4, v4, v5
    v_cmp_ne_u32 vcc, 0, v4
    s_nop 0
    s_cmp_lg_u64 vcc, 0
    s_cbranch_scc1 Ly_poll
    v_add_f32 v16, v16, v20
    v_add_f32 v18, v18, v22
    v_add_f32 v16, v16, v24
    v_add_f32 v18, v18, v26
    v_add_f32 v16, v16, v28
    v_add_f32 v18, v18, v30
    v_add_f32 v16, v16, v32
    v_add_f32 v18, v18, v34
    v_add_f32 v16, v16, v36
    v_add_f32 v18, v18, v38
    v_add_f32 v16, v16, v40
    v_add_f32 v18, v18, v42
    v_add_f32 v16, v16, v44
    v_add_f32 v18, v18, v46
    v_add_f32 v16, v16, v48
    v_add_f32 v18, v18, v50
    v_add_f32 v16, v16, v52
    v_add_f32 v18, v18, v54
    v_add_f32 v16, v16, v56
    v_add_f32 v18, v18, v58
    v_add_f32 v16, v16, v60
    v_add_f32 v18, v18, v62
    v_add_f32 v16, v16, v64
    v_add_f32 v18, v18, v66
    v_add_f32 v16, v16, v68
    v_add_f32 v18, v18, v70
    v_add_f32 v16, v16, v72
    v_add_f32 v18, v18, v74
    v_add_f32 v16, v16, v76
    v_add_f32 v18, v18, v78
    v_add_f32 v16, v16, v80
    v_add_f32 v18, v18, v82
    v_add_f32 v16, v16, v84
    v_add_f32 v18, v18, v86
    v_add_f32 v16, v16, v88
    v_add_f32 v18, v18, v90
    v_add_f32 v16, v16, v92
    v_add_f32 v18, v18, v94
    v_add_f32 v16, v16, v96
    v_add_f32 v18, v18, v98
    v_add_f32 v16, v16, v100
    v_add_f32 v18, v18, v102
    v_add_f32 v16, v16, v104
    v_add_f32 v18, v18, v106
    v_add_f32 v16, v16, v108
    v_add_f32 v18, v18, v110
    v_add_f32 v16, v16, v112
    v_add_f32 v18, v18, v114
    v_add_f32 v16, v16, v116
    v_add_f32 v18, v18, v118
    v_add_f32 v16, v16, v120
    v_add_f32 v18, v18, v122
    s_lshr_b32 s36, s11, 16
    s_cmp_ge_u32 s36, 0x8000
    s_cselect_b32 s37, 0x8000, -1
    s_xor_b32 s36, s36, s37
    s_lshl_b32 s36, s36, 16
    v_mov_b32 v4, s36
    v_mul_f32 v4, 0xbfb8aa3b, v4
    v_exp_f32 v4, v4
    s_nop 0
    v_add_f32 v4, 1.0, v4
    v_rcp_f32 v4, v4
    s_nop 0
    v_cvt_pk_bf16_f32 v4, v4, v4
    v_lshlrev_b32 v4, 16, v4
    v_cvt_pk_bf16_f32 v16, v16, v16
    v_lshlrev_b32 v16, 16, v16
    v_mul_f32 v16, v16, v4
    v_cvt_pk_bf16_f32 v16, v16, v16
    v_lshlrev_b32 v16, 16, v16
    s_lshr_b32 s36, s12, 16
    s_cmp_ge_u32 s36, 0x8000
    s_cselect_b32 s37, 0x8000, -1
    s_xor_b32 s36, s36, s37
    s_lshl_b32 s36, s36, 16
    v_mov_b32 v4, s36
    v_mul_f32 v4, 0xbfb8aa3b, v4
    v_exp_f32 v4, v4
    s_nop 0
    v_add_f32 v4, 1.0, v4
    v_rcp_f32 v4, v4
    s_nop 0
    v_cvt_pk_bf16_f32 v4, v4, v4
    v_lshlrev_b32 v4, 16, v4
    v_cvt_pk_bf16_f32 v18, v18, v18
    v_lshlrev_b32 v18, 16, v18
    v_mul_f32 v18, v18, v4
    v_cvt_pk_bf16_f32 v18, v18, v18
    v_lshlrev_b32 v18, 16, v18
    s_mul_i32 s36, s32, 96
    s_sub_u32 s36, s13, s36
    s_max_i32 s36, s36, 0
    s_lshl_b32 s36, s36, 2
    s_add_u32 s36, s36, 156288
    v_mov_b32 v4, s36
    ds_read2st64_b32 v[4:5], v4 offset0:0 offset1:2
    v_lshlrev_b32 v124, 16, v124
    s_waitcnt lgkmcnt(0)
    v_add_f32 v20, v124, v4
    v_cvt_pk_bf16_f32 v20, v20, v20
    v_lshlrev_b32 v20, 16, v20
    v_mul_f32 v20, v20, v5
    v_cvt_pk_bf16_f32 v20, v20, v20
    v_lshlrev_b32 v20, 16, v20
    v_add_f32 v20, v20, v16
    v_cvt_pk_bf16_f32 v20, v20, v20
    v_lshlrev_b32 v20, 16, v20
    v_mul_f32 v16, 0xbfb8aa3b, v20
    v_exp_f32 v16, v16
    s_nop 0
    v_add_f32 v16, 1.0, v16
    v_rcp_f32 v16, v16
    s_nop 0
    v_mul_f32 v16, v16, v20
    v_cvt_pk_bf16_f32 v16, v16, v16
    v_lshlrev_b32 v16, 16, v16
    s_mul_i32 s36, s32, 96
    s_sub_u32 s36, s14, s36
    s_max_i32 s36, s36, 0
    s_lshl_b32 s36, s36, 2
    s_add_u32 s36, s36, 156288
    v_mov_b32 v4, s36
    ds_read2st64_b32 v[4:5], v4 offset0:0 offset1:2
    v_lshlrev_b32 v125, 16, v125
    s_waitcnt lgkmcnt(0)
    v_add_f32 v22, v125, v4
    v_cvt_pk_bf16_f32 v22, v22, v22
    v_lshlrev_b32 v22, 16, v22
    v_mul_f32 v22, v22, v5
    v_cvt_pk_bf16_f32 v22, v22, v22
    v_lshlrev_b32 v22, 16, v22
    v_add_f32 v22, v22, v18
    v_cvt_pk_bf16_f32 v22, v22, v22
    v_lshlrev_b32 v22, 16, v22
    v_mul_f32 v18, 0xbfb8aa3b, v22
    v_exp_f32 v18, v18
    s_nop 0
    v_add_f32 v18, 1.0, v18
    v_rcp_f32 v18, v18
    s_nop 0
    v_mul_f32 v18, v18, v22
    v_cvt_pk_bf16_f32 v18, v18, v18
    v_lshlrev_b32 v18, 16, v18
    s_cmp_lg_u32 s13, -1
    s_cselect_b32 s39, 4, 0
    s_cmp_lg_u32 s14, -1
    s_cselect_b32 s36, 4, 0
    s_add_u32 s39, s39, s36
    v_mov_b32 v5, 157956
Lcw_8:
    s_sub_u32 s35, s35, 1
    s_cbranch_scc1 Lend
    ds_read_b32 v6, v5
    s_waitcnt lgkmcnt(0)
    v_readfirstlane_b32 s38, v6
    s_nop 0
    s_cmp_lt_u32 s38, s39
    s_cbranch_scc1 Lcw_8
    v_add_u32 v5, 158208, v12
    ds_read2st64_b32 v[126:127], v5 offset0:0 offset1:1
    s_waitcnt lgkmcnt(0)
    v_fma_f32 v16, v126, v16, v124
    v_cvt_pk_bf16_f32 v16, v16, v16
    s_mul_i32 s36, s13, 1280
    s_lshl_b32 s37, s33, 7
    s_add_u32 s36, s36, s37
    s_cmp_eq_u32 s13, -1
    s_cbranch_scc1 Lrow0
    buffer_store_short v16, v8, s[64:67], s36 offen
Lrow0:
    v_fma_f32 v18, v127, v18, v125
    v_cvt_pk_bf16_f32 v18, v18, v18
    s_mul_i32 s36, s14, 1280
    s_lshl_b32 s37, s33, 7
    s_add_u32 s36, s36, s37
    s_cmp_eq_u32 s14, -1
    s_cbranch_scc1 Lrow1
    buffer_store_short v18, v8, s[64:67], s36 offen
Lrow1:
Lw0_done:
    s_endpgm
Lcomp:
    s_lshl_b32 s43, s26, 1
    s_add_u32 s43, s43, s27
    s_sub_u32 s36, s33, 5
    s_cmp_ge_u32 s33, 5
    s_cselect_b32 s40, s36, s33
    s_mov_b32 s41, 0xbfe10856
    s_cmp_eq_u32 s40, 1
    s_cselect_b32 s41, 0xaff80255, s41
    s_cmp_eq_u32 s40, 2
    s_cselect_b32 s41, 0xabfe4015, s41
    s_cmp_eq_u32 s40, 3
    s_cselect_b32 s41, 0xaa7fd005, s41
    s_cmp_eq_u32 s40, 4
    s_cselect_b32 s41, 0x6adfb401, s41
    s_lshl_b32 s37, s27, 13
    s_cmp_eq_u32 s43, 1
    s_cselect_b32 s37, 0, s37
    v_bfe_u32 v7, v1, 2, 2
    v_and_b32 v8, 3, v1
    v_lshl_add_u32 v18, v2, 3, v7
    v_lshlrev_b32 v18, 7, v18
    v_lshlrev_b32 v19, 2, v1
    v_and_b32 v19, 0x60, v19
    v_lshlrev_b32 v10, 1, v8
    v_add_u32 v9, s37, v18
    v_add_u32 v11, 0, v10
    v_bfe_u32 v11, s41, v11, 2
    v_lshl_add_u32 v11, v11, 2, v8
    v_lshlrev_b32 v11, 3, v11
    v_xad_u32 v20, v11, v19, v9
    v_add_u32 v11, 8, v10
    v_bfe_u32 v11, s41, v11, 2
    v_lshl_add_u32 v11, v11, 2, v8
    v_lshlrev_b32 v11, 3, v11
    v_xad_u32 v21, v11, v19, v9
    v_add_u32 v11, 16, v10
    v_bfe_u32 v11, s41, v11, 2
    v_lshl_add_u32 v11, v11, 2, v8
    v_lshlrev_b32 v11, 3, v11
    v_xad_u32 v22, v11, v19, v9
    v_add_u32 v11, 24, v10
    v_bfe_u32 v11, s41, v11, 2
    v_lshl_add_u32 v11, v11, 2, v8
    v_lshlrev_b32 v11, 3, v11
    v_xad_u32 v23, v11, v19, v9
    v_add_u32 v24, 78080, v20
    v_add_u32 v25, 78080, v21
    v_add_u32 v26, 78080, v22
    v_add_u32 v27, 78080, v23
    v_lshrrev_b32 v10, 1, v3
    v_xor_b32 v9, v10, v2
    v_lshlrev_b32 v9, 4, v9
    v_lshl_add_u32 v9, v3, 7, v9
    s_lshl_b32 s36, s43, 11
    s_xor_b32 s38, s36, 2048
    s_add_u32 s36, s36, 22528
    s_add_u32 s38, s38, 22528
    v_add_u32 v76, s36, v9
    v_add_u32 v78, s38, v9
    s_mul_i32 s39, s26, 6144
    s_add_u32 s39, s39, 98560
    v_add_u32 v125, s39, v13
    s_lshl_b32 s48, s43, 11
    s_add_u32 s48, s48, 139648
    s_waitcnt lgkmcnt(0)
    s_mov_b64 s[28:29], s[24:25]
    s_mov_b32 s30, 268435456
    s_mov_b32 s31, 0x20000
    s_load_dword s34, s[28:29], 0
    s_cmp_eq_u32 s43, 1
    s_cbranch_scc1 Lhalo
    v_xor_b32 v77, 64, v76
    v_xor_b32 v79, 64, v78
    v_add_u32 v80, 78080, v76
    v_add_u32 v81, 78080, v77
    v_add_u32 v82, 78080, v78
    v_add_u32 v83, 78080, v79
    s_cmp_eq_u32 s27, 0
    s_cselect_b64 vcc, 0, -1
    s_sub_u32 s37, 16384, s37
    v_cndmask_b32 v84, v20, v22, vcc
    v_cndmask_b32 v85, v21, v23, vcc
    v_add_u32 v84, s37, v84
    v_add_u32 v85, s37, v85
    v_add_u32 v86, 78080, v84
    v_add_u32 v87, 78080, v85
    v_lshrrev_b32 v8, 1, v2
    v_xor_b32 v8, v8, v10
    v_lshlrev_b32 v8, 4, v8
    v_lshl_add_u32 v8, v3, 7, v8
    v_and_b32 v7, 1, v2
    v_lshl_add_u32 v124, v7, 3, v8
    s_lshl_b32 s49, s42, 12
    s_mov_b32 s38, 0x84736210
    s_mov_b32 s39, 0x95
    s_cmp_eq_u32 s42, 1
    s_cselect_b32 s38, 0x83712065, s38
    s_cselect_b32 s39, 0x94, s39
    s_cmp_eq_u32 s42, 2
    s_cselect_b32 s38, 0x81307564, s38
    s_cselect_b32 s39, 0x92, s39
    s_cmp_eq_u32 s42, 3
    s_cselect_b32 s38, 0x40857362, s38
    s_cselect_b32 s39, 0x91, s39
    s_cmp_eq_u32 s42, 4
    s_cselect_b32 s38, 0x94837261, s38
    s_cselect_b32 s39, 0x50, s39
    s_lshl_b32 s42, s33, 2
    s_lshr_b64 s[38:39], s[38:39], s42
    s_and_b32 s42, s38, 15
    s_and_b32 s38, s42, 3
    s_mul_i32 s38, s38, 39040
    s_add_u32 s38, s38, s36
    v_add_u32 v4, s38, v124
    v_xor_b32 v5, 32, v4
    v_xor_b32 v6, 64, v4
    v_xor_b32 v7, 0x60, v4
    s_mov_b64 s[44:45], s[20:21]
    s_mov_b32 s46, 2621440
    s_mov_b32 s47, 0x20000
    v_mov_b32 v14, 0x3f803f80
    v_mov_b32 v15, 0x3f803f80
    v_mov_b32 v16, 0x3f803f80
    v_mov_b32 v17, 0x3f803f80
    s_mov_b32 s4, 0xaae00455
    s_cmp_eq_u32 s40, 1
    s_cselect_b32 s4, 0xaaf80155, s4
    s_cmp_eq_u32 s40, 2
    s_cselect_b32 s4, 0xaafe4055, s4
    s_cmp_eq_u32 s40, 3
    s_cselect_b32 s4, 0xaabfd055, s4
    s_cmp_eq_u32 s40, 4
    s_cselect_b32 s4, 0xaaeff455, s4
    v_lshlrev_b32 v10, 1, v2
    v_add_u32 v10, 8, v10
    v_bfe_u32 v10, s4, v10, 2
    v_cmp_eq_u32 s[6:7], 0, v10
    v_cmp_eq_u32 s[8:9], 3, v10
    v_cmp_eq_u32 s[10:11], 1, v10
    v_lshlrev_b32 v10, 1, v2
    v_add_u32 v10, 16, v10
    v_bfe_u32 v10, s4, v10, 2
    v_cmp_eq_u32 s[12:13], 0, v10
    v_cmp_eq_u32 s[14:15], 3, v10
    v_cmp_eq_u32 s[16:17], 2, v10
    s_mov_b32 s4, 0xaaaaaaaa
    s_mov_b32 s5, 0xaaaaaaaa
    s_mov_b32 s18, 0xfff0ffff
    s_mov_b32 s19, 0xf000ff00
    s_mov_b32 s20, 0xffc0fffc
    s_mov_b32 s21, 0xc000fc00
    v_mov_b32 v8, 0xffff
    v_not_b32 v9, v8
    v_cndmask_b32 v8, v8, v9, s[4:5]
    v_cndmask_b32 v118, 0, v8, s[18:19]
    v_cndmask_b32 v119, 0, v8, s[20:21]
    v_xor_b32 v116, v118, v8
    v_xor_b32 v117, v119, v8
    s_cmp_eq_u32 s32, 0
    s_cselect_b32 s36, s43, 0
    s_cmp_eq_u32 s36, 2
    s_cselect_b32 s22, 0xff800000, 0
    s_mul_i32 s36, s32, 6
    s_add_u32 s36, s36, s43
    s_sub_u32 s36, s36, 2
    s_lshl_b32 s24, s36, 7
    s_add_u32 s24, s24, 7340032
    s_mul_i32 s50, s36, 20480
    s_add_u32 s50, s50, 4194304
    s_lshl_b32 s36, s33, 11
    s_add_u32 s23, s36, s50
    s_add_u32 s51, s50, s49
    s_add_u32 s49, s49, 4096
    s_cmp_eq_u32 s49, 20480
    s_cselect_b32 s49, 0, s49
    s_add_u32 s52, s50, s49
    s_add_u32 s49, s49, 4096
    s_cmp_eq_u32 s49, 20480
    s_cselect_b32 s49, 0, s49
    s_add_u32 s53, s50, s49
    s_add_u32 s49, s49, 4096
    s_cmp_eq_u32 s49, 20480
    s_cselect_b32 s49, 0, s49
    s_add_u32 s54, s50, s49
    s_add_u32 s49, s49, 4096
    s_cmp_eq_u32 s49, 20480
    s_cselect_b32 s49, 0, s49
    s_add_u32 s55, s50, s49
    s_add_u32 s49, s49, 4096
    s_cmp_eq_u32 s49, 20480
    s_cselect_b32 s49, 0, s49
    s_mul_i32 s36, s32, 10
    s_add_u32 s36, s36, s33
    s_mul_i32 s56, s36, 6144
    s_lshl_b32 s36, s43, 10
    s_add_u32 s56, s56, s36
    s_add_u32 s56, s56, 1046528
    s_sub_u32 s57, s56, 6144
    s_add_u32 s58, s56, 6144
    s_cmp_eq_u32 s40, 0
    s_cselect_b32 s59, 0, -1
    s_cmp_eq_u32 s40, 4
    s_cselect_b32 s60, 0, -1
    s_lshl_b32 s36, s33, 2
    v_mov_b32 v97, s36
    s_mov_b32 s25, 0x3ea52b5c
    s_lshl_b32 s36, s43, 6
    s_add_u32 s36, s36, 156160
    v_lshl_add_u32 v94, v3, 2, s36
    v_and_b32 v8, 1, v1
    v_lshl_add_u32 v8, v2, 2, v8
    v_lshl_add_u32 v8, v8, 2, s36
    v_subrev_u32 v9, 64, v8
    v_cndmask_b32 v92, v9, v8, s[18:19]
    v_cndmask_b32 v93, v9, v8, s[20:21]
    v_lshlrev_b32 v95, 4, v2
    s_lshl_b32 s36, s27, 8
    s_add_u32 s36, s36, 157184
    v_add_u32 v95, s36, v95
    v_mov_b32 v96, 157968
    v_mov_b32 v100, -1
    v_mov_b32 v101, -1
    v_mov_b32 v102, -1
    v_mov_b32 v103, -1
    v_mov_b32 v127, 157984
    s_lshl_b32 s36, s3, 2
    s_add_u32 s36, s36, 158016
    v_mov_b32 v10, s36
    v_xor_b32 v11, 16, v10
    v_cndmask_b32 v127, v127, v11, s[4:5]
    s_waitcnt lgkmcnt(0)
    s_barrier
    ds_read_b128 a[64:67], v76 offset:0
    ds_read_b128 a[68:71], v78 offset:0
    ds_read_b64_tr_b16 a[80:81], v20 offset:0
    ds_read_b64_tr_b16 a[82:83], v20 offset:512
    ds_read_b64_tr_b16 a[84:85], v21 offset:0
    ds_read_b64_tr_b16 a[86:87], v21 offset:512
    ds_read_b64_tr_b16 a[88:89], v22 offset:0
    ds_read_b64_tr_b16 a[90:91], v22 offset:512
    ds_read_b64_tr_b16 a[92:93], v23 offset:0
    ds_read_b64_tr_b16 a[94:95], v23 offset:512
    ds_read_b64_tr_b16 a[96:97], v84 offset:0
    ds_read_b64_tr_b16 a[98:99], v84 offset:512
    ds_read_b64_tr_b16 a[100:101], v85 offset:0
    ds_read_b64_tr_b16 a[102:103], v85 offset:512
    s_add_u32 s34, s34, 0x9e3779b8
    s_or_b32 s34, s34, 1
    s_cmp_eq_u32 s42, 0
    s_cbranch_scc1 Lxe0
Lxe0_b:
    s_setprio 1
    s_waitcnt lgkmcnt(10)
    v_mfma_f32_16x16x32_bf16 v[28:31], a[80:83], a[64:67], 0
    ds_read_b128 a[72:75], v77 offset:0
    ds_read_b128 a[76:79], v79 offset:0
    v_mfma_f32_16x16x32_bf16 v[44:47], a[80:83], a[68:71], 0
    ds_read_b64_tr_b16 a[104:105], v20 offset:4096
    s_waitcnt lgkmcnt(11)
    v_mfma_f32_16x16x32_bf16 v[32:35], a[84:87], a[64:67], 0
    ds_read_b64_tr_b16 a[106:107], v20 offset:4608
    v_mfma_f32_16x16x32_bf16 v[48:51], a[84:87], a[68:71], 0
    ds_read_b64_tr_b16 a[108:109], v21 offset:4096
    s_waitcnt lgkmcnt(11)
    v_mfma_f32_16x16x32_bf16 v[36:39], a[88:91], a[64:67], 0
    ds_read_b64_tr_b16 a[110:111], v21 offset:4608
    ds_read_b64_tr_b16 a[112:113], v22 offset:4096
    v_mfma_f32_16x16x32_bf16 v[52:55], a[88:91], a[68:71], 0
    ds_read_b64_tr_b16 a[114:115], v22 offset:4608
    s_setprio 0
    s_waitcnt lgkmcnt(12)
    v_mfma_f32_16x16x32_bf16 v[40:43], a[92:95], a[64:67], 0
    ds_read_b64_tr_b16 a[116:117], v23 offset:4096
    v_mfma_f32_16x16x32_bf16 v[56:59], a[92:95], a[68:71], 0
    ds_read_b64_tr_b16 a[118:119], v23 offset:4608
    s_waitcnt lgkmcnt(12)
    v_mfma_f32_16x16x32_bf16 v[60:63], a[64:67], a[96:99], 0
    ds_read_b64_tr_b16 a[120:121], v84 offset:4096
    v_mfma_f32_16x16x32_bf16 v[68:71], a[68:71], a[96:99], 0
    ds_read_b64_tr_b16 a[122:123], v84 offset:4608
    s_waitcnt lgkmcnt(12)
    v_mfma_f32_16x16x32_bf16 v[64:67], a[64:67], a[100:103], 0
    ds_read_b64_tr_b16 a[124:125], v85 offset:4096
    v_mfma_f32_16x16x32_bf16 v[72:75], a[68:71], a[100:103], 0
    ds_read_b64_tr_b16 a[126:127], v85 offset:4608
    s_barrier
    s_setprio 3
    s_waitcnt lgkmcnt(10)
    v_mfma_f32_16x16x32_bf16 v[28:31], a[104:107], a[72:75], v[28:31]
    ds_read_b128 a[64:67], v76 offset:39040
    ds_read_b128 a[68:71], v78 offset:39040
    v_mfma_f32_16x16x32_bf16 v[44:47], a[104:107], a[76:79], v[44:47]
    ds_read_b64_tr_b16 a[80:81], v20 offset:39040
    s_waitcnt lgkmcnt(11)
    v_mfma_f32_16x16x32_bf16 v[32:35], a[108:111], a[72:75], v[32:35]
    ds_read_b64_tr_b16 a[82:83], v20 offset:39552
    v_mfma_f32_16x16x32_bf16 v[48:51], a[108:111], a[76:79], v[48:51]
    ds_read_b64_tr_b16 a[84:85], v21 offset:39040
    s_waitcnt lgkmcnt(11)
    v_mfma_f32_16x16x32_bf16 v[36:39], a[112:115], a[72:75], v[36:39]
    ds_read_b64_tr_b16 a[86:87], v21 offset:39552
    v_mfma_f32_16x16x32_bf16 v[52:55], a[112:115], a[76:79], v[52:55]
    ds_read_b64_tr_b16 a[88:89], v22 offset:39040
    s_setprio 2
    s_waitcnt lgkmcnt(11)
    v_mfma_f32_16x16x32_bf16 v[40:43], a[116:119], a[72:75], v[40:43]
    ds_read_b64_tr_b16 a[90:91], v22 offset:39552
    ds_read_b64_tr_b16 a[92:93], v23 offset:39040
    v_mfma_f32_16x16x32_bf16 v[56:59], a[116:119], a[76:79], v[56:59]
    ds_read_b64_tr_b16 a[94:95], v23 offset:39552
    s_waitcnt lgkmcnt(12)
    v_mfma_f32_16x16x32_bf16 v[60:63], a[72:75], a[120:123], v[60:63]
    ds_read_b64_tr_b16 a[96:97], v84 offset:39040
    v_mfma_f32_16x16x32_bf16 v[68:71], a[76:79], a[120:123], v[68:71]
    ds_read_b64_tr_b16 a[98:99], v84 offset:39552
    s_waitcnt lgkmcnt(12)
    v_mfma_f32_16x16x32_bf16 v[64:67], a[72:75], a[124:127], v[64:67]
    ds_read_b64_tr_b16 a[100:101], v85 offset:39040
    v_mfma_f32_16x16x32_bf16 v[72:75], a[76:79], a[124:127], v[72:75]
    ds_read_b64_tr_b16 a[102:103], v85 offset:39552
    s_cmp_eq_u32 s42, 1
    s_cbranch_scc1 Lxe1
Lxe1_b:
    s_setprio 1
    s_waitcnt lgkmcnt(10)
    v_mfma_f32_16x16x32_bf16 v[28:31], a[80:83], a[64:67], v[28:31]
    ds_read_b128 a[72:75], v77 offset:39040
    ds_read_b128 a[76:79], v79 offset:39040
    v_mfma_f32_16x16x32_bf16 v[44:47], a[80:83], a[68:71], v[44:47]
    ds_read_b64_tr_b16 a[104:105], v20 offset:43136
    s_waitcnt lgkmcnt(11)
    v_mfma_f32_16x16x32_bf16 v[32:35], a[84:87], a[64:67], v[32:35]
    ds_read_b64_tr_b16 a[106:107], v20 offset:43648
    v_mfma_f32_16x16x32_bf16 v[48:51], a[84:87], a[68:71], v[48:51]
    ds_read_b64_tr_b16 a[108:109], v21 offset:43136
    s_waitcnt lgkmcnt(11)
    v_mfma_f32_16x16x32_bf16 v[36:39], a[88:91], a[64:67], v[36:39]
    ds_read_b64_tr_b16 a[110:111], v21 offset:43648
    ds_read_b64_tr_b16 a[112:113], v22 offset:43136
    v_mfma_f32_16x16x32_bf16 v[52:55], a[88:91], a[68:71], v[52:55]
    ds_read_b64_tr_b16 a[114:115], v22 offset:43648
    s_setprio 0
    s_waitcnt lgkmcnt(12)
    v_mfma_f32_16x16x32_bf16 v[40:43], a[92:95], a[64:67], v[40:43]
    ds_read_b64_tr_b16 a[116:117], v23 offset:43136
    v_mfma_f32_16x16x32_bf16 v[56:59], a[92:95], a[68:71], v[56:59]
    ds_read_b64_tr_b16 a[118:119], v23 offset:43648
    s_waitcnt lgkmcnt(12)
    v_mfma_f32_16x16x32_bf16 v[60:63], a[64:67], a[96:99], v[60:63]
    ds_read_b64_tr_b16 a[120:121], v84 offset:43136
    v_mfma_f32_16x16x32_bf16 v[68:71], a[68:71], a[96:99], v[68:71]
    ds_read_b64_tr_b16 a[122:123], v84 offset:43648
    s_waitcnt lgkmcnt(12)
    v_mfma_f32_16x16x32_bf16 v[64:67], a[64:67], a[100:103], v[64:67]
    ds_read_b64_tr_b16 a[124:125], v85 offset:43136
    v_mfma_f32_16x16x32_bf16 v[72:75], a[68:71], a[100:103], v[72:75]
    ds_read_b64_tr_b16 a[126:127], v85 offset:43648
    s_barrier
    s_setprio 3
    s_waitcnt lgkmcnt(10)
    v_mfma_f32_16x16x32_bf16 v[28:31], a[104:107], a[72:75], v[28:31]
    ds_read_b128 a[64:67], v80 offset:0
    ds_read_b128 a[68:71], v82 offset:0
    v_mfma_f32_16x16x32_bf16 v[44:47], a[104:107], a[76:79], v[44:47]
    ds_read_b64_tr_b16 a[80:81], v24 offset:0
    s_waitcnt lgkmcnt(11)
    v_mfma_f32_16x16x32_bf16 v[32:35], a[108:111], a[72:75], v[32:35]
    ds_read_b64_tr_b16 a[82:83], v24 offset:512
    v_mfma_f32_16x16x32_bf16 v[48:51], a[108:111], a[76:79], v[48:51]
    ds_read_b64_tr_b16 a[84:85], v25 offset:0
    s_waitcnt lgkmcnt(11)
    v_mfma_f32_16x16x32_bf16 v[36:39], a[112:115], a[72:75], v[36:39]
    ds_read_b64_tr_b16 a[86:87], v25 offset:512
    v_mfma_f32_16x16x32_bf16 v[52:55], a[112:115], a[76:79], v[52:55]
    ds_read_b64_tr_b16 a[88:89], v26 offset:0
    s_setprio 2
    s_waitcnt lgkmcnt(11)
    v_mfma_f32_16x16x32_bf16 v[40:43], a[116:119], a[72:75], v[40:43]
    ds_read_b64_tr_b16 a[90:91], v26 offset:512
    ds_read_b64_tr_b16 a[92:93], v27 offset:0
    v_mfma_f32_16x16x32_bf16 v[56:59], a[116:119], a[76:79], v[56:59]
    ds_read_b64_tr_b16 a[94:95], v27 offset:512
    s_waitcnt lgkmcnt(12)
    v_mfma_f32_16x16x32_bf16 v[60:63], a[72:75], a[120:123], v[60:63]
    ds_read_b64_tr_b16 a[96:97], v86 offset:0
    v_mfma_f32_16x16x32_bf16 v[68:71], a[76:79], a[120:123], v[68:71]
    ds_read_b64_tr_b16 a[98:99], v86 offset:512
    s_waitcnt lgkmcnt(12)
    v_mfma_f32_16x16x32_bf16 v[64:67], a[72:75], a[124:127], v[64:67]
    ds_read_b64_tr_b16 a[100:101], v87 offset:0
    v_mfma_f32_16x16x32_bf16 v[72:75], a[76:79], a[124:127], v[72:75]
    ds_read_b64_tr_b16 a[102:103], v87 offset:512
    buffer_store_dwordx4 v[100:103], v13, s[28:31], s56 offen sc1
    s_cmp_eq_u32 s42, 2
    s_cbranch_scc1 Lxe2
Lxe2_b:
    s_setprio 1
    s_waitcnt lgkmcnt(10)
    v_mfma_f32_16x16x32_bf16 v[28:31], a[80:83], a[64:67], v[28:31]
    ds_read_b128 a[72:75], v81 offset:0
    ds_read_b128 a[76:79], v83 offset:0
    v_mfma_f32_16x16x32_bf16 v[44:47], a[80:83], a[68:71], v[44:47]
    ds_read_b64_tr_b16 a[104:105], v24 offset:4096
    s_waitcnt lgkmcnt(11)
    v_mfma_f32_16x16x32_bf16 v[32:35], a[84:87], a[64:67], v[32:35]
    ds_read_b64_tr_b16 a[106:107], v24 offset:4608
    v_mfma_f32_16x16x32_bf16 v[48:51], a[84:87], a[68:71], v[48:51]
    ds_read_b64_tr_b16 a[108:109], v25 offset:4096
    s_waitcnt lgkmcnt(11)
    v_mfma_f32_16x16x32_bf16 v[36:39], a[88:91], a[64:67], v[36:39]
    ds_read_b64_tr_b16 a[110:111], v25 offset:4608
    ds_read_b64_tr_b16 a[112:113], v26 offset:4096
    v_mfma_f32_16x16x32_bf16 v[52:55], a[88:91], a[68:71], v[52:55]
    ds_read_b64_tr_b16 a[114:115], v26 offset:4608
    s_setprio 0
    s_waitcnt lgkmcnt(12)
    v_mfma_f32_16x16x32_bf16 v[40:43], a[92:95], a[64:67], v[40:43]
    ds_read_b64_tr_b16 a[116:117], v27 offset:4096
    v_mfma_f32_16x16x32_bf16 v[56:59], a[92:95], a[68:71], v[56:59]
    ds_read_b64_tr_b16 a[118:119], v27 offset:4608
    s_waitcnt lgkmcnt(12)
    v_mfma_f32_16x16x32_bf16 v[60:63], a[64:67], a[96:99], v[60:63]
    ds_read_b64_tr_b16 a[120:121], v86 offset:4096
    v_mfma_f32_16x16x32_bf16 v[68:71], a[68:71], a[96:99], v[68:71]
    ds_read_b64_tr_b16 a[122:123], v86 offset:4608
    s_waitcnt lgkmcnt(12)
    v_mfma_f32_16x16x32_bf16 v[64:67], a[64:67], a[100:103], v[64:67]
    ds_read_b64_tr_b16 a[124:125], v87 offset:4096
    v_mfma_f32_16x16x32_bf16 v[72:75], a[68:71], a[100:103], v[72:75]
    ds_read_b64_tr_b16 a[126:127], v87 offset:4608
    s_barrier
    s_setprio 3
    s_waitcnt lgkmcnt(10)
    v_mfma_f32_16x16x32_bf16 v[28:31], a[104:107], a[72:75], v[28:31]
    ds_read_b128 a[64:67], v80 offset:39040
    ds_read_b128 a[68:71], v82 offset:39040
    v_mfma_f32_16x16x32_bf16 v[44:47], a[104:107], a[76:79], v[44:47]
    ds_read_b64_tr_b16 a[80:81], v24 offset:39040
    s_waitcnt lgkmcnt(11)
    v_mfma_f32_16x16x32_bf16 v[32:35], a[108:111], a[72:75], v[32:35]
    ds_read_b64_tr_b16 a[82:83], v24 offset:39552
    v_mfma_f32_16x16x32_bf16 v[48:51], a[108:111], a[76:79], v[48:51]
    ds_read_b64_tr_b16 a[84:85], v25 offset:39040
    s_waitcnt lgkmcnt(11)
    v_mfma_f32_16x16x32_bf16 v[36:39], a[112:115], a[72:75], v[36:39]
    ds_read_b64_tr_b16 a[86:87], v25 offset:39552
    v_mfma_f32_16x16x32_bf16 v[52:55], a[112:115], a[76:79], v[52:55]
    ds_read_b64_tr_b16 a[88:89], v26 offset:39040
    s_setprio 2
    s_waitcnt lgkmcnt(11)
    v_mfma_f32_16x16x32_bf16 v[40:43], a[116:119], a[72:75], v[40:43]
    ds_read_b64_tr_b16 a[90:91], v26 offset:39552
    ds_read_b64_tr_b16 a[92:93], v27 offset:39040
    v_mfma_f32_16x16x32_bf16 v[56:59], a[116:119], a[76:79], v[56:59]
    ds_read_b64_tr_b16 a[94:95], v27 offset:39552
    s_waitcnt lgkmcnt(12)
    v_mfma_f32_16x16x32_bf16 v[60:63], a[72:75], a[120:123], v[60:63]
    ds_read_b64_tr_b16 a[96:97], v86 offset:39040
    v_mfma_f32_16x16x32_bf16 v[68:71], a[76:79], a[120:123], v[68:71]
    ds_read_b64_tr_b16 a[98:99], v86 offset:39552
    s_waitcnt lgkmcnt(12)
    v_mfma_f32_16x16x32_bf16 v[64:67], a[72:75], a[124:127], v[64:67]
    ds_read_b64_tr_b16 a[100:101], v87 offset:39040
    v_mfma_f32_16x16x32_bf16 v[72:75], a[76:79], a[124:127], v[72:75]
    ds_read_b64_tr_b16 a[102:103], v87 offset:39552
    s_cmp_eq_u32 s42, 3
    s_cbranch_scc1 Lxe3
Lxe3_b:
    s_setprio 1
    s_waitcnt lgkmcnt(10)
    v_mfma_f32_16x16x32_bf16 v[28:31], a[80:83], a[64:67], v[28:31]
    ds_read_b128 a[72:75], v81 offset:39040
    ds_read_b128 a[76:79], v83 offset:39040
    v_mfma_f32_16x16x32_bf16 v[44:47], a[80:83], a[68:71], v[44:47]
    ds_read_b64_tr_b16 a[104:105], v24 offset:43136
    s_waitcnt lgkmcnt(11)
    v_mfma_f32_16x16x32_bf16 v[32:35], a[84:87], a[64:67], v[32:35]
    ds_read_b64_tr_b16 a[106:107], v24 offset:43648
    v_mfma_f32_16x16x32_bf16 v[48:51], a[84:87], a[68:71], v[48:51]
    ds_read_b64_tr_b16 a[108:109], v25 offset:43136
    s_waitcnt lgkmcnt(11)
    v_mfma_f32_16x16x32_bf16 v[36:39], a[88:91], a[64:67], v[36:39]
    ds_read_b64_tr_b16 a[110:111], v25 offset:43648
    ds_read_b64_tr_b16 a[112:113], v26 offset:43136
    v_mfma_f32_16x16x32_bf16 v[52:55], a[88:91], a[68:71], v[52:55]
    ds_read_b64_tr_b16 a[114:115], v26 offset:43648
    s_setprio 0
    s_waitcnt lgkmcnt(12)
    v_mfma_f32_16x16x32_bf16 v[40:43], a[92:95], a[64:67], v[40:43]
    ds_read_b64_tr_b16 a[116:117], v27 offset:43136
    v_mfma_f32_16x16x32_bf16 v[56:59], a[92:95], a[68:71], v[56:59]
    ds_read_b64_tr_b16 a[118:119], v27 offset:43648
    s_waitcnt lgkmcnt(12)
    v_mfma_f32_16x16x32_bf16 v[60:63], a[64:67], a[96:99], v[60:63]
    ds_read_b64_tr_b16 a[120:121], v86 offset:43136
    v_mfma_f32_16x16x32_bf16 v[68:71], a[68:71], a[96:99], v[68:71]
    ds_read_b64_tr_b16 a[122:123], v86 offset:43648
    s_waitcnt lgkmcnt(12)
    v_mfma_f32_16x16x32_bf16 v[64:67], a[64:67], a[100:103], v[64:67]
    ds_read_b64_tr_b16 a[124:125], v87 offset:43136
    v_mfma_f32_16x16x32_bf16 v[72:75], a[68:71], a[100:103], v[72:75]
    ds_read_b64_tr_b16 a[126:127], v87 offset:43648
    s_barrier
    s_setprio 3
    s_waitcnt lgkmcnt(10)
    v_mfma_f32_16x16x32_bf16 v[28:31], a[104:107], a[72:75], v[28:31]
    ds_read_b128 a[64:67], v76 offset:0
    ds_read_b128 a[68:71], v78 offset:0
    v_mfma_f32_16x16x32_bf16 v[44:47], a[104:107], a[76:79], v[44:47]
    ds_read_b64_tr_b16 a[80:81], v20 offset:0
    s_waitcnt lgkmcnt(11)
    v_mfma_f32_16x16x32_bf16 v[32:35], a[108:111], a[72:75], v[32:35]
    ds_read_b64_tr_b16 a[82:83], v20 offset:512
    v_mfma_f32_16x16x32_bf16 v[48:51], a[108:111], a[76:79], v[48:51]
    ds_read_b64_tr_b16 a[84:85], v21 offset:0
    s_waitcnt lgkmcnt(11)
    v_mfma_f32_16x16x32_bf16 v[36:39], a[112:115], a[72:75], v[36:39]
    ds_read_b64_tr_b16 a[86:87], v21 offset:512
    v_mfma_f32_16x16x32_bf16 v[52:55], a[112:115], a[76:79], v[52:55]
    ds_read_b64_tr_b16 a[88:89], v22 offset:0
    s_setprio 2
    s_waitcnt lgkmcnt(11)
    v_mfma_f32_16x16x32_bf16 v[40:43], a[116:119], a[72:75], v[40:43]
    ds_read_b64_tr_b16 a[90:91], v22 offset:512
    ds_read_b64_tr_b16 a[92:93], v23 offset:0
    v_mfma_f32_16x16x32_bf16 v[56:59], a[116:119], a[76:79], v[56:59]
    ds_read_b64_tr_b16 a[94:95], v23 offset:512
    s_waitcnt lgkmcnt(12)
    v_mfma_f32_16x16x32_bf16 v[60:63], a[72:75], a[120:123], v[60:63]
    ds_read_b64_tr_b16 a[96:97], v84 offset:0
    v_mfma_f32_16x16x32_bf16 v[68:71], a[76:79], a[120:123], v[68:71]
    ds_read_b64_tr_b16 a[98:99], v84 offset:512
    s_waitcnt lgkmcnt(12)
    v_mfma_f32_16x16x32_bf16 v[64:67], a[72:75], a[124:127], v[64:67]
    ds_read_b64_tr_b16 a[100:101], v85 offset:0
    v_mfma_f32_16x16x32_bf16 v[72:75], a[76:79], a[124:127], v[72:75]
    ds_read_b64_tr_b16 a[102:103], v85 offset:512
    buffer_store_dwordx4 v[100:103], v13, s[28:31], s23 offen offset:0 sc1
    s_cmp_eq_u32 s42, 4
    s_cbranch_scc1 Lxe4
Lxe4_b:
    s_setprio 1
    s_waitcnt lgkmcnt(10)
    v_mfma_f32_16x16x32_bf16 v[28:31], a[80:83], a[64:67], v[28:31]
    ds_read_b128 a[72:75], v77 offset:0
    ds_read_b128 a[76:79], v79 offset:0
    v_mfma_f32_16x16x32_bf16 v[44:47], a[80:83], a[68:71], v[44:47]
    ds_read_b64_tr_b16 a[104:105], v20 offset:4096
    s_waitcnt lgkmcnt(11)
    v_mfma_f32_16x16x32_bf16 v[32:35], a[84:87], a[64:67], v[32:35]
    ds_read_b64_tr_b16 a[106:107], v20 offset:4608
    v_mfma_f32_16x16x32_bf16 v[48:51], a[84:87], a[68:71], v[48:51]
    ds_read_b64_tr_b16 a[108:109], v21 offset:4096
    s_waitcnt lgkmcnt(11)
    v_mfma_f32_16x16x32_bf16 v[36:39], a[88:91], a[64:67], v[36:39]
    ds_read_b64_tr_b16 a[110:111], v21 offset:4608
    ds_read_b64_tr_b16 a[112:113], v22 offset:4096
    v_mfma_f32_16x16x32_bf16 v[52:55], a[88:91], a[68:71], v[52:55]
    ds_read_b64_tr_b16 a[114:115], v22 offset:4608
    s_setprio 0
    s_waitcnt lgkmcnt(12)
    v_mfma_f32_16x16x32_bf16 v[40:43], a[92:95], a[64:67], v[40:43]
    ds_read_b64_tr_b16 a[116:117], v23 offset:4096
    v_mfma_f32_16x16x32_bf16 v[56:59], a[92:95], a[68:71], v[56:59]
    ds_read_b64_tr_b16 a[118:119], v23 offset:4608
    s_waitcnt lgkmcnt(12)
    v_mfma_f32_16x16x32_bf16 v[60:63], a[64:67], a[96:99], v[60:63]
    ds_read_b64_tr_b16 a[120:121], v84 offset:4096
    v_mfma_f32_16x16x32_bf16 v[68:71], a[68:71], a[96:99], v[68:71]
    ds_read_b64_tr_b16 a[122:123], v84 offset:4608
    s_waitcnt lgkmcnt(12)
    v_mfma_f32_16x16x32_bf16 v[64:67], a[64:67], a[100:103], v[64:67]
    ds_read_b64_tr_b16 a[124:125], v85 offset:4096
    v_mfma_f32_16x16x32_bf16 v[72:75], a[68:71], a[100:103], v[72:75]
    ds_read_b64_tr_b16 a[126:127], v85 offset:4608
    s_barrier
    s_setprio 3
    s_waitcnt lgkmcnt(10)
    v_mfma_f32_16x16x32_bf16 v[28:31], a[104:107], a[72:75], v[28:31]
    ds_read_b128 a[64:67], v76 offset:39040
    ds_read_b128 a[68:71], v78 offset:39040
    v_mfma_f32_16x16x32_bf16 v[44:47], a[104:107], a[76:79], v[44:47]
    ds_read_b64_tr_b16 a[80:81], v20 offset:39040
    s_waitcnt lgkmcnt(11)
    v_mfma_f32_16x16x32_bf16 v[32:35], a[108:111], a[72:75], v[32:35]
    ds_read_b64_tr_b16 a[82:83], v20 offset:39552
    v_mfma_f32_16x16x32_bf16 v[48:51], a[108:111], a[76:79], v[48:51]
    ds_read_b64_tr_b16 a[84:85], v21 offset:39040
    s_waitcnt lgkmcnt(11)
    v_mfma_f32_16x16x32_bf16 v[36:39], a[112:115], a[72:75], v[36:39]
    ds_read_b64_tr_b16 a[86:87], v21 offset:39552
    v_mfma_f32_16x16x32_bf16 v[52:55], a[112:115], a[76:79], v[52:55]
    ds_read_b64_tr_b16 a[88:89], v22 offset:39040
    s_setprio 2
    s_waitcnt lgkmcnt(11)
    v_mfma_f32_16x16x32_bf16 v[40:43], a[116:119], a[72:75], v[40:43]
    ds_read_b64_tr_b16 a[90:91], v22 offset:39552
    ds_read_b64_tr_b16 a[92:93], v23 offset:39040
    v_mfma_f32_16x16x32_bf16 v[56:59], a[116:119], a[76:79], v[56:59]
    ds_read_b64_tr_b16 a[94:95], v23 offset:39552
    s_waitcnt lgkmcnt(12)
    v_mfma_f32_16x16x32_bf16 v[60:63], a[72:75], a[120:123], v[60:63]
    ds_read_b64_tr_b16 a[96:97], v84 offset:39040
    v_mfma_f32_16x16x32_bf16 v[68:71], a[76:79], a[120:123], v[68:71]
    ds_read_b64_tr_b16 a[98:99], v84 offset:39552
    s_waitcnt lgkmcnt(12)
    v_mfma_f32_16x16x32_bf16 v[64:67], a[72:75], a[124:127], v[64:67]
    ds_read_b64_tr_b16 a[100:101], v85 offset:39040
    v_mfma_f32_16x16x32_bf16 v[72:75], a[76:79], a[124:127], v[72:75]
    ds_read_b64_tr_b16 a[102:103], v85 offset:39552
    s_cmp_eq_u32 s42, 5
    s_cbranch_scc1 Lxe5
Lxe5_b:
    s_setprio 1
    s_waitcnt lgkmcnt(10)
    v_mfma_f32_16x16x32_bf16 v[28:31], a[80:83], a[64:67], v[28:31]
    ds_read_b128 a[72:75], v77 offset:39040
    ds_read_b128 a[76:79], v79 offset:39040
    v_mfma_f32_16x16x32_bf16 v[44:47], a[80:83], a[68:71], v[44:47]
    ds_read_b64_tr_b16 a[104:105], v20 offset:43136
    s_waitcnt lgkmcnt(11)
    v_mfma_f32_16x16x32_bf16 v[32:35], a[84:87], a[64:67], v[32:35]
    ds_read_b64_tr_b16 a[106:107], v20 offset:43648
    v_mfma_f32_16x16x32_bf16 v[48:51], a[84:87], a[68:71], v[48:51]
    ds_read_b64_tr_b16 a[108:109], v21 offset:43136
    s_waitcnt lgkmcnt(11)
    v_mfma_f32_16x16x32_bf16 v[36:39], a[88:91], a[64:67], v[36:39]
    ds_read_b64_tr_b16 a[110:111], v21 offset:43648
    ds_read_b64_tr_b16 a[112:113], v22 offset:43136
    v_mfma_f32_16x16x32_bf16 v[52:55], a[88:91], a[68:71], v[52:55]
    ds_read_b64_tr_b16 a[114:115], v22 offset:43648
    s_setprio 0
    s_waitcnt lgkmcnt(12)
    v_mfma_f32_16x16x32_bf16 v[40:43], a[92:95], a[64:67], v[40:43]
    ds_read_b64_tr_b16 a[116:117], v23 offset:43136
    v_mfma_f32_16x16x32_bf16 v[56:59], a[92:95], a[68:71], v[56:59]
    ds_read_b64_tr_b16 a[118:119], v23 offset:43648
    s_waitcnt lgkmcnt(12)
    v_mfma_f32_16x16x32_bf16 v[60:63], a[64:67], a[96:99], v[60:63]
    ds_read_b64_tr_b16 a[120:121], v84 offset:43136
    v_mfma_f32_16x16x32_bf16 v[68:71], a[68:71], a[96:99], v[68:71]
    ds_read_b64_tr_b16 a[122:123], v84 offset:43648
    s_waitcnt lgkmcnt(12)
    v_mfma_f32_16x16x32_bf16 v[64:67], a[64:67], a[100:103], v[64:67]
    ds_read_b64_tr_b16 a[124:125], v85 offset:43136
    v_mfma_f32_16x16x32_bf16 v[72:75], a[68:71], a[100:103], v[72:75]
    ds_read_b64_tr_b16 a[126:127], v85 offset:43648
    s_barrier
    s_setprio 3
    s_waitcnt lgkmcnt(10)
    v_mfma_f32_16x16x32_bf16 v[28:31], a[104:107], a[72:75], v[28:31]
    ds_read_b128 a[0:3], v80 offset:0
    v_mfma_f32_16x16x32_bf16 v[44:47], a[104:107], a[76:79], v[44:47]
    ds_read_b128 a[4:7], v82 offset:0
    s_waitcnt lgkmcnt(10)
    v_mfma_f32_16x16x32_bf16 v[32:35], a[108:111], a[72:75], v[32:35]
    ds_read_b64_tr_b16 a[80:81], v24 offset:0
    v_mfma_f32_16x16x32_bf16 v[48:51], a[108:111], a[76:79], v[48:51]
    ds_read_b64_tr_b16 a[82:83], v24 offset:512
    s_waitcnt lgkmcnt(10)
    v_mfma_f32_16x16x32_bf16 v[36:39], a[112:115], a[72:75], v[36:39]
    ds_read_b64_tr_b16 a[84:85], v25 offset:0
    v_mfma_f32_16x16x32_bf16 v[52:55], a[112:115], a[76:79], v[52:55]
    s_setprio 2
    s_waitcnt lgkmcnt(9)
    v_mfma_f32_16x16x32_bf16 v[40:43], a[116:119], a[72:75], v[40:43]
    ds_read_b64_tr_b16 a[86:87], v25 offset:512
    v_mfma_f32_16x16x32_bf16 v[56:59], a[116:119], a[76:79], v[56:59]
    ds_read_b64_tr_b16 a[88:89], v26 offset:0
    s_waitcnt lgkmcnt(9)
    v_mfma_f32_16x16x32_bf16 v[60:63], a[72:75], a[120:123], v[60:63]
    ds_read_b64_tr_b16 a[90:91], v26 offset:512
    v_mfma_f32_16x16x32_bf16 v[68:71], a[76:79], a[120:123], v[68:71]
    ds_read_b64_tr_b16 a[92:93], v27 offset:0
    s_waitcnt lgkmcnt(9)
    v_mfma_f32_16x16x32_bf16 v[64:67], a[72:75], a[124:127], v[64:67]
    ds_read_b64_tr_b16 a[94:95], v27 offset:512
    v_mfma_f32_16x16x32_bf16 v[72:75], a[76:79], a[124:127], v[72:75]
    buffer_store_dwordx4 v[100:103], v13, s[28:31], s23 offen offset:1024 sc1
    s_cmp_eq_u32 s42, 6
    s_cbranch_scc1 Lxe6
Lxe6_b:
    s_setprio 1
    s_waitcnt lgkmcnt(6)
    v_mfma_f32_16x16x32_bf16 v[28:31], a[80:83], a[0:3], v[28:31]
    ds_read_b128 a[8:11], v81 offset:0
    ds_read_b128 a[12:15], v83 offset:0
    v_mfma_f32_16x16x32_bf16 v[44:47], a[80:83], a[4:7], v[44:47]
    ds_read_b64_tr_b16 a[104:105], v24 offset:4096
    s_waitcnt lgkmcnt(7)
    v_mfma_f32_16x16x32_bf16 v[32:35], a[84:87], a[0:3], v[32:35]
    ds_read_b64_tr_b16 a[106:107], v24 offset:4608
    ds_read_b64_tr_b16 a[108:109], v25 offset:4096
    v_mfma_f32_16x16x32_bf16 v[48:51], a[84:87], a[4:7], v[48:51]
    ds_read_b64_tr_b16 a[110:111], v25 offset:4608
    s_setprio 0
    s_waitcnt lgkmcnt(8)
    v_mfma_f32_16x16x32_bf16 v[36:39], a[88:91], a[0:3], v[36:39]
    v_mfma_f32_16x16x32_bf16 v[52:55], a[88:91], a[4:7], v[52:55]
    ds_read_b64_tr_b16 a[112:113], v26 offset:4096
    ds_read_b64_tr_b16 a[114:115], v26 offset:4608
    s_waitcnt lgkmcnt(8)
    v_mfma_f32_16x16x32_bf16 v[40:43], a[92:95], a[0:3], v[40:43]
    ds_read_b64_tr_b16 a[116:117], v27 offset:4096
    v_mfma_f32_16x16x32_bf16 v[56:59], a[92:95], a[4:7], v[56:59]
    ds_read_b64_tr_b16 a[118:119], v27 offset:4608
    s_barrier
    s_setprio 3
    s_waitcnt lgkmcnt(6)
    v_mfma_f32_16x16x32_bf16 v[28:31], a[104:107], a[8:11], v[28:31]
    ds_read_b128 a[16:19], v80 offset:39040
    ds_read_b128 a[20:23], v82 offset:39040
    v_mfma_f32_16x16x32_bf16 v[44:47], a[104:107], a[12:15], v[44:47]
    ds_read_b64_tr_b16 a[80:81], v24 offset:39040
    s_waitcnt lgkmcnt(7)
    v_mfma_f32_16x16x32_bf16 v[32:35], a[108:111], a[8:11], v[32:35]
    ds_read_b64_tr_b16 a[82:83], v24 offset:39552
    v_mfma_f32_16x16x32_bf16 v[48:51], a[108:111], a[12:15], v[48:51]
    ds_read_b64_tr_b16 a[84:85], v25 offset:39040
    s_setprio 2
    s_waitcnt lgkmcnt(7)
    v_mfma_f32_16x16x32_bf16 v[36:39], a[112:115], a[8:11], v[36:39]
    ds_read_b64_tr_b16 a[86:87], v25 offset:39552
    ds_read_b64_tr_b16 a[88:89], v26 offset:39040
    v_mfma_f32_16x16x32_bf16 v[52:55], a[112:115], a[12:15], v[52:55]
    ds_read_b64_tr_b16 a[90:91], v26 offset:39552
    s_waitcnt lgkmcnt(8)
    v_mfma_f32_16x16x32_bf16 v[40:43], a[116:119], a[8:11], v[40:43]
    ds_read_b64_tr_b16 a[92:93], v27 offset:39040
    v_mfma_f32_16x16x32_bf16 v[56:59], a[116:119], a[12:15], v[56:59]
    ds_read_b64_tr_b16 a[94:95], v27 offset:39552
    s_cmp_eq_u32 s42, 7
    s_cbranch_scc1 Lxe7
Lxe7_b:
    s_setprio 1
    s_waitcnt lgkmcnt(6)
    v_mfma_f32_16x16x32_bf16 v[28:31], a[80:83], a[16:19], v[28:31]
    ds_read_b128 a[24:27], v81 offset:39040
    ds_read_b128 a[28:31], v83 offset:39040
    v_mfma_f32_16x16x32_bf16 v[44:47], a[80:83], a[20:23], v[44:47]
    ds_read_b64_tr_b16 a[104:105], v24 offset:43136
    s_waitcnt lgkmcnt(7)
    v_mfma_f32_16x16x32_bf16 v[32:35], a[84:87], a[16:19], v[32:35]
    ds_read_b64_tr_b16 a[106:107], v24 offset:43648
    ds_read_b64_tr_b16 a[108:109], v25 offset:43136
    v_mfma_f32_16x16x32_bf16 v[48:51], a[84:87], a[20:23], v[48:51]
    ds_read_b64_tr_b16 a[110:111], v25 offset:43648
    s_setprio 0
    s_waitcnt lgkmcnt(8)
    v_mfma_f32_16x16x32_bf16 v[36:39], a[88:91], a[16:19], v[36:39]
    v_mfma_f32_16x16x32_bf16 v[52:55], a[88:91], a[20:23], v[52:55]
    ds_read_b64_tr_b16 a[112:113], v26 offset:43136
    ds_read_b64_tr_b16 a[114:115], v26 offset:43648
    s_waitcnt lgkmcnt(8)
    v_mfma_f32_16x16x32_bf16 v[40:43], a[92:95], a[16:19], v[40:43]
    ds_read_b64_tr_b16 a[116:117], v27 offset:43136
    v_mfma_f32_16x16x32_bf16 v[56:59], a[92:95], a[20:23], v[56:59]
    ds_read_b64_tr_b16 a[118:119], v27 offset:43648
    s_barrier
    s_setprio 3
    s_waitcnt lgkmcnt(6)
    v_mfma_f32_16x16x32_bf16 v[28:31], a[104:107], a[24:27], v[28:31]
    ds_read_b128 a[32:35], v76 offset:0
    ds_read_b128 a[36:39], v78 offset:0
    v_mfma_f32_16x16x32_bf16 v[44:47], a[104:107], a[28:31], v[44:47]
    ds_read_b64_tr_b16 a[80:81], v20 offset:0
    s_waitcnt lgkmcnt(7)
    v_mfma_f32_16x16x32_bf16 v[32:35], a[108:111], a[24:27], v[32:35]
    ds_read_b64_tr_b16 a[82:83], v20 offset:512
    v_mfma_f32_16x16x32_bf16 v[48:51], a[108:111], a[28:31], v[48:51]
    ds_read_b64_tr_b16 a[84:85], v21 offset:0
    s_setprio 2
    s_waitcnt lgkmcnt(7)
    v_mfma_f32_16x16x32_bf16 v[36:39], a[112:115], a[24:27], v[36:39]
    ds_read_b64_tr_b16 a[86:87], v21 offset:512
    ds_read_b64_tr_b16 a[88:89], v22 offset:0
    v_mfma_f32_16x16x32_bf16 v[52:55], a[112:115], a[28:31], v[52:55]
    ds_read_b64_tr_b16 a[90:91], v22 offset:512
    s_waitcnt lgkmcnt(8)
    v_mfma_f32_16x16x32_bf16 v[40:43], a[116:119], a[24:27], v[40:43]
    ds_read_b64_tr_b16 a[92:93], v23 offset:0
    v_mfma_f32_16x16x32_bf16 v[56:59], a[116:119], a[28:31], v[56:59]
    ds_read_b64_tr_b16 a[94:95], v23 offset:512
    s_cmp_eq_u32 s42, 8
    s_cbranch_scc1 Lxe8
Lxe8_b:
    s_setprio 1
    s_waitcnt lgkmcnt(6)
    v_mfma_f32_16x16x32_bf16 v[28:31], a[80:83], a[32:35], v[28:31]
    ds_read_b128 a[40:43], v77 offset:0
    ds_read_b128 a[44:47], v79 offset:0
    v_mfma_f32_16x16x32_bf16 v[44:47], a[80:83], a[36:39], v[44:47]
    ds_read_b64_tr_b16 a[104:105], v20 offset:4096
    s_waitcnt lgkmcnt(7)
    v_mfma_f32_16x16x32_bf16 v[32:35], a[84:87], a[32:35], v[32:35]
    ds_read_b64_tr_b16 a[106:107], v20 offset:4608
    v_mfma_f32_16x16x32_bf16 v[48:51], a[84:87], a[36:39], v[48:51]
    ds_read_b64_tr_b16 a[108:109], v21 offset:4096
    s_setprio 0
    s_waitcnt lgkmcnt(7)
    v_mfma_f32_16x16x32_bf16 v[36:39], a[88:91], a[32:35], v[36:39]
    ds_read_b64_tr_b16 a[110:111], v21 offset:4608
    ds_read_b64_tr_b16 a[112:113], v22 offset:4096
    v_mfma_f32_16x16x32_bf16 v[52:55], a[88:91], a[36:39], v[52:55]
    ds_read_b64_tr_b16 a[114:115], v22 offset:4608
    s_waitcnt lgkmcnt(8)
    v_mfma_f32_16x16x32_bf16 v[40:43], a[92:95], a[32:35], v[40:43]
    ds_read_b64_tr_b16 a[116:117], v23 offset:4096
    v_mfma_f32_16x16x32_bf16 v[56:59], a[92:95], a[36:39], v[56:59]
    ds_read_b64_tr_b16 a[118:119], v23 offset:4608
    s_waitcnt lgkmcnt(0)
    s_barrier
    s_setprio 3
    v_mfma_f32_16x16x32_bf16 v[28:31], a[104:107], a[40:43], v[28:31]
    ds_read_b128 a[48:51], v76 offset:39040
    ds_read_b128 a[52:55], v78 offset:39040
    v_mfma_f32_16x16x32_bf16 v[44:47], a[104:107], a[44:47], v[44:47]
    ds_read_b64_tr_b16 a[80:81], v20 offset:39040
    v_mfma_f32_16x16x32_bf16 v[32:35], a[108:111], a[40:43], v[32:35]
    ds_read_b64_tr_b16 a[82:83], v20 offset:39552
    v_mfma_f32_16x16x32_bf16 v[48:51], a[108:111], a[44:47], v[48:51]
    ds_read_b64_tr_b16 a[84:85], v21 offset:39040
    s_setprio 2
    v_mfma_f32_16x16x32_bf16 v[36:39], a[112:115], a[40:43], v[36:39]
    ds_read_b64_tr_b16 a[86:87], v21 offset:39552
    ds_read_b64_tr_b16 a[88:89], v22 offset:39040
    v_mfma_f32_16x16x32_bf16 v[52:55], a[112:115], a[44:47], v[52:55]
    ds_read_b64_tr_b16 a[90:91], v22 offset:39552
    v_mfma_f32_16x16x32_bf16 v[40:43], a[116:119], a[40:43], v[40:43]
    ds_read_b64_tr_b16 a[92:93], v23 offset:39040
    v_mfma_f32_16x16x32_bf16 v[56:59], a[116:119], a[44:47], v[56:59]
    ds_read_b64_tr_b16 a[94:95], v23 offset:39552
    v_mov_b32 v98, s34
    s_waitcnt vmcnt(0)
    s_mov_b64 exec, 1
    buffer_store_dword v98, v97, s[28:31], s24 offen sc1
    s_mov_b64 exec, -1
    s_cmp_eq_u32 s42, 9
    s_cbranch_scc1 Lxe9
Lxe9_b:
    s_setprio 1
    s_waitcnt lgkmcnt(6)
    v_mfma_f32_16x16x32_bf16 v[28:31], a[80:83], a[48:51], v[28:31]
    ds_read_b128 a[56:59], v77 offset:39040
    ds_read_b128 a[60:63], v79 offset:39040
    ds_read_b64_tr_b16 a[104:105], v20 offset:43136
    v_mfma_f32_16x16x32_bf16 v[44:47], a[80:83], a[52:55], v[44:47]
    ds_read_b64_tr_b16 a[106:107], v20 offset:43648
    ds_read_b64_tr_b16 a[108:109], v21 offset:43136
    s_waitcnt lgkmcnt(9)
    v_mfma_f32_16x16x32_bf16 v[32:35], a[84:87], a[48:51], v[32:35]
    ds_read_b64_tr_b16 a[110:111], v21 offset:43648
    ds_read_b64_tr_b16 a[112:113], v22 offset:43136
    ds_read_b64_tr_b16 a[114:115], v22 offset:43648
    v_mfma_f32_16x16x32_bf16 v[48:51], a[84:87], a[52:55], v[48:51]
    ds_read_b64_tr_b16 a[116:117], v23 offset:43136
    ds_read_b64_tr_b16 a[118:119], v23 offset:43648
    s_setprio 0
    s_waitcnt lgkmcnt(12)
    v_mfma_f32_16x16x32_bf16 v[36:39], a[88:91], a[48:51], v[36:39]
    ds_read_b32 v120, v94
    ds_read_b32 v121, v94 offset:512
    v_xor_b32 v94, 64, v94
    v_mfma_f32_16x16x32_bf16 v[52:55], a[88:91], a[52:55], v[52:55]
    ds_read_b32 v122, v94
    ds_read_b32 v123, v92 offset:512
    s_waitcnt lgkmcnt(14)
    v_mfma_f32_16x16x32_bf16 v[40:43], a[92:95], a[48:51], v[40:43]
    ds_read_b32 v126, v93 offset:520
    v_mov_b32 v24, v84
    v_mov_b32 v25, v85
    v_mfma_f32_16x16x32_bf16 v[56:59], a[92:95], a[52:55], v[56:59]
    v_mov_b32 v26, v86
    v_mov_b32 v27, v87
    s_waitcnt lgkmcnt(5)
    v_mfma_f32_16x16x32_bf16 v[44:47], a[104:107], a[60:63], v[44:47]
    v_mfma_f32_16x16x32_bf16 v[48:51], a[108:111], a[60:63], v[48:51]
    v_mfma_f32_16x16x32_bf16 v[52:55], a[112:115], a[60:63], v[52:55]
    v_mfma_f32_16x16x32_bf16 v[56:59], a[116:119], a[60:63], v[56:59]
    v_mfma_f32_16x16x32_bf16 v[28:31], a[104:107], a[56:59], v[28:31]
    v_mfma_f32_16x16x32_bf16 v[32:35], a[108:111], a[56:59], v[32:35]
    ds_read_b32 v7, v96
    ds_read_b128 v[76:79], v95 offset:0
    ds_read_b128 v[80:83], v95 offset:64
    ds_read_b128 v[84:87], v95 offset:128
    ds_read_b128 v[88:91], v95 offset:192
    v_mfma_f32_16x16x32_bf16 v[36:39], a[112:115], a[56:59], v[36:39]
    v_mfma_f32_16x16x32_bf16 v[40:43], a[116:119], a[56:59], v[40:43]
    s_waitcnt lgkmcnt(0)
Lqf:
    v_readfirstlane_b32 s38, v7
    s_nop 0
    s_cmp_eq_u32 s38, 0
    s_cbranch_scc1 Lqf_re
    s_cmp_eq_u32 s27, 0
    v_fmac_f32 v44, v76, v122
    v_fmac_f32 v45, v77, v122
    v_fmac_f32 v46, v78, v122
    v_fmac_f32 v47, v79, v122
    v_cvt_pk_bf16_f32 v44, v44, v45
    v_cvt_pk_bf16_f32 v45, v46, v47
    v_fmac_f32 v48, v80, v122
    v_fmac_f32 v49, v81, v122
    v_fmac_f32 v50, v82, v122
    v_fmac_f32 v51, v83, v122
    v_cvt_pk_bf16_f32 v46, v48, v49
    v_cvt_pk_bf16_f32 v47, v50, v51
    v_fmac_f32 v52, v84, v122
    v_fmac_f32 v53, v85, v122
    v_fmac_f32 v54, v86, v122
    v_fmac_f32 v55, v87, v122
    v_cvt_pk_bf16_f32 v48, v52, v53
    v_cvt_pk_bf16_f32 v49, v54, v55
    v_fmac_f32 v56, v88, v122
    v_fmac_f32 v57, v89, v122
    v_fmac_f32 v58, v90, v122
    v_fmac_f32 v59, v91, v122
    v_cvt_pk_bf16_f32 v50, v56, v57
    v_cvt_pk_bf16_f32 v51, v58, v59
    s_cbranch_scc1 Lh1
    s_setprio 3
    ds_write_b128 v125, v[44:47] offset:2048
    ds_write_b128 v125, v[48:51] offset:3072
    v_fmac_f32 v28, v76, v120
    v_fmac_f32 v29, v77, v120
    v_fmac_f32 v30, v78, v120
    v_fmac_f32 v31, v79, v120
    v_cvt_pk_bf16_f32 v52, v28, v29
    v_cvt_pk_bf16_f32 v53, v30, v31
    v_fmac_f32 v32, v80, v120
    v_fmac_f32 v33, v81, v120
    v_fmac_f32 v34, v82, v120
    v_fmac_f32 v35, v83, v120
    v_cvt_pk_bf16_f32 v54, v32, v33
    v_cvt_pk_bf16_f32 v55, v34, v35
    v_fmac_f32 v36, v84, v120
    v_fmac_f32 v37, v85, v120
    v_fmac_f32 v38, v86, v120
    v_fmac_f32 v39, v87, v120
    v_cvt_pk_bf16_f32 v56, v36, v37
    v_cvt_pk_bf16_f32 v57, v38, v39
    v_fmac_f32 v40, v88, v120
    v_fmac_f32 v41, v89, v120
    v_fmac_f32 v42, v90, v120
    v_fmac_f32 v43, v91, v120
    v_cvt_pk_bf16_f32 v58, v40, v41
    v_cvt_pk_bf16_f32 v59, v42, v43
    ds_write_b128 v125, v[52:55] offset:4096
    ds_write_b128 v125, v[56:59] offset:5120
    v_mov_b32 v5, 157972
    v_mov_b32 v6, 1
    s_mov_b64 exec, 1
    ds_add_u32 v5, v6
    s_mov_b64 exec, -1
    v_mov_b32 v8, s22
    v_mov_b32 v9, s22
    v_mov_b32 v10, s22
    v_mov_b32 v11, s22
Lcw_1:
    s_sub_u32 s35, s35, 1
    s_cbranch_scc1 Lend
    ds_read_b32 v6, v5
    s_waitcnt lgkmcnt(0)
    v_readfirstlane_b32 s38, v6
    s_nop 0
    s_cmp_lt_u32 s38, 8
    s_cbranch_scc1 Lcw_1
    ds_read_b128 v[28:31], v125 offset:0
    ds_read_b128 v[32:35], v125 offset:1024
Lh_join:
    buffer_load_dword v20, v12, s[28:31], s24 offen sc1
    ds_read_b64_tr_b16 a[64:65], v26 offset:0
    ds_read_b64_tr_b16 a[66:67], v26 offset:512
    ds_read_b64_tr_b16 a[68:69], v27 offset:0
    ds_read_b64_tr_b16 a[70:71], v27 offset:512
    ds_read_b64_tr_b16 a[72:73], v26 offset:4096
    ds_read_b64_tr_b16 a[74:75], v26 offset:4608
    ds_read_b64_tr_b16 a[76:77], v27 offset:4096
    ds_read_b64_tr_b16 a[78:79], v27 offset:4608
    s_waitcnt lgkmcnt(8)
    s_setprio 2
    v_cndmask_b32 v92, 0, v30, s[6:7]
    v_cndmask_b32 v93, 0, v31, s[6:7]
    v_cndmask_b32 v94, 0, v32, s[12:13]
    v_cndmask_b32 v95, 0, v33, s[12:13]
    v_cndmask_b32 v104, 0, v30, s[8:9]
    v_cndmask_b32 v105, 0, v31, s[8:9]
    v_mfma_f32_16x16x32_bf16 v[76:79], v[46:49], v[92:95], v[8:11]
    v_mfma_f32_16x16x32_bf16 v[80:83], v[54:57], v[92:95], 0
    v_cndmask_b32 v106, 0, v32, s[14:15]
    v_cndmask_b32 v107, 0, v33, s[14:15]
    v_mov_b32 v96, v28
    v_mov_b32 v97, v29
    v_mfma_f32_16x16x32_bf16 v[84:87], v[46:49], v[104:107], v[8:11]
    v_mfma_f32_16x16x32_bf16 v[88:91], v[54:57], v[104:107], 0
    v_cndmask_b32 v98, 0, v30, s[10:11]
    v_cndmask_b32 v99, 0, v31, s[10:11]
    v_cndmask_b32 v100, 0, v32, s[16:17]
    v_cndmask_b32 v101, 0, v33, s[16:17]
    v_mfma_f32_16x16x32_bf16 v[36:39], v[44:47], v[96:99], v[8:11]
    v_mfma_f32_16x16x32_bf16 v[40:43], v[52:55], v[96:99], 0
    v_cndmask_b32 v76, v76, v77, s[4:5]
    v_cndmask_b32 v80, v80, v81, s[4:5]
    v_cndmask_b32 v78, v78, v79, s[4:5]
    v_cndmask_b32 v82, v82, v83, s[4:5]
    v_cndmask_b32 v92, v76, v80, s[18:19]
    v_cndmask_b32 v94, v78, v82, s[20:21]
    v_min_u32 v4, -2, v92
    v_min_u32 v5, -2, v94
    v_cndmask_b32 v84, v84, v85, s[4:5]
    v_cndmask_b32 v88, v88, v89, s[4:5]
    v_cndmask_b32 v86, v86, v87, s[4:5]
    v_cndmask_b32 v90, v90, v91, s[4:5]
    v_cndmask_b32 v104, v84, v88, s[18:19]
    v_cndmask_b32 v106, v86, v90, s[20:21]
    v_min_u32 v6, -2, v104
    v_min_u32 v7, -2, v106
    buffer_store_dwordx4 v[4:7], v13, s[28:31], s56 offen sc1
    s_setprio 0
    ds_read_b64_tr_b16 a[80:81], v26 offset:39040
    ds_read_b64_tr_b16 a[82:83], v26 offset:39552
    ds_read_b64_tr_b16 a[84:85], v27 offset:39040
    ds_read_b64_tr_b16 a[86:87], v27 offset:39552
    ds_read_b64_tr_b16 a[88:89], v26 offset:43136
    ds_read_b64_tr_b16 a[90:91], v26 offset:43648
    ds_read_b64_tr_b16 a[92:93], v27 offset:43136
    ds_read_b64_tr_b16 a[94:95], v27 offset:43648
    ds_read_b64_tr_b16 a[96:97], v24 offset:0
    ds_read_b64_tr_b16 a[98:99], v24 offset:512
    ds_read_b64_tr_b16 a[100:101], v25 offset:0
    ds_read_b64_tr_b16 a[102:103], v25 offset:512
    ds_read_b64_tr_b16 a[104:105], v24 offset:4096
    ds_read_b64_tr_b16 a[106:107], v24 offset:4608
    ds_read_b64_tr_b16 a[108:109], v25 offset:4096
    ds_read_b64_tr_b16 a[110:111], v25 offset:4608
    ds_read_b64_tr_b16 a[112:113], v24 offset:39040
    ds_read_b64_tr_b16 a[114:115], v24 offset:39552
    ds_read_b64_tr_b16 a[116:117], v25 offset:39040
    ds_read_b64_tr_b16 a[118:119], v25 offset:39552
    ds_read_b64_tr_b16 a[120:121], v24 offset:43136
    ds_read_b64_tr_b16 a[122:123], v24 offset:43648
    ds_read_b64_tr_b16 a[124:125], v25 offset:43136
    ds_read_b64_tr_b16 a[126:127], v25 offset:43648
    s_waitcnt lgkmcnt(15)
    v_mfma_f32_16x16x32_bf16 v[60:63], a[0:3], a[64:67], v[60:63]
    v_mov_b32 v102, v34
    v_mov_b32 v103, v35
    v_mul_f32 v4, s25, v121
    v_mfma_f32_16x16x32_bf16 v[68:71], a[4:7], a[64:67], v[68:71]
    v_mfma_f32_16x16x32_bf16 v[76:79], v[48:51], v[100:103], v[8:11]
    v_mfma_f32_16x16x32_bf16 v[80:83], v[56:59], v[100:103], 0
    v_mfma_f32_16x16x32_bf16 v[64:67], a[0:3], a[68:71], v[64:67]
    v_mul_f32 v123, v123, v4
    v_mul_f32 v126, v126, v4
    v_cndmask_b32 v36, v36, v37, s[4:5]
    v_mfma_f32_16x16x32_bf16 v[72:75], a[4:7], a[68:71], v[72:75]
    v_cndmask_b32 v40, v40, v41, s[4:5]
    v_cndmask_b32 v38, v38, v39, s[4:5]
    v_mfma_f32_16x16x32_bf16 v[60:63], a[8:11], a[72:75], v[60:63]
    v_cndmask_b32 v42, v42, v43, s[4:5]
    v_cndmask_b32 v96, v36, v40, s[18:19]
    v_cndmask_b32 v98, v38, v42, s[20:21]
    v_mfma_f32_16x16x32_bf16 v[68:71], a[12:15], a[72:75], v[68:71]
    v_cndmask_b32 v76, v76, v77, s[4:5]
    v_cndmask_b32 v80, v80, v81, s[4:5]
    v_mfma_f32_16x16x32_bf16 v[64:67], a[8:11], a[76:79], v[64:67]
    v_cndmask_b32 v78, v78, v79, s[4:5]
    v_cndmask_b32 v82, v82, v83, s[4:5]
    v_cndmask_b32 v100, v76, v80, s[18:19]
    v_mfma_f32_16x16x32_bf16 v[72:75], a[12:15], a[76:79], v[72:75]
    v_cndmask_b32 v102, v78, v82, s[20:21]
    v_mul_f32 v96, v96, v123
    v_mfma_f32_16x16x32_bf16 v[60:63], a[16:19], a[80:83], v[60:63]
    v_mul_f32 v98, v98, v126
    v_mul_f32 v100, v100, v123
    v_mul_f32 v102, v102, v126
    v_mfma_f32_16x16x32_bf16 v[68:71], a[20:23], a[80:83], v[68:71]
    v_max_f32 v4, v96, v98
    v_max_f32 v5, v100, v102
    v_mfma_f32_16x16x32_bf16 v[64:67], a[16:19], a[84:87], v[64:67]
    v_mov_b32 v6, v4
    v_mov_b32 v7, v5
    s_nop 0
    v_permlane32_swap_b32 v4, v6
    v_mfma_f32_16x16x32_bf16 v[72:75], a[20:23], a[84:87], v[72:75]
    v_permlane32_swap_b32 v5, v7
    v_max_f32 v4, v4, v6
    v_mfma_f32_16x16x32_bf16 v[60:63], a[24:27], a[88:91], v[60:63]
    v_max_f32 v5, v5, v7
    v_mov_b32 v6, v4
    v_mov_b32 v7, v5
    v_mfma_f32_16x16x32_bf16 v[68:71], a[28:31], a[88:91], v[68:71]
    v_permlane16_swap_b32 v4, v6
    v_permlane16_swap_b32 v5, v7
    v_mfma_f32_16x16x32_bf16 v[64:67], a[24:27], a[92:95], v[64:67]
    v_max_f32 v4, v4, v6
    v_max_f32 v5, v5, v7
    v_mfma_f32_16x16x32_bf16 v[72:75], a[28:31], a[92:95], v[72:75]
    v_sub_f32 v96, v96, v4
    v_sub_f32 v98, v98, v4
    s_waitcnt lgkmcnt(12)
    v_mfma_f32_16x16x32_bf16 v[60:63], a[32:35], a[96:99], v[60:63]
    v_sub_f32 v100, v100, v5
    v_sub_f32 v102, v102, v5
    v_exp_f32 v96, v96
    v_mfma_f32_16x16x32_bf16 v[68:71], a[36:39], a[96:99], v[68:71]
    v_exp_f32 v98, v98
    v_exp_f32 v100, v100
    v_mfma_f32_16x16x32_bf16 v[64:67], a[32:35], a[100:103], v[64:67]
    v_exp_f32 v102, v102
    v_cvt_pk_bf16_f32 v96, v96, v96
    v_mfma_f32_16x16x32_bf16 v[72:75], a[36:39], a[100:103], v[72:75]
    v_cvt_pk_bf16_f32 v97, v98, v98
    v_cvt_pk_bf16_f32 v100, v100, v100
    s_waitcnt lgkmcnt(8)
    v_mfma_f32_16x16x32_bf16 v[60:63], a[40:43], a[104:107], v[60:63]
    v_cvt_pk_bf16_f32 v101, v102, v102
    v_and_b32 v98, v96, v118
    v_and_b32 v99, v97, v119
    v_mfma_f32_16x16x32_bf16 v[68:71], a[44:47], a[104:107], v[68:71]
    v_and_b32 v96, v96, v116
    v_and_b32 v97, v97, v117
    v_mfma_f32_16x16x32_bf16 v[64:67], a[40:43], a[108:111], v[64:67]
    v_and_b32 v102, v100, v118
    v_and_b32 v103, v101, v119
    v_mfma_f32_16x16x32_bf16 v[72:75], a[44:47], a[108:111], v[72:75]
    v_and_b32 v100, v100, v116
    v_and_b32 v101, v101, v117
    s_waitcnt lgkmcnt(4)
    v_mfma_f32_16x16x32_bf16 v[60:63], a[48:51], a[112:115], v[60:63]
    s_lshl_b32 s36, s43, 6
    s_add_u32 s36, s36, 156160
    v_lshl_add_u32 v48, v2, 4, s36
    v_xor_b32 v49, 64, v48
    ds_read_b128 v[28:31], v48 offset:0
    v_mfma_f32_16x16x32_bf16 v[68:71], a[52:55], a[112:115], v[68:71]
    ds_read_b128 v[32:35], v48 offset:512
    ds_read_b128 v[36:39], v49 offset:0
    ds_read_b128 v[40:43], v49 offset:512
    s_lshl_b32 s36, s27, 3
    s_add_u32 s36, s36, 157696
    v_mfma_f32_16x16x32_bf16 v[64:67], a[48:51], a[116:119], v[64:67]
    v_lshl_add_u32 v48, v3, 4, s36
    v_mov_b32 v49, 157952
    v_lshl_add_u32 v125, v1, 3, s48
    s_lshl_b32 s36, s27, 10
    v_add_u32 v50, s36, v125
    v_mfma_f32_16x16x32_bf16 v[72:75], a[52:55], a[116:119], v[72:75]
    s_lshl_b32 s37, s27, 12
    s_sub_u32 s37, 2048, s37
    v_add_u32 v51, s37, v50
    v_subrev_u32 v125, 2048, v125
    s_waitcnt vmcnt(1)
Lfl_chk:
    v_cmp_eq_u32 vcc, s34, v20
    s_nop 0
    s_and_b32 s36, vcc_lo, 0x3ff
    s_cmp_lg_u32 s36, 0x3ff
    s_cbranch_scc1 Lfl_re
    buffer_load_dwordx2 v[52:53], v13, s[28:31], s57 offen offset:8 sc1
    buffer_load_dwordx2 v[54:55], v13, s[28:31], s58 offen offset:0 sc1
    s_waitcnt lgkmcnt(4)
    v_mfma_f32_16x16x32_bf16 v[60:63], a[56:59], a[120:123], v[60:63]
    v_mfma_f32_16x16x32_bf16 v[68:71], a[60:63], a[120:123], v[68:71]
    v_mfma_f32_16x16x32_bf16 v[64:67], a[56:59], a[124:127], v[64:67]
    v_mfma_f32_16x16x32_bf16 v[72:75], a[60:63], a[124:127], v[72:75]
    ds_read_b32 v46, v49
    ds_read_b64 v[44:45], v48
    s_waitcnt lgkmcnt(0)
Lcsv:
    v_readfirstlane_b32 s38, v46
    s_nop 0
    s_cmp_eq_u32 s38, 0
    s_cbranch_scc1 Lcsv_re
    v_fmac_f32 v60, v28, v44
    v_fmac_f32 v61, v29, v44
    v_fmac_f32 v62, v30, v44
    v_fmac_f32 v63, v31, v44
    v_mul_f32 v60, v60, v32
    v_mul_f32 v61, v61, v33
    v_mul_f32 v62, v62, v34
    v_mul_f32 v63, v63, v35
    v_cvt_pk_bf16_f32 v60, v60, v61
    v_cvt_pk_bf16_f32 v61, v62, v63
    ds_write_b64 v50, v[60:61] offset:0
    v_fmac_f32 v64, v28, v45
    v_fmac_f32 v65, v29, v45
    v_fmac_f32 v66, v30, v45
    v_fmac_f32 v67, v31, v45
    v_mul_f32 v64, v64, v32
    v_mul_f32 v65, v65, v33
    v_mul_f32 v66, v66, v34
    v_mul_f32 v67, v67, v35
    v_cvt_pk_bf16_f32 v64, v64, v65
    v_cvt_pk_bf16_f32 v65, v66, v67
    ds_write_b64 v50, v[64:65] offset:512
    v_fmac_f32 v68, v36, v44
    v_fmac_f32 v69, v37, v44
    v_fmac_f32 v70, v38, v44
    v_fmac_f32 v71, v39, v44
    v_mul_f32 v68, v68, v40
    v_mul_f32 v69, v69, v41
    v_mul_f32 v70, v70, v42
    v_mul_f32 v71, v71, v43
    v_cvt_pk_bf16_f32 v68, v68, v69
    v_cvt_pk_bf16_f32 v69, v70, v71
    ds_write_b64 v51, v[68:69] offset:0
    v_fmac_f32 v72, v36, v45
    v_fmac_f32 v73, v37, v45
    v_fmac_f32 v74, v38, v45
    v_fmac_f32 v75, v39, v45
    v_mul_f32 v72, v72, v40
    v_mul_f32 v73, v73, v41
    v_mul_f32 v74, v74, v42
    v_mul_f32 v75, v75, v43
    v_cvt_pk_bf16_f32 v72, v72, v73
    v_cvt_pk_bf16_f32 v73, v74, v75
    ds_write_b64 v51, v[72:73] offset:512
    v_mov_b32 v8, 157976
    v_mov_b32 v9, 1
    s_mov_b64 exec, 1
    ds_add_u32 v8, v9
    s_mov_b64 exec, -1
    s_waitcnt vmcnt(0)
Lrx_chk:
    v_and_b32 v52, s59, v52
    v_and_b32 v53, s59, v53
    v_and_b32 v54, s60, v54
    v_and_b32 v55, s60, v55
    v_max3_u32 v4, v52, v53, v54
    v_max_u32 v4, v4, v55
    v_cmp_eq_u32 vcc, -1, v4
    s_nop 0
    s_cbranch_vccnz Lrx_re
    v_add_f32 v92, v92, v52
    v_add_f32 v94, v94, v53
    v_add_f32 v104, v104, v54
    v_add_f32 v106, v106, v55
    s_setprio 2
Lcw_4:
    s_sub_u32 s35, s35, 1
    s_cbranch_scc1 Lend
    ds_read_b32 v9, v8
    s_waitcnt lgkmcnt(0)
    v_readfirstlane_b32 s38, v9
    s_nop 0
    s_cmp_lt_u32 s38, 7
    s_cbranch_scc1 Lcw_4
    ds_read2st64_b64 v[60:63], v125 offset0:0 offset1:4
    ds_read2st64_b64 v[64:67], v125 offset0:1 offset1:5
    ds_read2st64_b64 v[68:71], v125 offset0:2 offset1:6
    ds_read2st64_b64 v[72:75], v125 offset0:3 offset1:7
    v_mul_f32 v92, v92, v123
    v_mul_f32 v94, v94, v126
    v_mul_f32 v104, v104, v123
    v_mul_f32 v106, v106, v126
    v_max_f32 v4, v92, v94
    v_max_f32 v5, v104, v106
    v_mov_b32 v6, v4
    v_mov_b32 v7, v5
    s_nop 0
    v_permlane32_swap_b32 v4, v6
    v_permlane32_swap_b32 v5, v7
    v_max_f32 v4, v4, v6
    v_max_f32 v5, v5, v7
    s_waitcnt lgkmcnt(0)
    v_mov_b32 v6, v4
    v_mfma_f32_16x16x32_bf16 v[80:83], v[14:17], v[96:99], 0
    v_mov_b32 v7, v5
    v_permlane16_swap_b32 v4, v6
    s_nop 0
    v_permlane16_swap_b32 v5, v7
    v_max_f32 v4, v4, v6
    v_mfma_f32_16x16x32_bf16 v[84:87], v[14:17], v[100:103], 0
    v_max_f32 v5, v5, v7
    v_sub_f32 v92, v92, v4
    v_sub_f32 v94, v94, v4
    v_sub_f32 v104, v104, v5
    v_mfma_f32_16x16x32_bf16 v[28:31], v[60:63], v[96:99], 0
    v_sub_f32 v106, v106, v5
    v_exp_f32 v92, v92
    v_exp_f32 v94, v94
    v_exp_f32 v104, v104
    v_exp_f32 v106, v106
    v_mfma_f32_16x16x32_bf16 v[32:35], v[64:67], v[96:99], 0
    v_cvt_pk_bf16_f32 v92, v92, v92
    v_cvt_pk_bf16_f32 v93, v94, v94
    v_cvt_pk_bf16_f32 v104, v104, v104
    v_cvt_pk_bf16_f32 v105, v106, v106
    v_mfma_f32_16x16x32_bf16 v[36:39], v[68:71], v[100:103], 0
    v_and_b32 v94, v92, v118
    v_and_b32 v95, v93, v119
    v_and_b32 v92, v92, v116
    v_and_b32 v93, v93, v117
    v_mfma_f32_16x16x32_bf16 v[40:43], v[72:75], v[100:103], 0
    v_and_b32 v106, v104, v118
    v_and_b32 v107, v105, v119
    v_and_b32 v104, v104, v116
    v_and_b32 v105, v105, v117
    v_mfma_f32_16x16x32_bf16 v[76:79], v[14:17], v[92:95], 0
    v_rcp_f32 v80, v80
    v_rcp_f32 v84, v84
    v_mfma_f32_16x16x32_bf16 v[88:91], v[14:17], v[104:107], 0
    v_mul_f32 v28, v28, v80
    v_mul_f32 v29, v29, v80
    v_mfma_f32_16x16x32_bf16 v[44:47], v[64:67], v[92:95], 0
    v_mul_f32 v30, v30, v80
    v_mfma_f32_16x16x32_bf16 v[48:51], v[68:71], v[92:95], 0
    v_mul_f32 v31, v31, v80
    v_cvt_pk_bf16_f32 v4, v28, v29
    v_mfma_f32_16x16x32_bf16 v[52:55], v[64:67], v[104:107], 0
    v_cvt_pk_bf16_f32 v5, v30, v31
    v_min_u32 v4, -2, v4
    v_mfma_f32_16x16x32_bf16 v[56:59], v[68:71], v[104:107], 0
    v_min_u32 v5, -2, v5
    v_mul_f32 v40, v40, v84
    v_mul_f32 v41, v41, v84
    v_mul_f32 v42, v42, v84
    v_mul_f32 v43, v43, v84
    v_cvt_pk_bf16_f32 v10, v40, v41
    v_cvt_pk_bf16_f32 v11, v42, v43
    v_min_u32 v10, -2, v10
    v_min_u32 v11, -2, v11
    v_rcp_f32 v76, v76
    v_rcp_f32 v88, v88
    v_cndmask_b32 v82, v80, v76, s[6:7]
    v_cndmask_b32 v82, v82, v88, s[8:9]
    v_cndmask_b32 v32, v32, v44, s[6:7]
    v_cndmask_b32 v33, v33, v45, s[6:7]
    v_cndmask_b32 v34, v34, v46, s[6:7]
    v_cndmask_b32 v35, v35, v47, s[6:7]
    v_cndmask_b32 v32, v32, v52, s[8:9]
    v_cndmask_b32 v33, v33, v53, s[8:9]
    v_cndmask_b32 v34, v34, v54, s[8:9]
    v_cndmask_b32 v35, v35, v55, s[8:9]
    v_mul_f32 v32, v32, v82
    v_mul_f32 v33, v33, v82
    v_mul_f32 v34, v34, v82
    v_mul_f32 v35, v35, v82
    v_cvt_pk_bf16_f32 v6, v32, v33
    v_cvt_pk_bf16_f32 v7, v34, v35
    v_min_u32 v6, -2, v6
    v_min_u32 v7, -2, v7
    buffer_store_dwordx4 v[4:7], v13, s[28:31], s23 offen offset:0 sc1
    v_cndmask_b32 v86, v84, v76, s[12:13]
    v_cndmask_b32 v86, v86, v88, s[14:15]
    v_cndmask_b32 v36, v36, v48, s[12:13]
    v_cndmask_b32 v37, v37, v49, s[12:13]
    v_cndmask_b32 v38, v38, v50, s[12:13]
    v_cndmask_b32 v39, v39, v51, s[12:13]
    v_cndmask_b32 v36, v36, v56, s[14:15]
    v_cndmask_b32 v37, v37, v57, s[14:15]
    v_cndmask_b32 v38, v38, v58, s[14:15]
    v_cndmask_b32 v39, v39, v59, s[14:15]
    v_mul_f32 v36, v36, v86
    v_mul_f32 v37, v37, v86
    v_mul_f32 v38, v38, v86
    v_mul_f32 v39, v39, v86
    v_cvt_pk_bf16_f32 v8, v36, v37
    v_cvt_pk_bf16_f32 v9, v38, v39
    v_min_u32 v8, -2, v8
    v_min_u32 v9, -2, v9
    buffer_store_dwordx4 v[8:11], v13, s[28:31], s23 offen offset:1024 sc1
    s_setprio 1
    s_nop 0
    v_mov_b32 v10, 157980
    v_and_b32 v6, 3, v1
    v_lshl_add_u32 v6, v6, 3, v19
    v_add_u32 v20, v6, v18
    v_xor_b32 v21, 32, v20
    v_xor_b32 v22, 64, v20
    v_xor_b32 v23, 96, v20
    v_add_u32 v24, 63616, v20
    v_add_u32 v25, 63616, v21
    v_add_u32 v26, 63616, v22
    v_add_u32 v27, 63616, v23
Lcw_3:
    s_sub_u32 s35, s35, 1
    s_cbranch_scc1 Lend
    ds_read_b32 v11, v10
    s_waitcnt lgkmcnt(0)
    v_readfirstlane_b32 s38, v11
    s_nop 0
    s_cmp_lt_u32 s38, 2
    s_cbranch_scc1 Lcw_3
    s_mul_i32 s36, s32, 96
    s_lshl_b32 s37, s43, 4
    s_add_u32 s36, s36, s37
    s_sub_u32 s36, s36, 32
    v_add_u32 v126, s36, v3
    v_lshrrev_b32 v6, 3, v1
    v_add_u32 v6, s36, v6
    v_mul_u32_u24 v6, 1280, v6
    v_and_b32 v7, 7, v1
    v_xor_b32 v7, v7, v2
    v_lshl_add_u32 v122, v7, 4, v6
    v_xor_b32 v123, 64, v122
    v_add_u32 v123, 10240, v123
    s_lshl_b32 s36, s43, 11
    s_add_u32 s36, s36, 102656
    v_add_u32 v124, s36, v124
    v_add_u32 v125, s36, v13
    s_lshl_b32 s24, s33, 7
    v_mov_b32 v10, 157960
    s_mov_b32 s41, 0
    s_mov_b32 s61, 3
    v_lshlrev_b32 v28, 16, v108
    ds_read_b64_tr_b16 a[0:1], v20 offset:0
    ds_read_b64_tr_b16 a[2:3], v20 offset:512
    ds_read_b64_tr_b16 a[4:5], v21 offset:0
    ds_read_b64_tr_b16 a[6:7], v21 offset:512
    ds_read_b64_tr_b16 a[8:9], v22 offset:0
    ds_read_b64_tr_b16 a[10:11], v22 offset:512
    ds_read_b64_tr_b16 a[12:13], v23 offset:0
    ds_read_b64_tr_b16 a[14:15], v23 offset:512
    v_and_b32 v29, 0xffff0000, v108
    v_lshlrev_b32 v30, 16, v109
    v_and_b32 v31, 0xffff0000, v109
    v_lshlrev_b32 v32, 16, v110
    v_and_b32 v33, 0xffff0000, v110
    v_lshlrev_b32 v34, 16, v111
    v_and_b32 v35, 0xffff0000, v111
    v_lshlrev_b32 v36, 16, v112
    v_and_b32 v37, 0xffff0000, v112
    v_lshlrev_b32 v38, 16, v113
    v_and_b32 v39, 0xffff0000, v113
    v_lshlrev_b32 v40, 16, v114
    v_and_b32 v41, 0xffff0000, v114
    v_lshlrev_b32 v42, 16, v115
    ds_read_b64_tr_b16 a[16:17], v20 offset:4096
    ds_read_b64_tr_b16 a[18:19], v20 offset:4608
    ds_read_b64_tr_b16 a[20:21], v21 offset:4096
    ds_read_b64_tr_b16 a[22:23], v21 offset:4608
    ds_read_b64_tr_b16 a[24:25], v22 offset:4096
    ds_read_b64_tr_b16 a[26:27], v22 offset:4608
    ds_read_b64_tr_b16 a[28:29], v23 offset:4096
    ds_read_b64_tr_b16 a[30:31], v23 offset:4608
    v_and_b32 v43, 0xffff0000, v115
    v_mul_f32 v4, v120, v121
    v_mul_f32 v5, 0xbfb8aa3b, v121
    v_mul_f32 v6, 0xbfb8aa3b, v4
    v_fma_f32 v44, v28, v5, v6
    v_fma_f32 v45, v29, v5, v6
    v_fma_f32 v46, v30, v5, v6
    v_fma_f32 v47, v31, v5, v6
    v_fma_f32 v48, v32, v5, v6
    v_fma_f32 v49, v33, v5, v6
    v_fma_f32 v50, v34, v5, v6
    v_fma_f32 v51, v35, v5, v6
    v_fma_f32 v52, v36, v5, v6
    v_fma_f32 v53, v37, v5, v6
    ds_read_b64_tr_b16 a[32:33], v20 offset:8192
    ds_read_b64_tr_b16 a[34:35], v20 offset:8704
    ds_read_b64_tr_b16 a[36:37], v21 offset:8192
    ds_read_b64_tr_b16 a[38:39], v21 offset:8704
    ds_read_b64_tr_b16 a[40:41], v22 offset:8192
    ds_read_b64_tr_b16 a[42:43], v22 offset:8704
    ds_read_b64_tr_b16 a[44:45], v23 offset:8192
    ds_read_b64_tr_b16 a[46:47], v23 offset:8704
    v_fma_f32 v54, v38, v5, v6
    v_fma_f32 v55, v39, v5, v6
    v_fma_f32 v56, v40, v5, v6
    v_fma_f32 v57, v41, v5, v6
    v_fma_f32 v58, v42, v5, v6
    v_fma_f32 v59, v43, v5, v6
    v_exp_f32 v44, v44
    v_exp_f32 v45, v45
    v_exp_f32 v46, v46
    v_exp_f32 v47, v47
    v_exp_f32 v48, v48
    v_exp_f32 v49, v49
    v_exp_f32 v50, v50
    v_exp_f32 v51, v51
    v_exp_f32 v52, v52
    ds_read_b64_tr_b16 a[48:49], v20 offset:12288
    ds_read_b64_tr_b16 a[50:51], v20 offset:12800
    ds_read_b64_tr_b16 a[52:53], v21 offset:12288
    ds_read_b64_tr_b16 a[54:55], v21 offset:12800
    ds_read_b64_tr_b16 a[56:57], v22 offset:12288
    ds_read_b64_tr_b16 a[58:59], v22 offset:12800
    ds_read_b64_tr_b16 a[60:61], v23 offset:12288
    ds_read_b64_tr_b16 a[62:63], v23 offset:12800
    v_exp_f32 v53, v53
    v_exp_f32 v54, v54
    v_exp_f32 v55, v55
    v_exp_f32 v56, v56
    v_exp_f32 v57, v57
    v_exp_f32 v58, v58
    v_exp_f32 v59, v59
    v_fma_f32 v92, v28, v121, v4
    v_fma_f32 v93, v29, v121, v4
    v_fma_f32 v94, v30, v121, v4
    v_fma_f32 v95, v31, v121, v4
    v_fma_f32 v96, v32, v121, v4
    v_fma_f32 v97, v33, v121, v4
    v_fma_f32 v98, v34, v121, v4
    ds_read_b64_tr_b16 a[64:65], v20 offset:24576
    ds_read_b64_tr_b16 a[66:67], v20 offset:25088
    ds_read_b64_tr_b16 a[68:69], v21 offset:24576
    ds_read_b64_tr_b16 a[70:71], v21 offset:25088
    ds_read_b64_tr_b16 a[72:73], v22 offset:24576
    ds_read_b64_tr_b16 a[74:75], v22 offset:25088
    ds_read_b64_tr_b16 a[76:77], v23 offset:24576
    ds_read_b64_tr_b16 a[78:79], v23 offset:25088
    v_fma_f32 v99, v35, v121, v4
    v_fma_f32 v100, v36, v121, v4
    v_fma_f32 v101, v37, v121, v4
    v_fma_f32 v102, v38, v121, v4
    v_fma_f32 v103, v39, v121, v4
    v_fma_f32 v104, v40, v121, v4
    v_fma_f32 v105, v41, v121, v4
    v_fma_f32 v106, v42, v121, v4
    v_fma_f32 v107, v43, v121, v4
    v_add_f32 v44, 1.0, v44
    v_add_f32 v45, 1.0, v45
    v_add_f32 v46, 1.0, v46
    v_add_f32 v47, 1.0, v47
    v_add_f32 v48, 1.0, v48
    ds_read_b64_tr_b16 a[80:81], v20 offset:28672
    ds_read_b64_tr_b16 a[82:83], v20 offset:29184
    ds_read_b64_tr_b16 a[84:85], v21 offset:28672
    ds_read_b64_tr_b16 a[86:87], v21 offset:29184
    ds_read_b64_tr_b16 a[88:89], v22 offset:28672
    ds_read_b64_tr_b16 a[90:91], v22 offset:29184
    ds_read_b64_tr_b16 a[92:93], v23 offset:28672
    ds_read_b64_tr_b16 a[94:95], v23 offset:29184
    v_add_f32 v49, 1.0, v49
    v_add_f32 v50, 1.0, v50
    v_add_f32 v51, 1.0, v51
    v_add_f32 v52, 1.0, v52
    v_add_f32 v53, 1.0, v53
    v_add_f32 v54, 1.0, v54
    v_add_f32 v55, 1.0, v55
    v_add_f32 v56, 1.0, v56
    v_add_f32 v57, 1.0, v57
    v_add_f32 v58, 1.0, v58
    v_add_f32 v59, 1.0, v59
    v_rcp_f32 v44, v44
    v_rcp_f32 v45, v45
    v_rcp_f32 v46, v46
    v_rcp_f32 v47, v47
    ds_read_b64_tr_b16 a[96:97], v24 offset:59520
    ds_read_b64_tr_b16 a[98:99], v24 offset:60032
    ds_read_b64_tr_b16 a[100:101], v25 offset:59520
    ds_read_b64_tr_b16 a[102:103], v25 offset:60032
    ds_read_b64_tr_b16 a[104:105], v26 offset:59520
    ds_read_b64_tr_b16 a[106:107], v26 offset:60032
    ds_read_b64_tr_b16 a[108:109], v27 offset:59520
    ds_read_b64_tr_b16 a[110:111], v27 offset:60032
    v_rcp_f32 v48, v48
    v_rcp_f32 v49, v49
    v_rcp_f32 v50, v50
    v_rcp_f32 v51, v51
    v_rcp_f32 v52, v52
    v_rcp_f32 v53, v53
    v_rcp_f32 v54, v54
    v_rcp_f32 v55, v55
    v_rcp_f32 v56, v56
    v_rcp_f32 v57, v57
    v_rcp_f32 v58, v58
    v_rcp_f32 v59, v59
    v_mul_f32 v44, v44, v92
    v_mul_f32 v45, v45, v93
    ds_read_b64_tr_b16 a[112:113], v24 offset:63616
    ds_read_b64_tr_b16 a[114:115], v24 offset:64128
    ds_read_b64_tr_b16 a[116:117], v25 offset:63616
    ds_read_b64_tr_b16 a[118:119], v25 offset:64128
    ds_read_b64_tr_b16 a[120:121], v26 offset:63616
    ds_read_b64_tr_b16 a[122:123], v26 offset:64128
    ds_read_b64_tr_b16 a[124:125], v27 offset:63616
    ds_read_b64_tr_b16 a[126:127], v27 offset:64128
    v_mul_f32 v46, v46, v94
    v_mul_f32 v47, v47, v95
    v_mul_f32 v48, v48, v96
    v_mul_f32 v49, v49, v97
    v_mul_f32 v50, v50, v98
    v_mul_f32 v51, v51, v99
    v_mul_f32 v52, v52, v100
    v_mul_f32 v53, v53, v101
    v_mul_f32 v54, v54, v102
    v_mul_f32 v55, v55, v103
    v_mul_f32 v56, v56, v104
    v_mul_f32 v57, v57, v105
    v_mul_f32 v58, v58, v106
    v_mul_f32 v59, v59, v107
    buffer_load_dwordx4 v[60:63], v13, s[28:31], s51 offen offset:0 sc1
    buffer_load_dwordx4 v[64:67], v13, s[28:31], s51 offen offset:1024 sc1
    buffer_load_dwordx4 v[68:71], v13, s[28:31], s51 offen offset:2048 sc1
    buffer_load_dwordx4 v[72:75], v13, s[28:31], s51 offen offset:3072 sc1
    buffer_load_dwordx4 v[76:79], v13, s[28:31], s52 offen offset:0 sc1
    buffer_load_dwordx4 v[80:83], v13, s[28:31], s52 offen offset:1024 sc1
    buffer_load_dwordx4 v[84:87], v13, s[28:31], s52 offen offset:2048 sc1
    buffer_load_dwordx4 v[88:91], v13, s[28:31], s52 offen offset:3072 sc1
    s_setprio 0
Lwo_go:
    s_setprio 3
    ds_read_b64 v[8:9], v10
    s_waitcnt vmcnt(6) lgkmcnt(15)
    v_mfma_f32_16x16x32_bf16 v[108:111], a[0:3], v[60:63], 0
    ds_read_b64_tr_b16 a[0:1], v24 offset:16384
    ds_read_b64_tr_b16 a[2:3], v24 offset:16896
    buffer_load_dwordx4 v[92:95], v13, s[28:31], s53 offen offset:0 sc1
    v_mfma_f32_16x16x32_bf16 v[112:115], a[4:7], v[60:63], 0
    ds_read_b64_tr_b16 a[4:5], v25 offset:16384
    ds_read_b64_tr_b16 a[6:7], v25 offset:16896
    v_mfma_f32_16x16x32_bf16 v[116:119], a[8:11], v[60:63], 0
    ds_read_b64_tr_b16 a[8:9], v26 offset:16384
    ds_read_b64_tr_b16 a[10:11], v26 offset:16896
    v_mfma_f32_16x16x32_bf16 v[14:17], a[12:15], v[60:63], 0
    ds_read_b64_tr_b16 a[12:13], v27 offset:16384
    ds_read_b64_tr_b16 a[14:15], v27 offset:16896
    v_mfma_f32_16x16x32_bf16 v[108:111], a[16:19], v[64:67], v[108:111]
    ds_read_b64_tr_b16 a[16:17], v24 offset:20480
    ds_read_b64_tr_b16 a[18:19], v24 offset:20992
    buffer_load_dwordx4 v[96:99], v13, s[28:31], s53 offen offset:1024 sc1
    v_mfma_f32_16x16x32_bf16 v[112:115], a[20:23], v[64:67], v[112:115]
    ds_read_b64_tr_b16 a[20:21], v25 offset:20480
    ds_read_b64_tr_b16 a[22:23], v25 offset:20992
    v_mfma_f32_16x16x32_bf16 v[116:119], a[24:27], v[64:67], v[116:119]
    ds_read_b64_tr_b16 a[24:25], v26 offset:20480
    ds_read_b64_tr_b16 a[26:27], v26 offset:20992
    v_mfma_f32_16x16x32_bf16 v[14:17], a[28:31], v[64:67], v[14:17]
    ds_read_b64_tr_b16 a[28:29], v27 offset:20480
    ds_read_b64_tr_b16 a[30:31], v27 offset:20992
    s_waitcnt lgkmcnt(15)
Linfo:
    v_readfirstlane_b32 s39, v8
    s_nop 0
    s_cmp_eq_u32 s39, -2
    s_cbranch_scc1 Linfo_re
    v_cmp_class_f32_e64 vcc, v108, s61
    s_nop 0
    s_cbranch_vccnz Lnan
    s_waitcnt vmcnt(6)
    v_mfma_f32_16x16x32_bf16 v[108:111], a[32:35], v[68:71], v[108:111]
    ds_read_b64_tr_b16 a[32:33], v20 offset:32768
    ds_read_b64_tr_b16 a[34:35], v20 offset:33280
    buffer_load_dwordx4 v[100:103], v13, s[28:31], s53 offen offset:2048 sc1
    v_mfma_f32_16x16x32_bf16 v[112:115], a[36:39], v[68:71], v[112:115]
    ds_read_b64_tr_b16 a[36:37], v21 offset:32768
    ds_read_b64_tr_b16 a[38:39], v21 offset:33280
    v_mfma_f32_16x16x32_bf16 v[116:119], a[40:43], v[68:71], v[116:119]
    ds_read_b64_tr_b16 a[40:41], v22 offset:32768
    ds_read_b64_tr_b16 a[42:43], v22 offset:33280
    v_mfma_f32_16x16x32_bf16 v[14:17], a[44:47], v[68:71], v[14:17]
    ds_read_b64_tr_b16 a[44:45], v23 offset:32768
    ds_read_b64_tr_b16 a[46:47], v23 offset:33280
    v_mfma_f32_16x16x32_bf16 v[108:111], a[48:51], v[72:75], v[108:111]
    ds_read_b64_tr_b16 a[48:49], v20 offset:36864
    ds_read_b64_tr_b16 a[50:51], v20 offset:37376
    buffer_load_dwordx4 v[104:107], v13, s[28:31], s53 offen offset:3072 sc1
    v_mfma_f32_16x16x32_bf16 v[112:115], a[52:55], v[72:75], v[112:115]
    ds_read_b64_tr_b16 a[52:53], v21 offset:36864
    ds_read_b64_tr_b16 a[54:55], v21 offset:37376
    v_mfma_f32_16x16x32_bf16 v[116:119], a[56:59], v[72:75], v[116:119]
    ds_read_b64_tr_b16 a[56:57], v22 offset:36864
    ds_read_b64_tr_b16 a[58:59], v22 offset:37376
    v_mfma_f32_16x16x32_bf16 v[14:17], a[60:63], v[72:75], v[14:17]
    ds_read_b64_tr_b16 a[60:61], v23 offset:36864
    ds_read_b64_tr_b16 a[62:63], v23 offset:37376
    v_cmp_class_f32_e64 vcc, v108, s61
    s_nop 0
    s_cbranch_vccnz Lnan
    s_waitcnt vmcnt(6)
    v_mfma_f32_16x16x32_bf16 v[108:111], a[64:67], v[76:79], v[108:111]
    ds_read_b64_tr_b16 a[64:65], v20 offset:40960
    ds_read_b64_tr_b16 a[66:67], v20 offset:41472
    buffer_load_dwordx4 v[60:63], v13, s[28:31], s54 offen offset:0 sc1
    v_mfma_f32_16x16x32_bf16 v[112:115], a[68:71], v[76:79], v[112:115]
    ds_read_b64_tr_b16 a[68:69], v21 offset:40960
    ds_read_b64_tr_b16 a[70:71], v21 offset:41472
    v_mfma_f32_16x16x32_bf16 v[116:119], a[72:75], v[76:79], v[116:119]
    ds_read_b64_tr_b16 a[72:73], v22 offset:40960
    ds_read_b64_tr_b16 a[74:75], v22 offset:41472
    v_mfma_f32_16x16x32_bf16 v[14:17], a[76:79], v[76:79], v[14:17]
    ds_read_b64_tr_b16 a[76:77], v23 offset:40960
    ds_read_b64_tr_b16 a[78:79], v23 offset:41472
    v_mfma_f32_16x16x32_bf16 v[108:111], a[80:83], v[80:83], v[108:111]
    ds_read_b64_tr_b16 a[80:81], v20 offset:45056
    ds_read_b64_tr_b16 a[82:83], v20 offset:45568
    buffer_load_dwordx4 v[64:67], v13, s[28:31], s54 offen offset:1024 sc1
    v_mfma_f32_16x16x32_bf16 v[112:115], a[84:87], v[80:83], v[112:115]
    ds_read_b64_tr_b16 a[84:85], v21 offset:45056
    ds_read_b64_tr_b16 a[86:87], v21 offset:45568
    v_mfma_f32_16x16x32_bf16 v[116:119], a[88:91], v[80:83], v[116:119]
    ds_read_b64_tr_b16 a[88:89], v22 offset:45056
    ds_read_b64_tr_b16 a[90:91], v22 offset:45568
    v_mfma_f32_16x16x32_bf16 v[14:17], a[92:95], v[80:83], v[14:17]
    ds_read_b64_tr_b16 a[92:93], v23 offset:45056
    ds_read_b64_tr_b16 a[94:95], v23 offset:45568
    s_setprio 2
    v_cmp_class_f32_e64 vcc, v108, s61
    s_nop 0
    s_cbranch_vccnz Lnan
    s_waitcnt vmcnt(6)
    v_mfma_f32_16x16x32_bf16 v[108:111], a[96:99], v[84:87], v[108:111]
    ds_read_b64_tr_b16 a[96:97], v24 offset:0
    ds_read_b64_tr_b16 a[98:99], v24 offset:512
    buffer_load_dwordx4 v[68:71], v13, s[28:31], s54 offen offset:2048 sc1
    v_mfma_f32_16x16x32_bf16 v[112:115], a[100:103], v[84:87], v[112:115]
    ds_read_b64_tr_b16 a[100:101], v25 offset:0
    ds_read_b64_tr_b16 a[102:103], v25 offset:512
    v_mfma_f32_16x16x32_bf16 v[116:119], a[104:107], v[84:87], v[116:119]
    ds_read_b64_tr_b16 a[104:105], v26 offset:0
    ds_read_b64_tr_b16 a[106:107], v26 offset:512
    v_mfma_f32_16x16x32_bf16 v[14:17], a[108:111], v[84:87], v[14:17]
    ds_read_b64_tr_b16 a[108:109], v27 offset:0
    ds_read_b64_tr_b16 a[110:111], v27 offset:512
    v_mfma_f32_16x16x32_bf16 v[108:111], a[112:115], v[88:91], v[108:111]
    ds_read_b64_tr_b16 a[112:113], v24 offset:4096
    ds_read_b64_tr_b16 a[114:115], v24 offset:4608
    buffer_load_dwordx4 v[72:75], v13, s[28:31], s54 offen offset:3072 sc1
    v_mfma_f32_16x16x32_bf16 v[112:115], a[116:119], v[88:91], v[112:115]
    ds_read_b64_tr_b16 a[116:117], v25 offset:4096
    ds_read_b64_tr_b16 a[118:119], v25 offset:4608
    v_mfma_f32_16x16x32_bf16 v[116:119], a[120:123], v[88:91], v[116:119]
    ds_read_b64_tr_b16 a[120:121], v26 offset:4096
    ds_read_b64_tr_b16 a[122:123], v26 offset:4608
    v_mfma_f32_16x16x32_bf16 v[14:17], a[124:127], v[88:91], v[14:17]
    ds_read_b64_tr_b16 a[124:125], v27 offset:4096
    ds_read_b64_tr_b16 a[126:127], v27 offset:4608
    v_cmp_class_f32_e64 vcc, v108, s61
    s_nop 0
    s_cbranch_vccnz Lnan
    s_waitcnt vmcnt(6) lgkmcnt(15)
    v_mfma_f32_16x16x32_bf16 v[108:111], a[0:3], v[92:95], v[108:111]
    ds_read_b64_tr_b16 a[0:1], v24 offset:8192
    ds_read_b64_tr_b16 a[2:3], v24 offset:8704
    buffer_load_dwordx4 v[76:79], v13, s[28:31], s55 offen offset:0 sc1
    v_mfma_f32_16x16x32_bf16 v[112:115], a[4:7], v[92:95], v[112:115]
    ds_read_b64_tr_b16 a[4:5], v25 offset:8192
    ds_read_b64_tr_b16 a[6:7], v25 offset:8704
    v_mfma_f32_16x16x32_bf16 v[116:119], a[8:11], v[92:95], v[116:119]
    ds_read_b64_tr_b16 a[8:9], v26 offset:8192
    ds_read_b64_tr_b16 a[10:11], v26 offset:8704
    v_mfma_f32_16x16x32_bf16 v[14:17], a[12:15], v[92:95], v[14:17]
    ds_read_b64_tr_b16 a[12:13], v27 offset:8192
    ds_read_b64_tr_b16 a[14:15], v27 offset:8704
    v_mfma_f32_16x16x32_bf16 v[108:111], a[16:19], v[96:99], v[108:111]
    ds_read_b64_tr_b16 a[16:17], v24 offset:12288
    ds_read_b64_tr_b16 a[18:19], v24 offset:12800
    buffer_load_dwordx4 v[80:83], v13, s[28:31], s55 offen offset:1024 sc1
    v_mfma_f32_16x16x32_bf16 v[112:115], a[20:23], v[96:99], v[112:115]
    ds_read_b64_tr_b16 a[20:21], v25 offset:12288
    ds_read_b64_tr_b16 a[22:23], v25 offset:12800
    v_mfma_f32_16x16x32_bf16 v[116:119], a[24:27], v[96:99], v[116:119]
    ds_read_b64_tr_b16 a[24:25], v26 offset:12288
    ds_read_b64_tr_b16 a[26:27], v26 offset:12800
    v_mfma_f32_16x16x32_bf16 v[14:17], a[28:31], v[96:99], v[14:17]
    ds_read_b64_tr_b16 a[28:29], v27 offset:12288
    ds_read_b64_tr_b16 a[30:31], v27 offset:12800
    v_cmp_class_f32_e64 vcc, v108, s61
    s_nop 0
    s_cbranch_vccnz Lnan
    s_waitcnt vmcnt(6)
    v_mfma_f32_16x16x32_bf16 v[108:111], a[32:35], v[100:103], v[108:111]
    ds_read_b64_tr_b16 a[32:33], v20 offset:49152
    ds_read_b64_tr_b16 a[34:35], v20 offset:49664
    buffer_load_dwordx4 v[84:87], v13, s[28:31], s55 offen offset:2048 sc1
    v_mfma_f32_16x16x32_bf16 v[112:115], a[36:39], v[100:103], v[112:115]
    ds_read_b64_tr_b16 a[36:37], v21 offset:49152
    ds_read_b64_tr_b16 a[38:39], v21 offset:49664
    v_mfma_f32_16x16x32_bf16 v[116:119], a[40:43], v[100:103], v[116:119]
    ds_read_b64_tr_b16 a[40:41], v22 offset:49152
    ds_read_b64_tr_b16 a[42:43], v22 offset:49664
    v_mfma_f32_16x16x32_bf16 v[14:17], a[44:47], v[100:103], v[14:17]
    ds_read_b64_tr_b16 a[44:45], v23 offset:49152
    ds_read_b64_tr_b16 a[46:47], v23 offset:49664
    v_mfma_f32_16x16x32_bf16 v[108:111], a[48:51], v[104:107], v[108:111]
    ds_read_b64_tr_b16 a[48:49], v24 offset:24576
    ds_read_b64_tr_b16 a[50:51], v24 offset:25088
    buffer_load_dwordx4 v[88:91], v13, s[28:31], s55 offen offset:3072 sc1
    v_mfma_f32_16x16x32_bf16 v[112:115], a[52:55], v[104:107], v[112:115]
    ds_read_b64_tr_b16 a[52:53], v25 offset:24576
    ds_read_b64_tr_b16 a[54:55], v25 offset:25088
    v_mfma_f32_16x16x32_bf16 v[116:119], a[56:59], v[104:107], v[116:119]
    ds_read_b64_tr_b16 a[56:57], v26 offset:24576
    ds_read_b64_tr_b16 a[58:59], v26 offset:25088
    v_mfma_f32_16x16x32_bf16 v[14:17], a[60:63], v[104:107], v[14:17]
    ds_read_b64_tr_b16 a[60:61], v27 offset:24576
    ds_read_b64_tr_b16 a[62:63], v27 offset:25088
    s_setprio 1
    v_cmp_class_f32_e64 vcc, v108, s61
    s_nop 0
    s_cbranch_vccnz Lnan
    s_waitcnt vmcnt(6)
    v_mfma_f32_16x16x32_bf16 v[108:111], a[64:67], v[60:63], v[108:111]
    v_mfma_f32_16x16x32_bf16 v[112:115], a[68:71], v[60:63], v[112:115]
    v_mfma_f32_16x16x32_bf16 v[116:119], a[72:75], v[60:63], v[116:119]
    v_mfma_f32_16x16x32_bf16 v[14:17], a[76:79], v[60:63], v[14:17]
    v_mfma_f32_16x16x32_bf16 v[108:111], a[80:83], v[64:67], v[108:111]
    v_mfma_f32_16x16x32_bf16 v[112:115], a[84:87], v[64:67], v[112:115]
    v_mfma_f32_16x16x32_bf16 v[116:119], a[88:91], v[64:67], v[116:119]
    v_mfma_f32_16x16x32_bf16 v[14:17], a[92:95], v[64:67], v[14:17]
    s_waitcnt vmcnt(4) lgkmcnt(15)
    v_mfma_f32_16x16x32_bf16 v[108:111], a[96:99], v[68:71], v[108:111]
    v_mfma_f32_16x16x32_bf16 v[112:115], a[100:103], v[68:71], v[112:115]
    v_mfma_f32_16x16x32_bf16 v[116:119], a[104:107], v[68:71], v[116:119]
    v_mfma_f32_16x16x32_bf16 v[14:17], a[108:111], v[68:71], v[14:17]
    v_mfma_f32_16x16x32_bf16 v[108:111], a[112:115], v[72:75], v[108:111]
    v_mfma_f32_16x16x32_bf16 v[112:115], a[116:119], v[72:75], v[112:115]
    v_mfma_f32_16x16x32_bf16 v[116:119], a[120:123], v[72:75], v[116:119]
    v_mfma_f32_16x16x32_bf16 v[14:17], a[124:127], v[72:75], v[14:17]
    s_setprio 0
    s_waitcnt vmcnt(2)
    v_mfma_f32_16x16x32_bf16 v[108:111], a[0:3], v[76:79], v[108:111]
    v_mfma_f32_16x16x32_bf16 v[112:115], a[4:7], v[76:79], v[112:115]
    v_mfma_f32_16x16x32_bf16 v[116:119], a[8:11], v[76:79], v[116:119]
    v_mfma_f32_16x16x32_bf16 v[14:17], a[12:15], v[76:79], v[14:17]
    v_mfma_f32_16x16x32_bf16 v[108:111], a[16:19], v[80:83], v[108:111]
    v_mfma_f32_16x16x32_bf16 v[112:115], a[20:23], v[80:83], v[112:115]
    v_mfma_f32_16x16x32_bf16 v[116:119], a[24:27], v[80:83], v[116:119]
    v_mfma_f32_16x16x32_bf16 v[14:17], a[28:31], v[80:83], v[14:17]
    s_waitcnt vmcnt(0) lgkmcnt(8)
    v_mfma_f32_16x16x32_bf16 v[108:111], a[32:35], v[84:87], v[108:111]
    v_mfma_f32_16x16x32_bf16 v[112:115], a[36:39], v[84:87], v[112:115]
    v_mfma_f32_16x16x32_bf16 v[116:119], a[40:43], v[84:87], v[116:119]
    v_mfma_f32_16x16x32_bf16 v[14:17], a[44:47], v[84:87], v[14:17]
    s_waitcnt lgkmcnt(0)
    v_mfma_f32_16x16x32_bf16 v[108:111], a[48:51], v[88:91], v[108:111]
    v_mfma_f32_16x16x32_bf16 v[112:115], a[52:55], v[88:91], v[112:115]
    v_mfma_f32_16x16x32_bf16 v[116:119], a[56:59], v[88:91], v[116:119]
    v_mfma_f32_16x16x32_bf16 v[14:17], a[60:63], v[88:91], v[14:17]
    v_xor_b32 v60, 32, v124
    v_xor_b32 v61, 64, v124
    v_xor_b32 v62, 96, v124
    v_and_b32 v6, v8, v9
    s_nop 0
    v_readfirstlane_b32 s39, v6
    v_cmp_class_f32_e64 vcc, v108, s61
    s_nop 0
    s_cbranch_vccnz Lnan
    s_cmp_eq_u32 s39, -1
    s_cbranch_scc0 Lfix
Lnofix:
    v_fma_f32 v108, v108, v44, v28
    v_fma_f32 v109, v109, v45, v29
    v_fma_f32 v110, v110, v46, v30
    v_fma_f32 v111, v111, v47, v31
    v_cvt_pk_bf16_f32 v68, v108, v109
    v_cvt_pk_bf16_f32 v69, v110, v111
    ds_write_b64 v124, v[68:69]
    v_fma_f32 v112, v112, v48, v32
    v_fma_f32 v113, v113, v49, v33
    v_fma_f32 v114, v114, v50, v34
    v_fma_f32 v115, v115, v51, v35
    v_cvt_pk_bf16_f32 v70, v112, v113
    v_cvt_pk_bf16_f32 v71, v114, v115
    ds_write_b64 v60, v[70:71]
    v_fma_f32 v116, v116, v52, v36
    v_fma_f32 v117, v117, v53, v37
    v_fma_f32 v118, v118, v54, v38
    v_fma_f32 v119, v119, v55, v39
    v_cvt_pk_bf16_f32 v72, v116, v117
    v_cvt_pk_bf16_f32 v73, v118, v119
    ds_write_b64 v61, v[72:73]
    v_fma_f32 v14, v14, v56, v40
    v_fma_f32 v15, v15, v57, v41
    v_fma_f32 v16, v16, v58, v42
    v_fma_f32 v17, v17, v59, v43
    v_cvt_pk_bf16_f32 v74, v14, v15
    v_cvt_pk_bf16_f32 v75, v16, v17
    ds_write_b64 v62, v[74:75]
    ds_read_b128 v[76:79], v125 offset:0
    ds_read_b128 v[80:83], v125 offset:1024
    s_waitcnt lgkmcnt(1)
    buffer_store_dwordx4 v[76:79], v122, s[44:47], s24 offen
    s_waitcnt lgkmcnt(0)
    buffer_store_dwordx4 v[80:83], v123, s[44:47], s24 offen
    s_endpgm
Lh1:
    ds_write_b128 v125, v[44:47] offset:0
    ds_write_b128 v125, v[48:51] offset:1024
    v_mov_b32 v5, 157972
    v_mov_b32 v6, 1
    s_mov_b64 exec, 1
    ds_add_u32 v5, v6
    s_mov_b64 exec, -1
    v_fmac_f32 v28, v76, v120
    v_fmac_f32 v29, v77, v120
    v_fmac_f32 v30, v78, v120
    v_fmac_f32 v31, v79, v120
    v_cvt_pk_bf16_f32 v28, v28, v29
    v_cvt_pk_bf16_f32 v29, v30, v31
    v_fmac_f32 v32, v80, v120
    v_fmac_f32 v33, v81, v120
    v_fmac_f32 v34, v82, v120
    v_fmac_f32 v35, v83, v120
    v_cvt_pk_bf16_f32 v30, v32, v33
    v_cvt_pk_bf16_f32 v31, v34, v35
    v_fmac_f32 v36, v84, v120
    v_fmac_f32 v37, v85, v120
    v_fmac_f32 v38, v86, v120
    v_fmac_f32 v39, v87, v120
    v_cvt_pk_bf16_f32 v32, v36, v37
    v_cvt_pk_bf16_f32 v33, v38, v39
    v_fmac_f32 v40, v88, v120
    v_fmac_f32 v41, v89, v120
    v_fmac_f32 v42, v90, v120
    v_fmac_f32 v43, v91, v120
    v_cvt_pk_bf16_f32 v34, v40, v41
    v_cvt_pk_bf16_f32 v35, v42, v43
    v_subrev_u32 v4, 6144, v125
    v_mov_b32 v8, s22
    v_mov_b32 v9, s22
    v_mov_b32 v10, s22
    v_mov_b32 v11, s22
Lcw_2:
    s_sub_u32 s35, s35, 1
    s_cbranch_scc1 Lend
    ds_read_b32 v6, v5
    s_waitcnt lgkmcnt(0)
    v_readfirstlane_b32 s38, v6
    s_nop 0
    s_cmp_lt_u32 s38, 8
    s_cbranch_scc1 Lcw_2
    ds_read_b128 v[52:55], v125 offset:2048
    ds_read_b128 v[56:59], v125 offset:3072
    ds_read_b128 v[44:47], v4 offset:4096
    ds_read_b128 v[48:51], v4 offset:5120
    s_branch Lh_join
Lqf_re:
    s_sub_u32 s35, s35, 1
    s_cbranch_scc1 Lend
    ds_read_b32 v7, v96
    ds_read_b128 v[76:79], v95 offset:0
    ds_read_b128 v[80:83], v95 offset:64
    ds_read_b128 v[84:87], v95 offset:128
    ds_read_b128 v[88:91], v95 offset:192
    s_waitcnt lgkmcnt(0)
    s_branch Lqf
Lcsv_re:
    s_sub_u32 s35, s35, 1
    s_cbranch_scc1 Lend
    ds_read_b32 v46, v49
    ds_read_b64 v[44:45], v48
    s_waitcnt lgkmcnt(0)
    s_branch Lcsv
Lrx_re:
    s_sub_u32 s35, s35, 1
    s_cbranch_scc1 Lend
    buffer_load_dwordx2 v[52:53], v13, s[28:31], s57 offen offset:8 sc1
    buffer_load_dwordx2 v[54:55], v13, s[28:31], s58 offen offset:0 sc1
    s_waitcnt vmcnt(0)
    s_branch Lrx_chk
Linfo_re:
    s_sub_u32 s35, s35, 1
    s_cbranch_scc1 Lend
    ds_read_b64 v[8:9], v10
    s_waitcnt lgkmcnt(0)
    s_branch Linfo
Lfl_re:
    s_sub_u32 s35, s35, 1
    s_cbranch_scc1 Lend
    buffer_load_dword v20, v12, s[28:31], s24 offen sc1
    s_waitcnt vmcnt(0)
    s_branch Lfl_chk
Lxe0:
    ds_read_b64 v[108:109], v4
    ds_read_b64 v[110:111], v5
    ds_read_b64 v[112:113], v6
    ds_read_b64 v[114:115], v7
    s_branch Lxe0_b
Lxe1:
    ds_read_b64 v[108:109], v4
    ds_read_b64 v[110:111], v5
    ds_read_b64 v[112:113], v6
    ds_read_b64 v[114:115], v7
    s_branch Lxe1_b
Lxe2:
    ds_read_b64 v[108:109], v4
    ds_read_b64 v[110:111], v5
    ds_read_b64 v[112:113], v6
    ds_read_b64 v[114:115], v7
    s_branch Lxe2_b
Lxe3:
    ds_read_b64 v[108:109], v4
    ds_read_b64 v[110:111], v5
    ds_read_b64 v[112:113], v6
    ds_read_b64 v[114:115], v7
    s_branch Lxe3_b
Lxe4:
    ds_read_b64 v[108:109], v4
    ds_read_b64 v[110:111], v5
    ds_read_b64 v[112:113], v6
    ds_read_b64 v[114:115], v7
    s_branch Lxe4_b
Lxe5:
    ds_read_b64 v[108:109], v4
    ds_read_b64 v[110:111], v5
    ds_read_b64 v[112:113], v6
    ds_read_b64 v[114:115], v7
    s_branch Lxe5_b
Lxe6:
    ds_read_b64 v[108:109], v4
    ds_read_b64 v[110:111], v5
    ds_read_b64 v[112:113], v6
    ds_read_b64 v[114:115], v7
    s_branch Lxe6_b
Lxe7:
    ds_read_b64 v[108:109], v4
    ds_read_b64 v[110:111], v5
    ds_read_b64 v[112:113], v6
    ds_read_b64 v[114:115], v7
    s_branch Lxe7_b
Lxe8:
    ds_read_b64 v[108:109], v4
    ds_read_b64 v[110:111], v5
    ds_read_b64 v[112:113], v6
    ds_read_b64 v[114:115], v7
    s_branch Lxe8_b
Lxe9:
    ds_read_b64 v[108:109], v4
    ds_read_b64 v[110:111], v5
    ds_read_b64 v[112:113], v6
    ds_read_b64 v[114:115], v7
    s_branch Lxe9_b
Lnan:
    s_add_u32 s41, s41, 1
    s_cmp_eq_u32 s41, 2
    s_cbranch_scc1 Lval0
    v_min_u32 v18, 19, v1
    v_lshlrev_b32 v18, 10, v18
Lprobe:
    s_sub_u32 s35, s35, 1
    s_cbranch_scc1 Lend
    buffer_load_dword v19, v18, s[28:31], s50 offen offset:1020 sc1
    s_waitcnt vmcnt(0)
    v_cmp_eq_u32 vcc, -1, v19
    s_nop 0
    s_cbranch_vccnz Lprobe
    s_branch Lredo
Lval0:
    s_mov_b32 s61, 0
    s_mov_b32 s36, s50
    s_add_u32 s37, s50, 20480
    s_waitcnt vmcnt(0)
Lval:
    s_sub_u32 s35, s35, 1
    s_cbranch_scc1 Lend
    buffer_load_dwordx4 v[60:63], v13, s[28:31], s36 offen sc1
    s_waitcnt vmcnt(0)
    v_max3_u32 v60, v60, v61, v62
    v_max_u32 v60, v60, v63
    v_cmp_eq_u32 vcc, -1, v60
    s_nop 0
    s_cbranch_vccnz Lval
    s_add_u32 s36, s36, 1024
    s_cmp_lt_u32 s36, s37
    s_cbranch_scc1 Lval
Lredo:
    buffer_load_dwordx4 v[60:63], v13, s[28:31], s51 offen offset:0 sc1
    buffer_load_dwordx4 v[64:67], v13, s[28:31], s51 offen offset:1024 sc1
    buffer_load_dwordx4 v[68:71], v13, s[28:31], s51 offen offset:2048 sc1
    buffer_load_dwordx4 v[72:75], v13, s[28:31], s51 offen offset:3072 sc1
    buffer_load_dwordx4 v[76:79], v13, s[28:31], s52 offen offset:0 sc1
    buffer_load_dwordx4 v[80:83], v13, s[28:31], s52 offen offset:1024 sc1
    buffer_load_dwordx4 v[84:87], v13, s[28:31], s52 offen offset:2048 sc1
    buffer_load_dwordx4 v[88:91], v13, s[28:31], s52 offen offset:3072 sc1
    ds_read_b64_tr_b16 a[0:1], v20 offset:0
    ds_read_b64_tr_b16 a[2:3], v20 offset:512
    ds_read_b64_tr_b16 a[4:5], v21 offset:0
    ds_read_b64_tr_b16 a[6:7], v21 offset:512
    ds_read_b64_tr_b16 a[8:9], v22 offset:0
    ds_read_b64_tr_b16 a[10:11], v22 offset:512
    ds_read_b64_tr_b16 a[12:13], v23 offset:0
    ds_read_b64_tr_b16 a[14:15], v23 offset:512
    ds_read_b64_tr_b16 a[16:17], v20 offset:4096
    ds_read_b64_tr_b16 a[18:19], v20 offset:4608
    ds_read_b64_tr_b16 a[20:21], v21 offset:4096
    ds_read_b64_tr_b16 a[22:23], v21 offset:4608
    ds_read_b64_tr_b16 a[24:25], v22 offset:4096
    ds_read_b64_tr_b16 a[26:27], v22 offset:4608
    ds_read_b64_tr_b16 a[28:29], v23 offset:4096
    ds_read_b64_tr_b16 a[30:31], v23 offset:4608
    ds_read_b64_tr_b16 a[32:33], v20 offset:8192
    ds_read_b64_tr_b16 a[34:35], v20 offset:8704
    ds_read_b64_tr_b16 a[36:37], v21 offset:8192
    ds_read_b64_tr_b16 a[38:39], v21 offset:8704
    ds_read_b64_tr_b16 a[40:41], v22 offset:8192
    ds_read_b64_tr_b16 a[42:43], v22 offset:8704
    ds_read_b64_tr_b16 a[44:45], v23 offset:8192
    ds_read_b64_tr_b16 a[46:47], v23 offset:8704
    ds_read_b64_tr_b16 a[48:49], v20 offset:12288
    ds_read_b64_tr_b16 a[50:51], v20 offset:12800
    ds_read_b64_tr_b16 a[52:53], v21 offset:12288
    ds_read_b64_tr_b16 a[54:55], v21 offset:12800
    ds_read_b64_tr_b16 a[56:57], v22 offset:12288
    ds_read_b64_tr_b16 a[58:59], v22 offset:12800
    ds_read_b64_tr_b16 a[60:61], v23 offset:12288
    ds_read_b64_tr_b16 a[62:63], v23 offset:12800
    ds_read_b64_tr_b16 a[64:65], v20 offset:24576
    ds_read_b64_tr_b16 a[66:67], v20 offset:25088
    ds_read_b64_tr_b16 a[68:69], v21 offset:24576
    ds_read_b64_tr_b16 a[70:71], v21 offset:25088
    ds_read_b64_tr_b16 a[72:73], v22 offset:24576
    ds_read_b64_tr_b16 a[74:75], v22 offset:25088
    ds_read_b64_tr_b16 a[76:77], v23 offset:24576
    ds_read_b64_tr_b16 a[78:79], v23 offset:25088
    ds_read_b64_tr_b16 a[80:81], v20 offset:28672
    ds_read_b64_tr_b16 a[82:83], v20 offset:29184
    ds_read_b64_tr_b16 a[84:85], v21 offset:28672
    ds_read_b64_tr_b16 a[86:87], v21 offset:29184
    ds_read_b64_tr_b16 a[88:89], v22 offset:28672
    ds_read_b64_tr_b16 a[90:91], v22 offset:29184
    ds_read_b64_tr_b16 a[92:93], v23 offset:28672
    ds_read_b64_tr_b16 a[94:95], v23 offset:29184
    ds_read_b64_tr_b16 a[96:97], v24 offset:59520
    ds_read_b64_tr_b16 a[98:99], v24 offset:60032
    ds_read_b64_tr_b16 a[100:101], v25 offset:59520
    ds_read_b64_tr_b16 a[102:103], v25 offset:60032
    ds_read_b64_tr_b16 a[104:105], v26 offset:59520
    ds_read_b64_tr_b16 a[106:107], v26 offset:60032
    ds_read_b64_tr_b16 a[108:109], v27 offset:59520
    ds_read_b64_tr_b16 a[110:111], v27 offset:60032
    ds_read_b64_tr_b16 a[112:113], v24 offset:63616
    ds_read_b64_tr_b16 a[114:115], v24 offset:64128
    ds_read_b64_tr_b16 a[116:117], v25 offset:63616
    ds_read_b64_tr_b16 a[118:119], v25 offset:64128
    ds_read_b64_tr_b16 a[120:121], v26 offset:63616
    ds_read_b64_tr_b16 a[122:123], v26 offset:64128
    ds_read_b64_tr_b16 a[124:125], v27 offset:63616
    ds_read_b64_tr_b16 a[126:127], v27 offset:64128
    s_waitcnt lgkmcnt(0)
    s_branch Lwo_go
Lfix:
    v_lshlrev_b32 v6, 4, v2
    v_add_u32 v6, 158208, v6
    v_mov_b32 v10, 157956
    v_mov_b32 v11, 1
    v_sub_u32 v4, v126, v3
    v_lshrrev_b32 v5, 3, v1
    v_add_u32 v4, v4, v5
    v_add_u32 v5, 8, v4
    v_mov_b32 v7, 0x40000000
    v_cmp_eq_u32 vcc, v8, v4
    s_nop 1
    v_cndmask_b32 v122, v122, v7, vcc
    v_cmp_eq_u32 vcc, v8, v5
    s_nop 1
    v_cndmask_b32 v123, v123, v7, vcc
    v_cmp_eq_u32 vcc, v8, v126
    s_nop 0
    s_mov_b64 exec, vcc
    ds_write_b128 v6, v[108:111] offset:0
    ds_write_b128 v6, v[112:115] offset:64
    ds_write_b128 v6, v[116:119] offset:128
    ds_write_b128 v6, v[14:17] offset:192
    ds_add_u32 v10, v11
    s_mov_b64 exec, -1
    v_cmp_eq_u32 vcc, v9, v4
    s_nop 1
    v_cndmask_b32 v122, v122, v7, vcc
    v_cmp_eq_u32 vcc, v9, v5
    s_nop 1
    v_cndmask_b32 v123, v123, v7, vcc
    v_cmp_eq_u32 vcc, v9, v126
    s_nop 0
    s_mov_b64 exec, vcc
    ds_write_b128 v6, v[108:111] offset:256
    ds_write_b128 v6, v[112:115] offset:320
    ds_write_b128 v6, v[116:119] offset:384
    ds_write_b128 v6, v[14:17] offset:448
    ds_add_u32 v10, v11
    s_mov_b64 exec, -1
    s_branch Lnofix
Lhalo:
    s_mov_b32 vcc_lo, 0x00010001
    s_mov_b32 vcc_hi, 0x00010001
    v_mov_b32 v11, 38912
    v_cndmask_b32 v76, v76, v11, vcc
    v_xor_b32 v77, 64, v76
    v_add_u32 v80, 78080, v76
    v_add_u32 v81, 78080, v77
    v_mov_b32 v14, 0x3f803f80
    v_mov_b32 v15, 0x3f803f80
    v_mov_b32 v16, 0x3f803f80
    v_mov_b32 v17, 0x3f803f80
    v_and_b32 v4, 7, v1
    v_lshlrev_b32 v4, 4, v4
    v_mul_u32_u24 v5, 39040, v2
    v_add_u32 v4, v4, v5
    ds_write_b128 v4, v[14:17] offset:38912
    v_mov_b32 v4, 157952
    v_mov_b32 v8, 0
    v_mov_b32 v9, 0
    v_mov_b32 v10, -2
    v_mov_b32 v11, -2
    ds_write_b128 v4, v[8:11]
    v_min_u32 v5, 23, v1
    v_lshl_add_u32 v5, v5, 2, v4
    ds_write_b32 v5, v8 offset:16
    s_mul_i32 s36, s32, 96
    s_sub_u32 s36, s36, 16
    v_add_u32 v96, s36, v1
    v_min_u32 v5, 47, v1
    v_add3_u32 v97, s36, v5, 64
    v_mov_b32 v6, 2047
    v_med3_i32 v96, v96, 0, v6
    v_med3_i32 v97, v97, 0, v6
    v_lshlrev_b32 v96, 3, v96
    v_lshlrev_b32 v97, 3, v97
    s_mov_b32 s49, 8192000
    v_mov_b32 v127, 157984
    s_lshl_b32 s36, s3, 2
    s_add_u32 s36, s36, 158016
    v_mov_b32 v10, s36
    s_waitcnt lgkmcnt(0)
    s_barrier
    s_add_u32 s34, s34, 0x9e3779b8
    s_or_b32 s34, s34, 1
    ds_read_b128 v[108:111], v76 offset:0
    ds_read_b128 v[112:115], v77 offset:0
    ds_read_b64_tr_b16 a[0:1], v20 offset:0
    ds_read_b64_tr_b16 a[2:3], v20 offset:512
    ds_read_b64_tr_b16 a[4:5], v21 offset:0
    ds_read_b64_tr_b16 a[6:7], v21 offset:512
    ds_read_b64_tr_b16 a[8:9], v22 offset:0
    ds_read_b64_tr_b16 a[10:11], v22 offset:512
    ds_read_b64_tr_b16 a[12:13], v23 offset:0
    ds_read_b64_tr_b16 a[14:15], v23 offset:512
    ds_read_b64_tr_b16 a[16:17], v20 offset:8192
    ds_read_b64_tr_b16 a[18:19], v20 offset:8704
    ds_read_b64_tr_b16 a[20:21], v21 offset:8192
    ds_read_b64_tr_b16 a[22:23], v21 offset:8704
    ds_read_b64_tr_b16 a[24:25], v22 offset:8192
    ds_read_b64_tr_b16 a[26:27], v22 offset:8704
    s_waitcnt lgkmcnt(12)
    v_mfma_f32_16x16x32_bf16 v[28:31], a[0:3], v[108:111], 0
    ds_read_b64_tr_b16 a[28:29], v23 offset:8192
    ds_read_b64_tr_b16 a[30:31], v23 offset:8704
    s_waitcnt lgkmcnt(12)
    v_mfma_f32_16x16x32_bf16 v[32:35], a[4:7], v[108:111], 0
    ds_read_b64_tr_b16 a[32:33], v20 offset:16384
    ds_read_b64_tr_b16 a[34:35], v20 offset:16896
    s_waitcnt lgkmcnt(12)
    v_mfma_f32_16x16x32_bf16 v[36:39], a[8:11], v[108:111], 0
    ds_read_b64_tr_b16 a[36:37], v21 offset:16384
    ds_read_b64_tr_b16 a[38:39], v21 offset:16896
    s_waitcnt lgkmcnt(12)
    v_mfma_f32_16x16x32_bf16 v[40:43], a[12:15], v[108:111], 0
    ds_read_b64_tr_b16 a[40:41], v22 offset:16384
    ds_read_b64_tr_b16 a[42:43], v22 offset:16896
    s_waitcnt lgkmcnt(12)
    v_mfma_f32_16x16x32_bf16 v[44:47], a[16:19], v[108:111], 0
    ds_read_b64_tr_b16 a[44:45], v23 offset:16384
    ds_read_b64_tr_b16 a[46:47], v23 offset:16896
    s_waitcnt lgkmcnt(12)
    v_mfma_f32_16x16x32_bf16 v[48:51], a[20:23], v[108:111], 0
    ds_read_b64_tr_b16 a[48:49], v20 offset:4096
    ds_read_b64_tr_b16 a[50:51], v20 offset:4608
    s_waitcnt lgkmcnt(12)
    v_mfma_f32_16x16x32_bf16 v[52:55], a[24:27], v[108:111], 0
    ds_read_b64_tr_b16 a[52:53], v21 offset:4096
    ds_read_b64_tr_b16 a[54:55], v21 offset:4608
    s_waitcnt lgkmcnt(12)
    v_mfma_f32_16x16x32_bf16 v[56:59], a[28:31], v[108:111], 0
    ds_read_b64_tr_b16 a[56:57], v22 offset:4096
    ds_read_b64_tr_b16 a[58:59], v22 offset:4608
    s_waitcnt lgkmcnt(12)
    v_mfma_f32_16x16x32_bf16 v[60:63], v[108:111], a[32:35], 0
    ds_read_b64_tr_b16 a[60:61], v23 offset:4096
    ds_read_b64_tr_b16 a[62:63], v23 offset:4608
    s_waitcnt lgkmcnt(12)
    v_mfma_f32_16x16x32_bf16 v[64:67], v[108:111], a[36:39], 0
    ds_read_b64_tr_b16 a[64:65], v20 offset:12288
    ds_read_b64_tr_b16 a[66:67], v20 offset:12800
    s_waitcnt lgkmcnt(12)
    v_mfma_f32_16x16x32_bf16 v[68:71], v[108:111], a[40:43], 0
    ds_read_b64_tr_b16 a[68:69], v21 offset:12288
    ds_read_b64_tr_b16 a[70:71], v21 offset:12800
    s_waitcnt lgkmcnt(12)
    v_mfma_f32_16x16x32_bf16 v[72:75], v[108:111], a[44:47], 0
    ds_read_b64_tr_b16 a[72:73], v22 offset:12288
    ds_read_b64_tr_b16 a[74:75], v22 offset:12800
    s_waitcnt lgkmcnt(12)
    v_mfma_f32_16x16x32_bf16 v[28:31], a[48:51], v[112:115], v[28:31]
    ds_read_b64_tr_b16 a[76:77], v23 offset:12288
    ds_read_b64_tr_b16 a[78:79], v23 offset:12800
    s_waitcnt lgkmcnt(12)
    v_mfma_f32_16x16x32_bf16 v[32:35], a[52:55], v[112:115], v[32:35]
    ds_read_b64_tr_b16 a[80:81], v20 offset:20480
    ds_read_b64_tr_b16 a[82:83], v20 offset:20992
    s_waitcnt lgkmcnt(12)
    v_mfma_f32_16x16x32_bf16 v[36:39], a[56:59], v[112:115], v[36:39]
    ds_read_b64_tr_b16 a[84:85], v21 offset:20480
    ds_read_b64_tr_b16 a[86:87], v21 offset:20992
    s_waitcnt lgkmcnt(12)
    v_mfma_f32_16x16x32_bf16 v[40:43], a[60:63], v[112:115], v[40:43]
    ds_read_b64_tr_b16 a[88:89], v22 offset:20480
    ds_read_b64_tr_b16 a[90:91], v22 offset:20992
    s_waitcnt lgkmcnt(12)
    v_mfma_f32_16x16x32_bf16 v[44:47], a[64:67], v[112:115], v[44:47]
    ds_read_b64_tr_b16 a[92:93], v23 offset:20480
    ds_read_b64_tr_b16 a[94:95], v23 offset:20992
    s_waitcnt lgkmcnt(12)
    v_mfma_f32_16x16x32_bf16 v[48:51], a[68:71], v[112:115], v[48:51]
    s_waitcnt lgkmcnt(10)
    v_mfma_f32_16x16x32_bf16 v[52:55], a[72:75], v[112:115], v[52:55]
    s_waitcnt lgkmcnt(8)
    v_mfma_f32_16x16x32_bf16 v[56:59], a[76:79], v[112:115], v[56:59]
    s_waitcnt lgkmcnt(6)
    v_mfma_f32_16x16x32_bf16 v[60:63], v[112:115], a[80:83], v[60:63]
    s_waitcnt lgkmcnt(4)
    v_mfma_f32_16x16x32_bf16 v[64:67], v[112:115], a[84:87], v[64:67]
    s_waitcnt lgkmcnt(2)
    v_mfma_f32_16x16x32_bf16 v[68:71], v[112:115], a[88:91], v[68:71]
    s_waitcnt lgkmcnt(0)
    v_mfma_f32_16x16x32_bf16 v[72:75], v[112:115], a[92:95], v[72:75]
    s_barrier
    ds_read_b128 v[108:111], v76 offset:39040
    ds_read_b128 v[112:115], v77 offset:39040
    ds_read_b64_tr_b16 a[0:1], v20 offset:39040
    ds_read_b64_tr_b16 a[2:3], v20 offset:39552
    ds_read_b64_tr_b16 a[4:5], v21 offset:39040
    ds_read_b64_tr_b16 a[6:7], v21 offset:39552
    ds_read_b64_tr_b16 a[8:9], v22 offset:39040
    ds_read_b64_tr_b16 a[10:11], v22 offset:39552
    ds_read_b64_tr_b16 a[12:13], v23 offset:39040
    ds_read_b64_tr_b16 a[14:15], v23 offset:39552
    ds_read_b64_tr_b16 a[16:17], v20 offset:47232
    ds_read_b64_tr_b16 a[18:19], v20 offset:47744
    ds_read_b64_tr_b16 a[20:21], v21 offset:47232
    ds_read_b64_tr_b16 a[22:23], v21 offset:47744
    ds_read_b64_tr_b16 a[24:25], v22 offset:47232
    ds_read_b64_tr_b16 a[26:27], v22 offset:47744
    s_waitcnt lgkmcnt(12)
    v_mfma_f32_16x16x32_bf16 v[28:31], a[0:3], v[108:111], v[28:31]
    ds_read_b64_tr_b16 a[28:29], v23 offset:47232
    ds_read_b64_tr_b16 a[30:31], v23 offset:47744
    s_waitcnt lgkmcnt(12)
    v_mfma_f32_16x16x32_bf16 v[32:35], a[4:7], v[108:111], v[32:35]
    ds_read_b64_tr_b16 a[32:33], v20 offset:55424
    ds_read_b64_tr_b16 a[34:35], v20 offset:55936
    s_waitcnt lgkmcnt(12)
    v_mfma_f32_16x16x32_bf16 v[36:39], a[8:11], v[108:111], v[36:39]
    ds_read_b64_tr_b16 a[36:37], v21 offset:55424
    ds_read_b64_tr_b16 a[38:39], v21 offset:55936
    s_waitcnt lgkmcnt(12)
    v_mfma_f32_16x16x32_bf16 v[40:43], a[12:15], v[108:111], v[40:43]
    ds_read_b64_tr_b16 a[40:41], v22 offset:55424
    ds_read_b64_tr_b16 a[42:43], v22 offset:55936
    s_waitcnt lgkmcnt(12)
    v_mfma_f32_16x16x32_bf16 v[44:47], a[16:19], v[108:111], v[44:47]
    ds_read_b64_tr_b16 a[44:45], v23 offset:55424
    ds_read_b64_tr_b16 a[46:47], v23 offset:55936
    s_waitcnt lgkmcnt(12)
    v_mfma_f32_16x16x32_bf16 v[48:51], a[20:23], v[108:111], v[48:51]
    ds_read_b64_tr_b16 a[48:49], v20 offset:43136
    ds_read_b64_tr_b16 a[50:51], v20 offset:43648
    s_waitcnt lgkmcnt(12)
    v_mfma_f32_16x16x32_bf16 v[52:55], a[24:27], v[108:111], v[52:55]
    ds_read_b64_tr_b16 a[52:53], v21 offset:43136
    ds_read_b64_tr_b16 a[54:55], v21 offset:43648
    s_waitcnt lgkmcnt(12)
    v_mfma_f32_16x16x32_bf16 v[56:59], a[28:31], v[108:111], v[56:59]
    ds_read_b64_tr_b16 a[56:57], v22 offset:43136
    ds_read_b64_tr_b16 a[58:59], v22 offset:43648
    s_waitcnt lgkmcnt(12)
    v_mfma_f32_16x16x32_bf16 v[60:63], v[108:111], a[32:35], v[60:63]
    ds_read_b64_tr_b16 a[60:61], v23 offset:43136
    ds_read_b64_tr_b16 a[62:63], v23 offset:43648
    s_waitcnt lgkmcnt(12)
    v_mfma_f32_16x16x32_bf16 v[64:67], v[108:111], a[36:39], v[64:67]
    ds_read_b64_tr_b16 a[64:65], v20 offset:51328
    ds_read_b64_tr_b16 a[66:67], v20 offset:51840
    s_waitcnt lgkmcnt(12)
    v_mfma_f32_16x16x32_bf16 v[68:71], v[108:111], a[40:43], v[68:71]
    ds_read_b64_tr_b16 a[68:69], v21 offset:51328
    ds_read_b64_tr_b16 a[70:71], v21 offset:51840
    s_waitcnt lgkmcnt(12)
    v_mfma_f32_16x16x32_bf16 v[72:75], v[108:111], a[44:47], v[72:75]
    ds_read_b64_tr_b16 a[72:73], v22 offset:51328
    ds_read_b64_tr_b16 a[74:75], v22 offset:51840
    s_waitcnt lgkmcnt(12)
    v_mfma_f32_16x16x32_bf16 v[28:31], a[48:51], v[112:115], v[28:31]
    ds_read_b64_tr_b16 a[76:77], v23 offset:51328
    ds_read_b64_tr_b16 a[78:79], v23 offset:51840
    s_waitcnt lgkmcnt(12)
    v_mfma_f32_16x16x32_bf16 v[32:35], a[52:55], v[112:115], v[32:35]
    ds_read_b64_tr_b16 a[80:81], v20 offset:59520
    ds_read_b64_tr_b16 a[82:83], v20 offset:60032
    s_waitcnt lgkmcnt(12)
    v_mfma_f32_16x16x32_bf16 v[36:39], a[56:59], v[112:115], v[36:39]
    ds_read_b64_tr_b16 a[84:85], v21 offset:59520
    ds_read_b64_tr_b16 a[86:87], v21 offset:60032
    s_waitcnt lgkmcnt(12)
    v_mfma_f32_16x16x32_bf16 v[40:43], a[60:63], v[112:115], v[40:43]
    ds_read_b64_tr_b16 a[88:89], v22 offset:59520
    ds_read_b64_tr_b16 a[90:91], v22 offset:60032
    s_waitcnt lgkmcnt(12)
    v_mfma_f32_16x16x32_bf16 v[44:47], a[64:67], v[112:115], v[44:47]
    ds_read_b64_tr_b16 a[92:93], v23 offset:59520
    ds_read_b64_tr_b16 a[94:95], v23 offset:60032
    s_waitcnt lgkmcnt(12)
    v_mfma_f32_16x16x32_bf16 v[48:51], a[68:71], v[112:115], v[48:51]
    s_waitcnt lgkmcnt(10)
    v_mfma_f32_16x16x32_bf16 v[52:55], a[72:75], v[112:115], v[52:55]
    s_waitcnt lgkmcnt(8)
    v_mfma_f32_16x16x32_bf16 v[56:59], a[76:79], v[112:115], v[56:59]
    s_waitcnt lgkmcnt(6)
    v_mfma_f32_16x16x32_bf16 v[60:63], v[112:115], a[80:83], v[60:63]
    s_waitcnt lgkmcnt(4)
    v_mfma_f32_16x16x32_bf16 v[64:67], v[112:115], a[84:87], v[64:67]
    s_waitcnt lgkmcnt(2)
    v_mfma_f32_16x16x32_bf16 v[68:71], v[112:115], a[88:91], v[68:71]
    s_waitcnt lgkmcnt(0)
    v_mfma_f32_16x16x32_bf16 v[72:75], v[112:115], a[92:95], v[72:75]
    s_mov_b64 exec, 1
    s_lshl_b32 s36, s2, 2
    s_add_u32 s36, s36, 8323072
    v_mov_b32 v4, s34
    v_mov_b32 v5, s36
    buffer_store_dword v4, v5, s[28:31], 0 offen sc1
    s_mov_b64 exec, -1
    s_barrier
    ds_read_b128 v[108:111], v80 offset:0
    ds_read_b128 v[112:115], v81 offset:0
    ds_read_b64_tr_b16 a[0:1], v24 offset:0
    ds_read_b64_tr_b16 a[2:3], v24 offset:512
    ds_read_b64_tr_b16 a[4:5], v25 offset:0
    ds_read_b64_tr_b16 a[6:7], v25 offset:512
    ds_read_b64_tr_b16 a[8:9], v26 offset:0
    ds_read_b64_tr_b16 a[10:11], v26 offset:512
    ds_read_b64_tr_b16 a[12:13], v27 offset:0
    ds_read_b64_tr_b16 a[14:15], v27 offset:512
    ds_read_b64_tr_b16 a[16:17], v24 offset:8192
    ds_read_b64_tr_b16 a[18:19], v24 offset:8704
    ds_read_b64_tr_b16 a[20:21], v25 offset:8192
    ds_read_b64_tr_b16 a[22:23], v25 offset:8704
    ds_read_b64_tr_b16 a[24:25], v26 offset:8192
    ds_read_b64_tr_b16 a[26:27], v26 offset:8704
    s_waitcnt lgkmcnt(12)
    v_mfma_f32_16x16x32_bf16 v[28:31], a[0:3], v[108:111], v[28:31]
    ds_read_b64_tr_b16 a[28:29], v27 offset:8192
    ds_read_b64_tr_b16 a[30:31], v27 offset:8704
    s_waitcnt lgkmcnt(12)
    v_mfma_f32_16x16x32_bf16 v[32:35], a[4:7], v[108:111], v[32:35]
    ds_read_b64_tr_b16 a[32:33], v24 offset:16384
    ds_read_b64_tr_b16 a[34:35], v24 offset:16896
    s_waitcnt lgkmcnt(12)
    v_mfma_f32_16x16x32_bf16 v[36:39], a[8:11], v[108:111], v[36:39]
    ds_read_b64_tr_b16 a[36:37], v25 offset:16384
    ds_read_b64_tr_b16 a[38:39], v25 offset:16896
    s_waitcnt lgkmcnt(12)
    v_mfma_f32_16x16x32_bf16 v[40:43], a[12:15], v[108:111], v[40:43]
    ds_read_b64_tr_b16 a[40:41], v26 offset:16384
    ds_read_b64_tr_b16 a[42:43], v26 offset:16896
    s_waitcnt lgkmcnt(12)
    v_mfma_f32_16x16x32_bf16 v[44:47], a[16:19], v[108:111], v[44:47]
    ds_read_b64_tr_b16 a[44:45], v27 offset:16384
    ds_read_b64_tr_b16 a[46:47], v27 offset:16896
    s_waitcnt lgkmcnt(12)
    v_mfma_f32_16x16x32_bf16 v[48:51], a[20:23], v[108:111], v[48:51]
    ds_read_b64_tr_b16 a[48:49], v24 offset:4096
    ds_read_b64_tr_b16 a[50:51], v24 offset:4608
    s_waitcnt lgkmcnt(12)
    v_mfma_f32_16x16x32_bf16 v[52:55], a[24:27], v[108:111], v[52:55]
    ds_read_b64_tr_b16 a[52:53], v25 offset:4096
    ds_read_b64_tr_b16 a[54:55], v25 offset:4608
    s_waitcnt lgkmcnt(12)
    v_mfma_f32_16x16x32_bf16 v[56:59], a[28:31], v[108:111], v[56:59]
    ds_read_b64_tr_b16 a[56:57], v26 offset:4096
    ds_read_b64_tr_b16 a[58:59], v26 offset:4608
    s_waitcnt lgkmcnt(12)
    v_mfma_f32_16x16x32_bf16 v[60:63], v[108:111], a[32:35], v[60:63]
    ds_read_b64_tr_b16 a[60:61], v27 offset:4096
    ds_read_b64_tr_b16 a[62:63], v27 offset:4608
    s_waitcnt lgkmcnt(12)
    v_mfma_f32_16x16x32_bf16 v[64:67], v[108:111], a[36:39], v[64:67]
    ds_read_b64_tr_b16 a[64:65], v24 offset:12288
    ds_read_b64_tr_b16 a[66:67], v24 offset:12800
    s_waitcnt lgkmcnt(12)
    v_mfma_f32_16x16x32_bf16 v[68:71], v[108:111], a[40:43], v[68:71]
    ds_read_b64_tr_b16 a[68:69], v25 offset:12288
    ds_read_b64_tr_b16 a[70:71], v25 offset:12800
    s_waitcnt lgkmcnt(12)
    v_mfma_f32_16x16x32_bf16 v[72:75], v[108:111], a[44:47], v[72:75]
    ds_read_b64_tr_b16 a[72:73], v26 offset:12288
    ds_read_b64_tr_b16 a[74:75], v26 offset:12800
    s_waitcnt lgkmcnt(12)
    v_mfma_f32_16x16x32_bf16 v[28:31], a[48:51], v[112:115], v[28:31]
    ds_read_b64_tr_b16 a[76:77], v27 offset:12288
    ds_read_b64_tr_b16 a[78:79], v27 offset:12800
    s_waitcnt lgkmcnt(12)
    v_mfma_f32_16x16x32_bf16 v[32:35], a[52:55], v[112:115], v[32:35]
    ds_read_b64_tr_b16 a[80:81], v24 offset:20480
    ds_read_b64_tr_b16 a[82:83], v24 offset:20992
    s_waitcnt lgkmcnt(12)
    v_mfma_f32_16x16x32_bf16 v[36:39], a[56:59], v[112:115], v[36:39]
    ds_read_b64_tr_b16 a[84:85], v25 offset:20480
    ds_read_b64_tr_b16 a[86:87], v25 offset:20992
    s_waitcnt lgkmcnt(12)
    v_mfma_f32_16x16x32_bf16 v[40:43], a[60:63], v[112:115], v[40:43]
    ds_read_b64_tr_b16 a[88:89], v26 offset:20480
    ds_read_b64_tr_b16 a[90:91], v26 offset:20992
    s_waitcnt lgkmcnt(12)
    v_mfma_f32_16x16x32_bf16 v[44:47], a[64:67], v[112:115], v[44:47]
    ds_read_b64_tr_b16 a[92:93], v27 offset:20480
    ds_read_b64_tr_b16 a[94:95], v27 offset:20992
    s_waitcnt lgkmcnt(12)
    v_mfma_f32_16x16x32_bf16 v[48:51], a[68:71], v[112:115], v[48:51]
    s_waitcnt lgkmcnt(10)
    v_mfma_f32_16x16x32_bf16 v[52:55], a[72:75], v[112:115], v[52:55]
    s_waitcnt lgkmcnt(8)
    v_mfma_f32_16x16x32_bf16 v[56:59], a[76:79], v[112:115], v[56:59]
    s_waitcnt lgkmcnt(6)
    v_mfma_f32_16x16x32_bf16 v[60:63], v[112:115], a[80:83], v[60:63]
    s_waitcnt lgkmcnt(4)
    v_mfma_f32_16x16x32_bf16 v[64:67], v[112:115], a[84:87], v[64:67]
    s_waitcnt lgkmcnt(2)
    v_mfma_f32_16x16x32_bf16 v[68:71], v[112:115], a[88:91], v[68:71]
    s_waitcnt lgkmcnt(0)
    v_mfma_f32_16x16x32_bf16 v[72:75], v[112:115], a[92:95], v[72:75]
    s_barrier
    ds_read_b128 v[108:111], v80 offset:39040
    ds_read_b128 v[112:115], v81 offset:39040
    ds_read_b64_tr_b16 a[0:1], v24 offset:39040
    ds_read_b64_tr_b16 a[2:3], v24 offset:39552
    ds_read_b64_tr_b16 a[4:5], v25 offset:39040
    ds_read_b64_tr_b16 a[6:7], v25 offset:39552
    ds_read_b64_tr_b16 a[8:9], v26 offset:39040
    ds_read_b64_tr_b16 a[10:11], v26 offset:39552
    ds_read_b64_tr_b16 a[12:13], v27 offset:39040
    ds_read_b64_tr_b16 a[14:15], v27 offset:39552
    ds_read_b64_tr_b16 a[16:17], v24 offset:47232
    ds_read_b64_tr_b16 a[18:19], v24 offset:47744
    ds_read_b64_tr_b16 a[20:21], v25 offset:47232
    ds_read_b64_tr_b16 a[22:23], v25 offset:47744
    ds_read_b64_tr_b16 a[24:25], v26 offset:47232
    ds_read_b64_tr_b16 a[26:27], v26 offset:47744
    s_waitcnt lgkmcnt(12)
    v_mfma_f32_16x16x32_bf16 v[28:31], a[0:3], v[108:111], v[28:31]
    ds_read_b64_tr_b16 a[28:29], v27 offset:47232
    ds_read_b64_tr_b16 a[30:31], v27 offset:47744
    s_waitcnt lgkmcnt(12)
    v_mfma_f32_16x16x32_bf16 v[32:35], a[4:7], v[108:111], v[32:35]
    ds_read_b64_tr_b16 a[32:33], v24 offset:55424
    ds_read_b64_tr_b16 a[34:35], v24 offset:55936
    s_waitcnt lgkmcnt(12)
    v_mfma_f32_16x16x32_bf16 v[36:39], a[8:11], v[108:111], v[36:39]
    ds_read_b64_tr_b16 a[36:37], v25 offset:55424
    ds_read_b64_tr_b16 a[38:39], v25 offset:55936
    s_waitcnt lgkmcnt(12)
    v_mfma_f32_16x16x32_bf16 v[40:43], a[12:15], v[108:111], v[40:43]
    ds_read_b64_tr_b16 a[40:41], v26 offset:55424
    ds_read_b64_tr_b16 a[42:43], v26 offset:55936
    s_waitcnt lgkmcnt(12)
    v_mfma_f32_16x16x32_bf16 v[44:47], a[16:19], v[108:111], v[44:47]
    ds_read_b64_tr_b16 a[44:45], v27 offset:55424
    ds_read_b64_tr_b16 a[46:47], v27 offset:55936
    s_waitcnt lgkmcnt(12)
    v_mfma_f32_16x16x32_bf16 v[48:51], a[20:23], v[108:111], v[48:51]
    ds_read_b64_tr_b16 a[48:49], v24 offset:43136
    ds_read_b64_tr_b16 a[50:51], v24 offset:43648
    s_waitcnt lgkmcnt(12)
    v_mfma_f32_16x16x32_bf16 v[52:55], a[24:27], v[108:111], v[52:55]
    ds_read_b64_tr_b16 a[52:53], v25 offset:43136
    ds_read_b64_tr_b16 a[54:55], v25 offset:43648
    s_waitcnt lgkmcnt(12)
    v_mfma_f32_16x16x32_bf16 v[56:59], a[28:31], v[108:111], v[56:59]
    ds_read_b64_tr_b16 a[56:57], v26 offset:43136
    ds_read_b64_tr_b16 a[58:59], v26 offset:43648
    s_waitcnt lgkmcnt(12)
    v_mfma_f32_16x16x32_bf16 v[60:63], v[108:111], a[32:35], v[60:63]
    ds_read_b64_tr_b16 a[60:61], v27 offset:43136
    ds_read_b64_tr_b16 a[62:63], v27 offset:43648
    s_waitcnt lgkmcnt(12)
    v_mfma_f32_16x16x32_bf16 v[64:67], v[108:111], a[36:39], v[64:67]
    ds_read_b64_tr_b16 a[64:65], v24 offset:51328
    ds_read_b64_tr_b16 a[66:67], v24 offset:51840
    s_waitcnt lgkmcnt(12)
    v_mfma_f32_16x16x32_bf16 v[68:71], v[108:111], a[40:43], v[68:71]
    ds_read_b64_tr_b16 a[68:69], v25 offset:51328
    ds_read_b64_tr_b16 a[70:71], v25 offset:51840
    s_waitcnt lgkmcnt(12)
    v_mfma_f32_16x16x32_bf16 v[72:75], v[108:111], a[44:47], v[72:75]
    ds_read_b64_tr_b16 a[72:73], v26 offset:51328
    ds_read_b64_tr_b16 a[74:75], v26 offset:51840
    s_waitcnt lgkmcnt(12)
    v_mfma_f32_16x16x32_bf16 v[28:31], a[48:51], v[112:115], v[28:31]
    ds_read_b64_tr_b16 a[76:77], v27 offset:51328
    ds_read_b64_tr_b16 a[78:79], v27 offset:51840
    s_waitcnt lgkmcnt(12)
    v_mfma_f32_16x16x32_bf16 v[32:35], a[52:55], v[112:115], v[32:35]
    ds_read_b64_tr_b16 a[80:81], v24 offset:59520
    ds_read_b64_tr_b16 a[82:83], v24 offset:60032
    s_waitcnt lgkmcnt(12)
    v_mfma_f32_16x16x32_bf16 v[36:39], a[56:59], v[112:115], v[36:39]
    ds_read_b64_tr_b16 a[84:85], v25 offset:59520
    ds_read_b64_tr_b16 a[86:87], v25 offset:60032
    s_waitcnt lgkmcnt(12)
    v_mfma_f32_16x16x32_bf16 v[40:43], a[60:63], v[112:115], v[40:43]
    ds_read_b64_tr_b16 a[88:89], v26 offset:59520
    ds_read_b64_tr_b16 a[90:91], v26 offset:60032
    s_waitcnt lgkmcnt(12)
    v_mfma_f32_16x16x32_bf16 v[44:47], a[64:67], v[112:115], v[44:47]
    ds_read_b64_tr_b16 a[92:93], v27 offset:59520
    ds_read_b64_tr_b16 a[94:95], v27 offset:60032
    s_waitcnt lgkmcnt(12)
    v_mfma_f32_16x16x32_bf16 v[48:51], a[68:71], v[112:115], v[48:51]
    s_waitcnt lgkmcnt(10)
    v_mfma_f32_16x16x32_bf16 v[52:55], a[72:75], v[112:115], v[52:55]
    s_waitcnt lgkmcnt(8)
    v_mfma_f32_16x16x32_bf16 v[56:59], a[76:79], v[112:115], v[56:59]
    s_waitcnt lgkmcnt(6)
    v_mfma_f32_16x16x32_bf16 v[60:63], v[112:115], a[80:83], v[60:63]
    s_waitcnt lgkmcnt(4)
    v_mfma_f32_16x16x32_bf16 v[64:67], v[112:115], a[84:87], v[64:67]
    s_waitcnt lgkmcnt(2)
    v_mfma_f32_16x16x32_bf16 v[68:71], v[112:115], a[88:91], v[68:71]
    s_waitcnt lgkmcnt(0)
    v_mfma_f32_16x16x32_bf16 v[72:75], v[112:115], a[92:95], v[72:75]
    v_add_u32 v4, 156224, v12
    v_min_u32 v5, 47, v1
    v_lshlrev_b32 v5, 2, v5
    v_add_u32 v5, 156480, v5
    v_lshlrev_b32 v6, 4, v2
    v_add_u32 v6, 157184, v6
    v_mov_b32 v7, 157968
    v_lshlrev_b32 v11, 2, v3
    v_add_u32 v11, 156224, v11
    s_barrier
    ds_read_b128 v[108:111], v76 offset:0
    ds_read_b128 v[112:115], v77 offset:0
    ds_read_b64_tr_b16 a[0:1], v20 offset:0
    ds_read_b64_tr_b16 a[2:3], v20 offset:512
    ds_read_b64_tr_b16 a[4:5], v21 offset:0
    ds_read_b64_tr_b16 a[6:7], v21 offset:512
    ds_read_b64_tr_b16 a[8:9], v22 offset:0
    ds_read_b64_tr_b16 a[10:11], v22 offset:512
    ds_read_b64_tr_b16 a[12:13], v23 offset:0
    ds_read_b64_tr_b16 a[14:15], v23 offset:512
    ds_read_b64_tr_b16 a[16:17], v20 offset:8192
    ds_read_b64_tr_b16 a[18:19], v20 offset:8704
    ds_read_b64_tr_b16 a[20:21], v21 offset:8192
    ds_read_b64_tr_b16 a[22:23], v21 offset:8704
    ds_read_b64_tr_b16 a[24:25], v22 offset:8192
    ds_read_b64_tr_b16 a[26:27], v22 offset:8704
    s_waitcnt lgkmcnt(12)
    v_mfma_f32_16x16x32_bf16 v[28:31], a[0:3], v[108:111], v[28:31]
    ds_read_b64_tr_b16 a[28:29], v23 offset:8192
    ds_read_b64_tr_b16 a[30:31], v23 offset:8704
    s_waitcnt lgkmcnt(12)
    v_mfma_f32_16x16x32_bf16 v[32:35], a[4:7], v[108:111], v[32:35]
    ds_read_b64_tr_b16 a[32:33], v20 offset:16384
    ds_read_b64_tr_b16 a[34:35], v20 offset:16896
    s_waitcnt lgkmcnt(12)
    v_mfma_f32_16x16x32_bf16 v[36:39], a[8:11], v[108:111], v[36:39]
    ds_read_b64_tr_b16 a[36:37], v21 offset:16384
    ds_read_b64_tr_b16 a[38:39], v21 offset:16896
    s_waitcnt lgkmcnt(12)
    v_mfma_f32_16x16x32_bf16 v[40:43], a[12:15], v[108:111], v[40:43]
    ds_read_b64_tr_b16 a[40:41], v22 offset:16384
    ds_read_b64_tr_b16 a[42:43], v22 offset:16896
    s_waitcnt lgkmcnt(12)
    v_mfma_f32_16x16x32_bf16 v[44:47], a[16:19], v[108:111], v[44:47]
    ds_read_b64_tr_b16 a[44:45], v23 offset:16384
    ds_read_b64_tr_b16 a[46:47], v23 offset:16896
    s_waitcnt lgkmcnt(12)
    v_mfma_f32_16x16x32_bf16 v[48:51], a[20:23], v[108:111], v[48:51]
    ds_read_b64_tr_b16 a[48:49], v20 offset:4096
    ds_read_b64_tr_b16 a[50:51], v20 offset:4608
    s_waitcnt lgkmcnt(12)
    v_mfma_f32_16x16x32_bf16 v[52:55], a[24:27], v[108:111], v[52:55]
    ds_read_b64_tr_b16 a[52:53], v21 offset:4096
    ds_read_b64_tr_b16 a[54:55], v21 offset:4608
    s_waitcnt lgkmcnt(12)
    v_mfma_f32_16x16x32_bf16 v[56:59], a[28:31], v[108:111], v[56:59]
    ds_read_b64_tr_b16 a[56:57], v22 offset:4096
    ds_read_b64_tr_b16 a[58:59], v22 offset:4608
    s_waitcnt lgkmcnt(12)
    v_mfma_f32_16x16x32_bf16 v[60:63], v[108:111], a[32:35], v[60:63]
    ds_read_b64_tr_b16 a[60:61], v23 offset:4096
    ds_read_b64_tr_b16 a[62:63], v23 offset:4608
    s_waitcnt lgkmcnt(12)
    v_mfma_f32_16x16x32_bf16 v[64:67], v[108:111], a[36:39], v[64:67]
    ds_read_b64_tr_b16 a[64:65], v20 offset:12288
    ds_read_b64_tr_b16 a[66:67], v20 offset:12800
    s_waitcnt lgkmcnt(12)
    v_mfma_f32_16x16x32_bf16 v[68:71], v[108:111], a[40:43], v[68:71]
    ds_read_b64_tr_b16 a[68:69], v21 offset:12288
    ds_read_b64_tr_b16 a[70:71], v21 offset:12800
    s_waitcnt lgkmcnt(12)
    v_mfma_f32_16x16x32_bf16 v[72:75], v[108:111], a[44:47], v[72:75]
    ds_read_b64_tr_b16 a[72:73], v22 offset:12288
    ds_read_b64_tr_b16 a[74:75], v22 offset:12800
    s_waitcnt lgkmcnt(12)
    v_mfma_f32_16x16x32_bf16 v[28:31], a[48:51], v[112:115], v[28:31]
    ds_read_b64_tr_b16 a[76:77], v23 offset:12288
    ds_read_b64_tr_b16 a[78:79], v23 offset:12800
    s_waitcnt lgkmcnt(12)
    v_mfma_f32_16x16x32_bf16 v[32:35], a[52:55], v[112:115], v[32:35]
    ds_read_b64_tr_b16 a[80:81], v20 offset:20480
    ds_read_b64_tr_b16 a[82:83], v20 offset:20992
    s_waitcnt lgkmcnt(12)
    v_mfma_f32_16x16x32_bf16 v[36:39], a[56:59], v[112:115], v[36:39]
    ds_read_b64_tr_b16 a[84:85], v21 offset:20480
    ds_read_b64_tr_b16 a[86:87], v21 offset:20992
    s_waitcnt lgkmcnt(12)
    v_mfma_f32_16x16x32_bf16 v[40:43], a[60:63], v[112:115], v[40:43]
    ds_read_b64_tr_b16 a[88:89], v22 offset:20480
    ds_read_b64_tr_b16 a[90:91], v22 offset:20992
    s_waitcnt lgkmcnt(12)
    v_mfma_f32_16x16x32_bf16 v[44:47], a[64:67], v[112:115], v[44:47]
    ds_read_b64_tr_b16 a[92:93], v23 offset:20480
    ds_read_b64_tr_b16 a[94:95], v23 offset:20992
    s_waitcnt lgkmcnt(12)
    v_mfma_f32_16x16x32_bf16 v[48:51], a[68:71], v[112:115], v[48:51]
    s_waitcnt lgkmcnt(10)
    v_mfma_f32_16x16x32_bf16 v[52:55], a[72:75], v[112:115], v[52:55]
    s_waitcnt lgkmcnt(8)
    v_mfma_f32_16x16x32_bf16 v[56:59], a[76:79], v[112:115], v[56:59]
    s_waitcnt lgkmcnt(6)
    v_mfma_f32_16x16x32_bf16 v[60:63], v[112:115], a[80:83], v[60:63]
    s_waitcnt lgkmcnt(4)
    v_mfma_f32_16x16x32_bf16 v[64:67], v[112:115], a[84:87], v[64:67]
    s_waitcnt lgkmcnt(2)
    v_mfma_f32_16x16x32_bf16 v[68:71], v[112:115], a[88:91], v[68:71]
    s_waitcnt lgkmcnt(0)
    v_mfma_f32_16x16x32_bf16 v[72:75], v[112:115], a[92:95], v[72:75]
    s_barrier
    ds_read_b128 v[108:111], v76 offset:39040
    ds_read_b128 v[112:115], v77 offset:39040
    ds_read_b64_tr_b16 a[0:1], v20 offset:39040
    ds_read_b64_tr_b16 a[2:3], v20 offset:39552
    ds_read_b64_tr_b16 a[4:5], v21 offset:39040
    ds_read_b64_tr_b16 a[6:7], v21 offset:39552
    ds_read_b64_tr_b16 a[8:9], v22 offset:39040
    ds_read_b64_tr_b16 a[10:11], v22 offset:39552
    ds_read_b64_tr_b16 a[12:13], v23 offset:39040
    ds_read_b64_tr_b16 a[14:15], v23 offset:39552
    ds_read_b64_tr_b16 a[16:17], v20 offset:47232
    ds_read_b64_tr_b16 a[18:19], v20 offset:47744
    ds_read_b64_tr_b16 a[20:21], v21 offset:47232
    ds_read_b64_tr_b16 a[22:23], v21 offset:47744
    ds_read_b64_tr_b16 a[24:25], v22 offset:47232
    ds_read_b64_tr_b16 a[26:27], v22 offset:47744
    s_waitcnt lgkmcnt(12)
    v_mfma_f32_16x16x32_bf16 v[28:31], a[0:3], v[108:111], v[28:31]
    ds_read_b64_tr_b16 a[28:29], v23 offset:47232
    ds_read_b64_tr_b16 a[30:31], v23 offset:47744
    s_waitcnt lgkmcnt(12)
    v_mfma_f32_16x16x32_bf16 v[32:35], a[4:7], v[108:111], v[32:35]
    ds_read_b64_tr_b16 a[32:33], v20 offset:55424
    ds_read_b64_tr_b16 a[34:35], v20 offset:55936
    s_waitcnt lgkmcnt(12)
    v_mfma_f32_16x16x32_bf16 v[36:39], a[8:11], v[108:111], v[36:39]
    ds_read_b64_tr_b16 a[36:37], v21 offset:55424
    ds_read_b64_tr_b16 a[38:39], v21 offset:55936
    s_waitcnt lgkmcnt(12)
    v_mfma_f32_16x16x32_bf16 v[40:43], a[12:15], v[108:111], v[40:43]
    ds_read_b64_tr_b16 a[40:41], v22 offset:55424
    ds_read_b64_tr_b16 a[42:43], v22 offset:55936
    s_waitcnt lgkmcnt(12)
    v_mfma_f32_16x16x32_bf16 v[44:47], a[16:19], v[108:111], v[44:47]
    ds_read_b64_tr_b16 a[44:45], v23 offset:55424
    ds_read_b64_tr_b16 a[46:47], v23 offset:55936
    s_waitcnt lgkmcnt(12)
    v_mfma_f32_16x16x32_bf16 v[48:51], a[20:23], v[108:111], v[48:51]
    ds_read_b64_tr_b16 a[48:49], v20 offset:43136
    ds_read_b64_tr_b16 a[50:51], v20 offset:43648
    s_waitcnt lgkmcnt(12)
    v_mfma_f32_16x16x32_bf16 v[52:55], a[24:27], v[108:111], v[52:55]
    ds_read_b64_tr_b16 a[52:53], v21 offset:43136
    ds_read_b64_tr_b16 a[54:55], v21 offset:43648
    s_waitcnt lgkmcnt(12)
    v_mfma_f32_16x16x32_bf16 v[56:59], a[28:31], v[108:111], v[56:59]
    ds_read_b64_tr_b16 a[56:57], v22 offset:43136
    ds_read_b64_tr_b16 a[58:59], v22 offset:43648
    s_waitcnt lgkmcnt(12)
    v_mfma_f32_16x16x32_bf16 v[60:63], v[108:111], a[32:35], v[60:63]
    ds_read_b64_tr_b16 a[60:61], v23 offset:43136
    ds_read_b64_tr_b16 a[62:63], v23 offset:43648
    s_waitcnt lgkmcnt(12)
    v_mfma_f32_16x16x32_bf16 v[64:67], v[108:111], a[36:39], v[64:67]
    ds_read_b64_tr_b16 a[64:65], v20 offset:51328
    ds_read_b64_tr_b16 a[66:67], v20 offset:51840
    s_waitcnt lgkmcnt(12)
    v_mfma_f32_16x16x32_bf16 v[68:71], v[108:111], a[40:43], v[68:71]
    ds_read_b64_tr_b16 a[68:69], v21 offset:51328
    ds_read_b64_tr_b16 a[70:71], v21 offset:51840
    s_waitcnt lgkmcnt(12)
    v_mfma_f32_16x16x32_bf16 v[72:75], v[108:111], a[44:47], v[72:75]
    ds_read_b64_tr_b16 a[72:73], v22 offset:51328
    ds_read_b64_tr_b16 a[74:75], v22 offset:51840
    s_waitcnt lgkmcnt(12)
    v_mfma_f32_16x16x32_bf16 v[28:31], a[48:51], v[112:115], v[28:31]
    ds_read_b64_tr_b16 a[76:77], v23 offset:51328
    ds_read_b64_tr_b16 a[78:79], v23 offset:51840
    s_waitcnt lgkmcnt(12)
    v_mfma_f32_16x16x32_bf16 v[32:35], a[52:55], v[112:115], v[32:35]
    ds_read_b64_tr_b16 a[80:81], v20 offset:59520
    ds_read_b64_tr_b16 a[82:83], v20 offset:60032
    s_waitcnt lgkmcnt(12)
    v_mfma_f32_16x16x32_bf16 v[36:39], a[56:59], v[112:115], v[36:39]
    ds_read_b64_tr_b16 a[84:85], v21 offset:59520
    ds_read_b64_tr_b16 a[86:87], v21 offset:60032
    s_waitcnt lgkmcnt(12)
    v_mfma_f32_16x16x32_bf16 v[40:43], a[60:63], v[112:115], v[40:43]
    ds_read_b64_tr_b16 a[88:89], v22 offset:59520
    ds_read_b64_tr_b16 a[90:91], v22 offset:60032
    s_waitcnt lgkmcnt(12)
    v_mfma_f32_16x16x32_bf16 v[44:47], a[64:67], v[112:115], v[44:47]
    ds_read_b64_tr_b16 a[92:93], v23 offset:59520
    ds_read_b64_tr_b16 a[94:95], v23 offset:60032
    s_waitcnt lgkmcnt(12)
    v_mfma_f32_16x16x32_bf16 v[48:51], a[68:71], v[112:115], v[48:51]
    s_waitcnt lgkmcnt(10)
    v_mfma_f32_16x16x32_bf16 v[52:55], a[72:75], v[112:115], v[52:55]
    s_waitcnt lgkmcnt(8)
    v_mfma_f32_16x16x32_bf16 v[56:59], a[76:79], v[112:115], v[56:59]
    s_waitcnt lgkmcnt(6)
    v_mfma_f32_16x16x32_bf16 v[60:63], v[112:115], a[80:83], v[60:63]
    s_waitcnt lgkmcnt(4)
    v_mfma_f32_16x16x32_bf16 v[64:67], v[112:115], a[84:87], v[64:67]
    s_waitcnt lgkmcnt(2)
    v_mfma_f32_16x16x32_bf16 v[68:71], v[112:115], a[88:91], v[68:71]
    s_waitcnt lgkmcnt(0)
    v_mfma_f32_16x16x32_bf16 v[72:75], v[112:115], a[92:95], v[72:75]
    s_barrier
    ds_read_b128 a[96:99], v80 offset:0
    ds_read_b128 a[100:103], v81 offset:0
    ds_read_b64_tr_b16 a[0:1], v24 offset:0
    ds_read_b64_tr_b16 a[2:3], v24 offset:512
    ds_read_b64_tr_b16 a[4:5], v25 offset:0
    ds_read_b64_tr_b16 a[6:7], v25 offset:512
    ds_read_b64_tr_b16 a[8:9], v26 offset:0
    ds_read_b64_tr_b16 a[10:11], v26 offset:512
    ds_read_b64_tr_b16 a[12:13], v27 offset:0
    ds_read_b64_tr_b16 a[14:15], v27 offset:512
    ds_read_b64_tr_b16 a[16:17], v24 offset:8192
    ds_read_b64_tr_b16 a[18:19], v24 offset:8704
    ds_read_b64_tr_b16 a[20:21], v25 offset:8192
    ds_read_b64_tr_b16 a[22:23], v25 offset:8704
    ds_read_b64_tr_b16 a[24:25], v26 offset:8192
    ds_read_b64_tr_b16 a[26:27], v26 offset:8704
    s_waitcnt lgkmcnt(12)
    v_mfma_f32_16x16x32_bf16 v[28:31], a[0:3], a[96:99], v[28:31]
    ds_read_b64_tr_b16 a[28:29], v27 offset:8192
    ds_read_b64_tr_b16 a[30:31], v27 offset:8704
    s_waitcnt lgkmcnt(12)
    v_mfma_f32_16x16x32_bf16 v[32:35], a[4:7], a[96:99], v[32:35]
    ds_read_b64_tr_b16 a[48:49], v24 offset:4096
    ds_read_b64_tr_b16 a[50:51], v24 offset:4608
    s_waitcnt lgkmcnt(12)
    v_mfma_f32_16x16x32_bf16 v[36:39], a[8:11], a[96:99], v[36:39]
    ds_read_b64_tr_b16 a[52:53], v25 offset:4096
    ds_read_b64_tr_b16 a[54:55], v25 offset:4608
    s_waitcnt lgkmcnt(12)
    v_mfma_f32_16x16x32_bf16 v[40:43], a[12:15], a[96:99], v[40:43]
    ds_read_b64_tr_b16 a[56:57], v26 offset:4096
    ds_read_b64_tr_b16 a[58:59], v26 offset:4608
    s_waitcnt lgkmcnt(12)
    v_mfma_f32_16x16x32_bf16 v[44:47], a[16:19], a[96:99], v[44:47]
    ds_read_b64_tr_b16 a[60:61], v27 offset:4096
    ds_read_b64_tr_b16 a[62:63], v27 offset:4608
    s_waitcnt lgkmcnt(12)
    v_mfma_f32_16x16x32_bf16 v[48:51], a[20:23], a[96:99], v[48:51]
    ds_read_b64_tr_b16 a[64:65], v24 offset:12288
    ds_read_b64_tr_b16 a[66:67], v24 offset:12800
    s_waitcnt lgkmcnt(12)
    v_mfma_f32_16x16x32_bf16 v[52:55], a[24:27], a[96:99], v[52:55]
    ds_read_b64_tr_b16 a[68:69], v25 offset:12288
    ds_read_b64_tr_b16 a[70:71], v25 offset:12800
    s_waitcnt lgkmcnt(12)
    v_mfma_f32_16x16x32_bf16 v[56:59], a[28:31], a[96:99], v[56:59]
    ds_read_b64_tr_b16 a[72:73], v26 offset:12288
    ds_read_b64_tr_b16 a[74:75], v26 offset:12800
    s_waitcnt lgkmcnt(12)
    v_mfma_f32_16x16x32_bf16 v[28:31], a[48:51], a[100:103], v[28:31]
    ds_read_b64_tr_b16 a[76:77], v27 offset:12288
    ds_read_b64_tr_b16 a[78:79], v27 offset:12800
    s_waitcnt lgkmcnt(12)
    v_mfma_f32_16x16x32_bf16 v[32:35], a[52:55], a[100:103], v[32:35]
    s_waitcnt lgkmcnt(10)
    v_mfma_f32_16x16x32_bf16 v[36:39], a[56:59], a[100:103], v[36:39]
    s_waitcnt lgkmcnt(8)
    v_mfma_f32_16x16x32_bf16 v[40:43], a[60:63], a[100:103], v[40:43]
    s_waitcnt lgkmcnt(6)
    v_mfma_f32_16x16x32_bf16 v[44:47], a[64:67], a[100:103], v[44:47]
    s_waitcnt lgkmcnt(4)
    v_mfma_f32_16x16x32_bf16 v[48:51], a[68:71], a[100:103], v[48:51]
    s_waitcnt lgkmcnt(2)
    v_mfma_f32_16x16x32_bf16 v[52:55], a[72:75], a[100:103], v[52:55]
    s_waitcnt lgkmcnt(0)
    v_mfma_f32_16x16x32_bf16 v[56:59], a[76:79], a[100:103], v[56:59]
    buffer_load_dwordx2 v[92:93], v96, s[28:31], s49 offen sc1
    buffer_load_dwordx2 v[94:95], v97, s[28:31], s49 offen sc1
    s_barrier
    ds_read_b128 a[104:107], v80 offset:39040
    ds_read_b128 a[108:111], v81 offset:39040
    ds_read_b64_tr_b16 a[0:1], v24 offset:39040
    ds_read_b64_tr_b16 a[2:3], v24 offset:39552
    ds_read_b64_tr_b16 a[4:5], v25 offset:39040
    ds_read_b64_tr_b16 a[6:7], v25 offset:39552
    ds_read_b64_tr_b16 a[8:9], v26 offset:39040
    ds_read_b64_tr_b16 a[10:11], v26 offset:39552
    ds_read_b64_tr_b16 a[12:13], v27 offset:39040
    ds_read_b64_tr_b16 a[14:15], v27 offset:39552
    ds_read_b64_tr_b16 a[16:17], v24 offset:47232
    ds_read_b64_tr_b16 a[18:19], v24 offset:47744
    ds_read_b64_tr_b16 a[20:21], v25 offset:47232
    ds_read_b64_tr_b16 a[22:23], v25 offset:47744
    ds_read_b64_tr_b16 a[24:25], v26 offset:47232
    ds_read_b64_tr_b16 a[26:27], v26 offset:47744
    s_waitcnt lgkmcnt(12)
    v_mfma_f32_16x16x32_bf16 v[28:31], a[0:3], a[104:107], v[28:31]
    ds_read_b64_tr_b16 a[28:29], v27 offset:47232
    ds_read_b64_tr_b16 a[30:31], v27 offset:47744
    s_waitcnt lgkmcnt(12)
    v_mfma_f32_16x16x32_bf16 v[32:35], a[4:7], a[104:107], v[32:35]
    ds_read_b64_tr_b16 a[48:49], v24 offset:43136
    ds_read_b64_tr_b16 a[50:51], v24 offset:43648
    s_waitcnt lgkmcnt(12)
    v_mfma_f32_16x16x32_bf16 v[36:39], a[8:11], a[104:107], v[36:39]
    ds_read_b64_tr_b16 a[52:53], v25 offset:43136
    ds_read_b64_tr_b16 a[54:55], v25 offset:43648
    s_waitcnt lgkmcnt(12)
    v_mfma_f32_16x16x32_bf16 v[40:43], a[12:15], a[104:107], v[40:43]
    ds_read_b64_tr_b16 a[56:57], v26 offset:43136
    ds_read_b64_tr_b16 a[58:59], v26 offset:43648
    s_waitcnt lgkmcnt(12)
    v_mfma_f32_16x16x32_bf16 v[44:47], a[16:19], a[104:107], v[44:47]
    ds_read_b64_tr_b16 a[60:61], v27 offset:43136
    ds_read_b64_tr_b16 a[62:63], v27 offset:43648
    s_waitcnt lgkmcnt(12)
    v_mfma_f32_16x16x32_bf16 v[48:51], a[20:23], a[104:107], v[48:51]
    ds_read_b64_tr_b16 a[64:65], v24 offset:51328
    ds_read_b64_tr_b16 a[66:67], v24 offset:51840
    s_waitcnt lgkmcnt(12)
    v_mfma_f32_16x16x32_bf16 v[52:55], a[24:27], a[104:107], v[52:55]
    ds_read_b64_tr_b16 a[68:69], v25 offset:51328
    ds_read_b64_tr_b16 a[70:71], v25 offset:51840
    s_waitcnt lgkmcnt(12)
    v_mfma_f32_16x16x32_bf16 v[56:59], a[28:31], a[104:107], v[56:59]
    ds_read_b64_tr_b16 a[72:73], v26 offset:51328
    ds_read_b64_tr_b16 a[74:75], v26 offset:51840
    s_waitcnt lgkmcnt(12)
    v_mfma_f32_16x16x32_bf16 v[28:31], a[48:51], a[108:111], v[28:31]
    ds_read_b64_tr_b16 a[76:77], v27 offset:51328
    ds_read_b64_tr_b16 a[78:79], v27 offset:51840
    s_waitcnt lgkmcnt(12)
    v_mfma_f32_16x16x32_bf16 v[32:35], a[52:55], a[108:111], v[32:35]
    s_waitcnt lgkmcnt(10)
    v_mfma_f32_16x16x32_bf16 v[36:39], a[56:59], a[108:111], v[36:39]
    s_waitcnt lgkmcnt(8)
    v_mfma_f32_16x16x32_bf16 v[40:43], a[60:63], a[108:111], v[40:43]
    s_waitcnt lgkmcnt(6)
    v_mfma_f32_16x16x32_bf16 v[44:47], a[64:67], a[108:111], v[44:47]
    s_waitcnt lgkmcnt(4)
    v_mfma_f32_16x16x32_bf16 v[48:51], a[68:71], a[108:111], v[48:51]
    s_waitcnt lgkmcnt(2)
    v_mfma_f32_16x16x32_bf16 v[52:55], a[72:75], a[108:111], v[52:55]
    s_waitcnt lgkmcnt(0)
    v_mfma_f32_16x16x32_bf16 v[56:59], a[76:79], a[108:111], v[56:59]
    s_barrier
    ds_read_b128 a[112:115], v76 offset:0
    ds_read_b128 a[116:119], v77 offset:0
    ds_read_b64_tr_b16 a[0:1], v20 offset:0
    ds_read_b64_tr_b16 a[2:3], v20 offset:512
    ds_read_b64_tr_b16 a[4:5], v21 offset:0
    ds_read_b64_tr_b16 a[6:7], v21 offset:512
    ds_read_b64_tr_b16 a[8:9], v22 offset:0
    ds_read_b64_tr_b16 a[10:11], v22 offset:512
    ds_read_b64_tr_b16 a[12:13], v23 offset:0
    ds_read_b64_tr_b16 a[14:15], v23 offset:512
    ds_read_b64_tr_b16 a[16:17], v20 offset:8192
    ds_read_b64_tr_b16 a[18:19], v20 offset:8704
    ds_read_b64_tr_b16 a[20:21], v21 offset:8192
    ds_read_b64_tr_b16 a[22:23], v21 offset:8704
    ds_read_b64_tr_b16 a[24:25], v22 offset:8192
    ds_read_b64_tr_b16 a[26:27], v22 offset:8704
    s_waitcnt lgkmcnt(12)
    v_mfma_f32_16x16x32_bf16 v[28:31], a[0:3], a[112:115], v[28:31]
    ds_read_b64_tr_b16 a[28:29], v23 offset:8192
    ds_read_b64_tr_b16 a[30:31], v23 offset:8704
    s_waitcnt lgkmcnt(12)
    v_mfma_f32_16x16x32_bf16 v[32:35], a[4:7], a[112:115], v[32:35]
    ds_read_b64_tr_b16 a[48:49], v20 offset:4096
    ds_read_b64_tr_b16 a[50:51], v20 offset:4608
    s_waitcnt lgkmcnt(12)
    v_mfma_f32_16x16x32_bf16 v[36:39], a[8:11], a[112:115], v[36:39]
    ds_read_b64_tr_b16 a[52:53], v21 offset:4096
    ds_read_b64_tr_b16 a[54:55], v21 offset:4608
    s_waitcnt lgkmcnt(12)
    v_mfma_f32_16x16x32_bf16 v[40:43], a[12:15], a[112:115], v[40:43]
    ds_read_b64_tr_b16 a[56:57], v22 offset:4096
    ds_read_b64_tr_b16 a[58:59], v22 offset:4608
    s_waitcnt lgkmcnt(12)
    v_mfma_f32_16x16x32_bf16 v[44:47], a[16:19], a[112:115], v[44:47]
    ds_read_b64_tr_b16 a[60:61], v23 offset:4096
    ds_read_b64_tr_b16 a[62:63], v23 offset:4608
    s_waitcnt lgkmcnt(12)
    v_mfma_f32_16x16x32_bf16 v[48:51], a[20:23], a[112:115], v[48:51]
    ds_read_b64_tr_b16 a[64:65], v20 offset:12288
    ds_read_b64_tr_b16 a[66:67], v20 offset:12800
    s_waitcnt lgkmcnt(12)
    v_mfma_f32_16x16x32_bf16 v[52:55], a[24:27], a[112:115], v[52:55]
    ds_read_b64_tr_b16 a[68:69], v21 offset:12288
    ds_read_b64_tr_b16 a[70:71], v21 offset:12800
    s_waitcnt lgkmcnt(12)
    v_mfma_f32_16x16x32_bf16 v[56:59], a[28:31], a[112:115], v[56:59]
    ds_read_b64_tr_b16 a[72:73], v22 offset:12288
    ds_read_b64_tr_b16 a[74:75], v22 offset:12800
    s_waitcnt lgkmcnt(12)
    v_mfma_f32_16x16x32_bf16 v[28:31], a[48:51], a[116:119], v[28:31]
    ds_read_b64_tr_b16 a[76:77], v23 offset:12288
    ds_read_b64_tr_b16 a[78:79], v23 offset:12800
    s_waitcnt lgkmcnt(12)
    v_mfma_f32_16x16x32_bf16 v[32:35], a[52:55], a[116:119], v[32:35]
    s_waitcnt lgkmcnt(10)
    v_mfma_f32_16x16x32_bf16 v[36:39], a[56:59], a[116:119], v[36:39]
    s_waitcnt vmcnt(0)
Lst_chk:
    v_cmp_ne_u32 vcc, s34, v93
    v_cmp_ne_u32 s[36:37], s34, v95
    s_nop 0
    s_or_b64 s[36:37], s[36:37], vcc
    s_cbranch_scc1 Lst_re
    v_lshlrev_b32 v93, 16, v92
    s_waitcnt lgkmcnt(8)
    v_mfma_f32_16x16x32_bf16 v[40:43], a[60:63], a[116:119], v[40:43]
    v_and_b32 v92, 0xffff0000, v92
    v_rcp_f32 v93, v93
    s_waitcnt lgkmcnt(6)
    v_mfma_f32_16x16x32_bf16 v[44:47], a[64:67], a[116:119], v[44:47]
    v_lshlrev_b32 v95, 16, v94
    v_and_b32 v94, 0xffff0000, v94
    s_waitcnt lgkmcnt(4)
    v_mfma_f32_16x16x32_bf16 v[48:51], a[68:71], a[116:119], v[48:51]
    v_rcp_f32 v95, v95
    ds_write2st64_b32 v4, v92, v93 offset0:0 offset1:2
    s_waitcnt lgkmcnt(3)
    v_mfma_f32_16x16x32_bf16 v[52:55], a[72:75], a[116:119], v[52:55]
    ds_write2st64_b32 v5, v94, v95 offset0:0 offset1:2
    ds_read_b32 v120, v11
    s_waitcnt lgkmcnt(3)
    v_mfma_f32_16x16x32_bf16 v[56:59], a[76:79], a[116:119], v[56:59]
    s_waitcnt lgkmcnt(0)
    s_barrier
    ds_read_b128 a[120:123], v76 offset:39040
    ds_read_b128 a[124:127], v77 offset:39040
    ds_read_b64_tr_b16 a[0:1], v20 offset:39040
    ds_read_b64_tr_b16 a[2:3], v20 offset:39552
    ds_read_b64_tr_b16 a[4:5], v21 offset:39040
    ds_read_b64_tr_b16 a[6:7], v21 offset:39552
    ds_read_b64_tr_b16 a[8:9], v22 offset:39040
    ds_read_b64_tr_b16 a[10:11], v22 offset:39552
    ds_read_b64_tr_b16 a[12:13], v23 offset:39040
    ds_read_b64_tr_b16 a[14:15], v23 offset:39552
    ds_read_b64_tr_b16 a[16:17], v20 offset:47232
    ds_read_b64_tr_b16 a[18:19], v20 offset:47744
    ds_read_b64_tr_b16 a[20:21], v21 offset:47232
    ds_read_b64_tr_b16 a[22:23], v21 offset:47744
    ds_read_b64_tr_b16 a[24:25], v22 offset:47232
    ds_read_b64_tr_b16 a[26:27], v22 offset:47744
    s_waitcnt lgkmcnt(12)
    v_mfma_f32_16x16x32_bf16 v[28:31], a[0:3], a[120:123], v[28:31]
    ds_read_b64_tr_b16 a[28:29], v23 offset:47232
    ds_read_b64_tr_b16 a[30:31], v23 offset:47744
    s_waitcnt lgkmcnt(12)
    v_mfma_f32_16x16x32_bf16 v[32:35], a[4:7], a[120:123], v[32:35]
    ds_read_b64_tr_b16 a[48:49], v20 offset:43136
    ds_read_b64_tr_b16 a[50:51], v20 offset:43648
    s_waitcnt lgkmcnt(12)
    v_mfma_f32_16x16x32_bf16 v[36:39], a[8:11], a[120:123], v[36:39]
    ds_read_b64_tr_b16 a[52:53], v21 offset:43136
    ds_read_b64_tr_b16 a[54:55], v21 offset:43648
    s_waitcnt lgkmcnt(12)
    v_mfma_f32_16x16x32_bf16 v[40:43], a[12:15], a[120:123], v[40:43]
    ds_read_b64_tr_b16 a[56:57], v22 offset:43136
    ds_read_b64_tr_b16 a[58:59], v22 offset:43648
    s_waitcnt lgkmcnt(12)
    v_mfma_f32_16x16x32_bf16 v[44:47], a[16:19], a[120:123], v[44:47]
    ds_read_b64_tr_b16 a[60:61], v23 offset:43136
    ds_read_b64_tr_b16 a[62:63], v23 offset:43648
    s_waitcnt lgkmcnt(12)
    v_mfma_f32_16x16x32_bf16 v[48:51], a[20:23], a[120:123], v[48:51]
    ds_read_b64_tr_b16 a[64:65], v20 offset:51328
    ds_read_b64_tr_b16 a[66:67], v20 offset:51840
    s_waitcnt lgkmcnt(12)
    v_mfma_f32_16x16x32_bf16 v[52:55], a[24:27], a[120:123], v[52:55]
    ds_read_b64_tr_b16 a[68:69], v21 offset:51328
    ds_read_b64_tr_b16 a[70:71], v21 offset:51840
    s_waitcnt lgkmcnt(12)
    v_mfma_f32_16x16x32_bf16 v[56:59], a[28:31], a[120:123], v[56:59]
    ds_read_b64_tr_b16 a[72:73], v22 offset:51328
    ds_read_b64_tr_b16 a[74:75], v22 offset:51840
    s_waitcnt lgkmcnt(12)
    v_mfma_f32_16x16x32_bf16 v[28:31], a[48:51], a[124:127], v[28:31]
    ds_read_b64_tr_b16 a[76:77], v23 offset:51328
    ds_read_b64_tr_b16 a[78:79], v23 offset:51840
    s_waitcnt lgkmcnt(12)
    v_mfma_f32_16x16x32_bf16 v[32:35], a[52:55], a[124:127], v[32:35]
    s_waitcnt lgkmcnt(10)
    v_mfma_f32_16x16x32_bf16 v[36:39], a[56:59], a[124:127], v[36:39]
    s_waitcnt lgkmcnt(8)
    v_mfma_f32_16x16x32_bf16 v[40:43], a[60:63], a[124:127], v[40:43]
    s_waitcnt lgkmcnt(6)
    v_mfma_f32_16x16x32_bf16 v[44:47], a[64:67], a[124:127], v[44:47]
    s_waitcnt lgkmcnt(4)
    v_mfma_f32_16x16x32_bf16 v[48:51], a[68:71], a[124:127], v[48:51]
    s_waitcnt lgkmcnt(2)
    v_mfma_f32_16x16x32_bf16 v[52:55], a[72:75], a[124:127], v[52:55]
    s_waitcnt lgkmcnt(0)
    v_mfma_f32_16x16x32_bf16 v[56:59], a[76:79], a[124:127], v[56:59]
    s_mov_b32 exec_lo, 0x00010001
    s_mov_b32 exec_hi, 0x00010001
    ds_write_b128 v6, v[28:31] offset:0
    ds_write_b128 v6, v[32:35] offset:64
    ds_write_b128 v6, v[36:39] offset:128
    ds_write_b128 v6, v[40:43] offset:192
    ds_write_b128 v6, v[44:47] offset:256
    ds_write_b128 v6, v[48:51] offset:320
    ds_write_b128 v6, v[52:55] offset:384
    ds_write_b128 v6, v[56:59] offset:448
    ds_write_b32 v7, v7
    s_mov_b64 exec, -1
    ds_read_b128 v[76:79], v6 offset:256
    ds_read_b128 v[80:83], v6 offset:320
    ds_read_b128 v[84:87], v6 offset:384
    ds_read_b128 v[88:91], v6 offset:448
    s_waitcnt lgkmcnt(0)
    v_fmac_f32 v44, v76, v120
    v_fmac_f32 v45, v77, v120
    v_fmac_f32 v46, v78, v120
    v_fmac_f32 v47, v79, v120
    v_cvt_pk_bf16_f32 v44, v44, v45
    v_cvt_pk_bf16_f32 v45, v46, v47
    v_fmac_f32 v48, v80, v120
    v_fmac_f32 v49, v81, v120
    v_fmac_f32 v50, v82, v120
    v_fmac_f32 v51, v83, v120
    v_cvt_pk_bf16_f32 v46, v48, v49
    v_cvt_pk_bf16_f32 v47, v50, v51
    v_fmac_f32 v52, v84, v120
    v_fmac_f32 v53, v85, v120
    v_fmac_f32 v54, v86, v120
    v_fmac_f32 v55, v87, v120
    v_cvt_pk_bf16_f32 v48, v52, v53
    v_cvt_pk_bf16_f32 v49, v54, v55
    v_fmac_f32 v56, v88, v120
    v_fmac_f32 v57, v89, v120
    v_fmac_f32 v58, v90, v120
    v_fmac_f32 v59, v91, v120
    v_cvt_pk_bf16_f32 v50, v56, v57
    v_cvt_pk_bf16_f32 v51, v58, v59
    ds_write_b128 v125, v[44:47] offset:4096
    ds_write_b128 v125, v[48:51] offset:5120
    v_mov_b32 v5, 157972
    v_mov_b32 v6, 1
    s_mov_b64 exec, 1
    ds_add_u32 v5, v6
    s_mov_b64 exec, -1
    v_mov_b32 v5, 157980
Lcw_5:
    s_sub_u32 s35, s35, 1
    s_cbranch_scc1 Lend
    ds_read_b32 v6, v5
    s_waitcnt lgkmcnt(0)
    v_readfirstlane_b32 s38, v6
    s_nop 0
    s_cmp_lt_u32 s38, 1
    s_cbranch_scc1 Lcw_5
    ds_read_b64_tr_b16 a[0:1], v24 offset:16384
    ds_read_b64_tr_b16 a[2:3], v24 offset:16896
    ds_read_b64_tr_b16 a[4:5], v25 offset:16384
    ds_read_b64_tr_b16 a[6:7], v25 offset:16896
    ds_read_b64_tr_b16 a[8:9], v26 offset:16384
    ds_read_b64_tr_b16 a[10:11], v26 offset:16896
    ds_read_b64_tr_b16 a[12:13], v27 offset:16384
    ds_read_b64_tr_b16 a[14:15], v27 offset:16896
    ds_read_b64_tr_b16 a[16:17], v24 offset:20480
    ds_read_b64_tr_b16 a[18:19], v24 offset:20992
    ds_read_b64_tr_b16 a[20:21], v25 offset:20480
    ds_read_b64_tr_b16 a[22:23], v25 offset:20992
    ds_read_b64_tr_b16 a[24:25], v26 offset:20480
    ds_read_b64_tr_b16 a[26:27], v26 offset:20992
    ds_read_b64_tr_b16 a[28:29], v27 offset:20480
    ds_read_b64_tr_b16 a[30:31], v27 offset:20992
    ds_read_b64_tr_b16 a[32:33], v24 offset:55424
    ds_read_b64_tr_b16 a[34:35], v24 offset:55936
    ds_read_b64_tr_b16 a[36:37], v25 offset:55424
    ds_read_b64_tr_b16 a[38:39], v25 offset:55936
    ds_read_b64_tr_b16 a[40:41], v26 offset:55424
    ds_read_b64_tr_b16 a[42:43], v26 offset:55936
    ds_read_b64_tr_b16 a[44:45], v27 offset:55424
    ds_read_b64_tr_b16 a[46:47], v27 offset:55936
    ds_read_b64_tr_b16 a[48:49], v24 offset:59520
    ds_read_b64_tr_b16 a[50:51], v24 offset:60032
    ds_read_b64_tr_b16 a[52:53], v25 offset:59520
    ds_read_b64_tr_b16 a[54:55], v25 offset:60032
    ds_read_b64_tr_b16 a[56:57], v26 offset:59520
    ds_read_b64_tr_b16 a[58:59], v26 offset:60032
    ds_read_b64_tr_b16 a[60:61], v27 offset:59520
    ds_read_b64_tr_b16 a[62:63], v27 offset:60032
    ds_read_b64_tr_b16 a[64:65], v20 offset:16384
    ds_read_b64_tr_b16 a[66:67], v20 offset:16896
    ds_read_b64_tr_b16 a[68:69], v21 offset:16384
    ds_read_b64_tr_b16 a[70:71], v21 offset:16896
    ds_read_b64_tr_b16 a[72:73], v22 offset:16384
    ds_read_b64_tr_b16 a[74:75], v22 offset:16896
    ds_read_b64_tr_b16 a[76:77], v23 offset:16384
    ds_read_b64_tr_b16 a[78:79], v23 offset:16896
    ds_read_b64_tr_b16 a[80:81], v20 offset:20480
    ds_read_b64_tr_b16 a[82:83], v20 offset:20992
    ds_read_b64_tr_b16 a[84:85], v21 offset:20480
    ds_read_b64_tr_b16 a[86:87], v21 offset:20992
    ds_read_b64_tr_b16 a[88:89], v22 offset:20480
    ds_read_b64_tr_b16 a[90:91], v22 offset:20992
    ds_read_b64_tr_b16 a[92:93], v23 offset:20480
    ds_read_b64_tr_b16 a[94:95], v23 offset:20992
    s_waitcnt lgkmcnt(15)
    v_mfma_f32_16x16x32_bf16 v[60:63], a[96:99], a[0:3], v[60:63]
    v_mfma_f32_16x16x32_bf16 v[64:67], a[96:99], a[4:7], v[64:67]
    v_mfma_f32_16x16x32_bf16 v[68:71], a[96:99], a[8:11], v[68:71]
    v_mfma_f32_16x16x32_bf16 v[72:75], a[96:99], a[12:15], v[72:75]
    ds_read_b64_tr_b16 a[0:1], v20 offset:55424
    ds_read_b64_tr_b16 a[2:3], v20 offset:55936
    ds_read_b64_tr_b16 a[4:5], v21 offset:55424
    ds_read_b64_tr_b16 a[6:7], v21 offset:55936
    ds_read_b64_tr_b16 a[8:9], v22 offset:55424
    ds_read_b64_tr_b16 a[10:11], v22 offset:55936
    ds_read_b64_tr_b16 a[12:13], v23 offset:55424
    ds_read_b64_tr_b16 a[14:15], v23 offset:55936
    v_mfma_f32_16x16x32_bf16 v[60:63], a[100:103], a[16:19], v[60:63]
    v_mfma_f32_16x16x32_bf16 v[64:67], a[100:103], a[20:23], v[64:67]
    v_mfma_f32_16x16x32_bf16 v[68:71], a[100:103], a[24:27], v[68:71]
    v_mfma_f32_16x16x32_bf16 v[72:75], a[100:103], a[28:31], v[72:75]
    ds_read_b64_tr_b16 a[16:17], v20 offset:59520
    ds_read_b64_tr_b16 a[18:19], v20 offset:60032
    ds_read_b64_tr_b16 a[20:21], v21 offset:59520
    ds_read_b64_tr_b16 a[22:23], v21 offset:60032
    ds_read_b64_tr_b16 a[24:25], v22 offset:59520
    ds_read_b64_tr_b16 a[26:27], v22 offset:60032
    ds_read_b64_tr_b16 a[28:29], v23 offset:59520
    ds_read_b64_tr_b16 a[30:31], v23 offset:60032
    v_mfma_f32_16x16x32_bf16 v[60:63], a[104:107], a[32:35], v[60:63]
    v_mfma_f32_16x16x32_bf16 v[64:67], a[104:107], a[36:39], v[64:67]
    v_mfma_f32_16x16x32_bf16 v[68:71], a[104:107], a[40:43], v[68:71]
    v_mfma_f32_16x16x32_bf16 v[72:75], a[104:107], a[44:47], v[72:75]
    v_mfma_f32_16x16x32_bf16 v[60:63], a[108:111], a[48:51], v[60:63]
    v_mfma_f32_16x16x32_bf16 v[64:67], a[108:111], a[52:55], v[64:67]
    v_mfma_f32_16x16x32_bf16 v[68:71], a[108:111], a[56:59], v[68:71]
    v_mfma_f32_16x16x32_bf16 v[72:75], a[108:111], a[60:63], v[72:75]
    s_waitcnt lgkmcnt(15)
    v_mfma_f32_16x16x32_bf16 v[60:63], a[112:115], a[64:67], v[60:63]
    v_mfma_f32_16x16x32_bf16 v[64:67], a[112:115], a[68:71], v[64:67]
    v_mfma_f32_16x16x32_bf16 v[68:71], a[112:115], a[72:75], v[68:71]
    v_mfma_f32_16x16x32_bf16 v[72:75], a[112:115], a[76:79], v[72:75]
    v_mfma_f32_16x16x32_bf16 v[60:63], a[116:119], a[80:83], v[60:63]
    v_mfma_f32_16x16x32_bf16 v[64:67], a[116:119], a[84:87], v[64:67]
    v_mfma_f32_16x16x32_bf16 v[68:71], a[116:119], a[88:91], v[68:71]
    v_mfma_f32_16x16x32_bf16 v[72:75], a[116:119], a[92:95], v[72:75]
    s_waitcnt lgkmcnt(8)
    v_mfma_f32_16x16x32_bf16 v[60:63], a[120:123], a[0:3], v[60:63]
    v_mfma_f32_16x16x32_bf16 v[64:67], a[120:123], a[4:7], v[64:67]
    v_mfma_f32_16x16x32_bf16 v[68:71], a[120:123], a[8:11], v[68:71]
    v_mfma_f32_16x16x32_bf16 v[72:75], a[120:123], a[12:15], v[72:75]
    s_waitcnt lgkmcnt(0)
    v_mfma_f32_16x16x32_bf16 v[60:63], a[124:127], a[16:19], v[60:63]
    v_mfma_f32_16x16x32_bf16 v[64:67], a[124:127], a[20:23], v[64:67]
    v_mfma_f32_16x16x32_bf16 v[68:71], a[124:127], a[24:27], v[68:71]
    v_mfma_f32_16x16x32_bf16 v[72:75], a[124:127], a[28:31], v[72:75]
    v_lshlrev_b32 v5, 4, v3
    v_add_u32 v5, 157696, v5
    v_mov_b32 v6, 157952
    v_lshlrev_b32 v4, 4, v2
    v_add_u32 v4, 156224, v4
    v_lshl_add_u32 v125, v1, 3, s48
    s_mov_b64 exec, 0xffff
    ds_write_b32 v5, v60 offset:0
    ds_write_b32 v5, v64 offset:4
    ds_write_b32 v5, v68 offset:8
    ds_write_b32 v5, v72 offset:12
    ds_write_b32 v6, v6
    s_mov_b64 exec, -1
    ds_read_b128 v[36:39], v5
    ds_read_b128 v[28:31], v4
    ds_read_b128 v[32:35], v4 offset:512
    s_waitcnt lgkmcnt(0)
    v_fmac_f32 v60, v28, v36
    v_fmac_f32 v61, v29, v36
    v_fmac_f32 v62, v30, v36
    v_fmac_f32 v63, v31, v36
    v_mul_f32 v60, v60, v32
    v_mul_f32 v61, v61, v33
    v_mul_f32 v62, v62, v34
    v_mul_f32 v63, v63, v35
    v_cvt_pk_bf16_f32 v60, v60, v61
    v_cvt_pk_bf16_f32 v61, v62, v63
    ds_write_b64 v125, v[60:61] offset:0
    v_fmac_f32 v64, v28, v37
    v_fmac_f32 v65, v29, v37
    v_fmac_f32 v66, v30, v37
    v_fmac_f32 v67, v31, v37
    v_mul_f32 v64, v64, v32
    v_mul_f32 v65, v65, v33
    v_mul_f32 v66, v66, v34
    v_mul_f32 v67, v67, v35
    v_cvt_pk_bf16_f32 v64, v64, v65
    v_cvt_pk_bf16_f32 v65, v66, v67
    ds_write_b64 v125, v[64:65] offset:512
    v_fmac_f32 v68, v28, v38
    v_fmac_f32 v69, v29, v38
    v_fmac_f32 v70, v30, v38
    v_fmac_f32 v71, v31, v38
    v_mul_f32 v68, v68, v32
    v_mul_f32 v69, v69, v33
    v_mul_f32 v70, v70, v34
    v_mul_f32 v71, v71, v35
    v_cvt_pk_bf16_f32 v68, v68, v69
    v_cvt_pk_bf16_f32 v69, v70, v71
    ds_write_b64 v125, v[68:69] offset:1024
    v_fmac_f32 v72, v28, v39
    v_fmac_f32 v73, v29, v39
    v_fmac_f32 v74, v30, v39
    v_fmac_f32 v75, v31, v39
    v_mul_f32 v72, v72, v32
    v_mul_f32 v73, v73, v33
    v_mul_f32 v74, v74, v34
    v_mul_f32 v75, v75, v35
    v_cvt_pk_bf16_f32 v72, v72, v73
    v_cvt_pk_bf16_f32 v73, v74, v75
    ds_write_b64 v125, v[72:73] offset:1536
    v_mov_b32 v8, 157976
    v_mov_b32 v9, 1
    s_mov_b64 exec, 1
    ds_add_u32 v8, v9
    s_mov_b64 exec, -1
    s_endpgm
Lst_re:
    s_sub_u32 s35, s35, 1
    s_cbranch_scc1 Lend
    buffer_load_dwordx2 v[92:93], v96, s[28:31], s49 offen sc1
    buffer_load_dwordx2 v[94:95], v97, s[28:31], s49 offen sc1
    s_waitcnt vmcnt(0)
    s_branch Lst_chk
Laux:
    s_lshl_b32 s32, s37, 3
    s_lshl_b32 s39, s38, 2
    s_add_u32 s32, s32, s36
    s_cmp_lt_u32 s37, 4
    s_cselect_b32 s39, s39, 0
    s_add_u32 s32, s32, s39
    s_and_b32 s33, s2, 3
    s_lshl_b32 s33, s33, 3
    s_and_b32 s39, s2, 4
    s_add_u32 s33, s33, s39
    s_add_u32 s33, s33, s37
    s_cmp_ge_u32 s32, 32
    s_cbranch_scc1 Lmst
    v_lshrrev_b32 v5, 3, v1
    v_and_b32 v6, 7, v1
    s_lshl_b32 s40, s3, 14
    s_cmp_eq_u32 s27, 0
    s_cbranch_scc0 Laux_u
    s_lshl_b32 s36, s33, 6
    s_lshl_b32 s37, s26, 4
    s_add_u32 s36, s36, s37
    v_add_u32 v7, s36, v5
    v_mul_u32_u24 v7, 1280, v7
    v_xor_b32 v8, v6, v2
    v_lshl_add_u32 v92, v8, 4, v7
    v_add_u32 v92, 4096, v92
    v_xor_b32 v93, 64, v92
    v_add_u32 v93, 9216, v93
    v_subrev_u32 v94, 1920, v92
    v_subrev_u32 v95, 1920, v93
    s_waitcnt lgkmcnt(0)
    s_sub_u32 s52, s4, 4096
    s_subb_u32 s53, s5, 0
    s_mov_b32 s54, 2625536
    s_mov_b32 s55, 0x20000
    s_mov_b64 s[60:61], s[12:13]
    s_mov_b32 s62, 1280
    s_mov_b32 s63, 0x20000
    s_mov_b32 m0, 131072
    s_nop 0
    buffer_load_dwordx4 v13, s[60:63], 0 offen lds
    s_mov_b64 exec, 0xffff
    buffer_load_dwordx4 v13, s[60:63], 0 offen offset:1024 lds
    s_mov_b64 exec, -1
    s_add_u32 m0, s40, 0
    s_mov_b32 s41, 0
    buffer_load_dwordx4 v92, s[52:55], s41 offen lds
    buffer_load_dwordx4 v93, s[52:55], s41 offen offset:1024 lds
    buffer_load_dwordx4 v94, s[52:55], s41 offen offset:2048 lds
    buffer_load_dwordx4 v95, s[52:55], s41 offen offset:3072 lds
    s_add_u32 m0, s40, 4096
    s_mov_b32 s41, 256
    buffer_load_dwordx4 v92, s[52:55], s41 offen lds
    buffer_load_dwordx4 v93, s[52:55], s41 offen offset:1024 lds
    buffer_load_dwordx4 v94, s[52:55], s41 offen offset:2048 lds
    buffer_load_dwordx4 v95, s[52:55], s41 offen offset:3072 lds
    s_add_u32 m0, s40, 8192
    s_mov_b32 s41, 512
    buffer_load_dwordx4 v92, s[52:55], s41 offen lds
    buffer_load_dwordx4 v93, s[52:55], s41 offen offset:1024 lds
    buffer_load_dwordx4 v94, s[52:55], s41 offen offset:2048 lds
    buffer_load_dwordx4 v95, s[52:55], s41 offen offset:3072 lds
    s_add_u32 m0, s40, 12288
    s_mov_b32 s41, 768
    buffer_load_dwordx4 v92, s[52:55], s41 offen lds
    buffer_load_dwordx4 v93, s[52:55], s41 offen offset:1024 lds
    buffer_load_dwordx4 v94, s[52:55], s41 offen offset:2048 lds
    buffer_load_dwordx4 v95, s[52:55], s41 offen offset:3072 lds
    s_mov_b64 s[28:29], s[24:25]
    s_mov_b32 s30, 268435456
    s_mov_b32 s31, 0x20000
    s_load_dword s34, s[28:29], 0
    s_mov_b64 s[44:45], s[14:15]
    s_mov_b32 s46, 2211840
    s_mov_b32 s47, 0x20000
    s_mov_b64 s[48:49], s[18:19]
    s_mov_b32 s50, 2211840
    s_mov_b32 s51, 0x20000
    v_and_b32 v8, 1, v2
    v_lshlrev_b32 v8, 1, v8
    v_xor_b32 v8, v8, v6
    v_lshlrev_b32 v8, 4, v8
    v_mul_u32_u24 v9, 3456, v5
    s_lshl_b32 s38, s32, 7
    v_add3_u32 v18, v9, v8, s38
    v_xor_b32 v19, 64, v18
    v_add_u32 v19, 26624, v19
    v_add_u32 v20, 53248, v18
    v_add_u32 v21, 53248, v19
    s_mul_i32 s42, s26, 110592
    v_mul_u32_u24 v9, 1280, v5
    v_add_u32 v22, v9, v8
    v_xor_b32 v23, 64, v22
    v_add_u32 v23, 9216, v23
    v_add_u32 v24, 18432, v22
    v_add_u32 v25, 18432, v23
    s_mul_i32 s43, s32, 81920
    s_lshl_b32 s38, s3, 7
    s_add_u32 s43, s43, s38
    v_mov_b32 v96, 0x3f803f80
    v_mov_b32 v97, 0x3f803f80
    v_mov_b32 v98, 0x3f803f80
    v_mov_b32 v99, 0x3f803f80
    v_lshlrev_b32 v100, 4, v2
    v_add_u32 v100, 131072, v100
    v_lshrrev_b32 v10, 1, v3
    v_xor_b32 v10, v10, v2
    v_lshlrev_b32 v10, 4, v10
    v_lshl_add_u32 v10, v3, 7, v10
    v_add_u32 v102, s40, v10
    v_xor_b32 v103, 64, v102
    s_mov_b32 s58, 0xaaaaaaaa
    s_mov_b32 s59, 0xaaaaaaaa
    s_mov_b32 s64, 0xcccccccc
    s_mov_b32 s65, 0xcccccccc
    v_lshrrev_b32 v101, 2, v3
    v_lshl_add_u32 v101, v101, 4, v3
    v_lshlrev_b32 v101, 2, v101
    s_lshl_b32 s36, s26, 4
    v_add_u32 v10, s36, v3
    s_lshl_b32 s37, s33, 6
    s_sub_u32 s37, 2047, s37
    v_sub_u32 v106, s37, v10
    v_lshlrev_b32 v107, 2, v10
    v_add_u32 v107, 132608, v107
    s_lshl_b32 s36, s33, 9
    s_add_u32 s36, s36, 8192000
    v_lshl_add_u32 v108, v10, 3, s36
    v_bfe_u32 v10, v1, 2, 2
    v_and_b32 v8, 3, v1
    v_lshl_add_u32 v14, v2, 3, v10
    v_lshlrev_b32 v14, 7, v14
    v_lshlrev_b32 v9, 2, v1
    v_and_b32 v9, 0x60, v9
    v_add3_u32 v14, v14, v9, s40
    v_lshl_add_u32 v14, v8, 3, v14
    v_xor_b32 v15, 32, v14
    v_xor_b32 v16, 64, v14
    v_xor_b32 v17, 96, v14
    s_lshl_b32 s36, s26, 6
    s_add_u32 s36, s36, 141312
    v_lshl_add_u32 v26, v2, 4, s36
    v_min_u32 v8, 2, v3
    v_mul_u32_u24 v8, 1536, v8
    v_add_u32 v26, v26, v8
    v_add_u32 v4, 132864, v12
    v_mov_b32 v5, 0
    ds_write_b32 v4, v5
    s_waitcnt lgkmcnt(0)
    s_add_u32 s34, s34, 0x9e3779b8
    s_or_b32 s34, s34, 1
    s_waitcnt vmcnt(12)
    ds_read_b128 a[80:83], v102 offset:0
    ds_read_b128 a[84:87], v100 offset:0
    ds_read_b128 a[88:91], v103 offset:0
    ds_read_b128 a[92:95], v100 offset:64
    ds_read_b128 a[96:99], v102 offset:2048
    ds_read_b128 a[100:103], v100 offset:128
    ds_read_b128 a[104:107], v103 offset:2048
    ds_read_b128 a[108:111], v100 offset:192
    s_waitcnt lgkmcnt(0)
    s_add_u32 m0, s40, 0
    s_mov_b32 s41, 1024
    buffer_load_dwordx4 v92, s[52:55], s41 offen lds
    buffer_load_dwordx4 v93, s[52:55], s41 offen offset:1024 lds
    buffer_load_dwordx4 v94, s[52:55], s41 offen offset:2048 lds
    buffer_load_dwordx4 v95, s[52:55], s41 offen offset:3072 lds
    s_barrier
    v_mfma_f32_16x16x32_bf16 v[116:119], a[80:83], a[80:83], 0
    v_mfma_f32_16x16x32_bf16 v[112:115], v[96:99], a[80:83], 0
    v_mfma_f32_16x16x32_bf16 v[120:123], a[84:87], a[80:83], 0
    v_mfma_f32_16x16x32_bf16 v[124:127], a[84:87], v[96:99], 0
    v_mfma_f32_16x16x32_bf16 v[116:119], a[88:91], a[88:91], v[116:119]
    v_mfma_f32_16x16x32_bf16 v[112:115], v[96:99], a[88:91], v[112:115]
    v_mfma_f32_16x16x32_bf16 v[120:123], a[92:95], a[88:91], v[120:123]
    v_mfma_f32_16x16x32_bf16 v[124:127], a[92:95], v[96:99], v[124:127]
    v_mfma_f32_16x16x32_bf16 v[116:119], a[96:99], a[96:99], v[116:119]
    v_mfma_f32_16x16x32_bf16 v[112:115], v[96:99], a[96:99], v[112:115]
    v_mfma_f32_16x16x32_bf16 v[120:123], a[100:103], a[96:99], v[120:123]
    v_mfma_f32_16x16x32_bf16 v[124:127], a[100:103], v[96:99], v[124:127]
    v_mfma_f32_16x16x32_bf16 v[116:119], a[104:107], a[104:107], v[116:119]
    v_mfma_f32_16x16x32_bf16 v[112:115], v[96:99], a[104:107], v[112:115]
    v_mfma_f32_16x16x32_bf16 v[120:123], a[108:111], a[104:107], v[120:123]
    v_mfma_f32_16x16x32_bf16 v[124:127], a[108:111], v[96:99], v[124:127]
    s_waitcnt vmcnt(12)
    ds_read_b128 a[80:83], v102 offset:4096
    ds_read_b128 a[84:87], v100 offset:256
    ds_read_b128 a[88:91], v103 offset:4096
    ds_read_b128 a[92:95], v100 offset:320
    ds_read_b128 a[96:99], v102 offset:6144
    ds_read_b128 a[100:103], v100 offset:384
    ds_read_b128 a[104:107], v103 offset:6144
    ds_read_b128 a[108:111], v100 offset:448
    s_waitcnt lgkmcnt(0)
    v_mfma_f32_16x16x32_bf16 v[116:119], a[80:83], a[80:83], v[116:119]
    v_mfma_f32_16x16x32_bf16 v[112:115], v[96:99], a[80:83], v[112:115]
    v_mfma_f32_16x16x32_bf16 v[120:123], a[84:87], a[80:83], v[120:123]
    v_mfma_f32_16x16x32_bf16 v[124:127], a[84:87], v[96:99], v[124:127]
    v_mfma_f32_16x16x32_bf16 v[116:119], a[88:91], a[88:91], v[116:119]
    v_mfma_f32_16x16x32_bf16 v[112:115], v[96:99], a[88:91], v[112:115]
    v_mfma_f32_16x16x32_bf16 v[120:123], a[92:95], a[88:91], v[120:123]
    v_mfma_f32_16x16x32_bf16 v[124:127], a[92:95], v[96:99], v[124:127]
    v_mfma_f32_16x16x32_bf16 v[116:119], a[96:99], a[96:99], v[116:119]
    v_mfma_f32_16x16x32_bf16 v[112:115], v[96:99], a[96:99], v[112:115]
    v_mfma_f32_16x16x32_bf16 v[120:123], a[100:103], a[96:99], v[120:123]
    v_mfma_f32_16x16x32_bf16 v[124:127], a[100:103], v[96:99], v[124:127]
    v_mfma_f32_16x16x32_bf16 v[116:119], a[104:107], a[104:107], v[116:119]
    v_mfma_f32_16x16x32_bf16 v[112:115], v[96:99], a[104:107], v[112:115]
    v_mfma_f32_16x16x32_bf16 v[120:123], a[108:111], a[104:107], v[120:123]
    v_mfma_f32_16x16x32_bf16 v[124:127], a[108:111], v[96:99], v[124:127]
    s_waitcnt vmcnt(8)
    ds_read_b128 a[80:83], v102 offset:8192
    ds_read_b128 a[84:87], v100 offset:512
    ds_read_b128 a[88:91], v103 offset:8192
    ds_read_b128 a[92:95], v100 offset:576
    ds_read_b128 a[96:99], v102 offset:10240
    ds_read_b128 a[100:103], v100 offset:640
    ds_read_b128 a[104:107], v103 offset:10240
    ds_read_b128 a[108:111], v100 offset:704
    s_waitcnt lgkmcnt(0)
    v_mfma_f32_16x16x32_bf16 v[116:119], a[80:83], a[80:83], v[116:119]
    v_mfma_f32_16x16x32_bf16 v[112:115], v[96:99], a[80:83], v[112:115]
    v_mfma_f32_16x16x32_bf16 v[120:123], a[84:87], a[80:83], v[120:123]
    v_mfma_f32_16x16x32_bf16 v[124:127], a[84:87], v[96:99], v[124:127]
    v_mfma_f32_16x16x32_bf16 v[116:119], a[88:91], a[88:91], v[116:119]
    v_mfma_f32_16x16x32_bf16 v[112:115], v[96:99], a[88:91], v[112:115]
    v_mfma_f32_16x16x32_bf16 v[120:123], a[92:95], a[88:91], v[120:123]
    v_mfma_f32_16x16x32_bf16 v[124:127], a[92:95], v[96:99], v[124:127]
    v_mfma_f32_16x16x32_bf16 v[116:119], a[96:99], a[96:99], v[116:119]
    v_mfma_f32_16x16x32_bf16 v[112:115], v[96:99], a[96:99], v[112:115]
    v_mfma_f32_16x16x32_bf16 v[120:123], a[100:103], a[96:99], v[120:123]
    v_mfma_f32_16x16x32_bf16 v[124:127], a[100:103], v[96:99], v[124:127]
    v_mfma_f32_16x16x32_bf16 v[116:119], a[104:107], a[104:107], v[116:119]
    v_mfma_f32_16x16x32_bf16 v[112:115], v[96:99], a[104:107], v[112:115]
    v_mfma_f32_16x16x32_bf16 v[120:123], a[108:111], a[104:107], v[120:123]
    v_mfma_f32_16x16x32_bf16 v[124:127], a[108:111], v[96:99], v[124:127]
    s_waitcnt vmcnt(4)
    ds_read_b128 a[80:83], v102 offset:12288
    ds_read_b128 a[84:87], v100 offset:768
    ds_read_b128 a[88:91], v103 offset:12288
    ds_read_b128 a[92:95], v100 offset:832
    ds_read_b128 a[96:99], v102 offset:14336
    ds_read_b128 a[100:103], v100 offset:896
    ds_read_b128 a[104:107], v103 offset:14336
    ds_read_b128 a[108:111], v100 offset:960
    s_waitcnt lgkmcnt(0)
    v_mfma_f32_16x16x32_bf16 v[116:119], a[80:83], a[80:83], v[116:119]
    v_mfma_f32_16x16x32_bf16 v[112:115], v[96:99], a[80:83], v[112:115]
    v_mfma_f32_16x16x32_bf16 v[120:123], a[84:87], a[80:83], v[120:123]
    v_mfma_f32_16x16x32_bf16 v[124:127], a[84:87], v[96:99], v[124:127]
    v_mfma_f32_16x16x32_bf16 v[116:119], a[88:91], a[88:91], v[116:119]
    v_mfma_f32_16x16x32_bf16 v[112:115], v[96:99], a[88:91], v[112:115]
    v_mfma_f32_16x16x32_bf16 v[120:123], a[92:95], a[88:91], v[120:123]
    v_mfma_f32_16x16x32_bf16 v[124:127], a[92:95], v[96:99], v[124:127]
    v_mfma_f32_16x16x32_bf16 v[116:119], a[96:99], a[96:99], v[116:119]
    v_mfma_f32_16x16x32_bf16 v[112:115], v[96:99], a[96:99], v[112:115]
    v_mfma_f32_16x16x32_bf16 v[120:123], a[100:103], a[96:99], v[120:123]
    v_mfma_f32_16x16x32_bf16 v[124:127], a[100:103], v[96:99], v[124:127]
    v_mfma_f32_16x16x32_bf16 v[116:119], a[104:107], a[104:107], v[116:119]
    v_mfma_f32_16x16x32_bf16 v[112:115], v[96:99], a[104:107], v[112:115]
    v_mfma_f32_16x16x32_bf16 v[120:123], a[108:111], a[104:107], v[120:123]
    v_mfma_f32_16x16x32_bf16 v[124:127], a[108:111], v[96:99], v[124:127]
    s_waitcnt vmcnt(0)
    ds_read_b128 a[80:83], v102 offset:0
    ds_read_b128 a[84:87], v100 offset:1024
    ds_read_b128 a[88:91], v103 offset:0
    ds_read_b128 a[92:95], v100 offset:1088
    ds_read_b128 a[96:99], v102 offset:2048
    ds_read_b128 a[100:103], v100 offset:1152
    ds_read_b128 a[104:107], v103 offset:2048
    ds_read_b128 a[108:111], v100 offset:1216
    s_waitcnt lgkmcnt(0)
    v_mfma_f32_16x16x32_bf16 v[116:119], a[80:83], a[80:83], v[116:119]
    v_mfma_f32_16x16x32_bf16 v[112:115], v[96:99], a[80:83], v[112:115]
    v_mfma_f32_16x16x32_bf16 v[120:123], a[84:87], a[80:83], v[120:123]
    v_mfma_f32_16x16x32_bf16 v[124:127], a[84:87], v[96:99], v[124:127]
    v_mfma_f32_16x16x32_bf16 v[116:119], a[88:91], a[88:91], v[116:119]
    v_mfma_f32_16x16x32_bf16 v[112:115], v[96:99], a[88:91], v[112:115]
    v_mfma_f32_16x16x32_bf16 v[120:123], a[92:95], a[88:91], v[120:123]
    v_mfma_f32_16x16x32_bf16 v[124:127], a[92:95], v[96:99], v[124:127]
    v_mfma_f32_16x16x32_bf16 v[116:119], a[96:99], a[96:99], v[116:119]
    v_mfma_f32_16x16x32_bf16 v[112:115], v[96:99], a[96:99], v[112:115]
    v_mfma_f32_16x16x32_bf16 v[120:123], a[100:103], a[96:99], v[120:123]
    v_mfma_f32_16x16x32_bf16 v[124:127], a[100:103], v[96:99], v[124:127]
    v_mfma_f32_16x16x32_bf16 v[116:119], a[104:107], a[104:107], v[116:119]
    v_mfma_f32_16x16x32_bf16 v[112:115], v[96:99], a[104:107], v[112:115]
    v_mfma_f32_16x16x32_bf16 v[120:123], a[108:111], a[104:107], v[120:123]
    v_mfma_f32_16x16x32_bf16 v[124:127], a[108:111], v[96:99], v[124:127]
    s_nop 4
    v_cndmask_b32 v4, v116, v117, s[58:59]
    v_cndmask_b32 v5, v118, v119, s[58:59]
    v_cndmask_b32 v4, v4, v5, s[64:65]
    ds_bpermute_b32 v4, v101, v4
    v_mul_f32 v5, 0xbacccccd, v112
    v_cvt_pk_bf16_f32 v104, v5, v5
    v_lshlrev_b32 v104, 16, v104
    v_mul_f32 v5, v5, v5
    v_mov_b32 v6, 0x3acccccd
    s_waitcnt lgkmcnt(0)
    v_fma_f32 v4, v4, v6, -v5
    v_max_f32 v4, 0, v4
    v_cvt_pk_bf16_f32 v4, v4, v4
    v_lshlrev_b32 v4, 16, v4
    v_add_f32 v4, 0x3727c5ac, v4
    v_cvt_pk_bf16_f32 v4, v4, v4
    v_lshlrev_b32 v4, 16, v4
    v_sqrt_f32 v4, v4
    s_nop 0
    v_cvt_pk_bf16_f32 v4, v4, v4
    v_lshlrev_b32 v4, 16, v4
    v_rcp_f32 v105, v4
    v_lshrrev_b32 v8, 16, v4
    v_fma_f32 v4, v104, v124, v120
    v_mul_f32 v4, v4, v105
    v_cvt_pk_bf16_f32 v4, v4, v4
    v_ashrrev_i32 v5, 31, v4
    v_or_b32 v5, 0x80000000, v5
    v_xor_b32 v4, v4, v5
    v_and_b32 v4, 0xffff0000, v4
    v_or_b32 v4, v4, v106
    ds_write_b32 v107, v4
    v_mov_b32 v11, 132864
    v_mov_b32 v7, 1
    s_mov_b64 exec, 1
    ds_add_u32 v11, v7
    s_mov_b64 exec, -1
    v_or_b32 v8, v8, v104
    v_mov_b32 v9, s34
    s_mov_b64 exec, 0xffff
    buffer_store_dwordx2 v[8:9], v108, s[28:31], 0 offen sc1
    s_mov_b64 exec, -1
    s_cmp_lg_u32 s26, 0
    s_cbranch_scc1 Lpub_done
    s_setprio 3
Lcw_9:
    s_sub_u32 s35, s35, 1
    s_cbranch_scc1 Lend
    ds_read_b32 v7, v11
    s_waitcnt lgkmcnt(0)
    v_readfirstlane_b32 s38, v7
    s_nop 0
    s_cmp_lt_u32 s38, 4
    s_cbranch_scc1 Lcw_9
    v_add_u32 v5, 132608, v12
    ds_read_b32 v6, v5
    s_waitcnt lgkmcnt(0)
    v_mov_b32 v4, v6
    s_nop 1
    v_max_u32_dpp v4, v4, v4 row_ror:8 row_mask:0xf bank_mask:0xf
    s_nop 1
    v_max_u32_dpp v4, v4, v4 row_ror:4 row_mask:0xf bank_mask:0xf
    s_nop 1
    v_max_u32_dpp v4, v4, v4 row_ror:2 row_mask:0xf bank_mask:0xf
    s_nop 1
    v_max_u32_dpp v4, v4, v4 row_ror:1 row_mask:0xf bank_mask:0xf
    s_nop 0
    v_readlane_b32 s66, v4, 0
    v_readlane_b32 s36, v4, 16
    v_readlane_b32 s37, v4, 32
    v_readlane_b32 s38, v4, 48
    s_max_u32 s66, s66, s36
    s_max_u32 s37, s37, s38
    s_max_u32 s66, s66, s37
    v_cmp_eq_u32 vcc, s66, v6
    s_nop 1
    v_cndmask_b32 v4, v6, 0, vcc
    s_nop 1
    v_max_u32_dpp v4, v4, v4 row_ror:8 row_mask:0xf bank_mask:0xf
    s_nop 1
    v_max_u32_dpp v4, v4, v4 row_ror:4 row_mask:0xf bank_mask:0xf
    s_nop 1
    v_max_u32_dpp v4, v4, v4 row_ror:2 row_mask:0xf bank_mask:0xf
    s_nop 1
    v_max_u32_dpp v4, v4, v4 row_ror:1 row_mask:0xf bank_mask:0xf
    s_nop 0
    v_readlane_b32 s67, v4, 0
    v_readlane_b32 s36, v4, 16
    v_readlane_b32 s37, v4, 32
    v_readlane_b32 s38, v4, 48
    s_max_u32 s67, s67, s36
    s_max_u32 s37, s37, s38
    s_max_u32 s67, s67, s37
    v_mov_b32 v112, s66
    v_mov_b32 v113, s34
    v_mov_b32 v114, s67
    v_mov_b32 v115, s34
    s_lshl_b32 s36, s32, 7
    s_add_u32 s36, s36, 8126464
    s_mov_b64 exec, 0xff
    buffer_store_dwordx4 v[112:115], v13, s[28:31], s36 offen sc1
    s_mov_b64 exec, -1
    v_mov_b32 v11, 132864
    v_mov_b32 v7, 1
    s_mov_b64 exec, 1
    ds_add_u32 v11, v7
    s_mov_b64 exec, -1
    s_mov_b64 exec, 1
    s_lshl_b32 s36, s2, 2
    s_add_u32 s36, s36, 8323072
    v_mov_b32 v4, s34
    v_mov_b32 v5, s36
    buffer_store_dword v4, v5, s[28:31], 0 offen sc1
    s_mov_b64 exec, -1
    s_setprio 0
Lpub_done:
Lcw_10:
    s_sub_u32 s35, s35, 1
    s_cbranch_scc1 Lend
    ds_read_b32 v7, v11
    s_waitcnt lgkmcnt(0)
    v_readfirstlane_b32 s38, v7
    s_nop 0
    s_cmp_lt_u32 s38, 5
    s_cbranch_scc1 Lcw_10
    s_cmp_ge_u32 s32, 27
    s_cbranch_scc1 Lhelp_r
    s_add_u32 m0, s40, 0
    s_add_u32 s41, s42, 0
    buffer_load_dwordx4 v18, s[44:47], s41 offen nt lds
    buffer_load_dwordx4 v19, s[44:47], s41 offen offset:1024 nt lds
    buffer_load_dwordx4 v20, s[44:47], s41 offen offset:2048 nt lds
    buffer_load_dwordx4 v21, s[44:47], s41 offen offset:3072 nt lds
    s_add_u32 m0, s40, 4096
    s_add_u32 s41, s42, 442368
    buffer_load_dwordx4 v18, s[44:47], s41 offen nt lds
    buffer_load_dwordx4 v19, s[44:47], s41 offen offset:1024 nt lds
    buffer_load_dwordx4 v20, s[44:47], s41 offen offset:2048 nt lds
    buffer_load_dwordx4 v21, s[44:47], s41 offen offset:3072 nt lds
    s_add_u32 m0, s40, 8192
    s_add_u32 s41, s42, 884736
    buffer_load_dwordx4 v18, s[44:47], s41 offen nt lds
    buffer_load_dwordx4 v19, s[44:47], s41 offen offset:1024 nt lds
    buffer_load_dwordx4 v20, s[44:47], s41 offen offset:2048 nt lds
    buffer_load_dwordx4 v21, s[44:47], s41 offen offset:3072 nt lds
    s_add_u32 m0, s40, 12288
    s_add_u32 s41, s42, 1327104
    buffer_load_dwordx4 v18, s[44:47], s41 offen nt lds
    buffer_load_dwordx4 v19, s[44:47], s41 offen offset:1024 nt lds
    buffer_load_dwordx4 v20, s[44:47], s41 offen offset:2048 nt lds
    buffer_load_dwordx4 v21, s[44:47], s41 offen offset:3072 nt lds
    s_waitcnt vmcnt(12)
    ds_read_b64_tr_b16 a[0:1], v14 offset:0
    ds_read_b64_tr_b16 a[2:3], v14 offset:512
    ds_read_b64_tr_b16 a[4:5], v15 offset:0
    ds_read_b64_tr_b16 a[6:7], v15 offset:512
    ds_read_b64_tr_b16 a[8:9], v16 offset:0
    ds_read_b64_tr_b16 a[10:11], v16 offset:512
    ds_read_b64_tr_b16 a[12:13], v17 offset:0
    ds_read_b64_tr_b16 a[14:15], v17 offset:512
    s_waitcnt lgkmcnt(0)
    s_add_u32 m0, s40, 0
    s_add_u32 s41, s42, 1769472
    buffer_load_dwordx4 v18, s[44:47], s41 offen nt lds
    buffer_load_dwordx4 v19, s[44:47], s41 offen offset:1024 nt lds
    buffer_load_dwordx4 v20, s[44:47], s41 offen offset:2048 nt lds
    buffer_load_dwordx4 v21, s[44:47], s41 offen offset:3072 nt lds
    v_mov_b32 v11, 132864
    v_mov_b32 v7, 1
    s_mov_b64 exec, 1
    ds_add_u32 v11, v7
    s_mov_b64 exec, -1
    s_waitcnt vmcnt(12)
    ds_read_b64_tr_b16 a[16:17], v14 offset:4096
    ds_read_b64_tr_b16 a[18:19], v14 offset:4608
    ds_read_b64_tr_b16 a[20:21], v15 offset:4096
    ds_read_b64_tr_b16 a[22:23], v15 offset:4608
    ds_read_b64_tr_b16 a[24:25], v16 offset:4096
    ds_read_b64_tr_b16 a[26:27], v16 offset:4608
    ds_read_b64_tr_b16 a[28:29], v17 offset:4096
    ds_read_b64_tr_b16 a[30:31], v17 offset:4608
    s_waitcnt lgkmcnt(0)
    s_add_u32 m0, s40, 4096
    s_add_u32 s41, s43, 0
    buffer_load_dwordx4 v22, s[48:51], s41 offen nt lds
    buffer_load_dwordx4 v23, s[48:51], s41 offen offset:1024 nt lds
    buffer_load_dwordx4 v24, s[48:51], s41 offen offset:2048 nt lds
    buffer_load_dwordx4 v25, s[48:51], s41 offen offset:3072 nt lds
    s_waitcnt vmcnt(12)
    ds_read_b64_tr_b16 a[32:33], v14 offset:8192
    ds_read_b64_tr_b16 a[34:35], v14 offset:8704
    ds_read_b64_tr_b16 a[36:37], v15 offset:8192
    ds_read_b64_tr_b16 a[38:39], v15 offset:8704
    ds_read_b64_tr_b16 a[40:41], v16 offset:8192
    ds_read_b64_tr_b16 a[42:43], v16 offset:8704
    ds_read_b64_tr_b16 a[44:45], v17 offset:8192
    ds_read_b64_tr_b16 a[46:47], v17 offset:8704
    s_waitcnt lgkmcnt(0)
    s_add_u32 m0, s40, 8192
    s_add_u32 s41, s43, 40960
    buffer_load_dwordx4 v22, s[48:51], s41 offen nt lds
    buffer_load_dwordx4 v23, s[48:51], s41 offen offset:1024 nt lds
    buffer_load_dwordx4 v24, s[48:51], s41 offen offset:2048 nt lds
    buffer_load_dwordx4 v25, s[48:51], s41 offen offset:3072 nt lds
    s_waitcnt vmcnt(12)
    ds_read_b64_tr_b16 a[48:49], v14 offset:12288
    ds_read_b64_tr_b16 a[50:51], v14 offset:12800
    ds_read_b64_tr_b16 a[52:53], v15 offset:12288
    ds_read_b64_tr_b16 a[54:55], v15 offset:12800
    ds_read_b64_tr_b16 a[56:57], v16 offset:12288
    ds_read_b64_tr_b16 a[58:59], v16 offset:12800
    ds_read_b64_tr_b16 a[60:61], v17 offset:12288
    ds_read_b64_tr_b16 a[62:63], v17 offset:12800
    s_waitcnt vmcnt(8)
    ds_read_b64_tr_b16 a[64:65], v14 offset:0
    ds_read_b64_tr_b16 a[66:67], v14 offset:512
    ds_read_b64_tr_b16 a[68:69], v15 offset:0
    ds_read_b64_tr_b16 a[70:71], v15 offset:512
    ds_read_b64_tr_b16 a[72:73], v16 offset:0
    ds_read_b64_tr_b16 a[74:75], v16 offset:512
    ds_read_b64_tr_b16 a[76:77], v17 offset:0
    ds_read_b64_tr_b16 a[78:79], v17 offset:512
    s_branch Laux_mm
Laux_u:
    s_cmp_ge_u32 s32, 27
    s_cbranch_scc1 Lend
    v_and_b32 v8, 1, v2
    v_lshlrev_b32 v8, 1, v8
    v_xor_b32 v8, v8, v6
    v_lshlrev_b32 v8, 4, v8
    v_mul_u32_u24 v9, 3456, v5
    s_lshl_b32 s38, s32, 7
    v_add3_u32 v18, v9, v8, s38
    v_xor_b32 v19, 64, v18
    v_add_u32 v19, 26624, v19
    v_add_u32 v20, 53248, v18
    v_add_u32 v21, 53248, v19
    s_mul_i32 s42, s26, 110592
    v_mul_u32_u24 v9, 1280, v5
    v_add_u32 v22, v9, v8
    v_xor_b32 v23, 64, v22
    v_add_u32 v23, 9216, v23
    v_add_u32 v24, 18432, v22
    v_add_u32 v25, 18432, v23
    s_mul_i32 s43, s32, 81920
    s_lshl_b32 s38, s3, 7
    s_add_u32 s43, s43, s38
    s_waitcnt lgkmcnt(0)
    s_mov_b64 s[44:45], s[16:17]
    s_mov_b32 s46, 2211840
    s_mov_b32 s47, 0x20000
    s_mov_b64 s[28:29], s[24:25]
    s_mov_b32 s30, 268435456
    s_mov_b32 s31, 0x20000
    s_load_dword s34, s[28:29], 0
    s_mov_b64 s[52:53], s[4:5]
    s_mov_b32 s54, 2621440
    s_mov_b32 s55, 0x20000
    s_mov_b64 s[48:49], s[18:19]
    s_mov_b32 s50, 2211840
    s_mov_b32 s51, 0x20000
    s_mov_b64 s[68:69], s[18:19]
    s_mov_b32 s70, 2211840
    s_mov_b32 s71, 0x20000
    s_cmp_ge_u32 s26, 2
    s_cselect_b32 s70, 0, s70
    v_bfe_u32 v10, v1, 2, 2
    v_and_b32 v8, 3, v1
    v_lshl_add_u32 v14, v2, 3, v10
    v_lshlrev_b32 v14, 7, v14
    v_lshlrev_b32 v9, 2, v1
    v_and_b32 v9, 0x60, v9
    v_add3_u32 v14, v14, v9, s40
    v_lshl_add_u32 v14, v8, 3, v14
    v_xor_b32 v15, 32, v14
    v_xor_b32 v16, 64, v14
    v_xor_b32 v17, 96, v14
    s_lshl_b32 s36, s26, 6
    s_add_u32 s36, s36, 141312
    v_lshl_add_u32 v26, v2, 4, s36
    v_min_u32 v8, 2, v3
    v_mul_u32_u24 v8, 1536, v8
    v_add_u32 v26, v26, v8
    s_waitcnt lgkmcnt(0)
    s_add_u32 s34, s34, 0x9e3779b8
    s_or_b32 s34, s34, 1
    s_cmp_lg_u32 s3, 7
    s_cbranch_scc1 Lnop7
    s_setprio 3
Lnop7:
    s_barrier
    s_add_u32 m0, s40, 0
    s_add_u32 s41, s42, 0
    buffer_load_dwordx4 v18, s[44:47], s41 offen nt lds
    buffer_load_dwordx4 v19, s[44:47], s41 offen offset:1024 nt lds
    buffer_load_dwordx4 v20, s[44:47], s41 offen offset:2048 nt lds
    buffer_load_dwordx4 v21, s[44:47], s41 offen offset:3072 nt lds
    s_add_u32 m0, s40, 4096
    s_add_u32 s41, s42, 442368
    buffer_load_dwordx4 v18, s[44:47], s41 offen nt lds
    buffer_load_dwordx4 v19, s[44:47], s41 offen offset:1024 nt lds
    buffer_load_dwordx4 v20, s[44:47], s41 offen offset:2048 nt lds
    buffer_load_dwordx4 v21, s[44:47], s41 offen offset:3072 nt lds
    s_add_u32 m0, s40, 8192
    s_add_u32 s41, s42, 884736
    buffer_load_dwordx4 v18, s[44:47], s41 offen nt lds
    buffer_load_dwordx4 v19, s[44:47], s41 offen offset:1024 nt lds
    buffer_load_dwordx4 v20, s[44:47], s41 offen offset:2048 nt lds
    buffer_load_dwordx4 v21, s[44:47], s41 offen offset:3072 nt lds
    s_add_u32 m0, s40, 12288
    s_add_u32 s41, s42, 1327104
    buffer_load_dwordx4 v18, s[44:47], s41 offen nt lds
    buffer_load_dwordx4 v19, s[44:47], s41 offen offset:1024 nt lds
    buffer_load_dwordx4 v20, s[44:47], s41 offen offset:2048 nt lds
    buffer_load_dwordx4 v21, s[44:47], s41 offen offset:3072 nt lds
    v_mov_b32 v11, 132864
Lcw_11:
    s_sub_u32 s35, s35, 1
    s_cbranch_scc1 Lend
    s_sleep 4
    ds_read_b32 v7, v11
    s_waitcnt lgkmcnt(0)
    v_readfirstlane_b32 s38, v7
    s_nop 0
    s_cmp_lt_u32 s38, 5
    s_cbranch_scc1 Lcw_11
    s_waitcnt vmcnt(12)
    ds_read_b64_tr_b16 a[0:1], v14 offset:0
    ds_read_b64_tr_b16 a[2:3], v14 offset:512
    ds_read_b64_tr_b16 a[4:5], v15 offset:0
    ds_read_b64_tr_b16 a[6:7], v15 offset:512
    ds_read_b64_tr_b16 a[8:9], v16 offset:0
    ds_read_b64_tr_b16 a[10:11], v16 offset:512
    ds_read_b64_tr_b16 a[12:13], v17 offset:0
    ds_read_b64_tr_b16 a[14:15], v17 offset:512
    s_waitcnt lgkmcnt(0)
    s_add_u32 m0, s40, 0
    s_add_u32 s41, s42, 1769472
    buffer_load_dwordx4 v18, s[44:47], s41 offen nt lds
    buffer_load_dwordx4 v19, s[44:47], s41 offen offset:1024 nt lds
    buffer_load_dwordx4 v20, s[44:47], s41 offen offset:2048 nt lds
    buffer_load_dwordx4 v21, s[44:47], s41 offen offset:3072 nt lds
    s_waitcnt vmcnt(12)
    ds_read_b64_tr_b16 a[16:17], v14 offset:4096
    ds_read_b64_tr_b16 a[18:19], v14 offset:4608
    ds_read_b64_tr_b16 a[20:21], v15 offset:4096
    ds_read_b64_tr_b16 a[22:23], v15 offset:4608
    ds_read_b64_tr_b16 a[24:25], v16 offset:4096
    ds_read_b64_tr_b16 a[26:27], v16 offset:4608
    ds_read_b64_tr_b16 a[28:29], v17 offset:4096
    ds_read_b64_tr_b16 a[30:31], v17 offset:4608
    s_waitcnt vmcnt(8)
    ds_read_b64_tr_b16 a[32:33], v14 offset:8192
    ds_read_b64_tr_b16 a[34:35], v14 offset:8704
    ds_read_b64_tr_b16 a[36:37], v15 offset:8192
    ds_read_b64_tr_b16 a[38:39], v15 offset:8704
    ds_read_b64_tr_b16 a[40:41], v16 offset:8192
    ds_read_b64_tr_b16 a[42:43], v16 offset:8704
    ds_read_b64_tr_b16 a[44:45], v17 offset:8192
    ds_read_b64_tr_b16 a[46:47], v17 offset:8704
    s_waitcnt vmcnt(4)
    ds_read_b64_tr_b16 a[48:49], v14 offset:12288
    ds_read_b64_tr_b16 a[50:51], v14 offset:12800
    ds_read_b64_tr_b16 a[52:53], v15 offset:12288
    ds_read_b64_tr_b16 a[54:55], v15 offset:12800
    ds_read_b64_tr_b16 a[56:57], v16 offset:12288
    ds_read_b64_tr_b16 a[58:59], v16 offset:12800
    ds_read_b64_tr_b16 a[60:61], v17 offset:12288
    ds_read_b64_tr_b16 a[62:63], v17 offset:12800
    s_waitcnt vmcnt(0)
    ds_read_b64_tr_b16 a[64:65], v14 offset:0
    ds_read_b64_tr_b16 a[66:67], v14 offset:512
    ds_read_b64_tr_b16 a[68:69], v15 offset:0
    ds_read_b64_tr_b16 a[70:71], v15 offset:512
    ds_read_b64_tr_b16 a[72:73], v16 offset:0
    ds_read_b64_tr_b16 a[74:75], v16 offset:512
    ds_read_b64_tr_b16 a[76:77], v17 offset:0
    ds_read_b64_tr_b16 a[78:79], v17 offset:512
    s_cmp_lg_u32 s3, 7
    s_cbranch_scc1 Lnofx
    v_mov_b32 v92, 0x3f803f80
    v_mov_b32 v93, 0x3f803f80
    v_mov_b32 v94, 0x3f803f80
    v_mov_b32 v95, 0x3f803f80
    v_add_u32 v4, 144384, v13
    ds_write_b128 v4, v[92:95]
    ds_write_b128 v4, v[92:95] offset:1024
    v_and_b32 v120, 31, v1
    v_lshlrev_b32 v120, 7, v120
    v_add_u32 v120, 8126464, v120
Lpt_12:
    s_sub_u32 s35, s35, 1
    s_cbranch_scc1 Lend
    s_sleep 2
    buffer_load_dwordx4 v[124:127], v120, s[28:31], 0 offen sc1
    s_waitcnt vmcnt(0)
    v_cmp_ne_u32 vcc, s34, v125
    v_cmp_ne_u32 s[36:37], s34, v127
    s_nop 0
    s_or_b64 s[36:37], s[36:37], vcc
    s_cbranch_scc1 Lpt_12
    v_mov_b32 v120, v124
    s_nop 1
    v_max_u32_dpp v120, v120, v120 row_ror:8 row_mask:0xf bank_mask:0xf
    s_nop 1
    v_max_u32_dpp v120, v120, v120 row_ror:4 row_mask:0xf bank_mask:0xf
    s_nop 1
    v_max_u32_dpp v120, v120, v120 row_ror:2 row_mask:0xf bank_mask:0xf
    s_nop 1
    v_max_u32_dpp v120, v120, v120 row_ror:1 row_mask:0xf bank_mask:0xf
    s_nop 0
    v_readlane_b32 s56, v120, 0
    v_readlane_b32 s36, v120, 16
    v_readlane_b32 s37, v120, 32
    v_readlane_b32 s38, v120, 48
    s_max_u32 s56, s56, s36
    s_max_u32 s37, s37, s38
    s_max_u32 s56, s56, s37
    v_cmp_eq_u32 vcc, s56, v124
    s_nop 1
    v_cndmask_b32 v120, v124, v126, vcc
    s_nop 1
    v_max_u32_dpp v120, v120, v120 row_ror:8 row_mask:0xf bank_mask:0xf
    s_nop 1
    v_max_u32_dpp v120, v120, v120 row_ror:4 row_mask:0xf bank_mask:0xf
    s_nop 1
    v_max_u32_dpp v120, v120, v120 row_ror:2 row_mask:0xf bank_mask:0xf
    s_nop 1
    v_max_u32_dpp v120, v120, v120 row_ror:1 row_mask:0xf bank_mask:0xf
    s_nop 0
    v_readlane_b32 s57, v120, 0
    v_readlane_b32 s36, v120, 16
    v_readlane_b32 s37, v120, 32
    v_readlane_b32 s38, v120, 48
    s_max_u32 s57, s57, s36
    s_max_u32 s37, s37, s38
    s_max_u32 s57, s57, s37
    s_and_b32 s36, s56, 0x7ff
    s_sub_u32 s36, 2047, s36
    s_and_b32 s37, s57, 0x7ff
    s_sub_u32 s37, 2047, s37
    s_mul_i32 s38, s36, 1280
    s_mul_i32 s39, s37, 1280
    s_mov_b32 m0, 141312
    v_mov_b32 v4, s36
    buffer_load_dwordx4 v13, s[52:55], s38 offen lds
    s_mov_b32 m0, 142848
    v_mov_b32 v5, s37
    buffer_load_dwordx4 v13, s[52:55], s39 offen lds
    s_mov_b64 exec, 0xffff
    buffer_load_dwordx4 v13, s[52:55], s39 offen offset:1024 lds
    s_mov_b32 m0, 141312
    s_mov_b32 vcc_lo, 0xaaaaaaaa
    buffer_load_dwordx4 v13, s[52:55], s38 offen offset:1024 lds
    s_mov_b64 exec, 3
    v_cndmask_b32 v4, v4, v5, vcc
    v_lshlrev_b32 v118, 3, v4
    v_add_u32 v118, 8192000, v118
    v_add_u32 v9, 132872, v12
Lxs_chk:
    s_sub_u32 s35, s35, 1
    s_cbranch_scc1 Lend
    buffer_load_dwordx2 v[116:117], v118, s[28:31], 0 offen sc1
    s_waitcnt vmcnt(0)
    v_cmp_ne_u32 vcc, s34, v117
    s_nop 0
    s_cbranch_vccnz Lxs_chk
    ds_write_b32 v9, v116
    s_mov_b64 exec, -1
    v_mov_b32 v10, 132868
    v_mov_b32 v7, 1
    s_mov_b64 exec, 1
    ds_add_u32 v10, v7
    s_mov_b64 exec, -1
Lnofx:
Lcw_13:
    s_sub_u32 s35, s35, 1
    s_cbranch_scc1 Lend
    s_sleep 2
    ds_read_b32 v7, v11
    s_waitcnt lgkmcnt(0)
    v_readfirstlane_b32 s38, v7
    s_nop 0
    s_cmp_lt_u32 s38, 9
    s_cbranch_scc1 Lcw_13
    s_add_u32 m0, s40, 4096
    s_add_u32 s41, s43, 0
    buffer_load_dwordx4 v22, s[48:51], s41 offen nt lds
    buffer_load_dwordx4 v23, s[48:51], s41 offen offset:1024 nt lds
    buffer_load_dwordx4 v24, s[48:51], s41 offen offset:2048 nt lds
    buffer_load_dwordx4 v25, s[48:51], s41 offen offset:3072 nt lds
    s_add_u32 m0, s40, 8192
    s_add_u32 s41, s43, 40960
    buffer_load_dwordx4 v22, s[48:51], s41 offen nt lds
    buffer_load_dwordx4 v23, s[48:51], s41 offen offset:1024 nt lds
    buffer_load_dwordx4 v24, s[48:51], s41 offen offset:2048 nt lds
    buffer_load_dwordx4 v25, s[48:51], s41 offen offset:3072 nt lds
    s_add_u32 m0, s40, 12288
    s_add_u32 s41, s43, 512
    buffer_load_dwordx4 v22, s[68:71], s41 offen nt lds
    buffer_load_dwordx4 v23, s[68:71], s41 offen offset:1024 nt lds
    buffer_load_dwordx4 v24, s[68:71], s41 offen offset:2048 nt lds
    buffer_load_dwordx4 v25, s[68:71], s41 offen offset:3072 nt lds
    s_add_u32 m0, s40, 0
    s_add_u32 s41, s43, 41472
    buffer_load_dwordx4 v22, s[68:71], s41 offen nt lds
    buffer_load_dwordx4 v23, s[68:71], s41 offen offset:1024 nt lds
    buffer_load_dwordx4 v24, s[68:71], s41 offen offset:2048 nt lds
    buffer_load_dwordx4 v25, s[68:71], s41 offen offset:3072 nt lds
Laux_mm:
    v_mov_b32 v10, 132868
Lcw_14:
    s_sub_u32 s35, s35, 1
    s_cbranch_scc1 Lend
    s_sleep 1
    ds_read_b32 v7, v10
    s_waitcnt lgkmcnt(0)
    v_readfirstlane_b32 s38, v7
    s_nop 0
    s_cmp_lt_u32 s38, 1
    s_cbranch_scc1 Lcw_14
    ds_read_b128 v[92:95], v26 offset:0
    ds_read_b128 v[96:99], v26 offset:256
    ds_read_b128 v[100:103], v26 offset:512
    ds_read_b128 v[104:107], v26 offset:768
    ds_read_b128 v[108:111], v26 offset:1024
    ds_read_b64 v[116:117], v10 offset:4
    s_waitcnt lgkmcnt(0)
    v_readfirstlane_b32 s56, v116
    v_readfirstlane_b32 s57, v117
    v_mfma_f32_16x16x32_bf16 v[112:115], a[0:3], v[92:95], 0
    v_mfma_f32_16x16x32_bf16 v[116:119], a[4:7], v[92:95], 0
    v_mfma_f32_16x16x32_bf16 v[120:123], a[8:11], v[92:95], 0
    v_mfma_f32_16x16x32_bf16 v[124:127], a[12:15], v[92:95], 0
    v_mfma_f32_16x16x32_bf16 v[112:115], a[16:19], v[96:99], v[112:115]
    v_mfma_f32_16x16x32_bf16 v[116:119], a[20:23], v[96:99], v[116:119]
    v_mfma_f32_16x16x32_bf16 v[120:123], a[24:27], v[96:99], v[120:123]
    v_mfma_f32_16x16x32_bf16 v[124:127], a[28:31], v[96:99], v[124:127]
    v_mfma_f32_16x16x32_bf16 v[112:115], a[32:35], v[100:103], v[112:115]
    v_mfma_f32_16x16x32_bf16 v[116:119], a[36:39], v[100:103], v[116:119]
    v_mfma_f32_16x16x32_bf16 v[120:123], a[40:43], v[100:103], v[120:123]
    v_mfma_f32_16x16x32_bf16 v[124:127], a[44:47], v[100:103], v[124:127]
    v_mfma_f32_16x16x32_bf16 v[112:115], a[48:51], v[104:107], v[112:115]
    v_mfma_f32_16x16x32_bf16 v[116:119], a[52:55], v[104:107], v[116:119]
    v_mfma_f32_16x16x32_bf16 v[120:123], a[56:59], v[104:107], v[120:123]
    v_mfma_f32_16x16x32_bf16 v[124:127], a[60:63], v[104:107], v[124:127]
    v_mfma_f32_16x16x32_bf16 v[112:115], a[64:67], v[108:111], v[112:115]
    v_mfma_f32_16x16x32_bf16 v[116:119], a[68:71], v[108:111], v[116:119]
    v_mfma_f32_16x16x32_bf16 v[120:123], a[72:75], v[108:111], v[120:123]
    v_mfma_f32_16x16x32_bf16 v[124:127], a[76:79], v[108:111], v[124:127]
    s_mul_i32 s36, s3, 768
    s_add_u32 s36, s36, 133120
    v_lshlrev_b32 v4, 8, v3
    v_lshl_add_u32 v4, v2, 4, v4
    v_add_u32 v4, s36, v4
    v_add_u32 v5, 133120, v12
    s_lshl_b32 s37, s3, 8
    s_add_u32 s37, s37, 139264
    v_lshl_add_u32 v6, v1, 1, s37
    v_and_b32 v7, 1, v1
    v_lshlrev_b32 v7, 7, v7
    v_lshl_add_u32 v7, v2, 4, v7
    v_add_u32 v7, s37, v7
    s_lshl_b32 s38, s56, 16
    s_lshl_b32 s39, s57, 16
    v_rcp_f32 v8, s38
    v_rcp_f32 v9, s39
    s_and_b32 s56, s56, 0xffff0000
    s_and_b32 s57, s57, 0xffff0000
    s_mov_b32 exec_lo, 0x00070007
    s_mov_b32 exec_hi, 0x00070007
    ds_write_b128 v4, v[112:115] offset:0
    ds_write_b128 v4, v[116:119] offset:64
    ds_write_b128 v4, v[120:123] offset:128
    ds_write_b128 v4, v[124:127] offset:192
    s_mov_b64 exec, -1
    s_waitcnt lgkmcnt(0)
    s_barrier
    ds_read2st64_b32 v[92:93], v5 offset0:0 offset1:1
    ds_read2st64_b32 v[94:95], v5 offset0:2 offset1:3
    ds_read2st64_b32 v[96:97], v5 offset0:4 offset1:5
    ds_read2st64_b32 v[98:99], v5 offset0:6 offset1:7
    ds_read2st64_b32 v[100:101], v5 offset0:8 offset1:9
    ds_read2st64_b32 v[102:103], v5 offset0:10 offset1:11
    ds_read2st64_b32 v[116:117], v5 offset0:12 offset1:13
    ds_read2st64_b32 v[118:119], v5 offset0:14 offset1:15
    ds_read2st64_b32 v[120:121], v5 offset0:16 offset1:17
    ds_read2st64_b32 v[122:123], v5 offset0:18 offset1:19
    ds_read2st64_b32 v[124:125], v5 offset0:20 offset1:21
    ds_read2st64_b32 v[126:127], v5 offset0:22 offset1:23
    v_cmp_eq_u32 s[72:73], 1, v2
    v_cmp_eq_u32 s[74:75], 2, v2
    v_cmp_eq_u32 s[76:77], 3, v2
    s_mul_i32 s37, s32, 10
    s_add_u32 s37, s37, s3
    s_lshl_b32 s37, s37, 10
    s_add_u32 s37, s37, 7405568
    s_waitcnt lgkmcnt(0)
    v_add_f32 v92, v92, v95
    v_add_f32 v98, v98, v101
    v_add_f32 v92, v92, v98
    v_add_f32 v93, v93, v96
    v_add_f32 v99, v99, v102
    v_add_f32 v93, v93, v99
    v_add_f32 v94, v94, v97
    v_add_f32 v100, v100, v103
    v_add_f32 v94, v94, v100
    v_add_f32 v116, v116, v119
    v_add_f32 v122, v122, v125
    v_add_f32 v116, v116, v122
    v_add_f32 v117, v117, v120
    v_add_f32 v123, v123, v126
    v_add_f32 v117, v117, v123
    v_add_f32 v118, v118, v121
    v_add_f32 v124, v124, v127
    v_add_f32 v118, v118, v124
    v_fmac_f32 v92, s56, v94
    v_mul_f32 v112, v92, v8
    v_fmac_f32 v93, s57, v94
    v_mul_f32 v113, v93, v9
    v_fmac_f32 v116, s56, v118
    v_mul_f32 v120, v116, v8
    v_fmac_f32 v117, s57, v118
    v_mul_f32 v121, v117, v9
    v_cvt_pk_bf16_f32 v113, v112, v113
    v_lshlrev_b32 v112, 16, v113
    v_and_b32 v113, 0xffff0000, v113
    v_cvt_pk_bf16_f32 v121, v120, v121
    v_lshlrev_b32 v120, 16, v121
    v_and_b32 v121, 0xffff0000, v121
    v_mul_f32 v114, 0xbfb8aa3b, v112
    v_mul_f32 v115, 0xbfb8aa3b, v113
    v_exp_f32 v114, v114
    v_exp_f32 v115, v115
    v_add_f32 v114, 1.0, v114
    v_add_f32 v115, 1.0, v115
    v_rcp_f32 v114, v114
    v_rcp_f32 v115, v115
    v_mul_f32 v114, v114, v112
    v_mul_f32 v115, v115, v113
    v_cvt_pk_bf16_f32 v115, v114, v115
    v_lshlrev_b32 v114, 16, v115
    v_and_b32 v115, 0xffff0000, v115
    v_mul_f32 v114, v114, v120
    v_mul_f32 v115, v115, v121
    v_cvt_pk_bf16_f32 v114, v114, v115
    ds_write_b16 v6, v114
    ds_write_b16_d16_hi v6, v114 offset:128
    ds_read_b128 v[92:95], v7 offset:0
    ds_read_b128 v[96:99], v7 offset:64
    v_mov_b32 v101, s34
    v_mov_b32 v103, s34
    s_waitcnt vmcnt(0)
    ds_read_b64_tr_b16 v[28:29], v14 offset:4096
    ds_read_b64_tr_b16 v[30:31], v14 offset:4608
    ds_read_b64_tr_b16 v[32:33], v15 offset:4096
    ds_read_b64_tr_b16 v[34:35], v15 offset:4608
    ds_read_b64_tr_b16 v[36:37], v16 offset:4096
    ds_read_b64_tr_b16 v[38:39], v16 offset:4608
    ds_read_b64_tr_b16 v[40:41], v17 offset:4096
    ds_read_b64_tr_b16 v[42:43], v17 offset:4608
    ds_read_b64_tr_b16 v[44:45], v14 offset:8192
    ds_read_b64_tr_b16 v[46:47], v14 offset:8704
    ds_read_b64_tr_b16 v[48:49], v15 offset:8192
    ds_read_b64_tr_b16 v[50:51], v15 offset:8704
    ds_read_b64_tr_b16 v[52:53], v16 offset:8192
    ds_read_b64_tr_b16 v[54:55], v16 offset:8704
    ds_read_b64_tr_b16 v[56:57], v17 offset:8192
    ds_read_b64_tr_b16 v[58:59], v17 offset:8704
    s_waitcnt lgkmcnt(0)
    v_mfma_f32_16x16x32_bf16 v[112:115], v[92:95], v[28:31], 0
    v_mfma_f32_16x16x32_bf16 v[116:119], v[92:95], v[32:35], 0
    v_mfma_f32_16x16x32_bf16 v[120:123], v[92:95], v[36:39], 0
    v_mfma_f32_16x16x32_bf16 v[124:127], v[92:95], v[40:43], 0
    v_mfma_f32_16x16x32_bf16 v[112:115], v[96:99], v[44:47], v[112:115]
    v_mfma_f32_16x16x32_bf16 v[116:119], v[96:99], v[48:51], v[116:119]
    v_mfma_f32_16x16x32_bf16 v[120:123], v[96:99], v[52:55], v[120:123]
    v_mfma_f32_16x16x32_bf16 v[124:127], v[96:99], v[56:59], v[124:127]
    s_nop 5
    v_cndmask_b32 v100, v112, v116, s[72:73]
    v_cndmask_b32 v100, v100, v120, s[74:75]
    v_cndmask_b32 v100, v100, v124, s[76:77]
    v_cndmask_b32 v102, v113, v117, s[72:73]
    v_cndmask_b32 v102, v102, v121, s[74:75]
    v_cndmask_b32 v102, v102, v125, s[76:77]
    buffer_store_dwordx4 v[100:103], v13, s[28:31], s37 offen sc1
    s_sub_u32 s36, s3, 4
    s_cmp_ge_u32 s36, 2
    s_cbranch_scc1 Laux_end
    s_add_u32 s37, s37, 4096
    ds_read_b64_tr_b16 v[60:61], v14 offset:12288
    ds_read_b64_tr_b16 v[62:63], v14 offset:12800
    ds_read_b64_tr_b16 v[64:65], v15 offset:12288
    ds_read_b64_tr_b16 v[66:67], v15 offset:12800
    ds_read_b64_tr_b16 v[68:69], v16 offset:12288
    ds_read_b64_tr_b16 v[70:71], v16 offset:12800
    ds_read_b64_tr_b16 v[72:73], v17 offset:12288
    ds_read_b64_tr_b16 v[74:75], v17 offset:12800
    ds_read_b64_tr_b16 v[76:77], v14 offset:0
    ds_read_b64_tr_b16 v[78:79], v14 offset:512
    ds_read_b64_tr_b16 v[80:81], v15 offset:0
    ds_read_b64_tr_b16 v[82:83], v15 offset:512
    ds_read_b64_tr_b16 v[84:85], v16 offset:0
    ds_read_b64_tr_b16 v[86:87], v16 offset:512
    ds_read_b64_tr_b16 v[88:89], v17 offset:0
    ds_read_b64_tr_b16 v[90:91], v17 offset:512
    s_waitcnt lgkmcnt(0)
    v_mfma_f32_16x16x32_bf16 v[112:115], v[92:95], v[60:63], 0
    v_mfma_f32_16x16x32_bf16 v[116:119], v[92:95], v[64:67], 0
    v_mfma_f32_16x16x32_bf16 v[120:123], v[92:95], v[68:71], 0
    v_mfma_f32_16x16x32_bf16 v[124:127], v[92:95], v[72:75], 0
    v_mfma_f32_16x16x32_bf16 v[112:115], v[96:99], v[76:79], v[112:115]
    v_mfma_f32_16x16x32_bf16 v[116:119], v[96:99], v[80:83], v[116:119]
    v_mfma_f32_16x16x32_bf16 v[120:123], v[96:99], v[84:87], v[120:123]
    v_mfma_f32_16x16x32_bf16 v[124:127], v[96:99], v[88:91], v[124:127]
    s_nop 5
    v_cndmask_b32 v100, v112, v116, s[72:73]
    v_cndmask_b32 v100, v100, v120, s[74:75]
    v_cndmask_b32 v100, v100, v124, s[76:77]
    v_cndmask_b32 v102, v113, v117, s[72:73]
    v_cndmask_b32 v102, v102, v121, s[74:75]
    v_cndmask_b32 v102, v102, v125, s[76:77]
    buffer_store_dwordx4 v[100:103], v13, s[28:31], s37 offen sc1
Laux_end:
    s_endpgm
Lmst:
    s_cmp_lg_u32 s3, 0
    s_cbranch_scc1 Lhelp_i
    s_waitcnt lgkmcnt(0)
    s_mov_b64 s[28:29], s[24:25]
    s_mov_b32 s30, 268435456
    s_mov_b32 s31, 0x20000
    s_load_dword s34, s[28:29], 0
    s_waitcnt lgkmcnt(0)
    s_add_u32 s34, s34, 0x9e3779b8
    s_or_b32 s34, s34, 1
    s_mov_b64 exec, 1
    s_lshl_b32 s36, s2, 2
    s_add_u32 s36, s36, 8323072
    v_mov_b32 v4, s34
    v_mov_b32 v5, s36
    buffer_store_dword v4, v5, s[28:31], 0 offen sc1
    s_mov_b64 exec, -1
    s_cmp_lg_u32 s32, 32
    s_cbranch_scc1 Lend
Lmst_bc:
    v_and_b32 v4, 31, v1
    v_lshlrev_b32 v4, 7, v4
    v_add_u32 v4, 8126464, v4
Lpt_15:
    s_sub_u32 s35, s35, 1
    s_cbranch_scc1 Lend
    s_sleep 8
    buffer_load_dwordx4 v[8:11], v4, s[28:31], 0 offen sc1
    s_waitcnt vmcnt(0)
    v_cmp_ne_u32 vcc, s34, v9
    v_cmp_ne_u32 s[36:37], s34, v11
    s_nop 0
    s_or_b64 s[36:37], s[36:37], vcc
    s_cbranch_scc1 Lpt_15
    v_mov_b32 v4, v8
    s_nop 1
    v_max_u32_dpp v4, v4, v4 row_ror:8 row_mask:0xf bank_mask:0xf
    s_nop 1
    v_max_u32_dpp v4, v4, v4 row_ror:4 row_mask:0xf bank_mask:0xf
    s_nop 1
    v_max_u32_dpp v4, v4, v4 row_ror:2 row_mask:0xf bank_mask:0xf
    s_nop 1
    v_max_u32_dpp v4, v4, v4 row_ror:1 row_mask:0xf bank_mask:0xf
    s_nop 0
    v_readlane_b32 s40, v4, 0
    v_readlane_b32 s36, v4, 16
    v_readlane_b32 s37, v4, 32
    v_readlane_b32 s38, v4, 48
    s_max_u32 s40, s40, s36
    s_max_u32 s37, s37, s38
    s_max_u32 s40, s40, s37
    v_cmp_eq_u32 vcc, s40, v8
    s_nop 1
    v_cndmask_b32 v4, v8, v10, vcc
    s_nop 1
    v_max_u32_dpp v4, v4, v4 row_ror:8 row_mask:0xf bank_mask:0xf
    s_nop 1
    v_max_u32_dpp v4, v4, v4 row_ror:4 row_mask:0xf bank_mask:0xf
    s_nop 1
    v_max_u32_dpp v4, v4, v4 row_ror:2 row_mask:0xf bank_mask:0xf
    s_nop 1
    v_max_u32_dpp v4, v4, v4 row_ror:1 row_mask:0xf bank_mask:0xf
    s_nop 0
    v_readlane_b32 s41, v4, 0
    v_readlane_b32 s36, v4, 16
    v_readlane_b32 s37, v4, 32
    v_readlane_b32 s38, v4, 48
    s_max_u32 s41, s41, s36
    s_max_u32 s37, s37, s38
    s_max_u32 s41, s41, s37
    v_mov_b32 v8, s40
    v_mov_b32 v9, s34
    v_mov_b32 v10, s41
    v_mov_b32 v11, s34
    s_mov_b32 s36, 8257536
    buffer_store_dwordx4 v[8:11], v13, s[28:31], s36 offen offset:0 sc1
    buffer_store_dwordx4 v[8:11], v13, s[28:31], s36 offen offset:1024 sc1
    buffer_store_dwordx4 v[8:11], v13, s[28:31], s36 offen offset:2048 sc1
    s_mov_b32 s36, 8323072
Lmaster:
    s_sub_u32 s35, s35, 1
    s_cbranch_scc1 Lend
    s_sleep 16
    buffer_load_dwordx4 v[4:7], v13, s[28:31], s36 offen sc1
    s_waitcnt vmcnt(0)
    v_xor_b32 v4, s34, v4
    v_xor_b32 v5, s34, v5
    v_xor_b32 v6, s34, v6
    v_xor_b32 v7, s34, v7
    v_or3_b32 v4, v4, v5, v6
    v_or_b32 v4, v4, v7
    v_cmp_ne_u32 vcc, 0, v4
    s_nop 0
    s_cbranch_vccnz Lmaster
    s_mov_b64 exec, 1
    buffer_store_dword v9, v4, s[28:31], 0 offen sc1
    s_endpgm
Lhelp_r:
    s_add_u32 s72, s32, 0
    s_mov_b32 s73, 5
    s_mov_b32 s37, 4
    s_branch Lhelp
Lhelp_i:
    s_cmp_eq_u32 s32, 32
    s_cbranch_scc1 Lend
    s_cmp_eq_u32 s27, 0
    s_cbranch_scc1 Lend
    s_sub_u32 s72, s32, 33
    s_mov_b32 s73, 3
    s_mov_b32 s37, 9
Lhelp:
    s_lshl_b32 s38, s26, 6
    v_add_u32 v4, s38, v1
    v_mul_u32_u24 v4, 1280, v4
    s_waitcnt lgkmcnt(0)
    s_mov_b64 s[68:69], s[18:19]
    s_mov_b32 s70, 2211840
    s_mov_b32 s71, 0x20000
Lhelp2:
    s_mul_i32 s38, s72, 9363
    s_lshr_b32 s38, s38, 16
    s_mul_i32 s39, s38, 7
    s_sub_u32 s39, s72, s39
    s_mul_i32 s39, s39, 327680
    s_lshl_b32 s38, s38, 7
    s_sub_u32 s39, s39, s38
    s_add_u32 s39, s39, 1152
    v_add_u32 v6, s39, v4
    buffer_load_dword v5, v6, s[68:71], 0 offen
    s_add_u32 s72, s72, s73
    s_sub_u32 s37, s37, 1
    s_cmp_lg_u32 s37, 0
    s_cbranch_scc1 Lhelp2
Lend:
    s_endpgm
.section .rodata,"a"
.p2align 6
.amdhsa_kernel recurrent_scan__sliding_local_dilated__moe_arch_mod__prompt_kernel
  .amdhsa_next_free_vgpr 256
  .amdhsa_next_free_sgpr 102
  .amdhsa_accum_offset 128
  .amdhsa_group_segment_fixed_size 0
  .amdhsa_kernarg_size 88
  .amdhsa_user_sgpr_count 2
  .amdhsa_user_sgpr_kernarg_segment_ptr 1
  .amdhsa_system_sgpr_workgroup_id_x 1
  .amdhsa_float_denorm_mode_32 3
.end_amdhsa_kernel
```

```asm
; @launch grid=(256,1,1) block=(512,1,1) lds=163840
.amdgcn_target "amdgcn-amd-amdhsa--gfx950"
.text
.globl recurrent_scan__sliding_local_dilated__moe_arch_mod__prompt_kernel
.p2align 8
.type recurrent_scan__sliding_local_dilated__moe_arch_mod__prompt_kernel,@function
recurrent_scan__sliding_local_dilated__moe_arch_mod__prompt_kernel:
    s_load_dwordx16 s[4:19], s[0:1], 0
    s_load_dwordx4 s[20:23], s[0:1], 64
    s_load_dwordx2 s[24:25], s[0:1], 80
    v_lshrrev_b32 v4, 6, v0
    v_and_b32 v1, 63, v0
    s_cmp_ge_u32 s2, 256
    s_cbranch_scc1 Lend
    v_readfirstlane_b32 s3, v4
    s_getpc_b64 s[36:37]
Lpc:
    s_and_b32 s38, s2, 0xf8
    v_add_u32 v5, s38, v4
    v_and_b32 v6, 1, v0
    v_lshl_add_u32 v5, v5, 1, v6
    v_lshlrev_b32 v5, 7, v5
    v_min_u32 v5, Lend-Lpc, v5
    v_mov_b32 v7, s37
    v_add_co_u32 v6, vcc, s36, v5
    s_nop 1
    v_addc_co_u32 v7, vcc, 0, v7, vcc
    global_load_dword v0, v[6:7], off
    v_lshrrev_b32 v2, 4, v1
    v_and_b32 v3, 15, v1
    v_lshlrev_b32 v12, 2, v1
    v_lshlrev_b32 v13, 4, v1
    s_mov_b32 s35, 2000000
    s_and_b32 s36, s2, 7
    s_lshr_b32 s37, s2, 3
    s_and_b32 s38, s36, 1
    s_lshr_b32 s36, s36, 1
    s_add_u32 s39, s38, 4
    s_and_b32 s26, s3, 3
    s_lshr_b32 s27, s3, 2
    s_cmp_lt_u32 s37, s39
    s_cbranch_scc1 Laux
    s_lshr_b32 s33, s36, 1
    s_and_b32 s36, s36, 1
    s_mul_i32 s36, s36, 55
    s_mul_i32 s38, s38, 28
    s_add_u32 s36, s36, s38
    s_add_u32 s36, s36, s37
    s_sub_u32 s36, s36, s39
    s_mul_i32 s32, s36, 13108
    s_lshr_b32 s32, s32, 16
    s_mul_i32 s37, s32, 5
    s_sub_u32 s36, s36, s37
    s_mul_i32 s33, s33, 5
    s_add_u32 s33, s33, s36
    s_add_u32 s42, s33, s32
    s_mul_i32 s36, s42, 13108
    s_lshr_b32 s36, s36, 16
    s_mul_i32 s36, s36, 5
    s_sub_u32 s42, s42, s36
    s_cmp_lg_u32 s3, 0
    s_cbranch_scc1 Lcomp
Lloader:
    s_setprio 3
    v_lshrrev_b32 v5, 3, v1
    v_and_b32 v6, 7, v1
    v_and_b32 v8, 1, v2
    v_lshlrev_b32 v8, 1, v8
    v_xor_b32 v8, v8, v6
    s_lshl_b32 s39, s33, 7
    v_lshl_add_u32 v50, v8, 4, s39
    v_mov_b32 v7, 3840
    v_mad_u32_u24 v28, v5, v7, v50
    v_xor_b32 v29, 64, v28
    v_add_u32 v29, 29696, v29
    v_add_u32 v30, 59392, v28
    v_add_u32 v31, 59392, v29
    v_add_u32 v32, 122880, v28
    v_add_u32 v33, 122880, v29
    v_add_u32 v34, 182272, v28
    v_add_u32 v35, 182272, v29
    s_lshl_b32 s78, s42, 2
    s_lshr_b32 s78, 0x86420, s78
    s_and_b32 s78, s78, 15
    s_mul_i32 s68, s78, 245760
    s_lshl_b32 s43, s78, 7
    s_mul_i32 s38, s32, 96
    s_sub_u32 s38, s38, 16
    v_add_u32 v7, s38, v5
    v_xor_b32 v9, v6, v2
    v_lshlrev_b32 v9, 4, v9
    v_xor_b32 v10, 64, v9
    v_mov_b32 v11, 2047
    v_mov_b32 v8, 1280
    v_add_u32 v36, 0, v7
    v_med3_i32 v36, v36, 0, v11
    v_mad_u32_u24 v36, v36, v8, v9
    v_add_u32 v36, 4096, v36
    v_add_u32 v37, 8, v7
    v_med3_i32 v37, v37, 0, v11
    v_mad_u32_u24 v37, v37, v8, v10
    v_add_u32 v37, 3072, v37
    v_add_u32 v38, 16, v7
    v_med3_i32 v38, v38, 0, v11
    v_mad_u32_u24 v38, v38, v8, v9
    v_add_u32 v38, 2048, v38
    v_add_u32 v39, 24, v7
    v_med3_i32 v39, v39, 0, v11
    v_mad_u32_u24 v39, v39, v8, v10
    v_add_u32 v39, 1024, v39
    s_waitcnt lgkmcnt(0)
    s_mov_b64 s[48:49], s[6:7]
    s_mov_b32 s50, 2457600
    s_mov_b32 s51, 0x20000
    s_add_u32 s52, s6, 1280
    s_addc_u32 s53, s7, 0
    s_mov_b32 s54, 2456320
    s_mov_b32 s55, 0x20000
    s_add_u32 s56, s6, 2560
    s_addc_u32 s57, s7, 0
    s_mov_b32 s58, 2455040
    s_mov_b32 s59, 0x20000
    s_mov_b32 m0, 0
    v_add_u32 v40, 32, v7
    v_med3_i32 v40, v40, 0, v11
    buffer_load_dwordx4 v28, s[48:51], s68 offen lds
    v_mad_u32_u24 v40, v40, v8, v9
    buffer_load_dwordx4 v29, s[48:51], s68 offen offset:1024 lds
    v_add_u32 v40, 4096, v40
    v_add_u32 v41, 40, v7
    buffer_load_dwordx4 v30, s[48:51], s68 offen offset:2048 lds
    v_med3_i32 v41, v41, 0, v11
    buffer_load_dwordx4 v31, s[48:51], s68 offen offset:3072 lds
    v_mad_u32_u24 v41, v41, v8, v10
    s_mov_b32 m0, 8192
    v_add_u32 v41, 3072, v41
    v_add_u32 v42, 48, v7
    buffer_load_dwordx4 v28, s[52:55], s68 offen lds
    v_med3_i32 v42, v42, 0, v11
    buffer_load_dwordx4 v29, s[52:55], s68 offen offset:1024 lds
    v_mad_u32_u24 v42, v42, v8, v9
    buffer_load_dwordx4 v30, s[52:55], s68 offen offset:2048 lds
    v_add_u32 v42, 2048, v42
    v_add_u32 v43, 56, v7
    buffer_load_dwordx4 v31, s[52:55], s68 offen offset:3072 lds
    v_med3_i32 v43, v43, 0, v11
    s_mov_b32 m0, 16384
    v_mad_u32_u24 v43, v43, v8, v10
    v_add_u32 v43, 1024, v43
    buffer_load_dwordx4 v28, s[56:59], s68 offen lds
    v_add_u32 v44, 64, v7
    buffer_load_dwordx4 v29, s[56:59], s68 offen offset:1024 lds
    v_med3_i32 v44, v44, 0, v11
    buffer_load_dwordx4 v30, s[56:59], s68 offen offset:2048 lds
    v_mad_u32_u24 v44, v44, v8, v9
    v_add_u32 v44, 4096, v44
    buffer_load_dwordx4 v31, s[56:59], s68 offen offset:3072 lds
    v_add_u32 v45, 72, v7
    s_mov_b32 m0, 4096
    v_med3_i32 v45, v45, 0, v11
    buffer_load_dwordx4 v32, s[48:51], s68 offen lds
    v_mad_u32_u24 v45, v45, v8, v10
    v_add_u32 v45, 3072, v45
    buffer_load_dwordx4 v33, s[48:51], s68 offen offset:1024 lds
    v_add_u32 v46, 80, v7
    buffer_load_dwordx4 v34, s[48:51], s68 offen offset:2048 lds
    v_med3_i32 v46, v46, 0, v11
    buffer_load_dwordx4 v35, s[48:51], s68 offen offset:3072 lds
    v_mad_u32_u24 v46, v46, v8, v9
    v_add_u32 v46, 2048, v46
    s_mov_b32 m0, 12288
    v_add_u32 v47, 88, v7
    buffer_load_dwordx4 v32, s[52:55], s68 offen lds
    v_med3_i32 v47, v47, 0, v11
    v_mad_u32_u24 v47, v47, v8, v10
    buffer_load_dwordx4 v33, s[52:55], s68 offen offset:1024 lds
    v_add_u32 v47, 1024, v47
    buffer_load_dwordx4 v34, s[52:55], s68 offen offset:2048 lds
    v_add_u32 v48, 96, v7
    buffer_load_dwordx4 v35, s[52:55], s68 offen offset:3072 lds
    v_med3_i32 v48, v48, 0, v11
    v_mad_u32_u24 v48, v48, v8, v9
    s_mov_b32 m0, 20480
    v_add_u32 v48, 4096, v48
    buffer_load_dwordx4 v32, s[56:59], s68 offen lds
    v_add_u32 v49, 104, v7
    buffer_load_dwordx4 v33, s[56:59], s68 offen offset:1024 lds
    v_med3_i32 v49, v49, 0, v11
    v_mad_u32_u24 v49, v49, v8, v10
    buffer_load_dwordx4 v34, s[56:59], s68 offen offset:2048 lds
    v_add_u32 v49, 3072, v49
    buffer_load_dwordx4 v35, s[56:59], s68 offen offset:3072 lds
    s_sub_u32 s44, s4, 4096
    s_subb_u32 s45, s5, 0
    s_mov_b32 s46, 2625536
    s_mov_b32 s47, 0x20000
    s_mov_b32 m0, 24576
    s_nop 0
    buffer_load_dwordx4 v36, s[44:47], s43 offen lds
    buffer_load_dwordx4 v37, s[44:47], s43 offen offset:1024 lds
    buffer_load_dwordx4 v38, s[44:47], s43 offen offset:2048 lds
    buffer_load_dwordx4 v39, s[44:47], s43 offen offset:3072 lds
    s_mov_b32 m0, 28672
    s_nop 0
    buffer_load_dwordx4 v40, s[44:47], s43 offen lds
    buffer_load_dwordx4 v41, s[44:47], s43 offen offset:1024 lds
    buffer_load_dwordx4 v42, s[44:47], s43 offen offset:2048 lds
    buffer_load_dwordx4 v43, s[44:47], s43 offen offset:3072 lds
    s_mov_b32 m0, 32768
    s_nop 0
    buffer_load_dwordx4 v44, s[44:47], s43 offen lds
    buffer_load_dwordx4 v45, s[44:47], s43 offen offset:1024 lds
    buffer_load_dwordx4 v46, s[44:47], s43 offen offset:2048 lds
    buffer_load_dwordx4 v47, s[44:47], s43 offen offset:3072 lds
    s_mov_b32 m0, 36864
    s_nop 0
    buffer_load_dwordx4 v48, s[44:47], s43 offen lds
    buffer_load_dwordx4 v49, s[44:47], s43 offen offset:1024 lds
    s_mov_b32 s80, 0x53864210
    s_mov_b32 s81, 0x97
    s_cmp_eq_u32 s42, 1
    s_cselect_b32 s80, 0x51086342, s80
    s_cselect_b32 s81, 0x97, s81
    s_cmp_eq_u32 s42, 2
    s_cselect_b32 s80, 0x31205864, s80
    s_cselect_b32 s81, 0x97, s81
    s_cmp_eq_u32 s42, 3
    s_cselect_b32 s80, 0x31472086, s80
    s_cselect_b32 s81, 0x95, s81
    s_cmp_eq_u32 s42, 4
    s_cselect_b32 s80, 0x31964208, s80
    s_cselect_b32 s81, 0x75, s81
    s_lshr_b64 s[80:81], s[80:81], 4
    s_and_b32 s78, s80, 15
    s_mov_b64 s[28:29], s[24:25]
    s_mov_b32 s30, 268435456
    s_mov_b32 s31, 0x20000
    s_load_dword s34, s[28:29], 0
    s_mov_b64 s[60:61], s[8:9]
    s_mov_b32 s62, 819200
    s_mov_b32 s63, 0x20000
    s_mov_b64 s[64:65], s[20:21]
    s_mov_b32 s66, 2621440
    s_mov_b32 s67, 0x20000
    v_mov_b32 v51, 157984
    v_and_b32 v66, 7, v1
    v_max_u32 v66, 1, v66
    v_lshlrev_b32 v66, 2, v66
    v_add_u32 v66, 158016, v66
    s_mul_i32 s69, s78, 245760
    s_lshl_b32 s43, s78, 7
    s_mov_b32 m0, 63616
    s_nop 0
    buffer_load_dwordx4 v36, s[44:47], s43 offen lds
    buffer_load_dwordx4 v37, s[44:47], s43 offen offset:1024 lds
    buffer_load_dwordx4 v38, s[44:47], s43 offen offset:2048 lds
    buffer_load_dwordx4 v39, s[44:47], s43 offen offset:3072 lds
    s_mov_b32 m0, 39040
    s_nop 0
    buffer_load_dwordx4 v28, s[48:51], s69 offen lds
    buffer_load_dwordx4 v29, s[48:51], s69 offen offset:1024 lds
    buffer_load_dwordx4 v30, s[48:51], s69 offen offset:2048 lds
    buffer_load_dwordx4 v31, s[48:51], s69 offen offset:3072 lds
    s_mov_b32 m0, 67712
    s_nop 0
    buffer_load_dwordx4 v40, s[44:47], s43 offen lds
    buffer_load_dwordx4 v41, s[44:47], s43 offen offset:1024 lds
    buffer_load_dwordx4 v42, s[44:47], s43 offen offset:2048 lds
    buffer_load_dwordx4 v43, s[44:47], s43 offen offset:3072 lds
    s_mov_b32 m0, 47232
    s_nop 0
    buffer_load_dwordx4 v28, s[52:55], s69 offen lds
    buffer_load_dwordx4 v29, s[52:55], s69 offen offset:1024 lds
    buffer_load_dwordx4 v30, s[52:55], s69 offen offset:2048 lds
    buffer_load_dwordx4 v31, s[52:55], s69 offen offset:3072 lds
    s_mov_b32 m0, 71808
    s_nop 0
    buffer_load_dwordx4 v44, s[44:47], s43 offen lds
    buffer_load_dwordx4 v45, s[44:47], s43 offen offset:1024 lds
    buffer_load_dwordx4 v46, s[44:47], s43 offen offset:2048 lds
    buffer_load_dwordx4 v47, s[44:47], s43 offen offset:3072 lds
    s_mov_b32 m0, 55424
    s_nop 0
    buffer_load_dwordx4 v28, s[56:59], s69 offen lds
    buffer_load_dwordx4 v29, s[56:59], s69 offen offset:1024 lds
    buffer_load_dwordx4 v30, s[56:59], s69 offen offset:2048 lds
    buffer_load_dwordx4 v31, s[56:59], s69 offen offset:3072 lds
    s_mov_b32 m0, 75904
    s_nop 0
    buffer_load_dwordx4 v48, s[44:47], s43 offen lds
    s_waitcnt vmcnt(55)
    buffer_load_dwordx4 v49, s[44:47], s43 offen offset:1024 lds
    s_mov_b32 m0, 43136
    s_nop 0
    buffer_load_dwordx4 v32, s[48:51], s69 offen lds
    buffer_load_dwordx4 v33, s[48:51], s69 offen offset:1024 lds
    buffer_load_dwordx4 v34, s[48:51], s69 offen offset:2048 lds
    buffer_load_dwordx4 v35, s[48:51], s69 offen offset:3072 lds
    s_mov_b32 m0, 51328
    s_nop 0
    buffer_load_dwordx4 v32, s[52:55], s69 offen lds
    buffer_load_dwordx4 v33, s[52:55], s69 offen offset:1024 lds
    buffer_load_dwordx4 v34, s[52:55], s69 offen offset:2048 lds
    s_waitcnt vmcnt(55)
    buffer_load_dwordx4 v35, s[52:55], s69 offen offset:3072 lds
    s_mov_b32 m0, 59520
    s_nop 0
    buffer_load_dwordx4 v32, s[56:59], s69 offen lds
    buffer_load_dwordx4 v33, s[56:59], s69 offen offset:1024 lds
    buffer_load_dwordx4 v34, s[56:59], s69 offen offset:2048 lds
    buffer_load_dwordx4 v35, s[56:59], s69 offen offset:3072 lds
    s_waitcnt vmcnt(38) lgkmcnt(0)
    s_barrier
    s_add_u32 s34, s34, 0x9e3779b8
    s_or_b32 s34, s34, 1
    s_lshr_b64 s[80:81], s[80:81], 4
    s_and_b32 s78, s80, 15
    s_mul_i32 s70, s78, 245760
    s_lshl_b32 s43, s78, 7
    s_mov_b32 m0, 102656
    s_nop 0
    buffer_load_dwordx4 v36, s[44:47], s43 offen lds
    buffer_load_dwordx4 v37, s[44:47], s43 offen offset:1024 lds
    buffer_load_dwordx4 v38, s[44:47], s43 offen offset:2048 lds
    buffer_load_dwordx4 v39, s[44:47], s43 offen offset:3072 lds
    s_mov_b32 m0, 78080
    s_nop 0
    buffer_load_dwordx4 v28, s[48:51], s70 offen lds
    buffer_load_dwordx4 v29, s[48:51], s70 offen offset:1024 lds
    buffer_load_dwordx4 v30, s[48:51], s70 offen offset:2048 lds
    buffer_load_dwordx4 v31, s[48:51], s70 offen offset:3072 lds
    s_mov_b32 m0, 106752
    s_nop 0
    buffer_load_dwordx4 v40, s[44:47], s43 offen lds
    buffer_load_dwordx4 v41, s[44:47], s43 offen offset:1024 lds
    buffer_load_dwordx4 v42, s[44:47], s43 offen offset:2048 lds
    buffer_load_dwordx4 v43, s[44:47], s43 offen offset:3072 lds
    s_mov_b32 m0, 86272
    s_nop 0
    buffer_load_dwordx4 v28, s[52:55], s70 offen lds
    buffer_load_dwordx4 v29, s[52:55], s70 offen offset:1024 lds
    buffer_load_dwordx4 v30, s[52:55], s70 offen offset:2048 lds
    buffer_load_dwordx4 v31, s[52:55], s70 offen offset:3072 lds
    s_mov_b32 m0, 110848
    s_nop 0
    buffer_load_dwordx4 v44, s[44:47], s43 offen lds
    buffer_load_dwordx4 v45, s[44:47], s43 offen offset:1024 lds
    buffer_load_dwordx4 v46, s[44:47], s43 offen offset:2048 lds
    buffer_load_dwordx4 v47, s[44:47], s43 offen offset:3072 lds
    s_mov_b32 m0, 94464
    s_nop 0
    buffer_load_dwordx4 v28, s[56:59], s70 offen lds
    buffer_load_dwordx4 v29, s[56:59], s70 offen offset:1024 lds
    buffer_load_dwordx4 v30, s[56:59], s70 offen offset:2048 lds
    buffer_load_dwordx4 v31, s[56:59], s70 offen offset:3072 lds
    s_mov_b32 m0, 114944
    s_nop 0
    buffer_load_dwordx4 v48, s[44:47], s43 offen lds
    s_waitcnt vmcnt(55)
    buffer_load_dwordx4 v49, s[44:47], s43 offen offset:1024 lds
    s_mov_b32 m0, 82176
    s_nop 0
    buffer_load_dwordx4 v32, s[48:51], s70 offen lds
    buffer_load_dwordx4 v33, s[48:51], s70 offen offset:1024 lds
    buffer_load_dwordx4 v34, s[48:51], s70 offen offset:2048 lds
    buffer_load_dwordx4 v35, s[48:51], s70 offen offset:3072 lds
    s_mov_b32 m0, 90368
    s_nop 0
    buffer_load_dwordx4 v32, s[52:55], s70 offen lds
    buffer_load_dwordx4 v33, s[52:55], s70 offen offset:1024 lds
    buffer_load_dwordx4 v34, s[52:55], s70 offen offset:2048 lds
    s_waitcnt vmcnt(55)
    buffer_load_dwordx4 v35, s[52:55], s70 offen offset:3072 lds
    s_mov_b32 m0, 98560
    s_nop 0
    buffer_load_dwordx4 v32, s[56:59], s70 offen lds
    buffer_load_dwordx4 v33, s[56:59], s70 offen offset:1024 lds
    buffer_load_dwordx4 v34, s[56:59], s70 offen offset:2048 lds
    buffer_load_dwordx4 v35, s[56:59], s70 offen offset:3072 lds
    s_waitcnt vmcnt(38) lgkmcnt(0)
    s_barrier
    s_lshr_b64 s[80:81], s[80:81], 4
    s_and_b32 s78, s80, 15
    s_mul_i32 s71, s78, 245760
    s_lshl_b32 s43, s78, 7
    s_mov_b32 m0, 141696
    s_nop 0
    buffer_load_dwordx4 v36, s[44:47], s43 offen lds
    buffer_load_dwordx4 v37, s[44:47], s43 offen offset:1024 lds
    buffer_load_dwordx4 v38, s[44:47], s43 offen offset:2048 lds
    buffer_load_dwordx4 v39, s[44:47], s43 offen offset:3072 lds
    s_mov_b32 m0, 117120
    s_nop 0
    buffer_load_dwordx4 v28, s[48:51], s71 offen lds
    buffer_load_dwordx4 v29, s[48:51], s71 offen offset:1024 lds
    buffer_load_dwordx4 v30, s[48:51], s71 offen offset:2048 lds
    buffer_load_dwordx4 v31, s[48:51], s71 offen offset:3072 lds
    s_mov_b32 m0, 145792
    s_nop 0
    buffer_load_dwordx4 v40, s[44:47], s43 offen lds
    buffer_load_dwordx4 v41, s[44:47], s43 offen offset:1024 lds
    buffer_load_dwordx4 v42, s[44:47], s43 offen offset:2048 lds
    buffer_load_dwordx4 v43, s[44:47], s43 offen offset:3072 lds
    s_mov_b32 m0, 125312
    s_nop 0
    buffer_load_dwordx4 v28, s[52:55], s71 offen lds
    buffer_load_dwordx4 v29, s[52:55], s71 offen offset:1024 lds
    buffer_load_dwordx4 v30, s[52:55], s71 offen offset:2048 lds
    buffer_load_dwordx4 v31, s[52:55], s71 offen offset:3072 lds
    s_mov_b32 m0, 149888
    s_nop 0
    buffer_load_dwordx4 v44, s[44:47], s43 offen lds
    buffer_load_dwordx4 v45, s[44:47], s43 offen offset:1024 lds
    buffer_load_dwordx4 v46, s[44:47], s43 offen offset:2048 lds
    buffer_load_dwordx4 v47, s[44:47], s43 offen offset:3072 lds
    s_mov_b32 m0, 133504
    s_nop 0
    buffer_load_dwordx4 v28, s[56:59], s71 offen lds
    buffer_load_dwordx4 v29, s[56:59], s71 offen offset:1024 lds
    buffer_load_dwordx4 v30, s[56:59], s71 offen offset:2048 lds
    buffer_load_dwordx4 v31, s[56:59], s71 offen offset:3072 lds
    s_mov_b32 m0, 153984
    s_nop 0
    buffer_load_dwordx4 v48, s[44:47], s43 offen lds
    s_waitcnt vmcnt(55)
    buffer_load_dwordx4 v49, s[44:47], s43 offen offset:1024 lds
    s_mov_b32 m0, 121216
    s_nop 0
    buffer_load_dwordx4 v32, s[48:51], s71 offen lds
    buffer_load_dwordx4 v33, s[48:51], s71 offen offset:1024 lds
    buffer_load_dwordx4 v34, s[48:51], s71 offen offset:2048 lds
    buffer_load_dwordx4 v35, s[48:51], s71 offen offset:3072 lds
    s_mov_b32 m0, 129408
    s_nop 0
    buffer_load_dwordx4 v32, s[52:55], s71 offen lds
    buffer_load_dwordx4 v33, s[52:55], s71 offen offset:1024 lds
    buffer_load_dwordx4 v34, s[52:55], s71 offen offset:2048 lds
    s_waitcnt vmcnt(55)
    buffer_load_dwordx4 v35, s[52:55], s71 offen offset:3072 lds
    s_mov_b32 m0, 137600
    s_nop 0
    buffer_load_dwordx4 v32, s[56:59], s71 offen lds
    buffer_load_dwordx4 v33, s[56:59], s71 offen offset:1024 lds
    buffer_load_dwordx4 v34, s[56:59], s71 offen offset:2048 lds
    buffer_load_dwordx4 v35, s[56:59], s71 offen offset:3072 lds
    s_waitcnt vmcnt(38) lgkmcnt(0)
    s_barrier
    s_lshr_b64 s[80:81], s[80:81], 4
    s_and_b32 s78, s80, 15
    s_mul_i32 s72, s78, 245760
    s_lshl_b32 s43, s78, 7
    s_mov_b32 m0, 24576
    s_nop 0
    buffer_load_dwordx4 v36, s[44:47], s43 offen lds
    buffer_load_dwordx4 v37, s[44:47], s43 offen offset:1024 lds
    buffer_load_dwordx4 v38, s[44:47], s43 offen offset:2048 lds
    buffer_load_dwordx4 v39, s[44:47], s43 offen offset:3072 lds
    s_mov_b32 m0, 0
    s_nop 0
    buffer_load_dwordx4 v28, s[48:51], s72 offen lds
    buffer_load_dwordx4 v29, s[48:51], s72 offen offset:1024 lds
    buffer_load_dwordx4 v30, s[48:51], s72 offen offset:2048 lds
    buffer_load_dwordx4 v31, s[48:51], s72 offen offset:3072 lds
    s_mov_b32 m0, 28672
    s_nop 0
    buffer_load_dwordx4 v40, s[44:47], s43 offen lds
    buffer_load_dwordx4 v41, s[44:47], s43 offen offset:1024 lds
    buffer_load_dwordx4 v42, s[44:47], s43 offen offset:2048 lds
    buffer_load_dwordx4 v43, s[44:47], s43 offen offset:3072 lds
    s_mov_b32 m0, 8192
    s_nop 0
    buffer_load_dwordx4 v28, s[52:55], s72 offen lds
    buffer_load_dwordx4 v29, s[52:55], s72 offen offset:1024 lds
    buffer_load_dwordx4 v30, s[52:55], s72 offen offset:2048 lds
    buffer_load_dwordx4 v31, s[52:55], s72 offen offset:3072 lds
    s_mov_b32 m0, 32768
    s_nop 0
    buffer_load_dwordx4 v44, s[44:47], s43 offen lds
    buffer_load_dwordx4 v45, s[44:47], s43 offen offset:1024 lds
    buffer_load_dwordx4 v46, s[44:47], s43 offen offset:2048 lds
    buffer_load_dwordx4 v47, s[44:47], s43 offen offset:3072 lds
    s_mov_b32 m0, 16384
    s_nop 0
    buffer_load_dwordx4 v28, s[56:59], s72 offen lds
    buffer_load_dwordx4 v29, s[56:59], s72 offen offset:1024 lds
    buffer_load_dwordx4 v30, s[56:59], s72 offen offset:2048 lds
    buffer_load_dwordx4 v31, s[56:59], s72 offen offset:3072 lds
    s_mov_b32 m0, 36864
    s_nop 0
    buffer_load_dwordx4 v48, s[44:47], s43 offen lds
    s_waitcnt vmcnt(55)
    buffer_load_dwordx4 v49, s[44:47], s43 offen offset:1024 lds
    s_mov_b32 m0, 4096
    s_nop 0
    buffer_load_dwordx4 v32, s[48:51], s72 offen lds
    buffer_load_dwordx4 v33, s[48:51], s72 offen offset:1024 lds
    buffer_load_dwordx4 v34, s[48:51], s72 offen offset:2048 lds
    buffer_load_dwordx4 v35, s[48:51], s72 offen offset:3072 lds
    s_mov_b32 m0, 12288
    s_nop 0
    buffer_load_dwordx4 v32, s[52:55], s72 offen lds
    buffer_load_dwordx4 v33, s[52:55], s72 offen offset:1024 lds
    buffer_load_dwordx4 v34, s[52:55], s72 offen offset:2048 lds
    s_waitcnt vmcnt(55)
    buffer_load_dwordx4 v35, s[52:55], s72 offen offset:3072 lds
    s_mov_b32 m0, 20480
    s_nop 0
    buffer_load_dwordx4 v32, s[56:59], s72 offen lds
    buffer_load_dwordx4 v33, s[56:59], s72 offen offset:1024 lds
    buffer_load_dwordx4 v34, s[56:59], s72 offen offset:2048 lds
    buffer_load_dwordx4 v35, s[56:59], s72 offen offset:3072 lds
    s_waitcnt vmcnt(38) lgkmcnt(0)
    s_barrier
    s_lshr_b64 s[80:81], s[80:81], 4
    s_and_b32 s78, s80, 15
    s_mul_i32 s73, s78, 245760
    s_lshl_b32 s43, s78, 7
    s_mov_b32 m0, 63616
    s_nop 0
    buffer_load_dwordx4 v36, s[44:47], s43 offen lds
    buffer_load_dwordx4 v37, s[44:47], s43 offen offset:1024 lds
    buffer_load_dwordx4 v38, s[44:47], s43 offen offset:2048 lds
    buffer_load_dwordx4 v39, s[44:47], s43 offen offset:3072 lds
    s_mov_b32 m0, 39040
    s_nop 0
    buffer_load_dwordx4 v28, s[48:51], s73 offen lds
    buffer_load_dwordx4 v29, s[48:51], s73 offen offset:1024 lds
    buffer_load_dwordx4 v30, s[48:51], s73 offen offset:2048 lds
    buffer_load_dwordx4 v31, s[48:51], s73 offen offset:3072 lds
    s_mov_b32 m0, 67712
    s_nop 0
    buffer_load_dwordx4 v40, s[44:47], s43 offen lds
    buffer_load_dwordx4 v41, s[44:47], s43 offen offset:1024 lds
    buffer_load_dwordx4 v42, s[44:47], s43 offen offset:2048 lds
    buffer_load_dwordx4 v43, s[44:47], s43 offen offset:3072 lds
    s_mov_b32 m0, 47232
    s_nop 0
    buffer_load_dwordx4 v28, s[52:55], s73 offen lds
    buffer_load_dwordx4 v29, s[52:55], s73 offen offset:1024 lds
    buffer_load_dwordx4 v30, s[52:55], s73 offen offset:2048 lds
    buffer_load_dwordx4 v31, s[52:55], s73 offen offset:3072 lds
    s_mov_b32 m0, 71808
    s_nop 0
    buffer_load_dwordx4 v44, s[44:47], s43 offen lds
    buffer_load_dwordx4 v45, s[44:47], s43 offen offset:1024 lds
    buffer_load_dwordx4 v46, s[44:47], s43 offen offset:2048 lds
    buffer_load_dwordx4 v47, s[44:47], s43 offen offset:3072 lds
    s_mov_b32 m0, 55424
    s_nop 0
    buffer_load_dwordx4 v28, s[56:59], s73 offen lds
    buffer_load_dwordx4 v29, s[56:59], s73 offen offset:1024 lds
    buffer_load_dwordx4 v30, s[56:59], s73 offen offset:2048 lds
    buffer_load_dwordx4 v31, s[56:59], s73 offen offset:3072 lds
    s_mov_b32 m0, 75904
    s_nop 0
    buffer_load_dwordx4 v48, s[44:47], s43 offen lds
    s_waitcnt vmcnt(55)
    buffer_load_dwordx4 v49, s[44:47], s43 offen offset:1024 lds
    s_mov_b32 m0, 43136
    s_nop 0
    buffer_load_dwordx4 v32, s[48:51], s73 offen lds
    buffer_load_dwordx4 v33, s[48:51], s73 offen offset:1024 lds
    buffer_load_dwordx4 v34, s[48:51], s73 offen offset:2048 lds
    buffer_load_dwordx4 v35, s[48:51], s73 offen offset:3072 lds
    s_mov_b32 m0, 51328
    s_nop 0
    buffer_load_dwordx4 v32, s[52:55], s73 offen lds
    buffer_load_dwordx4 v33, s[52:55], s73 offen offset:1024 lds
    buffer_load_dwordx4 v34, s[52:55], s73 offen offset:2048 lds
    s_waitcnt vmcnt(55)
    buffer_load_dwordx4 v35, s[52:55], s73 offen offset:3072 lds
    s_mov_b32 m0, 59520
    s_nop 0
    buffer_load_dwordx4 v32, s[56:59], s73 offen lds
    buffer_load_dwordx4 v33, s[56:59], s73 offen offset:1024 lds
    buffer_load_dwordx4 v34, s[56:59], s73 offen offset:2048 lds
    buffer_load_dwordx4 v35, s[56:59], s73 offen offset:3072 lds
    s_waitcnt vmcnt(38) lgkmcnt(0)
    s_barrier
    s_lshr_b64 s[80:81], s[80:81], 4
    s_and_b32 s78, s80, 15
    s_mul_i32 s74, s78, 245760
    s_lshl_b32 s43, s78, 7
    s_mov_b32 m0, 102656
    s_nop 0
    buffer_load_dwordx4 v36, s[44:47], s43 offen lds
    buffer_load_dwordx4 v37, s[44:47], s43 offen offset:1024 lds
    buffer_load_dwordx4 v38, s[44:47], s43 offen offset:2048 lds
    buffer_load_dwordx4 v39, s[44:47], s43 offen offset:3072 lds
    s_mov_b32 m0, 78080
    s_nop 0
    buffer_load_dwordx4 v28, s[48:51], s74 offen lds
    buffer_load_dwordx4 v29, s[48:51], s74 offen offset:1024 lds
    buffer_load_dwordx4 v30, s[48:51], s74 offen offset:2048 lds
    buffer_load_dwordx4 v31, s[48:51], s74 offen offset:3072 lds
    s_mov_b32 m0, 106752
    s_nop 0
    buffer_load_dwordx4 v40, s[44:47], s43 offen lds
    buffer_load_dwordx4 v41, s[44:47], s43 offen offset:1024 lds
    buffer_load_dwordx4 v42, s[44:47], s43 offen offset:2048 lds
    buffer_load_dwordx4 v43, s[44:47], s43 offen offset:3072 lds
    s_mov_b32 m0, 86272
    s_nop 0
    buffer_load_dwordx4 v28, s[52:55], s74 offen lds
    buffer_load_dwordx4 v29, s[52:55], s74 offen offset:1024 lds
    buffer_load_dwordx4 v30, s[52:55], s74 offen offset:2048 lds
    buffer_load_dwordx4 v31, s[52:55], s74 offen offset:3072 lds
    s_mov_b32 m0, 110848
    s_nop 0
    buffer_load_dwordx4 v44, s[44:47], s43 offen lds
    buffer_load_dwordx4 v45, s[44:47], s43 offen offset:1024 lds
    buffer_load_dwordx4 v46, s[44:47], s43 offen offset:2048 lds
    buffer_load_dwordx4 v47, s[44:47], s43 offen offset:3072 lds
    s_mov_b32 m0, 82176
    s_nop 0
    buffer_load_dwordx4 v32, s[48:51], s74 offen lds
    buffer_load_dwordx4 v33, s[48:51], s74 offen offset:1024 lds
    buffer_load_dwordx4 v34, s[48:51], s74 offen offset:2048 lds
    buffer_load_dwordx4 v35, s[48:51], s74 offen offset:3072 lds
    s_mov_b32 m0, 114944
    s_nop 0
    buffer_load_dwordx4 v48, s[44:47], s43 offen lds
    s_waitcnt vmcnt(55)
    buffer_load_dwordx4 v49, s[44:47], s43 offen offset:1024 lds
    s_mov_b32 m0, 90368
    s_nop 0
    buffer_load_dwordx4 v32, s[52:55], s74 offen lds
    buffer_load_dwordx4 v33, s[52:55], s74 offen offset:1024 lds
    buffer_load_dwordx4 v34, s[52:55], s74 offen offset:2048 lds
    buffer_load_dwordx4 v35, s[52:55], s74 offen offset:3072 lds
    s_waitcnt vmcnt(30) lgkmcnt(0)
    s_barrier
    s_lshr_b64 s[80:81], s[80:81], 4
    s_and_b32 s78, s80, 15
    s_mul_i32 s75, s78, 245760
    s_lshl_b32 s43, s78, 7
    s_mov_b32 m0, 141696
    s_nop 0
    buffer_load_dwordx4 v36, s[44:47], s43 offen lds
    buffer_load_dwordx4 v37, s[44:47], s43 offen offset:1024 lds
    buffer_load_dwordx4 v38, s[44:47], s43 offen offset:2048 lds
    buffer_load_dwordx4 v39, s[44:47], s43 offen offset:3072 lds
    s_mov_b32 m0, 117120
    s_nop 0
    buffer_load_dwordx4 v28, s[48:51], s75 offen lds
    buffer_load_dwordx4 v29, s[48:51], s75 offen offset:1024 lds
    buffer_load_dwordx4 v30, s[48:51], s75 offen offset:2048 lds
    buffer_load_dwordx4 v31, s[48:51], s75 offen offset:3072 lds
    s_mov_b32 m0, 145792
    s_nop 0
    buffer_load_dwordx4 v40, s[44:47], s43 offen lds
    buffer_load_dwordx4 v41, s[44:47], s43 offen offset:1024 lds
    buffer_load_dwordx4 v42, s[44:47], s43 offen offset:2048 lds
    buffer_load_dwordx4 v43, s[44:47], s43 offen offset:3072 lds
    s_mov_b32 m0, 125312
    s_nop 0
    buffer_load_dwordx4 v28, s[52:55], s75 offen lds
    buffer_load_dwordx4 v29, s[52:55], s75 offen offset:1024 lds
    buffer_load_dwordx4 v30, s[52:55], s75 offen offset:2048 lds
    buffer_load_dwordx4 v31, s[52:55], s75 offen offset:3072 lds
    s_mov_b32 m0, 149888
    s_nop 0
    buffer_load_dwordx4 v44, s[44:47], s43 offen lds
    buffer_load_dwordx4 v45, s[44:47], s43 offen offset:1024 lds
    buffer_load_dwordx4 v46, s[44:47], s43 offen offset:2048 lds
    buffer_load_dwordx4 v47, s[44:47], s43 offen offset:3072 lds
    s_mov_b32 m0, 121216
    s_nop 0
    buffer_load_dwordx4 v32, s[48:51], s75 offen lds
    buffer_load_dwordx4 v33, s[48:51], s75 offen offset:1024 lds
    buffer_load_dwordx4 v34, s[48:51], s75 offen offset:2048 lds
    buffer_load_dwordx4 v35, s[48:51], s75 offen offset:3072 lds
    s_mov_b32 m0, 153984
    s_nop 0
    buffer_load_dwordx4 v48, s[44:47], s43 offen lds
    buffer_load_dwordx4 v49, s[44:47], s43 offen offset:1024 lds
    s_mov_b32 m0, 129408
    s_nop 0
    buffer_load_dwordx4 v32, s[52:55], s75 offen lds
    buffer_load_dwordx4 v33, s[52:55], s75 offen offset:1024 lds
    buffer_load_dwordx4 v34, s[52:55], s75 offen offset:2048 lds
    buffer_load_dwordx4 v35, s[52:55], s75 offen offset:3072 lds
    s_waitcnt vmcnt(30) lgkmcnt(0)
    s_barrier
    s_lshr_b64 s[80:81], s[80:81], 4
    s_and_b32 s78, s80, 15
    s_mul_i32 s76, s78, 245760
    s_lshl_b32 s43, s78, 7
    s_mov_b32 m0, 24576
    s_nop 0
    buffer_load_dwordx4 v36, s[44:47], s43 offen lds
    buffer_load_dwordx4 v37, s[44:47], s43 offen offset:1024 lds
    buffer_load_dwordx4 v38, s[44:47], s43 offen offset:2048 lds
    buffer_load_dwordx4 v39, s[44:47], s43 offen offset:3072 lds
    s_mov_b32 m0, 0
    s_nop 0
    buffer_load_dwordx4 v28, s[48:51], s76 offen lds
    buffer_load_dwordx4 v29, s[48:51], s76 offen offset:1024 lds
    buffer_load_dwordx4 v30, s[48:51], s76 offen offset:2048 lds
    buffer_load_dwordx4 v31, s[48:51], s76 offen offset:3072 lds
    s_mov_b32 m0, 28672
    s_nop 0
    buffer_load_dwordx4 v40, s[44:47], s43 offen lds
    buffer_load_dwordx4 v41, s[44:47], s43 offen offset:1024 lds
    buffer_load_dwordx4 v42, s[44:47], s43 offen offset:2048 lds
    buffer_load_dwordx4 v43, s[44:47], s43 offen offset:3072 lds
    s_mov_b32 m0, 8192
    s_nop 0
    buffer_load_dwordx4 v28, s[52:55], s76 offen lds
    buffer_load_dwordx4 v29, s[52:55], s76 offen offset:1024 lds
    buffer_load_dwordx4 v30, s[52:55], s76 offen offset:2048 lds
    buffer_load_dwordx4 v31, s[52:55], s76 offen offset:3072 lds
    s_mov_b32 m0, 32768
    s_nop 0
    buffer_load_dwordx4 v44, s[44:47], s43 offen lds
    buffer_load_dwordx4 v45, s[44:47], s43 offen offset:1024 lds
    buffer_load_dwordx4 v46, s[44:47], s43 offen offset:2048 lds
    buffer_load_dwordx4 v47, s[44:47], s43 offen offset:3072 lds
    s_mov_b32 m0, 4096
    s_nop 0
    buffer_load_dwordx4 v32, s[48:51], s76 offen lds
    buffer_load_dwordx4 v33, s[48:51], s76 offen offset:1024 lds
    buffer_load_dwordx4 v34, s[48:51], s76 offen offset:2048 lds
    buffer_load_dwordx4 v35, s[48:51], s76 offen offset:3072 lds
    s_mov_b32 m0, 36864
    s_nop 0
    buffer_load_dwordx4 v48, s[44:47], s43 offen lds
    buffer_load_dwordx4 v49, s[44:47], s43 offen offset:1024 lds
    s_mov_b32 m0, 12288
    s_nop 0
    buffer_load_dwordx4 v32, s[52:55], s76 offen lds
    buffer_load_dwordx4 v33, s[52:55], s76 offen offset:1024 lds
    buffer_load_dwordx4 v34, s[52:55], s76 offen offset:2048 lds
    buffer_load_dwordx4 v35, s[52:55], s76 offen offset:3072 lds
    s_waitcnt vmcnt(30) lgkmcnt(0)
    s_barrier
    s_lshr_b64 s[80:81], s[80:81], 4
    s_and_b32 s78, s80, 15
    s_mul_i32 s77, s78, 245760
    s_lshl_b32 s43, s78, 7
    s_mov_b32 m0, 63616
    s_nop 0
    buffer_load_dwordx4 v36, s[44:47], s43 offen lds
    buffer_load_dwordx4 v37, s[44:47], s43 offen offset:1024 lds
    buffer_load_dwordx4 v38, s[44:47], s43 offen offset:2048 lds
    buffer_load_dwordx4 v39, s[44:47], s43 offen offset:3072 lds
    s_mov_b32 m0, 39040
    s_nop 0
    buffer_load_dwordx4 v28, s[48:51], s77 offen lds
    buffer_load_dwordx4 v29, s[48:51], s77 offen offset:1024 lds
    buffer_load_dwordx4 v30, s[48:51], s77 offen offset:2048 lds
    buffer_load_dwordx4 v31, s[48:51], s77 offen offset:3072 lds
    s_mov_b32 m0, 67712
    s_nop 0
    buffer_load_dwordx4 v40, s[44:47], s43 offen lds
    buffer_load_dwordx4 v41, s[44:47], s43 offen offset:1024 lds
    buffer_load_dwordx4 v42, s[44:47], s43 offen offset:2048 lds
    buffer_load_dwordx4 v43, s[44:47], s43 offen offset:3072 lds
    s_mov_b32 m0, 47232
    s_nop 0
    buffer_load_dwordx4 v28, s[52:55], s77 offen lds
    buffer_load_dwordx4 v29, s[52:55], s77 offen offset:1024 lds
    buffer_load_dwordx4 v30, s[52:55], s77 offen offset:2048 lds
    buffer_load_dwordx4 v31, s[52:55], s77 offen offset:3072 lds
    s_mov_b32 m0, 71808
    s_nop 0
    buffer_load_dwordx4 v44, s[44:47], s43 offen lds
    buffer_load_dwordx4 v45, s[44:47], s43 offen offset:1024 lds
    buffer_load_dwordx4 v46, s[44:47], s43 offen offset:2048 lds
    buffer_load_dwordx4 v47, s[44:47], s43 offen offset:3072 lds
    s_mov_b32 m0, 43136
    s_nop 0
    buffer_load_dwordx4 v32, s[48:51], s77 offen lds
    buffer_load_dwordx4 v33, s[48:51], s77 offen offset:1024 lds
    buffer_load_dwordx4 v34, s[48:51], s77 offen offset:2048 lds
    buffer_load_dwordx4 v35, s[48:51], s77 offen offset:3072 lds
    s_mov_b32 m0, 75904
    s_nop 0
    buffer_load_dwordx4 v48, s[44:47], s43 offen lds
    buffer_load_dwordx4 v49, s[44:47], s43 offen offset:1024 lds
    s_mov_b32 m0, 51328
    s_nop 0
    buffer_load_dwordx4 v32, s[52:55], s77 offen lds
    buffer_load_dwordx4 v33, s[52:55], s77 offen offset:1024 lds
    buffer_load_dwordx4 v34, s[52:55], s77 offen offset:2048 lds
    buffer_load_dwordx4 v35, s[52:55], s77 offen offset:3072 lds
    s_waitcnt vmcnt(30) lgkmcnt(0)
    s_barrier
    s_lshr_b64 s[80:81], s[80:81], 4
    s_and_b32 s78, s80, 15
    s_mov_b32 m0, 94464
    s_nop 0
    buffer_load_dwordx4 v28, s[56:59], s74 offen lds
    buffer_load_dwordx4 v29, s[56:59], s74 offen offset:1024 lds
    buffer_load_dwordx4 v30, s[56:59], s74 offen offset:2048 lds
    buffer_load_dwordx4 v31, s[56:59], s74 offen offset:3072 lds
    s_mov_b32 m0, 98560
    s_nop 0
    buffer_load_dwordx4 v32, s[56:59], s74 offen lds
    buffer_load_dwordx4 v33, s[56:59], s74 offen offset:1024 lds
    buffer_load_dwordx4 v34, s[56:59], s74 offen offset:2048 lds
    buffer_load_dwordx4 v35, s[56:59], s74 offen offset:3072 lds
    s_mov_b32 m0, 133504
    s_nop 0
    buffer_load_dwordx4 v28, s[56:59], s75 offen lds
    buffer_load_dwordx4 v29, s[56:59], s75 offen offset:1024 lds
    buffer_load_dwordx4 v30, s[56:59], s75 offen offset:2048 lds
    buffer_load_dwordx4 v31, s[56:59], s75 offen offset:3072 lds
    s_waitcnt vmcnt(12) lgkmcnt(0)
    s_barrier
    s_mov_b32 m0, 137600
    s_nop 0
    buffer_load_dwordx4 v32, s[56:59], s75 offen lds
    buffer_load_dwordx4 v33, s[56:59], s75 offen offset:1024 lds
    buffer_load_dwordx4 v34, s[56:59], s75 offen offset:2048 lds
    buffer_load_dwordx4 v35, s[56:59], s75 offen offset:3072 lds
    s_mov_b32 m0, 16384
    s_nop 0
    buffer_load_dwordx4 v28, s[56:59], s76 offen lds
    buffer_load_dwordx4 v29, s[56:59], s76 offen offset:1024 lds
    buffer_load_dwordx4 v30, s[56:59], s76 offen offset:2048 lds
    buffer_load_dwordx4 v31, s[56:59], s76 offen offset:3072 lds
    s_mov_b32 m0, 20480
    s_nop 0
    buffer_load_dwordx4 v32, s[56:59], s76 offen lds
    buffer_load_dwordx4 v33, s[56:59], s76 offen offset:1024 lds
    buffer_load_dwordx4 v34, s[56:59], s76 offen offset:2048 lds
    buffer_load_dwordx4 v35, s[56:59], s76 offen offset:3072 lds
    s_mov_b32 m0, 55424
    s_nop 0
    buffer_load_dwordx4 v28, s[56:59], s77 offen lds
    buffer_load_dwordx4 v29, s[56:59], s77 offen offset:1024 lds
    buffer_load_dwordx4 v30, s[56:59], s77 offen offset:2048 lds
    buffer_load_dwordx4 v31, s[56:59], s77 offen offset:3072 lds
    s_mov_b32 m0, 59520
    s_nop 0
    buffer_load_dwordx4 v32, s[56:59], s77 offen lds
    buffer_load_dwordx4 v33, s[56:59], s77 offen offset:1024 lds
    buffer_load_dwordx4 v34, s[56:59], s77 offen offset:2048 lds
    buffer_load_dwordx4 v35, s[56:59], s77 offen offset:3072 lds
    s_mov_b32 s10, 20480
    v_lshrrev_b32 v52, 5, v1
    v_lshlrev_b32 v52, 3, v52
    v_add_u32 v53, 2, v52
    v_add_u32 v54, 4, v52
    v_add_u32 v55, 6, v52
    v_add_u32 v56, 16, v52
    v_add_u32 v57, 18, v52
    v_add_u32 v58, 20, v52
    v_add_u32 v59, 22, v52
    v_and_b32 v7, 3, v5
    v_mul_u32_u24 v7, 1280, v7
    v_add_u32 v60, v7, v50
    v_xor_b32 v61, 64, v60
    v_add_u32 v61, 4096, v61
    v_add_u32 v62, 8192, v60
    v_add_u32 v63, 8192, v61
    s_mov_b32 s5, 0xbfe10856
    s_mov_b32 s6, 0xaff80255
    s_mov_b32 s7, 0xabfe4015
    s_mov_b32 s8, 0xaa7fd005
    s_mov_b32 s9, 0x6adfb401
    s_cmp_eq_u32 s42, 1
    s_cselect_b32 s5, 0xabfe4015, s5
    s_cselect_b32 s6, 0xaa7fd005, s6
    s_cselect_b32 s7, 0x6adfb401, s7
    s_cselect_b32 s8, 0xbfe10856, s8
    s_cselect_b32 s9, 0xaff80255, s9
    s_cmp_eq_u32 s42, 2
    s_cselect_b32 s5, 0x6adfb401, s5
    s_cselect_b32 s6, 0xbfe10856, s6
    s_cselect_b32 s7, 0xaff80255, s7
    s_cselect_b32 s8, 0xabfe4015, s8
    s_cselect_b32 s9, 0xaa7fd005, s9
    s_cmp_eq_u32 s42, 3
    s_cselect_b32 s5, 0xaff80255, s5
    s_cselect_b32 s6, 0xabfe4015, s6
    s_cselect_b32 s7, 0xaa7fd005, s7
    s_cselect_b32 s8, 0x6adfb401, s8
    s_cselect_b32 s9, 0xbfe10856, s9
    s_cmp_eq_u32 s42, 4
    s_cselect_b32 s5, 0xaa7fd005, s5
    s_cselect_b32 s6, 0x6adfb401, s6
    s_cselect_b32 s7, 0xbfe10856, s7
    s_cselect_b32 s8, 0xaff80255, s8
    s_cselect_b32 s9, 0xabfe4015, s9
    s_mul_i32 s4, s42, 163840
    s_mov_b32 m0, 0
    v_bfe_u32 v64, s5, v52, 2
    v_mad_u32_u24 v64, v64, s10, v60
    buffer_load_dwordx4 v64, s[60:63], s4 offen lds
    v_bfe_u32 v65, s5, v53, 2
    v_mad_u32_u24 v65, v65, s10, v61
    buffer_load_dwordx4 v65, s[60:63], s4 offen offset:1024 lds
    v_bfe_u32 v64, s5, v54, 2
    v_mad_u32_u24 v64, v64, s10, v62
    buffer_load_dwordx4 v64, s[60:63], s4 offen offset:2048 lds
    v_bfe_u32 v65, s5, v55, 2
    v_mad_u32_u24 v65, v65, s10, v63
    buffer_load_dwordx4 v65, s[60:63], s4 offen offset:3072 lds
    s_mov_b32 m0, 4096
    v_bfe_u32 v64, s5, v56, 2
    v_mad_u32_u24 v64, v64, s10, v60
    buffer_load_dwordx4 v64, s[60:63], s4 offen lds
    v_bfe_u32 v65, s5, v57, 2
    v_mad_u32_u24 v65, v65, s10, v61
    buffer_load_dwordx4 v65, s[60:63], s4 offen offset:1024 lds
    v_bfe_u32 v64, s5, v58, 2
    v_mad_u32_u24 v64, v64, s10, v62
    buffer_load_dwordx4 v64, s[60:63], s4 offen offset:2048 lds
    v_bfe_u32 v65, s5, v59, 2
    v_mad_u32_u24 v65, v65, s10, v63
    buffer_load_dwordx4 v65, s[60:63], s4 offen offset:3072 lds
    s_add_u32 s4, s4, 81920
    s_cmp_eq_u32 s4, 819200
    s_cselect_b32 s4, 0, s4
    s_mov_b32 m0, 8192
    v_bfe_u32 v64, s6, v52, 2
    v_mad_u32_u24 v64, v64, s10, v60
    buffer_load_dwordx4 v64, s[60:63], s4 offen lds
    v_bfe_u32 v65, s6, v53, 2
    v_mad_u32_u24 v65, v65, s10, v61
    buffer_load_dwordx4 v65, s[60:63], s4 offen offset:1024 lds
    v_bfe_u32 v64, s6, v54, 2
    v_mad_u32_u24 v64, v64, s10, v62
    buffer_load_dwordx4 v64, s[60:63], s4 offen offset:2048 lds
    v_bfe_u32 v65, s6, v55, 2
    v_mad_u32_u24 v65, v65, s10, v63
    buffer_load_dwordx4 v65, s[60:63], s4 offen offset:3072 lds
    s_mov_b32 m0, 12288
    v_bfe_u32 v64, s6, v56, 2
    v_mad_u32_u24 v64, v64, s10, v60
    buffer_load_dwordx4 v64, s[60:63], s4 offen lds
    v_bfe_u32 v65, s6, v57, 2
    v_mad_u32_u24 v65, v65, s10, v61
    buffer_load_dwordx4 v65, s[60:63], s4 offen offset:1024 lds
    v_bfe_u32 v64, s6, v58, 2
    v_mad_u32_u24 v64, v64, s10, v62
    buffer_load_dwordx4 v64, s[60:63], s4 offen offset:2048 lds
    v_bfe_u32 v65, s6, v59, 2
    v_mad_u32_u24 v65, v65, s10, v63
    buffer_load_dwordx4 v65, s[60:63], s4 offen offset:3072 lds
    s_add_u32 s4, s4, 81920
    s_cmp_eq_u32 s4, 819200
    s_cselect_b32 s4, 0, s4
    s_waitcnt vmcnt(16)
    v_mov_b32 v5, 157980
    v_mov_b32 v6, 1
    s_mov_b64 exec, 1
    ds_add_u32 v5, v6
    s_mov_b64 exec, -1
    v_mov_b32 v5, 157972
    v_mov_b32 v6, 1
    s_mov_b64 exec, 1
    ds_add_u32 v5, v6
    s_mov_b64 exec, -1
    s_mov_b32 m0, 24576
    v_bfe_u32 v64, s7, v52, 2
    v_mad_u32_u24 v64, v64, s10, v60
    buffer_load_dwordx4 v64, s[60:63], s4 offen lds
    v_bfe_u32 v65, s7, v53, 2
    v_mad_u32_u24 v65, v65, s10, v61
    buffer_load_dwordx4 v65, s[60:63], s4 offen offset:1024 lds
    v_bfe_u32 v64, s7, v54, 2
    v_mad_u32_u24 v64, v64, s10, v62
    buffer_load_dwordx4 v64, s[60:63], s4 offen offset:2048 lds
    v_bfe_u32 v65, s7, v55, 2
    v_mad_u32_u24 v65, v65, s10, v63
    buffer_load_dwordx4 v65, s[60:63], s4 offen offset:3072 lds
    s_mov_b32 m0, 28672
    v_bfe_u32 v64, s7, v56, 2
    v_mad_u32_u24 v64, v64, s10, v60
    buffer_load_dwordx4 v64, s[60:63], s4 offen lds
    v_bfe_u32 v65, s7, v57, 2
    v_mad_u32_u24 v65, v65, s10, v61
    buffer_load_dwordx4 v65, s[60:63], s4 offen offset:1024 lds
    v_bfe_u32 v64, s7, v58, 2
    v_mad_u32_u24 v64, v64, s10, v62
    buffer_load_dwordx4 v64, s[60:63], s4 offen offset:2048 lds
    v_bfe_u32 v65, s7, v59, 2
    v_mad_u32_u24 v65, v65, s10, v63
    buffer_load_dwordx4 v65, s[60:63], s4 offen offset:3072 lds
    s_add_u32 s4, s4, 81920
    s_cmp_eq_u32 s4, 819200
    s_cselect_b32 s4, 0, s4
    s_mov_b32 m0, 123136
    v_bfe_u32 v64, s8, v52, 2
    v_mad_u32_u24 v64, v64, s10, v60
    buffer_load_dwordx4 v64, s[60:63], s4 offen lds
    v_bfe_u32 v65, s8, v53, 2
    v_mad_u32_u24 v65, v65, s10, v61
    buffer_load_dwordx4 v65, s[60:63], s4 offen offset:1024 lds
    v_bfe_u32 v64, s8, v54, 2
    v_mad_u32_u24 v64, v64, s10, v62
    buffer_load_dwordx4 v64, s[60:63], s4 offen offset:2048 lds
    v_bfe_u32 v65, s8, v55, 2
    v_mad_u32_u24 v65, v65, s10, v63
    buffer_load_dwordx4 v65, s[60:63], s4 offen offset:3072 lds
    s_mov_b32 m0, 127232
    v_bfe_u32 v64, s8, v56, 2
    v_mad_u32_u24 v64, v64, s10, v60
    buffer_load_dwordx4 v64, s[60:63], s4 offen lds
    v_bfe_u32 v65, s8, v57, 2
    v_mad_u32_u24 v65, v65, s10, v61
    buffer_load_dwordx4 v65, s[60:63], s4 offen offset:1024 lds
    v_bfe_u32 v64, s8, v58, 2
    v_mad_u32_u24 v64, v64, s10, v62
    buffer_load_dwordx4 v64, s[60:63], s4 offen offset:2048 lds
    v_bfe_u32 v65, s8, v59, 2
    v_mad_u32_u24 v65, v65, s10, v63
    buffer_load_dwordx4 v65, s[60:63], s4 offen offset:3072 lds
    s_add_u32 s4, s4, 81920
    s_cmp_eq_u32 s4, 819200
    s_cselect_b32 s4, 0, s4
    s_mov_b32 m0, 80000
    v_bfe_u32 v64, s9, v52, 2
    v_mad_u32_u24 v64, v64, s10, v60
    buffer_load_dwordx4 v64, s[60:63], s4 offen lds
    v_bfe_u32 v65, s9, v53, 2
    v_mad_u32_u24 v65, v65, s10, v61
    buffer_load_dwordx4 v65, s[60:63], s4 offen offset:1024 lds
    v_bfe_u32 v64, s9, v54, 2
    v_mad_u32_u24 v64, v64, s10, v62
    buffer_load_dwordx4 v64, s[60:63], s4 offen offset:2048 lds
    v_bfe_u32 v65, s9, v55, 2
    v_mad_u32_u24 v65, v65, s10, v63
    buffer_load_dwordx4 v65, s[60:63], s4 offen offset:3072 lds
    s_mov_b32 m0, 84096
    v_bfe_u32 v64, s9, v56, 2
    v_mad_u32_u24 v64, v64, s10, v60
    buffer_load_dwordx4 v64, s[60:63], s4 offen lds
    v_bfe_u32 v65, s9, v57, 2
    v_mad_u32_u24 v65, v65, s10, v61
    buffer_load_dwordx4 v65, s[60:63], s4 offen offset:1024 lds
    v_bfe_u32 v64, s9, v58, 2
    v_mad_u32_u24 v64, v64, s10, v62
    buffer_load_dwordx4 v64, s[60:63], s4 offen offset:2048 lds
    v_bfe_u32 v65, s9, v59, 2
    v_mad_u32_u24 v65, v65, s10, v63
    buffer_load_dwordx4 v65, s[60:63], s4 offen offset:3072 lds
    s_add_u32 s4, s4, 81920
    s_cmp_eq_u32 s4, 819200
    s_cselect_b32 s4, 0, s4
    s_waitcnt vmcnt(0)
    v_mov_b32 v7, 157980
    v_mov_b32 v6, 1
    s_mov_b64 exec, 1
    ds_add_u32 v7, v6
    s_mov_b64 exec, -1
Lcw_6:
    s_sub_u32 s35, s35, 1
    s_cbranch_scc1 Lend
    ds_read_b32 v6, v5
    s_waitcnt lgkmcnt(0)
    v_readfirstlane_b32 s38, v6
    s_nop 0
    s_cmp_lt_u32 s38, 8
    s_cbranch_scc1 Lcw_6
    s_lshl_b32 s36, s32, 7
    s_add_u32 s36, s36, 8257536
    v_mov_b32 v69, s36
    buffer_load_dwordx4 v[70:73], v69, s[28:31], 0 offen sc1
    v_mov_b32 v5, 157976
Lcw_7:
    s_sub_u32 s35, s35, 1
    s_cbranch_scc1 Lend
    ds_read_b32 v6, v5
    s_waitcnt lgkmcnt(0)
    v_readfirstlane_b32 s38, v6
    s_nop 0
    s_cmp_lt_u32 s38, 7
    s_cbranch_scc1 Lcw_7
    s_mov_b32 m0, 32768
    v_bfe_u32 v64, s5, v52, 2
    v_mad_u32_u24 v64, v64, s10, v60
    buffer_load_dwordx4 v64, s[60:63], s4 offen lds
    v_bfe_u32 v65, s5, v53, 2
    v_mad_u32_u24 v65, v65, s10, v61
    buffer_load_dwordx4 v65, s[60:63], s4 offen offset:1024 lds
    v_bfe_u32 v64, s5, v54, 2
    v_mad_u32_u24 v64, v64, s10, v62
    buffer_load_dwordx4 v64, s[60:63], s4 offen offset:2048 lds
    v_bfe_u32 v65, s5, v55, 2
    v_mad_u32_u24 v65, v65, s10, v63
    buffer_load_dwordx4 v65, s[60:63], s4 offen offset:3072 lds
    s_mov_b32 m0, 36864
    v_bfe_u32 v64, s5, v56, 2
    v_mad_u32_u24 v64, v64, s10, v60
    buffer_load_dwordx4 v64, s[60:63], s4 offen lds
    v_bfe_u32 v65, s5, v57, 2
    v_mad_u32_u24 v65, v65, s10, v61
    buffer_load_dwordx4 v65, s[60:63], s4 offen offset:1024 lds
    v_bfe_u32 v64, s5, v58, 2
    v_mad_u32_u24 v64, v64, s10, v62
    buffer_load_dwordx4 v64, s[60:63], s4 offen offset:2048 lds
    v_bfe_u32 v65, s5, v59, 2
    v_mad_u32_u24 v65, v65, s10, v63
    buffer_load_dwordx4 v65, s[60:63], s4 offen offset:3072 lds
    s_add_u32 s4, s4, 81920
    s_cmp_eq_u32 s4, 819200
    s_cselect_b32 s4, 0, s4
    s_mov_b32 m0, 40960
    v_bfe_u32 v64, s6, v52, 2
    v_mad_u32_u24 v64, v64, s10, v60
    buffer_load_dwordx4 v64, s[60:63], s4 offen lds
    v_bfe_u32 v65, s6, v53, 2
    v_mad_u32_u24 v65, v65, s10, v61
    buffer_load_dwordx4 v65, s[60:63], s4 offen offset:1024 lds
    v_bfe_u32 v64, s6, v54, 2
    v_mad_u32_u24 v64, v64, s10, v62
    buffer_load_dwordx4 v64, s[60:63], s4 offen offset:2048 lds
    v_bfe_u32 v65, s6, v55, 2
    v_mad_u32_u24 v65, v65, s10, v63
    buffer_load_dwordx4 v65, s[60:63], s4 offen offset:3072 lds
    s_mov_b32 m0, 45056
    v_bfe_u32 v64, s6, v56, 2
    v_mad_u32_u24 v64, v64, s10, v60
    buffer_load_dwordx4 v64, s[60:63], s4 offen lds
    v_bfe_u32 v65, s6, v57, 2
    v_mad_u32_u24 v65, v65, s10, v61
    buffer_load_dwordx4 v65, s[60:63], s4 offen offset:1024 lds
    v_bfe_u32 v64, s6, v58, 2
    v_mad_u32_u24 v64, v64, s10, v62
    buffer_load_dwordx4 v64, s[60:63], s4 offen offset:2048 lds
    v_bfe_u32 v65, s6, v59, 2
    v_mad_u32_u24 v65, v65, s10, v63
    buffer_load_dwordx4 v65, s[60:63], s4 offen offset:3072 lds
    s_add_u32 s4, s4, 81920
    s_cmp_eq_u32 s4, 819200
    s_cselect_b32 s4, 0, s4
    s_mov_b32 m0, 63616
    v_bfe_u32 v64, s7, v52, 2
    v_mad_u32_u24 v64, v64, s10, v60
    buffer_load_dwordx4 v64, s[60:63], s4 offen lds
    v_bfe_u32 v65, s7, v53, 2
    v_mad_u32_u24 v65, v65, s10, v61
    buffer_load_dwordx4 v65, s[60:63], s4 offen offset:1024 lds
    v_bfe_u32 v64, s7, v54, 2
    v_mad_u32_u24 v64, v64, s10, v62
    buffer_load_dwordx4 v64, s[60:63], s4 offen offset:2048 lds
    v_bfe_u32 v65, s7, v55, 2
    v_mad_u32_u24 v65, v65, s10, v63
    buffer_load_dwordx4 v65, s[60:63], s4 offen offset:3072 lds
    s_mov_b32 m0, 67712
    v_bfe_u32 v64, s7, v56, 2
    v_mad_u32_u24 v64, v64, s10, v60
    buffer_load_dwordx4 v64, s[60:63], s4 offen lds
    v_bfe_u32 v65, s7, v57, 2
    v_mad_u32_u24 v65, v65, s10, v61
    buffer_load_dwordx4 v65, s[60:63], s4 offen offset:1024 lds
    v_bfe_u32 v64, s7, v58, 2
    v_mad_u32_u24 v64, v64, s10, v62
    buffer_load_dwordx4 v64, s[60:63], s4 offen offset:2048 lds
    v_bfe_u32 v65, s7, v59, 2
    v_mad_u32_u24 v65, v65, s10, v63
    buffer_load_dwordx4 v65, s[60:63], s4 offen offset:3072 lds
    s_add_u32 s4, s4, 81920
    s_cmp_eq_u32 s4, 819200
    s_cselect_b32 s4, 0, s4
    s_mov_b32 m0, 71808
    v_bfe_u32 v64, s8, v52, 2
    v_mad_u32_u24 v64, v64, s10, v60
    buffer_load_dwordx4 v64, s[60:63], s4 offen lds
    v_bfe_u32 v65, s8, v53, 2
    v_mad_u32_u24 v65, v65, s10, v61
    buffer_load_dwordx4 v65, s[60:63], s4 offen offset:1024 lds
    v_bfe_u32 v64, s8, v54, 2
    v_mad_u32_u24 v64, v64, s10, v62
    buffer_load_dwordx4 v64, s[60:63], s4 offen offset:2048 lds
    v_bfe_u32 v65, s8, v55, 2
    v_mad_u32_u24 v65, v65, s10, v63
    buffer_load_dwordx4 v65, s[60:63], s4 offen offset:3072 lds
    s_mov_b32 m0, 75904
    v_bfe_u32 v64, s8, v56, 2
    v_mad_u32_u24 v64, v64, s10, v60
    buffer_load_dwordx4 v64, s[60:63], s4 offen lds
    v_bfe_u32 v65, s8, v57, 2
    v_mad_u32_u24 v65, v65, s10, v61
    buffer_load_dwordx4 v65, s[60:63], s4 offen offset:1024 lds
    v_bfe_u32 v64, s8, v58, 2
    v_mad_u32_u24 v64, v64, s10, v62
    buffer_load_dwordx4 v64, s[60:63], s4 offen offset:2048 lds
    v_bfe_u32 v65, s8, v59, 2
    v_mad_u32_u24 v65, v65, s10, v63
    buffer_load_dwordx4 v65, s[60:63], s4 offen offset:3072 lds
    s_add_u32 s4, s4, 81920
    s_cmp_eq_u32 s4, 819200
    s_cselect_b32 s4, 0, s4
    s_mov_b32 m0, 49152
    v_bfe_u32 v64, s9, v52, 2
    v_mad_u32_u24 v64, v64, s10, v60
    buffer_load_dwordx4 v64, s[60:63], s4 offen lds
    v_bfe_u32 v65, s9, v53, 2
    v_mad_u32_u24 v65, v65, s10, v61
    buffer_load_dwordx4 v65, s[60:63], s4 offen offset:1024 lds
    v_bfe_u32 v64, s9, v54, 2
    v_mad_u32_u24 v64, v64, s10, v62
    buffer_load_dwordx4 v64, s[60:63], s4 offen offset:2048 lds
    v_bfe_u32 v65, s9, v55, 2
    v_mad_u32_u24 v65, v65, s10, v63
    buffer_load_dwordx4 v65, s[60:63], s4 offen offset:3072 lds
    s_mov_b32 m0, 88192
    v_bfe_u32 v64, s9, v56, 2
    v_mad_u32_u24 v64, v64, s10, v60
    buffer_load_dwordx4 v64, s[60:63], s4 offen lds
    v_bfe_u32 v65, s9, v57, 2
    v_mad_u32_u24 v65, v65, s10, v61
    buffer_load_dwordx4 v65, s[60:63], s4 offen offset:1024 lds
    v_bfe_u32 v64, s9, v58, 2
    v_mad_u32_u24 v64, v64, s10, v62
    buffer_load_dwordx4 v64, s[60:63], s4 offen offset:2048 lds
    v_bfe_u32 v65, s9, v59, 2
    v_mad_u32_u24 v65, v65, s10, v63
    buffer_load_dwordx4 v65, s[60:63], s4 offen offset:3072 lds
    s_add_u32 s4, s4, 81920
    s_cmp_eq_u32 s4, 819200
    s_cselect_b32 s4, 0, s4
    s_waitcnt vmcnt(0)
Lbc:
    v_readfirstlane_b32 s11, v70
    v_readfirstlane_b32 s36, v71
    v_readfirstlane_b32 s12, v72
    v_readfirstlane_b32 s37, v73
    s_cmp_eq_u32 s36, s34
    s_cselect_b32 s37, s37, s36
    s_cmp_eq_u32 s37, s34
    s_cbranch_scc1 Lbc_ok
    s_sub_u32 s35, s35, 1
    s_cbranch_scc1 Lend
    buffer_load_dwordx4 v[70:73], v69, s[28:31], 0 offen sc1
    s_waitcnt vmcnt(0)
    s_branch Lbc
Lbc_ok:
    s_mul_i32 s36, s32, 96
    s_and_b32 s13, s11, 0x7ff
    s_sub_u32 s13, 2047, s13
    s_sub_u32 s37, s13, s36
    s_cmp_lt_u32 s37, 96
    s_cselect_b32 s13, s13, -1
    s_and_b32 s14, s12, 0x7ff
    s_sub_u32 s14, 2047, s14
    s_sub_u32 s37, s14, s36
    s_cmp_lt_u32 s37, 96
    s_cselect_b32 s14, s14, -1
    v_mov_b32 v4, s13
    v_mov_b32 v5, s14
    v_mov_b32 v6, 157960
    ds_write_b64 v6, v[4:5]
    s_and_b32 s37, s13, s14
    s_cmp_eq_u32 s37, -1
    s_cbranch_scc1 Lw0_done
    s_max_i32 s36, s13, 0
    s_mul_i32 s36, s36, 1280
    s_lshl_b32 s37, s33, 7
    s_add_u32 s36, s36, s37
    s_add_u32 s36, s36, 4096
    v_lshlrev_b32 v8, 1, v1
    buffer_load_ushort v124, v8, s[44:47], s36 offen
    s_max_i32 s36, s14, 0
    s_mul_i32 s36, s36, 1280
    s_lshl_b32 s37, s33, 7
    s_add_u32 s36, s36, s37
    s_add_u32 s36, s36, 4096
    v_lshlrev_b32 v8, 1, v1
    buffer_load_ushort v125, v8, s[44:47], s36 offen
    v_min_u32 v7, 26, v1
    v_mul_u32_u24 v7, 10240, v7
Ly_poll:
    s_sub_u32 s35, s35, 1
    s_cbranch_scc1 Lend
    s_sleep 20
    s_lshl_b32 s36, s33, 10
    s_add_u32 s36, s36, 7405568
    buffer_load_dword v4, v7, s[28:31], s36 offen offset:1020 sc1
    s_waitcnt vmcnt(0)
    v_cmp_ne_u32 vcc, s34, v4
    s_nop 0
    s_cbranch_vccnz Ly_poll
    buffer_load_dwordx4 v[16:19], v13, s[28:31], s36 offen sc1
    s_add_u32 s36, s36, 10240
    buffer_load_dwordx4 v[20:23], v13, s[28:31], s36 offen sc1
    s_add_u32 s36, s36, 10240
    buffer_load_dwordx4 v[24:27], v13, s[28:31], s36 offen sc1
    s_add_u32 s36, s36, 10240
    buffer_load_dwordx4 v[28:31], v13, s[28:31], s36 offen sc1
    s_add_u32 s36, s36, 10240
    buffer_load_dwordx4 v[32:35], v13, s[28:31], s36 offen sc1
    s_add_u32 s36, s36, 10240
    buffer_load_dwordx4 v[36:39], v13, s[28:31], s36 offen sc1
    s_add_u32 s36, s36, 10240
    buffer_load_dwordx4 v[40:43], v13, s[28:31], s36 offen sc1
    s_add_u32 s36, s36, 10240
    buffer_load_dwordx4 v[44:47], v13, s[28:31], s36 offen sc1
    s_add_u32 s36, s36, 10240
    buffer_load_dwordx4 v[48:51], v13, s[28:31], s36 offen sc1
    s_add_u32 s36, s36, 10240
    buffer_load_dwordx4 v[52:55], v13, s[28:31], s36 offen sc1
    s_add_u32 s36, s36, 10240
    buffer_load_dwordx4 v[56:59], v13, s[28:31], s36 offen sc1
    s_add_u32 s36, s36, 10240
    buffer_load_dwordx4 v[60:63], v13, s[28:31], s36 offen sc1
    s_add_u32 s36, s36, 10240
    buffer_load_dwordx4 v[64:67], v13, s[28:31], s36 offen sc1
    s_add_u32 s36, s36, 10240
    buffer_load_dwordx4 v[68:71], v13, s[28:31], s36 offen sc1
    s_add_u32 s36, s36, 10240
    buffer_load_dwordx4 v[72:75], v13, s[28:31], s36 offen sc1
    s_add_u32 s36, s36, 10240
    buffer_load_dwordx4 v[76:79], v13, s[28:31], s36 offen sc1
    s_add_u32 s36, s36, 10240
    buffer_load_dwordx4 v[80:83], v13, s[28:31], s36 offen sc1
    s_add_u32 s36, s36, 10240
    buffer_load_dwordx4 v[84:87], v13, s[28:31], s36 offen sc1
    s_add_u32 s36, s36, 10240
    buffer_load_dwordx4 v[88:91], v13, s[28:31], s36 offen sc1
    s_add_u32 s36, s36, 10240
    buffer_load_dwordx4 v[92:95], v13, s[28:31], s36 offen sc1
    s_add_u32 s36, s36, 10240
    buffer_load_dwordx4 v[96:99], v13, s[28:31], s36 offen sc1
    s_add_u32 s36, s36, 10240
    buffer_load_dwordx4 v[100:103], v13, s[28:31], s36 offen sc1
    s_add_u32 s36, s36, 10240
    buffer_load_dwordx4 v[104:107], v13, s[28:31], s36 offen sc1
    s_add_u32 s36, s36, 10240
    buffer_load_dwordx4 v[108:111], v13, s[28:31], s36 offen sc1
    s_add_u32 s36, s36, 10240
    buffer_load_dwordx4 v[112:115], v13, s[28:31], s36 offen sc1
    s_add_u32 s36, s36, 10240
    buffer_load_dwordx4 v[116:119], v13, s[28:31], s36 offen sc1
    s_add_u32 s36, s36, 10240
    buffer_load_dwordx4 v[120:123], v13, s[28:31], s36 offen sc1
    s_add_u32 s36, s36, 10240
    s_waitcnt vmcnt(0)
    v_xor_b32 v4, s34, v17
    v_xor_b32 v5, s34, v19
    v_or_b32 v4, v4, v5
    v_xor_b32 v5, s34, v21
    v_or_b32 v4, v4, v5
    v_xor_b32 v5, s34, v23
    v_or_b32 v4, v4, v5
    v_xor_b32 v5, s34, v25
    v_or_b32 v4, v4, v5
    v_xor_b32 v5, s34, v27
    v_or_b32 v4, v4, v5
    v_xor_b32 v5, s34, v29
    v_or_b32 v4, v4, v5
    v_xor_b32 v5, s34, v31
    v_or_b32 v4, v4, v5
    v_xor_b32 v5, s34, v33
    v_or_b32 v4, v4, v5
    v_xor_b32 v5, s34, v35
    v_or_b32 v4, v4, v5
    v_xor_b32 v5, s34, v37
    v_or_b32 v4, v4, v5
    v_xor_b32 v5, s34, v39
    v_or_b32 v4, v4, v5
    v_xor_b32 v5, s34, v41
    v_or_b32 v4, v4, v5
    v_xor_b32 v5, s34, v43
    v_or_b32 v4, v4, v5
    v_xor_b32 v5, s34, v45
    v_or_b32 v4, v4, v5
    v_xor_b32 v5, s34, v47
    v_or_b32 v4, v4, v5
    v_xor_b32 v5, s34, v49
    v_or_b32 v4, v4, v5
    v_xor_b32 v5, s34, v51
    v_or_b32 v4, v4, v5
    v_xor_b32 v5, s34, v53
    v_or_b32 v4, v4, v5
    v_xor_b32 v5, s34, v55
    v_or_b32 v4, v4, v5
    v_xor_b32 v5, s34, v57
    v_or_b32 v4, v4, v5
    v_xor_b32 v5, s34, v59
    v_or_b32 v4, v4, v5
    v_xor_b32 v5, s34, v61
    v_or_b32 v4, v4, v5
    v_xor_b32 v5, s34, v63
    v_or_b32 v4, v4, v5
    v_xor_b32 v5, s34, v65
    v_or_b32 v4, v4, v5
    v_xor_b32 v5, s34, v67
    v_or_b32 v4, v4, v5
    v_xor_b32 v5, s34, v69
    v_or_b32 v4, v4, v5
    v_xor_b32 v5, s34, v71
    v_or_b32 v4, v4, v5
    v_xor_b32 v5, s34, v73
    v_or_b32 v4, v4, v5
    v_xor_b32 v5, s34, v75
    v_or_b32 v4, v4, v5
    v_xor_b32 v5, s34, v77
    v_or_b32 v4, v4, v5
    v_xor_b32 v5, s34, v79
    v_or_b32 v4, v4, v5
    v_xor_b32 v5, s34, v81
    v_or_b32 v4, v4, v5
    v_xor_b32 v5, s34, v83
    v_or_b32 v4, v4, v5
    v_xor_b32 v5, s34, v85
    v_or_b32 v4, v4, v5
    v_xor_b32 v5, s34, v87
    v_or_b32 v4, v4, v5
    v_xor_b32 v5, s34, v89
    v_or_b32 v4, v4, v5
    v_xor_b32 v5, s34, v91
    v_or_b32 v4, v4, v5
    v_xor_b32 v5, s34, v93
    v_or_b32 v4, v4, v5
    v_xor_b32 v5, s34, v95
    v_or_b32 v4, v4, v5
    v_xor_b32 v5, s34, v97
    v_or_b32 v4, v4, v5
    v_xor_b32 v5, s34, v99
    v_or_b32 v4, v4, v5
    v_xor_b32 v5, s34, v101
    v_or_b32 v4, v4, v5
    v_xor_b32 v5, s34, v103
    v_or_b32 v4, v4, v5
    v_xor_b32 v5, s34, v105
    v_or_b32 v4, v4, v5
    v_xor_b32 v5, s34, v107
    v_or_b32 v4, v4, v5
    v_xor_b32 v5, s34, v109
    v_or_b32 v4, v4, v5
    v_xor_b32 v5, s34, v111
    v_or_b32 v4, v4, v5
    v_xor_b32 v5, s34, v113
    v_or_b32 v4, v4, v5
    v_xor_b32 v5, s34, v115
    v_or_b32 v4, v4, v5
    v_xor_b32 v5, s34, v117
    v_or_b32 v4, v4, v5
    v_xor_b32 v5, s34, v119
    v_or_b32 v4, v4, v5
    v_xor_b32 v5, s34, v121
    v_or_b32 v4, v4, v5
    v_xor_b32 v5, s34, v123
    v_or_b32 v4, v4, v5
    v_cmp_ne_u32 vcc, 0, v4
    s_nop 0
    s_cmp_lg_u64 vcc, 0
    s_cbranch_scc1 Ly_poll
    v_add_f32 v16, v16, v20
    v_add_f32 v18, v18, v22
    v_add_f32 v16, v16, v24
    v_add_f32 v18, v18, v26
    v_add_f32 v16, v16, v28
    v_add_f32 v18, v18, v30
    v_add_f32 v16, v16, v32
    v_add_f32 v18, v18, v34
    v_add_f32 v16, v16, v36
    v_add_f32 v18, v18, v38
    v_add_f32 v16, v16, v40
    v_add_f32 v18, v18, v42
    v_add_f32 v16, v16, v44
    v_add_f32 v18, v18, v46
    v_add_f32 v16, v16, v48
    v_add_f32 v18, v18, v50
    v_add_f32 v16, v16, v52
    v_add_f32 v18, v18, v54
    v_add_f32 v16, v16, v56
    v_add_f32 v18, v18, v58
    v_add_f32 v16, v16, v60
    v_add_f32 v18, v18, v62
    v_add_f32 v16, v16, v64
    v_add_f32 v18, v18, v66
    v_add_f32 v16, v16, v68
    v_add_f32 v18, v18, v70
    v_add_f32 v16, v16, v72
    v_add_f32 v18, v18, v74
    v_add_f32 v16, v16, v76
    v_add_f32 v18, v18, v78
    v_add_f32 v16, v16, v80
    v_add_f32 v18, v18, v82
    v_add_f32 v16, v16, v84
    v_add_f32 v18, v18, v86
    v_add_f32 v16, v16, v88
    v_add_f32 v18, v18, v90
    v_add_f32 v16, v16, v92
    v_add_f32 v18, v18, v94
    v_add_f32 v16, v16, v96
    v_add_f32 v18, v18, v98
    v_add_f32 v16, v16, v100
    v_add_f32 v18, v18, v102
    v_add_f32 v16, v16, v104
    v_add_f32 v18, v18, v106
    v_add_f32 v16, v16, v108
    v_add_f32 v18, v18, v110
    v_add_f32 v16, v16, v112
    v_add_f32 v18, v18, v114
    v_add_f32 v16, v16, v116
    v_add_f32 v18, v18, v118
    v_add_f32 v16, v16, v120
    v_add_f32 v18, v18, v122
    s_lshr_b32 s36, s11, 16
    s_cmp_ge_u32 s36, 0x8000
    s_cselect_b32 s37, 0x8000, -1
    s_xor_b32 s36, s36, s37
    s_lshl_b32 s36, s36, 16
    v_mov_b32 v4, s36
    v_mul_f32 v4, 0xbfb8aa3b, v4
    v_exp_f32 v4, v4
    s_nop 0
    v_add_f32 v4, 1.0, v4
    v_rcp_f32 v4, v4
    s_nop 0
    v_cvt_pk_bf16_f32 v4, v4, v4
    v_lshlrev_b32 v4, 16, v4
    v_cvt_pk_bf16_f32 v16, v16, v16
    v_lshlrev_b32 v16, 16, v16
    v_mul_f32 v16, v16, v4
    v_cvt_pk_bf16_f32 v16, v16, v16
    v_lshlrev_b32 v16, 16, v16
    s_lshr_b32 s36, s12, 16
    s_cmp_ge_u32 s36, 0x8000
    s_cselect_b32 s37, 0x8000, -1
    s_xor_b32 s36, s36, s37
    s_lshl_b32 s36, s36, 16
    v_mov_b32 v4, s36
    v_mul_f32 v4, 0xbfb8aa3b, v4
    v_exp_f32 v4, v4
    s_nop 0
    v_add_f32 v4, 1.0, v4
    v_rcp_f32 v4, v4
    s_nop 0
    v_cvt_pk_bf16_f32 v4, v4, v4
    v_lshlrev_b32 v4, 16, v4
    v_cvt_pk_bf16_f32 v18, v18, v18
    v_lshlrev_b32 v18, 16, v18
    v_mul_f32 v18, v18, v4
    v_cvt_pk_bf16_f32 v18, v18, v18
    v_lshlrev_b32 v18, 16, v18
    s_mul_i32 s36, s32, 96
    s_sub_u32 s36, s13, s36
    s_max_i32 s36, s36, 0
    s_lshl_b32 s36, s36, 2
    s_add_u32 s36, s36, 156288
    v_mov_b32 v4, s36
    ds_read2st64_b32 v[4:5], v4 offset0:0 offset1:2
    v_lshlrev_b32 v124, 16, v124
    s_waitcnt lgkmcnt(0)
    v_add_f32 v20, v124, v4
    v_cvt_pk_bf16_f32 v20, v20, v20
    v_lshlrev_b32 v20, 16, v20
    v_mul_f32 v20, v20, v5
    v_cvt_pk_bf16_f32 v20, v20, v20
    v_lshlrev_b32 v20, 16, v20
    v_add_f32 v20, v20, v16
    v_cvt_pk_bf16_f32 v20, v20, v20
    v_lshlrev_b32 v20, 16, v20
    v_mul_f32 v16, 0xbfb8aa3b, v20
    v_exp_f32 v16, v16
    s_nop 0
    v_add_f32 v16, 1.0, v16
    v_rcp_f32 v16, v16
    s_nop 0
    v_mul_f32 v16, v16, v20
    v_cvt_pk_bf16_f32 v16, v16, v16
    v_lshlrev_b32 v16, 16, v16
    s_mul_i32 s36, s32, 96
    s_sub_u32 s36, s14, s36
    s_max_i32 s36, s36, 0
    s_lshl_b32 s36, s36, 2
    s_add_u32 s36, s36, 156288
    v_mov_b32 v4, s36
    ds_read2st64_b32 v[4:5], v4 offset0:0 offset1:2
    v_lshlrev_b32 v125, 16, v125
    s_waitcnt lgkmcnt(0)
    v_add_f32 v22, v125, v4
    v_cvt_pk_bf16_f32 v22, v22, v22
    v_lshlrev_b32 v22, 16, v22
    v_mul_f32 v22, v22, v5
    v_cvt_pk_bf16_f32 v22, v22, v22
    v_lshlrev_b32 v22, 16, v22
    v_add_f32 v22, v22, v18
    v_cvt_pk_bf16_f32 v22, v22, v22
    v_lshlrev_b32 v22, 16, v22
    v_mul_f32 v18, 0xbfb8aa3b, v22
    v_exp_f32 v18, v18
    s_nop 0
    v_add_f32 v18, 1.0, v18
    v_rcp_f32 v18, v18
    s_nop 0
    v_mul_f32 v18, v18, v22
    v_cvt_pk_bf16_f32 v18, v18, v18
    v_lshlrev_b32 v18, 16, v18
    s_cmp_lg_u32 s13, -1
    s_cselect_b32 s39, 4, 0
    s_cmp_lg_u32 s14, -1
    s_cselect_b32 s36, 4, 0
    s_add_u32 s39, s39, s36
    v_mov_b32 v5, 157956
Lcw_8:
    s_sub_u32 s35, s35, 1
    s_cbranch_scc1 Lend
    ds_read_b32 v6, v5
    s_waitcnt lgkmcnt(0)
    v_readfirstlane_b32 s38, v6
    s_nop 0
    s_cmp_lt_u32 s38, s39
    s_cbranch_scc1 Lcw_8
    v_add_u32 v5, 158208, v12
    ds_read2st64_b32 v[126:127], v5 offset0:0 offset1:1
    s_waitcnt lgkmcnt(0)
    v_fma_f32 v16, v126, v16, v124
    v_cvt_pk_bf16_f32 v16, v16, v16
    s_mul_i32 s36, s13, 1280
    s_lshl_b32 s37, s33, 7
    s_add_u32 s36, s36, s37
    s_cmp_eq_u32 s13, -1
    s_cbranch_scc1 Lrow0
    buffer_store_short v16, v8, s[64:67], s36 offen
Lrow0:
    v_fma_f32 v18, v127, v18, v125
    v_cvt_pk_bf16_f32 v18, v18, v18
    s_mul_i32 s36, s14, 1280
    s_lshl_b32 s37, s33, 7
    s_add_u32 s36, s36, s37
    s_cmp_eq_u32 s14, -1
    s_cbranch_scc1 Lrow1
    buffer_store_short v18, v8, s[64:67], s36 offen
Lrow1:
Lw0_done:
    s_endpgm
Lcomp:
    s_lshl_b32 s43, s26, 1
    s_add_u32 s43, s43, s27
    s_sub_u32 s36, s33, 5
    s_cmp_ge_u32 s33, 5
    s_cselect_b32 s40, s36, s33
    s_mov_b32 s41, 0xbfe10856
    s_cmp_eq_u32 s40, 1
    s_cselect_b32 s41, 0xaff80255, s41
    s_cmp_eq_u32 s40, 2
    s_cselect_b32 s41, 0xabfe4015, s41
    s_cmp_eq_u32 s40, 3
    s_cselect_b32 s41, 0xaa7fd005, s41
    s_cmp_eq_u32 s40, 4
    s_cselect_b32 s41, 0x6adfb401, s41
    s_lshl_b32 s37, s27, 13
    s_cmp_eq_u32 s43, 1
    s_cselect_b32 s37, 0, s37
    v_bfe_u32 v7, v1, 2, 2
    v_and_b32 v8, 3, v1
    v_lshl_add_u32 v18, v2, 3, v7
    v_lshlrev_b32 v18, 7, v18
    v_lshlrev_b32 v19, 2, v1
    v_and_b32 v19, 0x60, v19
    v_lshlrev_b32 v10, 1, v8
    v_add_u32 v9, s37, v18
    v_add_u32 v11, 0, v10
    v_bfe_u32 v11, s41, v11, 2
    v_lshl_add_u32 v11, v11, 2, v8
    v_lshlrev_b32 v11, 3, v11
    v_xad_u32 v20, v11, v19, v9
    v_add_u32 v11, 8, v10
    v_bfe_u32 v11, s41, v11, 2
    v_lshl_add_u32 v11, v11, 2, v8
    v_lshlrev_b32 v11, 3, v11
    v_xad_u32 v21, v11, v19, v9
    v_add_u32 v11, 16, v10
    v_bfe_u32 v11, s41, v11, 2
    v_lshl_add_u32 v11, v11, 2, v8
    v_lshlrev_b32 v11, 3, v11
    v_xad_u32 v22, v11, v19, v9
    v_add_u32 v11, 24, v10
    v_bfe_u32 v11, s41, v11, 2
    v_lshl_add_u32 v11, v11, 2, v8
    v_lshlrev_b32 v11, 3, v11
    v_xad_u32 v23, v11, v19, v9
    v_add_u32 v24, 78080, v20
    v_add_u32 v25, 78080, v21
    v_add_u32 v26, 78080, v22
    v_add_u32 v27, 78080, v23
    v_lshrrev_b32 v10, 1, v3
    v_xor_b32 v9, v10, v2
    v_lshlrev_b32 v9, 4, v9
    v_lshl_add_u32 v9, v3, 7, v9
    s_lshl_b32 s36, s43, 11
    s_xor_b32 s38, s36, 2048
    s_add_u32 s36, s36, 22528
    s_add_u32 s38, s38, 22528
    v_add_u32 v76, s36, v9
    v_add_u32 v78, s38, v9
    s_mul_i32 s39, s26, 6144
    s_add_u32 s39, s39, 98560
    v_add_u32 v125, s39, v13
    s_lshl_b32 s48, s43, 11
    s_add_u32 s48, s48, 139648
    s_waitcnt lgkmcnt(0)
    s_mov_b64 s[28:29], s[24:25]
    s_mov_b32 s30, 268435456
    s_mov_b32 s31, 0x20000
    s_load_dword s34, s[28:29], 0
    s_cmp_eq_u32 s43, 1
    s_cbranch_scc1 Lhalo
    v_xor_b32 v77, 64, v76
    v_xor_b32 v79, 64, v78
    v_add_u32 v80, 78080, v76
    v_add_u32 v81, 78080, v77
    v_add_u32 v82, 78080, v78
    v_add_u32 v83, 78080, v79
    s_cmp_eq_u32 s27, 0
    s_cselect_b64 vcc, 0, -1
    s_sub_u32 s37, 16384, s37
    v_cndmask_b32 v84, v20, v22, vcc
    v_cndmask_b32 v85, v21, v23, vcc
    v_add_u32 v84, s37, v84
    v_add_u32 v85, s37, v85
    v_add_u32 v86, 78080, v84
    v_add_u32 v87, 78080, v85
    v_lshrrev_b32 v8, 1, v2
    v_xor_b32 v8, v8, v10
    v_lshlrev_b32 v8, 4, v8
    v_lshl_add_u32 v8, v3, 7, v8
    v_and_b32 v7, 1, v2
    v_lshl_add_u32 v124, v7, 3, v8
    s_lshl_b32 s49, s42, 12
    s_mov_b32 s38, 0x84736210
    s_mov_b32 s39, 0x95
    s_cmp_eq_u32 s42, 1
    s_cselect_b32 s38, 0x83712065, s38
    s_cselect_b32 s39, 0x94, s39
    s_cmp_eq_u32 s42, 2
    s_cselect_b32 s38, 0x81307564, s38
    s_cselect_b32 s39, 0x92, s39
    s_cmp_eq_u32 s42, 3
    s_cselect_b32 s38, 0x40857362, s38
    s_cselect_b32 s39, 0x91, s39
    s_cmp_eq_u32 s42, 4
    s_cselect_b32 s38, 0x94837261, s38
    s_cselect_b32 s39, 0x50, s39
    s_lshl_b32 s42, s33, 2
    s_lshr_b64 s[38:39], s[38:39], s42
    s_and_b32 s42, s38, 15
    s_and_b32 s38, s42, 3
    s_mul_i32 s38, s38, 39040
    s_add_u32 s38, s38, s36
    v_add_u32 v4, s38, v124
    v_xor_b32 v5, 32, v4
    v_xor_b32 v6, 64, v4
    v_xor_b32 v7, 0x60, v4
    s_mov_b64 s[44:45], s[20:21]
    s_mov_b32 s46, 2621440
    s_mov_b32 s47, 0x20000
    v_mov_b32 v14, 0x3f803f80
    v_mov_b32 v15, 0x3f803f80
    v_mov_b32 v16, 0x3f803f80
    v_mov_b32 v17, 0x3f803f80
    s_mov_b32 s4, 0xaae00455
    s_cmp_eq_u32 s40, 1
    s_cselect_b32 s4, 0xaaf80155, s4
    s_cmp_eq_u32 s40, 2
    s_cselect_b32 s4, 0xaafe4055, s4
    s_cmp_eq_u32 s40, 3
    s_cselect_b32 s4, 0xaabfd055, s4
    s_cmp_eq_u32 s40, 4
    s_cselect_b32 s4, 0xaaeff455, s4
    v_lshlrev_b32 v10, 1, v2
    v_add_u32 v10, 8, v10
    v_bfe_u32 v10, s4, v10, 2
    v_cmp_eq_u32 s[6:7], 0, v10
    v_cmp_eq_u32 s[8:9], 3, v10
    v_cmp_eq_u32 s[10:11], 1, v10
    v_lshlrev_b32 v10, 1, v2
    v_add_u32 v10, 16, v10
    v_bfe_u32 v10, s4, v10, 2
    v_cmp_eq_u32 s[12:13], 0, v10
    v_cmp_eq_u32 s[14:15], 3, v10
    v_cmp_eq_u32 s[16:17], 2, v10
    s_mov_b32 s4, 0xaaaaaaaa
    s_mov_b32 s5, 0xaaaaaaaa
    s_mov_b32 s18, 0xfff0ffff
    s_mov_b32 s19, 0xf000ff00
    s_mov_b32 s20, 0xffc0fffc
    s_mov_b32 s21, 0xc000fc00
    v_mov_b32 v8, 0xffff
    v_not_b32 v9, v8
    v_cndmask_b32 v8, v8, v9, s[4:5]
    v_cndmask_b32 v118, 0, v8, s[18:19]
    v_cndmask_b32 v119, 0, v8, s[20:21]
    v_xor_b32 v116, v118, v8
    v_xor_b32 v117, v119, v8
    s_cmp_eq_u32 s32, 0
    s_cselect_b32 s36, s43, 0
    s_cmp_eq_u32 s36, 2
    s_cselect_b32 s22, 0xff800000, 0
    s_mul_i32 s36, s32, 6
    s_add_u32 s36, s36, s43
    s_sub_u32 s36, s36, 2
    s_lshl_b32 s24, s36, 7
    s_add_u32 s24, s24, 7340032
    s_mul_i32 s50, s36, 20480
    s_add_u32 s50, s50, 4194304
    s_lshl_b32 s36, s33, 11
    s_add_u32 s23, s36, s50
    s_add_u32 s51, s50, s49
    s_add_u32 s49, s49, 4096
    s_cmp_eq_u32 s49, 20480
    s_cselect_b32 s49, 0, s49
    s_add_u32 s52, s50, s49
    s_add_u32 s49, s49, 4096
    s_cmp_eq_u32 s49, 20480
    s_cselect_b32 s49, 0, s49
    s_add_u32 s53, s50, s49
    s_add_u32 s49, s49, 4096
    s_cmp_eq_u32 s49, 20480
    s_cselect_b32 s49, 0, s49
    s_add_u32 s54, s50, s49
    s_add_u32 s49, s49, 4096
    s_cmp_eq_u32 s49, 20480
    s_cselect_b32 s49, 0, s49
    s_add_u32 s55, s50, s49
    s_add_u32 s49, s49, 4096
    s_cmp_eq_u32 s49, 20480
    s_cselect_b32 s49, 0, s49
    s_mul_i32 s36, s32, 10
    s_add_u32 s36, s36, s33
    s_mul_i32 s56, s36, 6144
    s_lshl_b32 s36, s43, 10
    s_add_u32 s56, s56, s36
    s_add_u32 s56, s56, 1046528
    s_sub_u32 s57, s56, 6144
    s_add_u32 s58, s56, 6144
    s_cmp_eq_u32 s40, 0
    s_cselect_b32 s59, 0, -1
    s_cmp_eq_u32 s40, 4
    s_cselect_b32 s60, 0, -1
    s_lshl_b32 s36, s33, 2
    v_mov_b32 v97, s36
    s_mov_b32 s25, 0x3ea52b5c
    s_lshl_b32 s36, s43, 6
    s_add_u32 s36, s36, 156160
    v_lshl_add_u32 v94, v3, 2, s36
    v_and_b32 v8, 1, v1
    v_lshl_add_u32 v8, v2, 2, v8
    v_lshl_add_u32 v8, v8, 2, s36
    v_subrev_u32 v9, 64, v8
    v_cndmask_b32 v92, v9, v8, s[18:19]
    v_cndmask_b32 v93, v9, v8, s[20:21]
    v_lshlrev_b32 v95, 4, v2
    s_lshl_b32 s36, s27, 8
    s_add_u32 s36, s36, 157184
    v_add_u32 v95, s36, v95
    v_mov_b32 v96, 157968
    v_mov_b32 v100, -1
    v_mov_b32 v101, -1
    v_mov_b32 v102, -1
    v_mov_b32 v103, -1
    v_mov_b32 v127, 157984
    s_lshl_b32 s36, s3, 2
    s_add_u32 s36, s36, 158016
    v_mov_b32 v10, s36
    v_xor_b32 v11, 16, v10
    v_cndmask_b32 v127, v127, v11, s[4:5]
    s_waitcnt lgkmcnt(0)
    s_barrier
    ds_read_b128 a[64:67], v76 offset:0
    ds_read_b128 a[68:71], v78 offset:0
    ds_read_b64_tr_b16 a[80:81], v20 offset:0
    ds_read_b64_tr_b16 a[82:83], v20 offset:512
    ds_read_b64_tr_b16 a[84:85], v21 offset:0
    ds_read_b64_tr_b16 a[86:87], v21 offset:512
    ds_read_b64_tr_b16 a[88:89], v22 offset:0
    ds_read_b64_tr_b16 a[90:91], v22 offset:512
    ds_read_b64_tr_b16 a[92:93], v23 offset:0
    ds_read_b64_tr_b16 a[94:95], v23 offset:512
    ds_read_b64_tr_b16 a[96:97], v84 offset:0
    ds_read_b64_tr_b16 a[98:99], v84 offset:512
    ds_read_b64_tr_b16 a[100:101], v85 offset:0
    ds_read_b64_tr_b16 a[102:103], v85 offset:512
    s_add_u32 s34, s34, 0x9e3779b8
    s_or_b32 s34, s34, 1
    s_cmp_eq_u32 s42, 0
    s_cbranch_scc1 Lxe0
Lxe0_b:
    s_setprio 1
    s_waitcnt lgkmcnt(10)
    v_mfma_f32_16x16x32_bf16 v[28:31], a[80:83], a[64:67], 0
    ds_read_b128 a[72:75], v77 offset:0
    ds_read_b128 a[76:79], v79 offset:0
    v_mfma_f32_16x16x32_bf16 v[44:47], a[80:83], a[68:71], 0
    ds_read_b64_tr_b16 a[104:105], v20 offset:4096
    s_waitcnt lgkmcnt(11)
    v_mfma_f32_16x16x32_bf16 v[32:35], a[84:87], a[64:67], 0
    ds_read_b64_tr_b16 a[106:107], v20 offset:4608
    v_mfma_f32_16x16x32_bf16 v[48:51], a[84:87], a[68:71], 0
    ds_read_b64_tr_b16 a[108:109], v21 offset:4096
    s_waitcnt lgkmcnt(11)
    v_mfma_f32_16x16x32_bf16 v[36:39], a[88:91], a[64:67], 0
    ds_read_b64_tr_b16 a[110:111], v21 offset:4608
    ds_read_b64_tr_b16 a[112:113], v22 offset:4096
    v_mfma_f32_16x16x32_bf16 v[52:55], a[88:91], a[68:71], 0
    ds_read_b64_tr_b16 a[114:115], v22 offset:4608
    s_setprio 0
    s_waitcnt lgkmcnt(12)
    v_mfma_f32_16x16x32_bf16 v[40:43], a[92:95], a[64:67], 0
    ds_read_b64_tr_b16 a[116:117], v23 offset:4096
    v_mfma_f32_16x16x32_bf16 v[56:59], a[92:95], a[68:71], 0
    ds_read_b64_tr_b16 a[118:119], v23 offset:4608
    s_waitcnt lgkmcnt(12)
    v_mfma_f32_16x16x32_bf16 v[60:63], a[64:67], a[96:99], 0
    ds_read_b64_tr_b16 a[120:121], v84 offset:4096
    v_mfma_f32_16x16x32_bf16 v[68:71], a[68:71], a[96:99], 0
    ds_read_b64_tr_b16 a[122:123], v84 offset:4608
    s_waitcnt lgkmcnt(12)
    v_mfma_f32_16x16x32_bf16 v[64:67], a[64:67], a[100:103], 0
    ds_read_b64_tr_b16 a[124:125], v85 offset:4096
    v_mfma_f32_16x16x32_bf16 v[72:75], a[68:71], a[100:103], 0
    ds_read_b64_tr_b16 a[126:127], v85 offset:4608
    s_barrier
    s_setprio 3
    s_waitcnt lgkmcnt(10)
    v_mfma_f32_16x16x32_bf16 v[28:31], a[104:107], a[72:75], v[28:31]
    ds_read_b128 a[64:67], v76 offset:39040
    ds_read_b128 a[68:71], v78 offset:39040
    v_mfma_f32_16x16x32_bf16 v[44:47], a[104:107], a[76:79], v[44:47]
    ds_read_b64_tr_b16 a[80:81], v20 offset:39040
    s_waitcnt lgkmcnt(11)
    v_mfma_f32_16x16x32_bf16 v[32:35], a[108:111], a[72:75], v[32:35]
    ds_read_b64_tr_b16 a[82:83], v20 offset:39552
    v_mfma_f32_16x16x32_bf16 v[48:51], a[108:111], a[76:79], v[48:51]
    ds_read_b64_tr_b16 a[84:85], v21 offset:39040
    s_waitcnt lgkmcnt(11)
    v_mfma_f32_16x16x32_bf16 v[36:39], a[112:115], a[72:75], v[36:39]
    ds_read_b64_tr_b16 a[86:87], v21 offset:39552
    v_mfma_f32_16x16x32_bf16 v[52:55], a[112:115], a[76:79], v[52:55]
    ds_read_b64_tr_b16 a[88:89], v22 offset:39040
    s_setprio 2
    s_waitcnt lgkmcnt(11)
    v_mfma_f32_16x16x32_bf16 v[40:43], a[116:119], a[72:75], v[40:43]
    ds_read_b64_tr_b16 a[90:91], v22 offset:39552
    ds_read_b64_tr_b16 a[92:93], v23 offset:39040
    v_mfma_f32_16x16x32_bf16 v[56:59], a[116:119], a[76:79], v[56:59]
    ds_read_b64_tr_b16 a[94:95], v23 offset:39552
    s_waitcnt lgkmcnt(12)
    v_mfma_f32_16x16x32_bf16 v[60:63], a[72:75], a[120:123], v[60:63]
    ds_read_b64_tr_b16 a[96:97], v84 offset:39040
    v_mfma_f32_16x16x32_bf16 v[68:71], a[76:79], a[120:123], v[68:71]
    ds_read_b64_tr_b16 a[98:99], v84 offset:39552
    s_waitcnt lgkmcnt(12)
    v_mfma_f32_16x16x32_bf16 v[64:67], a[72:75], a[124:127], v[64:67]
    ds_read_b64_tr_b16 a[100:101], v85 offset:39040
    v_mfma_f32_16x16x32_bf16 v[72:75], a[76:79], a[124:127], v[72:75]
    ds_read_b64_tr_b16 a[102:103], v85 offset:39552
    s_cmp_eq_u32 s42, 1
    s_cbranch_scc1 Lxe1
Lxe1_b:
    s_setprio 1
    s_waitcnt lgkmcnt(10)
    v_mfma_f32_16x16x32_bf16 v[28:31], a[80:83], a[64:67], v[28:31]
    ds_read_b128 a[72:75], v77 offset:39040
    ds_read_b128 a[76:79], v79 offset:39040
    v_mfma_f32_16x16x32_bf16 v[44:47], a[80:83], a[68:71], v[44:47]
    ds_read_b64_tr_b16 a[104:105], v20 offset:43136
    s_waitcnt lgkmcnt(11)
    v_mfma_f32_16x16x32_bf16 v[32:35], a[84:87], a[64:67], v[32:35]
    ds_read_b64_tr_b16 a[106:107], v20 offset:43648
    v_mfma_f32_16x16x32_bf16 v[48:51], a[84:87], a[68:71], v[48:51]
    ds_read_b64_tr_b16 a[108:109], v21 offset:43136
    s_waitcnt lgkmcnt(11)
    v_mfma_f32_16x16x32_bf16 v[36:39], a[88:91], a[64:67], v[36:39]
    ds_read_b64_tr_b16 a[110:111], v21 offset:43648
    ds_read_b64_tr_b16 a[112:113], v22 offset:43136
    v_mfma_f32_16x16x32_bf16 v[52:55], a[88:91], a[68:71], v[52:55]
    ds_read_b64_tr_b16 a[114:115], v22 offset:43648
    s_setprio 0
    s_waitcnt lgkmcnt(12)
    v_mfma_f32_16x16x32_bf16 v[40:43], a[92:95], a[64:67], v[40:43]
    ds_read_b64_tr_b16 a[116:117], v23 offset:43136
    v_mfma_f32_16x16x32_bf16 v[56:59], a[92:95], a[68:71], v[56:59]
    ds_read_b64_tr_b16 a[118:119], v23 offset:43648
    s_waitcnt lgkmcnt(12)
    v_mfma_f32_16x16x32_bf16 v[60:63], a[64:67], a[96:99], v[60:63]
    ds_read_b64_tr_b16 a[120:121], v84 offset:43136
    v_mfma_f32_16x16x32_bf16 v[68:71], a[68:71], a[96:99], v[68:71]
    ds_read_b64_tr_b16 a[122:123], v84 offset:43648
    s_waitcnt lgkmcnt(12)
    v_mfma_f32_16x16x32_bf16 v[64:67], a[64:67], a[100:103], v[64:67]
    ds_read_b64_tr_b16 a[124:125], v85 offset:43136
    v_mfma_f32_16x16x32_bf16 v[72:75], a[68:71], a[100:103], v[72:75]
    ds_read_b64_tr_b16 a[126:127], v85 offset:43648
    s_barrier
    s_setprio 3
    s_waitcnt lgkmcnt(10)
    v_mfma_f32_16x16x32_bf16 v[28:31], a[104:107], a[72:75], v[28:31]
    ds_read_b128 a[64:67], v80 offset:0
    ds_read_b128 a[68:71], v82 offset:0
    v_mfma_f32_16x16x32_bf16 v[44:47], a[104:107], a[76:79], v[44:47]
    ds_read_b64_tr_b16 a[80:81], v24 offset:0
    s_waitcnt lgkmcnt(11)
    v_mfma_f32_16x16x32_bf16 v[32:35], a[108:111], a[72:75], v[32:35]
    ds_read_b64_tr_b16 a[82:83], v24 offset:512
    v_mfma_f32_16x16x32_bf16 v[48:51], a[108:111], a[76:79], v[48:51]
    ds_read_b64_tr_b16 a[84:85], v25 offset:0
    s_waitcnt lgkmcnt(11)
    v_mfma_f32_16x16x32_bf16 v[36:39], a[112:115], a[72:75], v[36:39]
    ds_read_b64_tr_b16 a[86:87], v25 offset:512
    v_mfma_f32_16x16x32_bf16 v[52:55], a[112:115], a[76:79], v[52:55]
    ds_read_b64_tr_b16 a[88:89], v26 offset:0
    s_setprio 2
    s_waitcnt lgkmcnt(11)
    v_mfma_f32_16x16x32_bf16 v[40:43], a[116:119], a[72:75], v[40:43]
    ds_read_b64_tr_b16 a[90:91], v26 offset:512
    ds_read_b64_tr_b16 a[92:93], v27 offset:0
    v_mfma_f32_16x16x32_bf16 v[56:59], a[116:119], a[76:79], v[56:59]
    ds_read_b64_tr_b16 a[94:95], v27 offset:512
    s_waitcnt lgkmcnt(12)
    v_mfma_f32_16x16x32_bf16 v[60:63], a[72:75], a[120:123], v[60:63]
    ds_read_b64_tr_b16 a[96:97], v86 offset:0
    v_mfma_f32_16x16x32_bf16 v[68:71], a[76:79], a[120:123], v[68:71]
    ds_read_b64_tr_b16 a[98:99], v86 offset:512
    s_waitcnt lgkmcnt(12)
    v_mfma_f32_16x16x32_bf16 v[64:67], a[72:75], a[124:127], v[64:67]
    ds_read_b64_tr_b16 a[100:101], v87 offset:0
    v_mfma_f32_16x16x32_bf16 v[72:75], a[76:79], a[124:127], v[72:75]
    ds_read_b64_tr_b16 a[102:103], v87 offset:512
    buffer_store_dwordx4 v[100:103], v13, s[28:31], s56 offen sc1
    s_cmp_eq_u32 s42, 2
    s_cbranch_scc1 Lxe2
Lxe2_b:
    s_setprio 1
    s_waitcnt lgkmcnt(10)
    v_mfma_f32_16x16x32_bf16 v[28:31], a[80:83], a[64:67], v[28:31]
    ds_read_b128 a[72:75], v81 offset:0
    ds_read_b128 a[76:79], v83 offset:0
    v_mfma_f32_16x16x32_bf16 v[44:47], a[80:83], a[68:71], v[44:47]
    ds_read_b64_tr_b16 a[104:105], v24 offset:4096
    s_waitcnt lgkmcnt(11)
    v_mfma_f32_16x16x32_bf16 v[32:35], a[84:87], a[64:67], v[32:35]
    ds_read_b64_tr_b16 a[106:107], v24 offset:4608
    v_mfma_f32_16x16x32_bf16 v[48:51], a[84:87], a[68:71], v[48:51]
    ds_read_b64_tr_b16 a[108:109], v25 offset:4096
    s_waitcnt lgkmcnt(11)
    v_mfma_f32_16x16x32_bf16 v[36:39], a[88:91], a[64:67], v[36:39]
    ds_read_b64_tr_b16 a[110:111], v25 offset:4608
    ds_read_b64_tr_b16 a[112:113], v26 offset:4096
    v_mfma_f32_16x16x32_bf16 v[52:55], a[88:91], a[68:71], v[52:55]
    ds_read_b64_tr_b16 a[114:115], v26 offset:4608
    s_setprio 0
    s_waitcnt lgkmcnt(12)
    v_mfma_f32_16x16x32_bf16 v[40:43], a[92:95], a[64:67], v[40:43]
    ds_read_b64_tr_b16 a[116:117], v27 offset:4096
    v_mfma_f32_16x16x32_bf16 v[56:59], a[92:95], a[68:71], v[56:59]
    ds_read_b64_tr_b16 a[118:119], v27 offset:4608
    s_waitcnt lgkmcnt(12)
    v_mfma_f32_16x16x32_bf16 v[60:63], a[64:67], a[96:99], v[60:63]
    ds_read_b64_tr_b16 a[120:121], v86 offset:4096
    v_mfma_f32_16x16x32_bf16 v[68:71], a[68:71], a[96:99], v[68:71]
    ds_read_b64_tr_b16 a[122:123], v86 offset:4608
    s_waitcnt lgkmcnt(12)
    v_mfma_f32_16x16x32_bf16 v[64:67], a[64:67], a[100:103], v[64:67]
    ds_read_b64_tr_b16 a[124:125], v87 offset:4096
    v_mfma_f32_16x16x32_bf16 v[72:75], a[68:71], a[100:103], v[72:75]
    ds_read_b64_tr_b16 a[126:127], v87 offset:4608
    s_barrier
    s_setprio 3
    s_waitcnt lgkmcnt(10)
    v_mfma_f32_16x16x32_bf16 v[28:31], a[104:107], a[72:75], v[28:31]
    ds_read_b128 a[64:67], v80 offset:39040
    ds_read_b128 a[68:71], v82 offset:39040
    v_mfma_f32_16x16x32_bf16 v[44:47], a[104:107], a[76:79], v[44:47]
    ds_read_b64_tr_b16 a[80:81], v24 offset:39040
    s_waitcnt lgkmcnt(11)
    v_mfma_f32_16x16x32_bf16 v[32:35], a[108:111], a[72:75], v[32:35]
    ds_read_b64_tr_b16 a[82:83], v24 offset:39552
    v_mfma_f32_16x16x32_bf16 v[48:51], a[108:111], a[76:79], v[48:51]
    ds_read_b64_tr_b16 a[84:85], v25 offset:39040
    s_waitcnt lgkmcnt(11)
    v_mfma_f32_16x16x32_bf16 v[36:39], a[112:115], a[72:75], v[36:39]
    ds_read_b64_tr_b16 a[86:87], v25 offset:39552
    v_mfma_f32_16x16x32_bf16 v[52:55], a[112:115], a[76:79], v[52:55]
    ds_read_b64_tr_b16 a[88:89], v26 offset:39040
    s_setprio 2
    s_waitcnt lgkmcnt(11)
    v_mfma_f32_16x16x32_bf16 v[40:43], a[116:119], a[72:75], v[40:43]
    ds_read_b64_tr_b16 a[90:91], v26 offset:39552
    ds_read_b64_tr_b16 a[92:93], v27 offset:39040
    v_mfma_f32_16x16x32_bf16 v[56:59], a[116:119], a[76:79], v[56:59]
    ds_read_b64_tr_b16 a[94:95], v27 offset:39552
    s_waitcnt lgkmcnt(12)
    v_mfma_f32_16x16x32_bf16 v[60:63], a[72:75], a[120:123], v[60:63]
    ds_read_b64_tr_b16 a[96:97], v86 offset:39040
    v_mfma_f32_16x16x32_bf16 v[68:71], a[76:79], a[120:123], v[68:71]
    ds_read_b64_tr_b16 a[98:99], v86 offset:39552
    s_waitcnt lgkmcnt(12)
    v_mfma_f32_16x16x32_bf16 v[64:67], a[72:75], a[124:127], v[64:67]
    ds_read_b64_tr_b16 a[100:101], v87 offset:39040
    v_mfma_f32_16x16x32_bf16 v[72:75], a[76:79], a[124:127], v[72:75]
    ds_read_b64_tr_b16 a[102:103], v87 offset:39552
    s_cmp_eq_u32 s42, 3
    s_cbranch_scc1 Lxe3
Lxe3_b:
    s_setprio 1
    s_waitcnt lgkmcnt(10)
    v_mfma_f32_16x16x32_bf16 v[28:31], a[80:83], a[64:67], v[28:31]
    ds_read_b128 a[72:75], v81 offset:39040
    ds_read_b128 a[76:79], v83 offset:39040
    v_mfma_f32_16x16x32_bf16 v[44:47], a[80:83], a[68:71], v[44:47]
    ds_read_b64_tr_b16 a[104:105], v24 offset:43136
    s_waitcnt lgkmcnt(11)
    v_mfma_f32_16x16x32_bf16 v[32:35], a[84:87], a[64:67], v[32:35]
    ds_read_b64_tr_b16 a[106:107], v24 offset:43648
    v_mfma_f32_16x16x32_bf16 v[48:51], a[84:87], a[68:71], v[48:51]
    ds_read_b64_tr_b16 a[108:109], v25 offset:43136
    s_waitcnt lgkmcnt(11)
    v_mfma_f32_16x16x32_bf16 v[36:39], a[88:91], a[64:67], v[36:39]
    ds_read_b64_tr_b16 a[110:111], v25 offset:43648
    ds_read_b64_tr_b16 a[112:113], v26 offset:43136
    v_mfma_f32_16x16x32_bf16 v[52:55], a[88:91], a[68:71], v[52:55]
    ds_read_b64_tr_b16 a[114:115], v26 offset:43648
    s_setprio 0
    s_waitcnt lgkmcnt(12)
    v_mfma_f32_16x16x32_bf16 v[40:43], a[92:95], a[64:67], v[40:43]
    ds_read_b64_tr_b16 a[116:117], v27 offset:43136
    v_mfma_f32_16x16x32_bf16 v[56:59], a[92:95], a[68:71], v[56:59]
    ds_read_b64_tr_b16 a[118:119], v27 offset:43648
    s_waitcnt lgkmcnt(12)
    v_mfma_f32_16x16x32_bf16 v[60:63], a[64:67], a[96:99], v[60:63]
    ds_read_b64_tr_b16 a[120:121], v86 offset:43136
    v_mfma_f32_16x16x32_bf16 v[68:71], a[68:71], a[96:99], v[68:71]
    ds_read_b64_tr_b16 a[122:123], v86 offset:43648
    s_waitcnt lgkmcnt(12)
    v_mfma_f32_16x16x32_bf16 v[64:67], a[64:67], a[100:103], v[64:67]
    ds_read_b64_tr_b16 a[124:125], v87 offset:43136
    v_mfma_f32_16x16x32_bf16 v[72:75], a[68:71], a[100:103], v[72:75]
    ds_read_b64_tr_b16 a[126:127], v87 offset:43648
    s_barrier
    s_setprio 3
    s_waitcnt lgkmcnt(10)
    v_mfma_f32_16x16x32_bf16 v[28:31], a[104:107], a[72:75], v[28:31]
    ds_read_b128 a[64:67], v76 offset:0
    ds_read_b128 a[68:71], v78 offset:0
    v_mfma_f32_16x16x32_bf16 v[44:47], a[104:107], a[76:79], v[44:47]
    ds_read_b64_tr_b16 a[80:81], v20 offset:0
    s_waitcnt lgkmcnt(11)
    v_mfma_f32_16x16x32_bf16 v[32:35], a[108:111], a[72:75], v[32:35]
    ds_read_b64_tr_b16 a[82:83], v20 offset:512
    v_mfma_f32_16x16x32_bf16 v[48:51], a[108:111], a[76:79], v[48:51]
    ds_read_b64_tr_b16 a[84:85], v21 offset:0
    s_waitcnt lgkmcnt(11)
    v_mfma_f32_16x16x32_bf16 v[36:39], a[112:115], a[72:75], v[36:39]
    ds_read_b64_tr_b16 a[86:87], v21 offset:512
    v_mfma_f32_16x16x32_bf16 v[52:55], a[112:115], a[76:79], v[52:55]
    ds_read_b64_tr_b16 a[88:89], v22 offset:0
    s_setprio 2
    s_waitcnt lgkmcnt(11)
    v_mfma_f32_16x16x32_bf16 v[40:43], a[116:119], a[72:75], v[40:43]
    ds_read_b64_tr_b16 a[90:91], v22 offset:512
    ds_read_b64_tr_b16 a[92:93], v23 offset:0
    v_mfma_f32_16x16x32_bf16 v[56:59], a[116:119], a[76:79], v[56:59]
    ds_read_b64_tr_b16 a[94:95], v23 offset:512
    s_waitcnt lgkmcnt(12)
    v_mfma_f32_16x16x32_bf16 v[60:63], a[72:75], a[120:123], v[60:63]
    ds_read_b64_tr_b16 a[96:97], v84 offset:0
    v_mfma_f32_16x16x32_bf16 v[68:71], a[76:79], a[120:123], v[68:71]
    ds_read_b64_tr_b16 a[98:99], v84 offset:512
    s_waitcnt lgkmcnt(12)
    v_mfma_f32_16x16x32_bf16 v[64:67], a[72:75], a[124:127], v[64:67]
    ds_read_b64_tr_b16 a[100:101], v85 offset:0
    v_mfma_f32_16x16x32_bf16 v[72:75], a[76:79], a[124:127], v[72:75]
    ds_read_b64_tr_b16 a[102:103], v85 offset:512
    buffer_store_dwordx4 v[100:103], v13, s[28:31], s23 offen offset:0 sc1
    s_cmp_eq_u32 s42, 4
    s_cbranch_scc1 Lxe4
Lxe4_b:
    s_setprio 1
    s_waitcnt lgkmcnt(10)
    v_mfma_f32_16x16x32_bf16 v[28:31], a[80:83], a[64:67], v[28:31]
    ds_read_b128 a[72:75], v77 offset:0
    ds_read_b128 a[76:79], v79 offset:0
    v_mfma_f32_16x16x32_bf16 v[44:47], a[80:83], a[68:71], v[44:47]
    ds_read_b64_tr_b16 a[104:105], v20 offset:4096
    s_waitcnt lgkmcnt(11)
    v_mfma_f32_16x16x32_bf16 v[32:35], a[84:87], a[64:67], v[32:35]
    ds_read_b64_tr_b16 a[106:107], v20 offset:4608
    v_mfma_f32_16x16x32_bf16 v[48:51], a[84:87], a[68:71], v[48:51]
    ds_read_b64_tr_b16 a[108:109], v21 offset:4096
    s_waitcnt lgkmcnt(11)
    v_mfma_f32_16x16x32_bf16 v[36:39], a[88:91], a[64:67], v[36:39]
    ds_read_b64_tr_b16 a[110:111], v21 offset:4608
    ds_read_b64_tr_b16 a[112:113], v22 offset:4096
    v_mfma_f32_16x16x32_bf16 v[52:55], a[88:91], a[68:71], v[52:55]
    ds_read_b64_tr_b16 a[114:115], v22 offset:4608
    s_setprio 0
    s_waitcnt lgkmcnt(12)
    v_mfma_f32_16x16x32_bf16 v[40:43], a[92:95], a[64:67], v[40:43]
    ds_read_b64_tr_b16 a[116:117], v23 offset:4096
    v_mfma_f32_16x16x32_bf16 v[56:59], a[92:95], a[68:71], v[56:59]
    ds_read_b64_tr_b16 a[118:119], v23 offset:4608
    s_waitcnt lgkmcnt(12)
    v_mfma_f32_16x16x32_bf16 v[60:63], a[64:67], a[96:99], v[60:63]
    ds_read_b64_tr_b16 a[120:121], v84 offset:4096
    v_mfma_f32_16x16x32_bf16 v[68:71], a[68:71], a[96:99], v[68:71]
    ds_read_b64_tr_b16 a[122:123], v84 offset:4608
    s_waitcnt lgkmcnt(12)
    v_mfma_f32_16x16x32_bf16 v[64:67], a[64:67], a[100:103], v[64:67]
    ds_read_b64_tr_b16 a[124:125], v85 offset:4096
    v_mfma_f32_16x16x32_bf16 v[72:75], a[68:71], a[100:103], v[72:75]
    ds_read_b64_tr_b16 a[126:127], v85 offset:4608
    s_barrier
    s_setprio 3
    s_waitcnt lgkmcnt(10)
    v_mfma_f32_16x16x32_bf16 v[28:31], a[104:107], a[72:75], v[28:31]
    ds_read_b128 a[64:67], v76 offset:39040
    ds_read_b128 a[68:71], v78 offset:39040
    v_mfma_f32_16x16x32_bf16 v[44:47], a[104:107], a[76:79], v[44:47]
    ds_read_b64_tr_b16 a[80:81], v20 offset:39040
    s_waitcnt lgkmcnt(11)
    v_mfma_f32_16x16x32_bf16 v[32:35], a[108:111], a[72:75], v[32:35]
    ds_read_b64_tr_b16 a[82:83], v20 offset:39552
    v_mfma_f32_16x16x32_bf16 v[48:51], a[108:111], a[76:79], v[48:51]
    ds_read_b64_tr_b16 a[84:85], v21 offset:39040
    s_waitcnt lgkmcnt(11)
    v_mfma_f32_16x16x32_bf16 v[36:39], a[112:115], a[72:75], v[36:39]
    ds_read_b64_tr_b16 a[86:87], v21 offset:39552
    v_mfma_f32_16x16x32_bf16 v[52:55], a[112:115], a[76:79], v[52:55]
    ds_read_b64_tr_b16 a[88:89], v22 offset:39040
    s_setprio 2
    s_waitcnt lgkmcnt(11)
    v_mfma_f32_16x16x32_bf16 v[40:43], a[116:119], a[72:75], v[40:43]
    ds_read_b64_tr_b16 a[90:91], v22 offset:39552
    ds_read_b64_tr_b16 a[92:93], v23 offset:39040
    v_mfma_f32_16x16x32_bf16 v[56:59], a[116:119], a[76:79], v[56:59]
    ds_read_b64_tr_b16 a[94:95], v23 offset:39552
    s_waitcnt lgkmcnt(12)
    v_mfma_f32_16x16x32_bf16 v[60:63], a[72:75], a[120:123], v[60:63]
    ds_read_b64_tr_b16 a[96:97], v84 offset:39040
    v_mfma_f32_16x16x32_bf16 v[68:71], a[76:79], a[120:123], v[68:71]
    ds_read_b64_tr_b16 a[98:99], v84 offset:39552
    s_waitcnt lgkmcnt(12)
    v_mfma_f32_16x16x32_bf16 v[64:67], a[72:75], a[124:127], v[64:67]
    ds_read_b64_tr_b16 a[100:101], v85 offset:39040
    v_mfma_f32_16x16x32_bf16 v[72:75], a[76:79], a[124:127], v[72:75]
    ds_read_b64_tr_b16 a[102:103], v85 offset:39552
    s_cmp_eq_u32 s42, 5
    s_cbranch_scc1 Lxe5
Lxe5_b:
    s_setprio 1
    s_waitcnt lgkmcnt(10)
    v_mfma_f32_16x16x32_bf16 v[28:31], a[80:83], a[64:67], v[28:31]
    ds_read_b128 a[72:75], v77 offset:39040
    ds_read_b128 a[76:79], v79 offset:39040
    v_mfma_f32_16x16x32_bf16 v[44:47], a[80:83], a[68:71], v[44:47]
    ds_read_b64_tr_b16 a[104:105], v20 offset:43136
    s_waitcnt lgkmcnt(11)
    v_mfma_f32_16x16x32_bf16 v[32:35], a[84:87], a[64:67], v[32:35]
    ds_read_b64_tr_b16 a[106:107], v20 offset:43648
    v_mfma_f32_16x16x32_bf16 v[48:51], a[84:87], a[68:71], v[48:51]
    ds_read_b64_tr_b16 a[108:109], v21 offset:43136
    s_waitcnt lgkmcnt(11)
    v_mfma_f32_16x16x32_bf16 v[36:39], a[88:91], a[64:67], v[36:39]
    ds_read_b64_tr_b16 a[110:111], v21 offset:43648
    ds_read_b64_tr_b16 a[112:113], v22 offset:43136
    v_mfma_f32_16x16x32_bf16 v[52:55], a[88:91], a[68:71], v[52:55]
    ds_read_b64_tr_b16 a[114:115], v22 offset:43648
    s_setprio 0
    s_waitcnt lgkmcnt(12)
    v_mfma_f32_16x16x32_bf16 v[40:43], a[92:95], a[64:67], v[40:43]
    ds_read_b64_tr_b16 a[116:117], v23 offset:43136
    v_mfma_f32_16x16x32_bf16 v[56:59], a[92:95], a[68:71], v[56:59]
    ds_read_b64_tr_b16 a[118:119], v23 offset:43648
    s_waitcnt lgkmcnt(12)
    v_mfma_f32_16x16x32_bf16 v[60:63], a[64:67], a[96:99], v[60:63]
    ds_read_b64_tr_b16 a[120:121], v84 offset:43136
    v_mfma_f32_16x16x32_bf16 v[68:71], a[68:71], a[96:99], v[68:71]
    ds_read_b64_tr_b16 a[122:123], v84 offset:43648
    s_waitcnt lgkmcnt(12)
    v_mfma_f32_16x16x32_bf16 v[64:67], a[64:67], a[100:103], v[64:67]
    ds_read_b64_tr_b16 a[124:125], v85 offset:43136
    v_mfma_f32_16x16x32_bf16 v[72:75], a[68:71], a[100:103], v[72:75]
    ds_read_b64_tr_b16 a[126:127], v85 offset:43648
    s_barrier
    s_setprio 3
    s_waitcnt lgkmcnt(10)
    v_mfma_f32_16x16x32_bf16 v[28:31], a[104:107], a[72:75], v[28:31]
    ds_read_b128 a[0:3], v80 offset:0
    v_mfma_f32_16x16x32_bf16 v[44:47], a[104:107], a[76:79], v[44:47]
    ds_read_b128 a[4:7], v82 offset:0
    s_waitcnt lgkmcnt(10)
    v_mfma_f32_16x16x32_bf16 v[32:35], a[108:111], a[72:75], v[32:35]
    ds_read_b64_tr_b16 a[80:81], v24 offset:0
    v_mfma_f32_16x16x32_bf16 v[48:51], a[108:111], a[76:79], v[48:51]
    ds_read_b64_tr_b16 a[82:83], v24 offset:512
    s_waitcnt lgkmcnt(10)
    v_mfma_f32_16x16x32_bf16 v[36:39], a[112:115], a[72:75], v[36:39]
    ds_read_b64_tr_b16 a[84:85], v25 offset:0
    v_mfma_f32_16x16x32_bf16 v[52:55], a[112:115], a[76:79], v[52:55]
    s_setprio 2
    s_waitcnt lgkmcnt(9)
    v_mfma_f32_16x16x32_bf16 v[40:43], a[116:119], a[72:75], v[40:43]
    ds_read_b64_tr_b16 a[86:87], v25 offset:512
    v_mfma_f32_16x16x32_bf16 v[56:59], a[116:119], a[76:79], v[56:59]
    ds_read_b64_tr_b16 a[88:89], v26 offset:0
    s_waitcnt lgkmcnt(9)
    v_mfma_f32_16x16x32_bf16 v[60:63], a[72:75], a[120:123], v[60:63]
    ds_read_b64_tr_b16 a[90:91], v26 offset:512
    v_mfma_f32_16x16x32_bf16 v[68:71], a[76:79], a[120:123], v[68:71]
    ds_read_b64_tr_b16 a[92:93], v27 offset:0
    s_waitcnt lgkmcnt(9)
    v_mfma_f32_16x16x32_bf16 v[64:67], a[72:75], a[124:127], v[64:67]
    ds_read_b64_tr_b16 a[94:95], v27 offset:512
    v_mfma_f32_16x16x32_bf16 v[72:75], a[76:79], a[124:127], v[72:75]
    buffer_store_dwordx4 v[100:103], v13, s[28:31], s23 offen offset:1024 sc1
    s_cmp_eq_u32 s42, 6
    s_cbranch_scc1 Lxe6
Lxe6_b:
    s_setprio 1
    s_waitcnt lgkmcnt(6)
    v_mfma_f32_16x16x32_bf16 v[28:31], a[80:83], a[0:3], v[28:31]
    ds_read_b128 a[8:11], v81 offset:0
    ds_read_b128 a[12:15], v83 offset:0
    v_mfma_f32_16x16x32_bf16 v[44:47], a[80:83], a[4:7], v[44:47]
    ds_read_b64_tr_b16 a[104:105], v24 offset:4096
    s_waitcnt lgkmcnt(7)
    v_mfma_f32_16x16x32_bf16 v[32:35], a[84:87], a[0:3], v[32:35]
    ds_read_b64_tr_b16 a[106:107], v24 offset:4608
    ds_read_b64_tr_b16 a[108:109], v25 offset:4096
    v_mfma_f32_16x16x32_bf16 v[48:51], a[84:87], a[4:7], v[48:51]
    ds_read_b64_tr_b16 a[110:111], v25 offset:4608
    s_setprio 0
    s_waitcnt lgkmcnt(8)
    v_mfma_f32_16x16x32_bf16 v[36:39], a[88:91], a[0:3], v[36:39]
    v_mfma_f32_16x16x32_bf16 v[52:55], a[88:91], a[4:7], v[52:55]
    ds_read_b64_tr_b16 a[112:113], v26 offset:4096
    ds_read_b64_tr_b16 a[114:115], v26 offset:4608
    s_waitcnt lgkmcnt(8)
    v_mfma_f32_16x16x32_bf16 v[40:43], a[92:95], a[0:3], v[40:43]
    ds_read_b64_tr_b16 a[116:117], v27 offset:4096
    v_mfma_f32_16x16x32_bf16 v[56:59], a[92:95], a[4:7], v[56:59]
    ds_read_b64_tr_b16 a[118:119], v27 offset:4608
    s_barrier
    s_setprio 3
    s_waitcnt lgkmcnt(6)
    v_mfma_f32_16x16x32_bf16 v[28:31], a[104:107], a[8:11], v[28:31]
    ds_read_b128 a[16:19], v80 offset:39040
    ds_read_b128 a[20:23], v82 offset:39040
    v_mfma_f32_16x16x32_bf16 v[44:47], a[104:107], a[12:15], v[44:47]
    ds_read_b64_tr_b16 a[80:81], v24 offset:39040
    s_waitcnt lgkmcnt(7)
    v_mfma_f32_16x16x32_bf16 v[32:35], a[108:111], a[8:11], v[32:35]
    ds_read_b64_tr_b16 a[82:83], v24 offset:39552
    v_mfma_f32_16x16x32_bf16 v[48:51], a[108:111], a[12:15], v[48:51]
    ds_read_b64_tr_b16 a[84:85], v25 offset:39040
    s_setprio 2
    s_waitcnt lgkmcnt(7)
    v_mfma_f32_16x16x32_bf16 v[36:39], a[112:115], a[8:11], v[36:39]
    ds_read_b64_tr_b16 a[86:87], v25 offset:39552
    ds_read_b64_tr_b16 a[88:89], v26 offset:39040
    v_mfma_f32_16x16x32_bf16 v[52:55], a[112:115], a[12:15], v[52:55]
    ds_read_b64_tr_b16 a[90:91], v26 offset:39552
    s_waitcnt lgkmcnt(8)
    v_mfma_f32_16x16x32_bf16 v[40:43], a[116:119], a[8:11], v[40:43]
    ds_read_b64_tr_b16 a[92:93], v27 offset:39040
    v_mfma_f32_16x16x32_bf16 v[56:59], a[116:119], a[12:15], v[56:59]
    ds_read_b64_tr_b16 a[94:95], v27 offset:39552
    s_cmp_eq_u32 s42, 7
    s_cbranch_scc1 Lxe7
Lxe7_b:
    s_setprio 1
    s_waitcnt lgkmcnt(6)
    v_mfma_f32_16x16x32_bf16 v[28:31], a[80:83], a[16:19], v[28:31]
    ds_read_b128 a[24:27], v81 offset:39040
    ds_read_b128 a[28:31], v83 offset:39040
    v_mfma_f32_16x16x32_bf16 v[44:47], a[80:83], a[20:23], v[44:47]
    ds_read_b64_tr_b16 a[104:105], v24 offset:43136
    s_waitcnt lgkmcnt(7)
    v_mfma_f32_16x16x32_bf16 v[32:35], a[84:87], a[16:19], v[32:35]
    ds_read_b64_tr_b16 a[106:107], v24 offset:43648
    ds_read_b64_tr_b16 a[108:109], v25 offset:43136
    v_mfma_f32_16x16x32_bf16 v[48:51], a[84:87], a[20:23], v[48:51]
    ds_read_b64_tr_b16 a[110:111], v25 offset:43648
    s_setprio 0
    s_waitcnt lgkmcnt(8)
    v_mfma_f32_16x16x32_bf16 v[36:39], a[88:91], a[16:19], v[36:39]
    v_mfma_f32_16x16x32_bf16 v[52:55], a[88:91], a[20:23], v[52:55]
    ds_read_b64_tr_b16 a[112:113], v26 offset:43136
    ds_read_b64_tr_b16 a[114:115], v26 offset:43648
    s_waitcnt lgkmcnt(8)
    v_mfma_f32_16x16x32_bf16 v[40:43], a[92:95], a[16:19], v[40:43]
    ds_read_b64_tr_b16 a[116:117], v27 offset:43136
    v_mfma_f32_16x16x32_bf16 v[56:59], a[92:95], a[20:23], v[56:59]
    ds_read_b64_tr_b16 a[118:119], v27 offset:43648
    s_barrier
    s_setprio 3
    s_waitcnt lgkmcnt(6)
    v_mfma_f32_16x16x32_bf16 v[28:31], a[104:107], a[24:27], v[28:31]
    ds_read_b128 a[32:35], v76 offset:0
    ds_read_b128 a[36:39], v78 offset:0
    v_mfma_f32_16x16x32_bf16 v[44:47], a[104:107], a[28:31], v[44:47]
    ds_read_b64_tr_b16 a[80:81], v20 offset:0
    s_waitcnt lgkmcnt(7)
    v_mfma_f32_16x16x32_bf16 v[32:35], a[108:111], a[24:27], v[32:35]
    ds_read_b64_tr_b16 a[82:83], v20 offset:512
    v_mfma_f32_16x16x32_bf16 v[48:51], a[108:111], a[28:31], v[48:51]
    ds_read_b64_tr_b16 a[84:85], v21 offset:0
    s_setprio 2
    s_waitcnt lgkmcnt(7)
    v_mfma_f32_16x16x32_bf16 v[36:39], a[112:115], a[24:27], v[36:39]
    ds_read_b64_tr_b16 a[86:87], v21 offset:512
    ds_read_b64_tr_b16 a[88:89], v22 offset:0
    v_mfma_f32_16x16x32_bf16 v[52:55], a[112:115], a[28:31], v[52:55]
    ds_read_b64_tr_b16 a[90:91], v22 offset:512
    s_waitcnt lgkmcnt(8)
    v_mfma_f32_16x16x32_bf16 v[40:43], a[116:119], a[24:27], v[40:43]
    ds_read_b64_tr_b16 a[92:93], v23 offset:0
    v_mfma_f32_16x16x32_bf16 v[56:59], a[116:119], a[28:31], v[56:59]
    ds_read_b64_tr_b16 a[94:95], v23 offset:512
    s_cmp_eq_u32 s42, 8
    s_cbranch_scc1 Lxe8
Lxe8_b:
    s_setprio 1
    s_waitcnt lgkmcnt(6)
    v_mfma_f32_16x16x32_bf16 v[28:31], a[80:83], a[32:35], v[28:31]
    ds_read_b128 a[40:43], v77 offset:0
    ds_read_b128 a[44:47], v79 offset:0
    v_mfma_f32_16x16x32_bf16 v[44:47], a[80:83], a[36:39], v[44:47]
    ds_read_b64_tr_b16 a[104:105], v20 offset:4096
    s_waitcnt lgkmcnt(7)
    v_mfma_f32_16x16x32_bf16 v[32:35], a[84:87], a[32:35], v[32:35]
    ds_read_b64_tr_b16 a[106:107], v20 offset:4608
    v_mfma_f32_16x16x32_bf16 v[48:51], a[84:87], a[36:39], v[48:51]
    ds_read_b64_tr_b16 a[108:109], v21 offset:4096
    s_setprio 0
    s_waitcnt lgkmcnt(7)
    v_mfma_f32_16x16x32_bf16 v[36:39], a[88:91], a[32:35], v[36:39]
    ds_read_b64_tr_b16 a[110:111], v21 offset:4608
    ds_read_b64_tr_b16 a[112:113], v22 offset:4096
    v_mfma_f32_16x16x32_bf16 v[52:55], a[88:91], a[36:39], v[52:55]
    ds_read_b64_tr_b16 a[114:115], v22 offset:4608
    s_waitcnt lgkmcnt(8)
    v_mfma_f32_16x16x32_bf16 v[40:43], a[92:95], a[32:35], v[40:43]
    ds_read_b64_tr_b16 a[116:117], v23 offset:4096
    v_mfma_f32_16x16x32_bf16 v[56:59], a[92:95], a[36:39], v[56:59]
    ds_read_b64_tr_b16 a[118:119], v23 offset:4608
    s_waitcnt lgkmcnt(0)
    s_barrier
    s_setprio 3
    v_mfma_f32_16x16x32_bf16 v[28:31], a[104:107], a[40:43], v[28:31]
    ds_read_b128 a[48:51], v76 offset:39040
    ds_read_b128 a[52:55], v78 offset:39040
    v_mfma_f32_16x16x32_bf16 v[44:47], a[104:107], a[44:47], v[44:47]
    ds_read_b64_tr_b16 a[80:81], v20 offset:39040
    v_mfma_f32_16x16x32_bf16 v[32:35], a[108:111], a[40:43], v[32:35]
    ds_read_b64_tr_b16 a[82:83], v20 offset:39552
    v_mfma_f32_16x16x32_bf16 v[48:51], a[108:111], a[44:47], v[48:51]
    ds_read_b64_tr_b16 a[84:85], v21 offset:39040
    s_setprio 2
    v_mfma_f32_16x16x32_bf16 v[36:39], a[112:115], a[40:43], v[36:39]
    ds_read_b64_tr_b16 a[86:87], v21 offset:39552
    ds_read_b64_tr_b16 a[88:89], v22 offset:39040
    v_mfma_f32_16x16x32_bf16 v[52:55], a[112:115], a[44:47], v[52:55]
    ds_read_b64_tr_b16 a[90:91], v22 offset:39552
    v_mfma_f32_16x16x32_bf16 v[40:43], a[116:119], a[40:43], v[40:43]
    ds_read_b64_tr_b16 a[92:93], v23 offset:39040
    v_mfma_f32_16x16x32_bf16 v[56:59], a[116:119], a[44:47], v[56:59]
    ds_read_b64_tr_b16 a[94:95], v23 offset:39552
    v_mov_b32 v98, s34
    s_waitcnt vmcnt(0)
    s_mov_b64 exec, 1
    buffer_store_dword v98, v97, s[28:31], s24 offen sc1
    s_mov_b64 exec, -1
    s_cmp_eq_u32 s42, 9
    s_cbranch_scc1 Lxe9
Lxe9_b:
    s_setprio 1
    s_waitcnt lgkmcnt(6)
    v_mfma_f32_16x16x32_bf16 v[28:31], a[80:83], a[48:51], v[28:31]
    ds_read_b128 a[56:59], v77 offset:39040
    ds_read_b128 a[60:63], v79 offset:39040
    ds_read_b64_tr_b16 a[104:105], v20 offset:43136
    v_mfma_f32_16x16x32_bf16 v[44:47], a[80:83], a[52:55], v[44:47]
    ds_read_b64_tr_b16 a[106:107], v20 offset:43648
    ds_read_b64_tr_b16 a[108:109], v21 offset:43136
    s_waitcnt lgkmcnt(9)
    v_mfma_f32_16x16x32_bf16 v[32:35], a[84:87], a[48:51], v[32:35]
    ds_read_b64_tr_b16 a[110:111], v21 offset:43648
    ds_read_b64_tr_b16 a[112:113], v22 offset:43136
    ds_read_b64_tr_b16 a[114:115], v22 offset:43648
    v_mfma_f32_16x16x32_bf16 v[48:51], a[84:87], a[52:55], v[48:51]
    ds_read_b64_tr_b16 a[116:117], v23 offset:43136
    ds_read_b64_tr_b16 a[118:119], v23 offset:43648
    s_setprio 0
    s_waitcnt lgkmcnt(12)
    v_mfma_f32_16x16x32_bf16 v[36:39], a[88:91], a[48:51], v[36:39]
    ds_read_b32 v120, v94
    ds_read_b32 v121, v94 offset:512
    v_xor_b32 v94, 64, v94
    v_mfma_f32_16x16x32_bf16 v[52:55], a[88:91], a[52:55], v[52:55]
    ds_read_b32 v122, v94
    ds_read_b32 v123, v92 offset:512
    s_waitcnt lgkmcnt(14)
    v_mfma_f32_16x16x32_bf16 v[40:43], a[92:95], a[48:51], v[40:43]
    ds_read_b32 v126, v93 offset:520
    v_mov_b32 v24, v84
    v_mov_b32 v25, v85
    v_mfma_f32_16x16x32_bf16 v[56:59], a[92:95], a[52:55], v[56:59]
    v_mov_b32 v26, v86
    v_mov_b32 v27, v87
    s_waitcnt lgkmcnt(5)
    v_mfma_f32_16x16x32_bf16 v[44:47], a[104:107], a[60:63], v[44:47]
    v_mfma_f32_16x16x32_bf16 v[48:51], a[108:111], a[60:63], v[48:51]
    v_mfma_f32_16x16x32_bf16 v[52:55], a[112:115], a[60:63], v[52:55]
    v_mfma_f32_16x16x32_bf16 v[56:59], a[116:119], a[60:63], v[56:59]
    v_mfma_f32_16x16x32_bf16 v[28:31], a[104:107], a[56:59], v[28:31]
    v_mfma_f32_16x16x32_bf16 v[32:35], a[108:111], a[56:59], v[32:35]
    ds_read_b32 v7, v96
    ds_read_b128 v[76:79], v95 offset:0
    ds_read_b128 v[80:83], v95 offset:64
    ds_read_b128 v[84:87], v95 offset:128
    ds_read_b128 v[88:91], v95 offset:192
    v_mfma_f32_16x16x32_bf16 v[36:39], a[112:115], a[56:59], v[36:39]
    v_mfma_f32_16x16x32_bf16 v[40:43], a[116:119], a[56:59], v[40:43]
    s_waitcnt lgkmcnt(0)
Lqf:
    v_readfirstlane_b32 s38, v7
    s_nop 0
    s_cmp_eq_u32 s38, 0
    s_cbranch_scc1 Lqf_re
    s_cmp_eq_u32 s27, 0
    v_fmac_f32 v44, v76, v122
    v_fmac_f32 v45, v77, v122
    v_fmac_f32 v46, v78, v122
    v_fmac_f32 v47, v79, v122
    v_cvt_pk_bf16_f32 v44, v44, v45
    v_cvt_pk_bf16_f32 v45, v46, v47
    v_fmac_f32 v48, v80, v122
    v_fmac_f32 v49, v81, v122
    v_fmac_f32 v50, v82, v122
    v_fmac_f32 v51, v83, v122
    v_cvt_pk_bf16_f32 v46, v48, v49
    v_cvt_pk_bf16_f32 v47, v50, v51
    v_fmac_f32 v52, v84, v122
    v_fmac_f32 v53, v85, v122
    v_fmac_f32 v54, v86, v122
    v_fmac_f32 v55, v87, v122
    v_cvt_pk_bf16_f32 v48, v52, v53
    v_cvt_pk_bf16_f32 v49, v54, v55
    v_fmac_f32 v56, v88, v122
    v_fmac_f32 v57, v89, v122
    v_fmac_f32 v58, v90, v122
    v_fmac_f32 v59, v91, v122
    v_cvt_pk_bf16_f32 v50, v56, v57
    v_cvt_pk_bf16_f32 v51, v58, v59
    s_cbranch_scc1 Lh1
    s_setprio 3
    ds_write_b128 v125, v[44:47] offset:2048
    ds_write_b128 v125, v[48:51] offset:3072
    v_fmac_f32 v28, v76, v120
    v_fmac_f32 v29, v77, v120
    v_fmac_f32 v30, v78, v120
    v_fmac_f32 v31, v79, v120
    v_cvt_pk_bf16_f32 v52, v28, v29
    v_cvt_pk_bf16_f32 v53, v30, v31
    v_fmac_f32 v32, v80, v120
    v_fmac_f32 v33, v81, v120
    v_fmac_f32 v34, v82, v120
    v_fmac_f32 v35, v83, v120
    v_cvt_pk_bf16_f32 v54, v32, v33
    v_cvt_pk_bf16_f32 v55, v34, v35
    v_fmac_f32 v36, v84, v120
    v_fmac_f32 v37, v85, v120
    v_fmac_f32 v38, v86, v120
    v_fmac_f32 v39, v87, v120
    v_cvt_pk_bf16_f32 v56, v36, v37
    v_cvt_pk_bf16_f32 v57, v38, v39
    v_fmac_f32 v40, v88, v120
    v_fmac_f32 v41, v89, v120
    v_fmac_f32 v42, v90, v120
    v_fmac_f32 v43, v91, v120
    v_cvt_pk_bf16_f32 v58, v40, v41
    v_cvt_pk_bf16_f32 v59, v42, v43
    ds_write_b128 v125, v[52:55] offset:4096
    ds_write_b128 v125, v[56:59] offset:5120
    v_mov_b32 v5, 157972
    v_mov_b32 v6, 1
    s_mov_b64 exec, 1
    ds_add_u32 v5, v6
    s_mov_b64 exec, -1
    v_mov_b32 v8, s22
    v_mov_b32 v9, s22
    v_mov_b32 v10, s22
    v_mov_b32 v11, s22
Lcw_1:
    s_sub_u32 s35, s35, 1
    s_cbranch_scc1 Lend
    ds_read_b32 v6, v5
    s_waitcnt lgkmcnt(0)
    v_readfirstlane_b32 s38, v6
    s_nop 0
    s_cmp_lt_u32 s38, 8
    s_cbranch_scc1 Lcw_1
    ds_read_b128 v[28:31], v125 offset:0
    ds_read_b128 v[32:35], v125 offset:1024
Lh_join:
    buffer_load_dword v20, v12, s[28:31], s24 offen sc1
    ds_read_b64_tr_b16 a[64:65], v26 offset:0
    ds_read_b64_tr_b16 a[66:67], v26 offset:512
    ds_read_b64_tr_b16 a[68:69], v27 offset:0
    ds_read_b64_tr_b16 a[70:71], v27 offset:512
    ds_read_b64_tr_b16 a[72:73], v26 offset:4096
    ds_read_b64_tr_b16 a[74:75], v26 offset:4608
    ds_read_b64_tr_b16 a[76:77], v27 offset:4096
    ds_read_b64_tr_b16 a[78:79], v27 offset:4608
    s_waitcnt lgkmcnt(8)
    s_setprio 3
    v_cndmask_b32 v92, 0, v30, s[6:7]
    v_cndmask_b32 v93, 0, v31, s[6:7]
    v_cndmask_b32 v94, 0, v32, s[12:13]
    v_cndmask_b32 v95, 0, v33, s[12:13]
    v_cndmask_b32 v104, 0, v30, s[8:9]
    v_cndmask_b32 v105, 0, v31, s[8:9]
    v_mfma_f32_16x16x32_bf16 v[76:79], v[46:49], v[92:95], v[8:11]
    v_mfma_f32_16x16x32_bf16 v[80:83], v[54:57], v[92:95], 0
    v_cndmask_b32 v106, 0, v32, s[14:15]
    v_cndmask_b32 v107, 0, v33, s[14:15]
    v_mov_b32 v96, v28
    v_mov_b32 v97, v29
    v_mfma_f32_16x16x32_bf16 v[84:87], v[46:49], v[104:107], v[8:11]
    v_mfma_f32_16x16x32_bf16 v[88:91], v[54:57], v[104:107], 0
    v_cndmask_b32 v98, 0, v30, s[10:11]
    v_cndmask_b32 v99, 0, v31, s[10:11]
    v_cndmask_b32 v100, 0, v32, s[16:17]
    v_cndmask_b32 v101, 0, v33, s[16:17]
    v_mfma_f32_16x16x32_bf16 v[36:39], v[44:47], v[96:99], v[8:11]
    v_mfma_f32_16x16x32_bf16 v[40:43], v[52:55], v[96:99], 0
    v_cndmask_b32 v76, v76, v77, s[4:5]
    v_cndmask_b32 v80, v80, v81, s[4:5]
    v_cndmask_b32 v78, v78, v79, s[4:5]
    v_cndmask_b32 v82, v82, v83, s[4:5]
    v_cndmask_b32 v92, v76, v80, s[18:19]
    v_cndmask_b32 v94, v78, v82, s[20:21]
    v_min_u32 v4, -2, v92
    v_min_u32 v5, -2, v94
    v_cndmask_b32 v84, v84, v85, s[4:5]
    v_cndmask_b32 v88, v88, v89, s[4:5]
    v_cndmask_b32 v86, v86, v87, s[4:5]
    v_cndmask_b32 v90, v90, v91, s[4:5]
    v_cndmask_b32 v104, v84, v88, s[18:19]
    v_cndmask_b32 v106, v86, v90, s[20:21]
    v_min_u32 v6, -2, v104
    v_min_u32 v7, -2, v106
    buffer_store_dwordx4 v[4:7], v13, s[28:31], s56 offen sc1
    s_setprio 2
    ds_read_b64_tr_b16 a[80:81], v26 offset:39040
    ds_read_b64_tr_b16 a[82:83], v26 offset:39552
    ds_read_b64_tr_b16 a[84:85], v27 offset:39040
    ds_read_b64_tr_b16 a[86:87], v27 offset:39552
    ds_read_b64_tr_b16 a[88:89], v26 offset:43136
    ds_read_b64_tr_b16 a[90:91], v26 offset:43648
    ds_read_b64_tr_b16 a[92:93], v27 offset:43136
    ds_read_b64_tr_b16 a[94:95], v27 offset:43648
    ds_read_b64_tr_b16 a[96:97], v24 offset:0
    ds_read_b64_tr_b16 a[98:99], v24 offset:512
    ds_read_b64_tr_b16 a[100:101], v25 offset:0
    ds_read_b64_tr_b16 a[102:103], v25 offset:512
    ds_read_b64_tr_b16 a[104:105], v24 offset:4096
    ds_read_b64_tr_b16 a[106:107], v24 offset:4608
    ds_read_b64_tr_b16 a[108:109], v25 offset:4096
    ds_read_b64_tr_b16 a[110:111], v25 offset:4608
    ds_read_b64_tr_b16 a[112:113], v24 offset:39040
    ds_read_b64_tr_b16 a[114:115], v24 offset:39552
    ds_read_b64_tr_b16 a[116:117], v25 offset:39040
    ds_read_b64_tr_b16 a[118:119], v25 offset:39552
    ds_read_b64_tr_b16 a[120:121], v24 offset:43136
    ds_read_b64_tr_b16 a[122:123], v24 offset:43648
    ds_read_b64_tr_b16 a[124:125], v25 offset:43136
    ds_read_b64_tr_b16 a[126:127], v25 offset:43648
    s_waitcnt lgkmcnt(15)
    v_mfma_f32_16x16x32_bf16 v[60:63], a[0:3], a[64:67], v[60:63]
    v_mov_b32 v102, v34
    v_mov_b32 v103, v35
    v_mul_f32 v4, s25, v121
    v_mfma_f32_16x16x32_bf16 v[68:71], a[4:7], a[64:67], v[68:71]
    v_mfma_f32_16x16x32_bf16 v[76:79], v[48:51], v[100:103], v[8:11]
    v_mfma_f32_16x16x32_bf16 v[80:83], v[56:59], v[100:103], 0
    v_mfma_f32_16x16x32_bf16 v[64:67], a[0:3], a[68:71], v[64:67]
    v_mul_f32 v123, v123, v4
    v_mul_f32 v126, v126, v4
    v_cndmask_b32 v36, v36, v37, s[4:5]
    v_mfma_f32_16x16x32_bf16 v[72:75], a[4:7], a[68:71], v[72:75]
    v_cndmask_b32 v40, v40, v41, s[4:5]
    v_cndmask_b32 v38, v38, v39, s[4:5]
    v_mfma_f32_16x16x32_bf16 v[60:63], a[8:11], a[72:75], v[60:63]
    v_cndmask_b32 v42, v42, v43, s[4:5]
    v_cndmask_b32 v96, v36, v40, s[18:19]
    v_cndmask_b32 v98, v38, v42, s[20:21]
    v_mfma_f32_16x16x32_bf16 v[68:71], a[12:15], a[72:75], v[68:71]
    v_cndmask_b32 v76, v76, v77, s[4:5]
    v_cndmask_b32 v80, v80, v81, s[4:5]
    v_mfma_f32_16x16x32_bf16 v[64:67], a[8:11], a[76:79], v[64:67]
    v_cndmask_b32 v78, v78, v79, s[4:5]
    v_cndmask_b32 v82, v82, v83, s[4:5]
    v_cndmask_b32 v100, v76, v80, s[18:19]
    v_mfma_f32_16x16x32_bf16 v[72:75], a[12:15], a[76:79], v[72:75]
    v_cndmask_b32 v102, v78, v82, s[20:21]
    v_mul_f32 v96, v96, v123
    v_mfma_f32_16x16x32_bf16 v[60:63], a[16:19], a[80:83], v[60:63]
    v_mul_f32 v98, v98, v126
    v_mul_f32 v100, v100, v123
    v_mul_f32 v102, v102, v126
    v_mfma_f32_16x16x32_bf16 v[68:71], a[20:23], a[80:83], v[68:71]
    v_max_f32 v4, v96, v98
    v_max_f32 v5, v100, v102
    v_mfma_f32_16x16x32_bf16 v[64:67], a[16:19], a[84:87], v[64:67]
    v_mov_b32 v6, v4
    v_mov_b32 v7, v5
    s_nop 0
    v_permlane32_swap_b32 v4, v6
    v_mfma_f32_16x16x32_bf16 v[72:75], a[20:23], a[84:87], v[72:75]
    v_permlane32_swap_b32 v5, v7
    v_max_f32 v4, v4, v6
    s_setprio 1
    v_mfma_f32_16x16x32_bf16 v[60:63], a[24:27], a[88:91], v[60:63]
    v_max_f32 v5, v5, v7
    v_mov_b32 v6, v4
    v_mov_b32 v7, v5
    v_mfma_f32_16x16x32_bf16 v[68:71], a[28:31], a[88:91], v[68:71]
    v_permlane16_swap_b32 v4, v6
    v_permlane16_swap_b32 v5, v7
    v_mfma_f32_16x16x32_bf16 v[64:67], a[24:27], a[92:95], v[64:67]
    v_max_f32 v4, v4, v6
    v_max_f32 v5, v5, v7
    v_mfma_f32_16x16x32_bf16 v[72:75], a[28:31], a[92:95], v[72:75]
    v_sub_f32 v96, v96, v4
    v_sub_f32 v98, v98, v4
    s_waitcnt lgkmcnt(12)
    v_mfma_f32_16x16x32_bf16 v[60:63], a[32:35], a[96:99], v[60:63]
    v_sub_f32 v100, v100, v5
    v_sub_f32 v102, v102, v5
    v_exp_f32 v96, v96
    v_mfma_f32_16x16x32_bf16 v[68:71], a[36:39], a[96:99], v[68:71]
    v_exp_f32 v98, v98
    v_exp_f32 v100, v100
    v_mfma_f32_16x16x32_bf16 v[64:67], a[32:35], a[100:103], v[64:67]
    v_exp_f32 v102, v102
    v_cvt_pk_bf16_f32 v96, v96, v96
    v_mfma_f32_16x16x32_bf16 v[72:75], a[36:39], a[100:103], v[72:75]
    v_cvt_pk_bf16_f32 v97, v98, v98
    v_cvt_pk_bf16_f32 v100, v100, v100
    s_waitcnt lgkmcnt(8)
    v_mfma_f32_16x16x32_bf16 v[60:63], a[40:43], a[104:107], v[60:63]
    v_cvt_pk_bf16_f32 v101, v102, v102
    v_and_b32 v98, v96, v118
    v_and_b32 v99, v97, v119
    v_mfma_f32_16x16x32_bf16 v[68:71], a[44:47], a[104:107], v[68:71]
    v_and_b32 v96, v96, v116
    v_and_b32 v97, v97, v117
    v_mfma_f32_16x16x32_bf16 v[64:67], a[40:43], a[108:111], v[64:67]
    v_and_b32 v102, v100, v118
    v_and_b32 v103, v101, v119
    v_mfma_f32_16x16x32_bf16 v[72:75], a[44:47], a[108:111], v[72:75]
    v_and_b32 v100, v100, v116
    v_and_b32 v101, v101, v117
    s_setprio 0
    s_waitcnt lgkmcnt(4)
    v_mfma_f32_16x16x32_bf16 v[60:63], a[48:51], a[112:115], v[60:63]
    s_lshl_b32 s36, s43, 6
    s_add_u32 s36, s36, 156160
    v_lshl_add_u32 v48, v2, 4, s36
    v_xor_b32 v49, 64, v48
    ds_read_b128 v[28:31], v48 offset:0
    v_mfma_f32_16x16x32_bf16 v[68:71], a[52:55], a[112:115], v[68:71]
    ds_read_b128 v[32:35], v48 offset:512
    ds_read_b128 v[36:39], v49 offset:0
    ds_read_b128 v[40:43], v49 offset:512
    s_lshl_b32 s36, s27, 3
    s_add_u32 s36, s36, 157696
    v_mfma_f32_16x16x32_bf16 v[64:67], a[48:51], a[116:119], v[64:67]
    v_lshl_add_u32 v48, v3, 4, s36
    v_mov_b32 v49, 157952
    v_lshl_add_u32 v125, v1, 3, s48
    s_lshl_b32 s36, s27, 10
    v_add_u32 v50, s36, v125
    v_mfma_f32_16x16x32_bf16 v[72:75], a[52:55], a[116:119], v[72:75]
    s_lshl_b32 s37, s27, 12
    s_sub_u32 s37, 2048, s37
    v_add_u32 v51, s37, v50
    v_subrev_u32 v125, 2048, v125
    s_waitcnt vmcnt(1)
Lfl_chk:
    v_cmp_eq_u32 vcc, s34, v20
    s_nop 0
    s_and_b32 s36, vcc_lo, 0x3ff
    s_cmp_lg_u32 s36, 0x3ff
    s_cbranch_scc1 Lfl_re
    buffer_load_dwordx2 v[52:53], v13, s[28:31], s57 offen offset:8 sc1
    buffer_load_dwordx2 v[54:55], v13, s[28:31], s58 offen offset:0 sc1
    s_waitcnt lgkmcnt(4)
    v_mfma_f32_16x16x32_bf16 v[60:63], a[56:59], a[120:123], v[60:63]
    v_mfma_f32_16x16x32_bf16 v[68:71], a[60:63], a[120:123], v[68:71]
    v_mfma_f32_16x16x32_bf16 v[64:67], a[56:59], a[124:127], v[64:67]
    v_mfma_f32_16x16x32_bf16 v[72:75], a[60:63], a[124:127], v[72:75]
    ds_read_b32 v46, v49
    ds_read_b64 v[44:45], v48
    s_waitcnt lgkmcnt(0)
Lcsv:
    v_readfirstlane_b32 s38, v46
    s_nop 0
    s_cmp_eq_u32 s38, 0
    s_cbranch_scc1 Lcsv_re
    v_fmac_f32 v60, v28, v44
    v_fmac_f32 v61, v29, v44
    v_fmac_f32 v62, v30, v44
    v_fmac_f32 v63, v31, v44
    v_mul_f32 v60, v60, v32
    v_mul_f32 v61, v61, v33
    v_mul_f32 v62, v62, v34
    v_mul_f32 v63, v63, v35
    v_cvt_pk_bf16_f32 v60, v60, v61
    v_cvt_pk_bf16_f32 v61, v62, v63
    ds_write_b64 v50, v[60:61] offset:0
    v_fmac_f32 v64, v28, v45
    v_fmac_f32 v65, v29, v45
    v_fmac_f32 v66, v30, v45
    v_fmac_f32 v67, v31, v45
    v_mul_f32 v64, v64, v32
    v_mul_f32 v65, v65, v33
    v_mul_f32 v66, v66, v34
    v_mul_f32 v67, v67, v35
    v_cvt_pk_bf16_f32 v64, v64, v65
    v_cvt_pk_bf16_f32 v65, v66, v67
    ds_write_b64 v50, v[64:65] offset:512
    v_fmac_f32 v68, v36, v44
    v_fmac_f32 v69, v37, v44
    v_fmac_f32 v70, v38, v44
    v_fmac_f32 v71, v39, v44
    v_mul_f32 v68, v68, v40
    v_mul_f32 v69, v69, v41
    v_mul_f32 v70, v70, v42
    v_mul_f32 v71, v71, v43
    v_cvt_pk_bf16_f32 v68, v68, v69
    v_cvt_pk_bf16_f32 v69, v70, v71
    ds_write_b64 v51, v[68:69] offset:0
    v_fmac_f32 v72, v36, v45
    v_fmac_f32 v73, v37, v45
    v_fmac_f32 v74, v38, v45
    v_fmac_f32 v75, v39, v45
    v_mul_f32 v72, v72, v40
    v_mul_f32 v73, v73, v41
    v_mul_f32 v74, v74, v42
    v_mul_f32 v75, v75, v43
    v_cvt_pk_bf16_f32 v72, v72, v73
    v_cvt_pk_bf16_f32 v73, v74, v75
    ds_write_b64 v51, v[72:73] offset:512
    v_mov_b32 v8, 157976
    v_mov_b32 v9, 1
    s_mov_b64 exec, 1
    ds_add_u32 v8, v9
    s_mov_b64 exec, -1
    s_waitcnt vmcnt(0)
Lrx_chk:
    v_and_b32 v52, s59, v52
    v_and_b32 v53, s59, v53
    v_and_b32 v54, s60, v54
    v_and_b32 v55, s60, v55
    v_max3_u32 v4, v52, v53, v54
    v_max_u32 v4, v4, v55
    v_cmp_eq_u32 vcc, -1, v4
    s_nop 0
    s_cbranch_vccnz Lrx_re
    v_add_f32 v92, v92, v52
    v_add_f32 v94, v94, v53
    v_add_f32 v104, v104, v54
    v_add_f32 v106, v106, v55
Lcw_4:
    s_sub_u32 s35, s35, 1
    s_cbranch_scc1 Lend
    ds_read_b32 v9, v8
    s_waitcnt lgkmcnt(0)
    v_readfirstlane_b32 s38, v9
    s_nop 0
    s_cmp_lt_u32 s38, 7
    s_cbranch_scc1 Lcw_4
    s_setprio 2
    ds_read2st64_b64 v[60:63], v125 offset0:0 offset1:4
    ds_read2st64_b64 v[64:67], v125 offset0:1 offset1:5
    ds_read2st64_b64 v[68:71], v125 offset0:2 offset1:6
    ds_read2st64_b64 v[72:75], v125 offset0:3 offset1:7
    v_mul_f32 v92, v92, v123
    v_mul_f32 v94, v94, v126
    v_mul_f32 v104, v104, v123
    v_mul_f32 v106, v106, v126
    v_max_f32 v4, v92, v94
    v_max_f32 v5, v104, v106
    v_mov_b32 v6, v4
    v_mov_b32 v7, v5
    s_nop 0
    v_permlane32_swap_b32 v4, v6
    v_permlane32_swap_b32 v5, v7
    v_max_f32 v4, v4, v6
    v_max_f32 v5, v5, v7
    s_waitcnt lgkmcnt(0)
    v_mov_b32 v6, v4
    v_mfma_f32_16x16x32_bf16 v[80:83], v[14:17], v[96:99], 0
    v_mov_b32 v7, v5
    v_permlane16_swap_b32 v4, v6
    s_nop 0
    v_permlane16_swap_b32 v5, v7
    v_max_f32 v4, v4, v6
    v_mfma_f32_16x16x32_bf16 v[84:87], v[14:17], v[100:103], 0
    v_max_f32 v5, v5, v7
    v_sub_f32 v92, v92, v4
    v_sub_f32 v94, v94, v4
    v_sub_f32 v104, v104, v5
    v_mfma_f32_16x16x32_bf16 v[28:31], v[60:63], v[96:99], 0
    v_sub_f32 v106, v106, v5
    v_exp_f32 v92, v92
    v_exp_f32 v94, v94
    v_exp_f32 v104, v104
    v_exp_f32 v106, v106
    v_mfma_f32_16x16x32_bf16 v[32:35], v[64:67], v[96:99], 0
    v_cvt_pk_bf16_f32 v92, v92, v92
    v_cvt_pk_bf16_f32 v93, v94, v94
    v_cvt_pk_bf16_f32 v104, v104, v104
    v_cvt_pk_bf16_f32 v105, v106, v106
    v_mfma_f32_16x16x32_bf16 v[36:39], v[68:71], v[100:103], 0
    v_and_b32 v94, v92, v118
    v_and_b32 v95, v93, v119
    v_and_b32 v92, v92, v116
    v_and_b32 v93, v93, v117
    v_mfma_f32_16x16x32_bf16 v[40:43], v[72:75], v[100:103], 0
    v_and_b32 v106, v104, v118
    v_and_b32 v107, v105, v119
    v_and_b32 v104, v104, v116
    v_and_b32 v105, v105, v117
    v_mfma_f32_16x16x32_bf16 v[76:79], v[14:17], v[92:95], 0
    v_rcp_f32 v80, v80
    v_rcp_f32 v84, v84
    v_mfma_f32_16x16x32_bf16 v[88:91], v[14:17], v[104:107], 0
    v_mul_f32 v28, v28, v80
    v_mul_f32 v29, v29, v80
    v_mfma_f32_16x16x32_bf16 v[44:47], v[64:67], v[92:95], 0
    v_mul_f32 v30, v30, v80
    v_mfma_f32_16x16x32_bf16 v[48:51], v[68:71], v[92:95], 0
    v_mul_f32 v31, v31, v80
    v_cvt_pk_bf16_f32 v4, v28, v29
    v_mfma_f32_16x16x32_bf16 v[52:55], v[64:67], v[104:107], 0
    v_cvt_pk_bf16_f32 v5, v30, v31
    v_min_u32 v4, -2, v4
    v_mfma_f32_16x16x32_bf16 v[56:59], v[68:71], v[104:107], 0
    v_min_u32 v5, -2, v5
    v_mul_f32 v40, v40, v84
    v_mul_f32 v41, v41, v84
    v_mul_f32 v42, v42, v84
    v_mul_f32 v43, v43, v84
    v_cvt_pk_bf16_f32 v10, v40, v41
    v_cvt_pk_bf16_f32 v11, v42, v43
    v_min_u32 v10, -2, v10
    v_min_u32 v11, -2, v11
    v_rcp_f32 v76, v76
    v_rcp_f32 v88, v88
    v_cndmask_b32 v82, v80, v76, s[6:7]
    v_cndmask_b32 v82, v82, v88, s[8:9]
    v_cndmask_b32 v32, v32, v44, s[6:7]
    v_cndmask_b32 v33, v33, v45, s[6:7]
    v_cndmask_b32 v34, v34, v46, s[6:7]
    v_cndmask_b32 v35, v35, v47, s[6:7]
    v_cndmask_b32 v32, v32, v52, s[8:9]
    v_cndmask_b32 v33, v33, v53, s[8:9]
    v_cndmask_b32 v34, v34, v54, s[8:9]
    v_cndmask_b32 v35, v35, v55, s[8:9]
    v_mul_f32 v32, v32, v82
    v_mul_f32 v33, v33, v82
    v_mul_f32 v34, v34, v82
    v_mul_f32 v35, v35, v82
    v_cvt_pk_bf16_f32 v6, v32, v33
    v_cvt_pk_bf16_f32 v7, v34, v35
    v_min_u32 v6, -2, v6
    v_min_u32 v7, -2, v7
    buffer_store_dwordx4 v[4:7], v13, s[28:31], s23 offen offset:0 sc1
    v_cndmask_b32 v86, v84, v76, s[12:13]
    v_cndmask_b32 v86, v86, v88, s[14:15]
    v_cndmask_b32 v36, v36, v48, s[12:13]
    v_cndmask_b32 v37, v37, v49, s[12:13]
    v_cndmask_b32 v38, v38, v50, s[12:13]
    v_cndmask_b32 v39, v39, v51, s[12:13]
    v_cndmask_b32 v36, v36, v56, s[14:15]
    v_cndmask_b32 v37, v37, v57, s[14:15]
    v_cndmask_b32 v38, v38, v58, s[14:15]
    v_cndmask_b32 v39, v39, v59, s[14:15]
    v_mul_f32 v36, v36, v86
    v_mul_f32 v37, v37, v86
    v_mul_f32 v38, v38, v86
    v_mul_f32 v39, v39, v86
    v_cvt_pk_bf16_f32 v8, v36, v37
    v_cvt_pk_bf16_f32 v9, v38, v39
    v_min_u32 v8, -2, v8
    v_min_u32 v9, -2, v9
    buffer_store_dwordx4 v[8:11], v13, s[28:31], s23 offen offset:1024 sc1
    s_setprio 1
    s_nop 0
    v_mov_b32 v10, 157980
    v_and_b32 v6, 3, v1
    v_lshl_add_u32 v6, v6, 3, v19
    v_add_u32 v20, v6, v18
    v_xor_b32 v21, 32, v20
    v_xor_b32 v22, 64, v20
    v_xor_b32 v23, 96, v20
    v_add_u32 v24, 63616, v20
    v_add_u32 v25, 63616, v21
    v_add_u32 v26, 63616, v22
    v_add_u32 v27, 63616, v23
Lcw_3:
    s_sub_u32 s35, s35, 1
    s_cbranch_scc1 Lend
    ds_read_b32 v11, v10
    s_waitcnt lgkmcnt(0)
    v_readfirstlane_b32 s38, v11
    s_nop 0
    s_cmp_lt_u32 s38, 2
    s_cbranch_scc1 Lcw_3
    s_mul_i32 s36, s32, 96
    s_lshl_b32 s37, s43, 4
    s_add_u32 s36, s36, s37
    s_sub_u32 s36, s36, 32
    v_add_u32 v126, s36, v3
    v_lshrrev_b32 v6, 3, v1
    v_add_u32 v6, s36, v6
    v_mul_u32_u24 v6, 1280, v6
    v_and_b32 v7, 7, v1
    v_xor_b32 v7, v7, v2
    v_lshl_add_u32 v122, v7, 4, v6
    v_xor_b32 v123, 64, v122
    v_add_u32 v123, 10240, v123
    s_lshl_b32 s36, s43, 11
    s_add_u32 s36, s36, 102656
    v_add_u32 v124, s36, v124
    v_add_u32 v125, s36, v13
    s_lshl_b32 s24, s33, 7
    v_mov_b32 v10, 157960
    s_mov_b32 s41, 0
    s_mov_b32 s61, 3
    v_lshlrev_b32 v28, 16, v108
    ds_read_b64_tr_b16 a[0:1], v20 offset:0
    ds_read_b64_tr_b16 a[2:3], v20 offset:512
    ds_read_b64_tr_b16 a[4:5], v21 offset:0
    ds_read_b64_tr_b16 a[6:7], v21 offset:512
    ds_read_b64_tr_b16 a[8:9], v22 offset:0
    ds_read_b64_tr_b16 a[10:11], v22 offset:512
    ds_read_b64_tr_b16 a[12:13], v23 offset:0
    ds_read_b64_tr_b16 a[14:15], v23 offset:512
    v_and_b32 v29, 0xffff0000, v108
    v_lshlrev_b32 v30, 16, v109
    v_and_b32 v31, 0xffff0000, v109
    v_lshlrev_b32 v32, 16, v110
    v_and_b32 v33, 0xffff0000, v110
    v_lshlrev_b32 v34, 16, v111
    v_and_b32 v35, 0xffff0000, v111
    v_lshlrev_b32 v36, 16, v112
    v_and_b32 v37, 0xffff0000, v112
    v_lshlrev_b32 v38, 16, v113
    v_and_b32 v39, 0xffff0000, v113
    v_lshlrev_b32 v40, 16, v114
    v_and_b32 v41, 0xffff0000, v114
    v_lshlrev_b32 v42, 16, v115
    ds_read_b64_tr_b16 a[16:17], v20 offset:4096
    ds_read_b64_tr_b16 a[18:19], v20 offset:4608
    ds_read_b64_tr_b16 a[20:21], v21 offset:4096
    ds_read_b64_tr_b16 a[22:23], v21 offset:4608
    ds_read_b64_tr_b16 a[24:25], v22 offset:4096
    ds_read_b64_tr_b16 a[26:27], v22 offset:4608
    ds_read_b64_tr_b16 a[28:29], v23 offset:4096
    ds_read_b64_tr_b16 a[30:31], v23 offset:4608
    v_and_b32 v43, 0xffff0000, v115
    v_mul_f32 v4, v120, v121
    v_mul_f32 v5, 0xbfb8aa3b, v121
    v_mul_f32 v6, 0xbfb8aa3b, v4
    v_fma_f32 v44, v28, v5, v6
    v_fma_f32 v45, v29, v5, v6
    v_fma_f32 v46, v30, v5, v6
    v_fma_f32 v47, v31, v5, v6
    v_fma_f32 v48, v32, v5, v6
    v_fma_f32 v49, v33, v5, v6
    v_fma_f32 v50, v34, v5, v6
    v_fma_f32 v51, v35, v5, v6
    v_fma_f32 v52, v36, v5, v6
    v_fma_f32 v53, v37, v5, v6
    ds_read_b64_tr_b16 a[32:33], v20 offset:8192
    ds_read_b64_tr_b16 a[34:35], v20 offset:8704
    ds_read_b64_tr_b16 a[36:37], v21 offset:8192
    ds_read_b64_tr_b16 a[38:39], v21 offset:8704
    ds_read_b64_tr_b16 a[40:41], v22 offset:8192
    ds_read_b64_tr_b16 a[42:43], v22 offset:8704
    ds_read_b64_tr_b16 a[44:45], v23 offset:8192
    ds_read_b64_tr_b16 a[46:47], v23 offset:8704
    v_fma_f32 v54, v38, v5, v6
    v_fma_f32 v55, v39, v5, v6
    v_fma_f32 v56, v40, v5, v6
    v_fma_f32 v57, v41, v5, v6
    v_fma_f32 v58, v42, v5, v6
    v_fma_f32 v59, v43, v5, v6
    v_exp_f32 v44, v44
    v_exp_f32 v45, v45
    v_exp_f32 v46, v46
    v_exp_f32 v47, v47
    v_exp_f32 v48, v48
    v_exp_f32 v49, v49
    v_exp_f32 v50, v50
    v_exp_f32 v51, v51
    v_exp_f32 v52, v52
    ds_read_b64_tr_b16 a[48:49], v20 offset:12288
    ds_read_b64_tr_b16 a[50:51], v20 offset:12800
    ds_read_b64_tr_b16 a[52:53], v21 offset:12288
    ds_read_b64_tr_b16 a[54:55], v21 offset:12800
    ds_read_b64_tr_b16 a[56:57], v22 offset:12288
    ds_read_b64_tr_b16 a[58:59], v22 offset:12800
    ds_read_b64_tr_b16 a[60:61], v23 offset:12288
    ds_read_b64_tr_b16 a[62:63], v23 offset:12800
    v_exp_f32 v53, v53
    v_exp_f32 v54, v54
    v_exp_f32 v55, v55
    v_exp_f32 v56, v56
    v_exp_f32 v57, v57
    v_exp_f32 v58, v58
    v_exp_f32 v59, v59
    v_fma_f32 v92, v28, v121, v4
    v_fma_f32 v93, v29, v121, v4
    v_fma_f32 v94, v30, v121, v4
    v_fma_f32 v95, v31, v121, v4
    v_fma_f32 v96, v32, v121, v4
    v_fma_f32 v97, v33, v121, v4
    v_fma_f32 v98, v34, v121, v4
    ds_read_b64_tr_b16 a[64:65], v20 offset:24576
    ds_read_b64_tr_b16 a[66:67], v20 offset:25088
    ds_read_b64_tr_b16 a[68:69], v21 offset:24576
    ds_read_b64_tr_b16 a[70:71], v21 offset:25088
    ds_read_b64_tr_b16 a[72:73], v22 offset:24576
    ds_read_b64_tr_b16 a[74:75], v22 offset:25088
    ds_read_b64_tr_b16 a[76:77], v23 offset:24576
    ds_read_b64_tr_b16 a[78:79], v23 offset:25088
    v_fma_f32 v99, v35, v121, v4
    v_fma_f32 v100, v36, v121, v4
    v_fma_f32 v101, v37, v121, v4
    v_fma_f32 v102, v38, v121, v4
    v_fma_f32 v103, v39, v121, v4
    v_fma_f32 v104, v40, v121, v4
    v_fma_f32 v105, v41, v121, v4
    v_fma_f32 v106, v42, v121, v4
    v_fma_f32 v107, v43, v121, v4
    v_add_f32 v44, 1.0, v44
    v_add_f32 v45, 1.0, v45
    v_add_f32 v46, 1.0, v46
    v_add_f32 v47, 1.0, v47
    v_add_f32 v48, 1.0, v48
    ds_read_b64_tr_b16 a[80:81], v20 offset:28672
    ds_read_b64_tr_b16 a[82:83], v20 offset:29184
    ds_read_b64_tr_b16 a[84:85], v21 offset:28672
    ds_read_b64_tr_b16 a[86:87], v21 offset:29184
    ds_read_b64_tr_b16 a[88:89], v22 offset:28672
    ds_read_b64_tr_b16 a[90:91], v22 offset:29184
    ds_read_b64_tr_b16 a[92:93], v23 offset:28672
    ds_read_b64_tr_b16 a[94:95], v23 offset:29184
    v_add_f32 v49, 1.0, v49
    v_add_f32 v50, 1.0, v50
    v_add_f32 v51, 1.0, v51
    v_add_f32 v52, 1.0, v52
    v_add_f32 v53, 1.0, v53
    v_add_f32 v54, 1.0, v54
    v_add_f32 v55, 1.0, v55
    v_add_f32 v56, 1.0, v56
    v_add_f32 v57, 1.0, v57
    v_add_f32 v58, 1.0, v58
    v_add_f32 v59, 1.0, v59
    v_rcp_f32 v44, v44
    v_rcp_f32 v45, v45
    v_rcp_f32 v46, v46
    v_rcp_f32 v47, v47
    ds_read_b64_tr_b16 a[96:97], v24 offset:59520
    ds_read_b64_tr_b16 a[98:99], v24 offset:60032
    ds_read_b64_tr_b16 a[100:101], v25 offset:59520
    ds_read_b64_tr_b16 a[102:103], v25 offset:60032
    ds_read_b64_tr_b16 a[104:105], v26 offset:59520
    ds_read_b64_tr_b16 a[106:107], v26 offset:60032
    ds_read_b64_tr_b16 a[108:109], v27 offset:59520
    ds_read_b64_tr_b16 a[110:111], v27 offset:60032
    v_rcp_f32 v48, v48
    v_rcp_f32 v49, v49
    v_rcp_f32 v50, v50
    v_rcp_f32 v51, v51
    v_rcp_f32 v52, v52
    v_rcp_f32 v53, v53
    v_rcp_f32 v54, v54
    v_rcp_f32 v55, v55
    v_rcp_f32 v56, v56
    v_rcp_f32 v57, v57
    v_rcp_f32 v58, v58
    v_rcp_f32 v59, v59
    v_mul_f32 v44, v44, v92
    v_mul_f32 v45, v45, v93
    ds_read_b64_tr_b16 a[112:113], v24 offset:63616
    ds_read_b64_tr_b16 a[114:115], v24 offset:64128
    ds_read_b64_tr_b16 a[116:117], v25 offset:63616
    ds_read_b64_tr_b16 a[118:119], v25 offset:64128
    ds_read_b64_tr_b16 a[120:121], v26 offset:63616
    ds_read_b64_tr_b16 a[122:123], v26 offset:64128
    ds_read_b64_tr_b16 a[124:125], v27 offset:63616
    ds_read_b64_tr_b16 a[126:127], v27 offset:64128
    v_mul_f32 v46, v46, v94
    v_mul_f32 v47, v47, v95
    v_mul_f32 v48, v48, v96
    v_mul_f32 v49, v49, v97
    v_mul_f32 v50, v50, v98
    v_mul_f32 v51, v51, v99
    v_mul_f32 v52, v52, v100
    v_mul_f32 v53, v53, v101
    v_mul_f32 v54, v54, v102
    v_mul_f32 v55, v55, v103
    v_mul_f32 v56, v56, v104
    v_mul_f32 v57, v57, v105
    v_mul_f32 v58, v58, v106
    v_mul_f32 v59, v59, v107
    buffer_load_dwordx4 v[60:63], v13, s[28:31], s51 offen offset:0 sc1
    buffer_load_dwordx4 v[64:67], v13, s[28:31], s51 offen offset:1024 sc1
    buffer_load_dwordx4 v[68:71], v13, s[28:31], s51 offen offset:2048 sc1
    buffer_load_dwordx4 v[72:75], v13, s[28:31], s51 offen offset:3072 sc1
    buffer_load_dwordx4 v[76:79], v13, s[28:31], s52 offen offset:0 sc1
    buffer_load_dwordx4 v[80:83], v13, s[28:31], s52 offen offset:1024 sc1
    buffer_load_dwordx4 v[84:87], v13, s[28:31], s52 offen offset:2048 sc1
    buffer_load_dwordx4 v[88:91], v13, s[28:31], s52 offen offset:3072 sc1
    s_setprio 0
Lwo_go:
    s_setprio 3
    ds_read_b64 v[8:9], v10
    s_waitcnt vmcnt(6) lgkmcnt(15)
    v_mfma_f32_16x16x32_bf16 v[108:111], a[0:3], v[60:63], 0
    ds_read_b64_tr_b16 a[0:1], v24 offset:16384
    ds_read_b64_tr_b16 a[2:3], v24 offset:16896
    buffer_load_dwordx4 v[92:95], v13, s[28:31], s53 offen offset:0 sc1
    v_mfma_f32_16x16x32_bf16 v[112:115], a[4:7], v[60:63], 0
    ds_read_b64_tr_b16 a[4:5], v25 offset:16384
    ds_read_b64_tr_b16 a[6:7], v25 offset:16896
    v_mfma_f32_16x16x32_bf16 v[116:119], a[8:11], v[60:63], 0
    ds_read_b64_tr_b16 a[8:9], v26 offset:16384
    ds_read_b64_tr_b16 a[10:11], v26 offset:16896
    v_mfma_f32_16x16x32_bf16 v[14:17], a[12:15], v[60:63], 0
    ds_read_b64_tr_b16 a[12:13], v27 offset:16384
    ds_read_b64_tr_b16 a[14:15], v27 offset:16896
    v_mfma_f32_16x16x32_bf16 v[108:111], a[16:19], v[64:67], v[108:111]
    ds_read_b64_tr_b16 a[16:17], v24 offset:20480
    ds_read_b64_tr_b16 a[18:19], v24 offset:20992
    buffer_load_dwordx4 v[96:99], v13, s[28:31], s53 offen offset:1024 sc1
    v_mfma_f32_16x16x32_bf16 v[112:115], a[20:23], v[64:67], v[112:115]
    ds_read_b64_tr_b16 a[20:21], v25 offset:20480
    ds_read_b64_tr_b16 a[22:23], v25 offset:20992
    v_mfma_f32_16x16x32_bf16 v[116:119], a[24:27], v[64:67], v[116:119]
    ds_read_b64_tr_b16 a[24:25], v26 offset:20480
    ds_read_b64_tr_b16 a[26:27], v26 offset:20992
    v_mfma_f32_16x16x32_bf16 v[14:17], a[28:31], v[64:67], v[14:17]
    ds_read_b64_tr_b16 a[28:29], v27 offset:20480
    ds_read_b64_tr_b16 a[30:31], v27 offset:20992
    s_waitcnt lgkmcnt(15)
Linfo:
    v_readfirstlane_b32 s39, v8
    s_nop 0
    s_cmp_eq_u32 s39, -2
    s_cbranch_scc1 Linfo_re
    v_cmp_class_f32_e64 vcc, v108, s61
    s_nop 0
    s_cbranch_vccnz Lnan
    s_waitcnt vmcnt(6)
    v_mfma_f32_16x16x32_bf16 v[108:111], a[32:35], v[68:71], v[108:111]
    ds_read_b64_tr_b16 a[32:33], v20 offset:32768
    ds_read_b64_tr_b16 a[34:35], v20 offset:33280
    buffer_load_dwordx4 v[100:103], v13, s[28:31], s53 offen offset:2048 sc1
    v_mfma_f32_16x16x32_bf16 v[112:115], a[36:39], v[68:71], v[112:115]
    ds_read_b64_tr_b16 a[36:37], v21 offset:32768
    ds_read_b64_tr_b16 a[38:39], v21 offset:33280
    v_mfma_f32_16x16x32_bf16 v[116:119], a[40:43], v[68:71], v[116:119]
    ds_read_b64_tr_b16 a[40:41], v22 offset:32768
    ds_read_b64_tr_b16 a[42:43], v22 offset:33280
    v_mfma_f32_16x16x32_bf16 v[14:17], a[44:47], v[68:71], v[14:17]
    ds_read_b64_tr_b16 a[44:45], v23 offset:32768
    ds_read_b64_tr_b16 a[46:47], v23 offset:33280
    v_mfma_f32_16x16x32_bf16 v[108:111], a[48:51], v[72:75], v[108:111]
    ds_read_b64_tr_b16 a[48:49], v20 offset:36864
    ds_read_b64_tr_b16 a[50:51], v20 offset:37376
    buffer_load_dwordx4 v[104:107], v13, s[28:31], s53 offen offset:3072 sc1
    v_mfma_f32_16x16x32_bf16 v[112:115], a[52:55], v[72:75], v[112:115]
    ds_read_b64_tr_b16 a[52:53], v21 offset:36864
    ds_read_b64_tr_b16 a[54:55], v21 offset:37376
    v_mfma_f32_16x16x32_bf16 v[116:119], a[56:59], v[72:75], v[116:119]
    ds_read_b64_tr_b16 a[56:57], v22 offset:36864
    ds_read_b64_tr_b16 a[58:59], v22 offset:37376
    v_mfma_f32_16x16x32_bf16 v[14:17], a[60:63], v[72:75], v[14:17]
    ds_read_b64_tr_b16 a[60:61], v23 offset:36864
    ds_read_b64_tr_b16 a[62:63], v23 offset:37376
    v_cmp_class_f32_e64 vcc, v108, s61
    s_nop 0
    s_cbranch_vccnz Lnan
    s_waitcnt vmcnt(6)
    v_mfma_f32_16x16x32_bf16 v[108:111], a[64:67], v[76:79], v[108:111]
    ds_read_b64_tr_b16 a[64:65], v20 offset:40960
    ds_read_b64_tr_b16 a[66:67], v20 offset:41472
    buffer_load_dwordx4 v[60:63], v13, s[28:31], s54 offen offset:0 sc1
    v_mfma_f32_16x16x32_bf16 v[112:115], a[68:71], v[76:79], v[112:115]
    ds_read_b64_tr_b16 a[68:69], v21 offset:40960
    ds_read_b64_tr_b16 a[70:71], v21 offset:41472
    v_mfma_f32_16x16x32_bf16 v[116:119], a[72:75], v[76:79], v[116:119]
    ds_read_b64_tr_b16 a[72:73], v22 offset:40960
    ds_read_b64_tr_b16 a[74:75], v22 offset:41472
    v_mfma_f32_16x16x32_bf16 v[14:17], a[76:79], v[76:79], v[14:17]
    ds_read_b64_tr_b16 a[76:77], v23 offset:40960
    ds_read_b64_tr_b16 a[78:79], v23 offset:41472
    v_mfma_f32_16x16x32_bf16 v[108:111], a[80:83], v[80:83], v[108:111]
    ds_read_b64_tr_b16 a[80:81], v20 offset:45056
    ds_read_b64_tr_b16 a[82:83], v20 offset:45568
    buffer_load_dwordx4 v[64:67], v13, s[28:31], s54 offen offset:1024 sc1
    v_mfma_f32_16x16x32_bf16 v[112:115], a[84:87], v[80:83], v[112:115]
    ds_read_b64_tr_b16 a[84:85], v21 offset:45056
    ds_read_b64_tr_b16 a[86:87], v21 offset:45568
    v_mfma_f32_16x16x32_bf16 v[116:119], a[88:91], v[80:83], v[116:119]
    ds_read_b64_tr_b16 a[88:89], v22 offset:45056
    ds_read_b64_tr_b16 a[90:91], v22 offset:45568
    v_mfma_f32_16x16x32_bf16 v[14:17], a[92:95], v[80:83], v[14:17]
    ds_read_b64_tr_b16 a[92:93], v23 offset:45056
    ds_read_b64_tr_b16 a[94:95], v23 offset:45568
    s_setprio 2
    v_cmp_class_f32_e64 vcc, v108, s61
    s_nop 0
    s_cbranch_vccnz Lnan
    s_waitcnt vmcnt(6)
    v_mfma_f32_16x16x32_bf16 v[108:111], a[96:99], v[84:87], v[108:111]
    ds_read_b64_tr_b16 a[96:97], v24 offset:0
    ds_read_b64_tr_b16 a[98:99], v24 offset:512
    buffer_load_dwordx4 v[68:71], v13, s[28:31], s54 offen offset:2048 sc1
    v_mfma_f32_16x16x32_bf16 v[112:115], a[100:103], v[84:87], v[112:115]
    ds_read_b64_tr_b16 a[100:101], v25 offset:0
    ds_read_b64_tr_b16 a[102:103], v25 offset:512
    v_mfma_f32_16x16x32_bf16 v[116:119], a[104:107], v[84:87], v[116:119]
    ds_read_b64_tr_b16 a[104:105], v26 offset:0
    ds_read_b64_tr_b16 a[106:107], v26 offset:512
    v_mfma_f32_16x16x32_bf16 v[14:17], a[108:111], v[84:87], v[14:17]
    ds_read_b64_tr_b16 a[108:109], v27 offset:0
    ds_read_b64_tr_b16 a[110:111], v27 offset:512
    v_mfma_f32_16x16x32_bf16 v[108:111], a[112:115], v[88:91], v[108:111]
    ds_read_b64_tr_b16 a[112:113], v24 offset:4096
    ds_read_b64_tr_b16 a[114:115], v24 offset:4608
    buffer_load_dwordx4 v[72:75], v13, s[28:31], s54 offen offset:3072 sc1
    v_mfma_f32_16x16x32_bf16 v[112:115], a[116:119], v[88:91], v[112:115]
    ds_read_b64_tr_b16 a[116:117], v25 offset:4096
    ds_read_b64_tr_b16 a[118:119], v25 offset:4608
    v_mfma_f32_16x16x32_bf16 v[116:119], a[120:123], v[88:91], v[116:119]
    ds_read_b64_tr_b16 a[120:121], v26 offset:4096
    ds_read_b64_tr_b16 a[122:123], v26 offset:4608
    v_mfma_f32_16x16x32_bf16 v[14:17], a[124:127], v[88:91], v[14:17]
    ds_read_b64_tr_b16 a[124:125], v27 offset:4096
    ds_read_b64_tr_b16 a[126:127], v27 offset:4608
    v_cmp_class_f32_e64 vcc, v108, s61
    s_nop 0
    s_cbranch_vccnz Lnan
    s_waitcnt vmcnt(6) lgkmcnt(15)
    v_mfma_f32_16x16x32_bf16 v[108:111], a[0:3], v[92:95], v[108:111]
    ds_read_b64_tr_b16 a[0:1], v24 offset:8192
    ds_read_b64_tr_b16 a[2:3], v24 offset:8704
    buffer_load_dwordx4 v[76:79], v13, s[28:31], s55 offen offset:0 sc1
    v_mfma_f32_16x16x32_bf16 v[112:115], a[4:7], v[92:95], v[112:115]
    ds_read_b64_tr_b16 a[4:5], v25 offset:8192
    ds_read_b64_tr_b16 a[6:7], v25 offset:8704
    v_mfma_f32_16x16x32_bf16 v[116:119], a[8:11], v[92:95], v[116:119]
    ds_read_b64_tr_b16 a[8:9], v26 offset:8192
    ds_read_b64_tr_b16 a[10:11], v26 offset:8704
    v_mfma_f32_16x16x32_bf16 v[14:17], a[12:15], v[92:95], v[14:17]
    ds_read_b64_tr_b16 a[12:13], v27 offset:8192
    ds_read_b64_tr_b16 a[14:15], v27 offset:8704
    v_mfma_f32_16x16x32_bf16 v[108:111], a[16:19], v[96:99], v[108:111]
    ds_read_b64_tr_b16 a[16:17], v24 offset:12288
    ds_read_b64_tr_b16 a[18:19], v24 offset:12800
    buffer_load_dwordx4 v[80:83], v13, s[28:31], s55 offen offset:1024 sc1
    v_mfma_f32_16x16x32_bf16 v[112:115], a[20:23], v[96:99], v[112:115]
    ds_read_b64_tr_b16 a[20:21], v25 offset:12288
    ds_read_b64_tr_b16 a[22:23], v25 offset:12800
    v_mfma_f32_16x16x32_bf16 v[116:119], a[24:27], v[96:99], v[116:119]
    ds_read_b64_tr_b16 a[24:25], v26 offset:12288
    ds_read_b64_tr_b16 a[26:27], v26 offset:12800
    v_mfma_f32_16x16x32_bf16 v[14:17], a[28:31], v[96:99], v[14:17]
    ds_read_b64_tr_b16 a[28:29], v27 offset:12288
    ds_read_b64_tr_b16 a[30:31], v27 offset:12800
    v_cmp_class_f32_e64 vcc, v108, s61
    s_nop 0
    s_cbranch_vccnz Lnan
    s_waitcnt vmcnt(6)
    v_mfma_f32_16x16x32_bf16 v[108:111], a[32:35], v[100:103], v[108:111]
    ds_read_b64_tr_b16 a[32:33], v20 offset:49152
    ds_read_b64_tr_b16 a[34:35], v20 offset:49664
    buffer_load_dwordx4 v[84:87], v13, s[28:31], s55 offen offset:2048 sc1
    v_mfma_f32_16x16x32_bf16 v[112:115], a[36:39], v[100:103], v[112:115]
    ds_read_b64_tr_b16 a[36:37], v21 offset:49152
    ds_read_b64_tr_b16 a[38:39], v21 offset:49664
    v_mfma_f32_16x16x32_bf16 v[116:119], a[40:43], v[100:103], v[116:119]
    ds_read_b64_tr_b16 a[40:41], v22 offset:49152
    ds_read_b64_tr_b16 a[42:43], v22 offset:49664
    v_mfma_f32_16x16x32_bf16 v[14:17], a[44:47], v[100:103], v[14:17]
    ds_read_b64_tr_b16 a[44:45], v23 offset:49152
    ds_read_b64_tr_b16 a[46:47], v23 offset:49664
    v_mfma_f32_16x16x32_bf16 v[108:111], a[48:51], v[104:107], v[108:111]
    ds_read_b64_tr_b16 a[48:49], v24 offset:24576
    ds_read_b64_tr_b16 a[50:51], v24 offset:25088
    buffer_load_dwordx4 v[88:91], v13, s[28:31], s55 offen offset:3072 sc1
    v_mfma_f32_16x16x32_bf16 v[112:115], a[52:55], v[104:107], v[112:115]
    ds_read_b64_tr_b16 a[52:53], v25 offset:24576
    ds_read_b64_tr_b16 a[54:55], v25 offset:25088
    v_mfma_f32_16x16x32_bf16 v[116:119], a[56:59], v[104:107], v[116:119]
    ds_read_b64_tr_b16 a[56:57], v26 offset:24576
    ds_read_b64_tr_b16 a[58:59], v26 offset:25088
    v_mfma_f32_16x16x32_bf16 v[14:17], a[60:63], v[104:107], v[14:17]
    ds_read_b64_tr_b16 a[60:61], v27 offset:24576
    ds_read_b64_tr_b16 a[62:63], v27 offset:25088
    s_setprio 1
    v_cmp_class_f32_e64 vcc, v108, s61
    s_nop 0
    s_cbranch_vccnz Lnan
    s_waitcnt vmcnt(6)
    v_mfma_f32_16x16x32_bf16 v[108:111], a[64:67], v[60:63], v[108:111]
    v_mfma_f32_16x16x32_bf16 v[112:115], a[68:71], v[60:63], v[112:115]
    v_mfma_f32_16x16x32_bf16 v[116:119], a[72:75], v[60:63], v[116:119]
    v_mfma_f32_16x16x32_bf16 v[14:17], a[76:79], v[60:63], v[14:17]
    v_mfma_f32_16x16x32_bf16 v[108:111], a[80:83], v[64:67], v[108:111]
    v_mfma_f32_16x16x32_bf16 v[112:115], a[84:87], v[64:67], v[112:115]
    v_mfma_f32_16x16x32_bf16 v[116:119], a[88:91], v[64:67], v[116:119]
    v_mfma_f32_16x16x32_bf16 v[14:17], a[92:95], v[64:67], v[14:17]
    s_waitcnt vmcnt(4) lgkmcnt(15)
    v_mfma_f32_16x16x32_bf16 v[108:111], a[96:99], v[68:71], v[108:111]
    v_mfma_f32_16x16x32_bf16 v[112:115], a[100:103], v[68:71], v[112:115]
    v_mfma_f32_16x16x32_bf16 v[116:119], a[104:107], v[68:71], v[116:119]
    v_mfma_f32_16x16x32_bf16 v[14:17], a[108:111], v[68:71], v[14:17]
    v_mfma_f32_16x16x32_bf16 v[108:111], a[112:115], v[72:75], v[108:111]
    v_mfma_f32_16x16x32_bf16 v[112:115], a[116:119], v[72:75], v[112:115]
    v_mfma_f32_16x16x32_bf16 v[116:119], a[120:123], v[72:75], v[116:119]
    v_mfma_f32_16x16x32_bf16 v[14:17], a[124:127], v[72:75], v[14:17]
    s_setprio 0
    s_waitcnt vmcnt(2)
    v_mfma_f32_16x16x32_bf16 v[108:111], a[0:3], v[76:79], v[108:111]
    v_mfma_f32_16x16x32_bf16 v[112:115], a[4:7], v[76:79], v[112:115]
    v_mfma_f32_16x16x32_bf16 v[116:119], a[8:11], v[76:79], v[116:119]
    v_mfma_f32_16x16x32_bf16 v[14:17], a[12:15], v[76:79], v[14:17]
    v_mfma_f32_16x16x32_bf16 v[108:111], a[16:19], v[80:83], v[108:111]
    v_mfma_f32_16x16x32_bf16 v[112:115], a[20:23], v[80:83], v[112:115]
    v_mfma_f32_16x16x32_bf16 v[116:119], a[24:27], v[80:83], v[116:119]
    v_mfma_f32_16x16x32_bf16 v[14:17], a[28:31], v[80:83], v[14:17]
    s_waitcnt vmcnt(0) lgkmcnt(8)
    v_mfma_f32_16x16x32_bf16 v[108:111], a[32:35], v[84:87], v[108:111]
    v_mfma_f32_16x16x32_bf16 v[112:115], a[36:39], v[84:87], v[112:115]
    v_mfma_f32_16x16x32_bf16 v[116:119], a[40:43], v[84:87], v[116:119]
    v_mfma_f32_16x16x32_bf16 v[14:17], a[44:47], v[84:87], v[14:17]
    s_waitcnt lgkmcnt(0)
    v_mfma_f32_16x16x32_bf16 v[108:111], a[48:51], v[88:91], v[108:111]
    v_mfma_f32_16x16x32_bf16 v[112:115], a[52:55], v[88:91], v[112:115]
    v_mfma_f32_16x16x32_bf16 v[116:119], a[56:59], v[88:91], v[116:119]
    v_mfma_f32_16x16x32_bf16 v[14:17], a[60:63], v[88:91], v[14:17]
    v_xor_b32 v60, 32, v124
    v_xor_b32 v61, 64, v124
    v_xor_b32 v62, 96, v124
    v_and_b32 v6, v8, v9
    s_nop 0
    v_readfirstlane_b32 s39, v6
    v_cmp_class_f32_e64 vcc, v108, s61
    s_nop 0
    s_cbranch_vccnz Lnan
    s_cmp_eq_u32 s39, -1
    s_cbranch_scc0 Lfix
Lnofix:
    v_fma_f32 v108, v108, v44, v28
    v_fma_f32 v109, v109, v45, v29
    v_fma_f32 v110, v110, v46, v30
    v_fma_f32 v111, v111, v47, v31
    v_cvt_pk_bf16_f32 v68, v108, v109
    v_cvt_pk_bf16_f32 v69, v110, v111
    ds_write_b64 v124, v[68:69]
    v_fma_f32 v112, v112, v48, v32
    v_fma_f32 v113, v113, v49, v33
    v_fma_f32 v114, v114, v50, v34
    v_fma_f32 v115, v115, v51, v35
    v_cvt_pk_bf16_f32 v70, v112, v113
    v_cvt_pk_bf16_f32 v71, v114, v115
    ds_write_b64 v60, v[70:71]
    v_fma_f32 v116, v116, v52, v36
    v_fma_f32 v117, v117, v53, v37
    v_fma_f32 v118, v118, v54, v38
    v_fma_f32 v119, v119, v55, v39
    v_cvt_pk_bf16_f32 v72, v116, v117
    v_cvt_pk_bf16_f32 v73, v118, v119
    ds_write_b64 v61, v[72:73]
    v_fma_f32 v14, v14, v56, v40
    v_fma_f32 v15, v15, v57, v41
    v_fma_f32 v16, v16, v58, v42
    v_fma_f32 v17, v17, v59, v43
    v_cvt_pk_bf16_f32 v74, v14, v15
    v_cvt_pk_bf16_f32 v75, v16, v17
    ds_write_b64 v62, v[74:75]
    ds_read_b128 v[76:79], v125 offset:0
    ds_read_b128 v[80:83], v125 offset:1024
    s_waitcnt lgkmcnt(1)
    buffer_store_dwordx4 v[76:79], v122, s[44:47], s24 offen
    s_waitcnt lgkmcnt(0)
    buffer_store_dwordx4 v[80:83], v123, s[44:47], s24 offen
    s_endpgm
Lh1:
    ds_write_b128 v125, v[44:47] offset:0
    ds_write_b128 v125, v[48:51] offset:1024
    v_mov_b32 v5, 157972
    v_mov_b32 v6, 1
    s_mov_b64 exec, 1
    ds_add_u32 v5, v6
    s_mov_b64 exec, -1
    v_fmac_f32 v28, v76, v120
    v_fmac_f32 v29, v77, v120
    v_fmac_f32 v30, v78, v120
    v_fmac_f32 v31, v79, v120
    v_cvt_pk_bf16_f32 v28, v28, v29
    v_cvt_pk_bf16_f32 v29, v30, v31
    v_fmac_f32 v32, v80, v120
    v_fmac_f32 v33, v81, v120
    v_fmac_f32 v34, v82, v120
    v_fmac_f32 v35, v83, v120
    v_cvt_pk_bf16_f32 v30, v32, v33
    v_cvt_pk_bf16_f32 v31, v34, v35
    v_fmac_f32 v36, v84, v120
    v_fmac_f32 v37, v85, v120
    v_fmac_f32 v38, v86, v120
    v_fmac_f32 v39, v87, v120
    v_cvt_pk_bf16_f32 v32, v36, v37
    v_cvt_pk_bf16_f32 v33, v38, v39
    v_fmac_f32 v40, v88, v120
    v_fmac_f32 v41, v89, v120
    v_fmac_f32 v42, v90, v120
    v_fmac_f32 v43, v91, v120
    v_cvt_pk_bf16_f32 v34, v40, v41
    v_cvt_pk_bf16_f32 v35, v42, v43
    v_subrev_u32 v4, 6144, v125
    v_mov_b32 v8, s22
    v_mov_b32 v9, s22
    v_mov_b32 v10, s22
    v_mov_b32 v11, s22
Lcw_2:
    s_sub_u32 s35, s35, 1
    s_cbranch_scc1 Lend
    ds_read_b32 v6, v5
    s_waitcnt lgkmcnt(0)
    v_readfirstlane_b32 s38, v6
    s_nop 0
    s_cmp_lt_u32 s38, 8
    s_cbranch_scc1 Lcw_2
    ds_read_b128 v[52:55], v125 offset:2048
    ds_read_b128 v[56:59], v125 offset:3072
    ds_read_b128 v[44:47], v4 offset:4096
    ds_read_b128 v[48:51], v4 offset:5120
    s_branch Lh_join
Lqf_re:
    s_sub_u32 s35, s35, 1
    s_cbranch_scc1 Lend
    ds_read_b32 v7, v96
    ds_read_b128 v[76:79], v95 offset:0
    ds_read_b128 v[80:83], v95 offset:64
    ds_read_b128 v[84:87], v95 offset:128
    ds_read_b128 v[88:91], v95 offset:192
    s_waitcnt lgkmcnt(0)
    s_branch Lqf
Lcsv_re:
    s_sub_u32 s35, s35, 1
    s_cbranch_scc1 Lend
    ds_read_b32 v46, v49
    ds_read_b64 v[44:45], v48
    s_waitcnt lgkmcnt(0)
    s_branch Lcsv
Lrx_re:
    s_sub_u32 s35, s35, 1
    s_cbranch_scc1 Lend
    buffer_load_dwordx2 v[52:53], v13, s[28:31], s57 offen offset:8 sc1
    buffer_load_dwordx2 v[54:55], v13, s[28:31], s58 offen offset:0 sc1
    s_waitcnt vmcnt(0)
    s_branch Lrx_chk
Linfo_re:
    s_sub_u32 s35, s35, 1
    s_cbranch_scc1 Lend
    ds_read_b64 v[8:9], v10
    s_waitcnt lgkmcnt(0)
    s_branch Linfo
Lfl_re:
    s_sub_u32 s35, s35, 1
    s_cbranch_scc1 Lend
    buffer_load_dword v20, v12, s[28:31], s24 offen sc1
    s_waitcnt vmcnt(0)
    s_branch Lfl_chk
Lxe0:
    ds_read_b64 v[108:109], v4
    ds_read_b64 v[110:111], v5
    ds_read_b64 v[112:113], v6
    ds_read_b64 v[114:115], v7
    s_branch Lxe0_b
Lxe1:
    ds_read_b64 v[108:109], v4
    ds_read_b64 v[110:111], v5
    ds_read_b64 v[112:113], v6
    ds_read_b64 v[114:115], v7
    s_branch Lxe1_b
Lxe2:
    ds_read_b64 v[108:109], v4
    ds_read_b64 v[110:111], v5
    ds_read_b64 v[112:113], v6
    ds_read_b64 v[114:115], v7
    s_branch Lxe2_b
Lxe3:
    ds_read_b64 v[108:109], v4
    ds_read_b64 v[110:111], v5
    ds_read_b64 v[112:113], v6
    ds_read_b64 v[114:115], v7
    s_branch Lxe3_b
Lxe4:
    ds_read_b64 v[108:109], v4
    ds_read_b64 v[110:111], v5
    ds_read_b64 v[112:113], v6
    ds_read_b64 v[114:115], v7
    s_branch Lxe4_b
Lxe5:
    ds_read_b64 v[108:109], v4
    ds_read_b64 v[110:111], v5
    ds_read_b64 v[112:113], v6
    ds_read_b64 v[114:115], v7
    s_branch Lxe5_b
Lxe6:
    ds_read_b64 v[108:109], v4
    ds_read_b64 v[110:111], v5
    ds_read_b64 v[112:113], v6
    ds_read_b64 v[114:115], v7
    s_branch Lxe6_b
Lxe7:
    ds_read_b64 v[108:109], v4
    ds_read_b64 v[110:111], v5
    ds_read_b64 v[112:113], v6
    ds_read_b64 v[114:115], v7
    s_branch Lxe7_b
Lxe8:
    ds_read_b64 v[108:109], v4
    ds_read_b64 v[110:111], v5
    ds_read_b64 v[112:113], v6
    ds_read_b64 v[114:115], v7
    s_branch Lxe8_b
Lxe9:
    ds_read_b64 v[108:109], v4
    ds_read_b64 v[110:111], v5
    ds_read_b64 v[112:113], v6
    ds_read_b64 v[114:115], v7
    s_branch Lxe9_b
Lnan:
    s_add_u32 s41, s41, 1
    s_cmp_eq_u32 s41, 2
    s_cbranch_scc1 Lval0
    v_min_u32 v18, 19, v1
    v_lshlrev_b32 v18, 10, v18
Lprobe:
    s_sub_u32 s35, s35, 1
    s_cbranch_scc1 Lend
    buffer_load_dword v19, v18, s[28:31], s50 offen offset:1020 sc1
    s_waitcnt vmcnt(0)
    v_cmp_eq_u32 vcc, -1, v19
    s_nop 0
    s_cbranch_vccnz Lprobe
    s_branch Lredo
Lval0:
    s_mov_b32 s61, 0
    s_mov_b32 s36, s50
    s_add_u32 s37, s50, 20480
    s_waitcnt vmcnt(0)
Lval:
    s_sub_u32 s35, s35, 1
    s_cbranch_scc1 Lend
    buffer_load_dwordx4 v[60:63], v13, s[28:31], s36 offen sc1
    s_waitcnt vmcnt(0)
    v_max3_u32 v60, v60, v61, v62
    v_max_u32 v60, v60, v63
    v_cmp_eq_u32 vcc, -1, v60
    s_nop 0
    s_cbranch_vccnz Lval
    s_add_u32 s36, s36, 1024
    s_cmp_lt_u32 s36, s37
    s_cbranch_scc1 Lval
Lredo:
    buffer_load_dwordx4 v[60:63], v13, s[28:31], s51 offen offset:0 sc1
    buffer_load_dwordx4 v[64:67], v13, s[28:31], s51 offen offset:1024 sc1
    buffer_load_dwordx4 v[68:71], v13, s[28:31], s51 offen offset:2048 sc1
    buffer_load_dwordx4 v[72:75], v13, s[28:31], s51 offen offset:3072 sc1
    buffer_load_dwordx4 v[76:79], v13, s[28:31], s52 offen offset:0 sc1
    buffer_load_dwordx4 v[80:83], v13, s[28:31], s52 offen offset:1024 sc1
    buffer_load_dwordx4 v[84:87], v13, s[28:31], s52 offen offset:2048 sc1
    buffer_load_dwordx4 v[88:91], v13, s[28:31], s52 offen offset:3072 sc1
    ds_read_b64_tr_b16 a[0:1], v20 offset:0
    ds_read_b64_tr_b16 a[2:3], v20 offset:512
    ds_read_b64_tr_b16 a[4:5], v21 offset:0
    ds_read_b64_tr_b16 a[6:7], v21 offset:512
    ds_read_b64_tr_b16 a[8:9], v22 offset:0
    ds_read_b64_tr_b16 a[10:11], v22 offset:512
    ds_read_b64_tr_b16 a[12:13], v23 offset:0
    ds_read_b64_tr_b16 a[14:15], v23 offset:512
    ds_read_b64_tr_b16 a[16:17], v20 offset:4096
    ds_read_b64_tr_b16 a[18:19], v20 offset:4608
    ds_read_b64_tr_b16 a[20:21], v21 offset:4096
    ds_read_b64_tr_b16 a[22:23], v21 offset:4608
    ds_read_b64_tr_b16 a[24:25], v22 offset:4096
    ds_read_b64_tr_b16 a[26:27], v22 offset:4608
    ds_read_b64_tr_b16 a[28:29], v23 offset:4096
    ds_read_b64_tr_b16 a[30:31], v23 offset:4608
    ds_read_b64_tr_b16 a[32:33], v20 offset:8192
    ds_read_b64_tr_b16 a[34:35], v20 offset:8704
    ds_read_b64_tr_b16 a[36:37], v21 offset:8192
    ds_read_b64_tr_b16 a[38:39], v21 offset:8704
    ds_read_b64_tr_b16 a[40:41], v22 offset:8192
    ds_read_b64_tr_b16 a[42:43], v22 offset:8704
    ds_read_b64_tr_b16 a[44:45], v23 offset:8192
    ds_read_b64_tr_b16 a[46:47], v23 offset:8704
    ds_read_b64_tr_b16 a[48:49], v20 offset:12288
    ds_read_b64_tr_b16 a[50:51], v20 offset:12800
    ds_read_b64_tr_b16 a[52:53], v21 offset:12288
    ds_read_b64_tr_b16 a[54:55], v21 offset:12800
    ds_read_b64_tr_b16 a[56:57], v22 offset:12288
    ds_read_b64_tr_b16 a[58:59], v22 offset:12800
    ds_read_b64_tr_b16 a[60:61], v23 offset:12288
    ds_read_b64_tr_b16 a[62:63], v23 offset:12800
    ds_read_b64_tr_b16 a[64:65], v20 offset:24576
    ds_read_b64_tr_b16 a[66:67], v20 offset:25088
    ds_read_b64_tr_b16 a[68:69], v21 offset:24576
    ds_read_b64_tr_b16 a[70:71], v21 offset:25088
    ds_read_b64_tr_b16 a[72:73], v22 offset:24576
    ds_read_b64_tr_b16 a[74:75], v22 offset:25088
    ds_read_b64_tr_b16 a[76:77], v23 offset:24576
    ds_read_b64_tr_b16 a[78:79], v23 offset:25088
    ds_read_b64_tr_b16 a[80:81], v20 offset:28672
    ds_read_b64_tr_b16 a[82:83], v20 offset:29184
    ds_read_b64_tr_b16 a[84:85], v21 offset:28672
    ds_read_b64_tr_b16 a[86:87], v21 offset:29184
    ds_read_b64_tr_b16 a[88:89], v22 offset:28672
    ds_read_b64_tr_b16 a[90:91], v22 offset:29184
    ds_read_b64_tr_b16 a[92:93], v23 offset:28672
    ds_read_b64_tr_b16 a[94:95], v23 offset:29184
    ds_read_b64_tr_b16 a[96:97], v24 offset:59520
    ds_read_b64_tr_b16 a[98:99], v24 offset:60032
    ds_read_b64_tr_b16 a[100:101], v25 offset:59520
    ds_read_b64_tr_b16 a[102:103], v25 offset:60032
    ds_read_b64_tr_b16 a[104:105], v26 offset:59520
    ds_read_b64_tr_b16 a[106:107], v26 offset:60032
    ds_read_b64_tr_b16 a[108:109], v27 offset:59520
    ds_read_b64_tr_b16 a[110:111], v27 offset:60032
    ds_read_b64_tr_b16 a[112:113], v24 offset:63616
    ds_read_b64_tr_b16 a[114:115], v24 offset:64128
    ds_read_b64_tr_b16 a[116:117], v25 offset:63616
    ds_read_b64_tr_b16 a[118:119], v25 offset:64128
    ds_read_b64_tr_b16 a[120:121], v26 offset:63616
    ds_read_b64_tr_b16 a[122:123], v26 offset:64128
    ds_read_b64_tr_b16 a[124:125], v27 offset:63616
    ds_read_b64_tr_b16 a[126:127], v27 offset:64128
    s_waitcnt lgkmcnt(0)
    s_branch Lwo_go
Lfix:
    v_lshlrev_b32 v6, 4, v2
    v_add_u32 v6, 158208, v6
    v_mov_b32 v10, 157956
    v_mov_b32 v11, 1
    v_sub_u32 v4, v126, v3
    v_lshrrev_b32 v5, 3, v1
    v_add_u32 v4, v4, v5
    v_add_u32 v5, 8, v4
    v_mov_b32 v7, 0x40000000
    v_cmp_eq_u32 vcc, v8, v4
    s_nop 1
    v_cndmask_b32 v122, v122, v7, vcc
    v_cmp_eq_u32 vcc, v8, v5
    s_nop 1
    v_cndmask_b32 v123, v123, v7, vcc
    v_cmp_eq_u32 vcc, v8, v126
    s_nop 0
    s_mov_b64 exec, vcc
    ds_write_b128 v6, v[108:111] offset:0
    ds_write_b128 v6, v[112:115] offset:64
    ds_write_b128 v6, v[116:119] offset:128
    ds_write_b128 v6, v[14:17] offset:192
    ds_add_u32 v10, v11
    s_mov_b64 exec, -1
    v_cmp_eq_u32 vcc, v9, v4
    s_nop 1
    v_cndmask_b32 v122, v122, v7, vcc
    v_cmp_eq_u32 vcc, v9, v5
    s_nop 1
    v_cndmask_b32 v123, v123, v7, vcc
    v_cmp_eq_u32 vcc, v9, v126
    s_nop 0
    s_mov_b64 exec, vcc
    ds_write_b128 v6, v[108:111] offset:256
    ds_write_b128 v6, v[112:115] offset:320
    ds_write_b128 v6, v[116:119] offset:384
    ds_write_b128 v6, v[14:17] offset:448
    ds_add_u32 v10, v11
    s_mov_b64 exec, -1
    s_branch Lnofix
Lhalo:
    s_mov_b32 vcc_lo, 0x00010001
    s_mov_b32 vcc_hi, 0x00010001
    v_mov_b32 v11, 38912
    v_cndmask_b32 v76, v76, v11, vcc
    v_xor_b32 v77, 64, v76
    v_add_u32 v80, 78080, v76
    v_add_u32 v81, 78080, v77
    v_mov_b32 v14, 0x3f803f80
    v_mov_b32 v15, 0x3f803f80
    v_mov_b32 v16, 0x3f803f80
    v_mov_b32 v17, 0x3f803f80
    v_and_b32 v4, 7, v1
    v_lshlrev_b32 v4, 4, v4
    v_mul_u32_u24 v5, 39040, v2
    v_add_u32 v4, v4, v5
    ds_write_b128 v4, v[14:17] offset:38912
    v_mov_b32 v4, 157952
    v_mov_b32 v8, 0
    v_mov_b32 v9, 0
    v_mov_b32 v10, -2
    v_mov_b32 v11, -2
    ds_write_b128 v4, v[8:11]
    v_min_u32 v5, 23, v1
    v_lshl_add_u32 v5, v5, 2, v4
    ds_write_b32 v5, v8 offset:16
    s_mul_i32 s36, s32, 96
    s_sub_u32 s36, s36, 16
    v_add_u32 v96, s36, v1
    v_min_u32 v5, 47, v1
    v_add3_u32 v97, s36, v5, 64
    v_mov_b32 v6, 2047
    v_med3_i32 v96, v96, 0, v6
    v_med3_i32 v97, v97, 0, v6
    v_lshlrev_b32 v96, 3, v96
    v_lshlrev_b32 v97, 3, v97
    s_mov_b32 s49, 8192000
    v_mov_b32 v127, 157984
    s_lshl_b32 s36, s3, 2
    s_add_u32 s36, s36, 158016
    v_mov_b32 v10, s36
    s_waitcnt lgkmcnt(0)
    s_barrier
    s_add_u32 s34, s34, 0x9e3779b8
    s_or_b32 s34, s34, 1
    ds_read_b128 v[108:111], v76 offset:0
    ds_read_b128 v[112:115], v77 offset:0
    ds_read_b64_tr_b16 a[0:1], v20 offset:0
    ds_read_b64_tr_b16 a[2:3], v20 offset:512
    ds_read_b64_tr_b16 a[4:5], v21 offset:0
    ds_read_b64_tr_b16 a[6:7], v21 offset:512
    ds_read_b64_tr_b16 a[8:9], v22 offset:0
    ds_read_b64_tr_b16 a[10:11], v22 offset:512
    ds_read_b64_tr_b16 a[12:13], v23 offset:0
    ds_read_b64_tr_b16 a[14:15], v23 offset:512
    ds_read_b64_tr_b16 a[16:17], v20 offset:8192
    ds_read_b64_tr_b16 a[18:19], v20 offset:8704
    ds_read_b64_tr_b16 a[20:21], v21 offset:8192
    ds_read_b64_tr_b16 a[22:23], v21 offset:8704
    ds_read_b64_tr_b16 a[24:25], v22 offset:8192
    ds_read_b64_tr_b16 a[26:27], v22 offset:8704
    s_waitcnt lgkmcnt(12)
    v_mfma_f32_16x16x32_bf16 v[28:31], a[0:3], v[108:111], 0
    ds_read_b64_tr_b16 a[28:29], v23 offset:8192
    ds_read_b64_tr_b16 a[30:31], v23 offset:8704
    s_waitcnt lgkmcnt(12)
    v_mfma_f32_16x16x32_bf16 v[32:35], a[4:7], v[108:111], 0
    ds_read_b64_tr_b16 a[32:33], v20 offset:16384
    ds_read_b64_tr_b16 a[34:35], v20 offset:16896
    s_waitcnt lgkmcnt(12)
    v_mfma_f32_16x16x32_bf16 v[36:39], a[8:11], v[108:111], 0
    ds_read_b64_tr_b16 a[36:37], v21 offset:16384
    ds_read_b64_tr_b16 a[38:39], v21 offset:16896
    s_waitcnt lgkmcnt(12)
    v_mfma_f32_16x16x32_bf16 v[40:43], a[12:15], v[108:111], 0
    ds_read_b64_tr_b16 a[40:41], v22 offset:16384
    ds_read_b64_tr_b16 a[42:43], v22 offset:16896
    s_waitcnt lgkmcnt(12)
    v_mfma_f32_16x16x32_bf16 v[44:47], a[16:19], v[108:111], 0
    ds_read_b64_tr_b16 a[44:45], v23 offset:16384
    ds_read_b64_tr_b16 a[46:47], v23 offset:16896
    s_waitcnt lgkmcnt(12)
    v_mfma_f32_16x16x32_bf16 v[48:51], a[20:23], v[108:111], 0
    ds_read_b64_tr_b16 a[48:49], v20 offset:4096
    ds_read_b64_tr_b16 a[50:51], v20 offset:4608
    s_waitcnt lgkmcnt(12)
    v_mfma_f32_16x16x32_bf16 v[52:55], a[24:27], v[108:111], 0
    ds_read_b64_tr_b16 a[52:53], v21 offset:4096
    ds_read_b64_tr_b16 a[54:55], v21 offset:4608
    s_waitcnt lgkmcnt(12)
    v_mfma_f32_16x16x32_bf16 v[56:59], a[28:31], v[108:111], 0
    ds_read_b64_tr_b16 a[56:57], v22 offset:4096
    ds_read_b64_tr_b16 a[58:59], v22 offset:4608
    s_waitcnt lgkmcnt(12)
    v_mfma_f32_16x16x32_bf16 v[60:63], v[108:111], a[32:35], 0
    ds_read_b64_tr_b16 a[60:61], v23 offset:4096
    ds_read_b64_tr_b16 a[62:63], v23 offset:4608
    s_waitcnt lgkmcnt(12)
    v_mfma_f32_16x16x32_bf16 v[64:67], v[108:111], a[36:39], 0
    ds_read_b64_tr_b16 a[64:65], v20 offset:12288
    ds_read_b64_tr_b16 a[66:67], v20 offset:12800
    s_waitcnt lgkmcnt(12)
    v_mfma_f32_16x16x32_bf16 v[68:71], v[108:111], a[40:43], 0
    ds_read_b64_tr_b16 a[68:69], v21 offset:12288
    ds_read_b64_tr_b16 a[70:71], v21 offset:12800
    s_waitcnt lgkmcnt(12)
    v_mfma_f32_16x16x32_bf16 v[72:75], v[108:111], a[44:47], 0
    ds_read_b64_tr_b16 a[72:73], v22 offset:12288
    ds_read_b64_tr_b16 a[74:75], v22 offset:12800
    s_waitcnt lgkmcnt(12)
    v_mfma_f32_16x16x32_bf16 v[28:31], a[48:51], v[112:115], v[28:31]
    ds_read_b64_tr_b16 a[76:77], v23 offset:12288
    ds_read_b64_tr_b16 a[78:79], v23 offset:12800
    s_waitcnt lgkmcnt(12)
    v_mfma_f32_16x16x32_bf16 v[32:35], a[52:55], v[112:115], v[32:35]
    ds_read_b64_tr_b16 a[80:81], v20 offset:20480
    ds_read_b64_tr_b16 a[82:83], v20 offset:20992
    s_waitcnt lgkmcnt(12)
    v_mfma_f32_16x16x32_bf16 v[36:39], a[56:59], v[112:115], v[36:39]
    ds_read_b64_tr_b16 a[84:85], v21 offset:20480
    ds_read_b64_tr_b16 a[86:87], v21 offset:20992
    s_waitcnt lgkmcnt(12)
    v_mfma_f32_16x16x32_bf16 v[40:43], a[60:63], v[112:115], v[40:43]
    ds_read_b64_tr_b16 a[88:89], v22 offset:20480
    ds_read_b64_tr_b16 a[90:91], v22 offset:20992
    s_waitcnt lgkmcnt(12)
    v_mfma_f32_16x16x32_bf16 v[44:47], a[64:67], v[112:115], v[44:47]
    ds_read_b64_tr_b16 a[92:93], v23 offset:20480
    ds_read_b64_tr_b16 a[94:95], v23 offset:20992
    s_waitcnt lgkmcnt(12)
    v_mfma_f32_16x16x32_bf16 v[48:51], a[68:71], v[112:115], v[48:51]
    s_waitcnt lgkmcnt(10)
    v_mfma_f32_16x16x32_bf16 v[52:55], a[72:75], v[112:115], v[52:55]
    s_waitcnt lgkmcnt(8)
    v_mfma_f32_16x16x32_bf16 v[56:59], a[76:79], v[112:115], v[56:59]
    s_waitcnt lgkmcnt(6)
    v_mfma_f32_16x16x32_bf16 v[60:63], v[112:115], a[80:83], v[60:63]
    s_waitcnt lgkmcnt(4)
    v_mfma_f32_16x16x32_bf16 v[64:67], v[112:115], a[84:87], v[64:67]
    s_waitcnt lgkmcnt(2)
    v_mfma_f32_16x16x32_bf16 v[68:71], v[112:115], a[88:91], v[68:71]
    s_waitcnt lgkmcnt(0)
    v_mfma_f32_16x16x32_bf16 v[72:75], v[112:115], a[92:95], v[72:75]
    s_barrier
    ds_read_b128 v[108:111], v76 offset:39040
    ds_read_b128 v[112:115], v77 offset:39040
    ds_read_b64_tr_b16 a[0:1], v20 offset:39040
    ds_read_b64_tr_b16 a[2:3], v20 offset:39552
    ds_read_b64_tr_b16 a[4:5], v21 offset:39040
    ds_read_b64_tr_b16 a[6:7], v21 offset:39552
    ds_read_b64_tr_b16 a[8:9], v22 offset:39040
    ds_read_b64_tr_b16 a[10:11], v22 offset:39552
    ds_read_b64_tr_b16 a[12:13], v23 offset:39040
    ds_read_b64_tr_b16 a[14:15], v23 offset:39552
    ds_read_b64_tr_b16 a[16:17], v20 offset:47232
    ds_read_b64_tr_b16 a[18:19], v20 offset:47744
    ds_read_b64_tr_b16 a[20:21], v21 offset:47232
    ds_read_b64_tr_b16 a[22:23], v21 offset:47744
    ds_read_b64_tr_b16 a[24:25], v22 offset:47232
    ds_read_b64_tr_b16 a[26:27], v22 offset:47744
    s_waitcnt lgkmcnt(12)
    v_mfma_f32_16x16x32_bf16 v[28:31], a[0:3], v[108:111], v[28:31]
    ds_read_b64_tr_b16 a[28:29], v23 offset:47232
    ds_read_b64_tr_b16 a[30:31], v23 offset:47744
    s_waitcnt lgkmcnt(12)
    v_mfma_f32_16x16x32_bf16 v[32:35], a[4:7], v[108:111], v[32:35]
    ds_read_b64_tr_b16 a[32:33], v20 offset:55424
    ds_read_b64_tr_b16 a[34:35], v20 offset:55936
    s_waitcnt lgkmcnt(12)
    v_mfma_f32_16x16x32_bf16 v[36:39], a[8:11], v[108:111], v[36:39]
    ds_read_b64_tr_b16 a[36:37], v21 offset:55424
    ds_read_b64_tr_b16 a[38:39], v21 offset:55936
    s_waitcnt lgkmcnt(12)
    v_mfma_f32_16x16x32_bf16 v[40:43], a[12:15], v[108:111], v[40:43]
    ds_read_b64_tr_b16 a[40:41], v22 offset:55424
    ds_read_b64_tr_b16 a[42:43], v22 offset:55936
    s_waitcnt lgkmcnt(12)
    v_mfma_f32_16x16x32_bf16 v[44:47], a[16:19], v[108:111], v[44:47]
    ds_read_b64_tr_b16 a[44:45], v23 offset:55424
    ds_read_b64_tr_b16 a[46:47], v23 offset:55936
    s_waitcnt lgkmcnt(12)
    v_mfma_f32_16x16x32_bf16 v[48:51], a[20:23], v[108:111], v[48:51]
    ds_read_b64_tr_b16 a[48:49], v20 offset:43136
    ds_read_b64_tr_b16 a[50:51], v20 offset:43648
    s_waitcnt lgkmcnt(12)
    v_mfma_f32_16x16x32_bf16 v[52:55], a[24:27], v[108:111], v[52:55]
    ds_read_b64_tr_b16 a[52:53], v21 offset:43136
    ds_read_b64_tr_b16 a[54:55], v21 offset:43648
    s_waitcnt lgkmcnt(12)
    v_mfma_f32_16x16x32_bf16 v[56:59], a[28:31], v[108:111], v[56:59]
    ds_read_b64_tr_b16 a[56:57], v22 offset:43136
    ds_read_b64_tr_b16 a[58:59], v22 offset:43648
    s_waitcnt lgkmcnt(12)
    v_mfma_f32_16x16x32_bf16 v[60:63], v[108:111], a[32:35], v[60:63]
    ds_read_b64_tr_b16 a[60:61], v23 offset:43136
    ds_read_b64_tr_b16 a[62:63], v23 offset:43648
    s_waitcnt lgkmcnt(12)
    v_mfma_f32_16x16x32_bf16 v[64:67], v[108:111], a[36:39], v[64:67]
    ds_read_b64_tr_b16 a[64:65], v20 offset:51328
    ds_read_b64_tr_b16 a[66:67], v20 offset:51840
    s_waitcnt lgkmcnt(12)
    v_mfma_f32_16x16x32_bf16 v[68:71], v[108:111], a[40:43], v[68:71]
    ds_read_b64_tr_b16 a[68:69], v21 offset:51328
    ds_read_b64_tr_b16 a[70:71], v21 offset:51840
    s_waitcnt lgkmcnt(12)
    v_mfma_f32_16x16x32_bf16 v[72:75], v[108:111], a[44:47], v[72:75]
    ds_read_b64_tr_b16 a[72:73], v22 offset:51328
    ds_read_b64_tr_b16 a[74:75], v22 offset:51840
    s_waitcnt lgkmcnt(12)
    v_mfma_f32_16x16x32_bf16 v[28:31], a[48:51], v[112:115], v[28:31]
    ds_read_b64_tr_b16 a[76:77], v23 offset:51328
    ds_read_b64_tr_b16 a[78:79], v23 offset:51840
    s_waitcnt lgkmcnt(12)
    v_mfma_f32_16x16x32_bf16 v[32:35], a[52:55], v[112:115], v[32:35]
    ds_read_b64_tr_b16 a[80:81], v20 offset:59520
    ds_read_b64_tr_b16 a[82:83], v20 offset:60032
    s_waitcnt lgkmcnt(12)
    v_mfma_f32_16x16x32_bf16 v[36:39], a[56:59], v[112:115], v[36:39]
    ds_read_b64_tr_b16 a[84:85], v21 offset:59520
    ds_read_b64_tr_b16 a[86:87], v21 offset:60032
    s_waitcnt lgkmcnt(12)
    v_mfma_f32_16x16x32_bf16 v[40:43], a[60:63], v[112:115], v[40:43]
    ds_read_b64_tr_b16 a[88:89], v22 offset:59520
    ds_read_b64_tr_b16 a[90:91], v22 offset:60032
    s_waitcnt lgkmcnt(12)
    v_mfma_f32_16x16x32_bf16 v[44:47], a[64:67], v[112:115], v[44:47]
    ds_read_b64_tr_b16 a[92:93], v23 offset:59520
    ds_read_b64_tr_b16 a[94:95], v23 offset:60032
    s_waitcnt lgkmcnt(12)
    v_mfma_f32_16x16x32_bf16 v[48:51], a[68:71], v[112:115], v[48:51]
    s_waitcnt lgkmcnt(10)
    v_mfma_f32_16x16x32_bf16 v[52:55], a[72:75], v[112:115], v[52:55]
    s_waitcnt lgkmcnt(8)
    v_mfma_f32_16x16x32_bf16 v[56:59], a[76:79], v[112:115], v[56:59]
    s_waitcnt lgkmcnt(6)
    v_mfma_f32_16x16x32_bf16 v[60:63], v[112:115], a[80:83], v[60:63]
    s_waitcnt lgkmcnt(4)
    v_mfma_f32_16x16x32_bf16 v[64:67], v[112:115], a[84:87], v[64:67]
    s_waitcnt lgkmcnt(2)
    v_mfma_f32_16x16x32_bf16 v[68:71], v[112:115], a[88:91], v[68:71]
    s_waitcnt lgkmcnt(0)
    v_mfma_f32_16x16x32_bf16 v[72:75], v[112:115], a[92:95], v[72:75]
    s_mov_b64 exec, 1
    s_lshl_b32 s36, s2, 2
    s_add_u32 s36, s36, 8323072
    v_mov_b32 v4, s34
    v_mov_b32 v5, s36
    buffer_store_dword v4, v5, s[28:31], 0 offen sc1
    s_mov_b64 exec, -1
    s_barrier
    ds_read_b128 v[108:111], v80 offset:0
    ds_read_b128 v[112:115], v81 offset:0
    ds_read_b64_tr_b16 a[0:1], v24 offset:0
    ds_read_b64_tr_b16 a[2:3], v24 offset:512
    ds_read_b64_tr_b16 a[4:5], v25 offset:0
    ds_read_b64_tr_b16 a[6:7], v25 offset:512
    ds_read_b64_tr_b16 a[8:9], v26 offset:0
    ds_read_b64_tr_b16 a[10:11], v26 offset:512
    ds_read_b64_tr_b16 a[12:13], v27 offset:0
    ds_read_b64_tr_b16 a[14:15], v27 offset:512
    ds_read_b64_tr_b16 a[16:17], v24 offset:8192
    ds_read_b64_tr_b16 a[18:19], v24 offset:8704
    ds_read_b64_tr_b16 a[20:21], v25 offset:8192
    ds_read_b64_tr_b16 a[22:23], v25 offset:8704
    ds_read_b64_tr_b16 a[24:25], v26 offset:8192
    ds_read_b64_tr_b16 a[26:27], v26 offset:8704
    s_waitcnt lgkmcnt(12)
    v_mfma_f32_16x16x32_bf16 v[28:31], a[0:3], v[108:111], v[28:31]
    ds_read_b64_tr_b16 a[28:29], v27 offset:8192
    ds_read_b64_tr_b16 a[30:31], v27 offset:8704
    s_waitcnt lgkmcnt(12)
    v_mfma_f32_16x16x32_bf16 v[32:35], a[4:7], v[108:111], v[32:35]
    ds_read_b64_tr_b16 a[32:33], v24 offset:16384
    ds_read_b64_tr_b16 a[34:35], v24 offset:16896
    s_waitcnt lgkmcnt(12)
    v_mfma_f32_16x16x32_bf16 v[36:39], a[8:11], v[108:111], v[36:39]
    ds_read_b64_tr_b16 a[36:37], v25 offset:16384
    ds_read_b64_tr_b16 a[38:39], v25 offset:16896
    s_waitcnt lgkmcnt(12)
    v_mfma_f32_16x16x32_bf16 v[40:43], a[12:15], v[108:111], v[40:43]
    ds_read_b64_tr_b16 a[40:41], v26 offset:16384
    ds_read_b64_tr_b16 a[42:43], v26 offset:16896
    s_waitcnt lgkmcnt(12)
    v_mfma_f32_16x16x32_bf16 v[44:47], a[16:19], v[108:111], v[44:47]
    ds_read_b64_tr_b16 a[44:45], v27 offset:16384
    ds_read_b64_tr_b16 a[46:47], v27 offset:16896
    s_waitcnt lgkmcnt(12)
    v_mfma_f32_16x16x32_bf16 v[48:51], a[20:23], v[108:111], v[48:51]
    ds_read_b64_tr_b16 a[48:49], v24 offset:4096
    ds_read_b64_tr_b16 a[50:51], v24 offset:4608
    s_waitcnt lgkmcnt(12)
    v_mfma_f32_16x16x32_bf16 v[52:55], a[24:27], v[108:111], v[52:55]
    ds_read_b64_tr_b16 a[52:53], v25 offset:4096
    ds_read_b64_tr_b16 a[54:55], v25 offset:4608
    s_waitcnt lgkmcnt(12)
    v_mfma_f32_16x16x32_bf16 v[56:59], a[28:31], v[108:111], v[56:59]
    ds_read_b64_tr_b16 a[56:57], v26 offset:4096
    ds_read_b64_tr_b16 a[58:59], v26 offset:4608
    s_waitcnt lgkmcnt(12)
    v_mfma_f32_16x16x32_bf16 v[60:63], v[108:111], a[32:35], v[60:63]
    ds_read_b64_tr_b16 a[60:61], v27 offset:4096
    ds_read_b64_tr_b16 a[62:63], v27 offset:4608
    s_waitcnt lgkmcnt(12)
    v_mfma_f32_16x16x32_bf16 v[64:67], v[108:111], a[36:39], v[64:67]
    ds_read_b64_tr_b16 a[64:65], v24 offset:12288
    ds_read_b64_tr_b16 a[66:67], v24 offset:12800
    s_waitcnt lgkmcnt(12)
    v_mfma_f32_16x16x32_bf16 v[68:71], v[108:111], a[40:43], v[68:71]
    ds_read_b64_tr_b16 a[68:69], v25 offset:12288
    ds_read_b64_tr_b16 a[70:71], v25 offset:12800
    s_waitcnt lgkmcnt(12)
    v_mfma_f32_16x16x32_bf16 v[72:75], v[108:111], a[44:47], v[72:75]
    ds_read_b64_tr_b16 a[72:73], v26 offset:12288
    ds_read_b64_tr_b16 a[74:75], v26 offset:12800
    s_waitcnt lgkmcnt(12)
    v_mfma_f32_16x16x32_bf16 v[28:31], a[48:51], v[112:115], v[28:31]
    ds_read_b64_tr_b16 a[76:77], v27 offset:12288
    ds_read_b64_tr_b16 a[78:79], v27 offset:12800
    s_waitcnt lgkmcnt(12)
    v_mfma_f32_16x16x32_bf16 v[32:35], a[52:55], v[112:115], v[32:35]
    ds_read_b64_tr_b16 a[80:81], v24 offset:20480
    ds_read_b64_tr_b16 a[82:83], v24 offset:20992
    s_waitcnt lgkmcnt(12)
    v_mfma_f32_16x16x32_bf16 v[36:39], a[56:59], v[112:115], v[36:39]
    ds_read_b64_tr_b16 a[84:85], v25 offset:20480
    ds_read_b64_tr_b16 a[86:87], v25 offset:20992
    s_waitcnt lgkmcnt(12)
    v_mfma_f32_16x16x32_bf16 v[40:43], a[60:63], v[112:115], v[40:43]
    ds_read_b64_tr_b16 a[88:89], v26 offset:20480
    ds_read_b64_tr_b16 a[90:91], v26 offset:20992
    s_waitcnt lgkmcnt(12)
    v_mfma_f32_16x16x32_bf16 v[44:47], a[64:67], v[112:115], v[44:47]
    ds_read_b64_tr_b16 a[92:93], v27 offset:20480
    ds_read_b64_tr_b16 a[94:95], v27 offset:20992
    s_waitcnt lgkmcnt(12)
    v_mfma_f32_16x16x32_bf16 v[48:51], a[68:71], v[112:115], v[48:51]
    s_waitcnt lgkmcnt(10)
    v_mfma_f32_16x16x32_bf16 v[52:55], a[72:75], v[112:115], v[52:55]
    s_waitcnt lgkmcnt(8)
    v_mfma_f32_16x16x32_bf16 v[56:59], a[76:79], v[112:115], v[56:59]
    s_waitcnt lgkmcnt(6)
    v_mfma_f32_16x16x32_bf16 v[60:63], v[112:115], a[80:83], v[60:63]
    s_waitcnt lgkmcnt(4)
    v_mfma_f32_16x16x32_bf16 v[64:67], v[112:115], a[84:87], v[64:67]
    s_waitcnt lgkmcnt(2)
    v_mfma_f32_16x16x32_bf16 v[68:71], v[112:115], a[88:91], v[68:71]
    s_waitcnt lgkmcnt(0)
    v_mfma_f32_16x16x32_bf16 v[72:75], v[112:115], a[92:95], v[72:75]
    s_barrier
    ds_read_b128 v[108:111], v80 offset:39040
    ds_read_b128 v[112:115], v81 offset:39040
    ds_read_b64_tr_b16 a[0:1], v24 offset:39040
    ds_read_b64_tr_b16 a[2:3], v24 offset:39552
    ds_read_b64_tr_b16 a[4:5], v25 offset:39040
    ds_read_b64_tr_b16 a[6:7], v25 offset:39552
    ds_read_b64_tr_b16 a[8:9], v26 offset:39040
    ds_read_b64_tr_b16 a[10:11], v26 offset:39552
    ds_read_b64_tr_b16 a[12:13], v27 offset:39040
    ds_read_b64_tr_b16 a[14:15], v27 offset:39552
    ds_read_b64_tr_b16 a[16:17], v24 offset:47232
    ds_read_b64_tr_b16 a[18:19], v24 offset:47744
    ds_read_b64_tr_b16 a[20:21], v25 offset:47232
    ds_read_b64_tr_b16 a[22:23], v25 offset:47744
    ds_read_b64_tr_b16 a[24:25], v26 offset:47232
    ds_read_b64_tr_b16 a[26:27], v26 offset:47744
    s_waitcnt lgkmcnt(12)
    v_mfma_f32_16x16x32_bf16 v[28:31], a[0:3], v[108:111], v[28:31]
    ds_read_b64_tr_b16 a[28:29], v27 offset:47232
    ds_read_b64_tr_b16 a[30:31], v27 offset:47744
    s_waitcnt lgkmcnt(12)
    v_mfma_f32_16x16x32_bf16 v[32:35], a[4:7], v[108:111], v[32:35]
    ds_read_b64_tr_b16 a[32:33], v24 offset:55424
    ds_read_b64_tr_b16 a[34:35], v24 offset:55936
    s_waitcnt lgkmcnt(12)
    v_mfma_f32_16x16x32_bf16 v[36:39], a[8:11], v[108:111], v[36:39]
    ds_read_b64_tr_b16 a[36:37], v25 offset:55424
    ds_read_b64_tr_b16 a[38:39], v25 offset:55936
    s_waitcnt lgkmcnt(12)
    v_mfma_f32_16x16x32_bf16 v[40:43], a[12:15], v[108:111], v[40:43]
    ds_read_b64_tr_b16 a[40:41], v26 offset:55424
    ds_read_b64_tr_b16 a[42:43], v26 offset:55936
    s_waitcnt lgkmcnt(12)
    v_mfma_f32_16x16x32_bf16 v[44:47], a[16:19], v[108:111], v[44:47]
    ds_read_b64_tr_b16 a[44:45], v27 offset:55424
    ds_read_b64_tr_b16 a[46:47], v27 offset:55936
    s_waitcnt lgkmcnt(12)
    v_mfma_f32_16x16x32_bf16 v[48:51], a[20:23], v[108:111], v[48:51]
    ds_read_b64_tr_b16 a[48:49], v24 offset:43136
    ds_read_b64_tr_b16 a[50:51], v24 offset:43648
    s_waitcnt lgkmcnt(12)
    v_mfma_f32_16x16x32_bf16 v[52:55], a[24:27], v[108:111], v[52:55]
    ds_read_b64_tr_b16 a[52:53], v25 offset:43136
    ds_read_b64_tr_b16 a[54:55], v25 offset:43648
    s_waitcnt lgkmcnt(12)
    v_mfma_f32_16x16x32_bf16 v[56:59], a[28:31], v[108:111], v[56:59]
    ds_read_b64_tr_b16 a[56:57], v26 offset:43136
    ds_read_b64_tr_b16 a[58:59], v26 offset:43648
    s_waitcnt lgkmcnt(12)
    v_mfma_f32_16x16x32_bf16 v[60:63], v[108:111], a[32:35], v[60:63]
    ds_read_b64_tr_b16 a[60:61], v27 offset:43136
    ds_read_b64_tr_b16 a[62:63], v27 offset:43648
    s_waitcnt lgkmcnt(12)
    v_mfma_f32_16x16x32_bf16 v[64:67], v[108:111], a[36:39], v[64:67]
    ds_read_b64_tr_b16 a[64:65], v24 offset:51328
    ds_read_b64_tr_b16 a[66:67], v24 offset:51840
    s_waitcnt lgkmcnt(12)
    v_mfma_f32_16x16x32_bf16 v[68:71], v[108:111], a[40:43], v[68:71]
    ds_read_b64_tr_b16 a[68:69], v25 offset:51328
    ds_read_b64_tr_b16 a[70:71], v25 offset:51840
    s_waitcnt lgkmcnt(12)
    v_mfma_f32_16x16x32_bf16 v[72:75], v[108:111], a[44:47], v[72:75]
    ds_read_b64_tr_b16 a[72:73], v26 offset:51328
    ds_read_b64_tr_b16 a[74:75], v26 offset:51840
    s_waitcnt lgkmcnt(12)
    v_mfma_f32_16x16x32_bf16 v[28:31], a[48:51], v[112:115], v[28:31]
    ds_read_b64_tr_b16 a[76:77], v27 offset:51328
    ds_read_b64_tr_b16 a[78:79], v27 offset:51840
    s_waitcnt lgkmcnt(12)
    v_mfma_f32_16x16x32_bf16 v[32:35], a[52:55], v[112:115], v[32:35]
    ds_read_b64_tr_b16 a[80:81], v24 offset:59520
    ds_read_b64_tr_b16 a[82:83], v24 offset:60032
    s_waitcnt lgkmcnt(12)
    v_mfma_f32_16x16x32_bf16 v[36:39], a[56:59], v[112:115], v[36:39]
    ds_read_b64_tr_b16 a[84:85], v25 offset:59520
    ds_read_b64_tr_b16 a[86:87], v25 offset:60032
    s_waitcnt lgkmcnt(12)
    v_mfma_f32_16x16x32_bf16 v[40:43], a[60:63], v[112:115], v[40:43]
    ds_read_b64_tr_b16 a[88:89], v26 offset:59520
    ds_read_b64_tr_b16 a[90:91], v26 offset:60032
    s_waitcnt lgkmcnt(12)
    v_mfma_f32_16x16x32_bf16 v[44:47], a[64:67], v[112:115], v[44:47]
    ds_read_b64_tr_b16 a[92:93], v27 offset:59520
    ds_read_b64_tr_b16 a[94:95], v27 offset:60032
    s_waitcnt lgkmcnt(12)
    v_mfma_f32_16x16x32_bf16 v[48:51], a[68:71], v[112:115], v[48:51]
    s_waitcnt lgkmcnt(10)
    v_mfma_f32_16x16x32_bf16 v[52:55], a[72:75], v[112:115], v[52:55]
    s_waitcnt lgkmcnt(8)
    v_mfma_f32_16x16x32_bf16 v[56:59], a[76:79], v[112:115], v[56:59]
    s_waitcnt lgkmcnt(6)
    v_mfma_f32_16x16x32_bf16 v[60:63], v[112:115], a[80:83], v[60:63]
    s_waitcnt lgkmcnt(4)
    v_mfma_f32_16x16x32_bf16 v[64:67], v[112:115], a[84:87], v[64:67]
    s_waitcnt lgkmcnt(2)
    v_mfma_f32_16x16x32_bf16 v[68:71], v[112:115], a[88:91], v[68:71]
    s_waitcnt lgkmcnt(0)
    v_mfma_f32_16x16x32_bf16 v[72:75], v[112:115], a[92:95], v[72:75]
    v_add_u32 v4, 156224, v12
    v_min_u32 v5, 47, v1
    v_lshlrev_b32 v5, 2, v5
    v_add_u32 v5, 156480, v5
    v_lshlrev_b32 v6, 4, v2
    v_add_u32 v6, 157184, v6
    v_mov_b32 v7, 157968
    v_lshlrev_b32 v11, 2, v3
    v_add_u32 v11, 156224, v11
    s_barrier
    ds_read_b128 v[108:111], v76 offset:0
    ds_read_b128 v[112:115], v77 offset:0
    ds_read_b64_tr_b16 a[0:1], v20 offset:0
    ds_read_b64_tr_b16 a[2:3], v20 offset:512
    ds_read_b64_tr_b16 a[4:5], v21 offset:0
    ds_read_b64_tr_b16 a[6:7], v21 offset:512
    ds_read_b64_tr_b16 a[8:9], v22 offset:0
    ds_read_b64_tr_b16 a[10:11], v22 offset:512
    ds_read_b64_tr_b16 a[12:13], v23 offset:0
    ds_read_b64_tr_b16 a[14:15], v23 offset:512
    ds_read_b64_tr_b16 a[16:17], v20 offset:8192
    ds_read_b64_tr_b16 a[18:19], v20 offset:8704
    ds_read_b64_tr_b16 a[20:21], v21 offset:8192
    ds_read_b64_tr_b16 a[22:23], v21 offset:8704
    ds_read_b64_tr_b16 a[24:25], v22 offset:8192
    ds_read_b64_tr_b16 a[26:27], v22 offset:8704
    s_waitcnt lgkmcnt(12)
    v_mfma_f32_16x16x32_bf16 v[28:31], a[0:3], v[108:111], v[28:31]
    ds_read_b64_tr_b16 a[28:29], v23 offset:8192
    ds_read_b64_tr_b16 a[30:31], v23 offset:8704
    s_waitcnt lgkmcnt(12)
    v_mfma_f32_16x16x32_bf16 v[32:35], a[4:7], v[108:111], v[32:35]
    ds_read_b64_tr_b16 a[32:33], v20 offset:16384
    ds_read_b64_tr_b16 a[34:35], v20 offset:16896
    s_waitcnt lgkmcnt(12)
    v_mfma_f32_16x16x32_bf16 v[36:39], a[8:11], v[108:111], v[36:39]
    ds_read_b64_tr_b16 a[36:37], v21 offset:16384
    ds_read_b64_tr_b16 a[38:39], v21 offset:16896
    s_waitcnt lgkmcnt(12)
    v_mfma_f32_16x16x32_bf16 v[40:43], a[12:15], v[108:111], v[40:43]
    ds_read_b64_tr_b16 a[40:41], v22 offset:16384
    ds_read_b64_tr_b16 a[42:43], v22 offset:16896
    s_waitcnt lgkmcnt(12)
    v_mfma_f32_16x16x32_bf16 v[44:47], a[16:19], v[108:111], v[44:47]
    ds_read_b64_tr_b16 a[44:45], v23 offset:16384
    ds_read_b64_tr_b16 a[46:47], v23 offset:16896
    s_waitcnt lgkmcnt(12)
    v_mfma_f32_16x16x32_bf16 v[48:51], a[20:23], v[108:111], v[48:51]
    ds_read_b64_tr_b16 a[48:49], v20 offset:4096
    ds_read_b64_tr_b16 a[50:51], v20 offset:4608
    s_waitcnt lgkmcnt(12)
    v_mfma_f32_16x16x32_bf16 v[52:55], a[24:27], v[108:111], v[52:55]
    ds_read_b64_tr_b16 a[52:53], v21 offset:4096
    ds_read_b64_tr_b16 a[54:55], v21 offset:4608
    s_waitcnt lgkmcnt(12)
    v_mfma_f32_16x16x32_bf16 v[56:59], a[28:31], v[108:111], v[56:59]
    ds_read_b64_tr_b16 a[56:57], v22 offset:4096
    ds_read_b64_tr_b16 a[58:59], v22 offset:4608
    s_waitcnt lgkmcnt(12)
    v_mfma_f32_16x16x32_bf16 v[60:63], v[108:111], a[32:35], v[60:63]
    ds_read_b64_tr_b16 a[60:61], v23 offset:4096
    ds_read_b64_tr_b16 a[62:63], v23 offset:4608
    s_waitcnt lgkmcnt(12)
    v_mfma_f32_16x16x32_bf16 v[64:67], v[108:111], a[36:39], v[64:67]
    ds_read_b64_tr_b16 a[64:65], v20 offset:12288
    ds_read_b64_tr_b16 a[66:67], v20 offset:12800
    s_waitcnt lgkmcnt(12)
    v_mfma_f32_16x16x32_bf16 v[68:71], v[108:111], a[40:43], v[68:71]
    ds_read_b64_tr_b16 a[68:69], v21 offset:12288
    ds_read_b64_tr_b16 a[70:71], v21 offset:12800
    s_waitcnt lgkmcnt(12)
    v_mfma_f32_16x16x32_bf16 v[72:75], v[108:111], a[44:47], v[72:75]
    ds_read_b64_tr_b16 a[72:73], v22 offset:12288
    ds_read_b64_tr_b16 a[74:75], v22 offset:12800
    s_waitcnt lgkmcnt(12)
    v_mfma_f32_16x16x32_bf16 v[28:31], a[48:51], v[112:115], v[28:31]
    ds_read_b64_tr_b16 a[76:77], v23 offset:12288
    ds_read_b64_tr_b16 a[78:79], v23 offset:12800
    s_waitcnt lgkmcnt(12)
    v_mfma_f32_16x16x32_bf16 v[32:35], a[52:55], v[112:115], v[32:35]
    ds_read_b64_tr_b16 a[80:81], v20 offset:20480
    ds_read_b64_tr_b16 a[82:83], v20 offset:20992
    s_waitcnt lgkmcnt(12)
    v_mfma_f32_16x16x32_bf16 v[36:39], a[56:59], v[112:115], v[36:39]
    ds_read_b64_tr_b16 a[84:85], v21 offset:20480
    ds_read_b64_tr_b16 a[86:87], v21 offset:20992
    s_waitcnt lgkmcnt(12)
    v_mfma_f32_16x16x32_bf16 v[40:43], a[60:63], v[112:115], v[40:43]
    ds_read_b64_tr_b16 a[88:89], v22 offset:20480
    ds_read_b64_tr_b16 a[90:91], v22 offset:20992
    s_waitcnt lgkmcnt(12)
    v_mfma_f32_16x16x32_bf16 v[44:47], a[64:67], v[112:115], v[44:47]
    ds_read_b64_tr_b16 a[92:93], v23 offset:20480
    ds_read_b64_tr_b16 a[94:95], v23 offset:20992
    s_waitcnt lgkmcnt(12)
    v_mfma_f32_16x16x32_bf16 v[48:51], a[68:71], v[112:115], v[48:51]
    s_waitcnt lgkmcnt(10)
    v_mfma_f32_16x16x32_bf16 v[52:55], a[72:75], v[112:115], v[52:55]
    s_waitcnt lgkmcnt(8)
    v_mfma_f32_16x16x32_bf16 v[56:59], a[76:79], v[112:115], v[56:59]
    s_waitcnt lgkmcnt(6)
    v_mfma_f32_16x16x32_bf16 v[60:63], v[112:115], a[80:83], v[60:63]
    s_waitcnt lgkmcnt(4)
    v_mfma_f32_16x16x32_bf16 v[64:67], v[112:115], a[84:87], v[64:67]
    s_waitcnt lgkmcnt(2)
    v_mfma_f32_16x16x32_bf16 v[68:71], v[112:115], a[88:91], v[68:71]
    s_waitcnt lgkmcnt(0)
    v_mfma_f32_16x16x32_bf16 v[72:75], v[112:115], a[92:95], v[72:75]
    s_barrier
    ds_read_b128 v[108:111], v76 offset:39040
    ds_read_b128 v[112:115], v77 offset:39040
    ds_read_b64_tr_b16 a[0:1], v20 offset:39040
    ds_read_b64_tr_b16 a[2:3], v20 offset:39552
    ds_read_b64_tr_b16 a[4:5], v21 offset:39040
    ds_read_b64_tr_b16 a[6:7], v21 offset:39552
    ds_read_b64_tr_b16 a[8:9], v22 offset:39040
    ds_read_b64_tr_b16 a[10:11], v22 offset:39552
    ds_read_b64_tr_b16 a[12:13], v23 offset:39040
    ds_read_b64_tr_b16 a[14:15], v23 offset:39552
    ds_read_b64_tr_b16 a[16:17], v20 offset:47232
    ds_read_b64_tr_b16 a[18:19], v20 offset:47744
    ds_read_b64_tr_b16 a[20:21], v21 offset:47232
    ds_read_b64_tr_b16 a[22:23], v21 offset:47744
    ds_read_b64_tr_b16 a[24:25], v22 offset:47232
    ds_read_b64_tr_b16 a[26:27], v22 offset:47744
    s_waitcnt lgkmcnt(12)
    v_mfma_f32_16x16x32_bf16 v[28:31], a[0:3], v[108:111], v[28:31]
    ds_read_b64_tr_b16 a[28:29], v23 offset:47232
    ds_read_b64_tr_b16 a[30:31], v23 offset:47744
    s_waitcnt lgkmcnt(12)
    v_mfma_f32_16x16x32_bf16 v[32:35], a[4:7], v[108:111], v[32:35]
    ds_read_b64_tr_b16 a[32:33], v20 offset:55424
    ds_read_b64_tr_b16 a[34:35], v20 offset:55936
    s_waitcnt lgkmcnt(12)
    v_mfma_f32_16x16x32_bf16 v[36:39], a[8:11], v[108:111], v[36:39]
    ds_read_b64_tr_b16 a[36:37], v21 offset:55424
    ds_read_b64_tr_b16 a[38:39], v21 offset:55936
    s_waitcnt lgkmcnt(12)
    v_mfma_f32_16x16x32_bf16 v[40:43], a[12:15], v[108:111], v[40:43]
    ds_read_b64_tr_b16 a[40:41], v22 offset:55424
    ds_read_b64_tr_b16 a[42:43], v22 offset:55936
    s_waitcnt lgkmcnt(12)
    v_mfma_f32_16x16x32_bf16 v[44:47], a[16:19], v[108:111], v[44:47]
    ds_read_b64_tr_b16 a[44:45], v23 offset:55424
    ds_read_b64_tr_b16 a[46:47], v23 offset:55936
    s_waitcnt lgkmcnt(12)
    v_mfma_f32_16x16x32_bf16 v[48:51], a[20:23], v[108:111], v[48:51]
    ds_read_b64_tr_b16 a[48:49], v20 offset:43136
    ds_read_b64_tr_b16 a[50:51], v20 offset:43648
    s_waitcnt lgkmcnt(12)
    v_mfma_f32_16x16x32_bf16 v[52:55], a[24:27], v[108:111], v[52:55]
    ds_read_b64_tr_b16 a[52:53], v21 offset:43136
    ds_read_b64_tr_b16 a[54:55], v21 offset:43648
    s_waitcnt lgkmcnt(12)
    v_mfma_f32_16x16x32_bf16 v[56:59], a[28:31], v[108:111], v[56:59]
    ds_read_b64_tr_b16 a[56:57], v22 offset:43136
    ds_read_b64_tr_b16 a[58:59], v22 offset:43648
    s_waitcnt lgkmcnt(12)
    v_mfma_f32_16x16x32_bf16 v[60:63], v[108:111], a[32:35], v[60:63]
    ds_read_b64_tr_b16 a[60:61], v23 offset:43136
    ds_read_b64_tr_b16 a[62:63], v23 offset:43648
    s_waitcnt lgkmcnt(12)
    v_mfma_f32_16x16x32_bf16 v[64:67], v[108:111], a[36:39], v[64:67]
    ds_read_b64_tr_b16 a[64:65], v20 offset:51328
    ds_read_b64_tr_b16 a[66:67], v20 offset:51840
    s_waitcnt lgkmcnt(12)
    v_mfma_f32_16x16x32_bf16 v[68:71], v[108:111], a[40:43], v[68:71]
    ds_read_b64_tr_b16 a[68:69], v21 offset:51328
    ds_read_b64_tr_b16 a[70:71], v21 offset:51840
    s_waitcnt lgkmcnt(12)
    v_mfma_f32_16x16x32_bf16 v[72:75], v[108:111], a[44:47], v[72:75]
    ds_read_b64_tr_b16 a[72:73], v22 offset:51328
    ds_read_b64_tr_b16 a[74:75], v22 offset:51840
    s_waitcnt lgkmcnt(12)
    v_mfma_f32_16x16x32_bf16 v[28:31], a[48:51], v[112:115], v[28:31]
    ds_read_b64_tr_b16 a[76:77], v23 offset:51328
    ds_read_b64_tr_b16 a[78:79], v23 offset:51840
    s_waitcnt lgkmcnt(12)
    v_mfma_f32_16x16x32_bf16 v[32:35], a[52:55], v[112:115], v[32:35]
    ds_read_b64_tr_b16 a[80:81], v20 offset:59520
    ds_read_b64_tr_b16 a[82:83], v20 offset:60032
    s_waitcnt lgkmcnt(12)
    v_mfma_f32_16x16x32_bf16 v[36:39], a[56:59], v[112:115], v[36:39]
    ds_read_b64_tr_b16 a[84:85], v21 offset:59520
    ds_read_b64_tr_b16 a[86:87], v21 offset:60032
    s_waitcnt lgkmcnt(12)
    v_mfma_f32_16x16x32_bf16 v[40:43], a[60:63], v[112:115], v[40:43]
    ds_read_b64_tr_b16 a[88:89], v22 offset:59520
    ds_read_b64_tr_b16 a[90:91], v22 offset:60032
    s_waitcnt lgkmcnt(12)
    v_mfma_f32_16x16x32_bf16 v[44:47], a[64:67], v[112:115], v[44:47]
    ds_read_b64_tr_b16 a[92:93], v23 offset:59520
    ds_read_b64_tr_b16 a[94:95], v23 offset:60032
    s_waitcnt lgkmcnt(12)
    v_mfma_f32_16x16x32_bf16 v[48:51], a[68:71], v[112:115], v[48:51]
    s_waitcnt lgkmcnt(10)
    v_mfma_f32_16x16x32_bf16 v[52:55], a[72:75], v[112:115], v[52:55]
    s_waitcnt lgkmcnt(8)
    v_mfma_f32_16x16x32_bf16 v[56:59], a[76:79], v[112:115], v[56:59]
    s_waitcnt lgkmcnt(6)
    v_mfma_f32_16x16x32_bf16 v[60:63], v[112:115], a[80:83], v[60:63]
    s_waitcnt lgkmcnt(4)
    v_mfma_f32_16x16x32_bf16 v[64:67], v[112:115], a[84:87], v[64:67]
    s_waitcnt lgkmcnt(2)
    v_mfma_f32_16x16x32_bf16 v[68:71], v[112:115], a[88:91], v[68:71]
    s_waitcnt lgkmcnt(0)
    v_mfma_f32_16x16x32_bf16 v[72:75], v[112:115], a[92:95], v[72:75]
    s_barrier
    ds_read_b128 a[96:99], v80 offset:0
    ds_read_b128 a[100:103], v81 offset:0
    ds_read_b64_tr_b16 a[0:1], v24 offset:0
    ds_read_b64_tr_b16 a[2:3], v24 offset:512
    ds_read_b64_tr_b16 a[4:5], v25 offset:0
    ds_read_b64_tr_b16 a[6:7], v25 offset:512
    ds_read_b64_tr_b16 a[8:9], v26 offset:0
    ds_read_b64_tr_b16 a[10:11], v26 offset:512
    ds_read_b64_tr_b16 a[12:13], v27 offset:0
    ds_read_b64_tr_b16 a[14:15], v27 offset:512
    ds_read_b64_tr_b16 a[16:17], v24 offset:8192
    ds_read_b64_tr_b16 a[18:19], v24 offset:8704
    ds_read_b64_tr_b16 a[20:21], v25 offset:8192
    ds_read_b64_tr_b16 a[22:23], v25 offset:8704
    ds_read_b64_tr_b16 a[24:25], v26 offset:8192
    ds_read_b64_tr_b16 a[26:27], v26 offset:8704
    s_waitcnt lgkmcnt(12)
    v_mfma_f32_16x16x32_bf16 v[28:31], a[0:3], a[96:99], v[28:31]
    ds_read_b64_tr_b16 a[28:29], v27 offset:8192
    ds_read_b64_tr_b16 a[30:31], v27 offset:8704
    s_waitcnt lgkmcnt(12)
    v_mfma_f32_16x16x32_bf16 v[32:35], a[4:7], a[96:99], v[32:35]
    ds_read_b64_tr_b16 a[48:49], v24 offset:4096
    ds_read_b64_tr_b16 a[50:51], v24 offset:4608
    s_waitcnt lgkmcnt(12)
    v_mfma_f32_16x16x32_bf16 v[36:39], a[8:11], a[96:99], v[36:39]
    ds_read_b64_tr_b16 a[52:53], v25 offset:4096
    ds_read_b64_tr_b16 a[54:55], v25 offset:4608
    s_waitcnt lgkmcnt(12)
    v_mfma_f32_16x16x32_bf16 v[40:43], a[12:15], a[96:99], v[40:43]
    ds_read_b64_tr_b16 a[56:57], v26 offset:4096
    ds_read_b64_tr_b16 a[58:59], v26 offset:4608
    s_waitcnt lgkmcnt(12)
    v_mfma_f32_16x16x32_bf16 v[44:47], a[16:19], a[96:99], v[44:47]
    ds_read_b64_tr_b16 a[60:61], v27 offset:4096
    ds_read_b64_tr_b16 a[62:63], v27 offset:4608
    s_waitcnt lgkmcnt(12)
    v_mfma_f32_16x16x32_bf16 v[48:51], a[20:23], a[96:99], v[48:51]
    ds_read_b64_tr_b16 a[64:65], v24 offset:12288
    ds_read_b64_tr_b16 a[66:67], v24 offset:12800
    s_waitcnt lgkmcnt(12)
    v_mfma_f32_16x16x32_bf16 v[52:55], a[24:27], a[96:99], v[52:55]
    ds_read_b64_tr_b16 a[68:69], v25 offset:12288
    ds_read_b64_tr_b16 a[70:71], v25 offset:12800
    s_waitcnt lgkmcnt(12)
    v_mfma_f32_16x16x32_bf16 v[56:59], a[28:31], a[96:99], v[56:59]
    ds_read_b64_tr_b16 a[72:73], v26 offset:12288
    ds_read_b64_tr_b16 a[74:75], v26 offset:12800
    s_waitcnt lgkmcnt(12)
    v_mfma_f32_16x16x32_bf16 v[28:31], a[48:51], a[100:103], v[28:31]
    ds_read_b64_tr_b16 a[76:77], v27 offset:12288
    ds_read_b64_tr_b16 a[78:79], v27 offset:12800
    s_waitcnt lgkmcnt(12)
    v_mfma_f32_16x16x32_bf16 v[32:35], a[52:55], a[100:103], v[32:35]
    s_waitcnt lgkmcnt(10)
    v_mfma_f32_16x16x32_bf16 v[36:39], a[56:59], a[100:103], v[36:39]
    s_waitcnt lgkmcnt(8)
    v_mfma_f32_16x16x32_bf16 v[40:43], a[60:63], a[100:103], v[40:43]
    s_waitcnt lgkmcnt(6)
    v_mfma_f32_16x16x32_bf16 v[44:47], a[64:67], a[100:103], v[44:47]
    s_waitcnt lgkmcnt(4)
    v_mfma_f32_16x16x32_bf16 v[48:51], a[68:71], a[100:103], v[48:51]
    s_waitcnt lgkmcnt(2)
    v_mfma_f32_16x16x32_bf16 v[52:55], a[72:75], a[100:103], v[52:55]
    s_waitcnt lgkmcnt(0)
    v_mfma_f32_16x16x32_bf16 v[56:59], a[76:79], a[100:103], v[56:59]
    buffer_load_dwordx2 v[92:93], v96, s[28:31], s49 offen sc1
    buffer_load_dwordx2 v[94:95], v97, s[28:31], s49 offen sc1
    s_barrier
    ds_read_b128 a[104:107], v80 offset:39040
    ds_read_b128 a[108:111], v81 offset:39040
    ds_read_b64_tr_b16 a[0:1], v24 offset:39040
    ds_read_b64_tr_b16 a[2:3], v24 offset:39552
    ds_read_b64_tr_b16 a[4:5], v25 offset:39040
    ds_read_b64_tr_b16 a[6:7], v25 offset:39552
    ds_read_b64_tr_b16 a[8:9], v26 offset:39040
    ds_read_b64_tr_b16 a[10:11], v26 offset:39552
    ds_read_b64_tr_b16 a[12:13], v27 offset:39040
    ds_read_b64_tr_b16 a[14:15], v27 offset:39552
    ds_read_b64_tr_b16 a[16:17], v24 offset:47232
    ds_read_b64_tr_b16 a[18:19], v24 offset:47744
    ds_read_b64_tr_b16 a[20:21], v25 offset:47232
    ds_read_b64_tr_b16 a[22:23], v25 offset:47744
    ds_read_b64_tr_b16 a[24:25], v26 offset:47232
    ds_read_b64_tr_b16 a[26:27], v26 offset:47744
    s_waitcnt lgkmcnt(12)
    v_mfma_f32_16x16x32_bf16 v[28:31], a[0:3], a[104:107], v[28:31]
    ds_read_b64_tr_b16 a[28:29], v27 offset:47232
    ds_read_b64_tr_b16 a[30:31], v27 offset:47744
    s_waitcnt lgkmcnt(12)
    v_mfma_f32_16x16x32_bf16 v[32:35], a[4:7], a[104:107], v[32:35]
    ds_read_b64_tr_b16 a[48:49], v24 offset:43136
    ds_read_b64_tr_b16 a[50:51], v24 offset:43648
    s_waitcnt lgkmcnt(12)
    v_mfma_f32_16x16x32_bf16 v[36:39], a[8:11], a[104:107], v[36:39]
    ds_read_b64_tr_b16 a[52:53], v25 offset:43136
    ds_read_b64_tr_b16 a[54:55], v25 offset:43648
    s_waitcnt lgkmcnt(12)
    v_mfma_f32_16x16x32_bf16 v[40:43], a[12:15], a[104:107], v[40:43]
    ds_read_b64_tr_b16 a[56:57], v26 offset:43136
    ds_read_b64_tr_b16 a[58:59], v26 offset:43648
    s_waitcnt lgkmcnt(12)
    v_mfma_f32_16x16x32_bf16 v[44:47], a[16:19], a[104:107], v[44:47]
    ds_read_b64_tr_b16 a[60:61], v27 offset:43136
    ds_read_b64_tr_b16 a[62:63], v27 offset:43648
    s_waitcnt lgkmcnt(12)
    v_mfma_f32_16x16x32_bf16 v[48:51], a[20:23], a[104:107], v[48:51]
    ds_read_b64_tr_b16 a[64:65], v24 offset:51328
    ds_read_b64_tr_b16 a[66:67], v24 offset:51840
    s_waitcnt lgkmcnt(12)
    v_mfma_f32_16x16x32_bf16 v[52:55], a[24:27], a[104:107], v[52:55]
    ds_read_b64_tr_b16 a[68:69], v25 offset:51328
    ds_read_b64_tr_b16 a[70:71], v25 offset:51840
    s_waitcnt lgkmcnt(12)
    v_mfma_f32_16x16x32_bf16 v[56:59], a[28:31], a[104:107], v[56:59]
    ds_read_b64_tr_b16 a[72:73], v26 offset:51328
    ds_read_b64_tr_b16 a[74:75], v26 offset:51840
    s_waitcnt lgkmcnt(12)
    v_mfma_f32_16x16x32_bf16 v[28:31], a[48:51], a[108:111], v[28:31]
    ds_read_b64_tr_b16 a[76:77], v27 offset:51328
    ds_read_b64_tr_b16 a[78:79], v27 offset:51840
    s_waitcnt lgkmcnt(12)
    v_mfma_f32_16x16x32_bf16 v[32:35], a[52:55], a[108:111], v[32:35]
    s_waitcnt lgkmcnt(10)
    v_mfma_f32_16x16x32_bf16 v[36:39], a[56:59], a[108:111], v[36:39]
    s_waitcnt lgkmcnt(8)
    v_mfma_f32_16x16x32_bf16 v[40:43], a[60:63], a[108:111], v[40:43]
    s_waitcnt lgkmcnt(6)
    v_mfma_f32_16x16x32_bf16 v[44:47], a[64:67], a[108:111], v[44:47]
    s_waitcnt lgkmcnt(4)
    v_mfma_f32_16x16x32_bf16 v[48:51], a[68:71], a[108:111], v[48:51]
    s_waitcnt lgkmcnt(2)
    v_mfma_f32_16x16x32_bf16 v[52:55], a[72:75], a[108:111], v[52:55]
    s_waitcnt lgkmcnt(0)
    v_mfma_f32_16x16x32_bf16 v[56:59], a[76:79], a[108:111], v[56:59]
    s_barrier
    ds_read_b128 a[112:115], v76 offset:0
    ds_read_b128 a[116:119], v77 offset:0
    ds_read_b64_tr_b16 a[0:1], v20 offset:0
    ds_read_b64_tr_b16 a[2:3], v20 offset:512
    ds_read_b64_tr_b16 a[4:5], v21 offset:0
    ds_read_b64_tr_b16 a[6:7], v21 offset:512
    ds_read_b64_tr_b16 a[8:9], v22 offset:0
    ds_read_b64_tr_b16 a[10:11], v22 offset:512
    ds_read_b64_tr_b16 a[12:13], v23 offset:0
    ds_read_b64_tr_b16 a[14:15], v23 offset:512
    ds_read_b64_tr_b16 a[16:17], v20 offset:8192
    ds_read_b64_tr_b16 a[18:19], v20 offset:8704
    ds_read_b64_tr_b16 a[20:21], v21 offset:8192
    ds_read_b64_tr_b16 a[22:23], v21 offset:8704
    ds_read_b64_tr_b16 a[24:25], v22 offset:8192
    ds_read_b64_tr_b16 a[26:27], v22 offset:8704
    s_waitcnt lgkmcnt(12)
    v_mfma_f32_16x16x32_bf16 v[28:31], a[0:3], a[112:115], v[28:31]
    ds_read_b64_tr_b16 a[28:29], v23 offset:8192
    ds_read_b64_tr_b16 a[30:31], v23 offset:8704
    s_waitcnt lgkmcnt(12)
    v_mfma_f32_16x16x32_bf16 v[32:35], a[4:7], a[112:115], v[32:35]
    ds_read_b64_tr_b16 a[48:49], v20 offset:4096
    ds_read_b64_tr_b16 a[50:51], v20 offset:4608
    s_waitcnt lgkmcnt(12)
    v_mfma_f32_16x16x32_bf16 v[36:39], a[8:11], a[112:115], v[36:39]
    ds_read_b64_tr_b16 a[52:53], v21 offset:4096
    ds_read_b64_tr_b16 a[54:55], v21 offset:4608
    s_waitcnt lgkmcnt(12)
    v_mfma_f32_16x16x32_bf16 v[40:43], a[12:15], a[112:115], v[40:43]
    ds_read_b64_tr_b16 a[56:57], v22 offset:4096
    ds_read_b64_tr_b16 a[58:59], v22 offset:4608
    s_waitcnt lgkmcnt(12)
    v_mfma_f32_16x16x32_bf16 v[44:47], a[16:19], a[112:115], v[44:47]
    ds_read_b64_tr_b16 a[60:61], v23 offset:4096
    ds_read_b64_tr_b16 a[62:63], v23 offset:4608
    s_waitcnt lgkmcnt(12)
    v_mfma_f32_16x16x32_bf16 v[48:51], a[20:23], a[112:115], v[48:51]
    ds_read_b64_tr_b16 a[64:65], v20 offset:12288
    ds_read_b64_tr_b16 a[66:67], v20 offset:12800
    s_waitcnt lgkmcnt(12)
    v_mfma_f32_16x16x32_bf16 v[52:55], a[24:27], a[112:115], v[52:55]
    ds_read_b64_tr_b16 a[68:69], v21 offset:12288
    ds_read_b64_tr_b16 a[70:71], v21 offset:12800
    s_waitcnt lgkmcnt(12)
    v_mfma_f32_16x16x32_bf16 v[56:59], a[28:31], a[112:115], v[56:59]
    ds_read_b64_tr_b16 a[72:73], v22 offset:12288
    ds_read_b64_tr_b16 a[74:75], v22 offset:12800
    s_waitcnt lgkmcnt(12)
    v_mfma_f32_16x16x32_bf16 v[28:31], a[48:51], a[116:119], v[28:31]
    ds_read_b64_tr_b16 a[76:77], v23 offset:12288
    ds_read_b64_tr_b16 a[78:79], v23 offset:12800
    s_waitcnt lgkmcnt(12)
    v_mfma_f32_16x16x32_bf16 v[32:35], a[52:55], a[116:119], v[32:35]
    s_waitcnt lgkmcnt(10)
    v_mfma_f32_16x16x32_bf16 v[36:39], a[56:59], a[116:119], v[36:39]
    s_waitcnt vmcnt(0)
Lst_chk:
    v_cmp_ne_u32 vcc, s34, v93
    v_cmp_ne_u32 s[36:37], s34, v95
    s_nop 0
    s_or_b64 s[36:37], s[36:37], vcc
    s_cbranch_scc1 Lst_re
    v_lshlrev_b32 v93, 16, v92
    s_waitcnt lgkmcnt(8)
    v_mfma_f32_16x16x32_bf16 v[40:43], a[60:63], a[116:119], v[40:43]
    v_and_b32 v92, 0xffff0000, v92
    v_rcp_f32 v93, v93
    s_waitcnt lgkmcnt(6)
    v_mfma_f32_16x16x32_bf16 v[44:47], a[64:67], a[116:119], v[44:47]
    v_lshlrev_b32 v95, 16, v94
    v_and_b32 v94, 0xffff0000, v94
    s_waitcnt lgkmcnt(4)
    v_mfma_f32_16x16x32_bf16 v[48:51], a[68:71], a[116:119], v[48:51]
    v_rcp_f32 v95, v95
    ds_write2st64_b32 v4, v92, v93 offset0:0 offset1:2
    s_waitcnt lgkmcnt(3)
    v_mfma_f32_16x16x32_bf16 v[52:55], a[72:75], a[116:119], v[52:55]
    ds_write2st64_b32 v5, v94, v95 offset0:0 offset1:2
    ds_read_b32 v120, v11
    s_waitcnt lgkmcnt(3)
    v_mfma_f32_16x16x32_bf16 v[56:59], a[76:79], a[116:119], v[56:59]
    s_waitcnt lgkmcnt(0)
    s_barrier
    ds_read_b128 a[120:123], v76 offset:39040
    ds_read_b128 a[124:127], v77 offset:39040
    ds_read_b64_tr_b16 a[0:1], v20 offset:39040
    ds_read_b64_tr_b16 a[2:3], v20 offset:39552
    ds_read_b64_tr_b16 a[4:5], v21 offset:39040
    ds_read_b64_tr_b16 a[6:7], v21 offset:39552
    ds_read_b64_tr_b16 a[8:9], v22 offset:39040
    ds_read_b64_tr_b16 a[10:11], v22 offset:39552
    ds_read_b64_tr_b16 a[12:13], v23 offset:39040
    ds_read_b64_tr_b16 a[14:15], v23 offset:39552
    ds_read_b64_tr_b16 a[16:17], v20 offset:47232
    ds_read_b64_tr_b16 a[18:19], v20 offset:47744
    ds_read_b64_tr_b16 a[20:21], v21 offset:47232
    ds_read_b64_tr_b16 a[22:23], v21 offset:47744
    ds_read_b64_tr_b16 a[24:25], v22 offset:47232
    ds_read_b64_tr_b16 a[26:27], v22 offset:47744
    s_waitcnt lgkmcnt(12)
    v_mfma_f32_16x16x32_bf16 v[28:31], a[0:3], a[120:123], v[28:31]
    ds_read_b64_tr_b16 a[28:29], v23 offset:47232
    ds_read_b64_tr_b16 a[30:31], v23 offset:47744
    s_waitcnt lgkmcnt(12)
    v_mfma_f32_16x16x32_bf16 v[32:35], a[4:7], a[120:123], v[32:35]
    ds_read_b64_tr_b16 a[48:49], v20 offset:43136
    ds_read_b64_tr_b16 a[50:51], v20 offset:43648
    s_waitcnt lgkmcnt(12)
    v_mfma_f32_16x16x32_bf16 v[36:39], a[8:11], a[120:123], v[36:39]
    ds_read_b64_tr_b16 a[52:53], v21 offset:43136
    ds_read_b64_tr_b16 a[54:55], v21 offset:43648
    s_waitcnt lgkmcnt(12)
    v_mfma_f32_16x16x32_bf16 v[40:43], a[12:15], a[120:123], v[40:43]
    ds_read_b64_tr_b16 a[56:57], v22 offset:43136
    ds_read_b64_tr_b16 a[58:59], v22 offset:43648
    s_waitcnt lgkmcnt(12)
    v_mfma_f32_16x16x32_bf16 v[44:47], a[16:19], a[120:123], v[44:47]
    ds_read_b64_tr_b16 a[60:61], v23 offset:43136
    ds_read_b64_tr_b16 a[62:63], v23 offset:43648
    s_waitcnt lgkmcnt(12)
    v_mfma_f32_16x16x32_bf16 v[48:51], a[20:23], a[120:123], v[48:51]
    ds_read_b64_tr_b16 a[64:65], v20 offset:51328
    ds_read_b64_tr_b16 a[66:67], v20 offset:51840
    s_waitcnt lgkmcnt(12)
    v_mfma_f32_16x16x32_bf16 v[52:55], a[24:27], a[120:123], v[52:55]
    ds_read_b64_tr_b16 a[68:69], v21 offset:51328
    ds_read_b64_tr_b16 a[70:71], v21 offset:51840
    s_waitcnt lgkmcnt(12)
    v_mfma_f32_16x16x32_bf16 v[56:59], a[28:31], a[120:123], v[56:59]
    ds_read_b64_tr_b16 a[72:73], v22 offset:51328
    ds_read_b64_tr_b16 a[74:75], v22 offset:51840
    s_waitcnt lgkmcnt(12)
    v_mfma_f32_16x16x32_bf16 v[28:31], a[48:51], a[124:127], v[28:31]
    ds_read_b64_tr_b16 a[76:77], v23 offset:51328
    ds_read_b64_tr_b16 a[78:79], v23 offset:51840
    s_waitcnt lgkmcnt(12)
    v_mfma_f32_16x16x32_bf16 v[32:35], a[52:55], a[124:127], v[32:35]
    s_waitcnt lgkmcnt(10)
    v_mfma_f32_16x16x32_bf16 v[36:39], a[56:59], a[124:127], v[36:39]
    s_waitcnt lgkmcnt(8)
    v_mfma_f32_16x16x32_bf16 v[40:43], a[60:63], a[124:127], v[40:43]
    s_waitcnt lgkmcnt(6)
    v_mfma_f32_16x16x32_bf16 v[44:47], a[64:67], a[124:127], v[44:47]
    s_waitcnt lgkmcnt(4)
    v_mfma_f32_16x16x32_bf16 v[48:51], a[68:71], a[124:127], v[48:51]
    s_waitcnt lgkmcnt(2)
    v_mfma_f32_16x16x32_bf16 v[52:55], a[72:75], a[124:127], v[52:55]
    s_waitcnt lgkmcnt(0)
    v_mfma_f32_16x16x32_bf16 v[56:59], a[76:79], a[124:127], v[56:59]
    s_mov_b32 exec_lo, 0x00010001
    s_mov_b32 exec_hi, 0x00010001
    ds_write_b128 v6, v[28:31] offset:0
    ds_write_b128 v6, v[32:35] offset:64
    ds_write_b128 v6, v[36:39] offset:128
    ds_write_b128 v6, v[40:43] offset:192
    ds_write_b128 v6, v[44:47] offset:256
    ds_write_b128 v6, v[48:51] offset:320
    ds_write_b128 v6, v[52:55] offset:384
    ds_write_b128 v6, v[56:59] offset:448
    ds_write_b32 v7, v7
    s_mov_b64 exec, -1
    ds_read_b128 v[76:79], v6 offset:256
    ds_read_b128 v[80:83], v6 offset:320
    ds_read_b128 v[84:87], v6 offset:384
    ds_read_b128 v[88:91], v6 offset:448
    s_waitcnt lgkmcnt(0)
    v_fmac_f32 v44, v76, v120
    v_fmac_f32 v45, v77, v120
    v_fmac_f32 v46, v78, v120
    v_fmac_f32 v47, v79, v120
    v_cvt_pk_bf16_f32 v44, v44, v45
    v_cvt_pk_bf16_f32 v45, v46, v47
    v_fmac_f32 v48, v80, v120
    v_fmac_f32 v49, v81, v120
    v_fmac_f32 v50, v82, v120
    v_fmac_f32 v51, v83, v120
    v_cvt_pk_bf16_f32 v46, v48, v49
    v_cvt_pk_bf16_f32 v47, v50, v51
    v_fmac_f32 v52, v84, v120
    v_fmac_f32 v53, v85, v120
    v_fmac_f32 v54, v86, v120
    v_fmac_f32 v55, v87, v120
    v_cvt_pk_bf16_f32 v48, v52, v53
    v_cvt_pk_bf16_f32 v49, v54, v55
    v_fmac_f32 v56, v88, v120
    v_fmac_f32 v57, v89, v120
    v_fmac_f32 v58, v90, v120
    v_fmac_f32 v59, v91, v120
    v_cvt_pk_bf16_f32 v50, v56, v57
    v_cvt_pk_bf16_f32 v51, v58, v59
    ds_write_b128 v125, v[44:47] offset:4096
    ds_write_b128 v125, v[48:51] offset:5120
    v_mov_b32 v5, 157972
    v_mov_b32 v6, 1
    s_mov_b64 exec, 1
    ds_add_u32 v5, v6
    s_mov_b64 exec, -1
    v_mov_b32 v5, 157980
Lcw_5:
    s_sub_u32 s35, s35, 1
    s_cbranch_scc1 Lend
    ds_read_b32 v6, v5
    s_waitcnt lgkmcnt(0)
    v_readfirstlane_b32 s38, v6
    s_nop 0
    s_cmp_lt_u32 s38, 1
    s_cbranch_scc1 Lcw_5
    ds_read_b64_tr_b16 a[0:1], v24 offset:16384
    ds_read_b64_tr_b16 a[2:3], v24 offset:16896
    ds_read_b64_tr_b16 a[4:5], v25 offset:16384
    ds_read_b64_tr_b16 a[6:7], v25 offset:16896
    ds_read_b64_tr_b16 a[8:9], v26 offset:16384
    ds_read_b64_tr_b16 a[10:11], v26 offset:16896
    ds_read_b64_tr_b16 a[12:13], v27 offset:16384
    ds_read_b64_tr_b16 a[14:15], v27 offset:16896
    ds_read_b64_tr_b16 a[16:17], v24 offset:20480
    ds_read_b64_tr_b16 a[18:19], v24 offset:20992
    ds_read_b64_tr_b16 a[20:21], v25 offset:20480
    ds_read_b64_tr_b16 a[22:23], v25 offset:20992
    ds_read_b64_tr_b16 a[24:25], v26 offset:20480
    ds_read_b64_tr_b16 a[26:27], v26 offset:20992
    ds_read_b64_tr_b16 a[28:29], v27 offset:20480
    ds_read_b64_tr_b16 a[30:31], v27 offset:20992
    ds_read_b64_tr_b16 a[32:33], v24 offset:55424
    ds_read_b64_tr_b16 a[34:35], v24 offset:55936
    ds_read_b64_tr_b16 a[36:37], v25 offset:55424
    ds_read_b64_tr_b16 a[38:39], v25 offset:55936
    ds_read_b64_tr_b16 a[40:41], v26 offset:55424
    ds_read_b64_tr_b16 a[42:43], v26 offset:55936
    ds_read_b64_tr_b16 a[44:45], v27 offset:55424
    ds_read_b64_tr_b16 a[46:47], v27 offset:55936
    ds_read_b64_tr_b16 a[48:49], v24 offset:59520
    ds_read_b64_tr_b16 a[50:51], v24 offset:60032
    ds_read_b64_tr_b16 a[52:53], v25 offset:59520
    ds_read_b64_tr_b16 a[54:55], v25 offset:60032
    ds_read_b64_tr_b16 a[56:57], v26 offset:59520
    ds_read_b64_tr_b16 a[58:59], v26 offset:60032
    ds_read_b64_tr_b16 a[60:61], v27 offset:59520
    ds_read_b64_tr_b16 a[62:63], v27 offset:60032
    ds_read_b64_tr_b16 a[64:65], v20 offset:16384
    ds_read_b64_tr_b16 a[66:67], v20 offset:16896
    ds_read_b64_tr_b16 a[68:69], v21 offset:16384
    ds_read_b64_tr_b16 a[70:71], v21 offset:16896
    ds_read_b64_tr_b16 a[72:73], v22 offset:16384
    ds_read_b64_tr_b16 a[74:75], v22 offset:16896
    ds_read_b64_tr_b16 a[76:77], v23 offset:16384
    ds_read_b64_tr_b16 a[78:79], v23 offset:16896
    ds_read_b64_tr_b16 a[80:81], v20 offset:20480
    ds_read_b64_tr_b16 a[82:83], v20 offset:20992
    ds_read_b64_tr_b16 a[84:85], v21 offset:20480
    ds_read_b64_tr_b16 a[86:87], v21 offset:20992
    ds_read_b64_tr_b16 a[88:89], v22 offset:20480
    ds_read_b64_tr_b16 a[90:91], v22 offset:20992
    ds_read_b64_tr_b16 a[92:93], v23 offset:20480
    ds_read_b64_tr_b16 a[94:95], v23 offset:20992
    s_waitcnt lgkmcnt(15)
    v_mfma_f32_16x16x32_bf16 v[60:63], a[96:99], a[0:3], v[60:63]
    v_mfma_f32_16x16x32_bf16 v[64:67], a[96:99], a[4:7], v[64:67]
    v_mfma_f32_16x16x32_bf16 v[68:71], a[96:99], a[8:11], v[68:71]
    v_mfma_f32_16x16x32_bf16 v[72:75], a[96:99], a[12:15], v[72:75]
    ds_read_b64_tr_b16 a[0:1], v20 offset:55424
    ds_read_b64_tr_b16 a[2:3], v20 offset:55936
    ds_read_b64_tr_b16 a[4:5], v21 offset:55424
    ds_read_b64_tr_b16 a[6:7], v21 offset:55936
    ds_read_b64_tr_b16 a[8:9], v22 offset:55424
    ds_read_b64_tr_b16 a[10:11], v22 offset:55936
    ds_read_b64_tr_b16 a[12:13], v23 offset:55424
    ds_read_b64_tr_b16 a[14:15], v23 offset:55936
    v_mfma_f32_16x16x32_bf16 v[60:63], a[100:103], a[16:19], v[60:63]
    v_mfma_f32_16x16x32_bf16 v[64:67], a[100:103], a[20:23], v[64:67]
    v_mfma_f32_16x16x32_bf16 v[68:71], a[100:103], a[24:27], v[68:71]
    v_mfma_f32_16x16x32_bf16 v[72:75], a[100:103], a[28:31], v[72:75]
    ds_read_b64_tr_b16 a[16:17], v20 offset:59520
    ds_read_b64_tr_b16 a[18:19], v20 offset:60032
    ds_read_b64_tr_b16 a[20:21], v21 offset:59520
    ds_read_b64_tr_b16 a[22:23], v21 offset:60032
    ds_read_b64_tr_b16 a[24:25], v22 offset:59520
    ds_read_b64_tr_b16 a[26:27], v22 offset:60032
    ds_read_b64_tr_b16 a[28:29], v23 offset:59520
    ds_read_b64_tr_b16 a[30:31], v23 offset:60032
    v_mfma_f32_16x16x32_bf16 v[60:63], a[104:107], a[32:35], v[60:63]
    v_mfma_f32_16x16x32_bf16 v[64:67], a[104:107], a[36:39], v[64:67]
    v_mfma_f32_16x16x32_bf16 v[68:71], a[104:107], a[40:43], v[68:71]
    v_mfma_f32_16x16x32_bf16 v[72:75], a[104:107], a[44:47], v[72:75]
    v_mfma_f32_16x16x32_bf16 v[60:63], a[108:111], a[48:51], v[60:63]
    v_mfma_f32_16x16x32_bf16 v[64:67], a[108:111], a[52:55], v[64:67]
    v_mfma_f32_16x16x32_bf16 v[68:71], a[108:111], a[56:59], v[68:71]
    v_mfma_f32_16x16x32_bf16 v[72:75], a[108:111], a[60:63], v[72:75]
    s_waitcnt lgkmcnt(15)
    v_mfma_f32_16x16x32_bf16 v[60:63], a[112:115], a[64:67], v[60:63]
    v_mfma_f32_16x16x32_bf16 v[64:67], a[112:115], a[68:71], v[64:67]
    v_mfma_f32_16x16x32_bf16 v[68:71], a[112:115], a[72:75], v[68:71]
    v_mfma_f32_16x16x32_bf16 v[72:75], a[112:115], a[76:79], v[72:75]
    v_mfma_f32_16x16x32_bf16 v[60:63], a[116:119], a[80:83], v[60:63]
    v_mfma_f32_16x16x32_bf16 v[64:67], a[116:119], a[84:87], v[64:67]
    v_mfma_f32_16x16x32_bf16 v[68:71], a[116:119], a[88:91], v[68:71]
    v_mfma_f32_16x16x32_bf16 v[72:75], a[116:119], a[92:95], v[72:75]
    s_waitcnt lgkmcnt(8)
    v_mfma_f32_16x16x32_bf16 v[60:63], a[120:123], a[0:3], v[60:63]
    v_mfma_f32_16x16x32_bf16 v[64:67], a[120:123], a[4:7], v[64:67]
    v_mfma_f32_16x16x32_bf16 v[68:71], a[120:123], a[8:11], v[68:71]
    v_mfma_f32_16x16x32_bf16 v[72:75], a[120:123], a[12:15], v[72:75]
    s_waitcnt lgkmcnt(0)
    v_mfma_f32_16x16x32_bf16 v[60:63], a[124:127], a[16:19], v[60:63]
    v_mfma_f32_16x16x32_bf16 v[64:67], a[124:127], a[20:23], v[64:67]
    v_mfma_f32_16x16x32_bf16 v[68:71], a[124:127], a[24:27], v[68:71]
    v_mfma_f32_16x16x32_bf16 v[72:75], a[124:127], a[28:31], v[72:75]
    v_lshlrev_b32 v5, 4, v3
    v_add_u32 v5, 157696, v5
    v_mov_b32 v6, 157952
    v_lshlrev_b32 v4, 4, v2
    v_add_u32 v4, 156224, v4
    v_lshl_add_u32 v125, v1, 3, s48
    s_mov_b64 exec, 0xffff
    ds_write_b32 v5, v60 offset:0
    ds_write_b32 v5, v64 offset:4
    ds_write_b32 v5, v68 offset:8
    ds_write_b32 v5, v72 offset:12
    ds_write_b32 v6, v6
    s_mov_b64 exec, -1
    ds_read_b128 v[36:39], v5
    ds_read_b128 v[28:31], v4
    ds_read_b128 v[32:35], v4 offset:512
    s_waitcnt lgkmcnt(0)
    v_fmac_f32 v60, v28, v36
    v_fmac_f32 v61, v29, v36
    v_fmac_f32 v62, v30, v36
    v_fmac_f32 v63, v31, v36
    v_mul_f32 v60, v60, v32
    v_mul_f32 v61, v61, v33
    v_mul_f32 v62, v62, v34
    v_mul_f32 v63, v63, v35
    v_cvt_pk_bf16_f32 v60, v60, v61
    v_cvt_pk_bf16_f32 v61, v62, v63
    ds_write_b64 v125, v[60:61] offset:0
    v_fmac_f32 v64, v28, v37
    v_fmac_f32 v65, v29, v37
    v_fmac_f32 v66, v30, v37
    v_fmac_f32 v67, v31, v37
    v_mul_f32 v64, v64, v32
    v_mul_f32 v65, v65, v33
    v_mul_f32 v66, v66, v34
    v_mul_f32 v67, v67, v35
    v_cvt_pk_bf16_f32 v64, v64, v65
    v_cvt_pk_bf16_f32 v65, v66, v67
    ds_write_b64 v125, v[64:65] offset:512
    v_fmac_f32 v68, v28, v38
    v_fmac_f32 v69, v29, v38
    v_fmac_f32 v70, v30, v38
    v_fmac_f32 v71, v31, v38
    v_mul_f32 v68, v68, v32
    v_mul_f32 v69, v69, v33
    v_mul_f32 v70, v70, v34
    v_mul_f32 v71, v71, v35
    v_cvt_pk_bf16_f32 v68, v68, v69
    v_cvt_pk_bf16_f32 v69, v70, v71
    ds_write_b64 v125, v[68:69] offset:1024
    v_fmac_f32 v72, v28, v39
    v_fmac_f32 v73, v29, v39
    v_fmac_f32 v74, v30, v39
    v_fmac_f32 v75, v31, v39
    v_mul_f32 v72, v72, v32
    v_mul_f32 v73, v73, v33
    v_mul_f32 v74, v74, v34
    v_mul_f32 v75, v75, v35
    v_cvt_pk_bf16_f32 v72, v72, v73
    v_cvt_pk_bf16_f32 v73, v74, v75
    ds_write_b64 v125, v[72:73] offset:1536
    v_mov_b32 v8, 157976
    v_mov_b32 v9, 1
    s_mov_b64 exec, 1
    ds_add_u32 v8, v9
    s_mov_b64 exec, -1
    s_endpgm
Lst_re:
    s_sub_u32 s35, s35, 1
    s_cbranch_scc1 Lend
    buffer_load_dwordx2 v[92:93], v96, s[28:31], s49 offen sc1
    buffer_load_dwordx2 v[94:95], v97, s[28:31], s49 offen sc1
    s_waitcnt vmcnt(0)
    s_branch Lst_chk
Laux:
    s_lshl_b32 s32, s37, 3
    s_lshl_b32 s39, s38, 2
    s_add_u32 s32, s32, s36
    s_cmp_lt_u32 s37, 4
    s_cselect_b32 s39, s39, 0
    s_add_u32 s32, s32, s39
    s_and_b32 s33, s2, 3
    s_lshl_b32 s33, s33, 3
    s_and_b32 s39, s2, 4
    s_add_u32 s33, s33, s39
    s_add_u32 s33, s33, s37
    s_cmp_ge_u32 s32, 32
    s_cbranch_scc1 Lmst
    v_lshrrev_b32 v5, 3, v1
    v_and_b32 v6, 7, v1
    s_lshl_b32 s40, s3, 14
    s_cmp_eq_u32 s27, 0
    s_cbranch_scc0 Laux_u
    s_lshl_b32 s36, s33, 6
    s_lshl_b32 s37, s26, 4
    s_add_u32 s36, s36, s37
    v_add_u32 v7, s36, v5
    v_mul_u32_u24 v7, 1280, v7
    v_xor_b32 v8, v6, v2
    v_lshl_add_u32 v92, v8, 4, v7
    v_add_u32 v92, 4096, v92
    v_xor_b32 v93, 64, v92
    v_add_u32 v93, 9216, v93
    v_subrev_u32 v94, 1920, v92
    v_subrev_u32 v95, 1920, v93
    s_waitcnt lgkmcnt(0)
    s_sub_u32 s52, s4, 4096
    s_subb_u32 s53, s5, 0
    s_mov_b32 s54, 2625536
    s_mov_b32 s55, 0x20000
    s_mov_b64 s[60:61], s[12:13]
    s_mov_b32 s62, 1280
    s_mov_b32 s63, 0x20000
    s_mov_b32 m0, 131072
    s_nop 0
    buffer_load_dwordx4 v13, s[60:63], 0 offen lds
    s_mov_b64 exec, 0xffff
    buffer_load_dwordx4 v13, s[60:63], 0 offen offset:1024 lds
    s_mov_b64 exec, -1
    s_add_u32 m0, s40, 0
    s_mov_b32 s41, 0
    buffer_load_dwordx4 v92, s[52:55], s41 offen lds
    buffer_load_dwordx4 v93, s[52:55], s41 offen offset:1024 lds
    buffer_load_dwordx4 v94, s[52:55], s41 offen offset:2048 lds
    buffer_load_dwordx4 v95, s[52:55], s41 offen offset:3072 lds
    s_add_u32 m0, s40, 4096
    s_mov_b32 s41, 256
    buffer_load_dwordx4 v92, s[52:55], s41 offen lds
    buffer_load_dwordx4 v93, s[52:55], s41 offen offset:1024 lds
    buffer_load_dwordx4 v94, s[52:55], s41 offen offset:2048 lds
    buffer_load_dwordx4 v95, s[52:55], s41 offen offset:3072 lds
    s_add_u32 m0, s40, 8192
    s_mov_b32 s41, 512
    buffer_load_dwordx4 v92, s[52:55], s41 offen lds
    buffer_load_dwordx4 v93, s[52:55], s41 offen offset:1024 lds
    buffer_load_dwordx4 v94, s[52:55], s41 offen offset:2048 lds
    buffer_load_dwordx4 v95, s[52:55], s41 offen offset:3072 lds
    s_add_u32 m0, s40, 12288
    s_mov_b32 s41, 768
    buffer_load_dwordx4 v92, s[52:55], s41 offen lds
    buffer_load_dwordx4 v93, s[52:55], s41 offen offset:1024 lds
    buffer_load_dwordx4 v94, s[52:55], s41 offen offset:2048 lds
    buffer_load_dwordx4 v95, s[52:55], s41 offen offset:3072 lds
    s_mov_b64 s[28:29], s[24:25]
    s_mov_b32 s30, 268435456
    s_mov_b32 s31, 0x20000
    s_load_dword s34, s[28:29], 0
    s_mov_b64 s[44:45], s[14:15]
    s_mov_b32 s46, 2211840
    s_mov_b32 s47, 0x20000
    s_mov_b64 s[48:49], s[18:19]
    s_mov_b32 s50, 2211840
    s_mov_b32 s51, 0x20000
    v_and_b32 v8, 1, v2
    v_lshlrev_b32 v8, 1, v8
    v_xor_b32 v8, v8, v6
    v_lshlrev_b32 v8, 4, v8
    v_mul_u32_u24 v9, 3456, v5
    s_lshl_b32 s38, s32, 7
    v_add3_u32 v18, v9, v8, s38
    v_xor_b32 v19, 64, v18
    v_add_u32 v19, 26624, v19
    v_add_u32 v20, 53248, v18
    v_add_u32 v21, 53248, v19
    s_mul_i32 s42, s26, 110592
    v_mul_u32_u24 v9, 1280, v5
    v_add_u32 v22, v9, v8
    v_xor_b32 v23, 64, v22
    v_add_u32 v23, 9216, v23
    v_add_u32 v24, 18432, v22
    v_add_u32 v25, 18432, v23
    s_mul_i32 s43, s32, 81920
    s_lshl_b32 s38, s3, 7
    s_add_u32 s43, s43, s38
    v_mov_b32 v96, 0x3f803f80
    v_mov_b32 v97, 0x3f803f80
    v_mov_b32 v98, 0x3f803f80
    v_mov_b32 v99, 0x3f803f80
    v_lshlrev_b32 v100, 4, v2
    v_add_u32 v100, 131072, v100
    v_lshrrev_b32 v10, 1, v3
    v_xor_b32 v10, v10, v2
    v_lshlrev_b32 v10, 4, v10
    v_lshl_add_u32 v10, v3, 7, v10
    v_add_u32 v102, s40, v10
    v_xor_b32 v103, 64, v102
    s_mov_b32 s58, 0xaaaaaaaa
    s_mov_b32 s59, 0xaaaaaaaa
    s_mov_b32 s64, 0xcccccccc
    s_mov_b32 s65, 0xcccccccc
    v_lshrrev_b32 v101, 2, v3
    v_lshl_add_u32 v101, v101, 4, v3
    v_lshlrev_b32 v101, 2, v101
    s_lshl_b32 s36, s26, 4
    v_add_u32 v10, s36, v3
    s_lshl_b32 s37, s33, 6
    s_sub_u32 s37, 2047, s37
    v_sub_u32 v106, s37, v10
    v_lshlrev_b32 v107, 2, v10
    v_add_u32 v107, 132608, v107
    s_lshl_b32 s36, s33, 9
    s_add_u32 s36, s36, 8192000
    v_lshl_add_u32 v108, v10, 3, s36
    v_bfe_u32 v10, v1, 2, 2
    v_and_b32 v8, 3, v1
    v_lshl_add_u32 v14, v2, 3, v10
    v_lshlrev_b32 v14, 7, v14
    v_lshlrev_b32 v9, 2, v1
    v_and_b32 v9, 0x60, v9
    v_add3_u32 v14, v14, v9, s40
    v_lshl_add_u32 v14, v8, 3, v14
    v_xor_b32 v15, 32, v14
    v_xor_b32 v16, 64, v14
    v_xor_b32 v17, 96, v14
    s_lshl_b32 s36, s26, 6
    s_add_u32 s36, s36, 141312
    v_lshl_add_u32 v26, v2, 4, s36
    v_min_u32 v8, 2, v3
    v_mul_u32_u24 v8, 1536, v8
    v_add_u32 v26, v26, v8
    v_add_u32 v4, 132864, v12
    v_mov_b32 v5, 0
    ds_write_b32 v4, v5
    s_waitcnt lgkmcnt(0)
    s_add_u32 s34, s34, 0x9e3779b8
    s_or_b32 s34, s34, 1
    s_waitcnt vmcnt(12)
    ds_read_b128 a[80:83], v102 offset:0
    ds_read_b128 a[84:87], v100 offset:0
    ds_read_b128 a[88:91], v103 offset:0
    ds_read_b128 a[92:95], v100 offset:64
    ds_read_b128 a[96:99], v102 offset:2048
    ds_read_b128 a[100:103], v100 offset:128
    ds_read_b128 a[104:107], v103 offset:2048
    ds_read_b128 a[108:111], v100 offset:192
    s_waitcnt lgkmcnt(0)
    s_add_u32 m0, s40, 0
    s_mov_b32 s41, 1024
    buffer_load_dwordx4 v92, s[52:55], s41 offen lds
    buffer_load_dwordx4 v93, s[52:55], s41 offen offset:1024 lds
    buffer_load_dwordx4 v94, s[52:55], s41 offen offset:2048 lds
    buffer_load_dwordx4 v95, s[52:55], s41 offen offset:3072 lds
    s_barrier
    v_mfma_f32_16x16x32_bf16 v[116:119], a[80:83], a[80:83], 0
    v_mfma_f32_16x16x32_bf16 v[112:115], v[96:99], a[80:83], 0
    v_mfma_f32_16x16x32_bf16 v[120:123], a[84:87], a[80:83], 0
    v_mfma_f32_16x16x32_bf16 v[124:127], a[84:87], v[96:99], 0
    v_mfma_f32_16x16x32_bf16 v[116:119], a[88:91], a[88:91], v[116:119]
    v_mfma_f32_16x16x32_bf16 v[112:115], v[96:99], a[88:91], v[112:115]
    v_mfma_f32_16x16x32_bf16 v[120:123], a[92:95], a[88:91], v[120:123]
    v_mfma_f32_16x16x32_bf16 v[124:127], a[92:95], v[96:99], v[124:127]
    v_mfma_f32_16x16x32_bf16 v[116:119], a[96:99], a[96:99], v[116:119]
    v_mfma_f32_16x16x32_bf16 v[112:115], v[96:99], a[96:99], v[112:115]
    v_mfma_f32_16x16x32_bf16 v[120:123], a[100:103], a[96:99], v[120:123]
    v_mfma_f32_16x16x32_bf16 v[124:127], a[100:103], v[96:99], v[124:127]
    v_mfma_f32_16x16x32_bf16 v[116:119], a[104:107], a[104:107], v[116:119]
    v_mfma_f32_16x16x32_bf16 v[112:115], v[96:99], a[104:107], v[112:115]
    v_mfma_f32_16x16x32_bf16 v[120:123], a[108:111], a[104:107], v[120:123]
    v_mfma_f32_16x16x32_bf16 v[124:127], a[108:111], v[96:99], v[124:127]
    s_waitcnt vmcnt(12)
    ds_read_b128 a[80:83], v102 offset:4096
    ds_read_b128 a[84:87], v100 offset:256
    ds_read_b128 a[88:91], v103 offset:4096
    ds_read_b128 a[92:95], v100 offset:320
    ds_read_b128 a[96:99], v102 offset:6144
    ds_read_b128 a[100:103], v100 offset:384
    ds_read_b128 a[104:107], v103 offset:6144
    ds_read_b128 a[108:111], v100 offset:448
    s_waitcnt lgkmcnt(0)
    v_mfma_f32_16x16x32_bf16 v[116:119], a[80:83], a[80:83], v[116:119]
    v_mfma_f32_16x16x32_bf16 v[112:115], v[96:99], a[80:83], v[112:115]
    v_mfma_f32_16x16x32_bf16 v[120:123], a[84:87], a[80:83], v[120:123]
    v_mfma_f32_16x16x32_bf16 v[124:127], a[84:87], v[96:99], v[124:127]
    v_mfma_f32_16x16x32_bf16 v[116:119], a[88:91], a[88:91], v[116:119]
    v_mfma_f32_16x16x32_bf16 v[112:115], v[96:99], a[88:91], v[112:115]
    v_mfma_f32_16x16x32_bf16 v[120:123], a[92:95], a[88:91], v[120:123]
    v_mfma_f32_16x16x32_bf16 v[124:127], a[92:95], v[96:99], v[124:127]
    v_mfma_f32_16x16x32_bf16 v[116:119], a[96:99], a[96:99], v[116:119]
    v_mfma_f32_16x16x32_bf16 v[112:115], v[96:99], a[96:99], v[112:115]
    v_mfma_f32_16x16x32_bf16 v[120:123], a[100:103], a[96:99], v[120:123]
    v_mfma_f32_16x16x32_bf16 v[124:127], a[100:103], v[96:99], v[124:127]
    v_mfma_f32_16x16x32_bf16 v[116:119], a[104:107], a[104:107], v[116:119]
    v_mfma_f32_16x16x32_bf16 v[112:115], v[96:99], a[104:107], v[112:115]
    v_mfma_f32_16x16x32_bf16 v[120:123], a[108:111], a[104:107], v[120:123]
    v_mfma_f32_16x16x32_bf16 v[124:127], a[108:111], v[96:99], v[124:127]
    s_waitcnt vmcnt(8)
    ds_read_b128 a[80:83], v102 offset:8192
    ds_read_b128 a[84:87], v100 offset:512
    ds_read_b128 a[88:91], v103 offset:8192
    ds_read_b128 a[92:95], v100 offset:576
    ds_read_b128 a[96:99], v102 offset:10240
    ds_read_b128 a[100:103], v100 offset:640
    ds_read_b128 a[104:107], v103 offset:10240
    ds_read_b128 a[108:111], v100 offset:704
    s_waitcnt lgkmcnt(0)
    v_mfma_f32_16x16x32_bf16 v[116:119], a[80:83], a[80:83], v[116:119]
    v_mfma_f32_16x16x32_bf16 v[112:115], v[96:99], a[80:83], v[112:115]
    v_mfma_f32_16x16x32_bf16 v[120:123], a[84:87], a[80:83], v[120:123]
    v_mfma_f32_16x16x32_bf16 v[124:127], a[84:87], v[96:99], v[124:127]
    v_mfma_f32_16x16x32_bf16 v[116:119], a[88:91], a[88:91], v[116:119]
    v_mfma_f32_16x16x32_bf16 v[112:115], v[96:99], a[88:91], v[112:115]
    v_mfma_f32_16x16x32_bf16 v[120:123], a[92:95], a[88:91], v[120:123]
    v_mfma_f32_16x16x32_bf16 v[124:127], a[92:95], v[96:99], v[124:127]
    v_mfma_f32_16x16x32_bf16 v[116:119], a[96:99], a[96:99], v[116:119]
    v_mfma_f32_16x16x32_bf16 v[112:115], v[96:99], a[96:99], v[112:115]
    v_mfma_f32_16x16x32_bf16 v[120:123], a[100:103], a[96:99], v[120:123]
    v_mfma_f32_16x16x32_bf16 v[124:127], a[100:103], v[96:99], v[124:127]
    v_mfma_f32_16x16x32_bf16 v[116:119], a[104:107], a[104:107], v[116:119]
    v_mfma_f32_16x16x32_bf16 v[112:115], v[96:99], a[104:107], v[112:115]
    v_mfma_f32_16x16x32_bf16 v[120:123], a[108:111], a[104:107], v[120:123]
    v_mfma_f32_16x16x32_bf16 v[124:127], a[108:111], v[96:99], v[124:127]
    s_waitcnt vmcnt(4)
    ds_read_b128 a[80:83], v102 offset:12288
    ds_read_b128 a[84:87], v100 offset:768
    ds_read_b128 a[88:91], v103 offset:12288
    ds_read_b128 a[92:95], v100 offset:832
    ds_read_b128 a[96:99], v102 offset:14336
    ds_read_b128 a[100:103], v100 offset:896
    ds_read_b128 a[104:107], v103 offset:14336
    ds_read_b128 a[108:111], v100 offset:960
    s_waitcnt lgkmcnt(0)
    v_mfma_f32_16x16x32_bf16 v[116:119], a[80:83], a[80:83], v[116:119]
    v_mfma_f32_16x16x32_bf16 v[112:115], v[96:99], a[80:83], v[112:115]
    v_mfma_f32_16x16x32_bf16 v[120:123], a[84:87], a[80:83], v[120:123]
    v_mfma_f32_16x16x32_bf16 v[124:127], a[84:87], v[96:99], v[124:127]
    v_mfma_f32_16x16x32_bf16 v[116:119], a[88:91], a[88:91], v[116:119]
    v_mfma_f32_16x16x32_bf16 v[112:115], v[96:99], a[88:91], v[112:115]
    v_mfma_f32_16x16x32_bf16 v[120:123], a[92:95], a[88:91], v[120:123]
    v_mfma_f32_16x16x32_bf16 v[124:127], a[92:95], v[96:99], v[124:127]
    v_mfma_f32_16x16x32_bf16 v[116:119], a[96:99], a[96:99], v[116:119]
    v_mfma_f32_16x16x32_bf16 v[112:115], v[96:99], a[96:99], v[112:115]
    v_mfma_f32_16x16x32_bf16 v[120:123], a[100:103], a[96:99], v[120:123]
    v_mfma_f32_16x16x32_bf16 v[124:127], a[100:103], v[96:99], v[124:127]
    v_mfma_f32_16x16x32_bf16 v[116:119], a[104:107], a[104:107], v[116:119]
    v_mfma_f32_16x16x32_bf16 v[112:115], v[96:99], a[104:107], v[112:115]
    v_mfma_f32_16x16x32_bf16 v[120:123], a[108:111], a[104:107], v[120:123]
    v_mfma_f32_16x16x32_bf16 v[124:127], a[108:111], v[96:99], v[124:127]
    s_waitcnt vmcnt(0)
    ds_read_b128 a[80:83], v102 offset:0
    ds_read_b128 a[84:87], v100 offset:1024
    ds_read_b128 a[88:91], v103 offset:0
    ds_read_b128 a[92:95], v100 offset:1088
    ds_read_b128 a[96:99], v102 offset:2048
    ds_read_b128 a[100:103], v100 offset:1152
    ds_read_b128 a[104:107], v103 offset:2048
    ds_read_b128 a[108:111], v100 offset:1216
    s_waitcnt lgkmcnt(0)
    v_mfma_f32_16x16x32_bf16 v[116:119], a[80:83], a[80:83], v[116:119]
    v_mfma_f32_16x16x32_bf16 v[112:115], v[96:99], a[80:83], v[112:115]
    v_mfma_f32_16x16x32_bf16 v[120:123], a[84:87], a[80:83], v[120:123]
    v_mfma_f32_16x16x32_bf16 v[124:127], a[84:87], v[96:99], v[124:127]
    v_mfma_f32_16x16x32_bf16 v[116:119], a[88:91], a[88:91], v[116:119]
    v_mfma_f32_16x16x32_bf16 v[112:115], v[96:99], a[88:91], v[112:115]
    v_mfma_f32_16x16x32_bf16 v[120:123], a[92:95], a[88:91], v[120:123]
    v_mfma_f32_16x16x32_bf16 v[124:127], a[92:95], v[96:99], v[124:127]
    v_mfma_f32_16x16x32_bf16 v[116:119], a[96:99], a[96:99], v[116:119]
    v_mfma_f32_16x16x32_bf16 v[112:115], v[96:99], a[96:99], v[112:115]
    v_mfma_f32_16x16x32_bf16 v[120:123], a[100:103], a[96:99], v[120:123]
    v_mfma_f32_16x16x32_bf16 v[124:127], a[100:103], v[96:99], v[124:127]
    v_mfma_f32_16x16x32_bf16 v[116:119], a[104:107], a[104:107], v[116:119]
    v_mfma_f32_16x16x32_bf16 v[112:115], v[96:99], a[104:107], v[112:115]
    v_mfma_f32_16x16x32_bf16 v[120:123], a[108:111], a[104:107], v[120:123]
    v_mfma_f32_16x16x32_bf16 v[124:127], a[108:111], v[96:99], v[124:127]
    s_nop 4
    v_cndmask_b32 v4, v116, v117, s[58:59]
    v_cndmask_b32 v5, v118, v119, s[58:59]
    v_cndmask_b32 v4, v4, v5, s[64:65]
    ds_bpermute_b32 v4, v101, v4
    v_mul_f32 v5, 0xbacccccd, v112
    v_cvt_pk_bf16_f32 v104, v5, v5
    v_lshlrev_b32 v104, 16, v104
    v_mul_f32 v5, v5, v5
    v_mov_b32 v6, 0x3acccccd
    s_waitcnt lgkmcnt(0)
    v_fma_f32 v4, v4, v6, -v5
    v_max_f32 v4, 0, v4
    v_cvt_pk_bf16_f32 v4, v4, v4
    v_lshlrev_b32 v4, 16, v4
    v_add_f32 v4, 0x3727c5ac, v4
    v_cvt_pk_bf16_f32 v4, v4, v4
    v_lshlrev_b32 v4, 16, v4
    v_sqrt_f32 v4, v4
    s_nop 0
    v_cvt_pk_bf16_f32 v4, v4, v4
    v_lshlrev_b32 v4, 16, v4
    v_rcp_f32 v105, v4
    v_lshrrev_b32 v8, 16, v4
    v_fma_f32 v4, v104, v124, v120
    v_mul_f32 v4, v4, v105
    v_cvt_pk_bf16_f32 v4, v4, v4
    v_ashrrev_i32 v5, 31, v4
    v_or_b32 v5, 0x80000000, v5
    v_xor_b32 v4, v4, v5
    v_and_b32 v4, 0xffff0000, v4
    v_or_b32 v4, v4, v106
    ds_write_b32 v107, v4
    v_mov_b32 v11, 132864
    v_mov_b32 v7, 1
    s_mov_b64 exec, 1
    ds_add_u32 v11, v7
    s_mov_b64 exec, -1
    v_or_b32 v8, v8, v104
    v_mov_b32 v9, s34
    s_mov_b64 exec, 0xffff
    buffer_store_dwordx2 v[8:9], v108, s[28:31], 0 offen sc1
    s_mov_b64 exec, -1
    s_cmp_lg_u32 s26, 0
    s_cbranch_scc1 Lpub_done
    s_setprio 3
Lcw_9:
    s_sub_u32 s35, s35, 1
    s_cbranch_scc1 Lend
    ds_read_b32 v7, v11
    s_waitcnt lgkmcnt(0)
    v_readfirstlane_b32 s38, v7
    s_nop 0
    s_cmp_lt_u32 s38, 4
    s_cbranch_scc1 Lcw_9
    v_add_u32 v5, 132608, v12
    ds_read_b32 v6, v5
    s_waitcnt lgkmcnt(0)
    v_mov_b32 v4, v6
    s_nop 1
    v_max_u32_dpp v4, v4, v4 row_ror:8 row_mask:0xf bank_mask:0xf
    s_nop 1
    v_max_u32_dpp v4, v4, v4 row_ror:4 row_mask:0xf bank_mask:0xf
    s_nop 1
    v_max_u32_dpp v4, v4, v4 row_ror:2 row_mask:0xf bank_mask:0xf
    s_nop 1
    v_max_u32_dpp v4, v4, v4 row_ror:1 row_mask:0xf bank_mask:0xf
    s_nop 0
    v_readlane_b32 s66, v4, 0
    v_readlane_b32 s36, v4, 16
    v_readlane_b32 s37, v4, 32
    v_readlane_b32 s38, v4, 48
    s_max_u32 s66, s66, s36
    s_max_u32 s37, s37, s38
    s_max_u32 s66, s66, s37
    v_cmp_eq_u32 vcc, s66, v6
    s_nop 1
    v_cndmask_b32 v4, v6, 0, vcc
    s_nop 1
    v_max_u32_dpp v4, v4, v4 row_ror:8 row_mask:0xf bank_mask:0xf
    s_nop 1
    v_max_u32_dpp v4, v4, v4 row_ror:4 row_mask:0xf bank_mask:0xf
    s_nop 1
    v_max_u32_dpp v4, v4, v4 row_ror:2 row_mask:0xf bank_mask:0xf
    s_nop 1
    v_max_u32_dpp v4, v4, v4 row_ror:1 row_mask:0xf bank_mask:0xf
    s_nop 0
    v_readlane_b32 s67, v4, 0
    v_readlane_b32 s36, v4, 16
    v_readlane_b32 s37, v4, 32
    v_readlane_b32 s38, v4, 48
    s_max_u32 s67, s67, s36
    s_max_u32 s37, s37, s38
    s_max_u32 s67, s67, s37
    v_mov_b32 v112, s66
    v_mov_b32 v113, s34
    v_mov_b32 v114, s67
    v_mov_b32 v115, s34
    s_lshl_b32 s36, s32, 7
    s_add_u32 s36, s36, 8126464
    s_mov_b64 exec, 0xff
    buffer_store_dwordx4 v[112:115], v13, s[28:31], s36 offen sc1
    s_mov_b64 exec, -1
    v_mov_b32 v11, 132864
    v_mov_b32 v7, 1
    s_mov_b64 exec, 1
    ds_add_u32 v11, v7
    s_mov_b64 exec, -1
    s_mov_b64 exec, 1
    s_lshl_b32 s36, s2, 2
    s_add_u32 s36, s36, 8323072
    v_mov_b32 v4, s34
    v_mov_b32 v5, s36
    buffer_store_dword v4, v5, s[28:31], 0 offen sc1
    s_mov_b64 exec, -1
    s_setprio 0
Lpub_done:
Lcw_10:
    s_sub_u32 s35, s35, 1
    s_cbranch_scc1 Lend
    ds_read_b32 v7, v11
    s_waitcnt lgkmcnt(0)
    v_readfirstlane_b32 s38, v7
    s_nop 0
    s_cmp_lt_u32 s38, 5
    s_cbranch_scc1 Lcw_10
    s_cmp_ge_u32 s32, 27
    s_cbranch_scc1 Lhelp_r
    s_add_u32 m0, s40, 0
    s_add_u32 s41, s42, 0
    buffer_load_dwordx4 v18, s[44:47], s41 offen nt lds
    buffer_load_dwordx4 v19, s[44:47], s41 offen offset:1024 nt lds
    buffer_load_dwordx4 v20, s[44:47], s41 offen offset:2048 nt lds
    buffer_load_dwordx4 v21, s[44:47], s41 offen offset:3072 nt lds
    s_add_u32 m0, s40, 4096
    s_add_u32 s41, s42, 442368
    buffer_load_dwordx4 v18, s[44:47], s41 offen nt lds
    buffer_load_dwordx4 v19, s[44:47], s41 offen offset:1024 nt lds
    buffer_load_dwordx4 v20, s[44:47], s41 offen offset:2048 nt lds
    buffer_load_dwordx4 v21, s[44:47], s41 offen offset:3072 nt lds
    s_add_u32 m0, s40, 8192
    s_add_u32 s41, s42, 884736
    buffer_load_dwordx4 v18, s[44:47], s41 offen nt lds
    buffer_load_dwordx4 v19, s[44:47], s41 offen offset:1024 nt lds
    buffer_load_dwordx4 v20, s[44:47], s41 offen offset:2048 nt lds
    buffer_load_dwordx4 v21, s[44:47], s41 offen offset:3072 nt lds
    s_add_u32 m0, s40, 12288
    s_add_u32 s41, s42, 1327104
    buffer_load_dwordx4 v18, s[44:47], s41 offen nt lds
    buffer_load_dwordx4 v19, s[44:47], s41 offen offset:1024 nt lds
    buffer_load_dwordx4 v20, s[44:47], s41 offen offset:2048 nt lds
    buffer_load_dwordx4 v21, s[44:47], s41 offen offset:3072 nt lds
    s_waitcnt vmcnt(12)
    ds_read_b64_tr_b16 a[0:1], v14 offset:0
    ds_read_b64_tr_b16 a[2:3], v14 offset:512
    ds_read_b64_tr_b16 a[4:5], v15 offset:0
    ds_read_b64_tr_b16 a[6:7], v15 offset:512
    ds_read_b64_tr_b16 a[8:9], v16 offset:0
    ds_read_b64_tr_b16 a[10:11], v16 offset:512
    ds_read_b64_tr_b16 a[12:13], v17 offset:0
    ds_read_b64_tr_b16 a[14:15], v17 offset:512
    s_waitcnt lgkmcnt(0)
    s_add_u32 m0, s40, 0
    s_add_u32 s41, s42, 1769472
    buffer_load_dwordx4 v18, s[44:47], s41 offen nt lds
    buffer_load_dwordx4 v19, s[44:47], s41 offen offset:1024 nt lds
    buffer_load_dwordx4 v20, s[44:47], s41 offen offset:2048 nt lds
    buffer_load_dwordx4 v21, s[44:47], s41 offen offset:3072 nt lds
    v_mov_b32 v11, 132864
    v_mov_b32 v7, 1
    s_mov_b64 exec, 1
    ds_add_u32 v11, v7
    s_mov_b64 exec, -1
    s_waitcnt vmcnt(12)
    ds_read_b64_tr_b16 a[16:17], v14 offset:4096
    ds_read_b64_tr_b16 a[18:19], v14 offset:4608
    ds_read_b64_tr_b16 a[20:21], v15 offset:4096
    ds_read_b64_tr_b16 a[22:23], v15 offset:4608
    ds_read_b64_tr_b16 a[24:25], v16 offset:4096
    ds_read_b64_tr_b16 a[26:27], v16 offset:4608
    ds_read_b64_tr_b16 a[28:29], v17 offset:4096
    ds_read_b64_tr_b16 a[30:31], v17 offset:4608
    s_waitcnt lgkmcnt(0)
    s_add_u32 m0, s40, 4096
    s_add_u32 s41, s43, 0
    buffer_load_dwordx4 v22, s[48:51], s41 offen nt lds
    buffer_load_dwordx4 v23, s[48:51], s41 offen offset:1024 nt lds
    buffer_load_dwordx4 v24, s[48:51], s41 offen offset:2048 nt lds
    buffer_load_dwordx4 v25, s[48:51], s41 offen offset:3072 nt lds
    s_waitcnt vmcnt(12)
    ds_read_b64_tr_b16 a[32:33], v14 offset:8192
    ds_read_b64_tr_b16 a[34:35], v14 offset:8704
    ds_read_b64_tr_b16 a[36:37], v15 offset:8192
    ds_read_b64_tr_b16 a[38:39], v15 offset:8704
    ds_read_b64_tr_b16 a[40:41], v16 offset:8192
    ds_read_b64_tr_b16 a[42:43], v16 offset:8704
    ds_read_b64_tr_b16 a[44:45], v17 offset:8192
    ds_read_b64_tr_b16 a[46:47], v17 offset:8704
    s_waitcnt lgkmcnt(0)
    s_add_u32 m0, s40, 8192
    s_add_u32 s41, s43, 40960
    buffer_load_dwordx4 v22, s[48:51], s41 offen nt lds
    buffer_load_dwordx4 v23, s[48:51], s41 offen offset:1024 nt lds
    buffer_load_dwordx4 v24, s[48:51], s41 offen offset:2048 nt lds
    buffer_load_dwordx4 v25, s[48:51], s41 offen offset:3072 nt lds
    s_waitcnt vmcnt(12)
    ds_read_b64_tr_b16 a[48:49], v14 offset:12288
    ds_read_b64_tr_b16 a[50:51], v14 offset:12800
    ds_read_b64_tr_b16 a[52:53], v15 offset:12288
    ds_read_b64_tr_b16 a[54:55], v15 offset:12800
    ds_read_b64_tr_b16 a[56:57], v16 offset:12288
    ds_read_b64_tr_b16 a[58:59], v16 offset:12800
    ds_read_b64_tr_b16 a[60:61], v17 offset:12288
    ds_read_b64_tr_b16 a[62:63], v17 offset:12800
    s_waitcnt vmcnt(8)
    ds_read_b64_tr_b16 a[64:65], v14 offset:0
    ds_read_b64_tr_b16 a[66:67], v14 offset:512
    ds_read_b64_tr_b16 a[68:69], v15 offset:0
    ds_read_b64_tr_b16 a[70:71], v15 offset:512
    ds_read_b64_tr_b16 a[72:73], v16 offset:0
    ds_read_b64_tr_b16 a[74:75], v16 offset:512
    ds_read_b64_tr_b16 a[76:77], v17 offset:0
    ds_read_b64_tr_b16 a[78:79], v17 offset:512
    s_branch Laux_mm
Laux_u:
    s_cmp_ge_u32 s32, 27
    s_cbranch_scc1 Lend
    v_and_b32 v8, 1, v2
    v_lshlrev_b32 v8, 1, v8
    v_xor_b32 v8, v8, v6
    v_lshlrev_b32 v8, 4, v8
    v_mul_u32_u24 v9, 3456, v5
    s_lshl_b32 s38, s32, 7
    v_add3_u32 v18, v9, v8, s38
    v_xor_b32 v19, 64, v18
    v_add_u32 v19, 26624, v19
    v_add_u32 v20, 53248, v18
    v_add_u32 v21, 53248, v19
    s_mul_i32 s42, s26, 110592
    v_mul_u32_u24 v9, 1280, v5
    v_add_u32 v22, v9, v8
    v_xor_b32 v23, 64, v22
    v_add_u32 v23, 9216, v23
    v_add_u32 v24, 18432, v22
    v_add_u32 v25, 18432, v23
    s_mul_i32 s43, s32, 81920
    s_lshl_b32 s38, s3, 7
    s_add_u32 s43, s43, s38
    s_waitcnt lgkmcnt(0)
    s_mov_b64 s[44:45], s[16:17]
    s_mov_b32 s46, 2211840
    s_mov_b32 s47, 0x20000
    s_mov_b64 s[28:29], s[24:25]
    s_mov_b32 s30, 268435456
    s_mov_b32 s31, 0x20000
    s_load_dword s34, s[28:29], 0
    s_mov_b64 s[52:53], s[4:5]
    s_mov_b32 s54, 2621440
    s_mov_b32 s55, 0x20000
    s_mov_b64 s[48:49], s[18:19]
    s_mov_b32 s50, 2211840
    s_mov_b32 s51, 0x20000
    s_mov_b64 s[68:69], s[18:19]
    s_mov_b32 s70, 2211840
    s_mov_b32 s71, 0x20000
    s_cmp_ge_u32 s26, 2
    s_cselect_b32 s70, 0, s70
    v_bfe_u32 v10, v1, 2, 2
    v_and_b32 v8, 3, v1
    v_lshl_add_u32 v14, v2, 3, v10
    v_lshlrev_b32 v14, 7, v14
    v_lshlrev_b32 v9, 2, v1
    v_and_b32 v9, 0x60, v9
    v_add3_u32 v14, v14, v9, s40
    v_lshl_add_u32 v14, v8, 3, v14
    v_xor_b32 v15, 32, v14
    v_xor_b32 v16, 64, v14
    v_xor_b32 v17, 96, v14
    s_lshl_b32 s36, s26, 6
    s_add_u32 s36, s36, 141312
    v_lshl_add_u32 v26, v2, 4, s36
    v_min_u32 v8, 2, v3
    v_mul_u32_u24 v8, 1536, v8
    v_add_u32 v26, v26, v8
    s_waitcnt lgkmcnt(0)
    s_add_u32 s34, s34, 0x9e3779b8
    s_or_b32 s34, s34, 1
    s_cmp_lg_u32 s3, 7
    s_cbranch_scc1 Lnop7
    s_setprio 3
Lnop7:
    s_barrier
    s_add_u32 m0, s40, 0
    s_add_u32 s41, s42, 0
    buffer_load_dwordx4 v18, s[44:47], s41 offen nt lds
    buffer_load_dwordx4 v19, s[44:47], s41 offen offset:1024 nt lds
    buffer_load_dwordx4 v20, s[44:47], s41 offen offset:2048 nt lds
    buffer_load_dwordx4 v21, s[44:47], s41 offen offset:3072 nt lds
    s_add_u32 m0, s40, 4096
    s_add_u32 s41, s42, 442368
    buffer_load_dwordx4 v18, s[44:47], s41 offen nt lds
    buffer_load_dwordx4 v19, s[44:47], s41 offen offset:1024 nt lds
    buffer_load_dwordx4 v20, s[44:47], s41 offen offset:2048 nt lds
    buffer_load_dwordx4 v21, s[44:47], s41 offen offset:3072 nt lds
    s_add_u32 m0, s40, 8192
    s_add_u32 s41, s42, 884736
    buffer_load_dwordx4 v18, s[44:47], s41 offen nt lds
    buffer_load_dwordx4 v19, s[44:47], s41 offen offset:1024 nt lds
    buffer_load_dwordx4 v20, s[44:47], s41 offen offset:2048 nt lds
    buffer_load_dwordx4 v21, s[44:47], s41 offen offset:3072 nt lds
    s_add_u32 m0, s40, 12288
    s_add_u32 s41, s42, 1327104
    buffer_load_dwordx4 v18, s[44:47], s41 offen nt lds
    buffer_load_dwordx4 v19, s[44:47], s41 offen offset:1024 nt lds
    buffer_load_dwordx4 v20, s[44:47], s41 offen offset:2048 nt lds
    buffer_load_dwordx4 v21, s[44:47], s41 offen offset:3072 nt lds
    v_mov_b32 v11, 132864
Lcw_11:
    s_sub_u32 s35, s35, 1
    s_cbranch_scc1 Lend
    s_sleep 4
    ds_read_b32 v7, v11
    s_waitcnt lgkmcnt(0)
    v_readfirstlane_b32 s38, v7
    s_nop 0
    s_cmp_lt_u32 s38, 5
    s_cbranch_scc1 Lcw_11
    s_waitcnt vmcnt(12)
    ds_read_b64_tr_b16 a[0:1], v14 offset:0
    ds_read_b64_tr_b16 a[2:3], v14 offset:512
    ds_read_b64_tr_b16 a[4:5], v15 offset:0
    ds_read_b64_tr_b16 a[6:7], v15 offset:512
    ds_read_b64_tr_b16 a[8:9], v16 offset:0
    ds_read_b64_tr_b16 a[10:11], v16 offset:512
    ds_read_b64_tr_b16 a[12:13], v17 offset:0
    ds_read_b64_tr_b16 a[14:15], v17 offset:512
    s_waitcnt lgkmcnt(0)
    s_add_u32 m0, s40, 0
    s_add_u32 s41, s42, 1769472
    buffer_load_dwordx4 v18, s[44:47], s41 offen nt lds
    buffer_load_dwordx4 v19, s[44:47], s41 offen offset:1024 nt lds
    buffer_load_dwordx4 v20, s[44:47], s41 offen offset:2048 nt lds
    buffer_load_dwordx4 v21, s[44:47], s41 offen offset:3072 nt lds
    s_waitcnt vmcnt(12)
    ds_read_b64_tr_b16 a[16:17], v14 offset:4096
    ds_read_b64_tr_b16 a[18:19], v14 offset:4608
    ds_read_b64_tr_b16 a[20:21], v15 offset:4096
    ds_read_b64_tr_b16 a[22:23], v15 offset:4608
    ds_read_b64_tr_b16 a[24:25], v16 offset:4096
    ds_read_b64_tr_b16 a[26:27], v16 offset:4608
    ds_read_b64_tr_b16 a[28:29], v17 offset:4096
    ds_read_b64_tr_b16 a[30:31], v17 offset:4608
    s_waitcnt vmcnt(8)
    ds_read_b64_tr_b16 a[32:33], v14 offset:8192
    ds_read_b64_tr_b16 a[34:35], v14 offset:8704
    ds_read_b64_tr_b16 a[36:37], v15 offset:8192
    ds_read_b64_tr_b16 a[38:39], v15 offset:8704
    ds_read_b64_tr_b16 a[40:41], v16 offset:8192
    ds_read_b64_tr_b16 a[42:43], v16 offset:8704
    ds_read_b64_tr_b16 a[44:45], v17 offset:8192
    ds_read_b64_tr_b16 a[46:47], v17 offset:8704
    s_waitcnt vmcnt(4)
    ds_read_b64_tr_b16 a[48:49], v14 offset:12288
    ds_read_b64_tr_b16 a[50:51], v14 offset:12800
    ds_read_b64_tr_b16 a[52:53], v15 offset:12288
    ds_read_b64_tr_b16 a[54:55], v15 offset:12800
    ds_read_b64_tr_b16 a[56:57], v16 offset:12288
    ds_read_b64_tr_b16 a[58:59], v16 offset:12800
    ds_read_b64_tr_b16 a[60:61], v17 offset:12288
    ds_read_b64_tr_b16 a[62:63], v17 offset:12800
    s_waitcnt vmcnt(0)
    ds_read_b64_tr_b16 a[64:65], v14 offset:0
    ds_read_b64_tr_b16 a[66:67], v14 offset:512
    ds_read_b64_tr_b16 a[68:69], v15 offset:0
    ds_read_b64_tr_b16 a[70:71], v15 offset:512
    ds_read_b64_tr_b16 a[72:73], v16 offset:0
    ds_read_b64_tr_b16 a[74:75], v16 offset:512
    ds_read_b64_tr_b16 a[76:77], v17 offset:0
    ds_read_b64_tr_b16 a[78:79], v17 offset:512
    s_cmp_lg_u32 s3, 7
    s_cbranch_scc1 Lnofx
    v_mov_b32 v92, 0x3f803f80
    v_mov_b32 v93, 0x3f803f80
    v_mov_b32 v94, 0x3f803f80
    v_mov_b32 v95, 0x3f803f80
    v_add_u32 v4, 144384, v13
    ds_write_b128 v4, v[92:95]
    ds_write_b128 v4, v[92:95] offset:1024
    v_and_b32 v120, 31, v1
    v_lshlrev_b32 v120, 7, v120
    v_add_u32 v120, 8126464, v120
Lpt_12:
    s_sub_u32 s35, s35, 1
    s_cbranch_scc1 Lend
    s_sleep 2
    buffer_load_dwordx4 v[124:127], v120, s[28:31], 0 offen sc1
    s_waitcnt vmcnt(0)
    v_cmp_ne_u32 vcc, s34, v125
    v_cmp_ne_u32 s[36:37], s34, v127
    s_nop 0
    s_or_b64 s[36:37], s[36:37], vcc
    s_cbranch_scc1 Lpt_12
    v_mov_b32 v120, v124
    s_nop 1
    v_max_u32_dpp v120, v120, v120 row_ror:8 row_mask:0xf bank_mask:0xf
    s_nop 1
    v_max_u32_dpp v120, v120, v120 row_ror:4 row_mask:0xf bank_mask:0xf
    s_nop 1
    v_max_u32_dpp v120, v120, v120 row_ror:2 row_mask:0xf bank_mask:0xf
    s_nop 1
    v_max_u32_dpp v120, v120, v120 row_ror:1 row_mask:0xf bank_mask:0xf
    s_nop 0
    v_readlane_b32 s56, v120, 0
    v_readlane_b32 s36, v120, 16
    v_readlane_b32 s37, v120, 32
    v_readlane_b32 s38, v120, 48
    s_max_u32 s56, s56, s36
    s_max_u32 s37, s37, s38
    s_max_u32 s56, s56, s37
    v_cmp_eq_u32 vcc, s56, v124
    s_nop 1
    v_cndmask_b32 v120, v124, v126, vcc
    s_nop 1
    v_max_u32_dpp v120, v120, v120 row_ror:8 row_mask:0xf bank_mask:0xf
    s_nop 1
    v_max_u32_dpp v120, v120, v120 row_ror:4 row_mask:0xf bank_mask:0xf
    s_nop 1
    v_max_u32_dpp v120, v120, v120 row_ror:2 row_mask:0xf bank_mask:0xf
    s_nop 1
    v_max_u32_dpp v120, v120, v120 row_ror:1 row_mask:0xf bank_mask:0xf
    s_nop 0
    v_readlane_b32 s57, v120, 0
    v_readlane_b32 s36, v120, 16
    v_readlane_b32 s37, v120, 32
    v_readlane_b32 s38, v120, 48
    s_max_u32 s57, s57, s36
    s_max_u32 s37, s37, s38
    s_max_u32 s57, s57, s37
    s_and_b32 s36, s56, 0x7ff
    s_sub_u32 s36, 2047, s36
    s_and_b32 s37, s57, 0x7ff
    s_sub_u32 s37, 2047, s37
    s_mul_i32 s38, s36, 1280
    s_mul_i32 s39, s37, 1280
    s_mov_b32 m0, 141312
    v_mov_b32 v4, s36
    buffer_load_dwordx4 v13, s[52:55], s38 offen lds
    s_mov_b32 m0, 142848
    v_mov_b32 v5, s37
    buffer_load_dwordx4 v13, s[52:55], s39 offen lds
    s_mov_b64 exec, 0xffff
    buffer_load_dwordx4 v13, s[52:55], s39 offen offset:1024 lds
    s_mov_b32 m0, 141312
    s_mov_b32 vcc_lo, 0xaaaaaaaa
    buffer_load_dwordx4 v13, s[52:55], s38 offen offset:1024 lds
    s_mov_b64 exec, 3
    v_cndmask_b32 v4, v4, v5, vcc
    v_lshlrev_b32 v118, 3, v4
    v_add_u32 v118, 8192000, v118
    v_add_u32 v9, 132872, v12
Lxs_chk:
    s_sub_u32 s35, s35, 1
    s_cbranch_scc1 Lend
    buffer_load_dwordx2 v[116:117], v118, s[28:31], 0 offen sc1
    s_waitcnt vmcnt(0)
    v_cmp_ne_u32 vcc, s34, v117
    s_nop 0
    s_cbranch_vccnz Lxs_chk
    ds_write_b32 v9, v116
    s_mov_b64 exec, -1
    v_mov_b32 v10, 132868
    v_mov_b32 v7, 1
    s_mov_b64 exec, 1
    ds_add_u32 v10, v7
    s_mov_b64 exec, -1
Lnofx:
Lcw_13:
    s_sub_u32 s35, s35, 1
    s_cbranch_scc1 Lend
    s_sleep 2
    ds_read_b32 v7, v11
    s_waitcnt lgkmcnt(0)
    v_readfirstlane_b32 s38, v7
    s_nop 0
    s_cmp_lt_u32 s38, 9
    s_cbranch_scc1 Lcw_13
    s_add_u32 m0, s40, 4096
    s_add_u32 s41, s43, 0
    buffer_load_dwordx4 v22, s[48:51], s41 offen nt lds
    buffer_load_dwordx4 v23, s[48:51], s41 offen offset:1024 nt lds
    buffer_load_dwordx4 v24, s[48:51], s41 offen offset:2048 nt lds
    buffer_load_dwordx4 v25, s[48:51], s41 offen offset:3072 nt lds
    s_add_u32 m0, s40, 8192
    s_add_u32 s41, s43, 40960
    buffer_load_dwordx4 v22, s[48:51], s41 offen nt lds
    buffer_load_dwordx4 v23, s[48:51], s41 offen offset:1024 nt lds
    buffer_load_dwordx4 v24, s[48:51], s41 offen offset:2048 nt lds
    buffer_load_dwordx4 v25, s[48:51], s41 offen offset:3072 nt lds
    s_add_u32 m0, s40, 12288
    s_add_u32 s41, s43, 512
    buffer_load_dwordx4 v22, s[68:71], s41 offen nt lds
    buffer_load_dwordx4 v23, s[68:71], s41 offen offset:1024 nt lds
    buffer_load_dwordx4 v24, s[68:71], s41 offen offset:2048 nt lds
    buffer_load_dwordx4 v25, s[68:71], s41 offen offset:3072 nt lds
    s_add_u32 m0, s40, 0
    s_add_u32 s41, s43, 41472
    buffer_load_dwordx4 v22, s[68:71], s41 offen nt lds
    buffer_load_dwordx4 v23, s[68:71], s41 offen offset:1024 nt lds
    buffer_load_dwordx4 v24, s[68:71], s41 offen offset:2048 nt lds
    buffer_load_dwordx4 v25, s[68:71], s41 offen offset:3072 nt lds
Laux_mm:
    v_mov_b32 v10, 132868
Lcw_14:
    s_sub_u32 s35, s35, 1
    s_cbranch_scc1 Lend
    s_sleep 1
    ds_read_b32 v7, v10
    s_waitcnt lgkmcnt(0)
    v_readfirstlane_b32 s38, v7
    s_nop 0
    s_cmp_lt_u32 s38, 1
    s_cbranch_scc1 Lcw_14
    ds_read_b128 v[92:95], v26 offset:0
    ds_read_b128 v[96:99], v26 offset:256
    ds_read_b128 v[100:103], v26 offset:512
    ds_read_b128 v[104:107], v26 offset:768
    ds_read_b128 v[108:111], v26 offset:1024
    ds_read_b64 v[116:117], v10 offset:4
    s_waitcnt lgkmcnt(0)
    v_readfirstlane_b32 s56, v116
    v_readfirstlane_b32 s57, v117
    v_mfma_f32_16x16x32_bf16 v[112:115], a[0:3], v[92:95], 0
    v_mfma_f32_16x16x32_bf16 v[116:119], a[4:7], v[92:95], 0
    v_mfma_f32_16x16x32_bf16 v[120:123], a[8:11], v[92:95], 0
    v_mfma_f32_16x16x32_bf16 v[124:127], a[12:15], v[92:95], 0
    v_mfma_f32_16x16x32_bf16 v[112:115], a[16:19], v[96:99], v[112:115]
    v_mfma_f32_16x16x32_bf16 v[116:119], a[20:23], v[96:99], v[116:119]
    v_mfma_f32_16x16x32_bf16 v[120:123], a[24:27], v[96:99], v[120:123]
    v_mfma_f32_16x16x32_bf16 v[124:127], a[28:31], v[96:99], v[124:127]
    v_mfma_f32_16x16x32_bf16 v[112:115], a[32:35], v[100:103], v[112:115]
    v_mfma_f32_16x16x32_bf16 v[116:119], a[36:39], v[100:103], v[116:119]
    v_mfma_f32_16x16x32_bf16 v[120:123], a[40:43], v[100:103], v[120:123]
    v_mfma_f32_16x16x32_bf16 v[124:127], a[44:47], v[100:103], v[124:127]
    v_mfma_f32_16x16x32_bf16 v[112:115], a[48:51], v[104:107], v[112:115]
    v_mfma_f32_16x16x32_bf16 v[116:119], a[52:55], v[104:107], v[116:119]
    v_mfma_f32_16x16x32_bf16 v[120:123], a[56:59], v[104:107], v[120:123]
    v_mfma_f32_16x16x32_bf16 v[124:127], a[60:63], v[104:107], v[124:127]
    v_mfma_f32_16x16x32_bf16 v[112:115], a[64:67], v[108:111], v[112:115]
    v_mfma_f32_16x16x32_bf16 v[116:119], a[68:71], v[108:111], v[116:119]
    v_mfma_f32_16x16x32_bf16 v[120:123], a[72:75], v[108:111], v[120:123]
    v_mfma_f32_16x16x32_bf16 v[124:127], a[76:79], v[108:111], v[124:127]
    s_mul_i32 s36, s3, 768
    s_add_u32 s36, s36, 133120
    v_lshlrev_b32 v4, 8, v3
    v_lshl_add_u32 v4, v2, 4, v4
    v_add_u32 v4, s36, v4
    v_add_u32 v5, 133120, v12
    s_lshl_b32 s37, s3, 8
    s_add_u32 s37, s37, 139264
    v_lshl_add_u32 v6, v1, 1, s37
    v_and_b32 v7, 1, v1
    v_lshlrev_b32 v7, 7, v7
    v_lshl_add_u32 v7, v2, 4, v7
    v_add_u32 v7, s37, v7
    s_lshl_b32 s38, s56, 16
    s_lshl_b32 s39, s57, 16
    v_rcp_f32 v8, s38
    v_rcp_f32 v9, s39
    s_and_b32 s56, s56, 0xffff0000
    s_and_b32 s57, s57, 0xffff0000
    s_mov_b32 exec_lo, 0x00070007
    s_mov_b32 exec_hi, 0x00070007
    ds_write_b128 v4, v[112:115] offset:0
    ds_write_b128 v4, v[116:119] offset:64
    ds_write_b128 v4, v[120:123] offset:128
    ds_write_b128 v4, v[124:127] offset:192
    s_mov_b64 exec, -1
    s_waitcnt lgkmcnt(0)
    s_barrier
    ds_read2st64_b32 v[92:93], v5 offset0:0 offset1:1
    ds_read2st64_b32 v[94:95], v5 offset0:2 offset1:3
    ds_read2st64_b32 v[96:97], v5 offset0:4 offset1:5
    ds_read2st64_b32 v[98:99], v5 offset0:6 offset1:7
    ds_read2st64_b32 v[100:101], v5 offset0:8 offset1:9
    ds_read2st64_b32 v[102:103], v5 offset0:10 offset1:11
    ds_read2st64_b32 v[116:117], v5 offset0:12 offset1:13
    ds_read2st64_b32 v[118:119], v5 offset0:14 offset1:15
    ds_read2st64_b32 v[120:121], v5 offset0:16 offset1:17
    ds_read2st64_b32 v[122:123], v5 offset0:18 offset1:19
    ds_read2st64_b32 v[124:125], v5 offset0:20 offset1:21
    ds_read2st64_b32 v[126:127], v5 offset0:22 offset1:23
    v_cmp_eq_u32 s[72:73], 1, v2
    v_cmp_eq_u32 s[74:75], 2, v2
    v_cmp_eq_u32 s[76:77], 3, v2
    s_mul_i32 s37, s32, 10
    s_add_u32 s37, s37, s3
    s_lshl_b32 s37, s37, 10
    s_add_u32 s37, s37, 7405568
    s_waitcnt lgkmcnt(0)
    v_add_f32 v92, v92, v95
    v_add_f32 v98, v98, v101
    v_add_f32 v92, v92, v98
    v_add_f32 v93, v93, v96
    v_add_f32 v99, v99, v102
    v_add_f32 v93, v93, v99
    v_add_f32 v94, v94, v97
    v_add_f32 v100, v100, v103
    v_add_f32 v94, v94, v100
    v_add_f32 v116, v116, v119
    v_add_f32 v122, v122, v125
    v_add_f32 v116, v116, v122
    v_add_f32 v117, v117, v120
    v_add_f32 v123, v123, v126
    v_add_f32 v117, v117, v123
    v_add_f32 v118, v118, v121
    v_add_f32 v124, v124, v127
    v_add_f32 v118, v118, v124
    v_fmac_f32 v92, s56, v94
    v_mul_f32 v112, v92, v8
    v_fmac_f32 v93, s57, v94
    v_mul_f32 v113, v93, v9
    v_fmac_f32 v116, s56, v118
    v_mul_f32 v120, v116, v8
    v_fmac_f32 v117, s57, v118
    v_mul_f32 v121, v117, v9
    v_cvt_pk_bf16_f32 v113, v112, v113
    v_lshlrev_b32 v112, 16, v113
    v_and_b32 v113, 0xffff0000, v113
    v_cvt_pk_bf16_f32 v121, v120, v121
    v_lshlrev_b32 v120, 16, v121
    v_and_b32 v121, 0xffff0000, v121
    v_mul_f32 v114, 0xbfb8aa3b, v112
    v_mul_f32 v115, 0xbfb8aa3b, v113
    v_exp_f32 v114, v114
    v_exp_f32 v115, v115
    v_add_f32 v114, 1.0, v114
    v_add_f32 v115, 1.0, v115
    v_rcp_f32 v114, v114
    v_rcp_f32 v115, v115
    v_mul_f32 v114, v114, v112
    v_mul_f32 v115, v115, v113
    v_cvt_pk_bf16_f32 v115, v114, v115
    v_lshlrev_b32 v114, 16, v115
    v_and_b32 v115, 0xffff0000, v115
    v_mul_f32 v114, v114, v120
    v_mul_f32 v115, v115, v121
    v_cvt_pk_bf16_f32 v114, v114, v115
    ds_write_b16 v6, v114
    ds_write_b16_d16_hi v6, v114 offset:128
    ds_read_b128 v[92:95], v7 offset:0
    ds_read_b128 v[96:99], v7 offset:64
    v_mov_b32 v101, s34
    v_mov_b32 v103, s34
    s_waitcnt vmcnt(0)
    ds_read_b64_tr_b16 v[28:29], v14 offset:4096
    ds_read_b64_tr_b16 v[30:31], v14 offset:4608
    ds_read_b64_tr_b16 v[32:33], v15 offset:4096
    ds_read_b64_tr_b16 v[34:35], v15 offset:4608
    ds_read_b64_tr_b16 v[36:37], v16 offset:4096
    ds_read_b64_tr_b16 v[38:39], v16 offset:4608
    ds_read_b64_tr_b16 v[40:41], v17 offset:4096
    ds_read_b64_tr_b16 v[42:43], v17 offset:4608
    ds_read_b64_tr_b16 v[44:45], v14 offset:8192
    ds_read_b64_tr_b16 v[46:47], v14 offset:8704
    ds_read_b64_tr_b16 v[48:49], v15 offset:8192
    ds_read_b64_tr_b16 v[50:51], v15 offset:8704
    ds_read_b64_tr_b16 v[52:53], v16 offset:8192
    ds_read_b64_tr_b16 v[54:55], v16 offset:8704
    ds_read_b64_tr_b16 v[56:57], v17 offset:8192
    ds_read_b64_tr_b16 v[58:59], v17 offset:8704
    s_waitcnt lgkmcnt(0)
    v_mfma_f32_16x16x32_bf16 v[112:115], v[92:95], v[28:31], 0
    v_mfma_f32_16x16x32_bf16 v[116:119], v[92:95], v[32:35], 0
    v_mfma_f32_16x16x32_bf16 v[120:123], v[92:95], v[36:39], 0
    v_mfma_f32_16x16x32_bf16 v[124:127], v[92:95], v[40:43], 0
    v_mfma_f32_16x16x32_bf16 v[112:115], v[96:99], v[44:47], v[112:115]
    v_mfma_f32_16x16x32_bf16 v[116:119], v[96:99], v[48:51], v[116:119]
    v_mfma_f32_16x16x32_bf16 v[120:123], v[96:99], v[52:55], v[120:123]
    v_mfma_f32_16x16x32_bf16 v[124:127], v[96:99], v[56:59], v[124:127]
    s_nop 5
    v_cndmask_b32 v100, v112, v116, s[72:73]
    v_cndmask_b32 v100, v100, v120, s[74:75]
    v_cndmask_b32 v100, v100, v124, s[76:77]
    v_cndmask_b32 v102, v113, v117, s[72:73]
    v_cndmask_b32 v102, v102, v121, s[74:75]
    v_cndmask_b32 v102, v102, v125, s[76:77]
    buffer_store_dwordx4 v[100:103], v13, s[28:31], s37 offen sc1
    s_sub_u32 s36, s3, 4
    s_cmp_ge_u32 s36, 2
    s_cbranch_scc1 Laux_end
    s_add_u32 s37, s37, 4096
    ds_read_b64_tr_b16 v[60:61], v14 offset:12288
    ds_read_b64_tr_b16 v[62:63], v14 offset:12800
    ds_read_b64_tr_b16 v[64:65], v15 offset:12288
    ds_read_b64_tr_b16 v[66:67], v15 offset:12800
    ds_read_b64_tr_b16 v[68:69], v16 offset:12288
    ds_read_b64_tr_b16 v[70:71], v16 offset:12800
    ds_read_b64_tr_b16 v[72:73], v17 offset:12288
    ds_read_b64_tr_b16 v[74:75], v17 offset:12800
    ds_read_b64_tr_b16 v[76:77], v14 offset:0
    ds_read_b64_tr_b16 v[78:79], v14 offset:512
    ds_read_b64_tr_b16 v[80:81], v15 offset:0
    ds_read_b64_tr_b16 v[82:83], v15 offset:512
    ds_read_b64_tr_b16 v[84:85], v16 offset:0
    ds_read_b64_tr_b16 v[86:87], v16 offset:512
    ds_read_b64_tr_b16 v[88:89], v17 offset:0
    ds_read_b64_tr_b16 v[90:91], v17 offset:512
    s_waitcnt lgkmcnt(0)
    v_mfma_f32_16x16x32_bf16 v[112:115], v[92:95], v[60:63], 0
    v_mfma_f32_16x16x32_bf16 v[116:119], v[92:95], v[64:67], 0
    v_mfma_f32_16x16x32_bf16 v[120:123], v[92:95], v[68:71], 0
    v_mfma_f32_16x16x32_bf16 v[124:127], v[92:95], v[72:75], 0
    v_mfma_f32_16x16x32_bf16 v[112:115], v[96:99], v[76:79], v[112:115]
    v_mfma_f32_16x16x32_bf16 v[116:119], v[96:99], v[80:83], v[116:119]
    v_mfma_f32_16x16x32_bf16 v[120:123], v[96:99], v[84:87], v[120:123]
    v_mfma_f32_16x16x32_bf16 v[124:127], v[96:99], v[88:91], v[124:127]
    s_nop 5
    v_cndmask_b32 v100, v112, v116, s[72:73]
    v_cndmask_b32 v100, v100, v120, s[74:75]
    v_cndmask_b32 v100, v100, v124, s[76:77]
    v_cndmask_b32 v102, v113, v117, s[72:73]
    v_cndmask_b32 v102, v102, v121, s[74:75]
    v_cndmask_b32 v102, v102, v125, s[76:77]
    buffer_store_dwordx4 v[100:103], v13, s[28:31], s37 offen sc1
Laux_end:
    s_endpgm
Lmst:
    s_cmp_lg_u32 s3, 0
    s_cbranch_scc1 Lhelp_i
    s_waitcnt lgkmcnt(0)
    s_mov_b64 s[28:29], s[24:25]
    s_mov_b32 s30, 268435456
    s_mov_b32 s31, 0x20000
    s_load_dword s34, s[28:29], 0
    s_waitcnt lgkmcnt(0)
    s_add_u32 s34, s34, 0x9e3779b8
    s_or_b32 s34, s34, 1
    s_mov_b64 exec, 1
    s_lshl_b32 s36, s2, 2
    s_add_u32 s36, s36, 8323072
    v_mov_b32 v4, s34
    v_mov_b32 v5, s36
    buffer_store_dword v4, v5, s[28:31], 0 offen sc1
    s_mov_b64 exec, -1
    s_cmp_lg_u32 s32, 32
    s_cbranch_scc1 Lend
Lmst_bc:
    v_and_b32 v4, 31, v1
    v_lshlrev_b32 v4, 7, v4
    v_add_u32 v4, 8126464, v4
Lpt_15:
    s_sub_u32 s35, s35, 1
    s_cbranch_scc1 Lend
    s_sleep 8
    buffer_load_dwordx4 v[8:11], v4, s[28:31], 0 offen sc1
    s_waitcnt vmcnt(0)
    v_cmp_ne_u32 vcc, s34, v9
    v_cmp_ne_u32 s[36:37], s34, v11
    s_nop 0
    s_or_b64 s[36:37], s[36:37], vcc
    s_cbranch_scc1 Lpt_15
    v_mov_b32 v4, v8
    s_nop 1
    v_max_u32_dpp v4, v4, v4 row_ror:8 row_mask:0xf bank_mask:0xf
    s_nop 1
    v_max_u32_dpp v4, v4, v4 row_ror:4 row_mask:0xf bank_mask:0xf
    s_nop 1
    v_max_u32_dpp v4, v4, v4 row_ror:2 row_mask:0xf bank_mask:0xf
    s_nop 1
    v_max_u32_dpp v4, v4, v4 row_ror:1 row_mask:0xf bank_mask:0xf
    s_nop 0
    v_readlane_b32 s40, v4, 0
    v_readlane_b32 s36, v4, 16
    v_readlane_b32 s37, v4, 32
    v_readlane_b32 s38, v4, 48
    s_max_u32 s40, s40, s36
    s_max_u32 s37, s37, s38
    s_max_u32 s40, s40, s37
    v_cmp_eq_u32 vcc, s40, v8
    s_nop 1
    v_cndmask_b32 v4, v8, v10, vcc
    s_nop 1
    v_max_u32_dpp v4, v4, v4 row_ror:8 row_mask:0xf bank_mask:0xf
    s_nop 1
    v_max_u32_dpp v4, v4, v4 row_ror:4 row_mask:0xf bank_mask:0xf
    s_nop 1
    v_max_u32_dpp v4, v4, v4 row_ror:2 row_mask:0xf bank_mask:0xf
    s_nop 1
    v_max_u32_dpp v4, v4, v4 row_ror:1 row_mask:0xf bank_mask:0xf
    s_nop 0
    v_readlane_b32 s41, v4, 0
    v_readlane_b32 s36, v4, 16
    v_readlane_b32 s37, v4, 32
    v_readlane_b32 s38, v4, 48
    s_max_u32 s41, s41, s36
    s_max_u32 s37, s37, s38
    s_max_u32 s41, s41, s37
    v_mov_b32 v8, s40
    v_mov_b32 v9, s34
    v_mov_b32 v10, s41
    v_mov_b32 v11, s34
    s_mov_b32 s36, 8257536
    buffer_store_dwordx4 v[8:11], v13, s[28:31], s36 offen offset:0 sc1
    buffer_store_dwordx4 v[8:11], v13, s[28:31], s36 offen offset:1024 sc1
    buffer_store_dwordx4 v[8:11], v13, s[28:31], s36 offen offset:2048 sc1
    s_mov_b32 s36, 8323072
Lmaster:
    s_sub_u32 s35, s35, 1
    s_cbranch_scc1 Lend
    s_sleep 16
    buffer_load_dwordx4 v[4:7], v13, s[28:31], s36 offen sc1
    s_waitcnt vmcnt(0)
    v_xor_b32 v4, s34, v4
    v_xor_b32 v5, s34, v5
    v_xor_b32 v6, s34, v6
    v_xor_b32 v7, s34, v7
    v_or3_b32 v4, v4, v5, v6
    v_or_b32 v4, v4, v7
    v_cmp_ne_u32 vcc, 0, v4
    s_nop 0
    s_cbranch_vccnz Lmaster
    s_mov_b64 exec, 1
    buffer_store_dword v9, v4, s[28:31], 0 offen sc1
    s_endpgm
Lhelp_r:
    s_add_u32 s72, s32, 0
    s_mov_b32 s73, 5
    s_mov_b32 s37, 4
    s_branch Lhelp
Lhelp_i:
    s_cmp_eq_u32 s32, 32
    s_cbranch_scc1 Lend
    s_cmp_eq_u32 s27, 0
    s_cbranch_scc1 Lend
    s_sub_u32 s72, s32, 33
    s_mov_b32 s73, 3
    s_mov_b32 s37, 9
Lhelp:
    s_lshl_b32 s38, s26, 6
    v_add_u32 v4, s38, v1
    v_mul_u32_u24 v4, 1280, v4
    s_waitcnt lgkmcnt(0)
    s_mov_b64 s[68:69], s[18:19]
    s_mov_b32 s70, 2211840
    s_mov_b32 s71, 0x20000
Lhelp2:
    s_mul_i32 s38, s72, 9363
    s_lshr_b32 s38, s38, 16
    s_mul_i32 s39, s38, 7
    s_sub_u32 s39, s72, s39
    s_mul_i32 s39, s39, 327680
    s_lshl_b32 s38, s38, 7
    s_sub_u32 s39, s39, s38
    s_add_u32 s39, s39, 1152
    v_add_u32 v6, s39, v4
    buffer_load_dword v5, v6, s[68:71], 0 offen
    s_add_u32 s72, s72, s73
    s_sub_u32 s37, s37, 1
    s_cmp_lg_u32 s37, 0
    s_cbranch_scc1 Lhelp2
Lend:
    s_endpgm
.section .rodata,"a"
.p2align 6
.amdhsa_kernel recurrent_scan__sliding_local_dilated__moe_arch_mod__prompt_kernel
  .amdhsa_next_free_vgpr 256
  .amdhsa_next_free_sgpr 102
  .amdhsa_accum_offset 128
  .amdhsa_group_segment_fixed_size 0
  .amdhsa_kernarg_size 88
  .amdhsa_user_sgpr_count 2
  .amdhsa_user_sgpr_kernarg_segment_ptr 1
  .amdhsa_system_sgpr_workgroup_id_x 1
  .amdhsa_float_denorm_mode_32 3
.end_amdhsa_kernel
```

```asm
; @launch grid=(256,1,1) block=(512,1,1) lds=163840
.amdgcn_target "amdgcn-amd-amdhsa--gfx950"
.text
.globl recurrent_scan__sliding_local_dilated__moe_arch_mod__prompt_kernel
.p2align 8
.type recurrent_scan__sliding_local_dilated__moe_arch_mod__prompt_kernel,@function
recurrent_scan__sliding_local_dilated__moe_arch_mod__prompt_kernel:
    s_load_dwordx16 s[4:19], s[0:1], 0
    s_load_dwordx4 s[20:23], s[0:1], 64
    s_load_dwordx2 s[24:25], s[0:1], 80
    v_lshrrev_b32 v4, 6, v0
    v_and_b32 v1, 63, v0
    s_cmp_ge_u32 s2, 256
    s_cbranch_scc1 Lend
    v_readfirstlane_b32 s3, v4
    s_getpc_b64 s[36:37]
Lpc:
    s_and_b32 s38, s2, 0xf8
    v_add_u32 v5, s38, v4
    v_and_b32 v6, 1, v0
    v_lshl_add_u32 v5, v5, 1, v6
    v_lshlrev_b32 v5, 7, v5
    v_min_u32 v5, Lend-Lpc, v5
    v_mov_b32 v7, s37
    v_add_co_u32 v6, vcc, s36, v5
    s_nop 1
    v_addc_co_u32 v7, vcc, 0, v7, vcc
    global_load_dword v0, v[6:7], off
    v_lshrrev_b32 v2, 4, v1
    v_and_b32 v3, 15, v1
    v_lshlrev_b32 v12, 2, v1
    v_lshlrev_b32 v13, 4, v1
    s_mov_b32 s35, 2000000
    s_and_b32 s36, s2, 7
    s_lshr_b32 s37, s2, 3
    s_and_b32 s38, s36, 1
    s_lshr_b32 s36, s36, 1
    s_add_u32 s39, s38, 4
    s_and_b32 s26, s3, 3
    s_lshr_b32 s27, s3, 2
    s_cmp_lt_u32 s37, s39
    s_cbranch_scc1 Laux
    s_lshr_b32 s33, s36, 1
    s_and_b32 s36, s36, 1
    s_mul_i32 s36, s36, 55
    s_mul_i32 s38, s38, 28
    s_add_u32 s36, s36, s38
    s_add_u32 s36, s36, s37
    s_sub_u32 s36, s36, s39
    s_mul_i32 s32, s36, 13108
    s_lshr_b32 s32, s32, 16
    s_mul_i32 s37, s32, 5
    s_sub_u32 s36, s36, s37
    s_mul_i32 s33, s33, 5
    s_add_u32 s33, s33, s36
    s_add_u32 s42, s33, s32
    s_mul_i32 s36, s42, 13108
    s_lshr_b32 s36, s36, 16
    s_mul_i32 s36, s36, 5
    s_sub_u32 s42, s42, s36
    s_and_b32 s43, s2, 7
    s_lshr_b32 s43, 0, s43
    s_and_b32 s43, s43, 1
    s_cmp_lg_u32 s3, 0
    s_cbranch_scc1 Lcomp
Lloader:
    s_setprio 3
    v_lshrrev_b32 v5, 3, v1
    v_and_b32 v6, 7, v1
    v_and_b32 v8, 1, v2
    v_lshlrev_b32 v8, 1, v8
    v_xor_b32 v8, v8, v6
    s_lshl_b32 s39, s33, 7
    v_lshl_add_u32 v50, v8, 4, s39
    v_mov_b32 v7, 3840
    v_mad_u32_u24 v28, v5, v7, v50
    v_xor_b32 v29, 64, v28
    v_add_u32 v29, 29696, v29
    v_add_u32 v30, 59392, v28
    v_add_u32 v31, 59392, v29
    v_add_u32 v32, 122880, v28
    v_add_u32 v33, 122880, v29
    v_add_u32 v34, 182272, v28
    v_add_u32 v35, 182272, v29
    s_lshl_b32 s79, s42, 2
    s_lshr_b32 s79, 0x86420, s79
    s_and_b32 s79, s79, 15
    s_xor_b32 s79, s79, s43
    s_mul_i32 s68, s79, 245760
    s_lshl_b32 s78, s79, 7
    s_mul_i32 s38, s32, 96
    s_sub_u32 s38, s38, 16
    v_add_u32 v7, s38, v5
    v_xor_b32 v9, v6, v2
    v_lshlrev_b32 v9, 4, v9
    v_xor_b32 v10, 64, v9
    v_mov_b32 v11, 2052
    v_mov_b32 v8, 1280
    v_add_u32 v36, 0, v7
    v_med3_i32 v36, v36, 0, v11
    v_mad_u32_u24 v36, v36, v8, v9
    v_add_u32 v36, 4096, v36
    v_add_u32 v37, 8, v7
    v_med3_i32 v37, v37, 0, v11
    v_mad_u32_u24 v37, v37, v8, v10
    v_add_u32 v37, 3072, v37
    v_add_u32 v38, 16, v7
    v_med3_i32 v38, v38, 0, v11
    v_mad_u32_u24 v38, v38, v8, v9
    v_add_u32 v38, 2048, v38
    v_add_u32 v39, 24, v7
    v_med3_i32 v39, v39, 0, v11
    v_mad_u32_u24 v39, v39, v8, v10
    v_add_u32 v39, 1024, v39
    s_waitcnt lgkmcnt(0)
    s_mov_b64 s[48:49], s[6:7]
    s_mov_b32 s50, 2457600
    s_mov_b32 s51, 0x20000
    s_add_u32 s52, s6, 1280
    s_addc_u32 s53, s7, 0
    s_mov_b32 s54, 2456320
    s_mov_b32 s55, 0x20000
    s_add_u32 s56, s6, 2560
    s_addc_u32 s57, s7, 0
    s_mov_b32 s58, 2455040
    s_mov_b32 s59, 0x20000
    s_mov_b32 m0, 0
    v_add_u32 v40, 32, v7
    v_med3_i32 v40, v40, 0, v11
    buffer_load_dwordx4 v28, s[48:51], s68 offen lds
    v_mad_u32_u24 v40, v40, v8, v9
    buffer_load_dwordx4 v29, s[48:51], s68 offen offset:1024 lds
    v_add_u32 v40, 4096, v40
    v_add_u32 v41, 40, v7
    buffer_load_dwordx4 v30, s[48:51], s68 offen offset:2048 lds
    v_med3_i32 v41, v41, 0, v11
    buffer_load_dwordx4 v31, s[48:51], s68 offen offset:3072 lds
    v_mad_u32_u24 v41, v41, v8, v10
    s_mov_b32 m0, 8192
    v_add_u32 v41, 3072, v41
    v_add_u32 v42, 48, v7
    buffer_load_dwordx4 v28, s[52:55], s68 offen lds
    v_med3_i32 v42, v42, 0, v11
    buffer_load_dwordx4 v29, s[52:55], s68 offen offset:1024 lds
    v_mad_u32_u24 v42, v42, v8, v9
    buffer_load_dwordx4 v30, s[52:55], s68 offen offset:2048 lds
    v_add_u32 v42, 2048, v42
    v_add_u32 v43, 56, v7
    buffer_load_dwordx4 v31, s[52:55], s68 offen offset:3072 lds
    v_med3_i32 v43, v43, 0, v11
    s_mov_b32 m0, 16384
    v_mad_u32_u24 v43, v43, v8, v10
    v_add_u32 v43, 1024, v43
    buffer_load_dwordx4 v28, s[56:59], s68 offen lds
    v_add_u32 v44, 64, v7
    buffer_load_dwordx4 v29, s[56:59], s68 offen offset:1024 lds
    v_med3_i32 v44, v44, 0, v11
    buffer_load_dwordx4 v30, s[56:59], s68 offen offset:2048 lds
    v_mad_u32_u24 v44, v44, v8, v9
    v_add_u32 v44, 4096, v44
    buffer_load_dwordx4 v31, s[56:59], s68 offen offset:3072 lds
    v_add_u32 v45, 72, v7
    s_mov_b32 m0, 4096
    v_med3_i32 v45, v45, 0, v11
    buffer_load_dwordx4 v32, s[48:51], s68 offen lds
    v_mad_u32_u24 v45, v45, v8, v10
    v_add_u32 v45, 3072, v45
    buffer_load_dwordx4 v33, s[48:51], s68 offen offset:1024 lds
    v_add_u32 v46, 80, v7
    buffer_load_dwordx4 v34, s[48:51], s68 offen offset:2048 lds
    v_med3_i32 v46, v46, 0, v11
    buffer_load_dwordx4 v35, s[48:51], s68 offen offset:3072 lds
    v_mad_u32_u24 v46, v46, v8, v9
    v_add_u32 v46, 2048, v46
    s_mov_b32 m0, 12288
    v_add_u32 v47, 88, v7
    buffer_load_dwordx4 v32, s[52:55], s68 offen lds
    v_med3_i32 v47, v47, 0, v11
    v_mad_u32_u24 v47, v47, v8, v10
    buffer_load_dwordx4 v33, s[52:55], s68 offen offset:1024 lds
    v_add_u32 v47, 1024, v47
    buffer_load_dwordx4 v34, s[52:55], s68 offen offset:2048 lds
    v_add_u32 v48, 96, v7
    buffer_load_dwordx4 v35, s[52:55], s68 offen offset:3072 lds
    v_med3_i32 v48, v48, 0, v11
    v_mad_u32_u24 v48, v48, v8, v9
    s_mov_b32 m0, 20480
    v_add_u32 v48, 4096, v48
    buffer_load_dwordx4 v32, s[56:59], s68 offen lds
    v_add_u32 v49, 104, v7
    buffer_load_dwordx4 v33, s[56:59], s68 offen offset:1024 lds
    v_med3_i32 v49, v49, 0, v11
    v_mad_u32_u24 v49, v49, v8, v10
    buffer_load_dwordx4 v34, s[56:59], s68 offen offset:2048 lds
    v_add_u32 v49, 3072, v49
    buffer_load_dwordx4 v35, s[56:59], s68 offen offset:3072 lds
    s_sub_u32 s44, s4, 4096
    s_subb_u32 s45, s5, 0
    s_mov_b32 s46, 2625536
    s_mov_b32 s47, 0x20000
    s_mov_b32 m0, 24576
    s_nop 0
    buffer_load_dwordx4 v36, s[44:47], s78 offen lds
    buffer_load_dwordx4 v37, s[44:47], s78 offen offset:1024 lds
    buffer_load_dwordx4 v38, s[44:47], s78 offen offset:2048 lds
    buffer_load_dwordx4 v39, s[44:47], s78 offen offset:3072 lds
    s_mov_b32 m0, 28672
    s_nop 0
    buffer_load_dwordx4 v40, s[44:47], s78 offen lds
    buffer_load_dwordx4 v41, s[44:47], s78 offen offset:1024 lds
    buffer_load_dwordx4 v42, s[44:47], s78 offen offset:2048 lds
    buffer_load_dwordx4 v43, s[44:47], s78 offen offset:3072 lds
    s_mov_b32 m0, 32768
    s_nop 0
    buffer_load_dwordx4 v44, s[44:47], s78 offen lds
    buffer_load_dwordx4 v45, s[44:47], s78 offen offset:1024 lds
    buffer_load_dwordx4 v46, s[44:47], s78 offen offset:2048 lds
    buffer_load_dwordx4 v47, s[44:47], s78 offen offset:3072 lds
    s_mov_b32 m0, 36864
    s_nop 0
    buffer_load_dwordx4 v48, s[44:47], s78 offen lds
    buffer_load_dwordx4 v49, s[44:47], s78 offen offset:1024 lds
    s_mov_b32 s80, 0x53864210
    s_mov_b32 s81, 0x97
    s_cmp_eq_u32 s42, 1
    s_cselect_b32 s80, 0x51086342, s80
    s_cselect_b32 s81, 0x97, s81
    s_cmp_eq_u32 s42, 2
    s_cselect_b32 s80, 0x31205864, s80
    s_cselect_b32 s81, 0x97, s81
    s_cmp_eq_u32 s42, 3
    s_cselect_b32 s80, 0x31472086, s80
    s_cselect_b32 s81, 0x95, s81
    s_cmp_eq_u32 s42, 4
    s_cselect_b32 s80, 0x31964208, s80
    s_cselect_b32 s81, 0x75, s81
    s_lshr_b64 s[80:81], s[80:81], 4
    s_and_b32 s79, s80, 15
    s_xor_b32 s79, s79, s43
    s_mov_b64 s[28:29], s[24:25]
    s_mov_b32 s30, 268435456
    s_mov_b32 s31, 0x20000
    s_load_dword s34, s[28:29], 0
    s_mov_b64 s[60:61], s[8:9]
    s_mov_b32 s62, 819200
    s_mov_b32 s63, 0x20000
    v_mov_b32 v51, 157984
    v_and_b32 v66, 7, v1
    v_max_u32 v66, 1, v66
    v_lshlrev_b32 v66, 2, v66
    v_add_u32 v66, 158016, v66
    s_mul_i32 s69, s79, 245760
    s_lshl_b32 s78, s79, 7
    s_mov_b32 m0, 63616
    s_nop 0
    buffer_load_dwordx4 v36, s[44:47], s78 offen lds
    buffer_load_dwordx4 v37, s[44:47], s78 offen offset:1024 lds
    buffer_load_dwordx4 v38, s[44:47], s78 offen offset:2048 lds
    buffer_load_dwordx4 v39, s[44:47], s78 offen offset:3072 lds
    s_mov_b32 m0, 39040
    s_nop 0
    buffer_load_dwordx4 v28, s[48:51], s69 offen lds
    buffer_load_dwordx4 v29, s[48:51], s69 offen offset:1024 lds
    buffer_load_dwordx4 v30, s[48:51], s69 offen offset:2048 lds
    buffer_load_dwordx4 v31, s[48:51], s69 offen offset:3072 lds
    s_mov_b32 m0, 67712
    s_nop 0
    buffer_load_dwordx4 v40, s[44:47], s78 offen lds
    buffer_load_dwordx4 v41, s[44:47], s78 offen offset:1024 lds
    buffer_load_dwordx4 v42, s[44:47], s78 offen offset:2048 lds
    buffer_load_dwordx4 v43, s[44:47], s78 offen offset:3072 lds
    s_mov_b32 m0, 47232
    s_nop 0
    buffer_load_dwordx4 v28, s[52:55], s69 offen lds
    buffer_load_dwordx4 v29, s[52:55], s69 offen offset:1024 lds
    buffer_load_dwordx4 v30, s[52:55], s69 offen offset:2048 lds
    buffer_load_dwordx4 v31, s[52:55], s69 offen offset:3072 lds
    s_mov_b32 m0, 71808
    s_nop 0
    buffer_load_dwordx4 v44, s[44:47], s78 offen lds
    buffer_load_dwordx4 v45, s[44:47], s78 offen offset:1024 lds
    buffer_load_dwordx4 v46, s[44:47], s78 offen offset:2048 lds
    buffer_load_dwordx4 v47, s[44:47], s78 offen offset:3072 lds
    s_mov_b32 m0, 55424
    s_nop 0
    buffer_load_dwordx4 v28, s[56:59], s69 offen lds
    buffer_load_dwordx4 v29, s[56:59], s69 offen offset:1024 lds
    buffer_load_dwordx4 v30, s[56:59], s69 offen offset:2048 lds
    buffer_load_dwordx4 v31, s[56:59], s69 offen offset:3072 lds
    s_mov_b32 m0, 75904
    s_nop 0
    buffer_load_dwordx4 v48, s[44:47], s78 offen lds
    s_waitcnt vmcnt(55)
    buffer_load_dwordx4 v49, s[44:47], s78 offen offset:1024 lds
    s_mov_b32 m0, 43136
    s_nop 0
    buffer_load_dwordx4 v32, s[48:51], s69 offen lds
    buffer_load_dwordx4 v33, s[48:51], s69 offen offset:1024 lds
    buffer_load_dwordx4 v34, s[48:51], s69 offen offset:2048 lds
    buffer_load_dwordx4 v35, s[48:51], s69 offen offset:3072 lds
    s_mov_b32 m0, 51328
    s_nop 0
    buffer_load_dwordx4 v32, s[52:55], s69 offen lds
    buffer_load_dwordx4 v33, s[52:55], s69 offen offset:1024 lds
    buffer_load_dwordx4 v34, s[52:55], s69 offen offset:2048 lds
    s_waitcnt vmcnt(55)
    buffer_load_dwordx4 v35, s[52:55], s69 offen offset:3072 lds
    s_mov_b32 m0, 59520
    s_nop 0
    buffer_load_dwordx4 v32, s[56:59], s69 offen lds
    buffer_load_dwordx4 v33, s[56:59], s69 offen offset:1024 lds
    buffer_load_dwordx4 v34, s[56:59], s69 offen offset:2048 lds
    buffer_load_dwordx4 v35, s[56:59], s69 offen offset:3072 lds
    s_waitcnt vmcnt(38) lgkmcnt(0)
    s_barrier
    s_add_u32 s34, s34, 0x9e3779b8
    s_or_b32 s34, s34, 1
    s_lshr_b64 s[80:81], s[80:81], 4
    s_and_b32 s79, s80, 15
    s_xor_b32 s79, s79, s43
    s_mul_i32 s70, s79, 245760
    s_lshl_b32 s78, s79, 7
    s_mov_b32 m0, 102656
    s_nop 0
    buffer_load_dwordx4 v36, s[44:47], s78 offen lds
    buffer_load_dwordx4 v37, s[44:47], s78 offen offset:1024 lds
    buffer_load_dwordx4 v38, s[44:47], s78 offen offset:2048 lds
    buffer_load_dwordx4 v39, s[44:47], s78 offen offset:3072 lds
    s_mov_b32 m0, 78080
    s_nop 0
    buffer_load_dwordx4 v28, s[48:51], s70 offen lds
    buffer_load_dwordx4 v29, s[48:51], s70 offen offset:1024 lds
    buffer_load_dwordx4 v30, s[48:51], s70 offen offset:2048 lds
    buffer_load_dwordx4 v31, s[48:51], s70 offen offset:3072 lds
    s_mov_b32 m0, 106752
    s_nop 0
    buffer_load_dwordx4 v40, s[44:47], s78 offen lds
    buffer_load_dwordx4 v41, s[44:47], s78 offen offset:1024 lds
    buffer_load_dwordx4 v42, s[44:47], s78 offen offset:2048 lds
    buffer_load_dwordx4 v43, s[44:47], s78 offen offset:3072 lds
    s_mov_b32 m0, 86272
    s_nop 0
    buffer_load_dwordx4 v28, s[52:55], s70 offen lds
    buffer_load_dwordx4 v29, s[52:55], s70 offen offset:1024 lds
    buffer_load_dwordx4 v30, s[52:55], s70 offen offset:2048 lds
    buffer_load_dwordx4 v31, s[52:55], s70 offen offset:3072 lds
    s_mov_b32 m0, 110848
    s_nop 0
    buffer_load_dwordx4 v44, s[44:47], s78 offen lds
    buffer_load_dwordx4 v45, s[44:47], s78 offen offset:1024 lds
    buffer_load_dwordx4 v46, s[44:47], s78 offen offset:2048 lds
    buffer_load_dwordx4 v47, s[44:47], s78 offen offset:3072 lds
    s_mov_b32 m0, 94464
    s_nop 0
    buffer_load_dwordx4 v28, s[56:59], s70 offen lds
    buffer_load_dwordx4 v29, s[56:59], s70 offen offset:1024 lds
    buffer_load_dwordx4 v30, s[56:59], s70 offen offset:2048 lds
    buffer_load_dwordx4 v31, s[56:59], s70 offen offset:3072 lds
    s_mov_b32 m0, 114944
    s_nop 0
    buffer_load_dwordx4 v48, s[44:47], s78 offen lds
    s_waitcnt vmcnt(55)
    buffer_load_dwordx4 v49, s[44:47], s78 offen offset:1024 lds
    s_mov_b32 m0, 82176
    s_nop 0
    buffer_load_dwordx4 v32, s[48:51], s70 offen lds
    buffer_load_dwordx4 v33, s[48:51], s70 offen offset:1024 lds
    buffer_load_dwordx4 v34, s[48:51], s70 offen offset:2048 lds
    buffer_load_dwordx4 v35, s[48:51], s70 offen offset:3072 lds
    s_mov_b32 m0, 90368
    s_nop 0
    buffer_load_dwordx4 v32, s[52:55], s70 offen lds
    buffer_load_dwordx4 v33, s[52:55], s70 offen offset:1024 lds
    buffer_load_dwordx4 v34, s[52:55], s70 offen offset:2048 lds
    s_waitcnt vmcnt(55)
    buffer_load_dwordx4 v35, s[52:55], s70 offen offset:3072 lds
    s_mov_b32 m0, 98560
    s_nop 0
    buffer_load_dwordx4 v32, s[56:59], s70 offen lds
    buffer_load_dwordx4 v33, s[56:59], s70 offen offset:1024 lds
    buffer_load_dwordx4 v34, s[56:59], s70 offen offset:2048 lds
    buffer_load_dwordx4 v35, s[56:59], s70 offen offset:3072 lds
    s_waitcnt vmcnt(38) lgkmcnt(0)
    s_barrier
    s_lshr_b64 s[80:81], s[80:81], 4
    s_and_b32 s79, s80, 15
    s_xor_b32 s79, s79, s43
    s_mul_i32 s71, s79, 245760
    s_lshl_b32 s78, s79, 7
    s_mov_b32 m0, 141696
    s_nop 0
    buffer_load_dwordx4 v36, s[44:47], s78 offen lds
    buffer_load_dwordx4 v37, s[44:47], s78 offen offset:1024 lds
    buffer_load_dwordx4 v38, s[44:47], s78 offen offset:2048 lds
    buffer_load_dwordx4 v39, s[44:47], s78 offen offset:3072 lds
    s_mov_b32 m0, 117120
    s_nop 0
    buffer_load_dwordx4 v28, s[48:51], s71 offen lds
    buffer_load_dwordx4 v29, s[48:51], s71 offen offset:1024 lds
    buffer_load_dwordx4 v30, s[48:51], s71 offen offset:2048 lds
    buffer_load_dwordx4 v31, s[48:51], s71 offen offset:3072 lds
    s_mov_b32 m0, 145792
    s_nop 0
    buffer_load_dwordx4 v40, s[44:47], s78 offen lds
    buffer_load_dwordx4 v41, s[44:47], s78 offen offset:1024 lds
    buffer_load_dwordx4 v42, s[44:47], s78 offen offset:2048 lds
    buffer_load_dwordx4 v43, s[44:47], s78 offen offset:3072 lds
    s_mov_b32 m0, 125312
    s_nop 0
    buffer_load_dwordx4 v28, s[52:55], s71 offen lds
    buffer_load_dwordx4 v29, s[52:55], s71 offen offset:1024 lds
    buffer_load_dwordx4 v30, s[52:55], s71 offen offset:2048 lds
    buffer_load_dwordx4 v31, s[52:55], s71 offen offset:3072 lds
    s_mov_b32 m0, 149888
    s_nop 0
    buffer_load_dwordx4 v44, s[44:47], s78 offen lds
    buffer_load_dwordx4 v45, s[44:47], s78 offen offset:1024 lds
    buffer_load_dwordx4 v46, s[44:47], s78 offen offset:2048 lds
    buffer_load_dwordx4 v47, s[44:47], s78 offen offset:3072 lds
    s_mov_b32 m0, 133504
    s_nop 0
    buffer_load_dwordx4 v28, s[56:59], s71 offen lds
    buffer_load_dwordx4 v29, s[56:59], s71 offen offset:1024 lds
    buffer_load_dwordx4 v30, s[56:59], s71 offen offset:2048 lds
    buffer_load_dwordx4 v31, s[56:59], s71 offen offset:3072 lds
    s_mov_b32 m0, 153984
    s_nop 0
    buffer_load_dwordx4 v48, s[44:47], s78 offen lds
    s_waitcnt vmcnt(55)
    buffer_load_dwordx4 v49, s[44:47], s78 offen offset:1024 lds
    s_mov_b32 m0, 121216
    s_nop 0
    buffer_load_dwordx4 v32, s[48:51], s71 offen lds
    buffer_load_dwordx4 v33, s[48:51], s71 offen offset:1024 lds
    buffer_load_dwordx4 v34, s[48:51], s71 offen offset:2048 lds
    buffer_load_dwordx4 v35, s[48:51], s71 offen offset:3072 lds
    s_mov_b32 m0, 129408
    s_nop 0
    buffer_load_dwordx4 v32, s[52:55], s71 offen lds
    buffer_load_dwordx4 v33, s[52:55], s71 offen offset:1024 lds
    buffer_load_dwordx4 v34, s[52:55], s71 offen offset:2048 lds
    s_waitcnt vmcnt(55)
    buffer_load_dwordx4 v35, s[52:55], s71 offen offset:3072 lds
    s_mov_b32 m0, 137600
    s_nop 0
    buffer_load_dwordx4 v32, s[56:59], s71 offen lds
    buffer_load_dwordx4 v33, s[56:59], s71 offen offset:1024 lds
    buffer_load_dwordx4 v34, s[56:59], s71 offen offset:2048 lds
    buffer_load_dwordx4 v35, s[56:59], s71 offen offset:3072 lds
    s_waitcnt vmcnt(38) lgkmcnt(0)
    s_barrier
    s_lshr_b64 s[80:81], s[80:81], 4
    s_and_b32 s79, s80, 15
    s_xor_b32 s79, s79, s43
    s_mul_i32 s72, s79, 245760
    s_lshl_b32 s78, s79, 7
    s_mov_b32 m0, 24576
    s_nop 0
    buffer_load_dwordx4 v36, s[44:47], s78 offen lds
    buffer_load_dwordx4 v37, s[44:47], s78 offen offset:1024 lds
    buffer_load_dwordx4 v38, s[44:47], s78 offen offset:2048 lds
    buffer_load_dwordx4 v39, s[44:47], s78 offen offset:3072 lds
    s_mov_b32 m0, 0
    s_nop 0
    buffer_load_dwordx4 v28, s[48:51], s72 offen lds
    buffer_load_dwordx4 v29, s[48:51], s72 offen offset:1024 lds
    buffer_load_dwordx4 v30, s[48:51], s72 offen offset:2048 lds
    buffer_load_dwordx4 v31, s[48:51], s72 offen offset:3072 lds
    s_mov_b32 m0, 28672
    s_nop 0
    buffer_load_dwordx4 v40, s[44:47], s78 offen lds
    buffer_load_dwordx4 v41, s[44:47], s78 offen offset:1024 lds
    buffer_load_dwordx4 v42, s[44:47], s78 offen offset:2048 lds
    buffer_load_dwordx4 v43, s[44:47], s78 offen offset:3072 lds
    s_mov_b32 m0, 8192
    s_nop 0
    buffer_load_dwordx4 v28, s[52:55], s72 offen lds
    buffer_load_dwordx4 v29, s[52:55], s72 offen offset:1024 lds
    buffer_load_dwordx4 v30, s[52:55], s72 offen offset:2048 lds
    buffer_load_dwordx4 v31, s[52:55], s72 offen offset:3072 lds
    s_mov_b32 m0, 32768
    s_nop 0
    buffer_load_dwordx4 v44, s[44:47], s78 offen lds
    buffer_load_dwordx4 v45, s[44:47], s78 offen offset:1024 lds
    buffer_load_dwordx4 v46, s[44:47], s78 offen offset:2048 lds
    buffer_load_dwordx4 v47, s[44:47], s78 offen offset:3072 lds
    s_mov_b32 m0, 16384
    s_nop 0
    buffer_load_dwordx4 v28, s[56:59], s72 offen lds
    buffer_load_dwordx4 v29, s[56:59], s72 offen offset:1024 lds
    buffer_load_dwordx4 v30, s[56:59], s72 offen offset:2048 lds
    buffer_load_dwordx4 v31, s[56:59], s72 offen offset:3072 lds
    s_mov_b32 m0, 36864
    s_nop 0
    buffer_load_dwordx4 v48, s[44:47], s78 offen lds
    s_waitcnt vmcnt(55)
    buffer_load_dwordx4 v49, s[44:47], s78 offen offset:1024 lds
    s_mov_b32 m0, 4096
    s_nop 0
    buffer_load_dwordx4 v32, s[48:51], s72 offen lds
    buffer_load_dwordx4 v33, s[48:51], s72 offen offset:1024 lds
    buffer_load_dwordx4 v34, s[48:51], s72 offen offset:2048 lds
    buffer_load_dwordx4 v35, s[48:51], s72 offen offset:3072 lds
    s_mov_b32 m0, 12288
    s_nop 0
    buffer_load_dwordx4 v32, s[52:55], s72 offen lds
    buffer_load_dwordx4 v33, s[52:55], s72 offen offset:1024 lds
    buffer_load_dwordx4 v34, s[52:55], s72 offen offset:2048 lds
    s_waitcnt vmcnt(55)
    buffer_load_dwordx4 v35, s[52:55], s72 offen offset:3072 lds
    s_mov_b32 m0, 20480
    s_nop 0
    buffer_load_dwordx4 v32, s[56:59], s72 offen lds
    buffer_load_dwordx4 v33, s[56:59], s72 offen offset:1024 lds
    buffer_load_dwordx4 v34, s[56:59], s72 offen offset:2048 lds
    buffer_load_dwordx4 v35, s[56:59], s72 offen offset:3072 lds
    s_waitcnt vmcnt(38) lgkmcnt(0)
    s_barrier
    s_lshr_b64 s[80:81], s[80:81], 4
    s_and_b32 s79, s80, 15
    s_xor_b32 s79, s79, s43
    s_mul_i32 s73, s79, 245760
    s_lshl_b32 s78, s79, 7
    s_mov_b32 m0, 63616
    s_nop 0
    buffer_load_dwordx4 v36, s[44:47], s78 offen lds
    buffer_load_dwordx4 v37, s[44:47], s78 offen offset:1024 lds
    buffer_load_dwordx4 v38, s[44:47], s78 offen offset:2048 lds
    buffer_load_dwordx4 v39, s[44:47], s78 offen offset:3072 lds
    s_mov_b32 m0, 39040
    s_nop 0
    buffer_load_dwordx4 v28, s[48:51], s73 offen lds
    buffer_load_dwordx4 v29, s[48:51], s73 offen offset:1024 lds
    buffer_load_dwordx4 v30, s[48:51], s73 offen offset:2048 lds
    buffer_load_dwordx4 v31, s[48:51], s73 offen offset:3072 lds
    s_mov_b32 m0, 67712
    s_nop 0
    buffer_load_dwordx4 v40, s[44:47], s78 offen lds
    buffer_load_dwordx4 v41, s[44:47], s78 offen offset:1024 lds
    buffer_load_dwordx4 v42, s[44:47], s78 offen offset:2048 lds
    buffer_load_dwordx4 v43, s[44:47], s78 offen offset:3072 lds
    s_mov_b32 m0, 47232
    s_nop 0
    buffer_load_dwordx4 v28, s[52:55], s73 offen lds
    buffer_load_dwordx4 v29, s[52:55], s73 offen offset:1024 lds
    buffer_load_dwordx4 v30, s[52:55], s73 offen offset:2048 lds
    buffer_load_dwordx4 v31, s[52:55], s73 offen offset:3072 lds
    s_mov_b32 m0, 71808
    s_nop 0
    buffer_load_dwordx4 v44, s[44:47], s78 offen lds
    buffer_load_dwordx4 v45, s[44:47], s78 offen offset:1024 lds
    buffer_load_dwordx4 v46, s[44:47], s78 offen offset:2048 lds
    buffer_load_dwordx4 v47, s[44:47], s78 offen offset:3072 lds
    s_mov_b32 m0, 55424
    s_nop 0
    buffer_load_dwordx4 v28, s[56:59], s73 offen lds
    buffer_load_dwordx4 v29, s[56:59], s73 offen offset:1024 lds
    buffer_load_dwordx4 v30, s[56:59], s73 offen offset:2048 lds
    buffer_load_dwordx4 v31, s[56:59], s73 offen offset:3072 lds
    s_mov_b32 m0, 75904
    s_nop 0
    buffer_load_dwordx4 v48, s[44:47], s78 offen lds
    s_waitcnt vmcnt(55)
    buffer_load_dwordx4 v49, s[44:47], s78 offen offset:1024 lds
    s_mov_b32 m0, 43136
    s_nop 0
    buffer_load_dwordx4 v32, s[48:51], s73 offen lds
    buffer_load_dwordx4 v33, s[48:51], s73 offen offset:1024 lds
    buffer_load_dwordx4 v34, s[48:51], s73 offen offset:2048 lds
    buffer_load_dwordx4 v35, s[48:51], s73 offen offset:3072 lds
    s_mov_b32 m0, 51328
    s_nop 0
    buffer_load_dwordx4 v32, s[52:55], s73 offen lds
    buffer_load_dwordx4 v33, s[52:55], s73 offen offset:1024 lds
    buffer_load_dwordx4 v34, s[52:55], s73 offen offset:2048 lds
    s_waitcnt vmcnt(55)
    buffer_load_dwordx4 v35, s[52:55], s73 offen offset:3072 lds
    s_mov_b32 m0, 59520
    s_nop 0
    buffer_load_dwordx4 v32, s[56:59], s73 offen lds
    buffer_load_dwordx4 v33, s[56:59], s73 offen offset:1024 lds
    buffer_load_dwordx4 v34, s[56:59], s73 offen offset:2048 lds
    buffer_load_dwordx4 v35, s[56:59], s73 offen offset:3072 lds
    s_waitcnt vmcnt(38) lgkmcnt(0)
    s_barrier
    s_lshr_b64 s[80:81], s[80:81], 4
    s_and_b32 s79, s80, 15
    s_xor_b32 s79, s79, s43
    s_mul_i32 s74, s79, 245760
    s_lshl_b32 s78, s79, 7
    s_mov_b32 m0, 102656
    s_nop 0
    buffer_load_dwordx4 v36, s[44:47], s78 offen lds
    buffer_load_dwordx4 v37, s[44:47], s78 offen offset:1024 lds
    buffer_load_dwordx4 v38, s[44:47], s78 offen offset:2048 lds
    buffer_load_dwordx4 v39, s[44:47], s78 offen offset:3072 lds
    s_mov_b32 m0, 78080
    s_nop 0
    buffer_load_dwordx4 v28, s[48:51], s74 offen lds
    buffer_load_dwordx4 v29, s[48:51], s74 offen offset:1024 lds
    buffer_load_dwordx4 v30, s[48:51], s74 offen offset:2048 lds
    buffer_load_dwordx4 v31, s[48:51], s74 offen offset:3072 lds
    s_mov_b32 m0, 106752
    s_nop 0
    buffer_load_dwordx4 v40, s[44:47], s78 offen lds
    buffer_load_dwordx4 v41, s[44:47], s78 offen offset:1024 lds
    buffer_load_dwordx4 v42, s[44:47], s78 offen offset:2048 lds
    buffer_load_dwordx4 v43, s[44:47], s78 offen offset:3072 lds
    s_mov_b32 m0, 86272
    s_nop 0
    buffer_load_dwordx4 v28, s[52:55], s74 offen lds
    buffer_load_dwordx4 v29, s[52:55], s74 offen offset:1024 lds
    buffer_load_dwordx4 v30, s[52:55], s74 offen offset:2048 lds
    buffer_load_dwordx4 v31, s[52:55], s74 offen offset:3072 lds
    s_mov_b32 m0, 110848
    s_nop 0
    buffer_load_dwordx4 v44, s[44:47], s78 offen lds
    buffer_load_dwordx4 v45, s[44:47], s78 offen offset:1024 lds
    buffer_load_dwordx4 v46, s[44:47], s78 offen offset:2048 lds
    buffer_load_dwordx4 v47, s[44:47], s78 offen offset:3072 lds
    s_mov_b32 m0, 82176
    s_nop 0
    buffer_load_dwordx4 v32, s[48:51], s74 offen lds
    buffer_load_dwordx4 v33, s[48:51], s74 offen offset:1024 lds
    buffer_load_dwordx4 v34, s[48:51], s74 offen offset:2048 lds
    buffer_load_dwordx4 v35, s[48:51], s74 offen offset:3072 lds
    s_mov_b32 m0, 114944
    s_nop 0
    buffer_load_dwordx4 v48, s[44:47], s78 offen lds
    s_waitcnt vmcnt(55)
    buffer_load_dwordx4 v49, s[44:47], s78 offen offset:1024 lds
    s_mov_b32 m0, 90368
    s_nop 0
    buffer_load_dwordx4 v32, s[52:55], s74 offen lds
    buffer_load_dwordx4 v33, s[52:55], s74 offen offset:1024 lds
    buffer_load_dwordx4 v34, s[52:55], s74 offen offset:2048 lds
    buffer_load_dwordx4 v35, s[52:55], s74 offen offset:3072 lds
    s_waitcnt vmcnt(30) lgkmcnt(0)
    s_barrier
    s_lshr_b64 s[80:81], s[80:81], 4
    s_and_b32 s79, s80, 15
    s_xor_b32 s79, s79, s43
    s_mul_i32 s75, s79, 245760
    s_lshl_b32 s78, s79, 7
    s_mov_b32 m0, 141696
    s_nop 0
    buffer_load_dwordx4 v36, s[44:47], s78 offen lds
    buffer_load_dwordx4 v37, s[44:47], s78 offen offset:1024 lds
    buffer_load_dwordx4 v38, s[44:47], s78 offen offset:2048 lds
    buffer_load_dwordx4 v39, s[44:47], s78 offen offset:3072 lds
    s_mov_b32 m0, 117120
    s_nop 0
    buffer_load_dwordx4 v28, s[48:51], s75 offen lds
    buffer_load_dwordx4 v29, s[48:51], s75 offen offset:1024 lds
    buffer_load_dwordx4 v30, s[48:51], s75 offen offset:2048 lds
    buffer_load_dwordx4 v31, s[48:51], s75 offen offset:3072 lds
    s_mov_b32 m0, 145792
    s_nop 0
    buffer_load_dwordx4 v40, s[44:47], s78 offen lds
    buffer_load_dwordx4 v41, s[44:47], s78 offen offset:1024 lds
    buffer_load_dwordx4 v42, s[44:47], s78 offen offset:2048 lds
    buffer_load_dwordx4 v43, s[44:47], s78 offen offset:3072 lds
    s_mov_b32 m0, 125312
    s_nop 0
    buffer_load_dwordx4 v28, s[52:55], s75 offen lds
    buffer_load_dwordx4 v29, s[52:55], s75 offen offset:1024 lds
    buffer_load_dwordx4 v30, s[52:55], s75 offen offset:2048 lds
    buffer_load_dwordx4 v31, s[52:55], s75 offen offset:3072 lds
    s_mov_b32 m0, 149888
    s_nop 0
    buffer_load_dwordx4 v44, s[44:47], s78 offen lds
    buffer_load_dwordx4 v45, s[44:47], s78 offen offset:1024 lds
    buffer_load_dwordx4 v46, s[44:47], s78 offen offset:2048 lds
    buffer_load_dwordx4 v47, s[44:47], s78 offen offset:3072 lds
    s_mov_b32 m0, 121216
    s_nop 0
    buffer_load_dwordx4 v32, s[48:51], s75 offen lds
    buffer_load_dwordx4 v33, s[48:51], s75 offen offset:1024 lds
    buffer_load_dwordx4 v34, s[48:51], s75 offen offset:2048 lds
    buffer_load_dwordx4 v35, s[48:51], s75 offen offset:3072 lds
    s_mov_b32 m0, 153984
    s_nop 0
    buffer_load_dwordx4 v48, s[44:47], s78 offen lds
    buffer_load_dwordx4 v49, s[44:47], s78 offen offset:1024 lds
    s_mov_b32 m0, 129408
    s_nop 0
    buffer_load_dwordx4 v32, s[52:55], s75 offen lds
    buffer_load_dwordx4 v33, s[52:55], s75 offen offset:1024 lds
    buffer_load_dwordx4 v34, s[52:55], s75 offen offset:2048 lds
    buffer_load_dwordx4 v35, s[52:55], s75 offen offset:3072 lds
    s_waitcnt vmcnt(30) lgkmcnt(0)
    s_barrier
    s_lshr_b64 s[80:81], s[80:81], 4
    s_and_b32 s79, s80, 15
    s_xor_b32 s79, s79, s43
    s_mul_i32 s76, s79, 245760
    s_lshl_b32 s78, s79, 7
    s_mov_b32 m0, 24576
    s_nop 0
    buffer_load_dwordx4 v36, s[44:47], s78 offen lds
    buffer_load_dwordx4 v37, s[44:47], s78 offen offset:1024 lds
    buffer_load_dwordx4 v38, s[44:47], s78 offen offset:2048 lds
    buffer_load_dwordx4 v39, s[44:47], s78 offen offset:3072 lds
    s_mov_b32 m0, 0
    s_nop 0
    buffer_load_dwordx4 v28, s[48:51], s76 offen lds
    buffer_load_dwordx4 v29, s[48:51], s76 offen offset:1024 lds
    buffer_load_dwordx4 v30, s[48:51], s76 offen offset:2048 lds
    buffer_load_dwordx4 v31, s[48:51], s76 offen offset:3072 lds
    s_mov_b32 m0, 28672
    s_nop 0
    buffer_load_dwordx4 v40, s[44:47], s78 offen lds
    buffer_load_dwordx4 v41, s[44:47], s78 offen offset:1024 lds
    buffer_load_dwordx4 v42, s[44:47], s78 offen offset:2048 lds
    buffer_load_dwordx4 v43, s[44:47], s78 offen offset:3072 lds
    s_mov_b32 m0, 8192
    s_nop 0
    buffer_load_dwordx4 v28, s[52:55], s76 offen lds
    buffer_load_dwordx4 v29, s[52:55], s76 offen offset:1024 lds
    buffer_load_dwordx4 v30, s[52:55], s76 offen offset:2048 lds
    buffer_load_dwordx4 v31, s[52:55], s76 offen offset:3072 lds
    s_mov_b32 m0, 32768
    s_nop 0
    buffer_load_dwordx4 v44, s[44:47], s78 offen lds
    buffer_load_dwordx4 v45, s[44:47], s78 offen offset:1024 lds
    buffer_load_dwordx4 v46, s[44:47], s78 offen offset:2048 lds
    buffer_load_dwordx4 v47, s[44:47], s78 offen offset:3072 lds
    s_mov_b32 m0, 4096
    s_nop 0
    buffer_load_dwordx4 v32, s[48:51], s76 offen lds
    buffer_load_dwordx4 v33, s[48:51], s76 offen offset:1024 lds
    buffer_load_dwordx4 v34, s[48:51], s76 offen offset:2048 lds
    buffer_load_dwordx4 v35, s[48:51], s76 offen offset:3072 lds
    s_mov_b32 m0, 36864
    s_nop 0
    buffer_load_dwordx4 v48, s[44:47], s78 offen lds
    buffer_load_dwordx4 v49, s[44:47], s78 offen offset:1024 lds
    s_mov_b32 m0, 12288
    s_nop 0
    buffer_load_dwordx4 v32, s[52:55], s76 offen lds
    buffer_load_dwordx4 v33, s[52:55], s76 offen offset:1024 lds
    buffer_load_dwordx4 v34, s[52:55], s76 offen offset:2048 lds
    buffer_load_dwordx4 v35, s[52:55], s76 offen offset:3072 lds
    s_waitcnt vmcnt(30) lgkmcnt(0)
    s_barrier
    s_lshr_b64 s[80:81], s[80:81], 4
    s_and_b32 s79, s80, 15
    s_xor_b32 s79, s79, s43
    s_mul_i32 s77, s79, 245760
    s_lshl_b32 s78, s79, 7
    s_mov_b32 m0, 63616
    s_nop 0
    buffer_load_dwordx4 v36, s[44:47], s78 offen lds
    buffer_load_dwordx4 v37, s[44:47], s78 offen offset:1024 lds
    buffer_load_dwordx4 v38, s[44:47], s78 offen offset:2048 lds
    buffer_load_dwordx4 v39, s[44:47], s78 offen offset:3072 lds
    s_mov_b32 m0, 39040
    s_nop 0
    buffer_load_dwordx4 v28, s[48:51], s77 offen lds
    buffer_load_dwordx4 v29, s[48:51], s77 offen offset:1024 lds
    buffer_load_dwordx4 v30, s[48:51], s77 offen offset:2048 lds
    buffer_load_dwordx4 v31, s[48:51], s77 offen offset:3072 lds
    s_mov_b32 m0, 67712
    s_nop 0
    buffer_load_dwordx4 v40, s[44:47], s78 offen lds
    buffer_load_dwordx4 v41, s[44:47], s78 offen offset:1024 lds
    buffer_load_dwordx4 v42, s[44:47], s78 offen offset:2048 lds
    buffer_load_dwordx4 v43, s[44:47], s78 offen offset:3072 lds
    s_mov_b32 m0, 47232
    s_nop 0
    buffer_load_dwordx4 v28, s[52:55], s77 offen lds
    buffer_load_dwordx4 v29, s[52:55], s77 offen offset:1024 lds
    buffer_load_dwordx4 v30, s[52:55], s77 offen offset:2048 lds
    buffer_load_dwordx4 v31, s[52:55], s77 offen offset:3072 lds
    s_mov_b32 m0, 71808
    s_nop 0
    buffer_load_dwordx4 v44, s[44:47], s78 offen lds
    buffer_load_dwordx4 v45, s[44:47], s78 offen offset:1024 lds
    buffer_load_dwordx4 v46, s[44:47], s78 offen offset:2048 lds
    buffer_load_dwordx4 v47, s[44:47], s78 offen offset:3072 lds
    s_mov_b32 m0, 43136
    s_nop 0
    buffer_load_dwordx4 v32, s[48:51], s77 offen lds
    buffer_load_dwordx4 v33, s[48:51], s77 offen offset:1024 lds
    buffer_load_dwordx4 v34, s[48:51], s77 offen offset:2048 lds
    buffer_load_dwordx4 v35, s[48:51], s77 offen offset:3072 lds
    s_mov_b32 m0, 75904
    s_nop 0
    buffer_load_dwordx4 v48, s[44:47], s78 offen lds
    buffer_load_dwordx4 v49, s[44:47], s78 offen offset:1024 lds
    s_mov_b32 m0, 51328
    s_nop 0
    buffer_load_dwordx4 v32, s[52:55], s77 offen lds
    buffer_load_dwordx4 v33, s[52:55], s77 offen offset:1024 lds
    buffer_load_dwordx4 v34, s[52:55], s77 offen offset:2048 lds
    buffer_load_dwordx4 v35, s[52:55], s77 offen offset:3072 lds
    s_waitcnt vmcnt(30) lgkmcnt(0)
    s_barrier
    s_lshr_b64 s[80:81], s[80:81], 4
    s_and_b32 s79, s80, 15
    s_xor_b32 s79, s79, s43
    s_mov_b32 m0, 94464
    s_nop 0
    buffer_load_dwordx4 v28, s[56:59], s74 offen lds
    buffer_load_dwordx4 v29, s[56:59], s74 offen offset:1024 lds
    buffer_load_dwordx4 v30, s[56:59], s74 offen offset:2048 lds
    buffer_load_dwordx4 v31, s[56:59], s74 offen offset:3072 lds
    s_mov_b32 m0, 98560
    s_nop 0
    buffer_load_dwordx4 v32, s[56:59], s74 offen lds
    buffer_load_dwordx4 v33, s[56:59], s74 offen offset:1024 lds
    buffer_load_dwordx4 v34, s[56:59], s74 offen offset:2048 lds
    buffer_load_dwordx4 v35, s[56:59], s74 offen offset:3072 lds
    s_mov_b32 m0, 133504
    s_nop 0
    buffer_load_dwordx4 v28, s[56:59], s75 offen lds
    buffer_load_dwordx4 v29, s[56:59], s75 offen offset:1024 lds
    buffer_load_dwordx4 v30, s[56:59], s75 offen offset:2048 lds
    buffer_load_dwordx4 v31, s[56:59], s75 offen offset:3072 lds
    s_waitcnt vmcnt(12) lgkmcnt(0)
    s_barrier
    s_mov_b32 m0, 137600
    s_nop 0
    buffer_load_dwordx4 v32, s[56:59], s75 offen lds
    buffer_load_dwordx4 v33, s[56:59], s75 offen offset:1024 lds
    buffer_load_dwordx4 v34, s[56:59], s75 offen offset:2048 lds
    buffer_load_dwordx4 v35, s[56:59], s75 offen offset:3072 lds
    s_mov_b32 m0, 16384
    s_nop 0
    buffer_load_dwordx4 v28, s[56:59], s76 offen lds
    buffer_load_dwordx4 v29, s[56:59], s76 offen offset:1024 lds
    buffer_load_dwordx4 v30, s[56:59], s76 offen offset:2048 lds
    buffer_load_dwordx4 v31, s[56:59], s76 offen offset:3072 lds
    s_mov_b32 m0, 20480
    s_nop 0
    buffer_load_dwordx4 v32, s[56:59], s76 offen lds
    buffer_load_dwordx4 v33, s[56:59], s76 offen offset:1024 lds
    buffer_load_dwordx4 v34, s[56:59], s76 offen offset:2048 lds
    buffer_load_dwordx4 v35, s[56:59], s76 offen offset:3072 lds
    s_mov_b32 m0, 55424
    s_nop 0
    buffer_load_dwordx4 v28, s[56:59], s77 offen lds
    buffer_load_dwordx4 v29, s[56:59], s77 offen offset:1024 lds
    buffer_load_dwordx4 v30, s[56:59], s77 offen offset:2048 lds
    buffer_load_dwordx4 v31, s[56:59], s77 offen offset:3072 lds
    s_mov_b32 m0, 59520
    s_nop 0
    buffer_load_dwordx4 v32, s[56:59], s77 offen lds
    buffer_load_dwordx4 v33, s[56:59], s77 offen offset:1024 lds
    buffer_load_dwordx4 v34, s[56:59], s77 offen offset:2048 lds
    buffer_load_dwordx4 v35, s[56:59], s77 offen offset:3072 lds
    s_mov_b32 s10, 20480
    v_lshrrev_b32 v52, 5, v1
    v_lshlrev_b32 v52, 3, v52
    v_add_u32 v53, 2, v52
    v_add_u32 v54, 4, v52
    v_add_u32 v55, 6, v52
    v_add_u32 v56, 16, v52
    v_add_u32 v57, 18, v52
    v_add_u32 v58, 20, v52
    v_add_u32 v59, 22, v52
    v_and_b32 v7, 3, v5
    v_mul_u32_u24 v7, 1280, v7
    v_add_u32 v60, v7, v50
    v_xor_b32 v61, 64, v60
    v_add_u32 v61, 4096, v61
    v_add_u32 v62, 8192, v60
    v_add_u32 v63, 8192, v61
    s_mov_b32 s5, 0xbfe10856
    s_mov_b32 s6, 0xaff80255
    s_mov_b32 s7, 0xabfe4015
    s_mov_b32 s8, 0xaa7fd005
    s_mov_b32 s9, 0x6adfb401
    s_cmp_eq_u32 s42, 1
    s_cselect_b32 s5, 0xabfe4015, s5
    s_cselect_b32 s6, 0xaa7fd005, s6
    s_cselect_b32 s7, 0x6adfb401, s7
    s_cselect_b32 s8, 0xbfe10856, s8
    s_cselect_b32 s9, 0xaff80255, s9
    s_cmp_eq_u32 s42, 2
    s_cselect_b32 s5, 0x6adfb401, s5
    s_cselect_b32 s6, 0xbfe10856, s6
    s_cselect_b32 s7, 0xaff80255, s7
    s_cselect_b32 s8, 0xabfe4015, s8
    s_cselect_b32 s9, 0xaa7fd005, s9
    s_cmp_eq_u32 s42, 3
    s_cselect_b32 s5, 0xaff80255, s5
    s_cselect_b32 s6, 0xabfe4015, s6
    s_cselect_b32 s7, 0xaa7fd005, s7
    s_cselect_b32 s8, 0x6adfb401, s8
    s_cselect_b32 s9, 0xbfe10856, s9
    s_cmp_eq_u32 s42, 4
    s_cselect_b32 s5, 0xaa7fd005, s5
    s_cselect_b32 s6, 0x6adfb401, s6
    s_cselect_b32 s7, 0xbfe10856, s7
    s_cselect_b32 s8, 0xaff80255, s8
    s_cselect_b32 s9, 0xabfe4015, s9
    s_mul_i32 s4, s42, 163840
    s_mov_b32 m0, 0
    v_bfe_u32 v64, s5, v52, 2
    v_mad_u32_u24 v64, v64, s10, v60
    buffer_load_dwordx4 v64, s[60:63], s4 offen lds
    v_bfe_u32 v65, s5, v53, 2
    v_mad_u32_u24 v65, v65, s10, v61
    buffer_load_dwordx4 v65, s[60:63], s4 offen offset:1024 lds
    v_bfe_u32 v64, s5, v54, 2
    v_mad_u32_u24 v64, v64, s10, v62
    buffer_load_dwordx4 v64, s[60:63], s4 offen offset:2048 lds
    v_bfe_u32 v65, s5, v55, 2
    v_mad_u32_u24 v65, v65, s10, v63
    buffer_load_dwordx4 v65, s[60:63], s4 offen offset:3072 lds
    s_mov_b32 m0, 4096
    v_bfe_u32 v64, s5, v56, 2
    v_mad_u32_u24 v64, v64, s10, v60
    buffer_load_dwordx4 v64, s[60:63], s4 offen lds
    v_bfe_u32 v65, s5, v57, 2
    v_mad_u32_u24 v65, v65, s10, v61
    buffer_load_dwordx4 v65, s[60:63], s4 offen offset:1024 lds
    v_bfe_u32 v64, s5, v58, 2
    v_mad_u32_u24 v64, v64, s10, v62
    buffer_load_dwordx4 v64, s[60:63], s4 offen offset:2048 lds
    v_bfe_u32 v65, s5, v59, 2
    v_mad_u32_u24 v65, v65, s10, v63
    buffer_load_dwordx4 v65, s[60:63], s4 offen offset:3072 lds
    s_add_u32 s4, s4, 81920
    s_cmp_eq_u32 s4, 819200
    s_cselect_b32 s4, 0, s4
    s_mov_b32 m0, 8192
    v_bfe_u32 v64, s6, v52, 2
    v_mad_u32_u24 v64, v64, s10, v60
    buffer_load_dwordx4 v64, s[60:63], s4 offen lds
    v_bfe_u32 v65, s6, v53, 2
    v_mad_u32_u24 v65, v65, s10, v61
    buffer_load_dwordx4 v65, s[60:63], s4 offen offset:1024 lds
    v_bfe_u32 v64, s6, v54, 2
    v_mad_u32_u24 v64, v64, s10, v62
    buffer_load_dwordx4 v64, s[60:63], s4 offen offset:2048 lds
    v_bfe_u32 v65, s6, v55, 2
    v_mad_u32_u24 v65, v65, s10, v63
    buffer_load_dwordx4 v65, s[60:63], s4 offen offset:3072 lds
    s_mov_b32 m0, 12288
    v_bfe_u32 v64, s6, v56, 2
    v_mad_u32_u24 v64, v64, s10, v60
    buffer_load_dwordx4 v64, s[60:63], s4 offen lds
    v_bfe_u32 v65, s6, v57, 2
    v_mad_u32_u24 v65, v65, s10, v61
    buffer_load_dwordx4 v65, s[60:63], s4 offen offset:1024 lds
    v_bfe_u32 v64, s6, v58, 2
    v_mad_u32_u24 v64, v64, s10, v62
    buffer_load_dwordx4 v64, s[60:63], s4 offen offset:2048 lds
    v_bfe_u32 v65, s6, v59, 2
    v_mad_u32_u24 v65, v65, s10, v63
    buffer_load_dwordx4 v65, s[60:63], s4 offen offset:3072 lds
    s_add_u32 s4, s4, 81920
    s_cmp_eq_u32 s4, 819200
    s_cselect_b32 s4, 0, s4
    s_waitcnt vmcnt(16)
    v_mov_b32 v5, 157980
    v_mov_b32 v6, 1
    s_mov_b64 exec, 1
    ds_add_u32 v5, v6
    s_mov_b64 exec, -1
    v_mov_b32 v5, 157972
    v_mov_b32 v6, 1
    s_mov_b64 exec, 1
    ds_add_u32 v5, v6
    s_mov_b64 exec, -1
    s_mov_b32 m0, 24576
    v_bfe_u32 v64, s7, v52, 2
    v_mad_u32_u24 v64, v64, s10, v60
    buffer_load_dwordx4 v64, s[60:63], s4 offen lds
    v_bfe_u32 v65, s7, v53, 2
    v_mad_u32_u24 v65, v65, s10, v61
    buffer_load_dwordx4 v65, s[60:63], s4 offen offset:1024 lds
    v_bfe_u32 v64, s7, v54, 2
    v_mad_u32_u24 v64, v64, s10, v62
    buffer_load_dwordx4 v64, s[60:63], s4 offen offset:2048 lds
    v_bfe_u32 v65, s7, v55, 2
    v_mad_u32_u24 v65, v65, s10, v63
    buffer_load_dwordx4 v65, s[60:63], s4 offen offset:3072 lds
    s_mov_b32 m0, 28672
    v_bfe_u32 v64, s7, v56, 2
    v_mad_u32_u24 v64, v64, s10, v60
    buffer_load_dwordx4 v64, s[60:63], s4 offen lds
    v_bfe_u32 v65, s7, v57, 2
    v_mad_u32_u24 v65, v65, s10, v61
    buffer_load_dwordx4 v65, s[60:63], s4 offen offset:1024 lds
    v_bfe_u32 v64, s7, v58, 2
    v_mad_u32_u24 v64, v64, s10, v62
    buffer_load_dwordx4 v64, s[60:63], s4 offen offset:2048 lds
    v_bfe_u32 v65, s7, v59, 2
    v_mad_u32_u24 v65, v65, s10, v63
    buffer_load_dwordx4 v65, s[60:63], s4 offen offset:3072 lds
    s_add_u32 s4, s4, 81920
    s_cmp_eq_u32 s4, 819200
    s_cselect_b32 s4, 0, s4
    s_mov_b32 m0, 123136
    v_bfe_u32 v64, s8, v52, 2
    v_mad_u32_u24 v64, v64, s10, v60
    buffer_load_dwordx4 v64, s[60:63], s4 offen lds
    v_bfe_u32 v65, s8, v53, 2
    v_mad_u32_u24 v65, v65, s10, v61
    buffer_load_dwordx4 v65, s[60:63], s4 offen offset:1024 lds
    v_bfe_u32 v64, s8, v54, 2
    v_mad_u32_u24 v64, v64, s10, v62
    buffer_load_dwordx4 v64, s[60:63], s4 offen offset:2048 lds
    v_bfe_u32 v65, s8, v55, 2
    v_mad_u32_u24 v65, v65, s10, v63
    buffer_load_dwordx4 v65, s[60:63], s4 offen offset:3072 lds
    s_mov_b32 m0, 127232
    v_bfe_u32 v64, s8, v56, 2
    v_mad_u32_u24 v64, v64, s10, v60
    buffer_load_dwordx4 v64, s[60:63], s4 offen lds
    v_bfe_u32 v65, s8, v57, 2
    v_mad_u32_u24 v65, v65, s10, v61
    buffer_load_dwordx4 v65, s[60:63], s4 offen offset:1024 lds
    v_bfe_u32 v64, s8, v58, 2
    v_mad_u32_u24 v64, v64, s10, v62
    buffer_load_dwordx4 v64, s[60:63], s4 offen offset:2048 lds
    v_bfe_u32 v65, s8, v59, 2
    v_mad_u32_u24 v65, v65, s10, v63
    buffer_load_dwordx4 v65, s[60:63], s4 offen offset:3072 lds
    s_add_u32 s4, s4, 81920
    s_cmp_eq_u32 s4, 819200
    s_cselect_b32 s4, 0, s4
    s_mov_b32 m0, 80000
    v_bfe_u32 v64, s9, v52, 2
    v_mad_u32_u24 v64, v64, s10, v60
    buffer_load_dwordx4 v64, s[60:63], s4 offen lds
    v_bfe_u32 v65, s9, v53, 2
    v_mad_u32_u24 v65, v65, s10, v61
    buffer_load_dwordx4 v65, s[60:63], s4 offen offset:1024 lds
    v_bfe_u32 v64, s9, v54, 2
    v_mad_u32_u24 v64, v64, s10, v62
    buffer_load_dwordx4 v64, s[60:63], s4 offen offset:2048 lds
    v_bfe_u32 v65, s9, v55, 2
    v_mad_u32_u24 v65, v65, s10, v63
    buffer_load_dwordx4 v65, s[60:63], s4 offen offset:3072 lds
    s_mov_b32 m0, 84096
    v_bfe_u32 v64, s9, v56, 2
    v_mad_u32_u24 v64, v64, s10, v60
    buffer_load_dwordx4 v64, s[60:63], s4 offen lds
    v_bfe_u32 v65, s9, v57, 2
    v_mad_u32_u24 v65, v65, s10, v61
    buffer_load_dwordx4 v65, s[60:63], s4 offen offset:1024 lds
    v_bfe_u32 v64, s9, v58, 2
    v_mad_u32_u24 v64, v64, s10, v62
    buffer_load_dwordx4 v64, s[60:63], s4 offen offset:2048 lds
    v_bfe_u32 v65, s9, v59, 2
    v_mad_u32_u24 v65, v65, s10, v63
    buffer_load_dwordx4 v65, s[60:63], s4 offen offset:3072 lds
    s_add_u32 s4, s4, 81920
    s_cmp_eq_u32 s4, 819200
    s_cselect_b32 s4, 0, s4
    s_waitcnt vmcnt(0)
    v_mov_b32 v7, 157980
    v_mov_b32 v6, 1
    s_mov_b64 exec, 1
    ds_add_u32 v7, v6
    s_mov_b64 exec, -1
Lcw_7:
    s_sub_u32 s35, s35, 1
    s_cbranch_scc1 Lend
    ds_read_b32 v6, v5
    s_waitcnt lgkmcnt(0)
    v_readfirstlane_b32 s38, v6
    s_nop 0
    s_cmp_lt_u32 s38, 8
    s_cbranch_scc1 Lcw_7
    s_lshl_b32 s36, s32, 7
    s_add_u32 s36, s36, 8257536
    v_mov_b32 v69, s36
    buffer_load_dwordx4 v[70:73], v69, s[28:31], 0 offen sc1
    v_mov_b32 v5, 157976
Lcw_8:
    s_sub_u32 s35, s35, 1
    s_cbranch_scc1 Lend
    ds_read_b32 v6, v5
    s_waitcnt lgkmcnt(0)
    v_readfirstlane_b32 s38, v6
    s_nop 0
    s_cmp_lt_u32 s38, 7
    s_cbranch_scc1 Lcw_8
    s_mov_b32 m0, 32768
    v_bfe_u32 v64, s5, v52, 2
    v_mad_u32_u24 v64, v64, s10, v60
    buffer_load_dwordx4 v64, s[60:63], s4 offen lds
    v_bfe_u32 v65, s5, v53, 2
    v_mad_u32_u24 v65, v65, s10, v61
    buffer_load_dwordx4 v65, s[60:63], s4 offen offset:1024 lds
    v_bfe_u32 v64, s5, v54, 2
    v_mad_u32_u24 v64, v64, s10, v62
    buffer_load_dwordx4 v64, s[60:63], s4 offen offset:2048 lds
    v_bfe_u32 v65, s5, v55, 2
    v_mad_u32_u24 v65, v65, s10, v63
    buffer_load_dwordx4 v65, s[60:63], s4 offen offset:3072 lds
    s_mov_b32 m0, 36864
    v_bfe_u32 v64, s5, v56, 2
    v_mad_u32_u24 v64, v64, s10, v60
    buffer_load_dwordx4 v64, s[60:63], s4 offen lds
    v_bfe_u32 v65, s5, v57, 2
    v_mad_u32_u24 v65, v65, s10, v61
    buffer_load_dwordx4 v65, s[60:63], s4 offen offset:1024 lds
    v_bfe_u32 v64, s5, v58, 2
    v_mad_u32_u24 v64, v64, s10, v62
    buffer_load_dwordx4 v64, s[60:63], s4 offen offset:2048 lds
    v_bfe_u32 v65, s5, v59, 2
    v_mad_u32_u24 v65, v65, s10, v63
    buffer_load_dwordx4 v65, s[60:63], s4 offen offset:3072 lds
    s_add_u32 s4, s4, 81920
    s_cmp_eq_u32 s4, 819200
    s_cselect_b32 s4, 0, s4
    s_mov_b32 m0, 40960
    v_bfe_u32 v64, s6, v52, 2
    v_mad_u32_u24 v64, v64, s10, v60
    buffer_load_dwordx4 v64, s[60:63], s4 offen lds
    v_bfe_u32 v65, s6, v53, 2
    v_mad_u32_u24 v65, v65, s10, v61
    buffer_load_dwordx4 v65, s[60:63], s4 offen offset:1024 lds
    v_bfe_u32 v64, s6, v54, 2
    v_mad_u32_u24 v64, v64, s10, v62
    buffer_load_dwordx4 v64, s[60:63], s4 offen offset:2048 lds
    v_bfe_u32 v65, s6, v55, 2
    v_mad_u32_u24 v65, v65, s10, v63
    buffer_load_dwordx4 v65, s[60:63], s4 offen offset:3072 lds
    s_mov_b32 m0, 45056
    v_bfe_u32 v64, s6, v56, 2
    v_mad_u32_u24 v64, v64, s10, v60
    buffer_load_dwordx4 v64, s[60:63], s4 offen lds
    v_bfe_u32 v65, s6, v57, 2
    v_mad_u32_u24 v65, v65, s10, v61
    buffer_load_dwordx4 v65, s[60:63], s4 offen offset:1024 lds
    v_bfe_u32 v64, s6, v58, 2
    v_mad_u32_u24 v64, v64, s10, v62
    buffer_load_dwordx4 v64, s[60:63], s4 offen offset:2048 lds
    v_bfe_u32 v65, s6, v59, 2
    v_mad_u32_u24 v65, v65, s10, v63
    buffer_load_dwordx4 v65, s[60:63], s4 offen offset:3072 lds
    s_add_u32 s4, s4, 81920
    s_cmp_eq_u32 s4, 819200
    s_cselect_b32 s4, 0, s4
    s_mov_b32 m0, 63616
    v_bfe_u32 v64, s7, v52, 2
    v_mad_u32_u24 v64, v64, s10, v60
    buffer_load_dwordx4 v64, s[60:63], s4 offen lds
    v_bfe_u32 v65, s7, v53, 2
    v_mad_u32_u24 v65, v65, s10, v61
    buffer_load_dwordx4 v65, s[60:63], s4 offen offset:1024 lds
    v_bfe_u32 v64, s7, v54, 2
    v_mad_u32_u24 v64, v64, s10, v62
    buffer_load_dwordx4 v64, s[60:63], s4 offen offset:2048 lds
    v_bfe_u32 v65, s7, v55, 2
    v_mad_u32_u24 v65, v65, s10, v63
    buffer_load_dwordx4 v65, s[60:63], s4 offen offset:3072 lds
    s_mov_b32 m0, 67712
    v_bfe_u32 v64, s7, v56, 2
    v_mad_u32_u24 v64, v64, s10, v60
    buffer_load_dwordx4 v64, s[60:63], s4 offen lds
    v_bfe_u32 v65, s7, v57, 2
    v_mad_u32_u24 v65, v65, s10, v61
    buffer_load_dwordx4 v65, s[60:63], s4 offen offset:1024 lds
    v_bfe_u32 v64, s7, v58, 2
    v_mad_u32_u24 v64, v64, s10, v62
    buffer_load_dwordx4 v64, s[60:63], s4 offen offset:2048 lds
    v_bfe_u32 v65, s7, v59, 2
    v_mad_u32_u24 v65, v65, s10, v63
    buffer_load_dwordx4 v65, s[60:63], s4 offen offset:3072 lds
    s_add_u32 s4, s4, 81920
    s_cmp_eq_u32 s4, 819200
    s_cselect_b32 s4, 0, s4
    s_mov_b32 m0, 71808
    v_bfe_u32 v64, s8, v52, 2
    v_mad_u32_u24 v64, v64, s10, v60
    buffer_load_dwordx4 v64, s[60:63], s4 offen lds
    v_bfe_u32 v65, s8, v53, 2
    v_mad_u32_u24 v65, v65, s10, v61
    buffer_load_dwordx4 v65, s[60:63], s4 offen offset:1024 lds
    v_bfe_u32 v64, s8, v54, 2
    v_mad_u32_u24 v64, v64, s10, v62
    buffer_load_dwordx4 v64, s[60:63], s4 offen offset:2048 lds
    v_bfe_u32 v65, s8, v55, 2
    v_mad_u32_u24 v65, v65, s10, v63
    buffer_load_dwordx4 v65, s[60:63], s4 offen offset:3072 lds
    s_mov_b32 m0, 75904
    v_bfe_u32 v64, s8, v56, 2
    v_mad_u32_u24 v64, v64, s10, v60
    buffer_load_dwordx4 v64, s[60:63], s4 offen lds
    v_bfe_u32 v65, s8, v57, 2
    v_mad_u32_u24 v65, v65, s10, v61
    buffer_load_dwordx4 v65, s[60:63], s4 offen offset:1024 lds
    v_bfe_u32 v64, s8, v58, 2
    v_mad_u32_u24 v64, v64, s10, v62
    buffer_load_dwordx4 v64, s[60:63], s4 offen offset:2048 lds
    v_bfe_u32 v65, s8, v59, 2
    v_mad_u32_u24 v65, v65, s10, v63
    buffer_load_dwordx4 v65, s[60:63], s4 offen offset:3072 lds
    s_add_u32 s4, s4, 81920
    s_cmp_eq_u32 s4, 819200
    s_cselect_b32 s4, 0, s4
    s_mov_b32 m0, 49152
    v_bfe_u32 v64, s9, v52, 2
    v_mad_u32_u24 v64, v64, s10, v60
    buffer_load_dwordx4 v64, s[60:63], s4 offen lds
    v_bfe_u32 v65, s9, v53, 2
    v_mad_u32_u24 v65, v65, s10, v61
    buffer_load_dwordx4 v65, s[60:63], s4 offen offset:1024 lds
    v_bfe_u32 v64, s9, v54, 2
    v_mad_u32_u24 v64, v64, s10, v62
    buffer_load_dwordx4 v64, s[60:63], s4 offen offset:2048 lds
    v_bfe_u32 v65, s9, v55, 2
    v_mad_u32_u24 v65, v65, s10, v63
    buffer_load_dwordx4 v65, s[60:63], s4 offen offset:3072 lds
    s_mov_b32 m0, 88192
    v_bfe_u32 v64, s9, v56, 2
    v_mad_u32_u24 v64, v64, s10, v60
    buffer_load_dwordx4 v64, s[60:63], s4 offen lds
    v_bfe_u32 v65, s9, v57, 2
    v_mad_u32_u24 v65, v65, s10, v61
    buffer_load_dwordx4 v65, s[60:63], s4 offen offset:1024 lds
    v_bfe_u32 v64, s9, v58, 2
    v_mad_u32_u24 v64, v64, s10, v62
    buffer_load_dwordx4 v64, s[60:63], s4 offen offset:2048 lds
    v_bfe_u32 v65, s9, v59, 2
    v_mad_u32_u24 v65, v65, s10, v63
    buffer_load_dwordx4 v65, s[60:63], s4 offen offset:3072 lds
    s_add_u32 s4, s4, 81920
    s_cmp_eq_u32 s4, 819200
    s_cselect_b32 s4, 0, s4
    s_waitcnt vmcnt(0)
Lbc:
    v_readfirstlane_b32 s11, v70
    v_readfirstlane_b32 s36, v71
    v_readfirstlane_b32 s12, v72
    v_readfirstlane_b32 s37, v73
    s_cmp_eq_u32 s36, s34
    s_cselect_b32 s37, s37, s36
    s_cmp_eq_u32 s37, s34
    s_cbranch_scc1 Lbc_ok
Lbc_re:
    s_sub_u32 s35, s35, 1
    s_cbranch_scc1 Lend
    buffer_load_dwordx4 v[70:73], v69, s[28:31], 0 offen sc1
    s_waitcnt vmcnt(0)
    s_branch Lbc
Lbc_ok:
    s_mul_i32 s36, s32, 96
    s_and_b32 s13, s11, 0x7ff
    s_sub_u32 s13, 2047, s13
    s_sub_u32 s37, s13, s36
    s_cmp_lt_u32 s37, 96
    s_cselect_b32 s13, s13, -1
    s_and_b32 s14, s12, 0x7ff
    s_sub_u32 s14, 2047, s14
    s_sub_u32 s37, s14, s36
    s_cmp_lt_u32 s37, 96
    s_cselect_b32 s14, s14, -1
    v_mov_b32 v4, s13
    v_mov_b32 v5, s14
    v_mov_b32 v6, 157960
    ds_write_b64 v6, v[4:5]
    s_and_b32 s37, s13, s14
    s_cmp_eq_u32 s37, -1
    s_cbranch_scc1 Lw0_done
    s_max_i32 s36, s13, 0
    s_mul_i32 s36, s36, 1280
    s_lshl_b32 s37, s33, 7
    s_add_u32 s36, s36, s37
    s_add_u32 s36, s36, 4096
    v_lshlrev_b32 v8, 1, v1
    buffer_load_ushort v124, v8, s[44:47], s36 offen
    s_max_i32 s36, s14, 0
    s_mul_i32 s36, s36, 1280
    s_lshl_b32 s37, s33, 7
    s_add_u32 s36, s36, s37
    s_add_u32 s36, s36, 4096
    v_lshlrev_b32 v8, 1, v1
    buffer_load_ushort v125, v8, s[44:47], s36 offen
    v_min_u32 v7, 26, v1
    v_mul_u32_u24 v7, 10240, v7
Ly_poll:
    s_sub_u32 s35, s35, 1
    s_cbranch_scc1 Lend
    s_sleep 4
    s_lshl_b32 s36, s33, 10
    s_add_u32 s36, s36, 7405568
    buffer_load_dword v4, v7, s[28:31], s36 offen offset:1020 sc1
    s_waitcnt vmcnt(0)
    v_cmp_ne_u32 vcc, s34, v4
    s_nop 0
    s_cbranch_vccnz Ly_poll
    buffer_load_dwordx4 v[16:19], v13, s[28:31], s36 offen sc1
    s_add_u32 s36, s36, 10240
    buffer_load_dwordx4 v[20:23], v13, s[28:31], s36 offen sc1
    s_add_u32 s36, s36, 10240
    buffer_load_dwordx4 v[24:27], v13, s[28:31], s36 offen sc1
    s_add_u32 s36, s36, 10240
    buffer_load_dwordx4 v[28:31], v13, s[28:31], s36 offen sc1
    s_add_u32 s36, s36, 10240
    buffer_load_dwordx4 v[32:35], v13, s[28:31], s36 offen sc1
    s_add_u32 s36, s36, 10240
    buffer_load_dwordx4 v[36:39], v13, s[28:31], s36 offen sc1
    s_add_u32 s36, s36, 10240
    buffer_load_dwordx4 v[40:43], v13, s[28:31], s36 offen sc1
    s_add_u32 s36, s36, 10240
    buffer_load_dwordx4 v[44:47], v13, s[28:31], s36 offen sc1
    s_add_u32 s36, s36, 10240
    buffer_load_dwordx4 v[48:51], v13, s[28:31], s36 offen sc1
    s_add_u32 s36, s36, 10240
    buffer_load_dwordx4 v[52:55], v13, s[28:31], s36 offen sc1
    s_add_u32 s36, s36, 10240
    buffer_load_dwordx4 v[56:59], v13, s[28:31], s36 offen sc1
    s_add_u32 s36, s36, 10240
    buffer_load_dwordx4 v[60:63], v13, s[28:31], s36 offen sc1
    s_add_u32 s36, s36, 10240
    buffer_load_dwordx4 v[64:67], v13, s[28:31], s36 offen sc1
    s_add_u32 s36, s36, 10240
    buffer_load_dwordx4 v[68:71], v13, s[28:31], s36 offen sc1
    s_add_u32 s36, s36, 10240
    buffer_load_dwordx4 v[72:75], v13, s[28:31], s36 offen sc1
    s_add_u32 s36, s36, 10240
    buffer_load_dwordx4 v[76:79], v13, s[28:31], s36 offen sc1
    s_add_u32 s36, s36, 10240
    buffer_load_dwordx4 v[80:83], v13, s[28:31], s36 offen sc1
    s_add_u32 s36, s36, 10240
    buffer_load_dwordx4 v[84:87], v13, s[28:31], s36 offen sc1
    s_add_u32 s36, s36, 10240
    buffer_load_dwordx4 v[88:91], v13, s[28:31], s36 offen sc1
    s_add_u32 s36, s36, 10240
    buffer_load_dwordx4 v[92:95], v13, s[28:31], s36 offen sc1
    s_add_u32 s36, s36, 10240
    buffer_load_dwordx4 v[96:99], v13, s[28:31], s36 offen sc1
    s_add_u32 s36, s36, 10240
    buffer_load_dwordx4 v[100:103], v13, s[28:31], s36 offen sc1
    s_add_u32 s36, s36, 10240
    buffer_load_dwordx4 v[104:107], v13, s[28:31], s36 offen sc1
    s_add_u32 s36, s36, 10240
    buffer_load_dwordx4 v[108:111], v13, s[28:31], s36 offen sc1
    s_add_u32 s36, s36, 10240
    buffer_load_dwordx4 v[112:115], v13, s[28:31], s36 offen sc1
    s_add_u32 s36, s36, 10240
    buffer_load_dwordx4 v[116:119], v13, s[28:31], s36 offen sc1
    s_add_u32 s36, s36, 10240
    buffer_load_dwordx4 v[120:123], v13, s[28:31], s36 offen sc1
    s_add_u32 s36, s36, 10240
    s_waitcnt vmcnt(0)
    v_xor_b32 v4, s34, v17
    v_xor_b32 v5, s34, v19
    v_or_b32 v4, v4, v5
    v_xor_b32 v5, s34, v21
    v_or_b32 v4, v4, v5
    v_xor_b32 v5, s34, v23
    v_or_b32 v4, v4, v5
    v_xor_b32 v5, s34, v25
    v_or_b32 v4, v4, v5
    v_xor_b32 v5, s34, v27
    v_or_b32 v4, v4, v5
    v_xor_b32 v5, s34, v29
    v_or_b32 v4, v4, v5
    v_xor_b32 v5, s34, v31
    v_or_b32 v4, v4, v5
    v_xor_b32 v5, s34, v33
    v_or_b32 v4, v4, v5
    v_xor_b32 v5, s34, v35
    v_or_b32 v4, v4, v5
    v_xor_b32 v5, s34, v37
    v_or_b32 v4, v4, v5
    v_xor_b32 v5, s34, v39
    v_or_b32 v4, v4, v5
    v_xor_b32 v5, s34, v41
    v_or_b32 v4, v4, v5
    v_xor_b32 v5, s34, v43
    v_or_b32 v4, v4, v5
    v_xor_b32 v5, s34, v45
    v_or_b32 v4, v4, v5
    v_xor_b32 v5, s34, v47
    v_or_b32 v4, v4, v5
    v_xor_b32 v5, s34, v49
    v_or_b32 v4, v4, v5
    v_xor_b32 v5, s34, v51
    v_or_b32 v4, v4, v5
    v_xor_b32 v5, s34, v53
    v_or_b32 v4, v4, v5
    v_xor_b32 v5, s34, v55
    v_or_b32 v4, v4, v5
    v_xor_b32 v5, s34, v57
    v_or_b32 v4, v4, v5
    v_xor_b32 v5, s34, v59
    v_or_b32 v4, v4, v5
    v_xor_b32 v5, s34, v61
    v_or_b32 v4, v4, v5
    v_xor_b32 v5, s34, v63
    v_or_b32 v4, v4, v5
    v_xor_b32 v5, s34, v65
    v_or_b32 v4, v4, v5
    v_xor_b32 v5, s34, v67
    v_or_b32 v4, v4, v5
    v_xor_b32 v5, s34, v69
    v_or_b32 v4, v4, v5
    v_xor_b32 v5, s34, v71
    v_or_b32 v4, v4, v5
    v_xor_b32 v5, s34, v73
    v_or_b32 v4, v4, v5
    v_xor_b32 v5, s34, v75
    v_or_b32 v4, v4, v5
    v_xor_b32 v5, s34, v77
    v_or_b32 v4, v4, v5
    v_xor_b32 v5, s34, v79
    v_or_b32 v4, v4, v5
    v_xor_b32 v5, s34, v81
    v_or_b32 v4, v4, v5
    v_xor_b32 v5, s34, v83
    v_or_b32 v4, v4, v5
    v_xor_b32 v5, s34, v85
    v_or_b32 v4, v4, v5
    v_xor_b32 v5, s34, v87
    v_or_b32 v4, v4, v5
    v_xor_b32 v5, s34, v89
    v_or_b32 v4, v4, v5
    v_xor_b32 v5, s34, v91
    v_or_b32 v4, v4, v5
    v_xor_b32 v5, s34, v93
    v_or_b32 v4, v4, v5
    v_xor_b32 v5, s34, v95
    v_or_b32 v4, v4, v5
    v_xor_b32 v5, s34, v97
    v_or_b32 v4, v4, v5
    v_xor_b32 v5, s34, v99
    v_or_b32 v4, v4, v5
    v_xor_b32 v5, s34, v101
    v_or_b32 v4, v4, v5
    v_xor_b32 v5, s34, v103
    v_or_b32 v4, v4, v5
    v_xor_b32 v5, s34, v105
    v_or_b32 v4, v4, v5
    v_xor_b32 v5, s34, v107
    v_or_b32 v4, v4, v5
    v_xor_b32 v5, s34, v109
    v_or_b32 v4, v4, v5
    v_xor_b32 v5, s34, v111
    v_or_b32 v4, v4, v5
    v_xor_b32 v5, s34, v113
    v_or_b32 v4, v4, v5
    v_xor_b32 v5, s34, v115
    v_or_b32 v4, v4, v5
    v_xor_b32 v5, s34, v117
    v_or_b32 v4, v4, v5
    v_xor_b32 v5, s34, v119
    v_or_b32 v4, v4, v5
    v_xor_b32 v5, s34, v121
    v_or_b32 v4, v4, v5
    v_xor_b32 v5, s34, v123
    v_or_b32 v4, v4, v5
    v_cmp_ne_u32 vcc, 0, v4
    s_nop 0
    s_cmp_lg_u64 vcc, 0
    s_cbranch_scc1 Ly_poll
    v_add_f32 v16, v16, v20
    v_add_f32 v18, v18, v22
    v_add_f32 v16, v16, v24
    v_add_f32 v18, v18, v26
    v_add_f32 v16, v16, v28
    v_add_f32 v18, v18, v30
    v_add_f32 v16, v16, v32
    v_add_f32 v18, v18, v34
    v_add_f32 v16, v16, v36
    v_add_f32 v18, v18, v38
    v_add_f32 v16, v16, v40
    v_add_f32 v18, v18, v42
    v_add_f32 v16, v16, v44
    v_add_f32 v18, v18, v46
    v_add_f32 v16, v16, v48
    v_add_f32 v18, v18, v50
    v_add_f32 v16, v16, v52
    v_add_f32 v18, v18, v54
    v_add_f32 v16, v16, v56
    v_add_f32 v18, v18, v58
    v_add_f32 v16, v16, v60
    v_add_f32 v18, v18, v62
    v_add_f32 v16, v16, v64
    v_add_f32 v18, v18, v66
    v_add_f32 v16, v16, v68
    v_add_f32 v18, v18, v70
    v_add_f32 v16, v16, v72
    v_add_f32 v18, v18, v74
    v_add_f32 v16, v16, v76
    v_add_f32 v18, v18, v78
    v_add_f32 v16, v16, v80
    v_add_f32 v18, v18, v82
    v_add_f32 v16, v16, v84
    v_add_f32 v18, v18, v86
    v_add_f32 v16, v16, v88
    v_add_f32 v18, v18, v90
    v_add_f32 v16, v16, v92
    v_add_f32 v18, v18, v94
    v_add_f32 v16, v16, v96
    v_add_f32 v18, v18, v98
    v_add_f32 v16, v16, v100
    v_add_f32 v18, v18, v102
    v_add_f32 v16, v16, v104
    v_add_f32 v18, v18, v106
    v_add_f32 v16, v16, v108
    v_add_f32 v18, v18, v110
    v_add_f32 v16, v16, v112
    v_add_f32 v18, v18, v114
    v_add_f32 v16, v16, v116
    v_add_f32 v18, v18, v118
    v_add_f32 v16, v16, v120
    v_add_f32 v18, v18, v122
    s_lshr_b32 s36, s11, 16
    s_cmp_ge_u32 s36, 0x8000
    s_cselect_b32 s37, 0x8000, -1
    s_xor_b32 s36, s36, s37
    s_lshl_b32 s36, s36, 16
    v_mov_b32 v4, s36
    v_mul_f32 v4, 0xbfb8aa3b, v4
    v_exp_f32 v4, v4
    s_nop 0
    v_add_f32 v4, 1.0, v4
    v_rcp_f32 v4, v4
    s_nop 0
    v_cvt_pk_bf16_f32 v4, v4, v4
    v_lshlrev_b32 v4, 16, v4
    v_cvt_pk_bf16_f32 v16, v16, v16
    v_lshlrev_b32 v16, 16, v16
    v_mul_f32 v16, v16, v4
    v_cvt_pk_bf16_f32 v16, v16, v16
    v_lshlrev_b32 v16, 16, v16
    s_lshr_b32 s36, s12, 16
    s_cmp_ge_u32 s36, 0x8000
    s_cselect_b32 s37, 0x8000, -1
    s_xor_b32 s36, s36, s37
    s_lshl_b32 s36, s36, 16
    v_mov_b32 v4, s36
    v_mul_f32 v4, 0xbfb8aa3b, v4
    v_exp_f32 v4, v4
    s_nop 0
    v_add_f32 v4, 1.0, v4
    v_rcp_f32 v4, v4
    s_nop 0
    v_cvt_pk_bf16_f32 v4, v4, v4
    v_lshlrev_b32 v4, 16, v4
    v_cvt_pk_bf16_f32 v18, v18, v18
    v_lshlrev_b32 v18, 16, v18
    v_mul_f32 v18, v18, v4
    v_cvt_pk_bf16_f32 v18, v18, v18
    v_lshlrev_b32 v18, 16, v18
    s_mul_i32 s36, s32, 96
    s_sub_u32 s36, s13, s36
    s_max_i32 s36, s36, 0
    s_lshl_b32 s36, s36, 2
    s_add_u32 s36, s36, 156288
    v_mov_b32 v4, s36
    ds_read2st64_b32 v[4:5], v4 offset0:0 offset1:2
    v_lshlrev_b32 v124, 16, v124
    s_waitcnt lgkmcnt(0)
    v_add_f32 v20, v124, v4
    v_cvt_pk_bf16_f32 v20, v20, v20
    v_lshlrev_b32 v20, 16, v20
    v_mul_f32 v20, v20, v5
    v_cvt_pk_bf16_f32 v20, v20, v20
    v_lshlrev_b32 v20, 16, v20
    v_add_f32 v20, v20, v16
    v_cvt_pk_bf16_f32 v20, v20, v20
    v_lshlrev_b32 v20, 16, v20
    v_mul_f32 v16, 0xbfb8aa3b, v20
    v_exp_f32 v16, v16
    s_nop 0
    v_add_f32 v16, 1.0, v16
    v_rcp_f32 v16, v16
    s_nop 0
    v_mul_f32 v16, v16, v20
    v_cvt_pk_bf16_f32 v16, v16, v16
    v_lshlrev_b32 v16, 16, v16
    s_mul_i32 s36, s32, 96
    s_sub_u32 s36, s14, s36
    s_max_i32 s36, s36, 0
    s_lshl_b32 s36, s36, 2
    s_add_u32 s36, s36, 156288
    v_mov_b32 v4, s36
    ds_read2st64_b32 v[4:5], v4 offset0:0 offset1:2
    v_lshlrev_b32 v125, 16, v125
    s_waitcnt lgkmcnt(0)
    v_add_f32 v22, v125, v4
    v_cvt_pk_bf16_f32 v22, v22, v22
    v_lshlrev_b32 v22, 16, v22
    v_mul_f32 v22, v22, v5
    v_cvt_pk_bf16_f32 v22, v22, v22
    v_lshlrev_b32 v22, 16, v22
    v_add_f32 v22, v22, v18
    v_cvt_pk_bf16_f32 v22, v22, v22
    v_lshlrev_b32 v22, 16, v22
    v_mul_f32 v18, 0xbfb8aa3b, v22
    v_exp_f32 v18, v18
    s_nop 0
    v_add_f32 v18, 1.0, v18
    v_rcp_f32 v18, v18
    s_nop 0
    v_mul_f32 v18, v18, v22
    v_cvt_pk_bf16_f32 v18, v18, v18
    v_lshlrev_b32 v18, 16, v18
    v_add_u32 v5, 158208, v12
    ds_write2st64_b32 v5, v16, v18 offset0:0 offset1:1
    v_mov_b32 v6, 157956
    v_mov_b32 v7, 1
    s_mov_b64 exec, 1
    ds_add_u32 v6, v7
    s_mov_b64 exec, -1
Lw0_done:
    s_endpgm
Lcomp:
    s_lshl_b32 s44, s26, 1
    s_add_u32 s44, s44, s27
    s_sub_u32 s36, s33, 5
    s_cmp_ge_u32 s33, 5
    s_cselect_b32 s40, s36, s33
    s_mov_b32 s41, 0xbfe10856
    s_cmp_eq_u32 s40, 1
    s_cselect_b32 s41, 0xaff80255, s41
    s_cmp_eq_u32 s40, 2
    s_cselect_b32 s41, 0xabfe4015, s41
    s_cmp_eq_u32 s40, 3
    s_cselect_b32 s41, 0xaa7fd005, s41
    s_cmp_eq_u32 s40, 4
    s_cselect_b32 s41, 0x6adfb401, s41
    s_lshl_b32 s37, s27, 13
    s_cmp_eq_u32 s44, 1
    s_cselect_b32 s37, 0, s37
    v_bfe_u32 v7, v1, 2, 2
    v_and_b32 v8, 3, v1
    v_lshl_add_u32 v18, v2, 3, v7
    v_lshlrev_b32 v18, 7, v18
    v_lshlrev_b32 v19, 2, v1
    v_and_b32 v19, 0x60, v19
    v_lshlrev_b32 v10, 1, v8
    v_add_u32 v9, s37, v18
    v_add_u32 v11, 0, v10
    v_bfe_u32 v11, s41, v11, 2
    v_lshl_add_u32 v11, v11, 2, v8
    v_lshlrev_b32 v11, 3, v11
    v_xad_u32 v20, v11, v19, v9
    v_add_u32 v11, 8, v10
    v_bfe_u32 v11, s41, v11, 2
    v_lshl_add_u32 v11, v11, 2, v8
    v_lshlrev_b32 v11, 3, v11
    v_xad_u32 v21, v11, v19, v9
    v_add_u32 v11, 16, v10
    v_bfe_u32 v11, s41, v11, 2
    v_lshl_add_u32 v11, v11, 2, v8
    v_lshlrev_b32 v11, 3, v11
    v_xad_u32 v22, v11, v19, v9
    v_add_u32 v11, 24, v10
    v_bfe_u32 v11, s41, v11, 2
    v_lshl_add_u32 v11, v11, 2, v8
    v_lshlrev_b32 v11, 3, v11
    v_xad_u32 v23, v11, v19, v9
    v_add_u32 v24, 78080, v20
    v_add_u32 v25, 78080, v21
    v_add_u32 v26, 78080, v22
    v_add_u32 v27, 78080, v23
    v_lshrrev_b32 v10, 1, v3
    v_xor_b32 v9, v10, v2
    v_lshlrev_b32 v9, 4, v9
    v_lshl_add_u32 v9, v3, 7, v9
    s_lshl_b32 s36, s44, 11
    s_xor_b32 s38, s36, 2048
    s_add_u32 s36, s36, 22528
    s_add_u32 s38, s38, 22528
    v_add_u32 v76, s36, v9
    v_add_u32 v78, s38, v9
    s_mul_i32 s39, s26, 6144
    s_add_u32 s39, s39, 98560
    v_add_u32 v125, s39, v13
    s_lshl_b32 s45, s44, 11
    s_add_u32 s45, s45, 139648
    s_waitcnt lgkmcnt(0)
    s_mov_b64 s[28:29], s[24:25]
    s_mov_b32 s30, 268435456
    s_mov_b32 s31, 0x20000
    s_load_dword s34, s[28:29], 0
    s_cmp_eq_u32 s44, 1
    s_cbranch_scc1 Lhalo
    v_xor_b32 v77, 64, v76
    v_xor_b32 v79, 64, v78
    v_add_u32 v80, 78080, v76
    v_add_u32 v81, 78080, v77
    v_add_u32 v82, 78080, v78
    v_add_u32 v83, 78080, v79
    s_cmp_eq_u32 s27, 0
    s_cselect_b64 vcc, 0, -1
    s_sub_u32 s37, 16384, s37
    v_cndmask_b32 v84, v20, v22, vcc
    v_cndmask_b32 v85, v21, v23, vcc
    v_add_u32 v84, s37, v84
    v_add_u32 v85, s37, v85
    v_add_u32 v86, 78080, v84
    v_add_u32 v87, 78080, v85
    v_lshrrev_b32 v8, 1, v2
    v_xor_b32 v8, v8, v10
    v_lshlrev_b32 v8, 4, v8
    v_lshl_add_u32 v8, v3, 7, v8
    v_and_b32 v7, 1, v2
    v_lshl_add_u32 v124, v7, 3, v8
    s_lshl_b32 s46, s42, 12
    s_mov_b32 s38, 0x84736210
    s_mov_b32 s39, 0x95
    s_cmp_eq_u32 s42, 1
    s_cselect_b32 s38, 0x83712065, s38
    s_cselect_b32 s39, 0x94, s39
    s_cmp_eq_u32 s42, 2
    s_cselect_b32 s38, 0x81307564, s38
    s_cselect_b32 s39, 0x92, s39
    s_cmp_eq_u32 s42, 3
    s_cselect_b32 s38, 0x40857362, s38
    s_cselect_b32 s39, 0x91, s39
    s_cmp_eq_u32 s42, 4
    s_cselect_b32 s38, 0x94837261, s38
    s_cselect_b32 s39, 0x50, s39
    s_xor_b32 s42, s33, s43
    s_lshl_b32 s42, s42, 2
    s_lshr_b64 s[38:39], s[38:39], s42
    s_and_b32 s42, s38, 15
    s_and_b32 s38, s42, 3
    s_mul_i32 s38, s38, 39040
    s_add_u32 s38, s38, s36
    v_add_u32 v4, s38, v124
    v_xor_b32 v5, 32, v4
    v_xor_b32 v6, 64, v4
    v_xor_b32 v7, 0x60, v4
    s_mov_b64 s[48:49], s[20:21]
    s_mov_b32 s50, 2621440
    s_mov_b32 s51, 0x20000
    v_mov_b32 v14, 0x3f803f80
    v_mov_b32 v15, 0x3f803f80
    v_mov_b32 v16, 0x3f803f80
    v_mov_b32 v17, 0x3f803f80
    s_mov_b32 s4, 0xaae00455
    s_cmp_eq_u32 s40, 1
    s_cselect_b32 s4, 0xaaf80155, s4
    s_cmp_eq_u32 s40, 2
    s_cselect_b32 s4, 0xaafe4055, s4
    s_cmp_eq_u32 s40, 3
    s_cselect_b32 s4, 0xaabfd055, s4
    s_cmp_eq_u32 s40, 4
    s_cselect_b32 s4, 0xaaeff455, s4
    v_lshlrev_b32 v10, 1, v2
    v_add_u32 v10, 8, v10
    v_bfe_u32 v10, s4, v10, 2
    v_cmp_eq_u32 s[6:7], 0, v10
    v_cmp_eq_u32 s[8:9], 3, v10
    v_cmp_eq_u32 s[10:11], 1, v10
    v_lshlrev_b32 v10, 1, v2
    v_add_u32 v10, 16, v10
    v_bfe_u32 v10, s4, v10, 2
    v_cmp_eq_u32 s[12:13], 0, v10
    v_cmp_eq_u32 s[14:15], 3, v10
    v_cmp_eq_u32 s[16:17], 2, v10
    s_mov_b32 s4, 0xaaaaaaaa
    s_mov_b32 s5, 0xaaaaaaaa
    s_mov_b32 s18, 0xfff0ffff
    s_mov_b32 s19, 0xf000ff00
    s_mov_b32 s20, 0xffc0fffc
    s_mov_b32 s21, 0xc000fc00
    v_mov_b32 v8, 0xffff
    v_not_b32 v9, v8
    v_cndmask_b32 v8, v8, v9, s[4:5]
    v_cndmask_b32 v118, 0, v8, s[18:19]
    v_cndmask_b32 v119, 0, v8, s[20:21]
    v_xor_b32 v116, v118, v8
    v_xor_b32 v117, v119, v8
    s_cmp_eq_u32 s32, 0
    s_cselect_b32 s36, s44, 0
    s_cmp_eq_u32 s36, 2
    s_cselect_b32 s22, 0xff800000, 0
    s_mul_i32 s36, s32, 6
    s_add_u32 s36, s36, s44
    s_sub_u32 s36, s36, 2
    s_lshl_b32 s24, s36, 7
    s_add_u32 s24, s24, 7340032
    s_mul_i32 s52, s36, 20480
    s_add_u32 s52, s52, 4194304
    s_lshl_b32 s36, s33, 11
    s_add_u32 s23, s36, s52
    s_add_u32 s53, s52, s46
    s_add_u32 s46, s46, 4096
    s_cmp_eq_u32 s46, 20480
    s_cselect_b32 s46, 0, s46
    s_add_u32 s54, s52, s46
    s_add_u32 s46, s46, 4096
    s_cmp_eq_u32 s46, 20480
    s_cselect_b32 s46, 0, s46
    s_add_u32 s55, s52, s46
    s_add_u32 s46, s46, 4096
    s_cmp_eq_u32 s46, 20480
    s_cselect_b32 s46, 0, s46
    s_add_u32 s56, s52, s46
    s_add_u32 s46, s46, 4096
    s_cmp_eq_u32 s46, 20480
    s_cselect_b32 s46, 0, s46
    s_add_u32 s57, s52, s46
    s_add_u32 s46, s46, 4096
    s_cmp_eq_u32 s46, 20480
    s_cselect_b32 s46, 0, s46
    s_mul_i32 s36, s32, 10
    s_add_u32 s36, s36, s33
    s_mul_i32 s58, s36, 6144
    s_lshl_b32 s36, s44, 10
    s_add_u32 s58, s58, s36
    s_add_u32 s58, s58, 1046528
    s_sub_u32 s59, s58, 6144
    s_add_u32 s60, s58, 6144
    s_cmp_eq_u32 s40, 0
    s_cselect_b32 s61, 0, -1
    s_cmp_eq_u32 s40, 4
    s_cselect_b32 s62, 0, -1
    s_lshl_b32 s36, s33, 2
    v_mov_b32 v97, s36
    s_mov_b32 s25, 0x3ea52b5c
    s_lshl_b32 s36, s44, 6
    s_add_u32 s36, s36, 156160
    v_lshl_add_u32 v94, v3, 2, s36
    v_and_b32 v8, 1, v1
    v_lshl_add_u32 v8, v2, 2, v8
    v_lshl_add_u32 v8, v8, 2, s36
    v_subrev_u32 v9, 64, v8
    v_cndmask_b32 v92, v9, v8, s[18:19]
    v_cndmask_b32 v93, v9, v8, s[20:21]
    v_lshlrev_b32 v95, 4, v2
    s_lshl_b32 s36, s27, 8
    s_add_u32 s36, s36, 157184
    v_add_u32 v95, s36, v95
    v_mov_b32 v96, 157968
    v_mov_b32 v100, -1
    v_mov_b32 v101, -1
    v_mov_b32 v102, -1
    v_mov_b32 v103, -1
    v_mov_b32 v127, 157984
    s_lshl_b32 s36, s3, 2
    s_add_u32 s36, s36, 158016
    v_mov_b32 v10, s36
    v_xor_b32 v11, 16, v10
    v_cndmask_b32 v127, v127, v11, s[4:5]
    s_waitcnt lgkmcnt(0)
    s_barrier
    ds_read_b128 a[64:67], v76 offset:0
    ds_read_b128 a[68:71], v78 offset:0
    ds_read_b64_tr_b16 a[80:81], v20 offset:0
    ds_read_b64_tr_b16 a[82:83], v20 offset:512
    ds_read_b64_tr_b16 a[84:85], v21 offset:0
    ds_read_b64_tr_b16 a[86:87], v21 offset:512
    ds_read_b64_tr_b16 a[88:89], v22 offset:0
    ds_read_b64_tr_b16 a[90:91], v22 offset:512
    ds_read_b64_tr_b16 a[92:93], v23 offset:0
    ds_read_b64_tr_b16 a[94:95], v23 offset:512
    ds_read_b64_tr_b16 a[96:97], v84 offset:0
    ds_read_b64_tr_b16 a[98:99], v84 offset:512
    ds_read_b64_tr_b16 a[100:101], v85 offset:0
    ds_read_b64_tr_b16 a[102:103], v85 offset:512
    s_add_u32 s34, s34, 0x9e3779b8
    s_or_b32 s34, s34, 1
    s_cmp_eq_u32 s42, 0
    s_cbranch_scc1 Lxe0
Lxe0_b:
    s_setprio 1
    s_waitcnt lgkmcnt(10)
    v_mfma_f32_16x16x32_bf16 v[28:31], a[80:83], a[64:67], 0
    ds_read_b128 a[72:75], v77 offset:0
    ds_read_b128 a[76:79], v79 offset:0
    v_mfma_f32_16x16x32_bf16 v[44:47], a[80:83], a[68:71], 0
    ds_read_b64_tr_b16 a[104:105], v20 offset:4096
    s_waitcnt lgkmcnt(11)
    v_mfma_f32_16x16x32_bf16 v[32:35], a[84:87], a[64:67], 0
    ds_read_b64_tr_b16 a[106:107], v20 offset:4608
    v_mfma_f32_16x16x32_bf16 v[48:51], a[84:87], a[68:71], 0
    ds_read_b64_tr_b16 a[108:109], v21 offset:4096
    s_waitcnt lgkmcnt(11)
    v_mfma_f32_16x16x32_bf16 v[36:39], a[88:91], a[64:67], 0
    ds_read_b64_tr_b16 a[110:111], v21 offset:4608
    ds_read_b64_tr_b16 a[112:113], v22 offset:4096
    v_mfma_f32_16x16x32_bf16 v[52:55], a[88:91], a[68:71], 0
    ds_read_b64_tr_b16 a[114:115], v22 offset:4608
    s_setprio 0
    s_waitcnt lgkmcnt(12)
    v_mfma_f32_16x16x32_bf16 v[40:43], a[92:95], a[64:67], 0
    ds_read_b64_tr_b16 a[116:117], v23 offset:4096
    v_mfma_f32_16x16x32_bf16 v[56:59], a[92:95], a[68:71], 0
    ds_read_b64_tr_b16 a[118:119], v23 offset:4608
    s_waitcnt lgkmcnt(12)
    v_mfma_f32_16x16x32_bf16 v[60:63], a[64:67], a[96:99], 0
    ds_read_b64_tr_b16 a[120:121], v84 offset:4096
    v_mfma_f32_16x16x32_bf16 v[68:71], a[68:71], a[96:99], 0
    ds_read_b64_tr_b16 a[122:123], v84 offset:4608
    s_waitcnt lgkmcnt(12)
    v_mfma_f32_16x16x32_bf16 v[64:67], a[64:67], a[100:103], 0
    ds_read_b64_tr_b16 a[124:125], v85 offset:4096
    v_mfma_f32_16x16x32_bf16 v[72:75], a[68:71], a[100:103], 0
    ds_read_b64_tr_b16 a[126:127], v85 offset:4608
    s_barrier
    s_setprio 3
    s_waitcnt lgkmcnt(10)
    v_mfma_f32_16x16x32_bf16 v[28:31], a[104:107], a[72:75], v[28:31]
    ds_read_b128 a[64:67], v76 offset:39040
    ds_read_b128 a[68:71], v78 offset:39040
    v_mfma_f32_16x16x32_bf16 v[44:47], a[104:107], a[76:79], v[44:47]
    ds_read_b64_tr_b16 a[80:81], v20 offset:39040
    s_waitcnt lgkmcnt(11)
    v_mfma_f32_16x16x32_bf16 v[32:35], a[108:111], a[72:75], v[32:35]
    ds_read_b64_tr_b16 a[82:83], v20 offset:39552
    v_mfma_f32_16x16x32_bf16 v[48:51], a[108:111], a[76:79], v[48:51]
    ds_read_b64_tr_b16 a[84:85], v21 offset:39040
    s_waitcnt lgkmcnt(11)
    v_mfma_f32_16x16x32_bf16 v[36:39], a[112:115], a[72:75], v[36:39]
    ds_read_b64_tr_b16 a[86:87], v21 offset:39552
    v_mfma_f32_16x16x32_bf16 v[52:55], a[112:115], a[76:79], v[52:55]
    ds_read_b64_tr_b16 a[88:89], v22 offset:39040
    s_setprio 2
    s_waitcnt lgkmcnt(11)
    v_mfma_f32_16x16x32_bf16 v[40:43], a[116:119], a[72:75], v[40:43]
    ds_read_b64_tr_b16 a[90:91], v22 offset:39552
    ds_read_b64_tr_b16 a[92:93], v23 offset:39040
    v_mfma_f32_16x16x32_bf16 v[56:59], a[116:119], a[76:79], v[56:59]
    ds_read_b64_tr_b16 a[94:95], v23 offset:39552
    s_waitcnt lgkmcnt(12)
    v_mfma_f32_16x16x32_bf16 v[60:63], a[72:75], a[120:123], v[60:63]
    ds_read_b64_tr_b16 a[96:97], v84 offset:39040
    v_mfma_f32_16x16x32_bf16 v[68:71], a[76:79], a[120:123], v[68:71]
    ds_read_b64_tr_b16 a[98:99], v84 offset:39552
    s_waitcnt lgkmcnt(12)
    v_mfma_f32_16x16x32_bf16 v[64:67], a[72:75], a[124:127], v[64:67]
    ds_read_b64_tr_b16 a[100:101], v85 offset:39040
    v_mfma_f32_16x16x32_bf16 v[72:75], a[76:79], a[124:127], v[72:75]
    ds_read_b64_tr_b16 a[102:103], v85 offset:39552
    s_cmp_eq_u32 s42, 1
    s_cbranch_scc1 Lxe1
Lxe1_b:
    s_setprio 1
    s_waitcnt lgkmcnt(10)
    v_mfma_f32_16x16x32_bf16 v[28:31], a[80:83], a[64:67], v[28:31]
    ds_read_b128 a[72:75], v77 offset:39040
    ds_read_b128 a[76:79], v79 offset:39040
    v_mfma_f32_16x16x32_bf16 v[44:47], a[80:83], a[68:71], v[44:47]
    ds_read_b64_tr_b16 a[104:105], v20 offset:43136
    s_waitcnt lgkmcnt(11)
    v_mfma_f32_16x16x32_bf16 v[32:35], a[84:87], a[64:67], v[32:35]
    ds_read_b64_tr_b16 a[106:107], v20 offset:43648
    v_mfma_f32_16x16x32_bf16 v[48:51], a[84:87], a[68:71], v[48:51]
    ds_read_b64_tr_b16 a[108:109], v21 offset:43136
    s_waitcnt lgkmcnt(11)
    v_mfma_f32_16x16x32_bf16 v[36:39], a[88:91], a[64:67], v[36:39]
    ds_read_b64_tr_b16 a[110:111], v21 offset:43648
    ds_read_b64_tr_b16 a[112:113], v22 offset:43136
    v_mfma_f32_16x16x32_bf16 v[52:55], a[88:91], a[68:71], v[52:55]
    ds_read_b64_tr_b16 a[114:115], v22 offset:43648
    s_setprio 0
    s_waitcnt lgkmcnt(12)
    v_mfma_f32_16x16x32_bf16 v[40:43], a[92:95], a[64:67], v[40:43]
    ds_read_b64_tr_b16 a[116:117], v23 offset:43136
    v_mfma_f32_16x16x32_bf16 v[56:59], a[92:95], a[68:71], v[56:59]
    ds_read_b64_tr_b16 a[118:119], v23 offset:43648
    s_waitcnt lgkmcnt(12)
    v_mfma_f32_16x16x32_bf16 v[60:63], a[64:67], a[96:99], v[60:63]
    ds_read_b64_tr_b16 a[120:121], v84 offset:43136
    v_mfma_f32_16x16x32_bf16 v[68:71], a[68:71], a[96:99], v[68:71]
    ds_read_b64_tr_b16 a[122:123], v84 offset:43648
    s_waitcnt lgkmcnt(12)
    v_mfma_f32_16x16x32_bf16 v[64:67], a[64:67], a[100:103], v[64:67]
    ds_read_b64_tr_b16 a[124:125], v85 offset:43136
    v_mfma_f32_16x16x32_bf16 v[72:75], a[68:71], a[100:103], v[72:75]
    ds_read_b64_tr_b16 a[126:127], v85 offset:43648
    s_barrier
    s_setprio 3
    s_waitcnt lgkmcnt(10)
    v_mfma_f32_16x16x32_bf16 v[28:31], a[104:107], a[72:75], v[28:31]
    ds_read_b128 a[64:67], v80 offset:0
    ds_read_b128 a[68:71], v82 offset:0
    v_mfma_f32_16x16x32_bf16 v[44:47], a[104:107], a[76:79], v[44:47]
    ds_read_b64_tr_b16 a[80:81], v24 offset:0
    s_waitcnt lgkmcnt(11)
    v_mfma_f32_16x16x32_bf16 v[32:35], a[108:111], a[72:75], v[32:35]
    ds_read_b64_tr_b16 a[82:83], v24 offset:512
    v_mfma_f32_16x16x32_bf16 v[48:51], a[108:111], a[76:79], v[48:51]
    ds_read_b64_tr_b16 a[84:85], v25 offset:0
    s_waitcnt lgkmcnt(11)
    v_mfma_f32_16x16x32_bf16 v[36:39], a[112:115], a[72:75], v[36:39]
    ds_read_b64_tr_b16 a[86:87], v25 offset:512
    v_mfma_f32_16x16x32_bf16 v[52:55], a[112:115], a[76:79], v[52:55]
    ds_read_b64_tr_b16 a[88:89], v26 offset:0
    s_setprio 2
    s_waitcnt lgkmcnt(11)
    v_mfma_f32_16x16x32_bf16 v[40:43], a[116:119], a[72:75], v[40:43]
    ds_read_b64_tr_b16 a[90:91], v26 offset:512
    ds_read_b64_tr_b16 a[92:93], v27 offset:0
    v_mfma_f32_16x16x32_bf16 v[56:59], a[116:119], a[76:79], v[56:59]
    ds_read_b64_tr_b16 a[94:95], v27 offset:512
    s_waitcnt lgkmcnt(12)
    v_mfma_f32_16x16x32_bf16 v[60:63], a[72:75], a[120:123], v[60:63]
    ds_read_b64_tr_b16 a[96:97], v86 offset:0
    v_mfma_f32_16x16x32_bf16 v[68:71], a[76:79], a[120:123], v[68:71]
    ds_read_b64_tr_b16 a[98:99], v86 offset:512
    s_waitcnt lgkmcnt(12)
    v_mfma_f32_16x16x32_bf16 v[64:67], a[72:75], a[124:127], v[64:67]
    ds_read_b64_tr_b16 a[100:101], v87 offset:0
    v_mfma_f32_16x16x32_bf16 v[72:75], a[76:79], a[124:127], v[72:75]
    ds_read_b64_tr_b16 a[102:103], v87 offset:512
    buffer_store_dwordx4 v[100:103], v13, s[28:31], s58 offen sc1
    s_cmp_eq_u32 s42, 2
    s_cbranch_scc1 Lxe2
Lxe2_b:
    s_setprio 1
    s_waitcnt lgkmcnt(10)
    v_mfma_f32_16x16x32_bf16 v[28:31], a[80:83], a[64:67], v[28:31]
    ds_read_b128 a[72:75], v81 offset:0
    ds_read_b128 a[76:79], v83 offset:0
    v_mfma_f32_16x16x32_bf16 v[44:47], a[80:83], a[68:71], v[44:47]
    ds_read_b64_tr_b16 a[104:105], v24 offset:4096
    s_waitcnt lgkmcnt(11)
    v_mfma_f32_16x16x32_bf16 v[32:35], a[84:87], a[64:67], v[32:35]
    ds_read_b64_tr_b16 a[106:107], v24 offset:4608
    v_mfma_f32_16x16x32_bf16 v[48:51], a[84:87], a[68:71], v[48:51]
    ds_read_b64_tr_b16 a[108:109], v25 offset:4096
    s_waitcnt lgkmcnt(11)
    v_mfma_f32_16x16x32_bf16 v[36:39], a[88:91], a[64:67], v[36:39]
    ds_read_b64_tr_b16 a[110:111], v25 offset:4608
    ds_read_b64_tr_b16 a[112:113], v26 offset:4096
    v_mfma_f32_16x16x32_bf16 v[52:55], a[88:91], a[68:71], v[52:55]
    ds_read_b64_tr_b16 a[114:115], v26 offset:4608
    s_setprio 0
    s_waitcnt lgkmcnt(12)
    v_mfma_f32_16x16x32_bf16 v[40:43], a[92:95], a[64:67], v[40:43]
    ds_read_b64_tr_b16 a[116:117], v27 offset:4096
    v_mfma_f32_16x16x32_bf16 v[56:59], a[92:95], a[68:71], v[56:59]
    ds_read_b64_tr_b16 a[118:119], v27 offset:4608
    s_waitcnt lgkmcnt(12)
    v_mfma_f32_16x16x32_bf16 v[60:63], a[64:67], a[96:99], v[60:63]
    ds_read_b64_tr_b16 a[120:121], v86 offset:4096
    v_mfma_f32_16x16x32_bf16 v[68:71], a[68:71], a[96:99], v[68:71]
    ds_read_b64_tr_b16 a[122:123], v86 offset:4608
    s_waitcnt lgkmcnt(12)
    v_mfma_f32_16x16x32_bf16 v[64:67], a[64:67], a[100:103], v[64:67]
    ds_read_b64_tr_b16 a[124:125], v87 offset:4096
    v_mfma_f32_16x16x32_bf16 v[72:75], a[68:71], a[100:103], v[72:75]
    ds_read_b64_tr_b16 a[126:127], v87 offset:4608
    s_barrier
    s_setprio 3
    s_waitcnt lgkmcnt(10)
    v_mfma_f32_16x16x32_bf16 v[28:31], a[104:107], a[72:75], v[28:31]
    ds_read_b128 a[64:67], v80 offset:39040
    ds_read_b128 a[68:71], v82 offset:39040
    v_mfma_f32_16x16x32_bf16 v[44:47], a[104:107], a[76:79], v[44:47]
    ds_read_b64_tr_b16 a[80:81], v24 offset:39040
    s_waitcnt lgkmcnt(11)
    v_mfma_f32_16x16x32_bf16 v[32:35], a[108:111], a[72:75], v[32:35]
    ds_read_b64_tr_b16 a[82:83], v24 offset:39552
    v_mfma_f32_16x16x32_bf16 v[48:51], a[108:111], a[76:79], v[48:51]
    ds_read_b64_tr_b16 a[84:85], v25 offset:39040
    s_waitcnt lgkmcnt(11)
    v_mfma_f32_16x16x32_bf16 v[36:39], a[112:115], a[72:75], v[36:39]
    ds_read_b64_tr_b16 a[86:87], v25 offset:39552
    v_mfma_f32_16x16x32_bf16 v[52:55], a[112:115], a[76:79], v[52:55]
    ds_read_b64_tr_b16 a[88:89], v26 offset:39040
    s_setprio 2
    s_waitcnt lgkmcnt(11)
    v_mfma_f32_16x16x32_bf16 v[40:43], a[116:119], a[72:75], v[40:43]
    ds_read_b64_tr_b16 a[90:91], v26 offset:39552
    ds_read_b64_tr_b16 a[92:93], v27 offset:39040
    v_mfma_f32_16x16x32_bf16 v[56:59], a[116:119], a[76:79], v[56:59]
    ds_read_b64_tr_b16 a[94:95], v27 offset:39552
    s_waitcnt lgkmcnt(12)
    v_mfma_f32_16x16x32_bf16 v[60:63], a[72:75], a[120:123], v[60:63]
    ds_read_b64_tr_b16 a[96:97], v86 offset:39040
    v_mfma_f32_16x16x32_bf16 v[68:71], a[76:79], a[120:123], v[68:71]
    ds_read_b64_tr_b16 a[98:99], v86 offset:39552
    s_waitcnt lgkmcnt(12)
    v_mfma_f32_16x16x32_bf16 v[64:67], a[72:75], a[124:127], v[64:67]
    ds_read_b64_tr_b16 a[100:101], v87 offset:39040
    v_mfma_f32_16x16x32_bf16 v[72:75], a[76:79], a[124:127], v[72:75]
    ds_read_b64_tr_b16 a[102:103], v87 offset:39552
    s_cmp_eq_u32 s42, 3
    s_cbranch_scc1 Lxe3
Lxe3_b:
    s_setprio 1
    s_waitcnt lgkmcnt(10)
    v_mfma_f32_16x16x32_bf16 v[28:31], a[80:83], a[64:67], v[28:31]
    ds_read_b128 a[72:75], v81 offset:39040
    ds_read_b128 a[76:79], v83 offset:39040
    v_mfma_f32_16x16x32_bf16 v[44:47], a[80:83], a[68:71], v[44:47]
    ds_read_b64_tr_b16 a[104:105], v24 offset:43136
    s_waitcnt lgkmcnt(11)
    v_mfma_f32_16x16x32_bf16 v[32:35], a[84:87], a[64:67], v[32:35]
    ds_read_b64_tr_b16 a[106:107], v24 offset:43648
    v_mfma_f32_16x16x32_bf16 v[48:51], a[84:87], a[68:71], v[48:51]
    ds_read_b64_tr_b16 a[108:109], v25 offset:43136
    s_waitcnt lgkmcnt(11)
    v_mfma_f32_16x16x32_bf16 v[36:39], a[88:91], a[64:67], v[36:39]
    ds_read_b64_tr_b16 a[110:111], v25 offset:43648
    ds_read_b64_tr_b16 a[112:113], v26 offset:43136
    v_mfma_f32_16x16x32_bf16 v[52:55], a[88:91], a[68:71], v[52:55]
    ds_read_b64_tr_b16 a[114:115], v26 offset:43648
    s_setprio 0
    s_waitcnt lgkmcnt(12)
    v_mfma_f32_16x16x32_bf16 v[40:43], a[92:95], a[64:67], v[40:43]
    ds_read_b64_tr_b16 a[116:117], v27 offset:43136
    v_mfma_f32_16x16x32_bf16 v[56:59], a[92:95], a[68:71], v[56:59]
    ds_read_b64_tr_b16 a[118:119], v27 offset:43648
    s_waitcnt lgkmcnt(12)
    v_mfma_f32_16x16x32_bf16 v[60:63], a[64:67], a[96:99], v[60:63]
    ds_read_b64_tr_b16 a[120:121], v86 offset:43136
    v_mfma_f32_16x16x32_bf16 v[68:71], a[68:71], a[96:99], v[68:71]
    ds_read_b64_tr_b16 a[122:123], v86 offset:43648
    s_waitcnt lgkmcnt(12)
    v_mfma_f32_16x16x32_bf16 v[64:67], a[64:67], a[100:103], v[64:67]
    ds_read_b64_tr_b16 a[124:125], v87 offset:43136
    v_mfma_f32_16x16x32_bf16 v[72:75], a[68:71], a[100:103], v[72:75]
    ds_read_b64_tr_b16 a[126:127], v87 offset:43648
    s_barrier
    s_setprio 3
    s_waitcnt lgkmcnt(10)
    v_mfma_f32_16x16x32_bf16 v[28:31], a[104:107], a[72:75], v[28:31]
    ds_read_b128 a[64:67], v76 offset:0
    ds_read_b128 a[68:71], v78 offset:0
    v_mfma_f32_16x16x32_bf16 v[44:47], a[104:107], a[76:79], v[44:47]
    ds_read_b64_tr_b16 a[80:81], v20 offset:0
    s_waitcnt lgkmcnt(11)
    v_mfma_f32_16x16x32_bf16 v[32:35], a[108:111], a[72:75], v[32:35]
    ds_read_b64_tr_b16 a[82:83], v20 offset:512
    v_mfma_f32_16x16x32_bf16 v[48:51], a[108:111], a[76:79], v[48:51]
    ds_read_b64_tr_b16 a[84:85], v21 offset:0
    s_waitcnt lgkmcnt(11)
    v_mfma_f32_16x16x32_bf16 v[36:39], a[112:115], a[72:75], v[36:39]
    ds_read_b64_tr_b16 a[86:87], v21 offset:512
    v_mfma_f32_16x16x32_bf16 v[52:55], a[112:115], a[76:79], v[52:55]
    ds_read_b64_tr_b16 a[88:89], v22 offset:0
    s_setprio 2
    s_waitcnt lgkmcnt(11)
    v_mfma_f32_16x16x32_bf16 v[40:43], a[116:119], a[72:75], v[40:43]
    ds_read_b64_tr_b16 a[90:91], v22 offset:512
    ds_read_b64_tr_b16 a[92:93], v23 offset:0
    v_mfma_f32_16x16x32_bf16 v[56:59], a[116:119], a[76:79], v[56:59]
    ds_read_b64_tr_b16 a[94:95], v23 offset:512
    s_waitcnt lgkmcnt(12)
    v_mfma_f32_16x16x32_bf16 v[60:63], a[72:75], a[120:123], v[60:63]
    ds_read_b64_tr_b16 a[96:97], v84 offset:0
    v_mfma_f32_16x16x32_bf16 v[68:71], a[76:79], a[120:123], v[68:71]
    ds_read_b64_tr_b16 a[98:99], v84 offset:512
    s_waitcnt lgkmcnt(12)
    v_mfma_f32_16x16x32_bf16 v[64:67], a[72:75], a[124:127], v[64:67]
    ds_read_b64_tr_b16 a[100:101], v85 offset:0
    v_mfma_f32_16x16x32_bf16 v[72:75], a[76:79], a[124:127], v[72:75]
    ds_read_b64_tr_b16 a[102:103], v85 offset:512
    buffer_store_dwordx4 v[100:103], v13, s[28:31], s23 offen offset:0 sc1
    s_cmp_eq_u32 s42, 4
    s_cbranch_scc1 Lxe4
Lxe4_b:
    s_setprio 1
    s_waitcnt lgkmcnt(10)
    v_mfma_f32_16x16x32_bf16 v[28:31], a[80:83], a[64:67], v[28:31]
    ds_read_b128 a[72:75], v77 offset:0
    ds_read_b128 a[76:79], v79 offset:0
    v_mfma_f32_16x16x32_bf16 v[44:47], a[80:83], a[68:71], v[44:47]
    ds_read_b64_tr_b16 a[104:105], v20 offset:4096
    s_waitcnt lgkmcnt(11)
    v_mfma_f32_16x16x32_bf16 v[32:35], a[84:87], a[64:67], v[32:35]
    ds_read_b64_tr_b16 a[106:107], v20 offset:4608
    v_mfma_f32_16x16x32_bf16 v[48:51], a[84:87], a[68:71], v[48:51]
    ds_read_b64_tr_b16 a[108:109], v21 offset:4096
    s_waitcnt lgkmcnt(11)
    v_mfma_f32_16x16x32_bf16 v[36:39], a[88:91], a[64:67], v[36:39]
    ds_read_b64_tr_b16 a[110:111], v21 offset:4608
    ds_read_b64_tr_b16 a[112:113], v22 offset:4096
    v_mfma_f32_16x16x32_bf16 v[52:55], a[88:91], a[68:71], v[52:55]
    ds_read_b64_tr_b16 a[114:115], v22 offset:4608
    s_setprio 0
    s_waitcnt lgkmcnt(12)
    v_mfma_f32_16x16x32_bf16 v[40:43], a[92:95], a[64:67], v[40:43]
    ds_read_b64_tr_b16 a[116:117], v23 offset:4096
    v_mfma_f32_16x16x32_bf16 v[56:59], a[92:95], a[68:71], v[56:59]
    ds_read_b64_tr_b16 a[118:119], v23 offset:4608
    s_waitcnt lgkmcnt(12)
    v_mfma_f32_16x16x32_bf16 v[60:63], a[64:67], a[96:99], v[60:63]
    ds_read_b64_tr_b16 a[120:121], v84 offset:4096
    v_mfma_f32_16x16x32_bf16 v[68:71], a[68:71], a[96:99], v[68:71]
    ds_read_b64_tr_b16 a[122:123], v84 offset:4608
    s_waitcnt lgkmcnt(12)
    v_mfma_f32_16x16x32_bf16 v[64:67], a[64:67], a[100:103], v[64:67]
    ds_read_b64_tr_b16 a[124:125], v85 offset:4096
    v_mfma_f32_16x16x32_bf16 v[72:75], a[68:71], a[100:103], v[72:75]
    ds_read_b64_tr_b16 a[126:127], v85 offset:4608
    s_barrier
    s_setprio 3
    s_waitcnt lgkmcnt(10)
    v_mfma_f32_16x16x32_bf16 v[28:31], a[104:107], a[72:75], v[28:31]
    ds_read_b128 a[64:67], v76 offset:39040
    ds_read_b128 a[68:71], v78 offset:39040
    v_mfma_f32_16x16x32_bf16 v[44:47], a[104:107], a[76:79], v[44:47]
    ds_read_b64_tr_b16 a[80:81], v20 offset:39040
    s_waitcnt lgkmcnt(11)
    v_mfma_f32_16x16x32_bf16 v[32:35], a[108:111], a[72:75], v[32:35]
    ds_read_b64_tr_b16 a[82:83], v20 offset:39552
    v_mfma_f32_16x16x32_bf16 v[48:51], a[108:111], a[76:79], v[48:51]
    ds_read_b64_tr_b16 a[84:85], v21 offset:39040
    s_waitcnt lgkmcnt(11)
    v_mfma_f32_16x16x32_bf16 v[36:39], a[112:115], a[72:75], v[36:39]
    ds_read_b64_tr_b16 a[86:87], v21 offset:39552
    v_mfma_f32_16x16x32_bf16 v[52:55], a[112:115], a[76:79], v[52:55]
    ds_read_b64_tr_b16 a[88:89], v22 offset:39040
    s_setprio 2
    s_waitcnt lgkmcnt(11)
    v_mfma_f32_16x16x32_bf16 v[40:43], a[116:119], a[72:75], v[40:43]
    ds_read_b64_tr_b16 a[90:91], v22 offset:39552
    ds_read_b64_tr_b16 a[92:93], v23 offset:39040
    v_mfma_f32_16x16x32_bf16 v[56:59], a[116:119], a[76:79], v[56:59]
    ds_read_b64_tr_b16 a[94:95], v23 offset:39552
    s_waitcnt lgkmcnt(12)
    v_mfma_f32_16x16x32_bf16 v[60:63], a[72:75], a[120:123], v[60:63]
    ds_read_b64_tr_b16 a[96:97], v84 offset:39040
    v_mfma_f32_16x16x32_bf16 v[68:71], a[76:79], a[120:123], v[68:71]
    ds_read_b64_tr_b16 a[98:99], v84 offset:39552
    s_waitcnt lgkmcnt(12)
    v_mfma_f32_16x16x32_bf16 v[64:67], a[72:75], a[124:127], v[64:67]
    ds_read_b64_tr_b16 a[100:101], v85 offset:39040
    v_mfma_f32_16x16x32_bf16 v[72:75], a[76:79], a[124:127], v[72:75]
    ds_read_b64_tr_b16 a[102:103], v85 offset:39552
    s_cmp_eq_u32 s42, 5
    s_cbranch_scc1 Lxe5
Lxe5_b:
    s_setprio 1
    s_waitcnt lgkmcnt(10)
    v_mfma_f32_16x16x32_bf16 v[28:31], a[80:83], a[64:67], v[28:31]
    ds_read_b128 a[72:75], v77 offset:39040
    ds_read_b128 a[76:79], v79 offset:39040
    v_mfma_f32_16x16x32_bf16 v[44:47], a[80:83], a[68:71], v[44:47]
    ds_read_b64_tr_b16 a[104:105], v20 offset:43136
    s_waitcnt lgkmcnt(11)
    v_mfma_f32_16x16x32_bf16 v[32:35], a[84:87], a[64:67], v[32:35]
    ds_read_b64_tr_b16 a[106:107], v20 offset:43648
    v_mfma_f32_16x16x32_bf16 v[48:51], a[84:87], a[68:71], v[48:51]
    ds_read_b64_tr_b16 a[108:109], v21 offset:43136
    s_waitcnt lgkmcnt(11)
    v_mfma_f32_16x16x32_bf16 v[36:39], a[88:91], a[64:67], v[36:39]
    ds_read_b64_tr_b16 a[110:111], v21 offset:43648
    ds_read_b64_tr_b16 a[112:113], v22 offset:43136
    v_mfma_f32_16x16x32_bf16 v[52:55], a[88:91], a[68:71], v[52:55]
    ds_read_b64_tr_b16 a[114:115], v22 offset:43648
    s_setprio 0
    s_waitcnt lgkmcnt(12)
    v_mfma_f32_16x16x32_bf16 v[40:43], a[92:95], a[64:67], v[40:43]
    ds_read_b64_tr_b16 a[116:117], v23 offset:43136
    v_mfma_f32_16x16x32_bf16 v[56:59], a[92:95], a[68:71], v[56:59]
    ds_read_b64_tr_b16 a[118:119], v23 offset:43648
    s_waitcnt lgkmcnt(12)
    v_mfma_f32_16x16x32_bf16 v[60:63], a[64:67], a[96:99], v[60:63]
    ds_read_b64_tr_b16 a[120:121], v84 offset:43136
    v_mfma_f32_16x16x32_bf16 v[68:71], a[68:71], a[96:99], v[68:71]
    ds_read_b64_tr_b16 a[122:123], v84 offset:43648
    s_waitcnt lgkmcnt(12)
    v_mfma_f32_16x16x32_bf16 v[64:67], a[64:67], a[100:103], v[64:67]
    ds_read_b64_tr_b16 a[124:125], v85 offset:43136
    v_mfma_f32_16x16x32_bf16 v[72:75], a[68:71], a[100:103], v[72:75]
    ds_read_b64_tr_b16 a[126:127], v85 offset:43648
    s_barrier
    s_setprio 3
    s_waitcnt lgkmcnt(10)
    v_mfma_f32_16x16x32_bf16 v[28:31], a[104:107], a[72:75], v[28:31]
    ds_read_b128 a[0:3], v80 offset:0
    v_mfma_f32_16x16x32_bf16 v[44:47], a[104:107], a[76:79], v[44:47]
    ds_read_b128 a[4:7], v82 offset:0
    s_waitcnt lgkmcnt(10)
    v_mfma_f32_16x16x32_bf16 v[32:35], a[108:111], a[72:75], v[32:35]
    ds_read_b64_tr_b16 a[80:81], v24 offset:0
    v_mfma_f32_16x16x32_bf16 v[48:51], a[108:111], a[76:79], v[48:51]
    ds_read_b64_tr_b16 a[82:83], v24 offset:512
    s_waitcnt lgkmcnt(10)
    v_mfma_f32_16x16x32_bf16 v[36:39], a[112:115], a[72:75], v[36:39]
    ds_read_b64_tr_b16 a[84:85], v25 offset:0
    v_mfma_f32_16x16x32_bf16 v[52:55], a[112:115], a[76:79], v[52:55]
    s_setprio 2
    s_waitcnt lgkmcnt(9)
    v_mfma_f32_16x16x32_bf16 v[40:43], a[116:119], a[72:75], v[40:43]
    ds_read_b64_tr_b16 a[86:87], v25 offset:512
    v_mfma_f32_16x16x32_bf16 v[56:59], a[116:119], a[76:79], v[56:59]
    ds_read_b64_tr_b16 a[88:89], v26 offset:0
    s_waitcnt lgkmcnt(9)
    v_mfma_f32_16x16x32_bf16 v[60:63], a[72:75], a[120:123], v[60:63]
    ds_read_b64_tr_b16 a[90:91], v26 offset:512
    v_mfma_f32_16x16x32_bf16 v[68:71], a[76:79], a[120:123], v[68:71]
    ds_read_b64_tr_b16 a[92:93], v27 offset:0
    s_waitcnt lgkmcnt(9)
    v_mfma_f32_16x16x32_bf16 v[64:67], a[72:75], a[124:127], v[64:67]
    ds_read_b64_tr_b16 a[94:95], v27 offset:512
    v_mfma_f32_16x16x32_bf16 v[72:75], a[76:79], a[124:127], v[72:75]
    buffer_store_dwordx4 v[100:103], v13, s[28:31], s23 offen offset:1024 sc1
    s_cmp_eq_u32 s42, 6
    s_cbranch_scc1 Lxe6
Lxe6_b:
    s_setprio 1
    s_waitcnt lgkmcnt(6)
    v_mfma_f32_16x16x32_bf16 v[28:31], a[80:83], a[0:3], v[28:31]
    ds_read_b128 a[8:11], v81 offset:0
    ds_read_b128 a[12:15], v83 offset:0
    v_mfma_f32_16x16x32_bf16 v[44:47], a[80:83], a[4:7], v[44:47]
    ds_read_b64_tr_b16 a[104:105], v24 offset:4096
    s_waitcnt lgkmcnt(7)
    v_mfma_f32_16x16x32_bf16 v[32:35], a[84:87], a[0:3], v[32:35]
    ds_read_b64_tr_b16 a[106:107], v24 offset:4608
    ds_read_b64_tr_b16 a[108:109], v25 offset:4096
    v_mfma_f32_16x16x32_bf16 v[48:51], a[84:87], a[4:7], v[48:51]
    ds_read_b64_tr_b16 a[110:111], v25 offset:4608
    s_setprio 0
    s_waitcnt lgkmcnt(8)
    v_mfma_f32_16x16x32_bf16 v[36:39], a[88:91], a[0:3], v[36:39]
    v_mfma_f32_16x16x32_bf16 v[52:55], a[88:91], a[4:7], v[52:55]
    ds_read_b64_tr_b16 a[112:113], v26 offset:4096
    ds_read_b64_tr_b16 a[114:115], v26 offset:4608
    s_waitcnt lgkmcnt(8)
    v_mfma_f32_16x16x32_bf16 v[40:43], a[92:95], a[0:3], v[40:43]
    ds_read_b64_tr_b16 a[116:117], v27 offset:4096
    v_mfma_f32_16x16x32_bf16 v[56:59], a[92:95], a[4:7], v[56:59]
    ds_read_b64_tr_b16 a[118:119], v27 offset:4608
    s_barrier
    s_setprio 3
    s_waitcnt lgkmcnt(6)
    v_mfma_f32_16x16x32_bf16 v[28:31], a[104:107], a[8:11], v[28:31]
    ds_read_b128 a[16:19], v80 offset:39040
    ds_read_b128 a[20:23], v82 offset:39040
    v_mfma_f32_16x16x32_bf16 v[44:47], a[104:107], a[12:15], v[44:47]
    ds_read_b64_tr_b16 a[80:81], v24 offset:39040
    s_waitcnt lgkmcnt(7)
    v_mfma_f32_16x16x32_bf16 v[32:35], a[108:111], a[8:11], v[32:35]
    ds_read_b64_tr_b16 a[82:83], v24 offset:39552
    v_mfma_f32_16x16x32_bf16 v[48:51], a[108:111], a[12:15], v[48:51]
    ds_read_b64_tr_b16 a[84:85], v25 offset:39040
    s_setprio 2
    s_waitcnt lgkmcnt(7)
    v_mfma_f32_16x16x32_bf16 v[36:39], a[112:115], a[8:11], v[36:39]
    ds_read_b64_tr_b16 a[86:87], v25 offset:39552
    ds_read_b64_tr_b16 a[88:89], v26 offset:39040
    v_mfma_f32_16x16x32_bf16 v[52:55], a[112:115], a[12:15], v[52:55]
    ds_read_b64_tr_b16 a[90:91], v26 offset:39552
    s_waitcnt lgkmcnt(8)
    v_mfma_f32_16x16x32_bf16 v[40:43], a[116:119], a[8:11], v[40:43]
    ds_read_b64_tr_b16 a[92:93], v27 offset:39040
    v_mfma_f32_16x16x32_bf16 v[56:59], a[116:119], a[12:15], v[56:59]
    ds_read_b64_tr_b16 a[94:95], v27 offset:39552
    s_cmp_eq_u32 s42, 7
    s_cbranch_scc1 Lxe7
Lxe7_b:
    s_setprio 1
    s_waitcnt lgkmcnt(6)
    v_mfma_f32_16x16x32_bf16 v[28:31], a[80:83], a[16:19], v[28:31]
    ds_read_b128 a[24:27], v81 offset:39040
    ds_read_b128 a[28:31], v83 offset:39040
    v_mfma_f32_16x16x32_bf16 v[44:47], a[80:83], a[20:23], v[44:47]
    ds_read_b64_tr_b16 a[104:105], v24 offset:43136
    s_waitcnt lgkmcnt(7)
    v_mfma_f32_16x16x32_bf16 v[32:35], a[84:87], a[16:19], v[32:35]
    ds_read_b64_tr_b16 a[106:107], v24 offset:43648
    ds_read_b64_tr_b16 a[108:109], v25 offset:43136
    v_mfma_f32_16x16x32_bf16 v[48:51], a[84:87], a[20:23], v[48:51]
    ds_read_b64_tr_b16 a[110:111], v25 offset:43648
    s_setprio 0
    s_waitcnt lgkmcnt(8)
    v_mfma_f32_16x16x32_bf16 v[36:39], a[88:91], a[16:19], v[36:39]
    v_mfma_f32_16x16x32_bf16 v[52:55], a[88:91], a[20:23], v[52:55]
    ds_read_b64_tr_b16 a[112:113], v26 offset:43136
    ds_read_b64_tr_b16 a[114:115], v26 offset:43648
    s_waitcnt lgkmcnt(8)
    v_mfma_f32_16x16x32_bf16 v[40:43], a[92:95], a[16:19], v[40:43]
    ds_read_b64_tr_b16 a[116:117], v27 offset:43136
    v_mfma_f32_16x16x32_bf16 v[56:59], a[92:95], a[20:23], v[56:59]
    ds_read_b64_tr_b16 a[118:119], v27 offset:43648
    s_barrier
    s_setprio 3
    s_waitcnt lgkmcnt(6)
    v_mfma_f32_16x16x32_bf16 v[28:31], a[104:107], a[24:27], v[28:31]
    ds_read_b128 a[32:35], v76 offset:0
    ds_read_b128 a[36:39], v78 offset:0
    v_mfma_f32_16x16x32_bf16 v[44:47], a[104:107], a[28:31], v[44:47]
    ds_read_b64_tr_b16 a[80:81], v20 offset:0
    s_waitcnt lgkmcnt(7)
    v_mfma_f32_16x16x32_bf16 v[32:35], a[108:111], a[24:27], v[32:35]
    ds_read_b64_tr_b16 a[82:83], v20 offset:512
    v_mfma_f32_16x16x32_bf16 v[48:51], a[108:111], a[28:31], v[48:51]
    ds_read_b64_tr_b16 a[84:85], v21 offset:0
    s_setprio 2
    s_waitcnt lgkmcnt(7)
    v_mfma_f32_16x16x32_bf16 v[36:39], a[112:115], a[24:27], v[36:39]
    ds_read_b64_tr_b16 a[86:87], v21 offset:512
    ds_read_b64_tr_b16 a[88:89], v22 offset:0
    v_mfma_f32_16x16x32_bf16 v[52:55], a[112:115], a[28:31], v[52:55]
    ds_read_b64_tr_b16 a[90:91], v22 offset:512
    s_waitcnt lgkmcnt(8)
    v_mfma_f32_16x16x32_bf16 v[40:43], a[116:119], a[24:27], v[40:43]
    ds_read_b64_tr_b16 a[92:93], v23 offset:0
    v_mfma_f32_16x16x32_bf16 v[56:59], a[116:119], a[28:31], v[56:59]
    ds_read_b64_tr_b16 a[94:95], v23 offset:512
    s_cmp_eq_u32 s42, 8
    s_cbranch_scc1 Lxe8
Lxe8_b:
    s_setprio 1
    s_waitcnt lgkmcnt(6)
    v_mfma_f32_16x16x32_bf16 v[28:31], a[80:83], a[32:35], v[28:31]
    ds_read_b128 a[40:43], v77 offset:0
    ds_read_b128 a[44:47], v79 offset:0
    v_mfma_f32_16x16x32_bf16 v[44:47], a[80:83], a[36:39], v[44:47]
    ds_read_b64_tr_b16 a[104:105], v20 offset:4096
    s_waitcnt lgkmcnt(7)
    v_mfma_f32_16x16x32_bf16 v[32:35], a[84:87], a[32:35], v[32:35]
    ds_read_b64_tr_b16 a[106:107], v20 offset:4608
    v_mfma_f32_16x16x32_bf16 v[48:51], a[84:87], a[36:39], v[48:51]
    ds_read_b64_tr_b16 a[108:109], v21 offset:4096
    s_setprio 0
    s_waitcnt lgkmcnt(7)
    v_mfma_f32_16x16x32_bf16 v[36:39], a[88:91], a[32:35], v[36:39]
    ds_read_b64_tr_b16 a[110:111], v21 offset:4608
    ds_read_b64_tr_b16 a[112:113], v22 offset:4096
    v_mfma_f32_16x16x32_bf16 v[52:55], a[88:91], a[36:39], v[52:55]
    ds_read_b64_tr_b16 a[114:115], v22 offset:4608
    s_waitcnt lgkmcnt(8)
    v_mfma_f32_16x16x32_bf16 v[40:43], a[92:95], a[32:35], v[40:43]
    ds_read_b64_tr_b16 a[116:117], v23 offset:4096
    v_mfma_f32_16x16x32_bf16 v[56:59], a[92:95], a[36:39], v[56:59]
    ds_read_b64_tr_b16 a[118:119], v23 offset:4608
    s_waitcnt lgkmcnt(0)
    s_barrier
    s_setprio 3
    v_mfma_f32_16x16x32_bf16 v[28:31], a[104:107], a[40:43], v[28:31]
    ds_read_b128 a[48:51], v76 offset:39040
    ds_read_b128 a[52:55], v78 offset:39040
    v_mfma_f32_16x16x32_bf16 v[44:47], a[104:107], a[44:47], v[44:47]
    ds_read_b64_tr_b16 a[80:81], v20 offset:39040
    v_mfma_f32_16x16x32_bf16 v[32:35], a[108:111], a[40:43], v[32:35]
    ds_read_b64_tr_b16 a[82:83], v20 offset:39552
    v_mfma_f32_16x16x32_bf16 v[48:51], a[108:111], a[44:47], v[48:51]
    ds_read_b64_tr_b16 a[84:85], v21 offset:39040
    s_setprio 2
    v_mfma_f32_16x16x32_bf16 v[36:39], a[112:115], a[40:43], v[36:39]
    ds_read_b64_tr_b16 a[86:87], v21 offset:39552
    ds_read_b64_tr_b16 a[88:89], v22 offset:39040
    v_mfma_f32_16x16x32_bf16 v[52:55], a[112:115], a[44:47], v[52:55]
    ds_read_b64_tr_b16 a[90:91], v22 offset:39552
    v_mfma_f32_16x16x32_bf16 v[40:43], a[116:119], a[40:43], v[40:43]
    ds_read_b64_tr_b16 a[92:93], v23 offset:39040
    v_mfma_f32_16x16x32_bf16 v[56:59], a[116:119], a[44:47], v[56:59]
    ds_read_b64_tr_b16 a[94:95], v23 offset:39552
    v_mov_b32 v98, s34
    s_waitcnt vmcnt(0)
    s_mov_b64 exec, 1
    buffer_store_dword v98, v97, s[28:31], s24 offen sc1
    s_mov_b64 exec, -1
    s_cmp_eq_u32 s42, 9
    s_cbranch_scc1 Lxe9
Lxe9_b:
    s_setprio 1
    s_waitcnt lgkmcnt(6)
    v_mfma_f32_16x16x32_bf16 v[28:31], a[80:83], a[48:51], v[28:31]
    ds_read_b128 a[56:59], v77 offset:39040
    ds_read_b128 a[60:63], v79 offset:39040
    ds_read_b64_tr_b16 a[104:105], v20 offset:43136
    v_mfma_f32_16x16x32_bf16 v[44:47], a[80:83], a[52:55], v[44:47]
    ds_read_b64_tr_b16 a[106:107], v20 offset:43648
    ds_read_b64_tr_b16 a[108:109], v21 offset:43136
    s_waitcnt lgkmcnt(9)
    v_mfma_f32_16x16x32_bf16 v[32:35], a[84:87], a[48:51], v[32:35]
    ds_read_b64_tr_b16 a[110:111], v21 offset:43648
    ds_read_b64_tr_b16 a[112:113], v22 offset:43136
    ds_read_b64_tr_b16 a[114:115], v22 offset:43648
    v_mfma_f32_16x16x32_bf16 v[48:51], a[84:87], a[52:55], v[48:51]
    ds_read_b64_tr_b16 a[116:117], v23 offset:43136
    ds_read_b64_tr_b16 a[118:119], v23 offset:43648
    s_setprio 0
    s_waitcnt lgkmcnt(12)
    v_mfma_f32_16x16x32_bf16 v[36:39], a[88:91], a[48:51], v[36:39]
    ds_read_b32 v120, v94
    ds_read_b32 v121, v94 offset:512
    v_xor_b32 v94, 64, v94
    v_mfma_f32_16x16x32_bf16 v[52:55], a[88:91], a[52:55], v[52:55]
    ds_read_b32 v122, v94
    ds_read_b32 v123, v92 offset:512
    s_waitcnt lgkmcnt(14)
    v_mfma_f32_16x16x32_bf16 v[40:43], a[92:95], a[48:51], v[40:43]
    ds_read_b32 v126, v93 offset:520
    v_mov_b32 v24, v84
    v_mov_b32 v25, v85
    v_mfma_f32_16x16x32_bf16 v[56:59], a[92:95], a[52:55], v[56:59]
    v_mov_b32 v26, v86
    v_mov_b32 v27, v87
    s_waitcnt lgkmcnt(5)
    v_mfma_f32_16x16x32_bf16 v[44:47], a[104:107], a[60:63], v[44:47]
    v_mfma_f32_16x16x32_bf16 v[48:51], a[108:111], a[60:63], v[48:51]
    v_mfma_f32_16x16x32_bf16 v[52:55], a[112:115], a[60:63], v[52:55]
    v_mfma_f32_16x16x32_bf16 v[56:59], a[116:119], a[60:63], v[56:59]
    v_mfma_f32_16x16x32_bf16 v[28:31], a[104:107], a[56:59], v[28:31]
    v_mfma_f32_16x16x32_bf16 v[32:35], a[108:111], a[56:59], v[32:35]
    ds_read_b32 v7, v96
    ds_read_b128 v[76:79], v95 offset:0
    ds_read_b128 v[80:83], v95 offset:64
    ds_read_b128 v[84:87], v95 offset:128
    ds_read_b128 v[88:91], v95 offset:192
    v_mfma_f32_16x16x32_bf16 v[36:39], a[112:115], a[56:59], v[36:39]
    v_mfma_f32_16x16x32_bf16 v[40:43], a[116:119], a[56:59], v[40:43]
    s_waitcnt lgkmcnt(0)
Lqf:
    v_readfirstlane_b32 s38, v7
    s_nop 0
    s_cmp_eq_u32 s38, 0
    s_cbranch_scc1 Lqf_re
    s_cmp_eq_u32 s27, 0
    v_fmac_f32 v44, v76, v122
    v_fmac_f32 v45, v77, v122
    v_fmac_f32 v46, v78, v122
    v_fmac_f32 v47, v79, v122
    v_cvt_pk_bf16_f32 v44, v44, v45
    v_cvt_pk_bf16_f32 v45, v46, v47
    v_fmac_f32 v48, v80, v122
    v_fmac_f32 v49, v81, v122
    v_fmac_f32 v50, v82, v122
    v_fmac_f32 v51, v83, v122
    v_cvt_pk_bf16_f32 v46, v48, v49
    v_cvt_pk_bf16_f32 v47, v50, v51
    v_fmac_f32 v52, v84, v122
    v_fmac_f32 v53, v85, v122
    v_fmac_f32 v54, v86, v122
    v_fmac_f32 v55, v87, v122
    v_cvt_pk_bf16_f32 v48, v52, v53
    v_cvt_pk_bf16_f32 v49, v54, v55
    v_fmac_f32 v56, v88, v122
    v_fmac_f32 v57, v89, v122
    v_fmac_f32 v58, v90, v122
    v_fmac_f32 v59, v91, v122
    v_cvt_pk_bf16_f32 v50, v56, v57
    v_cvt_pk_bf16_f32 v51, v58, v59
    s_cbranch_scc1 Lh1
    s_setprio 3
    ds_write_b128 v125, v[44:47] offset:2048
    ds_write_b128 v125, v[48:51] offset:3072
    v_fmac_f32 v28, v76, v120
    v_fmac_f32 v29, v77, v120
    v_fmac_f32 v30, v78, v120
    v_fmac_f32 v31, v79, v120
    v_cvt_pk_bf16_f32 v52, v28, v29
    v_cvt_pk_bf16_f32 v53, v30, v31
    v_fmac_f32 v32, v80, v120
    v_fmac_f32 v33, v81, v120
    v_fmac_f32 v34, v82, v120
    v_fmac_f32 v35, v83, v120
    v_cvt_pk_bf16_f32 v54, v32, v33
    v_cvt_pk_bf16_f32 v55, v34, v35
    v_fmac_f32 v36, v84, v120
    v_fmac_f32 v37, v85, v120
    v_fmac_f32 v38, v86, v120
    v_fmac_f32 v39, v87, v120
    v_cvt_pk_bf16_f32 v56, v36, v37
    v_cvt_pk_bf16_f32 v57, v38, v39
    v_fmac_f32 v40, v88, v120
    v_fmac_f32 v41, v89, v120
    v_fmac_f32 v42, v90, v120
    v_fmac_f32 v43, v91, v120
    v_cvt_pk_bf16_f32 v58, v40, v41
    v_cvt_pk_bf16_f32 v59, v42, v43
    ds_write_b128 v125, v[52:55] offset:4096
    ds_write_b128 v125, v[56:59] offset:5120
    v_mov_b32 v5, 157972
    v_mov_b32 v6, 1
    s_mov_b64 exec, 1
    ds_add_u32 v5, v6
    s_mov_b64 exec, -1
    v_mov_b32 v8, s22
    v_mov_b32 v9, s22
    v_mov_b32 v10, s22
    v_mov_b32 v11, s22
Lcw_1:
    s_sub_u32 s35, s35, 1
    s_cbranch_scc1 Lend
    ds_read_b32 v6, v5
    s_waitcnt lgkmcnt(0)
    v_readfirstlane_b32 s38, v6
    s_nop 0
    s_cmp_lt_u32 s38, 8
    s_cbranch_scc1 Lcw_1
    ds_read_b128 v[28:31], v125 offset:0
    ds_read_b128 v[32:35], v125 offset:1024
Lh_join:
    buffer_load_dword v20, v12, s[28:31], s24 offen sc1
    ds_read_b64_tr_b16 a[64:65], v26 offset:0
    ds_read_b64_tr_b16 a[66:67], v26 offset:512
    ds_read_b64_tr_b16 a[68:69], v27 offset:0
    ds_read_b64_tr_b16 a[70:71], v27 offset:512
    ds_read_b64_tr_b16 a[72:73], v26 offset:4096
    ds_read_b64_tr_b16 a[74:75], v26 offset:4608
    ds_read_b64_tr_b16 a[76:77], v27 offset:4096
    ds_read_b64_tr_b16 a[78:79], v27 offset:4608
    s_waitcnt lgkmcnt(8)
    s_setprio 3
    v_cndmask_b32 v92, 0, v30, s[6:7]
    v_cndmask_b32 v93, 0, v31, s[6:7]
    v_cndmask_b32 v94, 0, v32, s[12:13]
    v_cndmask_b32 v95, 0, v33, s[12:13]
    v_cndmask_b32 v104, 0, v30, s[8:9]
    v_cndmask_b32 v105, 0, v31, s[8:9]
    v_mfma_f32_16x16x32_bf16 v[76:79], v[46:49], v[92:95], v[8:11]
    v_mfma_f32_16x16x32_bf16 v[80:83], v[54:57], v[92:95], 0
    v_cndmask_b32 v106, 0, v32, s[14:15]
    v_cndmask_b32 v107, 0, v33, s[14:15]
    v_mov_b32 v96, v28
    v_mov_b32 v97, v29
    v_mfma_f32_16x16x32_bf16 v[84:87], v[46:49], v[104:107], v[8:11]
    v_mfma_f32_16x16x32_bf16 v[88:91], v[54:57], v[104:107], 0
    v_cndmask_b32 v98, 0, v30, s[10:11]
    v_cndmask_b32 v99, 0, v31, s[10:11]
    v_cndmask_b32 v100, 0, v32, s[16:17]
    v_cndmask_b32 v101, 0, v33, s[16:17]
    v_mfma_f32_16x16x32_bf16 v[36:39], v[44:47], v[96:99], v[8:11]
    v_mfma_f32_16x16x32_bf16 v[40:43], v[52:55], v[96:99], 0
    v_cndmask_b32 v76, v76, v77, s[4:5]
    v_cndmask_b32 v80, v80, v81, s[4:5]
    v_cndmask_b32 v78, v78, v79, s[4:5]
    v_cndmask_b32 v82, v82, v83, s[4:5]
    v_cndmask_b32 v92, v76, v80, s[18:19]
    v_cndmask_b32 v94, v78, v82, s[20:21]
    v_min_u32 v4, -2, v92
    v_min_u32 v5, -2, v94
    v_cndmask_b32 v84, v84, v85, s[4:5]
    v_cndmask_b32 v88, v88, v89, s[4:5]
    v_cndmask_b32 v86, v86, v87, s[4:5]
    v_cndmask_b32 v90, v90, v91, s[4:5]
    v_cndmask_b32 v104, v84, v88, s[18:19]
    v_cndmask_b32 v106, v86, v90, s[20:21]
    v_min_u32 v6, -2, v104
    v_min_u32 v7, -2, v106
    buffer_store_dwordx4 v[4:7], v13, s[28:31], s58 offen sc1
    s_setprio 2
    ds_read_b64_tr_b16 a[80:81], v26 offset:39040
    ds_read_b64_tr_b16 a[82:83], v26 offset:39552
    ds_read_b64_tr_b16 a[84:85], v27 offset:39040
    ds_read_b64_tr_b16 a[86:87], v27 offset:39552
    ds_read_b64_tr_b16 a[88:89], v26 offset:43136
    ds_read_b64_tr_b16 a[90:91], v26 offset:43648
    ds_read_b64_tr_b16 a[92:93], v27 offset:43136
    ds_read_b64_tr_b16 a[94:95], v27 offset:43648
    ds_read_b64_tr_b16 a[96:97], v24 offset:0
    ds_read_b64_tr_b16 a[98:99], v24 offset:512
    ds_read_b64_tr_b16 a[100:101], v25 offset:0
    ds_read_b64_tr_b16 a[102:103], v25 offset:512
    ds_read_b64_tr_b16 a[104:105], v24 offset:4096
    ds_read_b64_tr_b16 a[106:107], v24 offset:4608
    ds_read_b64_tr_b16 a[108:109], v25 offset:4096
    ds_read_b64_tr_b16 a[110:111], v25 offset:4608
    ds_read_b64_tr_b16 a[112:113], v24 offset:39040
    ds_read_b64_tr_b16 a[114:115], v24 offset:39552
    ds_read_b64_tr_b16 a[116:117], v25 offset:39040
    ds_read_b64_tr_b16 a[118:119], v25 offset:39552
    ds_read_b64_tr_b16 a[120:121], v24 offset:43136
    ds_read_b64_tr_b16 a[122:123], v24 offset:43648
    ds_read_b64_tr_b16 a[124:125], v25 offset:43136
    ds_read_b64_tr_b16 a[126:127], v25 offset:43648
    s_waitcnt lgkmcnt(15)
    v_mfma_f32_16x16x32_bf16 v[60:63], a[0:3], a[64:67], v[60:63]
    v_mov_b32 v102, v34
    v_mov_b32 v103, v35
    v_mul_f32 v4, s25, v121
    v_mfma_f32_16x16x32_bf16 v[68:71], a[4:7], a[64:67], v[68:71]
    v_mfma_f32_16x16x32_bf16 v[76:79], v[48:51], v[100:103], v[8:11]
    v_mfma_f32_16x16x32_bf16 v[80:83], v[56:59], v[100:103], 0
    v_mfma_f32_16x16x32_bf16 v[64:67], a[0:3], a[68:71], v[64:67]
    v_mul_f32 v123, v123, v4
    v_mul_f32 v126, v126, v4
    v_cndmask_b32 v36, v36, v37, s[4:5]
    v_mfma_f32_16x16x32_bf16 v[72:75], a[4:7], a[68:71], v[72:75]
    v_cndmask_b32 v40, v40, v41, s[4:5]
    v_cndmask_b32 v38, v38, v39, s[4:5]
    v_mfma_f32_16x16x32_bf16 v[60:63], a[8:11], a[72:75], v[60:63]
    v_cndmask_b32 v42, v42, v43, s[4:5]
    v_cndmask_b32 v96, v36, v40, s[18:19]
    v_cndmask_b32 v98, v38, v42, s[20:21]
    v_mfma_f32_16x16x32_bf16 v[68:71], a[12:15], a[72:75], v[68:71]
    v_cndmask_b32 v76, v76, v77, s[4:5]
    v_cndmask_b32 v80, v80, v81, s[4:5]
    v_mfma_f32_16x16x32_bf16 v[64:67], a[8:11], a[76:79], v[64:67]
    v_cndmask_b32 v78, v78, v79, s[4:5]
    v_cndmask_b32 v82, v82, v83, s[4:5]
    v_cndmask_b32 v100, v76, v80, s[18:19]
    v_mfma_f32_16x16x32_bf16 v[72:75], a[12:15], a[76:79], v[72:75]
    v_cndmask_b32 v102, v78, v82, s[20:21]
    v_mul_f32 v96, v96, v123
    v_mfma_f32_16x16x32_bf16 v[60:63], a[16:19], a[80:83], v[60:63]
    v_mul_f32 v98, v98, v126
    v_mul_f32 v100, v100, v123
    v_mul_f32 v102, v102, v126
    v_mfma_f32_16x16x32_bf16 v[68:71], a[20:23], a[80:83], v[68:71]
    v_max_f32 v4, v96, v98
    v_max_f32 v5, v100, v102
    v_mfma_f32_16x16x32_bf16 v[64:67], a[16:19], a[84:87], v[64:67]
    v_mov_b32 v6, v4
    v_mov_b32 v7, v5
    s_nop 0
    v_permlane32_swap_b32 v4, v6
    v_mfma_f32_16x16x32_bf16 v[72:75], a[20:23], a[84:87], v[72:75]
    v_permlane32_swap_b32 v5, v7
    v_max_f32 v4, v4, v6
    s_setprio 1
    v_mfma_f32_16x16x32_bf16 v[60:63], a[24:27], a[88:91], v[60:63]
    v_max_f32 v5, v5, v7
    v_mov_b32 v6, v4
    v_mov_b32 v7, v5
    v_mfma_f32_16x16x32_bf16 v[68:71], a[28:31], a[88:91], v[68:71]
    v_permlane16_swap_b32 v4, v6
    v_permlane16_swap_b32 v5, v7
    v_mfma_f32_16x16x32_bf16 v[64:67], a[24:27], a[92:95], v[64:67]
    v_max_f32 v4, v4, v6
    v_max_f32 v5, v5, v7
    v_mfma_f32_16x16x32_bf16 v[72:75], a[28:31], a[92:95], v[72:75]
    v_sub_f32 v96, v96, v4
    v_sub_f32 v98, v98, v4
    s_waitcnt lgkmcnt(12)
    v_mfma_f32_16x16x32_bf16 v[60:63], a[32:35], a[96:99], v[60:63]
    v_sub_f32 v100, v100, v5
    v_sub_f32 v102, v102, v5
    v_exp_f32 v96, v96
    v_mfma_f32_16x16x32_bf16 v[68:71], a[36:39], a[96:99], v[68:71]
    v_exp_f32 v98, v98
    v_exp_f32 v100, v100
    v_mfma_f32_16x16x32_bf16 v[64:67], a[32:35], a[100:103], v[64:67]
    v_exp_f32 v102, v102
    v_cvt_pk_bf16_f32 v96, v96, v96
    v_mfma_f32_16x16x32_bf16 v[72:75], a[36:39], a[100:103], v[72:75]
    v_cvt_pk_bf16_f32 v97, v98, v98
    v_cvt_pk_bf16_f32 v100, v100, v100
    s_waitcnt lgkmcnt(8)
    v_mfma_f32_16x16x32_bf16 v[60:63], a[40:43], a[104:107], v[60:63]
    v_cvt_pk_bf16_f32 v101, v102, v102
    v_and_b32 v98, v96, v118
    v_and_b32 v99, v97, v119
    v_mfma_f32_16x16x32_bf16 v[68:71], a[44:47], a[104:107], v[68:71]
    v_and_b32 v96, v96, v116
    v_and_b32 v97, v97, v117
    v_mfma_f32_16x16x32_bf16 v[64:67], a[40:43], a[108:111], v[64:67]
    v_and_b32 v102, v100, v118
    v_and_b32 v103, v101, v119
    v_mfma_f32_16x16x32_bf16 v[72:75], a[44:47], a[108:111], v[72:75]
    v_and_b32 v100, v100, v116
    v_and_b32 v101, v101, v117
    s_setprio 0
    s_waitcnt lgkmcnt(4)
    v_mfma_f32_16x16x32_bf16 v[60:63], a[48:51], a[112:115], v[60:63]
    s_lshl_b32 s36, s44, 6
    s_add_u32 s36, s36, 156160
    v_lshl_add_u32 v48, v2, 4, s36
    v_xor_b32 v49, 64, v48
    ds_read_b128 v[28:31], v48 offset:0
    v_mfma_f32_16x16x32_bf16 v[68:71], a[52:55], a[112:115], v[68:71]
    ds_read_b128 v[32:35], v48 offset:512
    ds_read_b128 v[36:39], v49 offset:0
    ds_read_b128 v[40:43], v49 offset:512
    s_lshl_b32 s36, s27, 3
    s_add_u32 s36, s36, 157696
    v_mfma_f32_16x16x32_bf16 v[64:67], a[48:51], a[116:119], v[64:67]
    v_lshl_add_u32 v48, v3, 4, s36
    v_mov_b32 v49, 157952
    v_lshl_add_u32 v125, v1, 3, s45
    s_lshl_b32 s36, s27, 10
    v_add_u32 v50, s36, v125
    v_mfma_f32_16x16x32_bf16 v[72:75], a[52:55], a[116:119], v[72:75]
    s_lshl_b32 s37, s27, 12
    s_sub_u32 s37, 2048, s37
    v_add_u32 v51, s37, v50
    v_subrev_u32 v125, 2048, v125
    s_waitcnt vmcnt(1)
Lfl_chk:
    v_cmp_eq_u32 vcc, s34, v20
    s_nop 0
    s_and_b32 s36, vcc_lo, 0x3ff
    s_cmp_lg_u32 s36, 0x3ff
    s_cbranch_scc1 Lfl_re
    buffer_load_dwordx2 v[52:53], v13, s[28:31], s59 offen offset:8 sc1
    buffer_load_dwordx2 v[54:55], v13, s[28:31], s60 offen offset:0 sc1
    s_waitcnt lgkmcnt(4)
    v_mfma_f32_16x16x32_bf16 v[60:63], a[56:59], a[120:123], v[60:63]
    v_mfma_f32_16x16x32_bf16 v[68:71], a[60:63], a[120:123], v[68:71]
    v_mfma_f32_16x16x32_bf16 v[64:67], a[56:59], a[124:127], v[64:67]
    v_mfma_f32_16x16x32_bf16 v[72:75], a[60:63], a[124:127], v[72:75]
    ds_read_b32 v46, v49
    ds_read_b64 v[44:45], v48
    s_waitcnt lgkmcnt(0)
Lcsv:
    v_readfirstlane_b32 s38, v46
    s_nop 0
    s_cmp_eq_u32 s38, 0
    s_cbranch_scc1 Lcsv_re
    v_fmac_f32 v60, v28, v44
    v_fmac_f32 v61, v29, v44
    v_fmac_f32 v62, v30, v44
    v_fmac_f32 v63, v31, v44
    v_mul_f32 v60, v60, v32
    v_mul_f32 v61, v61, v33
    v_mul_f32 v62, v62, v34
    v_mul_f32 v63, v63, v35
    v_cvt_pk_bf16_f32 v60, v60, v61
    v_cvt_pk_bf16_f32 v61, v62, v63
    ds_write_b64 v50, v[60:61] offset:0
    v_fmac_f32 v64, v28, v45
    v_fmac_f32 v65, v29, v45
    v_fmac_f32 v66, v30, v45
    v_fmac_f32 v67, v31, v45
    v_mul_f32 v64, v64, v32
    v_mul_f32 v65, v65, v33
    v_mul_f32 v66, v66, v34
    v_mul_f32 v67, v67, v35
    v_cvt_pk_bf16_f32 v64, v64, v65
    v_cvt_pk_bf16_f32 v65, v66, v67
    ds_write_b64 v50, v[64:65] offset:512
    v_fmac_f32 v68, v36, v44
    v_fmac_f32 v69, v37, v44
    v_fmac_f32 v70, v38, v44
    v_fmac_f32 v71, v39, v44
    v_mul_f32 v68, v68, v40
    v_mul_f32 v69, v69, v41
    v_mul_f32 v70, v70, v42
    v_mul_f32 v71, v71, v43
    v_cvt_pk_bf16_f32 v68, v68, v69
    v_cvt_pk_bf16_f32 v69, v70, v71
    ds_write_b64 v51, v[68:69] offset:0
    v_fmac_f32 v72, v36, v45
    v_fmac_f32 v73, v37, v45
    v_fmac_f32 v74, v38, v45
    v_fmac_f32 v75, v39, v45
    v_mul_f32 v72, v72, v40
    v_mul_f32 v73, v73, v41
    v_mul_f32 v74, v74, v42
    v_mul_f32 v75, v75, v43
    v_cvt_pk_bf16_f32 v72, v72, v73
    v_cvt_pk_bf16_f32 v73, v74, v75
    ds_write_b64 v51, v[72:73] offset:512
    v_mov_b32 v8, 157976
    v_mov_b32 v9, 1
    s_mov_b64 exec, 1
    ds_add_u32 v8, v9
    s_mov_b64 exec, -1
    s_waitcnt vmcnt(0)
Lrx_chk:
    v_and_b32 v52, s61, v52
    v_and_b32 v53, s61, v53
    v_and_b32 v54, s62, v54
    v_and_b32 v55, s62, v55
    v_max3_u32 v4, v52, v53, v54
    v_max_u32 v4, v4, v55
    v_cmp_eq_u32 vcc, -1, v4
    s_nop 0
    s_cbranch_vccnz Lrx_re
    v_add_f32 v92, v92, v52
    v_add_f32 v94, v94, v53
    v_add_f32 v104, v104, v54
    v_add_f32 v106, v106, v55
Lcw_4:
    s_sub_u32 s35, s35, 1
    s_cbranch_scc1 Lend
    ds_read_b32 v9, v8
    s_waitcnt lgkmcnt(0)
    v_readfirstlane_b32 s38, v9
    s_nop 0
    s_cmp_lt_u32 s38, 7
    s_cbranch_scc1 Lcw_4
    s_setprio 2
    ds_read2st64_b64 v[60:63], v125 offset0:0 offset1:4
    ds_read2st64_b64 v[64:67], v125 offset0:1 offset1:5
    ds_read2st64_b64 v[68:71], v125 offset0:2 offset1:6
    ds_read2st64_b64 v[72:75], v125 offset0:3 offset1:7
    v_mul_f32 v92, v92, v123
    v_mul_f32 v94, v94, v126
    v_mul_f32 v104, v104, v123
    v_mul_f32 v106, v106, v126
    v_max_f32 v4, v92, v94
    v_max_f32 v5, v104, v106
    v_mov_b32 v6, v4
    v_mov_b32 v7, v5
    s_nop 0
    v_permlane32_swap_b32 v4, v6
    v_permlane32_swap_b32 v5, v7
    v_max_f32 v4, v4, v6
    v_max_f32 v5, v5, v7
    s_waitcnt lgkmcnt(0)
    v_mov_b32 v6, v4
    v_mfma_f32_16x16x32_bf16 v[80:83], v[14:17], v[96:99], 0
    v_mov_b32 v7, v5
    v_permlane16_swap_b32 v4, v6
    s_nop 0
    v_permlane16_swap_b32 v5, v7
    v_max_f32 v4, v4, v6
    v_mfma_f32_16x16x32_bf16 v[84:87], v[14:17], v[100:103], 0
    v_max_f32 v5, v5, v7
    v_sub_f32 v92, v92, v4
    v_sub_f32 v94, v94, v4
    v_sub_f32 v104, v104, v5
    v_mfma_f32_16x16x32_bf16 v[28:31], v[60:63], v[96:99], 0
    v_sub_f32 v106, v106, v5
    v_exp_f32 v92, v92
    v_exp_f32 v94, v94
    v_exp_f32 v104, v104
    v_exp_f32 v106, v106
    v_mfma_f32_16x16x32_bf16 v[32:35], v[64:67], v[96:99], 0
    v_cvt_pk_bf16_f32 v92, v92, v92
    v_cvt_pk_bf16_f32 v93, v94, v94
    v_cvt_pk_bf16_f32 v104, v104, v104
    v_cvt_pk_bf16_f32 v105, v106, v106
    v_mfma_f32_16x16x32_bf16 v[36:39], v[68:71], v[100:103], 0
    v_and_b32 v94, v92, v118
    v_and_b32 v95, v93, v119
    v_and_b32 v92, v92, v116
    v_and_b32 v93, v93, v117
    v_mfma_f32_16x16x32_bf16 v[40:43], v[72:75], v[100:103], 0
    v_and_b32 v106, v104, v118
    v_and_b32 v107, v105, v119
    v_and_b32 v104, v104, v116
    v_and_b32 v105, v105, v117
    v_mfma_f32_16x16x32_bf16 v[76:79], v[14:17], v[92:95], 0
    v_rcp_f32 v80, v80
    v_rcp_f32 v84, v84
    v_mfma_f32_16x16x32_bf16 v[88:91], v[14:17], v[104:107], 0
    v_mul_f32 v28, v28, v80
    v_mul_f32 v29, v29, v80
    v_mfma_f32_16x16x32_bf16 v[44:47], v[64:67], v[92:95], 0
    v_mul_f32 v30, v30, v80
    v_mfma_f32_16x16x32_bf16 v[48:51], v[68:71], v[92:95], 0
    v_mul_f32 v31, v31, v80
    v_cvt_pk_bf16_f32 v4, v28, v29
    v_mfma_f32_16x16x32_bf16 v[52:55], v[64:67], v[104:107], 0
    v_cvt_pk_bf16_f32 v5, v30, v31
    v_min_u32 v4, -2, v4
    v_mfma_f32_16x16x32_bf16 v[56:59], v[68:71], v[104:107], 0
    v_min_u32 v5, -2, v5
    v_mul_f32 v40, v40, v84
    v_mul_f32 v41, v41, v84
    v_mul_f32 v42, v42, v84
    v_mul_f32 v43, v43, v84
    v_cvt_pk_bf16_f32 v10, v40, v41
    v_cvt_pk_bf16_f32 v11, v42, v43
    v_min_u32 v10, -2, v10
    v_min_u32 v11, -2, v11
    v_rcp_f32 v76, v76
    v_rcp_f32 v88, v88
    v_cndmask_b32 v82, v80, v76, s[6:7]
    v_cndmask_b32 v82, v82, v88, s[8:9]
    v_cndmask_b32 v32, v32, v44, s[6:7]
    v_cndmask_b32 v33, v33, v45, s[6:7]
    v_cndmask_b32 v34, v34, v46, s[6:7]
    v_cndmask_b32 v35, v35, v47, s[6:7]
    v_cndmask_b32 v32, v32, v52, s[8:9]
    v_cndmask_b32 v33, v33, v53, s[8:9]
    v_cndmask_b32 v34, v34, v54, s[8:9]
    v_cndmask_b32 v35, v35, v55, s[8:9]
    v_mul_f32 v32, v32, v82
    v_mul_f32 v33, v33, v82
    v_mul_f32 v34, v34, v82
    v_mul_f32 v35, v35, v82
    v_cvt_pk_bf16_f32 v6, v32, v33
    v_cvt_pk_bf16_f32 v7, v34, v35
    v_min_u32 v6, -2, v6
    v_min_u32 v7, -2, v7
    buffer_store_dwordx4 v[4:7], v13, s[28:31], s23 offen offset:0 sc1
    v_cndmask_b32 v86, v84, v76, s[12:13]
    v_cndmask_b32 v86, v86, v88, s[14:15]
    v_cndmask_b32 v36, v36, v48, s[12:13]
    v_cndmask_b32 v37, v37, v49, s[12:13]
    v_cndmask_b32 v38, v38, v50, s[12:13]
    v_cndmask_b32 v39, v39, v51, s[12:13]
    v_cndmask_b32 v36, v36, v56, s[14:15]
    v_cndmask_b32 v37, v37, v57, s[14:15]
    v_cndmask_b32 v38, v38, v58, s[14:15]
    v_cndmask_b32 v39, v39, v59, s[14:15]
    v_mul_f32 v36, v36, v86
    v_mul_f32 v37, v37, v86
    v_mul_f32 v38, v38, v86
    v_mul_f32 v39, v39, v86
    v_cvt_pk_bf16_f32 v8, v36, v37
    v_cvt_pk_bf16_f32 v9, v38, v39
    v_min_u32 v8, -2, v8
    v_min_u32 v9, -2, v9
    buffer_store_dwordx4 v[8:11], v13, s[28:31], s23 offen offset:1024 sc1
    s_setprio 1
    s_nop 0
    v_mov_b32 v10, 157980
    v_and_b32 v6, 3, v1
    v_lshl_add_u32 v6, v6, 3, v19
    v_add_u32 v20, v6, v18
    v_xor_b32 v21, 32, v20
    v_xor_b32 v22, 64, v20
    v_xor_b32 v23, 96, v20
    v_add_u32 v24, 63616, v20
    v_add_u32 v25, 63616, v21
    v_add_u32 v26, 63616, v22
    v_add_u32 v27, 63616, v23
Lcw_3:
    s_sub_u32 s35, s35, 1
    s_cbranch_scc1 Lend
    ds_read_b32 v11, v10
    s_waitcnt lgkmcnt(0)
    v_readfirstlane_b32 s38, v11
    s_nop 0
    s_cmp_lt_u32 s38, 2
    s_cbranch_scc1 Lcw_3
    s_mul_i32 s36, s32, 96
    s_lshl_b32 s37, s44, 4
    s_add_u32 s36, s36, s37
    s_sub_u32 s36, s36, 32
    v_add_u32 v126, s36, v3
    v_lshrrev_b32 v6, 3, v1
    v_add_u32 v6, s36, v6
    v_mul_u32_u24 v6, 1280, v6
    v_and_b32 v7, 7, v1
    v_xor_b32 v7, v7, v2
    v_lshl_add_u32 v122, v7, 4, v6
    v_xor_b32 v123, 64, v122
    v_add_u32 v123, 10240, v123
    s_lshl_b32 s36, s44, 11
    s_add_u32 s36, s36, 102656
    v_add_u32 v124, s36, v124
    v_add_u32 v125, s36, v13
    s_lshl_b32 s24, s33, 7
    v_mov_b32 v10, 157960
    s_mov_b32 s41, 0
    s_mov_b32 s47, 3
    v_lshlrev_b32 v28, 16, v108
    ds_read_b64_tr_b16 a[0:1], v20 offset:0
    ds_read_b64_tr_b16 a[2:3], v20 offset:512
    ds_read_b64_tr_b16 a[4:5], v21 offset:0
    ds_read_b64_tr_b16 a[6:7], v21 offset:512
    ds_read_b64_tr_b16 a[8:9], v22 offset:0
    ds_read_b64_tr_b16 a[10:11], v22 offset:512
    ds_read_b64_tr_b16 a[12:13], v23 offset:0
    ds_read_b64_tr_b16 a[14:15], v23 offset:512
    v_and_b32 v29, 0xffff0000, v108
    v_lshlrev_b32 v30, 16, v109
    v_and_b32 v31, 0xffff0000, v109
    v_lshlrev_b32 v32, 16, v110
    v_and_b32 v33, 0xffff0000, v110
    v_lshlrev_b32 v34, 16, v111
    v_and_b32 v35, 0xffff0000, v111
    v_lshlrev_b32 v36, 16, v112
    v_and_b32 v37, 0xffff0000, v112
    v_lshlrev_b32 v38, 16, v113
    v_and_b32 v39, 0xffff0000, v113
    v_lshlrev_b32 v40, 16, v114
    v_and_b32 v41, 0xffff0000, v114
    v_lshlrev_b32 v42, 16, v115
    ds_read_b64_tr_b16 a[16:17], v20 offset:4096
    ds_read_b64_tr_b16 a[18:19], v20 offset:4608
    ds_read_b64_tr_b16 a[20:21], v21 offset:4096
    ds_read_b64_tr_b16 a[22:23], v21 offset:4608
    ds_read_b64_tr_b16 a[24:25], v22 offset:4096
    ds_read_b64_tr_b16 a[26:27], v22 offset:4608
    ds_read_b64_tr_b16 a[28:29], v23 offset:4096
    ds_read_b64_tr_b16 a[30:31], v23 offset:4608
    v_and_b32 v43, 0xffff0000, v115
    v_mul_f32 v4, v120, v121
    v_mul_f32 v5, 0xbfb8aa3b, v121
    v_mul_f32 v6, 0xbfb8aa3b, v4
    v_fma_f32 v44, v28, v5, v6
    v_fma_f32 v45, v29, v5, v6
    v_fma_f32 v46, v30, v5, v6
    v_fma_f32 v47, v31, v5, v6
    v_fma_f32 v48, v32, v5, v6
    v_fma_f32 v49, v33, v5, v6
    v_fma_f32 v50, v34, v5, v6
    v_fma_f32 v51, v35, v5, v6
    v_fma_f32 v52, v36, v5, v6
    v_fma_f32 v53, v37, v5, v6
    ds_read_b64_tr_b16 a[32:33], v20 offset:8192
    ds_read_b64_tr_b16 a[34:35], v20 offset:8704
    ds_read_b64_tr_b16 a[36:37], v21 offset:8192
    ds_read_b64_tr_b16 a[38:39], v21 offset:8704
    ds_read_b64_tr_b16 a[40:41], v22 offset:8192
    ds_read_b64_tr_b16 a[42:43], v22 offset:8704
    ds_read_b64_tr_b16 a[44:45], v23 offset:8192
    ds_read_b64_tr_b16 a[46:47], v23 offset:8704
    v_fma_f32 v54, v38, v5, v6
    v_fma_f32 v55, v39, v5, v6
    v_fma_f32 v56, v40, v5, v6
    v_fma_f32 v57, v41, v5, v6
    v_fma_f32 v58, v42, v5, v6
    v_fma_f32 v59, v43, v5, v6
    v_exp_f32 v44, v44
    v_exp_f32 v45, v45
    v_exp_f32 v46, v46
    v_exp_f32 v47, v47
    v_exp_f32 v48, v48
    v_exp_f32 v49, v49
    v_exp_f32 v50, v50
    v_exp_f32 v51, v51
    v_exp_f32 v52, v52
    ds_read_b64_tr_b16 a[48:49], v20 offset:12288
    ds_read_b64_tr_b16 a[50:51], v20 offset:12800
    ds_read_b64_tr_b16 a[52:53], v21 offset:12288
    ds_read_b64_tr_b16 a[54:55], v21 offset:12800
    ds_read_b64_tr_b16 a[56:57], v22 offset:12288
    ds_read_b64_tr_b16 a[58:59], v22 offset:12800
    ds_read_b64_tr_b16 a[60:61], v23 offset:12288
    ds_read_b64_tr_b16 a[62:63], v23 offset:12800
    v_exp_f32 v53, v53
    v_exp_f32 v54, v54
    v_exp_f32 v55, v55
    v_exp_f32 v56, v56
    v_exp_f32 v57, v57
    v_exp_f32 v58, v58
    v_exp_f32 v59, v59
    v_fma_f32 v92, v28, v121, v4
    v_fma_f32 v93, v29, v121, v4
    v_fma_f32 v94, v30, v121, v4
    v_fma_f32 v95, v31, v121, v4
    v_fma_f32 v96, v32, v121, v4
    v_fma_f32 v97, v33, v121, v4
    v_fma_f32 v98, v34, v121, v4
    ds_read_b64_tr_b16 a[64:65], v20 offset:24576
    ds_read_b64_tr_b16 a[66:67], v20 offset:25088
    ds_read_b64_tr_b16 a[68:69], v21 offset:24576
    ds_read_b64_tr_b16 a[70:71], v21 offset:25088
    ds_read_b64_tr_b16 a[72:73], v22 offset:24576
    ds_read_b64_tr_b16 a[74:75], v22 offset:25088
    ds_read_b64_tr_b16 a[76:77], v23 offset:24576
    ds_read_b64_tr_b16 a[78:79], v23 offset:25088
    v_fma_f32 v99, v35, v121, v4
    v_fma_f32 v100, v36, v121, v4
    v_fma_f32 v101, v37, v121, v4
    v_fma_f32 v102, v38, v121, v4
    v_fma_f32 v103, v39, v121, v4
    v_fma_f32 v104, v40, v121, v4
    v_fma_f32 v105, v41, v121, v4
    v_fma_f32 v106, v42, v121, v4
    v_fma_f32 v107, v43, v121, v4
    v_add_f32 v44, 1.0, v44
    v_add_f32 v45, 1.0, v45
    v_add_f32 v46, 1.0, v46
    v_add_f32 v47, 1.0, v47
    v_add_f32 v48, 1.0, v48
    ds_read_b64_tr_b16 a[80:81], v20 offset:28672
    ds_read_b64_tr_b16 a[82:83], v20 offset:29184
    ds_read_b64_tr_b16 a[84:85], v21 offset:28672
    ds_read_b64_tr_b16 a[86:87], v21 offset:29184
    ds_read_b64_tr_b16 a[88:89], v22 offset:28672
    ds_read_b64_tr_b16 a[90:91], v22 offset:29184
    ds_read_b64_tr_b16 a[92:93], v23 offset:28672
    ds_read_b64_tr_b16 a[94:95], v23 offset:29184
    v_add_f32 v49, 1.0, v49
    v_add_f32 v50, 1.0, v50
    v_add_f32 v51, 1.0, v51
    v_add_f32 v52, 1.0, v52
    v_add_f32 v53, 1.0, v53
    v_add_f32 v54, 1.0, v54
    v_add_f32 v55, 1.0, v55
    v_add_f32 v56, 1.0, v56
    v_add_f32 v57, 1.0, v57
    v_add_f32 v58, 1.0, v58
    v_add_f32 v59, 1.0, v59
    v_rcp_f32 v44, v44
    v_rcp_f32 v45, v45
    v_rcp_f32 v46, v46
    v_rcp_f32 v47, v47
    ds_read_b64_tr_b16 a[96:97], v24 offset:59520
    ds_read_b64_tr_b16 a[98:99], v24 offset:60032
    ds_read_b64_tr_b16 a[100:101], v25 offset:59520
    ds_read_b64_tr_b16 a[102:103], v25 offset:60032
    ds_read_b64_tr_b16 a[104:105], v26 offset:59520
    ds_read_b64_tr_b16 a[106:107], v26 offset:60032
    ds_read_b64_tr_b16 a[108:109], v27 offset:59520
    ds_read_b64_tr_b16 a[110:111], v27 offset:60032
    v_rcp_f32 v48, v48
    v_rcp_f32 v49, v49
    v_rcp_f32 v50, v50
    v_rcp_f32 v51, v51
    v_rcp_f32 v52, v52
    v_rcp_f32 v53, v53
    v_rcp_f32 v54, v54
    v_rcp_f32 v55, v55
    v_rcp_f32 v56, v56
    v_rcp_f32 v57, v57
    v_rcp_f32 v58, v58
    v_rcp_f32 v59, v59
    v_mul_f32 v44, v44, v92
    v_mul_f32 v45, v45, v93
    ds_read_b64_tr_b16 a[112:113], v24 offset:63616
    ds_read_b64_tr_b16 a[114:115], v24 offset:64128
    ds_read_b64_tr_b16 a[116:117], v25 offset:63616
    ds_read_b64_tr_b16 a[118:119], v25 offset:64128
    ds_read_b64_tr_b16 a[120:121], v26 offset:63616
    ds_read_b64_tr_b16 a[122:123], v26 offset:64128
    ds_read_b64_tr_b16 a[124:125], v27 offset:63616
    ds_read_b64_tr_b16 a[126:127], v27 offset:64128
    v_mul_f32 v46, v46, v94
    v_mul_f32 v47, v47, v95
    v_mul_f32 v48, v48, v96
    v_mul_f32 v49, v49, v97
    v_mul_f32 v50, v50, v98
    v_mul_f32 v51, v51, v99
    v_mul_f32 v52, v52, v100
    v_mul_f32 v53, v53, v101
    v_mul_f32 v54, v54, v102
    v_mul_f32 v55, v55, v103
    v_mul_f32 v56, v56, v104
    v_mul_f32 v57, v57, v105
    v_mul_f32 v58, v58, v106
    v_mul_f32 v59, v59, v107
    buffer_load_dwordx4 v[60:63], v13, s[28:31], s53 offen offset:0 sc1
    buffer_load_dwordx4 v[64:67], v13, s[28:31], s53 offen offset:1024 sc1
    buffer_load_dwordx4 v[68:71], v13, s[28:31], s53 offen offset:2048 sc1
    buffer_load_dwordx4 v[72:75], v13, s[28:31], s53 offen offset:3072 sc1
    buffer_load_dwordx4 v[76:79], v13, s[28:31], s54 offen offset:0 sc1
    buffer_load_dwordx4 v[80:83], v13, s[28:31], s54 offen offset:1024 sc1
    buffer_load_dwordx4 v[84:87], v13, s[28:31], s54 offen offset:2048 sc1
    buffer_load_dwordx4 v[88:91], v13, s[28:31], s54 offen offset:3072 sc1
    s_setprio 0
Lwo_go:
    s_setprio 3
    ds_read_b64 v[8:9], v10
    s_waitcnt vmcnt(6)
    v_max3_u32 v4, v60, v61, v62
    v_max3_u32 v5, v64, v65, v66
    v_max3_u32 v4, v4, v63, v67
    v_max_u32 v4, v4, v5
    v_cmp_eq_u32 vcc, -1, v4
    s_nop 0
    s_cbranch_vccnz Lre_0
Lck_0:
    s_waitcnt lgkmcnt(15)
    v_mfma_f32_16x16x32_bf16 v[108:111], a[0:3], v[60:63], 0
    ds_read_b64_tr_b16 a[0:1], v24 offset:16384
    ds_read_b64_tr_b16 a[2:3], v24 offset:16896
    buffer_load_dwordx4 v[92:95], v13, s[28:31], s55 offen offset:0 sc1
    v_mfma_f32_16x16x32_bf16 v[112:115], a[4:7], v[60:63], 0
    ds_read_b64_tr_b16 a[4:5], v25 offset:16384
    ds_read_b64_tr_b16 a[6:7], v25 offset:16896
    v_mfma_f32_16x16x32_bf16 v[116:119], a[8:11], v[60:63], 0
    ds_read_b64_tr_b16 a[8:9], v26 offset:16384
    ds_read_b64_tr_b16 a[10:11], v26 offset:16896
    buffer_load_dwordx4 v[96:99], v13, s[28:31], s55 offen offset:1024 sc1
    v_mfma_f32_16x16x32_bf16 v[14:17], a[12:15], v[60:63], 0
    ds_read_b64_tr_b16 a[12:13], v27 offset:16384
    ds_read_b64_tr_b16 a[14:15], v27 offset:16896
    v_mfma_f32_16x16x32_bf16 v[108:111], a[16:19], v[64:67], v[108:111]
    ds_read_b64_tr_b16 a[16:17], v24 offset:20480
    ds_read_b64_tr_b16 a[18:19], v24 offset:20992
    s_waitcnt vmcnt(6)
    v_max3_u32 v4, v68, v69, v70
    v_mfma_f32_16x16x32_bf16 v[112:115], a[20:23], v[64:67], v[112:115]
    ds_read_b64_tr_b16 a[20:21], v25 offset:20480
    ds_read_b64_tr_b16 a[22:23], v25 offset:20992
    v_max3_u32 v5, v72, v73, v74
    v_max3_u32 v4, v4, v71, v75
    v_mfma_f32_16x16x32_bf16 v[116:119], a[24:27], v[64:67], v[116:119]
    ds_read_b64_tr_b16 a[24:25], v26 offset:20480
    ds_read_b64_tr_b16 a[26:27], v26 offset:20992
    v_max_u32 v4, v4, v5
    v_cmp_eq_u32 vcc, -1, v4
    v_mfma_f32_16x16x32_bf16 v[14:17], a[28:31], v[64:67], v[14:17]
    ds_read_b64_tr_b16 a[28:29], v27 offset:20480
    ds_read_b64_tr_b16 a[30:31], v27 offset:20992
    s_cbranch_vccnz Lre_1
Lck_1:
    s_waitcnt lgkmcnt(15)
Linfo:
    v_readfirstlane_b32 s39, v8
    s_nop 0
    s_cmp_eq_u32 s39, -2
    s_cbranch_scc1 Linfo_re
    v_mfma_f32_16x16x32_bf16 v[108:111], a[32:35], v[68:71], v[108:111]
    ds_read_b64_tr_b16 a[32:33], v20 offset:32768
    ds_read_b64_tr_b16 a[34:35], v20 offset:33280
    buffer_load_dwordx4 v[100:103], v13, s[28:31], s55 offen offset:2048 sc1
    v_mfma_f32_16x16x32_bf16 v[112:115], a[36:39], v[68:71], v[112:115]
    ds_read_b64_tr_b16 a[36:37], v21 offset:32768
    ds_read_b64_tr_b16 a[38:39], v21 offset:33280
    v_mfma_f32_16x16x32_bf16 v[116:119], a[40:43], v[68:71], v[116:119]
    ds_read_b64_tr_b16 a[40:41], v22 offset:32768
    ds_read_b64_tr_b16 a[42:43], v22 offset:33280
    buffer_load_dwordx4 v[104:107], v13, s[28:31], s55 offen offset:3072 sc1
    v_mfma_f32_16x16x32_bf16 v[14:17], a[44:47], v[68:71], v[14:17]
    ds_read_b64_tr_b16 a[44:45], v23 offset:32768
    ds_read_b64_tr_b16 a[46:47], v23 offset:33280
    v_mfma_f32_16x16x32_bf16 v[108:111], a[48:51], v[72:75], v[108:111]
    ds_read_b64_tr_b16 a[48:49], v20 offset:36864
    ds_read_b64_tr_b16 a[50:51], v20 offset:37376
    s_waitcnt vmcnt(6)
    v_max3_u32 v4, v76, v77, v78
    v_mfma_f32_16x16x32_bf16 v[112:115], a[52:55], v[72:75], v[112:115]
    ds_read_b64_tr_b16 a[52:53], v21 offset:36864
    ds_read_b64_tr_b16 a[54:55], v21 offset:37376
    v_max3_u32 v5, v80, v81, v82
    v_max3_u32 v4, v4, v79, v83
    v_mfma_f32_16x16x32_bf16 v[116:119], a[56:59], v[72:75], v[116:119]
    ds_read_b64_tr_b16 a[56:57], v22 offset:36864
    ds_read_b64_tr_b16 a[58:59], v22 offset:37376
    v_max_u32 v4, v4, v5
    v_cmp_eq_u32 vcc, -1, v4
    v_mfma_f32_16x16x32_bf16 v[14:17], a[60:63], v[72:75], v[14:17]
    ds_read_b64_tr_b16 a[60:61], v23 offset:36864
    ds_read_b64_tr_b16 a[62:63], v23 offset:37376
    s_cbranch_vccnz Lre_2
Lck_2:
    v_mfma_f32_16x16x32_bf16 v[108:111], a[64:67], v[76:79], v[108:111]
    ds_read_b64_tr_b16 a[64:65], v20 offset:40960
    ds_read_b64_tr_b16 a[66:67], v20 offset:41472
    buffer_load_dwordx4 v[60:63], v13, s[28:31], s56 offen offset:0 sc1
    v_mfma_f32_16x16x32_bf16 v[112:115], a[68:71], v[76:79], v[112:115]
    ds_read_b64_tr_b16 a[68:69], v21 offset:40960
    ds_read_b64_tr_b16 a[70:71], v21 offset:41472
    v_mfma_f32_16x16x32_bf16 v[116:119], a[72:75], v[76:79], v[116:119]
    ds_read_b64_tr_b16 a[72:73], v22 offset:40960
    ds_read_b64_tr_b16 a[74:75], v22 offset:41472
    buffer_load_dwordx4 v[64:67], v13, s[28:31], s56 offen offset:1024 sc1
    v_mfma_f32_16x16x32_bf16 v[14:17], a[76:79], v[76:79], v[14:17]
    ds_read_b64_tr_b16 a[76:77], v23 offset:40960
    ds_read_b64_tr_b16 a[78:79], v23 offset:41472
    v_mfma_f32_16x16x32_bf16 v[108:111], a[80:83], v[80:83], v[108:111]
    ds_read_b64_tr_b16 a[80:81], v20 offset:45056
    ds_read_b64_tr_b16 a[82:83], v20 offset:45568
    s_waitcnt vmcnt(6)
    v_max3_u32 v4, v84, v85, v86
    v_mfma_f32_16x16x32_bf16 v[112:115], a[84:87], v[80:83], v[112:115]
    ds_read_b64_tr_b16 a[84:85], v21 offset:45056
    ds_read_b64_tr_b16 a[86:87], v21 offset:45568
    v_max3_u32 v5, v88, v89, v90
    v_max3_u32 v4, v4, v87, v91
    v_mfma_f32_16x16x32_bf16 v[116:119], a[88:91], v[80:83], v[116:119]
    ds_read_b64_tr_b16 a[88:89], v22 offset:45056
    ds_read_b64_tr_b16 a[90:91], v22 offset:45568
    v_max_u32 v4, v4, v5
    v_cmp_eq_u32 vcc, -1, v4
    v_mfma_f32_16x16x32_bf16 v[14:17], a[92:95], v[80:83], v[14:17]
    ds_read_b64_tr_b16 a[92:93], v23 offset:45056
    ds_read_b64_tr_b16 a[94:95], v23 offset:45568
    s_cbranch_vccnz Lre_3
Lck_3:
    s_setprio 2
    v_mfma_f32_16x16x32_bf16 v[108:111], a[96:99], v[84:87], v[108:111]
    ds_read_b64_tr_b16 a[96:97], v24 offset:0
    ds_read_b64_tr_b16 a[98:99], v24 offset:512
    buffer_load_dwordx4 v[68:71], v13, s[28:31], s56 offen offset:2048 sc1
    v_mfma_f32_16x16x32_bf16 v[112:115], a[100:103], v[84:87], v[112:115]
    ds_read_b64_tr_b16 a[100:101], v25 offset:0
    ds_read_b64_tr_b16 a[102:103], v25 offset:512
    v_mfma_f32_16x16x32_bf16 v[116:119], a[104:107], v[84:87], v[116:119]
    ds_read_b64_tr_b16 a[104:105], v26 offset:0
    ds_read_b64_tr_b16 a[106:107], v26 offset:512
    buffer_load_dwordx4 v[72:75], v13, s[28:31], s56 offen offset:3072 sc1
    v_mfma_f32_16x16x32_bf16 v[14:17], a[108:111], v[84:87], v[14:17]
    ds_read_b64_tr_b16 a[108:109], v27 offset:0
    ds_read_b64_tr_b16 a[110:111], v27 offset:512
    v_mfma_f32_16x16x32_bf16 v[108:111], a[112:115], v[88:91], v[108:111]
    ds_read_b64_tr_b16 a[112:113], v24 offset:4096
    ds_read_b64_tr_b16 a[114:115], v24 offset:4608
    s_waitcnt vmcnt(6)
    v_max3_u32 v4, v92, v93, v94
    v_mfma_f32_16x16x32_bf16 v[112:115], a[116:119], v[88:91], v[112:115]
    ds_read_b64_tr_b16 a[116:117], v25 offset:4096
    ds_read_b64_tr_b16 a[118:119], v25 offset:4608
    v_max3_u32 v5, v96, v97, v98
    v_max3_u32 v4, v4, v95, v99
    v_mfma_f32_16x16x32_bf16 v[116:119], a[120:123], v[88:91], v[116:119]
    ds_read_b64_tr_b16 a[120:121], v26 offset:4096
    ds_read_b64_tr_b16 a[122:123], v26 offset:4608
    v_max_u32 v4, v4, v5
    v_cmp_eq_u32 vcc, -1, v4
    v_mfma_f32_16x16x32_bf16 v[14:17], a[124:127], v[88:91], v[14:17]
    ds_read_b64_tr_b16 a[124:125], v27 offset:4096
    ds_read_b64_tr_b16 a[126:127], v27 offset:4608
    s_cbranch_vccnz Lre_4
Lck_4:
    s_waitcnt lgkmcnt(15)
    v_mfma_f32_16x16x32_bf16 v[108:111], a[0:3], v[92:95], v[108:111]
    ds_read_b64_tr_b16 a[0:1], v24 offset:8192
    ds_read_b64_tr_b16 a[2:3], v24 offset:8704
    buffer_load_dwordx4 v[76:79], v13, s[28:31], s57 offen offset:0 sc1
    v_mfma_f32_16x16x32_bf16 v[112:115], a[4:7], v[92:95], v[112:115]
    ds_read_b64_tr_b16 a[4:5], v25 offset:8192
    ds_read_b64_tr_b16 a[6:7], v25 offset:8704
    v_mfma_f32_16x16x32_bf16 v[116:119], a[8:11], v[92:95], v[116:119]
    ds_read_b64_tr_b16 a[8:9], v26 offset:8192
    ds_read_b64_tr_b16 a[10:11], v26 offset:8704
    buffer_load_dwordx4 v[80:83], v13, s[28:31], s57 offen offset:1024 sc1
    v_mfma_f32_16x16x32_bf16 v[14:17], a[12:15], v[92:95], v[14:17]
    ds_read_b64_tr_b16 a[12:13], v27 offset:8192
    ds_read_b64_tr_b16 a[14:15], v27 offset:8704
    v_mfma_f32_16x16x32_bf16 v[108:111], a[16:19], v[96:99], v[108:111]
    ds_read_b64_tr_b16 a[16:17], v24 offset:12288
    ds_read_b64_tr_b16 a[18:19], v24 offset:12800
    s_waitcnt vmcnt(6)
    v_max3_u32 v4, v100, v101, v102
    v_mfma_f32_16x16x32_bf16 v[112:115], a[20:23], v[96:99], v[112:115]
    ds_read_b64_tr_b16 a[20:21], v25 offset:12288
    ds_read_b64_tr_b16 a[22:23], v25 offset:12800
    v_max3_u32 v5, v104, v105, v106
    v_max3_u32 v4, v4, v103, v107
    v_mfma_f32_16x16x32_bf16 v[116:119], a[24:27], v[96:99], v[116:119]
    ds_read_b64_tr_b16 a[24:25], v26 offset:12288
    ds_read_b64_tr_b16 a[26:27], v26 offset:12800
    v_max_u32 v4, v4, v5
    v_cmp_eq_u32 vcc, -1, v4
    v_mfma_f32_16x16x32_bf16 v[14:17], a[28:31], v[96:99], v[14:17]
    ds_read_b64_tr_b16 a[28:29], v27 offset:12288
    ds_read_b64_tr_b16 a[30:31], v27 offset:12800
    s_cbranch_vccnz Lre_5
Lck_5:
    v_mfma_f32_16x16x32_bf16 v[108:111], a[32:35], v[100:103], v[108:111]
    ds_read_b64_tr_b16 a[32:33], v20 offset:49152
    ds_read_b64_tr_b16 a[34:35], v20 offset:49664
    buffer_load_dwordx4 v[84:87], v13, s[28:31], s57 offen offset:2048 sc1
    v_mfma_f32_16x16x32_bf16 v[112:115], a[36:39], v[100:103], v[112:115]
    ds_read_b64_tr_b16 a[36:37], v21 offset:49152
    ds_read_b64_tr_b16 a[38:39], v21 offset:49664
    v_mfma_f32_16x16x32_bf16 v[116:119], a[40:43], v[100:103], v[116:119]
    ds_read_b64_tr_b16 a[40:41], v22 offset:49152
    ds_read_b64_tr_b16 a[42:43], v22 offset:49664
    buffer_load_dwordx4 v[88:91], v13, s[28:31], s57 offen offset:3072 sc1
    v_mfma_f32_16x16x32_bf16 v[14:17], a[44:47], v[100:103], v[14:17]
    ds_read_b64_tr_b16 a[44:45], v23 offset:49152
    ds_read_b64_tr_b16 a[46:47], v23 offset:49664
    v_mfma_f32_16x16x32_bf16 v[108:111], a[48:51], v[104:107], v[108:111]
    ds_read_b64_tr_b16 a[48:49], v24 offset:24576
    ds_read_b64_tr_b16 a[50:51], v24 offset:25088
    s_waitcnt vmcnt(6)
    v_max3_u32 v4, v60, v61, v62
    v_mfma_f32_16x16x32_bf16 v[112:115], a[52:55], v[104:107], v[112:115]
    ds_read_b64_tr_b16 a[52:53], v25 offset:24576
    ds_read_b64_tr_b16 a[54:55], v25 offset:25088
    v_max3_u32 v5, v64, v65, v66
    v_max3_u32 v4, v4, v63, v67
    v_mfma_f32_16x16x32_bf16 v[116:119], a[56:59], v[104:107], v[116:119]
    ds_read_b64_tr_b16 a[56:57], v26 offset:24576
    ds_read_b64_tr_b16 a[58:59], v26 offset:25088
    v_max_u32 v4, v4, v5
    v_cmp_eq_u32 vcc, -1, v4
    v_mfma_f32_16x16x32_bf16 v[14:17], a[60:63], v[104:107], v[14:17]
    ds_read_b64_tr_b16 a[60:61], v27 offset:24576
    ds_read_b64_tr_b16 a[62:63], v27 offset:25088
    s_cbranch_vccnz Lre_6
Lck_6:
    s_setprio 1
    v_mfma_f32_16x16x32_bf16 v[108:111], a[64:67], v[60:63], v[108:111]
    v_mfma_f32_16x16x32_bf16 v[112:115], a[68:71], v[60:63], v[112:115]
    v_mfma_f32_16x16x32_bf16 v[116:119], a[72:75], v[60:63], v[116:119]
    v_mfma_f32_16x16x32_bf16 v[14:17], a[76:79], v[60:63], v[14:17]
    v_mfma_f32_16x16x32_bf16 v[108:111], a[80:83], v[64:67], v[108:111]
    s_waitcnt vmcnt(4)
    v_max3_u32 v4, v68, v69, v70
    v_mfma_f32_16x16x32_bf16 v[112:115], a[84:87], v[64:67], v[112:115]
    v_max3_u32 v5, v72, v73, v74
    v_max3_u32 v4, v4, v71, v75
    v_mfma_f32_16x16x32_bf16 v[116:119], a[88:91], v[64:67], v[116:119]
    v_max_u32 v4, v4, v5
    v_cmp_eq_u32 vcc, -1, v4
    v_mfma_f32_16x16x32_bf16 v[14:17], a[92:95], v[64:67], v[14:17]
    s_cbranch_vccnz Lre_7
Lck_7:
    s_waitcnt lgkmcnt(15)
    v_mfma_f32_16x16x32_bf16 v[108:111], a[96:99], v[68:71], v[108:111]
    v_mfma_f32_16x16x32_bf16 v[112:115], a[100:103], v[68:71], v[112:115]
    v_mfma_f32_16x16x32_bf16 v[116:119], a[104:107], v[68:71], v[116:119]
    v_mfma_f32_16x16x32_bf16 v[14:17], a[108:111], v[68:71], v[14:17]
    v_mfma_f32_16x16x32_bf16 v[108:111], a[112:115], v[72:75], v[108:111]
    s_waitcnt vmcnt(2)
    v_max3_u32 v4, v76, v77, v78
    v_mfma_f32_16x16x32_bf16 v[112:115], a[116:119], v[72:75], v[112:115]
    v_max3_u32 v5, v80, v81, v82
    v_max3_u32 v4, v4, v79, v83
    v_mfma_f32_16x16x32_bf16 v[116:119], a[120:123], v[72:75], v[116:119]
    v_max_u32 v4, v4, v5
    v_cmp_eq_u32 vcc, -1, v4
    v_mfma_f32_16x16x32_bf16 v[14:17], a[124:127], v[72:75], v[14:17]
    s_cbranch_vccnz Lre_8
Lck_8:
    s_setprio 0
    v_mfma_f32_16x16x32_bf16 v[108:111], a[0:3], v[76:79], v[108:111]
    v_mfma_f32_16x16x32_bf16 v[112:115], a[4:7], v[76:79], v[112:115]
    v_mfma_f32_16x16x32_bf16 v[116:119], a[8:11], v[76:79], v[116:119]
    v_mfma_f32_16x16x32_bf16 v[14:17], a[12:15], v[76:79], v[14:17]
    v_mfma_f32_16x16x32_bf16 v[108:111], a[16:19], v[80:83], v[108:111]
    s_waitcnt vmcnt(0)
    v_max3_u32 v4, v84, v85, v86
    v_mfma_f32_16x16x32_bf16 v[112:115], a[20:23], v[80:83], v[112:115]
    v_max3_u32 v5, v88, v89, v90
    v_max3_u32 v4, v4, v87, v91
    v_mfma_f32_16x16x32_bf16 v[116:119], a[24:27], v[80:83], v[116:119]
    v_max_u32 v4, v4, v5
    v_cmp_eq_u32 vcc, -1, v4
    v_mfma_f32_16x16x32_bf16 v[14:17], a[28:31], v[80:83], v[14:17]
    s_cbranch_vccnz Lre_9
Lck_9:
    s_waitcnt lgkmcnt(8)
    v_mfma_f32_16x16x32_bf16 v[108:111], a[32:35], v[84:87], v[108:111]
    v_mfma_f32_16x16x32_bf16 v[112:115], a[36:39], v[84:87], v[112:115]
    v_mfma_f32_16x16x32_bf16 v[116:119], a[40:43], v[84:87], v[116:119]
    v_mfma_f32_16x16x32_bf16 v[14:17], a[44:47], v[84:87], v[14:17]
    s_waitcnt lgkmcnt(0)
    v_mfma_f32_16x16x32_bf16 v[108:111], a[48:51], v[88:91], v[108:111]
    v_mfma_f32_16x16x32_bf16 v[112:115], a[52:55], v[88:91], v[112:115]
    v_mfma_f32_16x16x32_bf16 v[116:119], a[56:59], v[88:91], v[116:119]
    v_mfma_f32_16x16x32_bf16 v[14:17], a[60:63], v[88:91], v[14:17]
    v_xor_b32 v60, 32, v124
    v_xor_b32 v61, 64, v124
    v_xor_b32 v62, 96, v124
    v_cmp_eq_u32 s[36:37], v8, v126
    v_cmp_eq_u32 s[38:39], v9, v126
    s_nop 0
    s_or_b64 vcc, s[36:37], s[38:39]
    s_cbranch_scc1 Lfix
Lnofix:
    v_fma_f32 v108, v108, v44, v28
    v_fma_f32 v109, v109, v45, v29
    v_fma_f32 v110, v110, v46, v30
    v_fma_f32 v111, v111, v47, v31
    v_cvt_pk_bf16_f32 v68, v108, v109
    v_cvt_pk_bf16_f32 v69, v110, v111
    ds_write_b64 v124, v[68:69]
    v_fma_f32 v112, v112, v48, v32
    v_fma_f32 v113, v113, v49, v33
    v_fma_f32 v114, v114, v50, v34
    v_fma_f32 v115, v115, v51, v35
    v_cvt_pk_bf16_f32 v70, v112, v113
    v_cvt_pk_bf16_f32 v71, v114, v115
    ds_write_b64 v60, v[70:71]
    v_fma_f32 v116, v116, v52, v36
    v_fma_f32 v117, v117, v53, v37
    v_fma_f32 v118, v118, v54, v38
    v_fma_f32 v119, v119, v55, v39
    v_cvt_pk_bf16_f32 v72, v116, v117
    v_cvt_pk_bf16_f32 v73, v118, v119
    ds_write_b64 v61, v[72:73]
    v_fma_f32 v14, v14, v56, v40
    v_fma_f32 v15, v15, v57, v41
    v_fma_f32 v16, v16, v58, v42
    v_fma_f32 v17, v17, v59, v43
    v_cvt_pk_bf16_f32 v74, v14, v15
    v_cvt_pk_bf16_f32 v75, v16, v17
    ds_write_b64 v62, v[74:75]
    ds_read_b128 v[76:79], v125 offset:0
    ds_read_b128 v[80:83], v125 offset:1024
    s_waitcnt lgkmcnt(1)
    buffer_store_dwordx4 v[76:79], v122, s[48:51], s24 offen
    s_waitcnt lgkmcnt(0)
    buffer_store_dwordx4 v[80:83], v123, s[48:51], s24 offen
    s_endpgm
Lh1:
    ds_write_b128 v125, v[44:47] offset:0
    ds_write_b128 v125, v[48:51] offset:1024
    v_mov_b32 v5, 157972
    v_mov_b32 v6, 1
    s_mov_b64 exec, 1
    ds_add_u32 v5, v6
    s_mov_b64 exec, -1
    v_fmac_f32 v28, v76, v120
    v_fmac_f32 v29, v77, v120
    v_fmac_f32 v30, v78, v120
    v_fmac_f32 v31, v79, v120
    v_cvt_pk_bf16_f32 v28, v28, v29
    v_cvt_pk_bf16_f32 v29, v30, v31
    v_fmac_f32 v32, v80, v120
    v_fmac_f32 v33, v81, v120
    v_fmac_f32 v34, v82, v120
    v_fmac_f32 v35, v83, v120
    v_cvt_pk_bf16_f32 v30, v32, v33
    v_cvt_pk_bf16_f32 v31, v34, v35
    v_fmac_f32 v36, v84, v120
    v_fmac_f32 v37, v85, v120
    v_fmac_f32 v38, v86, v120
    v_fmac_f32 v39, v87, v120
    v_cvt_pk_bf16_f32 v32, v36, v37
    v_cvt_pk_bf16_f32 v33, v38, v39
    v_fmac_f32 v40, v88, v120
    v_fmac_f32 v41, v89, v120
    v_fmac_f32 v42, v90, v120
    v_fmac_f32 v43, v91, v120
    v_cvt_pk_bf16_f32 v34, v40, v41
    v_cvt_pk_bf16_f32 v35, v42, v43
    v_subrev_u32 v4, 6144, v125
    v_mov_b32 v8, s22
    v_mov_b32 v9, s22
    v_mov_b32 v10, s22
    v_mov_b32 v11, s22
Lcw_2:
    s_sub_u32 s35, s35, 1
    s_cbranch_scc1 Lend
    ds_read_b32 v6, v5
    s_waitcnt lgkmcnt(0)
    v_readfirstlane_b32 s38, v6
    s_nop 0
    s_cmp_lt_u32 s38, 8
    s_cbranch_scc1 Lcw_2
    ds_read_b128 v[52:55], v125 offset:2048
    ds_read_b128 v[56:59], v125 offset:3072
    ds_read_b128 v[44:47], v4 offset:4096
    ds_read_b128 v[48:51], v4 offset:5120
    s_branch Lh_join
Lqf_re:
    s_sub_u32 s35, s35, 1
    s_cbranch_scc1 Lend
    ds_read_b32 v7, v96
    ds_read_b128 v[76:79], v95 offset:0
    ds_read_b128 v[80:83], v95 offset:64
    ds_read_b128 v[84:87], v95 offset:128
    ds_read_b128 v[88:91], v95 offset:192
    s_waitcnt lgkmcnt(0)
    s_branch Lqf
Lcsv_re:
    s_sub_u32 s35, s35, 1
    s_cbranch_scc1 Lend
    ds_read_b32 v46, v49
    ds_read_b64 v[44:45], v48
    s_waitcnt lgkmcnt(0)
    s_branch Lcsv
Lrx_re:
    s_sub_u32 s35, s35, 1
    s_cbranch_scc1 Lend
    buffer_load_dwordx2 v[52:53], v13, s[28:31], s59 offen offset:8 sc1
    buffer_load_dwordx2 v[54:55], v13, s[28:31], s60 offen offset:0 sc1
    s_waitcnt vmcnt(0)
    s_branch Lrx_chk
Linfo_re:
    s_sub_u32 s35, s35, 1
    s_cbranch_scc1 Lend
    ds_read_b64 v[8:9], v10
    s_waitcnt lgkmcnt(0)
    s_branch Linfo
Lfl_re:
    s_sub_u32 s35, s35, 1
    s_cbranch_scc1 Lend
    buffer_load_dword v20, v12, s[28:31], s24 offen sc1
    s_waitcnt vmcnt(0)
    s_branch Lfl_chk
Lxe0:
    ds_read_b64 v[108:109], v4
    ds_read_b64 v[110:111], v5
    ds_read_b64 v[112:113], v6
    ds_read_b64 v[114:115], v7
    s_branch Lxe0_b
Lxe1:
    ds_read_b64 v[108:109], v4
    ds_read_b64 v[110:111], v5
    ds_read_b64 v[112:113], v6
    ds_read_b64 v[114:115], v7
    s_branch Lxe1_b
Lxe2:
    ds_read_b64 v[108:109], v4
    ds_read_b64 v[110:111], v5
    ds_read_b64 v[112:113], v6
    ds_read_b64 v[114:115], v7
    s_branch Lxe2_b
Lxe3:
    ds_read_b64 v[108:109], v4
    ds_read_b64 v[110:111], v5
    ds_read_b64 v[112:113], v6
    ds_read_b64 v[114:115], v7
    s_branch Lxe3_b
Lxe4:
    ds_read_b64 v[108:109], v4
    ds_read_b64 v[110:111], v5
    ds_read_b64 v[112:113], v6
    ds_read_b64 v[114:115], v7
    s_branch Lxe4_b
Lxe5:
    ds_read_b64 v[108:109], v4
    ds_read_b64 v[110:111], v5
    ds_read_b64 v[112:113], v6
    ds_read_b64 v[114:115], v7
    s_branch Lxe5_b
Lxe6:
    ds_read_b64 v[108:109], v4
    ds_read_b64 v[110:111], v5
    ds_read_b64 v[112:113], v6
    ds_read_b64 v[114:115], v7
    s_branch Lxe6_b
Lxe7:
    ds_read_b64 v[108:109], v4
    ds_read_b64 v[110:111], v5
    ds_read_b64 v[112:113], v6
    ds_read_b64 v[114:115], v7
    s_branch Lxe7_b
Lxe8:
    ds_read_b64 v[108:109], v4
    ds_read_b64 v[110:111], v5
    ds_read_b64 v[112:113], v6
    ds_read_b64 v[114:115], v7
    s_branch Lxe8_b
Lxe9:
    ds_read_b64 v[108:109], v4
    ds_read_b64 v[110:111], v5
    ds_read_b64 v[112:113], v6
    ds_read_b64 v[114:115], v7
    s_branch Lxe9_b
Lre_0:
    s_mov_b32 s41, 1
    s_sub_u32 s35, s35, 1
    s_cbranch_scc1 Lend
    s_sleep 2
    buffer_load_dwordx4 v[60:63], v13, s[28:31], s53 offen offset:0 sc1
    buffer_load_dwordx4 v[64:67], v13, s[28:31], s53 offen offset:1024 sc1
    s_waitcnt vmcnt(0)
    v_max3_u32 v4, v60, v61, v62
    v_max3_u32 v5, v64, v65, v66
    v_max3_u32 v4, v4, v63, v67
    v_max_u32 v4, v4, v5
    v_cmp_eq_u32 vcc, -1, v4
    s_nop 0
    s_cbranch_vccnz Lre_0
    buffer_load_dwordx4 v[68:71], v13, s[28:31], s53 offen offset:2048 sc1
    buffer_load_dwordx4 v[72:75], v13, s[28:31], s53 offen offset:3072 sc1
    buffer_load_dwordx4 v[76:79], v13, s[28:31], s54 offen offset:0 sc1
    buffer_load_dwordx4 v[80:83], v13, s[28:31], s54 offen offset:1024 sc1
    buffer_load_dwordx4 v[84:87], v13, s[28:31], s54 offen offset:2048 sc1
    buffer_load_dwordx4 v[88:91], v13, s[28:31], s54 offen offset:3072 sc1
    s_branch Lck_0
Lre_1:
    s_mov_b32 s41, 1
    s_sub_u32 s35, s35, 1
    s_cbranch_scc1 Lend
    s_sleep 2
    buffer_load_dwordx4 v[68:71], v13, s[28:31], s53 offen offset:2048 sc1
    buffer_load_dwordx4 v[72:75], v13, s[28:31], s53 offen offset:3072 sc1
    s_waitcnt vmcnt(0)
    v_max3_u32 v4, v68, v69, v70
    v_max3_u32 v5, v72, v73, v74
    v_max3_u32 v4, v4, v71, v75
    v_max_u32 v4, v4, v5
    v_cmp_eq_u32 vcc, -1, v4
    s_nop 0
    s_cbranch_vccnz Lre_1
    buffer_load_dwordx4 v[76:79], v13, s[28:31], s54 offen offset:0 sc1
    buffer_load_dwordx4 v[80:83], v13, s[28:31], s54 offen offset:1024 sc1
    buffer_load_dwordx4 v[84:87], v13, s[28:31], s54 offen offset:2048 sc1
    buffer_load_dwordx4 v[88:91], v13, s[28:31], s54 offen offset:3072 sc1
    buffer_load_dwordx4 v[92:95], v13, s[28:31], s55 offen offset:0 sc1
    buffer_load_dwordx4 v[96:99], v13, s[28:31], s55 offen offset:1024 sc1
    s_branch Lck_1
Lre_2:
    s_mov_b32 s41, 1
    s_sub_u32 s35, s35, 1
    s_cbranch_scc1 Lend
    s_sleep 2
    buffer_load_dwordx4 v[76:79], v13, s[28:31], s54 offen offset:0 sc1
    buffer_load_dwordx4 v[80:83], v13, s[28:31], s54 offen offset:1024 sc1
    s_waitcnt vmcnt(0)
    v_max3_u32 v4, v76, v77, v78
    v_max3_u32 v5, v80, v81, v82
    v_max3_u32 v4, v4, v79, v83
    v_max_u32 v4, v4, v5
    v_cmp_eq_u32 vcc, -1, v4
    s_nop 0
    s_cbranch_vccnz Lre_2
    buffer_load_dwordx4 v[84:87], v13, s[28:31], s54 offen offset:2048 sc1
    buffer_load_dwordx4 v[88:91], v13, s[28:31], s54 offen offset:3072 sc1
    buffer_load_dwordx4 v[92:95], v13, s[28:31], s55 offen offset:0 sc1
    buffer_load_dwordx4 v[96:99], v13, s[28:31], s55 offen offset:1024 sc1
    buffer_load_dwordx4 v[100:103], v13, s[28:31], s55 offen offset:2048 sc1
    buffer_load_dwordx4 v[104:107], v13, s[28:31], s55 offen offset:3072 sc1
    s_branch Lck_2
Lre_3:
    s_mov_b32 s41, 1
    s_sub_u32 s35, s35, 1
    s_cbranch_scc1 Lend
    s_sleep 2
    buffer_load_dwordx4 v[84:87], v13, s[28:31], s54 offen offset:2048 sc1
    buffer_load_dwordx4 v[88:91], v13, s[28:31], s54 offen offset:3072 sc1
    s_waitcnt vmcnt(0)
    v_max3_u32 v4, v84, v85, v86
    v_max3_u32 v5, v88, v89, v90
    v_max3_u32 v4, v4, v87, v91
    v_max_u32 v4, v4, v5
    v_cmp_eq_u32 vcc, -1, v4
    s_nop 0
    s_cbranch_vccnz Lre_3
    buffer_load_dwordx4 v[92:95], v13, s[28:31], s55 offen offset:0 sc1
    buffer_load_dwordx4 v[96:99], v13, s[28:31], s55 offen offset:1024 sc1
    buffer_load_dwordx4 v[100:103], v13, s[28:31], s55 offen offset:2048 sc1
    buffer_load_dwordx4 v[104:107], v13, s[28:31], s55 offen offset:3072 sc1
    buffer_load_dwordx4 v[60:63], v13, s[28:31], s56 offen offset:0 sc1
    buffer_load_dwordx4 v[64:67], v13, s[28:31], s56 offen offset:1024 sc1
    s_branch Lck_3
Lre_4:
    s_mov_b32 s41, 1
    s_sub_u32 s35, s35, 1
    s_cbranch_scc1 Lend
    s_sleep 2
    buffer_load_dwordx4 v[92:95], v13, s[28:31], s55 offen offset:0 sc1
    buffer_load_dwordx4 v[96:99], v13, s[28:31], s55 offen offset:1024 sc1
    s_waitcnt vmcnt(0)
    v_max3_u32 v4, v92, v93, v94
    v_max3_u32 v5, v96, v97, v98
    v_max3_u32 v4, v4, v95, v99
    v_max_u32 v4, v4, v5
    v_cmp_eq_u32 vcc, -1, v4
    s_nop 0
    s_cbranch_vccnz Lre_4
    buffer_load_dwordx4 v[100:103], v13, s[28:31], s55 offen offset:2048 sc1
    buffer_load_dwordx4 v[104:107], v13, s[28:31], s55 offen offset:3072 sc1
    buffer_load_dwordx4 v[60:63], v13, s[28:31], s56 offen offset:0 sc1
    buffer_load_dwordx4 v[64:67], v13, s[28:31], s56 offen offset:1024 sc1
    buffer_load_dwordx4 v[68:71], v13, s[28:31], s56 offen offset:2048 sc1
    buffer_load_dwordx4 v[72:75], v13, s[28:31], s56 offen offset:3072 sc1
    s_branch Lck_4
Lre_5:
    s_mov_b32 s41, 1
    s_sub_u32 s35, s35, 1
    s_cbranch_scc1 Lend
    s_sleep 2
    buffer_load_dwordx4 v[100:103], v13, s[28:31], s55 offen offset:2048 sc1
    buffer_load_dwordx4 v[104:107], v13, s[28:31], s55 offen offset:3072 sc1
    s_waitcnt vmcnt(0)
    v_max3_u32 v4, v100, v101, v102
    v_max3_u32 v5, v104, v105, v106
    v_max3_u32 v4, v4, v103, v107
    v_max_u32 v4, v4, v5
    v_cmp_eq_u32 vcc, -1, v4
    s_nop 0
    s_cbranch_vccnz Lre_5
    buffer_load_dwordx4 v[60:63], v13, s[28:31], s56 offen offset:0 sc1
    buffer_load_dwordx4 v[64:67], v13, s[28:31], s56 offen offset:1024 sc1
    buffer_load_dwordx4 v[68:71], v13, s[28:31], s56 offen offset:2048 sc1
    buffer_load_dwordx4 v[72:75], v13, s[28:31], s56 offen offset:3072 sc1
    buffer_load_dwordx4 v[76:79], v13, s[28:31], s57 offen offset:0 sc1
    buffer_load_dwordx4 v[80:83], v13, s[28:31], s57 offen offset:1024 sc1
    s_branch Lck_5
Lre_6:
    s_mov_b32 s41, 1
    s_sub_u32 s35, s35, 1
    s_cbranch_scc1 Lend
    s_sleep 2
    buffer_load_dwordx4 v[60:63], v13, s[28:31], s56 offen offset:0 sc1
    buffer_load_dwordx4 v[64:67], v13, s[28:31], s56 offen offset:1024 sc1
    s_waitcnt vmcnt(0)
    v_max3_u32 v4, v60, v61, v62
    v_max3_u32 v5, v64, v65, v66
    v_max3_u32 v4, v4, v63, v67
    v_max_u32 v4, v4, v5
    v_cmp_eq_u32 vcc, -1, v4
    s_nop 0
    s_cbranch_vccnz Lre_6
    buffer_load_dwordx4 v[68:71], v13, s[28:31], s56 offen offset:2048 sc1
    buffer_load_dwordx4 v[72:75], v13, s[28:31], s56 offen offset:3072 sc1
    buffer_load_dwordx4 v[76:79], v13, s[28:31], s57 offen offset:0 sc1
    buffer_load_dwordx4 v[80:83], v13, s[28:31], s57 offen offset:1024 sc1
    buffer_load_dwordx4 v[84:87], v13, s[28:31], s57 offen offset:2048 sc1
    buffer_load_dwordx4 v[88:91], v13, s[28:31], s57 offen offset:3072 sc1
    s_branch Lck_6
Lre_7:
    s_mov_b32 s41, 1
    s_sub_u32 s35, s35, 1
    s_cbranch_scc1 Lend
    s_sleep 2
    buffer_load_dwordx4 v[68:71], v13, s[28:31], s56 offen offset:2048 sc1
    buffer_load_dwordx4 v[72:75], v13, s[28:31], s56 offen offset:3072 sc1
    s_waitcnt vmcnt(0)
    v_max3_u32 v4, v68, v69, v70
    v_max3_u32 v5, v72, v73, v74
    v_max3_u32 v4, v4, v71, v75
    v_max_u32 v4, v4, v5
    v_cmp_eq_u32 vcc, -1, v4
    s_nop 0
    s_cbranch_vccnz Lre_7
    buffer_load_dwordx4 v[76:79], v13, s[28:31], s57 offen offset:0 sc1
    buffer_load_dwordx4 v[80:83], v13, s[28:31], s57 offen offset:1024 sc1
    buffer_load_dwordx4 v[84:87], v13, s[28:31], s57 offen offset:2048 sc1
    buffer_load_dwordx4 v[88:91], v13, s[28:31], s57 offen offset:3072 sc1
    s_branch Lck_7
Lre_8:
    s_mov_b32 s41, 1
    s_sub_u32 s35, s35, 1
    s_cbranch_scc1 Lend
    s_sleep 2
    buffer_load_dwordx4 v[76:79], v13, s[28:31], s57 offen offset:0 sc1
    buffer_load_dwordx4 v[80:83], v13, s[28:31], s57 offen offset:1024 sc1
    s_waitcnt vmcnt(0)
    v_max3_u32 v4, v76, v77, v78
    v_max3_u32 v5, v80, v81, v82
    v_max3_u32 v4, v4, v79, v83
    v_max_u32 v4, v4, v5
    v_cmp_eq_u32 vcc, -1, v4
    s_nop 0
    s_cbranch_vccnz Lre_8
    buffer_load_dwordx4 v[84:87], v13, s[28:31], s57 offen offset:2048 sc1
    buffer_load_dwordx4 v[88:91], v13, s[28:31], s57 offen offset:3072 sc1
    s_branch Lck_8
Lre_9:
    s_mov_b32 s41, 1
    s_sub_u32 s35, s35, 1
    s_cbranch_scc1 Lend
    s_sleep 2
    buffer_load_dwordx4 v[84:87], v13, s[28:31], s57 offen offset:2048 sc1
    buffer_load_dwordx4 v[88:91], v13, s[28:31], s57 offen offset:3072 sc1
    s_waitcnt vmcnt(0)
    v_max3_u32 v4, v84, v85, v86
    v_max3_u32 v5, v88, v89, v90
    v_max3_u32 v4, v4, v87, v91
    v_max_u32 v4, v4, v5
    v_cmp_eq_u32 vcc, -1, v4
    s_nop 0
    s_cbranch_vccnz Lre_9
    s_branch Lck_9
Lfix:
    s_mov_b64 vcc, s[38:39]
    v_lshlrev_b32 v6, 4, v2
    v_add_u32 v6, 158208, v6
    v_mov_b32 v10, 157956
Lcw_5:
    s_sub_u32 s35, s35, 1
    s_cbranch_scc1 Lend
    ds_read_b32 v11, v10
    s_waitcnt lgkmcnt(0)
    v_readfirstlane_b32 s38, v11
    s_nop 0
    s_cmp_lt_u32 s38, 1
    s_cbranch_scc1 Lcw_5
    s_mov_b64 exec, s[36:37]
    ds_read_b128 v[44:47], v6 offset:0
    ds_read_b128 v[48:51], v6 offset:64
    ds_read_b128 v[52:55], v6 offset:128
    ds_read_b128 v[56:59], v6 offset:192
    s_mov_b64 exec, vcc
    ds_read_b128 v[44:47], v6 offset:256
    ds_read_b128 v[48:51], v6 offset:320
    ds_read_b128 v[52:55], v6 offset:384
    ds_read_b128 v[56:59], v6 offset:448
    s_mov_b64 exec, -1
    s_waitcnt lgkmcnt(0)
    s_branch Lnofix
Lhalo:
    s_mov_b32 vcc_lo, 0x00010001
    s_mov_b32 vcc_hi, 0x00010001
    v_mov_b32 v11, 38912
    v_cndmask_b32 v76, v76, v11, vcc
    v_xor_b32 v77, 64, v76
    v_add_u32 v80, 78080, v76
    v_add_u32 v81, 78080, v77
    v_mov_b32 v14, 0x3f803f80
    v_mov_b32 v15, 0x3f803f80
    v_mov_b32 v16, 0x3f803f80
    v_mov_b32 v17, 0x3f803f80
    v_and_b32 v4, 7, v1
    v_lshlrev_b32 v4, 4, v4
    v_mul_u32_u24 v5, 39040, v2
    v_add_u32 v4, v4, v5
    ds_write_b128 v4, v[14:17] offset:38912
    v_mov_b32 v4, 157952
    v_mov_b32 v8, 0
    v_mov_b32 v9, 0
    v_mov_b32 v10, -2
    v_mov_b32 v11, -2
    ds_write_b128 v4, v[8:11]
    v_min_u32 v5, 23, v1
    v_lshl_add_u32 v5, v5, 2, v4
    ds_write_b32 v5, v8 offset:16
    s_mul_i32 s36, s32, 96
    s_sub_u32 s36, s36, 16
    v_add_u32 v96, s36, v1
    v_min_u32 v5, 47, v1
    v_add3_u32 v97, s36, v5, 64
    v_mov_b32 v6, 2047
    v_med3_i32 v96, v96, 0, v6
    v_med3_i32 v97, v97, 0, v6
    v_lshlrev_b32 v96, 3, v96
    v_lshlrev_b32 v97, 3, v97
    s_mov_b32 s46, 8192000
    v_mov_b32 v127, 157984
    s_lshl_b32 s36, s3, 2
    s_add_u32 s36, s36, 158016
    v_mov_b32 v10, s36
    s_mov_b32 vcc_lo, 0x00010001
    s_mov_b32 vcc_hi, 0x00010001
    v_cndmask_b32 v116, 0, v14, vcc
    v_cndmask_b32 v117, 0, v15, vcc
    v_cndmask_b32 v118, 0, v16, vcc
    v_cndmask_b32 v119, 0, v17, vcc
    s_waitcnt lgkmcnt(0)
    s_barrier
    s_add_u32 s34, s34, 0x9e3779b8
    s_or_b32 s34, s34, 1
    ds_read_b128 v[108:111], v76 offset:0
    ds_read_b128 v[112:115], v77 offset:0
    ds_read_b64_tr_b16 a[0:1], v20 offset:0
    ds_read_b64_tr_b16 a[2:3], v20 offset:512
    ds_read_b64_tr_b16 a[4:5], v21 offset:0
    ds_read_b64_tr_b16 a[6:7], v21 offset:512
    ds_read_b64_tr_b16 a[8:9], v22 offset:0
    ds_read_b64_tr_b16 a[10:11], v22 offset:512
    ds_read_b64_tr_b16 a[12:13], v23 offset:0
    ds_read_b64_tr_b16 a[14:15], v23 offset:512
    ds_read_b64_tr_b16 a[16:17], v20 offset:8192
    ds_read_b64_tr_b16 a[18:19], v20 offset:8704
    ds_read_b64_tr_b16 a[20:21], v21 offset:8192
    ds_read_b64_tr_b16 a[22:23], v21 offset:8704
    ds_read_b64_tr_b16 a[24:25], v22 offset:8192
    ds_read_b64_tr_b16 a[26:27], v22 offset:8704
    s_waitcnt lgkmcnt(12)
    v_mfma_f32_16x16x32_bf16 v[28:31], a[0:3], v[116:119], 0
    ds_read_b64_tr_b16 a[28:29], v23 offset:8192
    ds_read_b64_tr_b16 a[30:31], v23 offset:8704
    s_waitcnt lgkmcnt(12)
    v_mfma_f32_16x16x32_bf16 v[32:35], a[4:7], v[116:119], 0
    ds_read_b64_tr_b16 a[32:33], v20 offset:16384
    ds_read_b64_tr_b16 a[34:35], v20 offset:16896
    s_waitcnt lgkmcnt(12)
    v_mfma_f32_16x16x32_bf16 v[36:39], a[8:11], v[116:119], 0
    ds_read_b64_tr_b16 a[36:37], v21 offset:16384
    ds_read_b64_tr_b16 a[38:39], v21 offset:16896
    s_waitcnt lgkmcnt(12)
    v_mfma_f32_16x16x32_bf16 v[40:43], a[12:15], v[116:119], 0
    ds_read_b64_tr_b16 a[40:41], v22 offset:16384
    ds_read_b64_tr_b16 a[42:43], v22 offset:16896
    s_waitcnt lgkmcnt(12)
    v_mfma_f32_16x16x32_bf16 v[44:47], a[16:19], v[108:111], 0
    ds_read_b64_tr_b16 a[44:45], v23 offset:16384
    ds_read_b64_tr_b16 a[46:47], v23 offset:16896
    s_waitcnt lgkmcnt(12)
    v_mfma_f32_16x16x32_bf16 v[48:51], a[20:23], v[108:111], 0
    ds_read_b64_tr_b16 a[48:49], v20 offset:4096
    ds_read_b64_tr_b16 a[50:51], v20 offset:4608
    s_waitcnt lgkmcnt(12)
    v_mfma_f32_16x16x32_bf16 v[52:55], a[24:27], v[108:111], 0
    ds_read_b64_tr_b16 a[52:53], v21 offset:4096
    ds_read_b64_tr_b16 a[54:55], v21 offset:4608
    s_waitcnt lgkmcnt(12)
    v_mfma_f32_16x16x32_bf16 v[56:59], a[28:31], v[108:111], 0
    ds_read_b64_tr_b16 a[56:57], v22 offset:4096
    ds_read_b64_tr_b16 a[58:59], v22 offset:4608
    s_waitcnt lgkmcnt(12)
    v_mfma_f32_16x16x32_bf16 v[60:63], v[108:111], a[32:35], 0
    ds_read_b64_tr_b16 a[60:61], v23 offset:4096
    ds_read_b64_tr_b16 a[62:63], v23 offset:4608
    s_waitcnt lgkmcnt(12)
    v_mfma_f32_16x16x32_bf16 v[64:67], v[108:111], a[36:39], 0
    ds_read_b64_tr_b16 a[64:65], v20 offset:12288
    ds_read_b64_tr_b16 a[66:67], v20 offset:12800
    s_waitcnt lgkmcnt(12)
    v_mfma_f32_16x16x32_bf16 v[68:71], v[108:111], a[40:43], 0
    ds_read_b64_tr_b16 a[68:69], v21 offset:12288
    ds_read_b64_tr_b16 a[70:71], v21 offset:12800
    s_waitcnt lgkmcnt(12)
    v_mfma_f32_16x16x32_bf16 v[72:75], v[108:111], a[44:47], 0
    ds_read_b64_tr_b16 a[72:73], v22 offset:12288
    ds_read_b64_tr_b16 a[74:75], v22 offset:12800
    s_waitcnt lgkmcnt(12)
    v_mfma_f32_16x16x32_bf16 v[28:31], a[48:51], v[116:119], v[28:31]
    ds_read_b64_tr_b16 a[76:77], v23 offset:12288
    ds_read_b64_tr_b16 a[78:79], v23 offset:12800
    s_waitcnt lgkmcnt(12)
    v_mfma_f32_16x16x32_bf16 v[32:35], a[52:55], v[116:119], v[32:35]
    ds_read_b64_tr_b16 a[80:81], v20 offset:20480
    ds_read_b64_tr_b16 a[82:83], v20 offset:20992
    s_waitcnt lgkmcnt(12)
    v_mfma_f32_16x16x32_bf16 v[36:39], a[56:59], v[116:119], v[36:39]
    ds_read_b64_tr_b16 a[84:85], v21 offset:20480
    ds_read_b64_tr_b16 a[86:87], v21 offset:20992
    s_waitcnt lgkmcnt(12)
    v_mfma_f32_16x16x32_bf16 v[40:43], a[60:63], v[116:119], v[40:43]
    ds_read_b64_tr_b16 a[88:89], v22 offset:20480
    ds_read_b64_tr_b16 a[90:91], v22 offset:20992
    s_waitcnt lgkmcnt(12)
    v_mfma_f32_16x16x32_bf16 v[44:47], a[64:67], v[112:115], v[44:47]
    ds_read_b64_tr_b16 a[92:93], v23 offset:20480
    ds_read_b64_tr_b16 a[94:95], v23 offset:20992
    s_waitcnt lgkmcnt(12)
    v_mfma_f32_16x16x32_bf16 v[48:51], a[68:71], v[112:115], v[48:51]
    s_waitcnt lgkmcnt(10)
    v_mfma_f32_16x16x32_bf16 v[52:55], a[72:75], v[112:115], v[52:55]
    s_waitcnt lgkmcnt(8)
    v_mfma_f32_16x16x32_bf16 v[56:59], a[76:79], v[112:115], v[56:59]
    s_waitcnt lgkmcnt(6)
    v_mfma_f32_16x16x32_bf16 v[60:63], v[112:115], a[80:83], v[60:63]
    s_waitcnt lgkmcnt(4)
    v_mfma_f32_16x16x32_bf16 v[64:67], v[112:115], a[84:87], v[64:67]
    s_waitcnt lgkmcnt(2)
    v_mfma_f32_16x16x32_bf16 v[68:71], v[112:115], a[88:91], v[68:71]
    s_waitcnt lgkmcnt(0)
    v_mfma_f32_16x16x32_bf16 v[72:75], v[112:115], a[92:95], v[72:75]
    s_barrier
    ds_read_b128 v[108:111], v76 offset:39040
    ds_read_b128 v[112:115], v77 offset:39040
    ds_read_b64_tr_b16 a[0:1], v20 offset:39040
    ds_read_b64_tr_b16 a[2:3], v20 offset:39552
    ds_read_b64_tr_b16 a[4:5], v21 offset:39040
    ds_read_b64_tr_b16 a[6:7], v21 offset:39552
    ds_read_b64_tr_b16 a[8:9], v22 offset:39040
    ds_read_b64_tr_b16 a[10:11], v22 offset:39552
    ds_read_b64_tr_b16 a[12:13], v23 offset:39040
    ds_read_b64_tr_b16 a[14:15], v23 offset:39552
    ds_read_b64_tr_b16 a[16:17], v20 offset:47232
    ds_read_b64_tr_b16 a[18:19], v20 offset:47744
    ds_read_b64_tr_b16 a[20:21], v21 offset:47232
    ds_read_b64_tr_b16 a[22:23], v21 offset:47744
    ds_read_b64_tr_b16 a[24:25], v22 offset:47232
    ds_read_b64_tr_b16 a[26:27], v22 offset:47744
    s_waitcnt lgkmcnt(12)
    v_mfma_f32_16x16x32_bf16 v[28:31], a[0:3], v[116:119], v[28:31]
    ds_read_b64_tr_b16 a[28:29], v23 offset:47232
    ds_read_b64_tr_b16 a[30:31], v23 offset:47744
    s_waitcnt lgkmcnt(12)
    v_mfma_f32_16x16x32_bf16 v[32:35], a[4:7], v[116:119], v[32:35]
    ds_read_b64_tr_b16 a[32:33], v20 offset:55424
    ds_read_b64_tr_b16 a[34:35], v20 offset:55936
    s_waitcnt lgkmcnt(12)
    v_mfma_f32_16x16x32_bf16 v[36:39], a[8:11], v[116:119], v[36:39]
    ds_read_b64_tr_b16 a[36:37], v21 offset:55424
    ds_read_b64_tr_b16 a[38:39], v21 offset:55936
    s_waitcnt lgkmcnt(12)
    v_mfma_f32_16x16x32_bf16 v[40:43], a[12:15], v[116:119], v[40:43]
    ds_read_b64_tr_b16 a[40:41], v22 offset:55424
    ds_read_b64_tr_b16 a[42:43], v22 offset:55936
    s_waitcnt lgkmcnt(12)
    v_mfma_f32_16x16x32_bf16 v[44:47], a[16:19], v[108:111], v[44:47]
    ds_read_b64_tr_b16 a[44:45], v23 offset:55424
    ds_read_b64_tr_b16 a[46:47], v23 offset:55936
    s_waitcnt lgkmcnt(12)
    v_mfma_f32_16x16x32_bf16 v[48:51], a[20:23], v[108:111], v[48:51]
    ds_read_b64_tr_b16 a[48:49], v20 offset:43136
    ds_read_b64_tr_b16 a[50:51], v20 offset:43648
    s_waitcnt lgkmcnt(12)
    v_mfma_f32_16x16x32_bf16 v[52:55], a[24:27], v[108:111], v[52:55]
    ds_read_b64_tr_b16 a[52:53], v21 offset:43136
    ds_read_b64_tr_b16 a[54:55], v21 offset:43648
    s_waitcnt lgkmcnt(12)
    v_mfma_f32_16x16x32_bf16 v[56:59], a[28:31], v[108:111], v[56:59]
    ds_read_b64_tr_b16 a[56:57], v22 offset:43136
    ds_read_b64_tr_b16 a[58:59], v22 offset:43648
    s_waitcnt lgkmcnt(12)
    v_mfma_f32_16x16x32_bf16 v[60:63], v[108:111], a[32:35], v[60:63]
    ds_read_b64_tr_b16 a[60:61], v23 offset:43136
    ds_read_b64_tr_b16 a[62:63], v23 offset:43648
    s_waitcnt lgkmcnt(12)
    v_mfma_f32_16x16x32_bf16 v[64:67], v[108:111], a[36:39], v[64:67]
    ds_read_b64_tr_b16 a[64:65], v20 offset:51328
    ds_read_b64_tr_b16 a[66:67], v20 offset:51840
    s_waitcnt lgkmcnt(12)
    v_mfma_f32_16x16x32_bf16 v[68:71], v[108:111], a[40:43], v[68:71]
    ds_read_b64_tr_b16 a[68:69], v21 offset:51328
    ds_read_b64_tr_b16 a[70:71], v21 offset:51840
    s_waitcnt lgkmcnt(12)
    v_mfma_f32_16x16x32_bf16 v[72:75], v[108:111], a[44:47], v[72:75]
    ds_read_b64_tr_b16 a[72:73], v22 offset:51328
    ds_read_b64_tr_b16 a[74:75], v22 offset:51840
    s_waitcnt lgkmcnt(12)
    v_mfma_f32_16x16x32_bf16 v[28:31], a[48:51], v[116:119], v[28:31]
    ds_read_b64_tr_b16 a[76:77], v23 offset:51328
    ds_read_b64_tr_b16 a[78:79], v23 offset:51840
    s_waitcnt lgkmcnt(12)
    v_mfma_f32_16x16x32_bf16 v[32:35], a[52:55], v[116:119], v[32:35]
    ds_read_b64_tr_b16 a[80:81], v20 offset:59520
    ds_read_b64_tr_b16 a[82:83], v20 offset:60032
    s_waitcnt lgkmcnt(12)
    v_mfma_f32_16x16x32_bf16 v[36:39], a[56:59], v[116:119], v[36:39]
    ds_read_b64_tr_b16 a[84:85], v21 offset:59520
    ds_read_b64_tr_b16 a[86:87], v21 offset:60032
    s_waitcnt lgkmcnt(12)
    v_mfma_f32_16x16x32_bf16 v[40:43], a[60:63], v[116:119], v[40:43]
    ds_read_b64_tr_b16 a[88:89], v22 offset:59520
    ds_read_b64_tr_b16 a[90:91], v22 offset:60032
    s_waitcnt lgkmcnt(12)
    v_mfma_f32_16x16x32_bf16 v[44:47], a[64:67], v[112:115], v[44:47]
    ds_read_b64_tr_b16 a[92:93], v23 offset:59520
    ds_read_b64_tr_b16 a[94:95], v23 offset:60032
    s_waitcnt lgkmcnt(12)
    v_mfma_f32_16x16x32_bf16 v[48:51], a[68:71], v[112:115], v[48:51]
    s_waitcnt lgkmcnt(10)
    v_mfma_f32_16x16x32_bf16 v[52:55], a[72:75], v[112:115], v[52:55]
    s_waitcnt lgkmcnt(8)
    v_mfma_f32_16x16x32_bf16 v[56:59], a[76:79], v[112:115], v[56:59]
    s_waitcnt lgkmcnt(6)
    v_mfma_f32_16x16x32_bf16 v[60:63], v[112:115], a[80:83], v[60:63]
    s_waitcnt lgkmcnt(4)
    v_mfma_f32_16x16x32_bf16 v[64:67], v[112:115], a[84:87], v[64:67]
    s_waitcnt lgkmcnt(2)
    v_mfma_f32_16x16x32_bf16 v[68:71], v[112:115], a[88:91], v[68:71]
    s_waitcnt lgkmcnt(0)
    v_mfma_f32_16x16x32_bf16 v[72:75], v[112:115], a[92:95], v[72:75]
    s_mov_b64 exec, 1
    s_lshl_b32 s36, s2, 2
    s_add_u32 s36, s36, 8323072
    v_mov_b32 v4, s34
    v_mov_b32 v5, s36
    buffer_store_dword v4, v5, s[28:31], 0 offen sc1
    s_mov_b64 exec, -1
    s_barrier
    ds_read_b128 v[108:111], v80 offset:0
    ds_read_b128 v[112:115], v81 offset:0
    ds_read_b64_tr_b16 a[0:1], v24 offset:0
    ds_read_b64_tr_b16 a[2:3], v24 offset:512
    ds_read_b64_tr_b16 a[4:5], v25 offset:0
    ds_read_b64_tr_b16 a[6:7], v25 offset:512
    ds_read_b64_tr_b16 a[8:9], v26 offset:0
    ds_read_b64_tr_b16 a[10:11], v26 offset:512
    ds_read_b64_tr_b16 a[12:13], v27 offset:0
    ds_read_b64_tr_b16 a[14:15], v27 offset:512
    ds_read_b64_tr_b16 a[16:17], v24 offset:8192
    ds_read_b64_tr_b16 a[18:19], v24 offset:8704
    ds_read_b64_tr_b16 a[20:21], v25 offset:8192
    ds_read_b64_tr_b16 a[22:23], v25 offset:8704
    ds_read_b64_tr_b16 a[24:25], v26 offset:8192
    ds_read_b64_tr_b16 a[26:27], v26 offset:8704
    s_waitcnt lgkmcnt(12)
    v_mfma_f32_16x16x32_bf16 v[28:31], a[0:3], v[116:119], v[28:31]
    ds_read_b64_tr_b16 a[28:29], v27 offset:8192
    ds_read_b64_tr_b16 a[30:31], v27 offset:8704
    s_waitcnt lgkmcnt(12)
    v_mfma_f32_16x16x32_bf16 v[32:35], a[4:7], v[116:119], v[32:35]
    ds_read_b64_tr_b16 a[32:33], v24 offset:16384
    ds_read_b64_tr_b16 a[34:35], v24 offset:16896
    s_waitcnt lgkmcnt(12)
    v_mfma_f32_16x16x32_bf16 v[36:39], a[8:11], v[116:119], v[36:39]
    ds_read_b64_tr_b16 a[36:37], v25 offset:16384
    ds_read_b64_tr_b16 a[38:39], v25 offset:16896
    s_waitcnt lgkmcnt(12)
    v_mfma_f32_16x16x32_bf16 v[40:43], a[12:15], v[116:119], v[40:43]
    ds_read_b64_tr_b16 a[40:41], v26 offset:16384
    ds_read_b64_tr_b16 a[42:43], v26 offset:16896
    s_waitcnt lgkmcnt(12)
    v_mfma_f32_16x16x32_bf16 v[44:47], a[16:19], v[108:111], v[44:47]
    ds_read_b64_tr_b16 a[44:45], v27 offset:16384
    ds_read_b64_tr_b16 a[46:47], v27 offset:16896
    s_waitcnt lgkmcnt(12)
    v_mfma_f32_16x16x32_bf16 v[48:51], a[20:23], v[108:111], v[48:51]
    ds_read_b64_tr_b16 a[48:49], v24 offset:4096
    ds_read_b64_tr_b16 a[50:51], v24 offset:4608
    s_waitcnt lgkmcnt(12)
    v_mfma_f32_16x16x32_bf16 v[52:55], a[24:27], v[108:111], v[52:55]
    ds_read_b64_tr_b16 a[52:53], v25 offset:4096
    ds_read_b64_tr_b16 a[54:55], v25 offset:4608
    s_waitcnt lgkmcnt(12)
    v_mfma_f32_16x16x32_bf16 v[56:59], a[28:31], v[108:111], v[56:59]
    ds_read_b64_tr_b16 a[56:57], v26 offset:4096
    ds_read_b64_tr_b16 a[58:59], v26 offset:4608
    s_waitcnt lgkmcnt(12)
    v_mfma_f32_16x16x32_bf16 v[60:63], v[108:111], a[32:35], v[60:63]
    ds_read_b64_tr_b16 a[60:61], v27 offset:4096
    ds_read_b64_tr_b16 a[62:63], v27 offset:4608
    s_waitcnt lgkmcnt(12)
    v_mfma_f32_16x16x32_bf16 v[64:67], v[108:111], a[36:39], v[64:67]
    ds_read_b64_tr_b16 a[64:65], v24 offset:12288
    ds_read_b64_tr_b16 a[66:67], v24 offset:12800
    s_waitcnt lgkmcnt(12)
    v_mfma_f32_16x16x32_bf16 v[68:71], v[108:111], a[40:43], v[68:71]
    ds_read_b64_tr_b16 a[68:69], v25 offset:12288
    ds_read_b64_tr_b16 a[70:71], v25 offset:12800
    s_waitcnt lgkmcnt(12)
    v_mfma_f32_16x16x32_bf16 v[72:75], v[108:111], a[44:47], v[72:75]
    ds_read_b64_tr_b16 a[72:73], v26 offset:12288
    ds_read_b64_tr_b16 a[74:75], v26 offset:12800
    s_waitcnt lgkmcnt(12)
    v_mfma_f32_16x16x32_bf16 v[28:31], a[48:51], v[116:119], v[28:31]
    ds_read_b64_tr_b16 a[76:77], v27 offset:12288
    ds_read_b64_tr_b16 a[78:79], v27 offset:12800
    s_waitcnt lgkmcnt(12)
    v_mfma_f32_16x16x32_bf16 v[32:35], a[52:55], v[116:119], v[32:35]
    ds_read_b64_tr_b16 a[80:81], v24 offset:20480
    ds_read_b64_tr_b16 a[82:83], v24 offset:20992
    s_waitcnt lgkmcnt(12)
    v_mfma_f32_16x16x32_bf16 v[36:39], a[56:59], v[116:119], v[36:39]
    ds_read_b64_tr_b16 a[84:85], v25 offset:20480
    ds_read_b64_tr_b16 a[86:87], v25 offset:20992
    s_waitcnt lgkmcnt(12)
    v_mfma_f32_16x16x32_bf16 v[40:43], a[60:63], v[116:119], v[40:43]
    ds_read_b64_tr_b16 a[88:89], v26 offset:20480
    ds_read_b64_tr_b16 a[90:91], v26 offset:20992
    s_waitcnt lgkmcnt(12)
    v_mfma_f32_16x16x32_bf16 v[44:47], a[64:67], v[112:115], v[44:47]
    ds_read_b64_tr_b16 a[92:93], v27 offset:20480
    ds_read_b64_tr_b16 a[94:95], v27 offset:20992
    s_waitcnt lgkmcnt(12)
    v_mfma_f32_16x16x32_bf16 v[48:51], a[68:71], v[112:115], v[48:51]
    s_waitcnt lgkmcnt(10)
    v_mfma_f32_16x16x32_bf16 v[52:55], a[72:75], v[112:115], v[52:55]
    s_waitcnt lgkmcnt(8)
    v_mfma_f32_16x16x32_bf16 v[56:59], a[76:79], v[112:115], v[56:59]
    s_waitcnt lgkmcnt(6)
    v_mfma_f32_16x16x32_bf16 v[60:63], v[112:115], a[80:83], v[60:63]
    s_waitcnt lgkmcnt(4)
    v_mfma_f32_16x16x32_bf16 v[64:67], v[112:115], a[84:87], v[64:67]
    s_waitcnt lgkmcnt(2)
    v_mfma_f32_16x16x32_bf16 v[68:71], v[112:115], a[88:91], v[68:71]
    s_waitcnt lgkmcnt(0)
    v_mfma_f32_16x16x32_bf16 v[72:75], v[112:115], a[92:95], v[72:75]
    s_barrier
    ds_read_b128 v[108:111], v80 offset:39040
    ds_read_b128 v[112:115], v81 offset:39040
    ds_read_b64_tr_b16 a[0:1], v24 offset:39040
    ds_read_b64_tr_b16 a[2:3], v24 offset:39552
    ds_read_b64_tr_b16 a[4:5], v25 offset:39040
    ds_read_b64_tr_b16 a[6:7], v25 offset:39552
    ds_read_b64_tr_b16 a[8:9], v26 offset:39040
    ds_read_b64_tr_b16 a[10:11], v26 offset:39552
    ds_read_b64_tr_b16 a[12:13], v27 offset:39040
    ds_read_b64_tr_b16 a[14:15], v27 offset:39552
    ds_read_b64_tr_b16 a[16:17], v24 offset:47232
    ds_read_b64_tr_b16 a[18:19], v24 offset:47744
    ds_read_b64_tr_b16 a[20:21], v25 offset:47232
    ds_read_b64_tr_b16 a[22:23], v25 offset:47744
    ds_read_b64_tr_b16 a[24:25], v26 offset:47232
    ds_read_b64_tr_b16 a[26:27], v26 offset:47744
    s_waitcnt lgkmcnt(12)
    v_mfma_f32_16x16x32_bf16 v[28:31], a[0:3], v[116:119], v[28:31]
    ds_read_b64_tr_b16 a[28:29], v27 offset:47232
    ds_read_b64_tr_b16 a[30:31], v27 offset:47744
    s_waitcnt lgkmcnt(12)
    v_mfma_f32_16x16x32_bf16 v[32:35], a[4:7], v[116:119], v[32:35]
    ds_read_b64_tr_b16 a[32:33], v24 offset:55424
    ds_read_b64_tr_b16 a[34:35], v24 offset:55936
    s_waitcnt lgkmcnt(12)
    v_mfma_f32_16x16x32_bf16 v[36:39], a[8:11], v[116:119], v[36:39]
    ds_read_b64_tr_b16 a[36:37], v25 offset:55424
    ds_read_b64_tr_b16 a[38:39], v25 offset:55936
    s_waitcnt lgkmcnt(12)
    v_mfma_f32_16x16x32_bf16 v[40:43], a[12:15], v[116:119], v[40:43]
    ds_read_b64_tr_b16 a[40:41], v26 offset:55424
    ds_read_b64_tr_b16 a[42:43], v26 offset:55936
    s_waitcnt lgkmcnt(12)
    v_mfma_f32_16x16x32_bf16 v[44:47], a[16:19], v[108:111], v[44:47]
    ds_read_b64_tr_b16 a[44:45], v27 offset:55424
    ds_read_b64_tr_b16 a[46:47], v27 offset:55936
    s_waitcnt lgkmcnt(12)
    v_mfma_f32_16x16x32_bf16 v[48:51], a[20:23], v[108:111], v[48:51]
    ds_read_b64_tr_b16 a[48:49], v24 offset:43136
    ds_read_b64_tr_b16 a[50:51], v24 offset:43648
    s_waitcnt lgkmcnt(12)
    v_mfma_f32_16x16x32_bf16 v[52:55], a[24:27], v[108:111], v[52:55]
    ds_read_b64_tr_b16 a[52:53], v25 offset:43136
    ds_read_b64_tr_b16 a[54:55], v25 offset:43648
    s_waitcnt lgkmcnt(12)
    v_mfma_f32_16x16x32_bf16 v[56:59], a[28:31], v[108:111], v[56:59]
    ds_read_b64_tr_b16 a[56:57], v26 offset:43136
    ds_read_b64_tr_b16 a[58:59], v26 offset:43648
    s_waitcnt lgkmcnt(12)
    v_mfma_f32_16x16x32_bf16 v[60:63], v[108:111], a[32:35], v[60:63]
    ds_read_b64_tr_b16 a[60:61], v27 offset:43136
    ds_read_b64_tr_b16 a[62:63], v27 offset:43648
    s_waitcnt lgkmcnt(12)
    v_mfma_f32_16x16x32_bf16 v[64:67], v[108:111], a[36:39], v[64:67]
    ds_read_b64_tr_b16 a[64:65], v24 offset:51328
    ds_read_b64_tr_b16 a[66:67], v24 offset:51840
    s_waitcnt lgkmcnt(12)
    v_mfma_f32_16x16x32_bf16 v[68:71], v[108:111], a[40:43], v[68:71]
    ds_read_b64_tr_b16 a[68:69], v25 offset:51328
    ds_read_b64_tr_b16 a[70:71], v25 offset:51840
    s_waitcnt lgkmcnt(12)
    v_mfma_f32_16x16x32_bf16 v[72:75], v[108:111], a[44:47], v[72:75]
    ds_read_b64_tr_b16 a[72:73], v26 offset:51328
    ds_read_b64_tr_b16 a[74:75], v26 offset:51840
    s_waitcnt lgkmcnt(12)
    v_mfma_f32_16x16x32_bf16 v[28:31], a[48:51], v[116:119], v[28:31]
    ds_read_b64_tr_b16 a[76:77], v27 offset:51328
    ds_read_b64_tr_b16 a[78:79], v27 offset:51840
    s_waitcnt lgkmcnt(12)
    v_mfma_f32_16x16x32_bf16 v[32:35], a[52:55], v[116:119], v[32:35]
    ds_read_b64_tr_b16 a[80:81], v24 offset:59520
    ds_read_b64_tr_b16 a[82:83], v24 offset:60032
    s_waitcnt lgkmcnt(12)
    v_mfma_f32_16x16x32_bf16 v[36:39], a[56:59], v[116:119], v[36:39]
    ds_read_b64_tr_b16 a[84:85], v25 offset:59520
    ds_read_b64_tr_b16 a[86:87], v25 offset:60032
    s_waitcnt lgkmcnt(12)
    v_mfma_f32_16x16x32_bf16 v[40:43], a[60:63], v[116:119], v[40:43]
    ds_read_b64_tr_b16 a[88:89], v26 offset:59520
    ds_read_b64_tr_b16 a[90:91], v26 offset:60032
    s_waitcnt lgkmcnt(12)
    v_mfma_f32_16x16x32_bf16 v[44:47], a[64:67], v[112:115], v[44:47]
    ds_read_b64_tr_b16 a[92:93], v27 offset:59520
    ds_read_b64_tr_b16 a[94:95], v27 offset:60032
    s_waitcnt lgkmcnt(12)
    v_mfma_f32_16x16x32_bf16 v[48:51], a[68:71], v[112:115], v[48:51]
    s_waitcnt lgkmcnt(10)
    v_mfma_f32_16x16x32_bf16 v[52:55], a[72:75], v[112:115], v[52:55]
    s_waitcnt lgkmcnt(8)
    v_mfma_f32_16x16x32_bf16 v[56:59], a[76:79], v[112:115], v[56:59]
    s_waitcnt lgkmcnt(6)
    v_mfma_f32_16x16x32_bf16 v[60:63], v[112:115], a[80:83], v[60:63]
    s_waitcnt lgkmcnt(4)
    v_mfma_f32_16x16x32_bf16 v[64:67], v[112:115], a[84:87], v[64:67]
    s_waitcnt lgkmcnt(2)
    v_mfma_f32_16x16x32_bf16 v[68:71], v[112:115], a[88:91], v[68:71]
    s_waitcnt lgkmcnt(0)
    v_mfma_f32_16x16x32_bf16 v[72:75], v[112:115], a[92:95], v[72:75]
    v_add_u32 v4, 156224, v12
    v_min_u32 v5, 47, v1
    v_lshlrev_b32 v5, 2, v5
    v_add_u32 v5, 156480, v5
    v_lshlrev_b32 v6, 4, v2
    v_add_u32 v6, 157184, v6
    v_mov_b32 v7, 157968
    v_lshlrev_b32 v11, 2, v3
    v_add_u32 v11, 156224, v11
    s_barrier
    ds_read_b128 v[108:111], v76 offset:0
    ds_read_b128 v[112:115], v77 offset:0
    ds_read_b64_tr_b16 a[0:1], v20 offset:0
    ds_read_b64_tr_b16 a[2:3], v20 offset:512
    ds_read_b64_tr_b16 a[4:5], v21 offset:0
    ds_read_b64_tr_b16 a[6:7], v21 offset:512
    ds_read_b64_tr_b16 a[8:9], v22 offset:0
    ds_read_b64_tr_b16 a[10:11], v22 offset:512
    ds_read_b64_tr_b16 a[12:13], v23 offset:0
    ds_read_b64_tr_b16 a[14:15], v23 offset:512
    ds_read_b64_tr_b16 a[16:17], v20 offset:8192
    ds_read_b64_tr_b16 a[18:19], v20 offset:8704
    ds_read_b64_tr_b16 a[20:21], v21 offset:8192
    ds_read_b64_tr_b16 a[22:23], v21 offset:8704
    ds_read_b64_tr_b16 a[24:25], v22 offset:8192
    ds_read_b64_tr_b16 a[26:27], v22 offset:8704
    s_waitcnt lgkmcnt(12)
    v_mfma_f32_16x16x32_bf16 v[28:31], a[0:3], v[116:119], v[28:31]
    ds_read_b64_tr_b16 a[28:29], v23 offset:8192
    ds_read_b64_tr_b16 a[30:31], v23 offset:8704
    s_waitcnt lgkmcnt(12)
    v_mfma_f32_16x16x32_bf16 v[32:35], a[4:7], v[116:119], v[32:35]
    ds_read_b64_tr_b16 a[32:33], v20 offset:16384
    ds_read_b64_tr_b16 a[34:35], v20 offset:16896
    s_waitcnt lgkmcnt(12)
    v_mfma_f32_16x16x32_bf16 v[36:39], a[8:11], v[116:119], v[36:39]
    ds_read_b64_tr_b16 a[36:37], v21 offset:16384
    ds_read_b64_tr_b16 a[38:39], v21 offset:16896
    s_waitcnt lgkmcnt(12)
    v_mfma_f32_16x16x32_bf16 v[40:43], a[12:15], v[116:119], v[40:43]
    ds_read_b64_tr_b16 a[40:41], v22 offset:16384
    ds_read_b64_tr_b16 a[42:43], v22 offset:16896
    s_waitcnt lgkmcnt(12)
    v_mfma_f32_16x16x32_bf16 v[44:47], a[16:19], v[108:111], v[44:47]
    ds_read_b64_tr_b16 a[44:45], v23 offset:16384
    ds_read_b64_tr_b16 a[46:47], v23 offset:16896
    s_waitcnt lgkmcnt(12)
    v_mfma_f32_16x16x32_bf16 v[48:51], a[20:23], v[108:111], v[48:51]
    ds_read_b64_tr_b16 a[48:49], v20 offset:4096
    ds_read_b64_tr_b16 a[50:51], v20 offset:4608
    s_waitcnt lgkmcnt(12)
    v_mfma_f32_16x16x32_bf16 v[52:55], a[24:27], v[108:111], v[52:55]
    ds_read_b64_tr_b16 a[52:53], v21 offset:4096
    ds_read_b64_tr_b16 a[54:55], v21 offset:4608
    s_waitcnt lgkmcnt(12)
    v_mfma_f32_16x16x32_bf16 v[56:59], a[28:31], v[108:111], v[56:59]
    ds_read_b64_tr_b16 a[56:57], v22 offset:4096
    ds_read_b64_tr_b16 a[58:59], v22 offset:4608
    s_waitcnt lgkmcnt(12)
    v_mfma_f32_16x16x32_bf16 v[60:63], v[108:111], a[32:35], v[60:63]
    ds_read_b64_tr_b16 a[60:61], v23 offset:4096
    ds_read_b64_tr_b16 a[62:63], v23 offset:4608
    s_waitcnt lgkmcnt(12)
    v_mfma_f32_16x16x32_bf16 v[64:67], v[108:111], a[36:39], v[64:67]
    ds_read_b64_tr_b16 a[64:65], v20 offset:12288
    ds_read_b64_tr_b16 a[66:67], v20 offset:12800
    s_waitcnt lgkmcnt(12)
    v_mfma_f32_16x16x32_bf16 v[68:71], v[108:111], a[40:43], v[68:71]
    ds_read_b64_tr_b16 a[68:69], v21 offset:12288
    ds_read_b64_tr_b16 a[70:71], v21 offset:12800
    s_waitcnt lgkmcnt(12)
    v_mfma_f32_16x16x32_bf16 v[72:75], v[108:111], a[44:47], v[72:75]
    ds_read_b64_tr_b16 a[72:73], v22 offset:12288
    ds_read_b64_tr_b16 a[74:75], v22 offset:12800
    s_waitcnt lgkmcnt(12)
    v_mfma_f32_16x16x32_bf16 v[28:31], a[48:51], v[116:119], v[28:31]
    ds_read_b64_tr_b16 a[76:77], v23 offset:12288
    ds_read_b64_tr_b16 a[78:79], v23 offset:12800
    s_waitcnt lgkmcnt(12)
    v_mfma_f32_16x16x32_bf16 v[32:35], a[52:55], v[116:119], v[32:35]
    ds_read_b64_tr_b16 a[80:81], v20 offset:20480
    ds_read_b64_tr_b16 a[82:83], v20 offset:20992
    s_waitcnt lgkmcnt(12)
    v_mfma_f32_16x16x32_bf16 v[36:39], a[56:59], v[116:119], v[36:39]
    ds_read_b64_tr_b16 a[84:85], v21 offset:20480
    ds_read_b64_tr_b16 a[86:87], v21 offset:20992
    s_waitcnt lgkmcnt(12)
    v_mfma_f32_16x16x32_bf16 v[40:43], a[60:63], v[116:119], v[40:43]
    ds_read_b64_tr_b16 a[88:89], v22 offset:20480
    ds_read_b64_tr_b16 a[90:91], v22 offset:20992
    s_waitcnt lgkmcnt(12)
    v_mfma_f32_16x16x32_bf16 v[44:47], a[64:67], v[112:115], v[44:47]
    ds_read_b64_tr_b16 a[92:93], v23 offset:20480
    ds_read_b64_tr_b16 a[94:95], v23 offset:20992
    s_waitcnt lgkmcnt(12)
    v_mfma_f32_16x16x32_bf16 v[48:51], a[68:71], v[112:115], v[48:51]
    s_waitcnt lgkmcnt(10)
    v_mfma_f32_16x16x32_bf16 v[52:55], a[72:75], v[112:115], v[52:55]
    s_waitcnt lgkmcnt(8)
    v_mfma_f32_16x16x32_bf16 v[56:59], a[76:79], v[112:115], v[56:59]
    s_waitcnt lgkmcnt(6)
    v_mfma_f32_16x16x32_bf16 v[60:63], v[112:115], a[80:83], v[60:63]
    s_waitcnt lgkmcnt(4)
    v_mfma_f32_16x16x32_bf16 v[64:67], v[112:115], a[84:87], v[64:67]
    s_waitcnt lgkmcnt(2)
    v_mfma_f32_16x16x32_bf16 v[68:71], v[112:115], a[88:91], v[68:71]
    s_waitcnt lgkmcnt(0)
    v_mfma_f32_16x16x32_bf16 v[72:75], v[112:115], a[92:95], v[72:75]
    s_barrier
    ds_read_b128 v[108:111], v76 offset:39040
    ds_read_b128 v[112:115], v77 offset:39040
    ds_read_b64_tr_b16 a[0:1], v20 offset:39040
    ds_read_b64_tr_b16 a[2:3], v20 offset:39552
    ds_read_b64_tr_b16 a[4:5], v21 offset:39040
    ds_read_b64_tr_b16 a[6:7], v21 offset:39552
    ds_read_b64_tr_b16 a[8:9], v22 offset:39040
    ds_read_b64_tr_b16 a[10:11], v22 offset:39552
    ds_read_b64_tr_b16 a[12:13], v23 offset:39040
    ds_read_b64_tr_b16 a[14:15], v23 offset:39552
    ds_read_b64_tr_b16 a[16:17], v20 offset:47232
    ds_read_b64_tr_b16 a[18:19], v20 offset:47744
    ds_read_b64_tr_b16 a[20:21], v21 offset:47232
    ds_read_b64_tr_b16 a[22:23], v21 offset:47744
    ds_read_b64_tr_b16 a[24:25], v22 offset:47232
    ds_read_b64_tr_b16 a[26:27], v22 offset:47744
    s_waitcnt lgkmcnt(12)
    v_mfma_f32_16x16x32_bf16 v[28:31], a[0:3], v[116:119], v[28:31]
    ds_read_b64_tr_b16 a[28:29], v23 offset:47232
    ds_read_b64_tr_b16 a[30:31], v23 offset:47744
    s_waitcnt lgkmcnt(12)
    v_mfma_f32_16x16x32_bf16 v[32:35], a[4:7], v[116:119], v[32:35]
    ds_read_b64_tr_b16 a[32:33], v20 offset:55424
    ds_read_b64_tr_b16 a[34:35], v20 offset:55936
    s_waitcnt lgkmcnt(12)
    v_mfma_f32_16x16x32_bf16 v[36:39], a[8:11], v[116:119], v[36:39]
    ds_read_b64_tr_b16 a[36:37], v21 offset:55424
    ds_read_b64_tr_b16 a[38:39], v21 offset:55936
    s_waitcnt lgkmcnt(12)
    v_mfma_f32_16x16x32_bf16 v[40:43], a[12:15], v[116:119], v[40:43]
    ds_read_b64_tr_b16 a[40:41], v22 offset:55424
    ds_read_b64_tr_b16 a[42:43], v22 offset:55936
    s_waitcnt lgkmcnt(12)
    v_mfma_f32_16x16x32_bf16 v[44:47], a[16:19], v[108:111], v[44:47]
    ds_read_b64_tr_b16 a[44:45], v23 offset:55424
    ds_read_b64_tr_b16 a[46:47], v23 offset:55936
    s_waitcnt lgkmcnt(12)
    v_mfma_f32_16x16x32_bf16 v[48:51], a[20:23], v[108:111], v[48:51]
    ds_read_b64_tr_b16 a[48:49], v20 offset:43136
    ds_read_b64_tr_b16 a[50:51], v20 offset:43648
    s_waitcnt lgkmcnt(12)
    v_mfma_f32_16x16x32_bf16 v[52:55], a[24:27], v[108:111], v[52:55]
    ds_read_b64_tr_b16 a[52:53], v21 offset:43136
    ds_read_b64_tr_b16 a[54:55], v21 offset:43648
    s_waitcnt lgkmcnt(12)
    v_mfma_f32_16x16x32_bf16 v[56:59], a[28:31], v[108:111], v[56:59]
    ds_read_b64_tr_b16 a[56:57], v22 offset:43136
    ds_read_b64_tr_b16 a[58:59], v22 offset:43648
    s_waitcnt lgkmcnt(12)
    v_mfma_f32_16x16x32_bf16 v[60:63], v[108:111], a[32:35], v[60:63]
    ds_read_b64_tr_b16 a[60:61], v23 offset:43136
    ds_read_b64_tr_b16 a[62:63], v23 offset:43648
    s_waitcnt lgkmcnt(12)
    v_mfma_f32_16x16x32_bf16 v[64:67], v[108:111], a[36:39], v[64:67]
    ds_read_b64_tr_b16 a[64:65], v20 offset:51328
    ds_read_b64_tr_b16 a[66:67], v20 offset:51840
    s_waitcnt lgkmcnt(12)
    v_mfma_f32_16x16x32_bf16 v[68:71], v[108:111], a[40:43], v[68:71]
    ds_read_b64_tr_b16 a[68:69], v21 offset:51328
    ds_read_b64_tr_b16 a[70:71], v21 offset:51840
    s_waitcnt lgkmcnt(12)
    v_mfma_f32_16x16x32_bf16 v[72:75], v[108:111], a[44:47], v[72:75]
    ds_read_b64_tr_b16 a[72:73], v22 offset:51328
    ds_read_b64_tr_b16 a[74:75], v22 offset:51840
    s_waitcnt lgkmcnt(12)
    v_mfma_f32_16x16x32_bf16 v[28:31], a[48:51], v[116:119], v[28:31]
    ds_read_b64_tr_b16 a[76:77], v23 offset:51328
    ds_read_b64_tr_b16 a[78:79], v23 offset:51840
    s_waitcnt lgkmcnt(12)
    v_mfma_f32_16x16x32_bf16 v[32:35], a[52:55], v[116:119], v[32:35]
    ds_read_b64_tr_b16 a[80:81], v20 offset:59520
    ds_read_b64_tr_b16 a[82:83], v20 offset:60032
    s_waitcnt lgkmcnt(12)
    v_mfma_f32_16x16x32_bf16 v[36:39], a[56:59], v[116:119], v[36:39]
    ds_read_b64_tr_b16 a[84:85], v21 offset:59520
    ds_read_b64_tr_b16 a[86:87], v21 offset:60032
    s_waitcnt lgkmcnt(12)
    v_mfma_f32_16x16x32_bf16 v[40:43], a[60:63], v[116:119], v[40:43]
    ds_read_b64_tr_b16 a[88:89], v22 offset:59520
    ds_read_b64_tr_b16 a[90:91], v22 offset:60032
    s_waitcnt lgkmcnt(12)
    v_mfma_f32_16x16x32_bf16 v[44:47], a[64:67], v[112:115], v[44:47]
    ds_read_b64_tr_b16 a[92:93], v23 offset:59520
    ds_read_b64_tr_b16 a[94:95], v23 offset:60032
    s_waitcnt lgkmcnt(12)
    v_mfma_f32_16x16x32_bf16 v[48:51], a[68:71], v[112:115], v[48:51]
    s_waitcnt lgkmcnt(10)
    v_mfma_f32_16x16x32_bf16 v[52:55], a[72:75], v[112:115], v[52:55]
    s_waitcnt lgkmcnt(8)
    v_mfma_f32_16x16x32_bf16 v[56:59], a[76:79], v[112:115], v[56:59]
    s_waitcnt lgkmcnt(6)
    v_mfma_f32_16x16x32_bf16 v[60:63], v[112:115], a[80:83], v[60:63]
    s_waitcnt lgkmcnt(4)
    v_mfma_f32_16x16x32_bf16 v[64:67], v[112:115], a[84:87], v[64:67]
    s_waitcnt lgkmcnt(2)
    v_mfma_f32_16x16x32_bf16 v[68:71], v[112:115], a[88:91], v[68:71]
    s_waitcnt lgkmcnt(0)
    v_mfma_f32_16x16x32_bf16 v[72:75], v[112:115], a[92:95], v[72:75]
    s_barrier
    ds_read_b128 a[96:99], v80 offset:0
    ds_read_b128 a[100:103], v81 offset:0
    ds_read_b64_tr_b16 a[0:1], v24 offset:0
    ds_read_b64_tr_b16 a[2:3], v24 offset:512
    ds_read_b64_tr_b16 a[4:5], v25 offset:0
    ds_read_b64_tr_b16 a[6:7], v25 offset:512
    ds_read_b64_tr_b16 a[8:9], v26 offset:0
    ds_read_b64_tr_b16 a[10:11], v26 offset:512
    ds_read_b64_tr_b16 a[12:13], v27 offset:0
    ds_read_b64_tr_b16 a[14:15], v27 offset:512
    ds_read_b64_tr_b16 a[16:17], v24 offset:8192
    ds_read_b64_tr_b16 a[18:19], v24 offset:8704
    ds_read_b64_tr_b16 a[20:21], v25 offset:8192
    ds_read_b64_tr_b16 a[22:23], v25 offset:8704
    ds_read_b64_tr_b16 a[24:25], v26 offset:8192
    ds_read_b64_tr_b16 a[26:27], v26 offset:8704
    s_waitcnt lgkmcnt(12)
    v_mfma_f32_16x16x32_bf16 v[28:31], a[0:3], v[116:119], v[28:31]
    ds_read_b64_tr_b16 a[28:29], v27 offset:8192
    ds_read_b64_tr_b16 a[30:31], v27 offset:8704
    s_waitcnt lgkmcnt(12)
    v_mfma_f32_16x16x32_bf16 v[32:35], a[4:7], v[116:119], v[32:35]
    ds_read_b64_tr_b16 a[48:49], v24 offset:4096
    ds_read_b64_tr_b16 a[50:51], v24 offset:4608
    s_waitcnt lgkmcnt(12)
    v_mfma_f32_16x16x32_bf16 v[36:39], a[8:11], v[116:119], v[36:39]
    ds_read_b64_tr_b16 a[52:53], v25 offset:4096
    ds_read_b64_tr_b16 a[54:55], v25 offset:4608
    s_waitcnt lgkmcnt(12)
    v_mfma_f32_16x16x32_bf16 v[40:43], a[12:15], v[116:119], v[40:43]
    ds_read_b64_tr_b16 a[56:57], v26 offset:4096
    ds_read_b64_tr_b16 a[58:59], v26 offset:4608
    s_waitcnt lgkmcnt(12)
    v_mfma_f32_16x16x32_bf16 v[44:47], a[16:19], a[96:99], v[44:47]
    ds_read_b64_tr_b16 a[60:61], v27 offset:4096
    ds_read_b64_tr_b16 a[62:63], v27 offset:4608
    s_waitcnt lgkmcnt(12)
    v_mfma_f32_16x16x32_bf16 v[48:51], a[20:23], a[96:99], v[48:51]
    ds_read_b64_tr_b16 a[64:65], v24 offset:12288
    ds_read_b64_tr_b16 a[66:67], v24 offset:12800
    s_waitcnt lgkmcnt(12)
    v_mfma_f32_16x16x32_bf16 v[52:55], a[24:27], a[96:99], v[52:55]
    ds_read_b64_tr_b16 a[68:69], v25 offset:12288
    ds_read_b64_tr_b16 a[70:71], v25 offset:12800
    s_waitcnt lgkmcnt(12)
    v_mfma_f32_16x16x32_bf16 v[56:59], a[28:31], a[96:99], v[56:59]
    ds_read_b64_tr_b16 a[72:73], v26 offset:12288
    ds_read_b64_tr_b16 a[74:75], v26 offset:12800
    s_waitcnt lgkmcnt(12)
    v_mfma_f32_16x16x32_bf16 v[28:31], a[48:51], v[116:119], v[28:31]
    ds_read_b64_tr_b16 a[76:77], v27 offset:12288
    ds_read_b64_tr_b16 a[78:79], v27 offset:12800
    s_waitcnt lgkmcnt(12)
    v_mfma_f32_16x16x32_bf16 v[32:35], a[52:55], v[116:119], v[32:35]
    s_waitcnt lgkmcnt(10)
    v_mfma_f32_16x16x32_bf16 v[36:39], a[56:59], v[116:119], v[36:39]
    s_waitcnt lgkmcnt(8)
    v_mfma_f32_16x16x32_bf16 v[40:43], a[60:63], v[116:119], v[40:43]
    s_waitcnt lgkmcnt(6)
    v_mfma_f32_16x16x32_bf16 v[44:47], a[64:67], a[100:103], v[44:47]
    s_waitcnt lgkmcnt(4)
    v_mfma_f32_16x16x32_bf16 v[48:51], a[68:71], a[100:103], v[48:51]
    s_waitcnt lgkmcnt(2)
    v_mfma_f32_16x16x32_bf16 v[52:55], a[72:75], a[100:103], v[52:55]
    s_waitcnt lgkmcnt(0)
    v_mfma_f32_16x16x32_bf16 v[56:59], a[76:79], a[100:103], v[56:59]
    buffer_load_dwordx2 v[92:93], v96, s[28:31], s46 offen sc1
    buffer_load_dwordx2 v[94:95], v97, s[28:31], s46 offen sc1
    s_barrier
    ds_read_b128 a[104:107], v80 offset:39040
    ds_read_b128 a[108:111], v81 offset:39040
    ds_read_b64_tr_b16 a[0:1], v24 offset:39040
    ds_read_b64_tr_b16 a[2:3], v24 offset:39552
    ds_read_b64_tr_b16 a[4:5], v25 offset:39040
    ds_read_b64_tr_b16 a[6:7], v25 offset:39552
    ds_read_b64_tr_b16 a[8:9], v26 offset:39040
    ds_read_b64_tr_b16 a[10:11], v26 offset:39552
    ds_read_b64_tr_b16 a[12:13], v27 offset:39040
    ds_read_b64_tr_b16 a[14:15], v27 offset:39552
    ds_read_b64_tr_b16 a[16:17], v24 offset:47232
    ds_read_b64_tr_b16 a[18:19], v24 offset:47744
    ds_read_b64_tr_b16 a[20:21], v25 offset:47232
    ds_read_b64_tr_b16 a[22:23], v25 offset:47744
    ds_read_b64_tr_b16 a[24:25], v26 offset:47232
    ds_read_b64_tr_b16 a[26:27], v26 offset:47744
    s_waitcnt lgkmcnt(12)
    v_mfma_f32_16x16x32_bf16 v[28:31], a[0:3], v[116:119], v[28:31]
    ds_read_b64_tr_b16 a[28:29], v27 offset:47232
    ds_read_b64_tr_b16 a[30:31], v27 offset:47744
    s_waitcnt lgkmcnt(12)
    v_mfma_f32_16x16x32_bf16 v[32:35], a[4:7], v[116:119], v[32:35]
    ds_read_b64_tr_b16 a[48:49], v24 offset:43136
    ds_read_b64_tr_b16 a[50:51], v24 offset:43648
    s_waitcnt lgkmcnt(12)
    v_mfma_f32_16x16x32_bf16 v[36:39], a[8:11], v[116:119], v[36:39]
    ds_read_b64_tr_b16 a[52:53], v25 offset:43136
    ds_read_b64_tr_b16 a[54:55], v25 offset:43648
    s_waitcnt lgkmcnt(12)
    v_mfma_f32_16x16x32_bf16 v[40:43], a[12:15], v[116:119], v[40:43]
    ds_read_b64_tr_b16 a[56:57], v26 offset:43136
    ds_read_b64_tr_b16 a[58:59], v26 offset:43648
    s_waitcnt lgkmcnt(12)
    v_mfma_f32_16x16x32_bf16 v[44:47], a[16:19], a[104:107], v[44:47]
    ds_read_b64_tr_b16 a[60:61], v27 offset:43136
    ds_read_b64_tr_b16 a[62:63], v27 offset:43648
    s_waitcnt lgkmcnt(12)
    v_mfma_f32_16x16x32_bf16 v[48:51], a[20:23], a[104:107], v[48:51]
    ds_read_b64_tr_b16 a[64:65], v24 offset:51328
    ds_read_b64_tr_b16 a[66:67], v24 offset:51840
    s_waitcnt lgkmcnt(12)
    v_mfma_f32_16x16x32_bf16 v[52:55], a[24:27], a[104:107], v[52:55]
    ds_read_b64_tr_b16 a[68:69], v25 offset:51328
    ds_read_b64_tr_b16 a[70:71], v25 offset:51840
    s_waitcnt lgkmcnt(12)
    v_mfma_f32_16x16x32_bf16 v[56:59], a[28:31], a[104:107], v[56:59]
    ds_read_b64_tr_b16 a[72:73], v26 offset:51328
    ds_read_b64_tr_b16 a[74:75], v26 offset:51840
    s_waitcnt lgkmcnt(12)
    v_mfma_f32_16x16x32_bf16 v[28:31], a[48:51], v[116:119], v[28:31]
    ds_read_b64_tr_b16 a[76:77], v27 offset:51328
    ds_read_b64_tr_b16 a[78:79], v27 offset:51840
    s_waitcnt lgkmcnt(12)
    v_mfma_f32_16x16x32_bf16 v[32:35], a[52:55], v[116:119], v[32:35]
    s_waitcnt lgkmcnt(10)
    v_mfma_f32_16x16x32_bf16 v[36:39], a[56:59], v[116:119], v[36:39]
    s_waitcnt lgkmcnt(8)
    v_mfma_f32_16x16x32_bf16 v[40:43], a[60:63], v[116:119], v[40:43]
    s_waitcnt lgkmcnt(6)
    v_mfma_f32_16x16x32_bf16 v[44:47], a[64:67], a[108:111], v[44:47]
    s_waitcnt lgkmcnt(4)
    v_mfma_f32_16x16x32_bf16 v[48:51], a[68:71], a[108:111], v[48:51]
    s_waitcnt lgkmcnt(2)
    v_mfma_f32_16x16x32_bf16 v[52:55], a[72:75], a[108:111], v[52:55]
    s_waitcnt lgkmcnt(0)
    v_mfma_f32_16x16x32_bf16 v[56:59], a[76:79], a[108:111], v[56:59]
    s_barrier
    ds_read_b128 a[112:115], v76 offset:0
    ds_read_b128 a[116:119], v77 offset:0
    ds_read_b64_tr_b16 a[0:1], v20 offset:0
    ds_read_b64_tr_b16 a[2:3], v20 offset:512
    ds_read_b64_tr_b16 a[4:5], v21 offset:0
    ds_read_b64_tr_b16 a[6:7], v21 offset:512
    ds_read_b64_tr_b16 a[8:9], v22 offset:0
    ds_read_b64_tr_b16 a[10:11], v22 offset:512
    ds_read_b64_tr_b16 a[12:13], v23 offset:0
    ds_read_b64_tr_b16 a[14:15], v23 offset:512
    ds_read_b64_tr_b16 a[16:17], v20 offset:8192
    ds_read_b64_tr_b16 a[18:19], v20 offset:8704
    ds_read_b64_tr_b16 a[20:21], v21 offset:8192
    ds_read_b64_tr_b16 a[22:23], v21 offset:8704
    ds_read_b64_tr_b16 a[24:25], v22 offset:8192
    ds_read_b64_tr_b16 a[26:27], v22 offset:8704
    s_waitcnt lgkmcnt(12)
    v_mfma_f32_16x16x32_bf16 v[28:31], a[0:3], v[116:119], v[28:31]
    ds_read_b64_tr_b16 a[28:29], v23 offset:8192
    ds_read_b64_tr_b16 a[30:31], v23 offset:8704
    s_waitcnt lgkmcnt(12)
    v_mfma_f32_16x16x32_bf16 v[32:35], a[4:7], v[116:119], v[32:35]
    ds_read_b64_tr_b16 a[48:49], v20 offset:4096
    ds_read_b64_tr_b16 a[50:51], v20 offset:4608
    s_waitcnt lgkmcnt(12)
    v_mfma_f32_16x16x32_bf16 v[36:39], a[8:11], v[116:119], v[36:39]
    ds_read_b64_tr_b16 a[52:53], v21 offset:4096
    ds_read_b64_tr_b16 a[54:55], v21 offset:4608
    s_waitcnt lgkmcnt(12)
    v_mfma_f32_16x16x32_bf16 v[40:43], a[12:15], v[116:119], v[40:43]
    ds_read_b64_tr_b16 a[56:57], v22 offset:4096
    ds_read_b64_tr_b16 a[58:59], v22 offset:4608
    s_waitcnt lgkmcnt(12)
    v_mfma_f32_16x16x32_bf16 v[44:47], a[16:19], a[112:115], v[44:47]
    ds_read_b64_tr_b16 a[60:61], v23 offset:4096
    ds_read_b64_tr_b16 a[62:63], v23 offset:4608
    s_waitcnt lgkmcnt(12)
    v_mfma_f32_16x16x32_bf16 v[48:51], a[20:23], a[112:115], v[48:51]
    ds_read_b64_tr_b16 a[64:65], v20 offset:12288
    ds_read_b64_tr_b16 a[66:67], v20 offset:12800
    s_waitcnt lgkmcnt(12)
    v_mfma_f32_16x16x32_bf16 v[52:55], a[24:27], a[112:115], v[52:55]
    ds_read_b64_tr_b16 a[68:69], v21 offset:12288
    ds_read_b64_tr_b16 a[70:71], v21 offset:12800
    s_waitcnt lgkmcnt(12)
    v_mfma_f32_16x16x32_bf16 v[56:59], a[28:31], a[112:115], v[56:59]
    ds_read_b64_tr_b16 a[72:73], v22 offset:12288
    ds_read_b64_tr_b16 a[74:75], v22 offset:12800
    s_waitcnt lgkmcnt(12)
    v_mfma_f32_16x16x32_bf16 v[28:31], a[48:51], v[116:119], v[28:31]
    ds_read_b64_tr_b16 a[76:77], v23 offset:12288
    ds_read_b64_tr_b16 a[78:79], v23 offset:12800
    s_waitcnt lgkmcnt(12)
    v_mfma_f32_16x16x32_bf16 v[32:35], a[52:55], v[116:119], v[32:35]
    s_waitcnt lgkmcnt(10)
    v_mfma_f32_16x16x32_bf16 v[36:39], a[56:59], v[116:119], v[36:39]
    s_waitcnt vmcnt(0)
Lst_chk:
    v_cmp_ne_u32 vcc, s34, v93
    v_cmp_ne_u32 s[36:37], s34, v95
    s_nop 0
    s_or_b64 s[36:37], s[36:37], vcc
    s_cbranch_scc1 Lst_re
    v_lshlrev_b32 v93, 16, v92
    s_waitcnt lgkmcnt(8)
    v_mfma_f32_16x16x32_bf16 v[40:43], a[60:63], v[116:119], v[40:43]
    v_and_b32 v92, 0xffff0000, v92
    v_rcp_f32 v93, v93
    s_waitcnt lgkmcnt(6)
    v_mfma_f32_16x16x32_bf16 v[44:47], a[64:67], a[116:119], v[44:47]
    v_lshlrev_b32 v95, 16, v94
    v_and_b32 v94, 0xffff0000, v94
    s_waitcnt lgkmcnt(4)
    v_mfma_f32_16x16x32_bf16 v[48:51], a[68:71], a[116:119], v[48:51]
    v_rcp_f32 v95, v95
    ds_write2st64_b32 v4, v92, v93 offset0:0 offset1:2
    s_waitcnt lgkmcnt(3)
    v_mfma_f32_16x16x32_bf16 v[52:55], a[72:75], a[116:119], v[52:55]
    ds_write2st64_b32 v5, v94, v95 offset0:0 offset1:2
    ds_read_b32 v120, v11
    s_waitcnt lgkmcnt(3)
    v_mfma_f32_16x16x32_bf16 v[56:59], a[76:79], a[116:119], v[56:59]
    s_waitcnt lgkmcnt(0)
    s_barrier
    ds_read_b128 a[120:123], v76 offset:39040
    ds_read_b128 a[124:127], v77 offset:39040
    ds_read_b64_tr_b16 a[0:1], v20 offset:39040
    ds_read_b64_tr_b16 a[2:3], v20 offset:39552
    ds_read_b64_tr_b16 a[4:5], v21 offset:39040
    ds_read_b64_tr_b16 a[6:7], v21 offset:39552
    ds_read_b64_tr_b16 a[8:9], v22 offset:39040
    ds_read_b64_tr_b16 a[10:11], v22 offset:39552
    ds_read_b64_tr_b16 a[12:13], v23 offset:39040
    ds_read_b64_tr_b16 a[14:15], v23 offset:39552
    ds_read_b64_tr_b16 a[16:17], v20 offset:47232
    ds_read_b64_tr_b16 a[18:19], v20 offset:47744
    ds_read_b64_tr_b16 a[20:21], v21 offset:47232
    ds_read_b64_tr_b16 a[22:23], v21 offset:47744
    ds_read_b64_tr_b16 a[24:25], v22 offset:47232
    ds_read_b64_tr_b16 a[26:27], v22 offset:47744
    s_waitcnt lgkmcnt(12)
    v_mfma_f32_16x16x32_bf16 v[28:31], a[0:3], v[116:119], v[28:31]
    ds_read_b64_tr_b16 a[28:29], v23 offset:47232
    ds_read_b64_tr_b16 a[30:31], v23 offset:47744
    s_waitcnt lgkmcnt(12)
    v_mfma_f32_16x16x32_bf16 v[32:35], a[4:7], v[116:119], v[32:35]
    ds_read_b64_tr_b16 a[48:49], v20 offset:43136
    ds_read_b64_tr_b16 a[50:51], v20 offset:43648
    s_waitcnt lgkmcnt(12)
    v_mfma_f32_16x16x32_bf16 v[36:39], a[8:11], v[116:119], v[36:39]
    ds_read_b64_tr_b16 a[52:53], v21 offset:43136
    ds_read_b64_tr_b16 a[54:55], v21 offset:43648
    s_waitcnt lgkmcnt(12)
    v_mfma_f32_16x16x32_bf16 v[40:43], a[12:15], v[116:119], v[40:43]
    ds_read_b64_tr_b16 a[56:57], v22 offset:43136
    ds_read_b64_tr_b16 a[58:59], v22 offset:43648
    s_waitcnt lgkmcnt(12)
    v_mfma_f32_16x16x32_bf16 v[44:47], a[16:19], a[120:123], v[44:47]
    ds_read_b64_tr_b16 a[60:61], v23 offset:43136
    ds_read_b64_tr_b16 a[62:63], v23 offset:43648
    s_waitcnt lgkmcnt(12)
    v_mfma_f32_16x16x32_bf16 v[48:51], a[20:23], a[120:123], v[48:51]
    ds_read_b64_tr_b16 a[64:65], v20 offset:51328
    ds_read_b64_tr_b16 a[66:67], v20 offset:51840
    s_waitcnt lgkmcnt(12)
    v_mfma_f32_16x16x32_bf16 v[52:55], a[24:27], a[120:123], v[52:55]
    ds_read_b64_tr_b16 a[68:69], v21 offset:51328
    ds_read_b64_tr_b16 a[70:71], v21 offset:51840
    s_waitcnt lgkmcnt(12)
    v_mfma_f32_16x16x32_bf16 v[56:59], a[28:31], a[120:123], v[56:59]
    ds_read_b64_tr_b16 a[72:73], v22 offset:51328
    ds_read_b64_tr_b16 a[74:75], v22 offset:51840
    s_waitcnt lgkmcnt(12)
    v_mfma_f32_16x16x32_bf16 v[28:31], a[48:51], v[116:119], v[28:31]
    ds_read_b64_tr_b16 a[76:77], v23 offset:51328
    ds_read_b64_tr_b16 a[78:79], v23 offset:51840
    s_waitcnt lgkmcnt(12)
    v_mfma_f32_16x16x32_bf16 v[32:35], a[52:55], v[116:119], v[32:35]
    s_waitcnt lgkmcnt(10)
    v_mfma_f32_16x16x32_bf16 v[36:39], a[56:59], v[116:119], v[36:39]
    s_waitcnt lgkmcnt(8)
    v_mfma_f32_16x16x32_bf16 v[40:43], a[60:63], v[116:119], v[40:43]
    s_waitcnt lgkmcnt(6)
    v_mfma_f32_16x16x32_bf16 v[44:47], a[64:67], a[124:127], v[44:47]
    s_waitcnt lgkmcnt(4)
    v_mfma_f32_16x16x32_bf16 v[48:51], a[68:71], a[124:127], v[48:51]
    s_waitcnt lgkmcnt(2)
    v_mfma_f32_16x16x32_bf16 v[52:55], a[72:75], a[124:127], v[52:55]
    s_waitcnt lgkmcnt(0)
    v_mfma_f32_16x16x32_bf16 v[56:59], a[76:79], a[124:127], v[56:59]
    s_mov_b32 exec_lo, 0x00010001
    s_mov_b32 exec_hi, 0x00010001
    ds_write_b128 v6, v[28:31] offset:0
    ds_write_b128 v6, v[32:35] offset:64
    ds_write_b128 v6, v[36:39] offset:128
    ds_write_b128 v6, v[40:43] offset:192
    ds_write_b128 v6, v[44:47] offset:256
    ds_write_b128 v6, v[48:51] offset:320
    ds_write_b128 v6, v[52:55] offset:384
    ds_write_b128 v6, v[56:59] offset:448
    ds_write_b32 v7, v7
    s_mov_b64 exec, -1
    ds_read_b128 v[76:79], v6 offset:256
    ds_read_b128 v[80:83], v6 offset:320
    ds_read_b128 v[84:87], v6 offset:384
    ds_read_b128 v[88:91], v6 offset:448
    s_waitcnt lgkmcnt(0)
    v_fmac_f32 v44, v76, v120
    v_fmac_f32 v45, v77, v120
    v_fmac_f32 v46, v78, v120
    v_fmac_f32 v47, v79, v120
    v_cvt_pk_bf16_f32 v44, v44, v45
    v_cvt_pk_bf16_f32 v45, v46, v47
    v_fmac_f32 v48, v80, v120
    v_fmac_f32 v49, v81, v120
    v_fmac_f32 v50, v82, v120
    v_fmac_f32 v51, v83, v120
    v_cvt_pk_bf16_f32 v46, v48, v49
    v_cvt_pk_bf16_f32 v47, v50, v51
    v_fmac_f32 v52, v84, v120
    v_fmac_f32 v53, v85, v120
    v_fmac_f32 v54, v86, v120
    v_fmac_f32 v55, v87, v120
    v_cvt_pk_bf16_f32 v48, v52, v53
    v_cvt_pk_bf16_f32 v49, v54, v55
    v_fmac_f32 v56, v88, v120
    v_fmac_f32 v57, v89, v120
    v_fmac_f32 v58, v90, v120
    v_fmac_f32 v59, v91, v120
    v_cvt_pk_bf16_f32 v50, v56, v57
    v_cvt_pk_bf16_f32 v51, v58, v59
    ds_write_b128 v125, v[44:47] offset:4096
    ds_write_b128 v125, v[48:51] offset:5120
    v_mov_b32 v5, 157972
    v_mov_b32 v6, 1
    s_mov_b64 exec, 1
    ds_add_u32 v5, v6
    s_mov_b64 exec, -1
    v_mov_b32 v5, 157980
Lcw_6:
    s_sub_u32 s35, s35, 1
    s_cbranch_scc1 Lend
    ds_read_b32 v6, v5
    s_waitcnt lgkmcnt(0)
    v_readfirstlane_b32 s38, v6
    s_nop 0
    s_cmp_lt_u32 s38, 1
    s_cbranch_scc1 Lcw_6
    ds_read_b64_tr_b16 a[0:1], v24 offset:16384
    ds_read_b64_tr_b16 a[2:3], v24 offset:16896
    ds_read_b64_tr_b16 a[4:5], v25 offset:16384
    ds_read_b64_tr_b16 a[6:7], v25 offset:16896
    ds_read_b64_tr_b16 a[8:9], v26 offset:16384
    ds_read_b64_tr_b16 a[10:11], v26 offset:16896
    ds_read_b64_tr_b16 a[12:13], v27 offset:16384
    ds_read_b64_tr_b16 a[14:15], v27 offset:16896
    ds_read_b64_tr_b16 a[16:17], v24 offset:20480
    ds_read_b64_tr_b16 a[18:19], v24 offset:20992
    ds_read_b64_tr_b16 a[20:21], v25 offset:20480
    ds_read_b64_tr_b16 a[22:23], v25 offset:20992
    ds_read_b64_tr_b16 a[24:25], v26 offset:20480
    ds_read_b64_tr_b16 a[26:27], v26 offset:20992
    ds_read_b64_tr_b16 a[28:29], v27 offset:20480
    ds_read_b64_tr_b16 a[30:31], v27 offset:20992
    ds_read_b64_tr_b16 a[32:33], v24 offset:55424
    ds_read_b64_tr_b16 a[34:35], v24 offset:55936
    ds_read_b64_tr_b16 a[36:37], v25 offset:55424
    ds_read_b64_tr_b16 a[38:39], v25 offset:55936
    ds_read_b64_tr_b16 a[40:41], v26 offset:55424
    ds_read_b64_tr_b16 a[42:43], v26 offset:55936
    ds_read_b64_tr_b16 a[44:45], v27 offset:55424
    ds_read_b64_tr_b16 a[46:47], v27 offset:55936
    ds_read_b64_tr_b16 a[48:49], v24 offset:59520
    ds_read_b64_tr_b16 a[50:51], v24 offset:60032
    ds_read_b64_tr_b16 a[52:53], v25 offset:59520
    ds_read_b64_tr_b16 a[54:55], v25 offset:60032
    ds_read_b64_tr_b16 a[56:57], v26 offset:59520
    ds_read_b64_tr_b16 a[58:59], v26 offset:60032
    ds_read_b64_tr_b16 a[60:61], v27 offset:59520
    ds_read_b64_tr_b16 a[62:63], v27 offset:60032
    ds_read_b64_tr_b16 a[64:65], v20 offset:16384
    ds_read_b64_tr_b16 a[66:67], v20 offset:16896
    ds_read_b64_tr_b16 a[68:69], v21 offset:16384
    ds_read_b64_tr_b16 a[70:71], v21 offset:16896
    ds_read_b64_tr_b16 a[72:73], v22 offset:16384
    ds_read_b64_tr_b16 a[74:75], v22 offset:16896
    ds_read_b64_tr_b16 a[76:77], v23 offset:16384
    ds_read_b64_tr_b16 a[78:79], v23 offset:16896
    ds_read_b64_tr_b16 a[80:81], v20 offset:20480
    ds_read_b64_tr_b16 a[82:83], v20 offset:20992
    ds_read_b64_tr_b16 a[84:85], v21 offset:20480
    ds_read_b64_tr_b16 a[86:87], v21 offset:20992
    ds_read_b64_tr_b16 a[88:89], v22 offset:20480
    ds_read_b64_tr_b16 a[90:91], v22 offset:20992
    ds_read_b64_tr_b16 a[92:93], v23 offset:20480
    ds_read_b64_tr_b16 a[94:95], v23 offset:20992
    s_waitcnt lgkmcnt(15)
    v_mfma_f32_16x16x32_bf16 v[60:63], a[96:99], a[0:3], v[60:63]
    v_mfma_f32_16x16x32_bf16 v[64:67], a[96:99], a[4:7], v[64:67]
    v_mfma_f32_16x16x32_bf16 v[68:71], a[96:99], a[8:11], v[68:71]
    v_mfma_f32_16x16x32_bf16 v[72:75], a[96:99], a[12:15], v[72:75]
    ds_read_b64_tr_b16 a[0:1], v20 offset:55424
    ds_read_b64_tr_b16 a[2:3], v20 offset:55936
    ds_read_b64_tr_b16 a[4:5], v21 offset:55424
    ds_read_b64_tr_b16 a[6:7], v21 offset:55936
    ds_read_b64_tr_b16 a[8:9], v22 offset:55424
    ds_read_b64_tr_b16 a[10:11], v22 offset:55936
    ds_read_b64_tr_b16 a[12:13], v23 offset:55424
    ds_read_b64_tr_b16 a[14:15], v23 offset:55936
    v_mfma_f32_16x16x32_bf16 v[60:63], a[100:103], a[16:19], v[60:63]
    v_mfma_f32_16x16x32_bf16 v[64:67], a[100:103], a[20:23], v[64:67]
    v_mfma_f32_16x16x32_bf16 v[68:71], a[100:103], a[24:27], v[68:71]
    v_mfma_f32_16x16x32_bf16 v[72:75], a[100:103], a[28:31], v[72:75]
    ds_read_b64_tr_b16 a[16:17], v20 offset:59520
    ds_read_b64_tr_b16 a[18:19], v20 offset:60032
    ds_read_b64_tr_b16 a[20:21], v21 offset:59520
    ds_read_b64_tr_b16 a[22:23], v21 offset:60032
    ds_read_b64_tr_b16 a[24:25], v22 offset:59520
    ds_read_b64_tr_b16 a[26:27], v22 offset:60032
    ds_read_b64_tr_b16 a[28:29], v23 offset:59520
    ds_read_b64_tr_b16 a[30:31], v23 offset:60032
    v_mfma_f32_16x16x32_bf16 v[60:63], a[104:107], a[32:35], v[60:63]
    v_mfma_f32_16x16x32_bf16 v[64:67], a[104:107], a[36:39], v[64:67]
    v_mfma_f32_16x16x32_bf16 v[68:71], a[104:107], a[40:43], v[68:71]
    v_mfma_f32_16x16x32_bf16 v[72:75], a[104:107], a[44:47], v[72:75]
    v_mfma_f32_16x16x32_bf16 v[60:63], a[108:111], a[48:51], v[60:63]
    v_mfma_f32_16x16x32_bf16 v[64:67], a[108:111], a[52:55], v[64:67]
    v_mfma_f32_16x16x32_bf16 v[68:71], a[108:111], a[56:59], v[68:71]
    v_mfma_f32_16x16x32_bf16 v[72:75], a[108:111], a[60:63], v[72:75]
    s_waitcnt lgkmcnt(15)
    v_mfma_f32_16x16x32_bf16 v[60:63], a[112:115], a[64:67], v[60:63]
    v_mfma_f32_16x16x32_bf16 v[64:67], a[112:115], a[68:71], v[64:67]
    v_mfma_f32_16x16x32_bf16 v[68:71], a[112:115], a[72:75], v[68:71]
    v_mfma_f32_16x16x32_bf16 v[72:75], a[112:115], a[76:79], v[72:75]
    v_mfma_f32_16x16x32_bf16 v[60:63], a[116:119], a[80:83], v[60:63]
    v_mfma_f32_16x16x32_bf16 v[64:67], a[116:119], a[84:87], v[64:67]
    v_mfma_f32_16x16x32_bf16 v[68:71], a[116:119], a[88:91], v[68:71]
    v_mfma_f32_16x16x32_bf16 v[72:75], a[116:119], a[92:95], v[72:75]
    s_waitcnt lgkmcnt(8)
    v_mfma_f32_16x16x32_bf16 v[60:63], a[120:123], a[0:3], v[60:63]
    v_mfma_f32_16x16x32_bf16 v[64:67], a[120:123], a[4:7], v[64:67]
    v_mfma_f32_16x16x32_bf16 v[68:71], a[120:123], a[8:11], v[68:71]
    v_mfma_f32_16x16x32_bf16 v[72:75], a[120:123], a[12:15], v[72:75]
    s_waitcnt lgkmcnt(0)
    v_mfma_f32_16x16x32_bf16 v[60:63], a[124:127], a[16:19], v[60:63]
    v_mfma_f32_16x16x32_bf16 v[64:67], a[124:127], a[20:23], v[64:67]
    v_mfma_f32_16x16x32_bf16 v[68:71], a[124:127], a[24:27], v[68:71]
    v_mfma_f32_16x16x32_bf16 v[72:75], a[124:127], a[28:31], v[72:75]
    v_lshlrev_b32 v5, 4, v3
    v_add_u32 v5, 157696, v5
    v_mov_b32 v6, 157952
    v_lshlrev_b32 v4, 4, v2
    v_add_u32 v4, 156224, v4
    v_lshl_add_u32 v125, v1, 3, s45
    s_mov_b64 exec, 0xffff
    ds_write_b32 v5, v60 offset:0
    ds_write_b32 v5, v64 offset:4
    ds_write_b32 v5, v68 offset:8
    ds_write_b32 v5, v72 offset:12
    ds_write_b32 v6, v6
    s_mov_b64 exec, -1
    ds_read_b128 v[36:39], v5
    ds_read_b128 v[28:31], v4
    ds_read_b128 v[32:35], v4 offset:512
    s_waitcnt lgkmcnt(0)
    v_fmac_f32 v60, v28, v36
    v_fmac_f32 v61, v29, v36
    v_fmac_f32 v62, v30, v36
    v_fmac_f32 v63, v31, v36
    v_mul_f32 v60, v60, v32
    v_mul_f32 v61, v61, v33
    v_mul_f32 v62, v62, v34
    v_mul_f32 v63, v63, v35
    v_cvt_pk_bf16_f32 v60, v60, v61
    v_cvt_pk_bf16_f32 v61, v62, v63
    ds_write_b64 v125, v[60:61] offset:0
    v_fmac_f32 v64, v28, v37
    v_fmac_f32 v65, v29, v37
    v_fmac_f32 v66, v30, v37
    v_fmac_f32 v67, v31, v37
    v_mul_f32 v64, v64, v32
    v_mul_f32 v65, v65, v33
    v_mul_f32 v66, v66, v34
    v_mul_f32 v67, v67, v35
    v_cvt_pk_bf16_f32 v64, v64, v65
    v_cvt_pk_bf16_f32 v65, v66, v67
    ds_write_b64 v125, v[64:65] offset:512
    v_fmac_f32 v68, v28, v38
    v_fmac_f32 v69, v29, v38
    v_fmac_f32 v70, v30, v38
    v_fmac_f32 v71, v31, v38
    v_mul_f32 v68, v68, v32
    v_mul_f32 v69, v69, v33
    v_mul_f32 v70, v70, v34
    v_mul_f32 v71, v71, v35
    v_cvt_pk_bf16_f32 v68, v68, v69
    v_cvt_pk_bf16_f32 v69, v70, v71
    ds_write_b64 v125, v[68:69] offset:1024
    v_fmac_f32 v72, v28, v39
    v_fmac_f32 v73, v29, v39
    v_fmac_f32 v74, v30, v39
    v_fmac_f32 v75, v31, v39
    v_mul_f32 v72, v72, v32
    v_mul_f32 v73, v73, v33
    v_mul_f32 v74, v74, v34
    v_mul_f32 v75, v75, v35
    v_cvt_pk_bf16_f32 v72, v72, v73
    v_cvt_pk_bf16_f32 v73, v74, v75
    ds_write_b64 v125, v[72:73] offset:1536
    v_mov_b32 v8, 157976
    v_mov_b32 v9, 1
    s_mov_b64 exec, 1
    ds_add_u32 v8, v9
    s_mov_b64 exec, -1
    s_endpgm
Lst_re:
    s_sub_u32 s35, s35, 1
    s_cbranch_scc1 Lend
    buffer_load_dwordx2 v[92:93], v96, s[28:31], s46 offen sc1
    buffer_load_dwordx2 v[94:95], v97, s[28:31], s46 offen sc1
    s_waitcnt vmcnt(0)
    s_branch Lst_chk
Laux:
    s_lshl_b32 s32, s37, 3
    s_lshl_b32 s39, s38, 2
    s_add_u32 s32, s32, s36
    s_cmp_lt_u32 s37, 4
    s_cselect_b32 s39, s39, 0
    s_add_u32 s32, s32, s39
    s_and_b32 s33, s2, 3
    s_lshl_b32 s33, s33, 3
    s_and_b32 s39, s2, 4
    s_add_u32 s33, s33, s39
    s_add_u32 s33, s33, s37
    s_cmp_ge_u32 s32, 32
    s_cbranch_scc1 Lmst
    v_lshrrev_b32 v5, 3, v1
    v_and_b32 v6, 7, v1
    s_lshl_b32 s40, s3, 14
    s_cmp_eq_u32 s27, 0
    s_cbranch_scc0 Laux_u
    s_lshl_b32 s36, s33, 6
    s_lshl_b32 s37, s26, 4
    s_add_u32 s36, s36, s37
    v_add_u32 v7, s36, v5
    v_mul_u32_u24 v7, 1280, v7
    v_xor_b32 v8, v6, v2
    v_lshl_add_u32 v92, v8, 4, v7
    v_add_u32 v92, 4096, v92
    v_xor_b32 v93, 64, v92
    v_add_u32 v93, 9216, v93
    v_subrev_u32 v94, 1920, v92
    v_subrev_u32 v95, 1920, v93
    s_waitcnt lgkmcnt(0)
    s_sub_u32 s52, s4, 4096
    s_subb_u32 s53, s5, 0
    s_mov_b32 s54, 2625536
    s_mov_b32 s55, 0x20000
    s_mov_b64 s[60:61], s[12:13]
    s_mov_b32 s62, 1280
    s_mov_b32 s63, 0x20000
    s_mov_b32 m0, 131072
    s_nop 0
    buffer_load_dwordx4 v13, s[60:63], 0 offen lds
    s_mov_b64 exec, 0xffff
    buffer_load_dwordx4 v13, s[60:63], 0 offen offset:1024 lds
    s_mov_b64 exec, -1
    s_add_u32 m0, s40, 0
    s_mov_b32 s41, 0
    buffer_load_dwordx4 v92, s[52:55], s41 offen lds
    buffer_load_dwordx4 v93, s[52:55], s41 offen offset:1024 lds
    buffer_load_dwordx4 v94, s[52:55], s41 offen offset:2048 lds
    buffer_load_dwordx4 v95, s[52:55], s41 offen offset:3072 lds
    s_add_u32 m0, s40, 4096
    s_mov_b32 s41, 256
    buffer_load_dwordx4 v92, s[52:55], s41 offen lds
    buffer_load_dwordx4 v93, s[52:55], s41 offen offset:1024 lds
    buffer_load_dwordx4 v94, s[52:55], s41 offen offset:2048 lds
    buffer_load_dwordx4 v95, s[52:55], s41 offen offset:3072 lds
    s_add_u32 m0, s40, 8192
    s_mov_b32 s41, 512
    buffer_load_dwordx4 v92, s[52:55], s41 offen lds
    buffer_load_dwordx4 v93, s[52:55], s41 offen offset:1024 lds
    buffer_load_dwordx4 v94, s[52:55], s41 offen offset:2048 lds
    buffer_load_dwordx4 v95, s[52:55], s41 offen offset:3072 lds
    s_add_u32 m0, s40, 12288
    s_mov_b32 s41, 768
    buffer_load_dwordx4 v92, s[52:55], s41 offen lds
    buffer_load_dwordx4 v93, s[52:55], s41 offen offset:1024 lds
    buffer_load_dwordx4 v94, s[52:55], s41 offen offset:2048 lds
    buffer_load_dwordx4 v95, s[52:55], s41 offen offset:3072 lds
    s_mov_b64 s[28:29], s[24:25]
    s_mov_b32 s30, 268435456
    s_mov_b32 s31, 0x20000
    s_load_dword s34, s[28:29], 0
    s_mov_b64 s[44:45], s[14:15]
    s_mov_b32 s46, 2211840
    s_mov_b32 s47, 0x20000
    s_mov_b64 s[48:49], s[18:19]
    s_mov_b32 s50, 2211840
    s_mov_b32 s51, 0x20000
    v_and_b32 v8, 1, v2
    v_lshlrev_b32 v8, 1, v8
    v_xor_b32 v8, v8, v6
    v_lshlrev_b32 v8, 4, v8
    v_mul_u32_u24 v9, 3456, v5
    s_lshl_b32 s38, s32, 7
    v_add3_u32 v18, v9, v8, s38
    v_xor_b32 v19, 64, v18
    v_add_u32 v19, 26624, v19
    v_add_u32 v20, 53248, v18
    v_add_u32 v21, 53248, v19
    s_mul_i32 s42, s26, 110592
    v_mul_u32_u24 v9, 1280, v5
    v_add_u32 v22, v9, v8
    v_xor_b32 v23, 64, v22
    v_add_u32 v23, 9216, v23
    v_add_u32 v24, 18432, v22
    v_add_u32 v25, 18432, v23
    s_mul_i32 s43, s32, 81920
    s_lshl_b32 s38, s3, 7
    s_add_u32 s43, s43, s38
    v_mov_b32 v96, 0x3f803f80
    v_mov_b32 v97, 0x3f803f80
    v_mov_b32 v98, 0x3f803f80
    v_mov_b32 v99, 0x3f803f80
    v_lshlrev_b32 v100, 4, v2
    v_add_u32 v100, 131072, v100
    v_lshrrev_b32 v10, 1, v3
    v_xor_b32 v10, v10, v2
    v_lshlrev_b32 v10, 4, v10
    v_lshl_add_u32 v10, v3, 7, v10
    v_add_u32 v102, s40, v10
    v_xor_b32 v103, 64, v102
    s_mov_b32 s58, 0xaaaaaaaa
    s_mov_b32 s59, 0xaaaaaaaa
    s_mov_b32 s64, 0xcccccccc
    s_mov_b32 s65, 0xcccccccc
    v_lshrrev_b32 v101, 2, v3
    v_lshl_add_u32 v101, v101, 4, v3
    v_lshlrev_b32 v101, 2, v101
    s_lshl_b32 s36, s26, 4
    v_add_u32 v10, s36, v3
    s_lshl_b32 s37, s33, 6
    s_sub_u32 s37, 2047, s37
    v_sub_u32 v106, s37, v10
    v_lshlrev_b32 v107, 2, v10
    v_add_u32 v107, 132608, v107
    s_lshl_b32 s36, s33, 9
    s_add_u32 s36, s36, 8192000
    v_lshl_add_u32 v108, v10, 3, s36
    v_bfe_u32 v10, v1, 2, 2
    v_and_b32 v8, 3, v1
    v_lshl_add_u32 v14, v2, 3, v10
    v_lshlrev_b32 v14, 7, v14
    v_lshlrev_b32 v9, 2, v1
    v_and_b32 v9, 0x60, v9
    v_add3_u32 v14, v14, v9, s40
    v_lshl_add_u32 v14, v8, 3, v14
    v_xor_b32 v15, 32, v14
    v_xor_b32 v16, 64, v14
    v_xor_b32 v17, 96, v14
    s_lshl_b32 s36, s26, 6
    s_add_u32 s36, s36, 141312
    v_lshl_add_u32 v26, v2, 4, s36
    v_min_u32 v8, 2, v3
    v_mul_u32_u24 v8, 1536, v8
    v_add_u32 v26, v26, v8
    v_add_u32 v4, 132864, v12
    v_mov_b32 v5, 0
    ds_write_b32 v4, v5
    s_waitcnt lgkmcnt(0)
    s_add_u32 s34, s34, 0x9e3779b8
    s_or_b32 s34, s34, 1
    s_waitcnt vmcnt(12)
    ds_read_b128 a[80:83], v102 offset:0
    ds_read_b128 a[84:87], v100 offset:0
    ds_read_b128 a[88:91], v103 offset:0
    ds_read_b128 a[92:95], v100 offset:64
    ds_read_b128 a[96:99], v102 offset:2048
    ds_read_b128 a[100:103], v100 offset:128
    ds_read_b128 a[104:107], v103 offset:2048
    ds_read_b128 a[108:111], v100 offset:192
    s_waitcnt lgkmcnt(0)
    s_add_u32 m0, s40, 0
    s_mov_b32 s41, 1024
    buffer_load_dwordx4 v92, s[52:55], s41 offen lds
    buffer_load_dwordx4 v93, s[52:55], s41 offen offset:1024 lds
    buffer_load_dwordx4 v94, s[52:55], s41 offen offset:2048 lds
    buffer_load_dwordx4 v95, s[52:55], s41 offen offset:3072 lds
    s_barrier
    v_mfma_f32_16x16x32_bf16 v[116:119], a[80:83], a[80:83], 0
    v_mfma_f32_16x16x32_bf16 v[112:115], v[96:99], a[80:83], 0
    v_mfma_f32_16x16x32_bf16 v[120:123], a[84:87], a[80:83], 0
    v_mfma_f32_16x16x32_bf16 v[124:127], a[84:87], v[96:99], 0
    v_mfma_f32_16x16x32_bf16 v[116:119], a[88:91], a[88:91], v[116:119]
    v_mfma_f32_16x16x32_bf16 v[112:115], v[96:99], a[88:91], v[112:115]
    v_mfma_f32_16x16x32_bf16 v[120:123], a[92:95], a[88:91], v[120:123]
    v_mfma_f32_16x16x32_bf16 v[124:127], a[92:95], v[96:99], v[124:127]
    v_mfma_f32_16x16x32_bf16 v[116:119], a[96:99], a[96:99], v[116:119]
    v_mfma_f32_16x16x32_bf16 v[112:115], v[96:99], a[96:99], v[112:115]
    v_mfma_f32_16x16x32_bf16 v[120:123], a[100:103], a[96:99], v[120:123]
    v_mfma_f32_16x16x32_bf16 v[124:127], a[100:103], v[96:99], v[124:127]
    v_mfma_f32_16x16x32_bf16 v[116:119], a[104:107], a[104:107], v[116:119]
    v_mfma_f32_16x16x32_bf16 v[112:115], v[96:99], a[104:107], v[112:115]
    v_mfma_f32_16x16x32_bf16 v[120:123], a[108:111], a[104:107], v[120:123]
    v_mfma_f32_16x16x32_bf16 v[124:127], a[108:111], v[96:99], v[124:127]
    s_waitcnt vmcnt(12)
    ds_read_b128 a[80:83], v102 offset:4096
    ds_read_b128 a[84:87], v100 offset:256
    ds_read_b128 a[88:91], v103 offset:4096
    ds_read_b128 a[92:95], v100 offset:320
    ds_read_b128 a[96:99], v102 offset:6144
    ds_read_b128 a[100:103], v100 offset:384
    ds_read_b128 a[104:107], v103 offset:6144
    ds_read_b128 a[108:111], v100 offset:448
    s_waitcnt lgkmcnt(0)
    v_mfma_f32_16x16x32_bf16 v[116:119], a[80:83], a[80:83], v[116:119]
    v_mfma_f32_16x16x32_bf16 v[112:115], v[96:99], a[80:83], v[112:115]
    v_mfma_f32_16x16x32_bf16 v[120:123], a[84:87], a[80:83], v[120:123]
    v_mfma_f32_16x16x32_bf16 v[124:127], a[84:87], v[96:99], v[124:127]
    v_mfma_f32_16x16x32_bf16 v[116:119], a[88:91], a[88:91], v[116:119]
    v_mfma_f32_16x16x32_bf16 v[112:115], v[96:99], a[88:91], v[112:115]
    v_mfma_f32_16x16x32_bf16 v[120:123], a[92:95], a[88:91], v[120:123]
    v_mfma_f32_16x16x32_bf16 v[124:127], a[92:95], v[96:99], v[124:127]
    v_mfma_f32_16x16x32_bf16 v[116:119], a[96:99], a[96:99], v[116:119]
    v_mfma_f32_16x16x32_bf16 v[112:115], v[96:99], a[96:99], v[112:115]
    v_mfma_f32_16x16x32_bf16 v[120:123], a[100:103], a[96:99], v[120:123]
    v_mfma_f32_16x16x32_bf16 v[124:127], a[100:103], v[96:99], v[124:127]
    v_mfma_f32_16x16x32_bf16 v[116:119], a[104:107], a[104:107], v[116:119]
    v_mfma_f32_16x16x32_bf16 v[112:115], v[96:99], a[104:107], v[112:115]
    v_mfma_f32_16x16x32_bf16 v[120:123], a[108:111], a[104:107], v[120:123]
    v_mfma_f32_16x16x32_bf16 v[124:127], a[108:111], v[96:99], v[124:127]
    s_waitcnt vmcnt(8)
    ds_read_b128 a[80:83], v102 offset:8192
    ds_read_b128 a[84:87], v100 offset:512
    ds_read_b128 a[88:91], v103 offset:8192
    ds_read_b128 a[92:95], v100 offset:576
    ds_read_b128 a[96:99], v102 offset:10240
    ds_read_b128 a[100:103], v100 offset:640
    ds_read_b128 a[104:107], v103 offset:10240
    ds_read_b128 a[108:111], v100 offset:704
    s_waitcnt lgkmcnt(0)
    v_mfma_f32_16x16x32_bf16 v[116:119], a[80:83], a[80:83], v[116:119]
    v_mfma_f32_16x16x32_bf16 v[112:115], v[96:99], a[80:83], v[112:115]
    v_mfma_f32_16x16x32_bf16 v[120:123], a[84:87], a[80:83], v[120:123]
    v_mfma_f32_16x16x32_bf16 v[124:127], a[84:87], v[96:99], v[124:127]
    v_mfma_f32_16x16x32_bf16 v[116:119], a[88:91], a[88:91], v[116:119]
    v_mfma_f32_16x16x32_bf16 v[112:115], v[96:99], a[88:91], v[112:115]
    v_mfma_f32_16x16x32_bf16 v[120:123], a[92:95], a[88:91], v[120:123]
    v_mfma_f32_16x16x32_bf16 v[124:127], a[92:95], v[96:99], v[124:127]
    v_mfma_f32_16x16x32_bf16 v[116:119], a[96:99], a[96:99], v[116:119]
    v_mfma_f32_16x16x32_bf16 v[112:115], v[96:99], a[96:99], v[112:115]
    v_mfma_f32_16x16x32_bf16 v[120:123], a[100:103], a[96:99], v[120:123]
    v_mfma_f32_16x16x32_bf16 v[124:127], a[100:103], v[96:99], v[124:127]
    v_mfma_f32_16x16x32_bf16 v[116:119], a[104:107], a[104:107], v[116:119]
    v_mfma_f32_16x16x32_bf16 v[112:115], v[96:99], a[104:107], v[112:115]
    v_mfma_f32_16x16x32_bf16 v[120:123], a[108:111], a[104:107], v[120:123]
    v_mfma_f32_16x16x32_bf16 v[124:127], a[108:111], v[96:99], v[124:127]
    s_waitcnt vmcnt(4)
    ds_read_b128 a[80:83], v102 offset:12288
    ds_read_b128 a[84:87], v100 offset:768
    ds_read_b128 a[88:91], v103 offset:12288
    ds_read_b128 a[92:95], v100 offset:832
    ds_read_b128 a[96:99], v102 offset:14336
    ds_read_b128 a[100:103], v100 offset:896
    ds_read_b128 a[104:107], v103 offset:14336
    ds_read_b128 a[108:111], v100 offset:960
    s_waitcnt lgkmcnt(0)
    v_mfma_f32_16x16x32_bf16 v[116:119], a[80:83], a[80:83], v[116:119]
    v_mfma_f32_16x16x32_bf16 v[112:115], v[96:99], a[80:83], v[112:115]
    v_mfma_f32_16x16x32_bf16 v[120:123], a[84:87], a[80:83], v[120:123]
    v_mfma_f32_16x16x32_bf16 v[124:127], a[84:87], v[96:99], v[124:127]
    v_mfma_f32_16x16x32_bf16 v[116:119], a[88:91], a[88:91], v[116:119]
    v_mfma_f32_16x16x32_bf16 v[112:115], v[96:99], a[88:91], v[112:115]
    v_mfma_f32_16x16x32_bf16 v[120:123], a[92:95], a[88:91], v[120:123]
    v_mfma_f32_16x16x32_bf16 v[124:127], a[92:95], v[96:99], v[124:127]
    v_mfma_f32_16x16x32_bf16 v[116:119], a[96:99], a[96:99], v[116:119]
    v_mfma_f32_16x16x32_bf16 v[112:115], v[96:99], a[96:99], v[112:115]
    v_mfma_f32_16x16x32_bf16 v[120:123], a[100:103], a[96:99], v[120:123]
    v_mfma_f32_16x16x32_bf16 v[124:127], a[100:103], v[96:99], v[124:127]
    v_mfma_f32_16x16x32_bf16 v[116:119], a[104:107], a[104:107], v[116:119]
    v_mfma_f32_16x16x32_bf16 v[112:115], v[96:99], a[104:107], v[112:115]
    v_mfma_f32_16x16x32_bf16 v[120:123], a[108:111], a[104:107], v[120:123]
    v_mfma_f32_16x16x32_bf16 v[124:127], a[108:111], v[96:99], v[124:127]
    s_waitcnt vmcnt(0)
    ds_read_b128 a[80:83], v102 offset:0
    ds_read_b128 a[84:87], v100 offset:1024
    ds_read_b128 a[88:91], v103 offset:0
    ds_read_b128 a[92:95], v100 offset:1088
    ds_read_b128 a[96:99], v102 offset:2048
    ds_read_b128 a[100:103], v100 offset:1152
    ds_read_b128 a[104:107], v103 offset:2048
    ds_read_b128 a[108:111], v100 offset:1216
    s_waitcnt lgkmcnt(0)
    v_mfma_f32_16x16x32_bf16 v[116:119], a[80:83], a[80:83], v[116:119]
    v_mfma_f32_16x16x32_bf16 v[112:115], v[96:99], a[80:83], v[112:115]
    v_mfma_f32_16x16x32_bf16 v[120:123], a[84:87], a[80:83], v[120:123]
    v_mfma_f32_16x16x32_bf16 v[124:127], a[84:87], v[96:99], v[124:127]
    v_mfma_f32_16x16x32_bf16 v[116:119], a[88:91], a[88:91], v[116:119]
    v_mfma_f32_16x16x32_bf16 v[112:115], v[96:99], a[88:91], v[112:115]
    v_mfma_f32_16x16x32_bf16 v[120:123], a[92:95], a[88:91], v[120:123]
    v_mfma_f32_16x16x32_bf16 v[124:127], a[92:95], v[96:99], v[124:127]
    v_mfma_f32_16x16x32_bf16 v[116:119], a[96:99], a[96:99], v[116:119]
    v_mfma_f32_16x16x32_bf16 v[112:115], v[96:99], a[96:99], v[112:115]
    v_mfma_f32_16x16x32_bf16 v[120:123], a[100:103], a[96:99], v[120:123]
    v_mfma_f32_16x16x32_bf16 v[124:127], a[100:103], v[96:99], v[124:127]
    v_mfma_f32_16x16x32_bf16 v[116:119], a[104:107], a[104:107], v[116:119]
    v_mfma_f32_16x16x32_bf16 v[112:115], v[96:99], a[104:107], v[112:115]
    v_mfma_f32_16x16x32_bf16 v[120:123], a[108:111], a[104:107], v[120:123]
    v_mfma_f32_16x16x32_bf16 v[124:127], a[108:111], v[96:99], v[124:127]
    s_nop 4
    v_cndmask_b32 v4, v116, v117, s[58:59]
    v_cndmask_b32 v5, v118, v119, s[58:59]
    v_cndmask_b32 v4, v4, v5, s[64:65]
    ds_bpermute_b32 v4, v101, v4
    v_mul_f32 v5, 0xbacccccd, v112
    v_cvt_pk_bf16_f32 v104, v5, v5
    v_lshlrev_b32 v104, 16, v104
    v_mul_f32 v5, v5, v5
    v_mov_b32 v6, 0x3acccccd
    s_waitcnt lgkmcnt(0)
    v_fma_f32 v4, v4, v6, -v5
    v_max_f32 v4, 0, v4
    v_cvt_pk_bf16_f32 v4, v4, v4
    v_lshlrev_b32 v4, 16, v4
    v_add_f32 v4, 0x3727c5ac, v4
    v_cvt_pk_bf16_f32 v4, v4, v4
    v_lshlrev_b32 v4, 16, v4
    v_sqrt_f32 v4, v4
    s_nop 0
    v_cvt_pk_bf16_f32 v4, v4, v4
    v_lshlrev_b32 v4, 16, v4
    v_rcp_f32 v105, v4
    v_lshrrev_b32 v8, 16, v4
    v_fma_f32 v4, v104, v124, v120
    v_mul_f32 v4, v4, v105
    v_cvt_pk_bf16_f32 v4, v4, v4
    v_ashrrev_i32 v5, 31, v4
    v_or_b32 v5, 0x80000000, v5
    v_xor_b32 v4, v4, v5
    v_and_b32 v4, 0xffff0000, v4
    v_or_b32 v4, v4, v106
    ds_write_b32 v107, v4
    v_mov_b32 v11, 132864
    v_mov_b32 v7, 1
    s_mov_b64 exec, 1
    ds_add_u32 v11, v7
    s_mov_b64 exec, -1
    v_or_b32 v8, v8, v104
    v_mov_b32 v9, s34
    s_mov_b64 exec, 0xffff
    buffer_store_dwordx2 v[8:9], v108, s[28:31], 0 offen sc1
    s_mov_b64 exec, -1
    s_cmp_lg_u32 s26, 0
    s_cbranch_scc1 Lpub_done
    s_setprio 3
Lcw_9:
    s_sub_u32 s35, s35, 1
    s_cbranch_scc1 Lend
    ds_read_b32 v7, v11
    s_waitcnt lgkmcnt(0)
    v_readfirstlane_b32 s38, v7
    s_nop 0
    s_cmp_lt_u32 s38, 4
    s_cbranch_scc1 Lcw_9
    v_add_u32 v5, 132608, v12
    ds_read_b32 v6, v5
    s_waitcnt lgkmcnt(0)
    v_mov_b32 v4, v6
    s_nop 1
    v_max_u32_dpp v4, v4, v4 row_ror:8 row_mask:0xf bank_mask:0xf
    s_nop 1
    v_max_u32_dpp v4, v4, v4 row_ror:4 row_mask:0xf bank_mask:0xf
    s_nop 1
    v_max_u32_dpp v4, v4, v4 row_ror:2 row_mask:0xf bank_mask:0xf
    s_nop 1
    v_max_u32_dpp v4, v4, v4 row_ror:1 row_mask:0xf bank_mask:0xf
    s_nop 0
    v_readlane_b32 s66, v4, 0
    v_readlane_b32 s36, v4, 16
    v_readlane_b32 s37, v4, 32
    v_readlane_b32 s38, v4, 48
    s_max_u32 s66, s66, s36
    s_max_u32 s37, s37, s38
    s_max_u32 s66, s66, s37
    v_cmp_eq_u32 vcc, s66, v6
    s_nop 1
    v_cndmask_b32 v4, v6, 0, vcc
    s_nop 1
    v_max_u32_dpp v4, v4, v4 row_ror:8 row_mask:0xf bank_mask:0xf
    s_nop 1
    v_max_u32_dpp v4, v4, v4 row_ror:4 row_mask:0xf bank_mask:0xf
    s_nop 1
    v_max_u32_dpp v4, v4, v4 row_ror:2 row_mask:0xf bank_mask:0xf
    s_nop 1
    v_max_u32_dpp v4, v4, v4 row_ror:1 row_mask:0xf bank_mask:0xf
    s_nop 0
    v_readlane_b32 s67, v4, 0
    v_readlane_b32 s36, v4, 16
    v_readlane_b32 s37, v4, 32
    v_readlane_b32 s38, v4, 48
    s_max_u32 s67, s67, s36
    s_max_u32 s37, s37, s38
    s_max_u32 s67, s67, s37
    v_mov_b32 v112, s66
    v_mov_b32 v113, s34
    v_mov_b32 v114, s67
    v_mov_b32 v115, s34
    s_lshl_b32 s36, s32, 7
    s_add_u32 s36, s36, 8126464
    s_mov_b64 exec, 0xff
    buffer_store_dwordx4 v[112:115], v13, s[28:31], s36 offen sc1
    s_mov_b64 exec, -1
    v_mov_b32 v11, 132864
    v_mov_b32 v7, 1
    s_mov_b64 exec, 1
    ds_add_u32 v11, v7
    s_mov_b64 exec, -1
    s_mov_b64 exec, 1
    s_lshl_b32 s36, s2, 2
    s_add_u32 s36, s36, 8323072
    v_mov_b32 v4, s34
    v_mov_b32 v5, s36
    buffer_store_dword v4, v5, s[28:31], 0 offen sc1
    s_mov_b64 exec, -1
    s_setprio 0
Lpub_done:
Lcw_10:
    s_sub_u32 s35, s35, 1
    s_cbranch_scc1 Lend
    ds_read_b32 v7, v11
    s_waitcnt lgkmcnt(0)
    v_readfirstlane_b32 s38, v7
    s_nop 0
    s_cmp_lt_u32 s38, 5
    s_cbranch_scc1 Lcw_10
    s_cmp_ge_u32 s32, 27
    s_cbranch_scc1 Lhelp_r
    s_add_u32 m0, s40, 0
    s_add_u32 s41, s42, 0
    buffer_load_dwordx4 v18, s[44:47], s41 offen nt lds
    buffer_load_dwordx4 v19, s[44:47], s41 offen offset:1024 nt lds
    buffer_load_dwordx4 v20, s[44:47], s41 offen offset:2048 nt lds
    buffer_load_dwordx4 v21, s[44:47], s41 offen offset:3072 nt lds
    s_add_u32 m0, s40, 4096
    s_add_u32 s41, s42, 442368
    buffer_load_dwordx4 v18, s[44:47], s41 offen nt lds
    buffer_load_dwordx4 v19, s[44:47], s41 offen offset:1024 nt lds
    buffer_load_dwordx4 v20, s[44:47], s41 offen offset:2048 nt lds
    buffer_load_dwordx4 v21, s[44:47], s41 offen offset:3072 nt lds
    s_add_u32 m0, s40, 8192
    s_add_u32 s41, s42, 884736
    buffer_load_dwordx4 v18, s[44:47], s41 offen nt lds
    buffer_load_dwordx4 v19, s[44:47], s41 offen offset:1024 nt lds
    buffer_load_dwordx4 v20, s[44:47], s41 offen offset:2048 nt lds
    buffer_load_dwordx4 v21, s[44:47], s41 offen offset:3072 nt lds
    s_add_u32 m0, s40, 12288
    s_add_u32 s41, s42, 1327104
    buffer_load_dwordx4 v18, s[44:47], s41 offen nt lds
    buffer_load_dwordx4 v19, s[44:47], s41 offen offset:1024 nt lds
    buffer_load_dwordx4 v20, s[44:47], s41 offen offset:2048 nt lds
    buffer_load_dwordx4 v21, s[44:47], s41 offen offset:3072 nt lds
    s_waitcnt vmcnt(12)
    ds_read_b64_tr_b16 a[0:1], v14 offset:0
    ds_read_b64_tr_b16 a[2:3], v14 offset:512
    ds_read_b64_tr_b16 a[4:5], v15 offset:0
    ds_read_b64_tr_b16 a[6:7], v15 offset:512
    ds_read_b64_tr_b16 a[8:9], v16 offset:0
    ds_read_b64_tr_b16 a[10:11], v16 offset:512
    ds_read_b64_tr_b16 a[12:13], v17 offset:0
    ds_read_b64_tr_b16 a[14:15], v17 offset:512
    s_waitcnt lgkmcnt(0)
    s_add_u32 m0, s40, 0
    s_add_u32 s41, s42, 1769472
    buffer_load_dwordx4 v18, s[44:47], s41 offen nt lds
    buffer_load_dwordx4 v19, s[44:47], s41 offen offset:1024 nt lds
    buffer_load_dwordx4 v20, s[44:47], s41 offen offset:2048 nt lds
    buffer_load_dwordx4 v21, s[44:47], s41 offen offset:3072 nt lds
    v_mov_b32 v11, 132864
    v_mov_b32 v7, 1
    s_mov_b64 exec, 1
    ds_add_u32 v11, v7
    s_mov_b64 exec, -1
    s_waitcnt vmcnt(12)
    ds_read_b64_tr_b16 a[16:17], v14 offset:4096
    ds_read_b64_tr_b16 a[18:19], v14 offset:4608
    ds_read_b64_tr_b16 a[20:21], v15 offset:4096
    ds_read_b64_tr_b16 a[22:23], v15 offset:4608
    ds_read_b64_tr_b16 a[24:25], v16 offset:4096
    ds_read_b64_tr_b16 a[26:27], v16 offset:4608
    ds_read_b64_tr_b16 a[28:29], v17 offset:4096
    ds_read_b64_tr_b16 a[30:31], v17 offset:4608
    s_waitcnt lgkmcnt(0)
    s_add_u32 m0, s40, 4096
    s_add_u32 s41, s43, 0
    buffer_load_dwordx4 v22, s[48:51], s41 offen nt lds
    buffer_load_dwordx4 v23, s[48:51], s41 offen offset:1024 nt lds
    buffer_load_dwordx4 v24, s[48:51], s41 offen offset:2048 nt lds
    buffer_load_dwordx4 v25, s[48:51], s41 offen offset:3072 nt lds
    s_waitcnt vmcnt(12)
    ds_read_b64_tr_b16 a[32:33], v14 offset:8192
    ds_read_b64_tr_b16 a[34:35], v14 offset:8704
    ds_read_b64_tr_b16 a[36:37], v15 offset:8192
    ds_read_b64_tr_b16 a[38:39], v15 offset:8704
    ds_read_b64_tr_b16 a[40:41], v16 offset:8192
    ds_read_b64_tr_b16 a[42:43], v16 offset:8704
    ds_read_b64_tr_b16 a[44:45], v17 offset:8192
    ds_read_b64_tr_b16 a[46:47], v17 offset:8704
    s_waitcnt lgkmcnt(0)
    s_add_u32 m0, s40, 8192
    s_add_u32 s41, s43, 40960
    buffer_load_dwordx4 v22, s[48:51], s41 offen nt lds
    buffer_load_dwordx4 v23, s[48:51], s41 offen offset:1024 nt lds
    buffer_load_dwordx4 v24, s[48:51], s41 offen offset:2048 nt lds
    buffer_load_dwordx4 v25, s[48:51], s41 offen offset:3072 nt lds
    s_waitcnt vmcnt(12)
    ds_read_b64_tr_b16 a[48:49], v14 offset:12288
    ds_read_b64_tr_b16 a[50:51], v14 offset:12800
    ds_read_b64_tr_b16 a[52:53], v15 offset:12288
    ds_read_b64_tr_b16 a[54:55], v15 offset:12800
    ds_read_b64_tr_b16 a[56:57], v16 offset:12288
    ds_read_b64_tr_b16 a[58:59], v16 offset:12800
    ds_read_b64_tr_b16 a[60:61], v17 offset:12288
    ds_read_b64_tr_b16 a[62:63], v17 offset:12800
    s_waitcnt vmcnt(8)
    ds_read_b64_tr_b16 a[64:65], v14 offset:0
    ds_read_b64_tr_b16 a[66:67], v14 offset:512
    ds_read_b64_tr_b16 a[68:69], v15 offset:0
    ds_read_b64_tr_b16 a[70:71], v15 offset:512
    ds_read_b64_tr_b16 a[72:73], v16 offset:0
    ds_read_b64_tr_b16 a[74:75], v16 offset:512
    ds_read_b64_tr_b16 a[76:77], v17 offset:0
    ds_read_b64_tr_b16 a[78:79], v17 offset:512
    s_branch Laux_mm
Laux_u:
    s_cmp_ge_u32 s32, 27
    s_cbranch_scc1 Lend
    v_and_b32 v8, 1, v2
    v_lshlrev_b32 v8, 1, v8
    v_xor_b32 v8, v8, v6
    v_lshlrev_b32 v8, 4, v8
    v_mul_u32_u24 v9, 3456, v5
    s_lshl_b32 s38, s32, 7
    v_add3_u32 v18, v9, v8, s38
    v_xor_b32 v19, 64, v18
    v_add_u32 v19, 26624, v19
    v_add_u32 v20, 53248, v18
    v_add_u32 v21, 53248, v19
    s_mul_i32 s42, s26, 110592
    v_mul_u32_u24 v9, 1280, v5
    v_add_u32 v22, v9, v8
    v_xor_b32 v23, 64, v22
    v_add_u32 v23, 9216, v23
    v_add_u32 v24, 18432, v22
    v_add_u32 v25, 18432, v23
    s_mul_i32 s43, s32, 81920
    s_lshl_b32 s38, s3, 7
    s_add_u32 s43, s43, s38
    s_waitcnt lgkmcnt(0)
    s_mov_b64 s[44:45], s[16:17]
    s_mov_b32 s46, 2211840
    s_mov_b32 s47, 0x20000
    s_mov_b64 s[28:29], s[24:25]
    s_mov_b32 s30, 268435456
    s_mov_b32 s31, 0x20000
    s_load_dword s34, s[28:29], 0
    s_mov_b64 s[52:53], s[4:5]
    s_mov_b32 s54, 2621440
    s_mov_b32 s55, 0x20000
    s_mov_b64 s[48:49], s[18:19]
    s_mov_b32 s50, 2211840
    s_mov_b32 s51, 0x20000
    s_mov_b64 s[68:69], s[18:19]
    s_mov_b32 s70, 2211840
    s_mov_b32 s71, 0x20000
    s_cmp_ge_u32 s26, 2
    s_cselect_b32 s70, 0, s70
    v_bfe_u32 v10, v1, 2, 2
    v_and_b32 v8, 3, v1
    v_lshl_add_u32 v14, v2, 3, v10
    v_lshlrev_b32 v14, 7, v14
    v_lshlrev_b32 v9, 2, v1
    v_and_b32 v9, 0x60, v9
    v_add3_u32 v14, v14, v9, s40
    v_lshl_add_u32 v14, v8, 3, v14
    v_xor_b32 v15, 32, v14
    v_xor_b32 v16, 64, v14
    v_xor_b32 v17, 96, v14
    s_lshl_b32 s36, s26, 6
    s_add_u32 s36, s36, 141312
    v_lshl_add_u32 v26, v2, 4, s36
    v_min_u32 v8, 2, v3
    v_mul_u32_u24 v8, 1536, v8
    v_add_u32 v26, v26, v8
    s_waitcnt lgkmcnt(0)
    s_add_u32 s34, s34, 0x9e3779b8
    s_or_b32 s34, s34, 1
    s_cmp_lg_u32 s3, 7
    s_cbranch_scc1 Lnop7
    s_setprio 3
Lnop7:
    s_barrier
    s_add_u32 m0, s40, 0
    s_add_u32 s41, s42, 0
    buffer_load_dwordx4 v18, s[44:47], s41 offen nt lds
    buffer_load_dwordx4 v19, s[44:47], s41 offen offset:1024 nt lds
    buffer_load_dwordx4 v20, s[44:47], s41 offen offset:2048 nt lds
    buffer_load_dwordx4 v21, s[44:47], s41 offen offset:3072 nt lds
    s_add_u32 m0, s40, 4096
    s_add_u32 s41, s42, 442368
    buffer_load_dwordx4 v18, s[44:47], s41 offen nt lds
    buffer_load_dwordx4 v19, s[44:47], s41 offen offset:1024 nt lds
    buffer_load_dwordx4 v20, s[44:47], s41 offen offset:2048 nt lds
    buffer_load_dwordx4 v21, s[44:47], s41 offen offset:3072 nt lds
    s_add_u32 m0, s40, 8192
    s_add_u32 s41, s42, 884736
    buffer_load_dwordx4 v18, s[44:47], s41 offen nt lds
    buffer_load_dwordx4 v19, s[44:47], s41 offen offset:1024 nt lds
    buffer_load_dwordx4 v20, s[44:47], s41 offen offset:2048 nt lds
    buffer_load_dwordx4 v21, s[44:47], s41 offen offset:3072 nt lds
    s_add_u32 m0, s40, 12288
    s_add_u32 s41, s42, 1327104
    buffer_load_dwordx4 v18, s[44:47], s41 offen nt lds
    buffer_load_dwordx4 v19, s[44:47], s41 offen offset:1024 nt lds
    buffer_load_dwordx4 v20, s[44:47], s41 offen offset:2048 nt lds
    buffer_load_dwordx4 v21, s[44:47], s41 offen offset:3072 nt lds
    v_mov_b32 v11, 132864
Lcw_11:
    s_sub_u32 s35, s35, 1
    s_cbranch_scc1 Lend
    s_sleep 4
    ds_read_b32 v7, v11
    s_waitcnt lgkmcnt(0)
    v_readfirstlane_b32 s38, v7
    s_nop 0
    s_cmp_lt_u32 s38, 5
    s_cbranch_scc1 Lcw_11
    s_waitcnt vmcnt(12)
    ds_read_b64_tr_b16 a[0:1], v14 offset:0
    ds_read_b64_tr_b16 a[2:3], v14 offset:512
    ds_read_b64_tr_b16 a[4:5], v15 offset:0
    ds_read_b64_tr_b16 a[6:7], v15 offset:512
    ds_read_b64_tr_b16 a[8:9], v16 offset:0
    ds_read_b64_tr_b16 a[10:11], v16 offset:512
    ds_read_b64_tr_b16 a[12:13], v17 offset:0
    ds_read_b64_tr_b16 a[14:15], v17 offset:512
    s_waitcnt lgkmcnt(0)
    s_add_u32 m0, s40, 0
    s_add_u32 s41, s42, 1769472
    buffer_load_dwordx4 v18, s[44:47], s41 offen nt lds
    buffer_load_dwordx4 v19, s[44:47], s41 offen offset:1024 nt lds
    buffer_load_dwordx4 v20, s[44:47], s41 offen offset:2048 nt lds
    buffer_load_dwordx4 v21, s[44:47], s41 offen offset:3072 nt lds
    s_waitcnt vmcnt(12)
    ds_read_b64_tr_b16 a[16:17], v14 offset:4096
    ds_read_b64_tr_b16 a[18:19], v14 offset:4608
    ds_read_b64_tr_b16 a[20:21], v15 offset:4096
    ds_read_b64_tr_b16 a[22:23], v15 offset:4608
    ds_read_b64_tr_b16 a[24:25], v16 offset:4096
    ds_read_b64_tr_b16 a[26:27], v16 offset:4608
    ds_read_b64_tr_b16 a[28:29], v17 offset:4096
    ds_read_b64_tr_b16 a[30:31], v17 offset:4608
    s_waitcnt vmcnt(8)
    ds_read_b64_tr_b16 a[32:33], v14 offset:8192
    ds_read_b64_tr_b16 a[34:35], v14 offset:8704
    ds_read_b64_tr_b16 a[36:37], v15 offset:8192
    ds_read_b64_tr_b16 a[38:39], v15 offset:8704
    ds_read_b64_tr_b16 a[40:41], v16 offset:8192
    ds_read_b64_tr_b16 a[42:43], v16 offset:8704
    ds_read_b64_tr_b16 a[44:45], v17 offset:8192
    ds_read_b64_tr_b16 a[46:47], v17 offset:8704
    s_waitcnt vmcnt(4)
    ds_read_b64_tr_b16 a[48:49], v14 offset:12288
    ds_read_b64_tr_b16 a[50:51], v14 offset:12800
    ds_read_b64_tr_b16 a[52:53], v15 offset:12288
    ds_read_b64_tr_b16 a[54:55], v15 offset:12800
    ds_read_b64_tr_b16 a[56:57], v16 offset:12288
    ds_read_b64_tr_b16 a[58:59], v16 offset:12800
    ds_read_b64_tr_b16 a[60:61], v17 offset:12288
    ds_read_b64_tr_b16 a[62:63], v17 offset:12800
    s_waitcnt vmcnt(0)
    ds_read_b64_tr_b16 a[64:65], v14 offset:0
    ds_read_b64_tr_b16 a[66:67], v14 offset:512
    ds_read_b64_tr_b16 a[68:69], v15 offset:0
    ds_read_b64_tr_b16 a[70:71], v15 offset:512
    ds_read_b64_tr_b16 a[72:73], v16 offset:0
    ds_read_b64_tr_b16 a[74:75], v16 offset:512
    ds_read_b64_tr_b16 a[76:77], v17 offset:0
    ds_read_b64_tr_b16 a[78:79], v17 offset:512
    s_cmp_lg_u32 s3, 7
    s_cbranch_scc1 Lnofx
    v_mov_b32 v92, 0x3f803f80
    v_mov_b32 v93, 0x3f803f80
    v_mov_b32 v94, 0x3f803f80
    v_mov_b32 v95, 0x3f803f80
    v_add_u32 v4, 144384, v13
    ds_write_b128 v4, v[92:95]
    ds_write_b128 v4, v[92:95] offset:1024
    v_and_b32 v120, 31, v1
    v_lshlrev_b32 v120, 7, v120
    v_add_u32 v120, 8126464, v120
Lpt_12:
    s_sub_u32 s35, s35, 1
    s_cbranch_scc1 Lend
    s_sleep 2
    buffer_load_dwordx4 v[124:127], v120, s[28:31], 0 offen sc1
    s_waitcnt vmcnt(0)
    v_cmp_ne_u32 vcc, s34, v125
    v_cmp_ne_u32 s[36:37], s34, v127
    s_nop 0
    s_or_b64 s[36:37], s[36:37], vcc
    s_cbranch_scc1 Lpt_12
    v_mov_b32 v120, v124
    s_nop 1
    v_max_u32_dpp v120, v120, v120 row_ror:8 row_mask:0xf bank_mask:0xf
    s_nop 1
    v_max_u32_dpp v120, v120, v120 row_ror:4 row_mask:0xf bank_mask:0xf
    s_nop 1
    v_max_u32_dpp v120, v120, v120 row_ror:2 row_mask:0xf bank_mask:0xf
    s_nop 1
    v_max_u32_dpp v120, v120, v120 row_ror:1 row_mask:0xf bank_mask:0xf
    s_nop 0
    v_readlane_b32 s56, v120, 0
    v_readlane_b32 s36, v120, 16
    v_readlane_b32 s37, v120, 32
    v_readlane_b32 s38, v120, 48
    s_max_u32 s56, s56, s36
    s_max_u32 s37, s37, s38
    s_max_u32 s56, s56, s37
    v_cmp_eq_u32 vcc, s56, v124
    s_nop 1
    v_cndmask_b32 v120, v124, v126, vcc
    s_nop 1
    v_max_u32_dpp v120, v120, v120 row_ror:8 row_mask:0xf bank_mask:0xf
    s_nop 1
    v_max_u32_dpp v120, v120, v120 row_ror:4 row_mask:0xf bank_mask:0xf
    s_nop 1
    v_max_u32_dpp v120, v120, v120 row_ror:2 row_mask:0xf bank_mask:0xf
    s_nop 1
    v_max_u32_dpp v120, v120, v120 row_ror:1 row_mask:0xf bank_mask:0xf
    s_nop 0
    v_readlane_b32 s57, v120, 0
    v_readlane_b32 s36, v120, 16
    v_readlane_b32 s37, v120, 32
    v_readlane_b32 s38, v120, 48
    s_max_u32 s57, s57, s36
    s_max_u32 s37, s37, s38
    s_max_u32 s57, s57, s37
    s_and_b32 s36, s56, 0x7ff
    s_sub_u32 s36, 2047, s36
    s_and_b32 s37, s57, 0x7ff
    s_sub_u32 s37, 2047, s37
    s_mul_i32 s38, s36, 1280
    s_mul_i32 s39, s37, 1280
    s_mov_b32 m0, 141312
    v_mov_b32 v4, s36
    buffer_load_dwordx4 v13, s[52:55], s38 offen lds
    s_mov_b32 m0, 142848
    v_mov_b32 v5, s37
    buffer_load_dwordx4 v13, s[52:55], s39 offen lds
    s_mov_b64 exec, 0xffff
    buffer_load_dwordx4 v13, s[52:55], s39 offen offset:1024 lds
    s_mov_b32 m0, 141312
    s_mov_b32 vcc_lo, 0xaaaaaaaa
    buffer_load_dwordx4 v13, s[52:55], s38 offen offset:1024 lds
    s_mov_b64 exec, 3
    v_cndmask_b32 v4, v4, v5, vcc
    v_lshlrev_b32 v118, 3, v4
    v_add_u32 v118, 8192000, v118
    v_add_u32 v9, 132872, v12
Lxs_chk:
    s_sub_u32 s35, s35, 1
    s_cbranch_scc1 Lend
    buffer_load_dwordx2 v[116:117], v118, s[28:31], 0 offen sc1
    s_waitcnt vmcnt(0)
    v_cmp_ne_u32 vcc, s34, v117
    s_nop 0
    s_cbranch_vccnz Lxs_chk
    ds_write_b32 v9, v116
    s_mov_b64 exec, -1
    v_mov_b32 v10, 132868
    v_mov_b32 v7, 1
    s_mov_b64 exec, 1
    ds_add_u32 v10, v7
    s_mov_b64 exec, -1
Lnofx:
Lcw_13:
    s_sub_u32 s35, s35, 1
    s_cbranch_scc1 Lend
    s_sleep 2
    ds_read_b32 v7, v11
    s_waitcnt lgkmcnt(0)
    v_readfirstlane_b32 s38, v7
    s_nop 0
    s_cmp_lt_u32 s38, 9
    s_cbranch_scc1 Lcw_13
    s_add_u32 m0, s40, 4096
    s_add_u32 s41, s43, 0
    buffer_load_dwordx4 v22, s[48:51], s41 offen nt lds
    buffer_load_dwordx4 v23, s[48:51], s41 offen offset:1024 nt lds
    buffer_load_dwordx4 v24, s[48:51], s41 offen offset:2048 nt lds
    buffer_load_dwordx4 v25, s[48:51], s41 offen offset:3072 nt lds
    s_add_u32 m0, s40, 8192
    s_add_u32 s41, s43, 40960
    buffer_load_dwordx4 v22, s[48:51], s41 offen nt lds
    buffer_load_dwordx4 v23, s[48:51], s41 offen offset:1024 nt lds
    buffer_load_dwordx4 v24, s[48:51], s41 offen offset:2048 nt lds
    buffer_load_dwordx4 v25, s[48:51], s41 offen offset:3072 nt lds
    s_add_u32 m0, s40, 12288
    s_add_u32 s41, s43, 512
    buffer_load_dwordx4 v22, s[68:71], s41 offen nt lds
    buffer_load_dwordx4 v23, s[68:71], s41 offen offset:1024 nt lds
    buffer_load_dwordx4 v24, s[68:71], s41 offen offset:2048 nt lds
    buffer_load_dwordx4 v25, s[68:71], s41 offen offset:3072 nt lds
    s_add_u32 m0, s40, 0
    s_add_u32 s41, s43, 41472
    buffer_load_dwordx4 v22, s[68:71], s41 offen nt lds
    buffer_load_dwordx4 v23, s[68:71], s41 offen offset:1024 nt lds
    buffer_load_dwordx4 v24, s[68:71], s41 offen offset:2048 nt lds
    buffer_load_dwordx4 v25, s[68:71], s41 offen offset:3072 nt lds
Laux_mm:
    v_mov_b32 v10, 132868
Lcw_14:
    s_sub_u32 s35, s35, 1
    s_cbranch_scc1 Lend
    s_sleep 1
    ds_read_b32 v7, v10
    s_waitcnt lgkmcnt(0)
    v_readfirstlane_b32 s38, v7
    s_nop 0
    s_cmp_lt_u32 s38, 1
    s_cbranch_scc1 Lcw_14
    ds_read_b128 v[92:95], v26 offset:0
    ds_read_b128 v[96:99], v26 offset:256
    ds_read_b128 v[100:103], v26 offset:512
    ds_read_b128 v[104:107], v26 offset:768
    ds_read_b128 v[108:111], v26 offset:1024
    ds_read_b64 v[116:117], v10 offset:4
    s_waitcnt lgkmcnt(0)
    v_readfirstlane_b32 s56, v116
    v_readfirstlane_b32 s57, v117
    v_mfma_f32_16x16x32_bf16 v[112:115], a[0:3], v[92:95], 0
    v_mfma_f32_16x16x32_bf16 v[116:119], a[4:7], v[92:95], 0
    v_mfma_f32_16x16x32_bf16 v[120:123], a[8:11], v[92:95], 0
    v_mfma_f32_16x16x32_bf16 v[124:127], a[12:15], v[92:95], 0
    v_mfma_f32_16x16x32_bf16 v[112:115], a[16:19], v[96:99], v[112:115]
    v_mfma_f32_16x16x32_bf16 v[116:119], a[20:23], v[96:99], v[116:119]
    v_mfma_f32_16x16x32_bf16 v[120:123], a[24:27], v[96:99], v[120:123]
    v_mfma_f32_16x16x32_bf16 v[124:127], a[28:31], v[96:99], v[124:127]
    v_mfma_f32_16x16x32_bf16 v[112:115], a[32:35], v[100:103], v[112:115]
    v_mfma_f32_16x16x32_bf16 v[116:119], a[36:39], v[100:103], v[116:119]
    v_mfma_f32_16x16x32_bf16 v[120:123], a[40:43], v[100:103], v[120:123]
    v_mfma_f32_16x16x32_bf16 v[124:127], a[44:47], v[100:103], v[124:127]
    v_mfma_f32_16x16x32_bf16 v[112:115], a[48:51], v[104:107], v[112:115]
    v_mfma_f32_16x16x32_bf16 v[116:119], a[52:55], v[104:107], v[116:119]
    v_mfma_f32_16x16x32_bf16 v[120:123], a[56:59], v[104:107], v[120:123]
    v_mfma_f32_16x16x32_bf16 v[124:127], a[60:63], v[104:107], v[124:127]
    v_mfma_f32_16x16x32_bf16 v[112:115], a[64:67], v[108:111], v[112:115]
    v_mfma_f32_16x16x32_bf16 v[116:119], a[68:71], v[108:111], v[116:119]
    v_mfma_f32_16x16x32_bf16 v[120:123], a[72:75], v[108:111], v[120:123]
    v_mfma_f32_16x16x32_bf16 v[124:127], a[76:79], v[108:111], v[124:127]
    s_mul_i32 s36, s3, 768
    s_add_u32 s36, s36, 133120
    v_lshlrev_b32 v4, 8, v3
    v_lshl_add_u32 v4, v2, 4, v4
    v_add_u32 v4, s36, v4
    v_add_u32 v5, 133120, v12
    s_lshl_b32 s37, s3, 8
    s_add_u32 s37, s37, 139264
    v_lshl_add_u32 v6, v1, 1, s37
    v_and_b32 v7, 1, v1
    v_lshlrev_b32 v7, 7, v7
    v_lshl_add_u32 v7, v2, 4, v7
    v_add_u32 v7, s37, v7
    s_lshl_b32 s38, s56, 16
    s_lshl_b32 s39, s57, 16
    v_rcp_f32 v8, s38
    v_rcp_f32 v9, s39
    s_and_b32 s56, s56, 0xffff0000
    s_and_b32 s57, s57, 0xffff0000
    s_mov_b32 exec_lo, 0x00070007
    s_mov_b32 exec_hi, 0x00070007
    ds_write_b128 v4, v[112:115] offset:0
    ds_write_b128 v4, v[116:119] offset:64
    ds_write_b128 v4, v[120:123] offset:128
    ds_write_b128 v4, v[124:127] offset:192
    s_mov_b64 exec, -1
    s_waitcnt lgkmcnt(0)
    s_barrier
    ds_read2st64_b32 v[92:93], v5 offset0:0 offset1:1
    ds_read2st64_b32 v[94:95], v5 offset0:2 offset1:3
    ds_read2st64_b32 v[96:97], v5 offset0:4 offset1:5
    ds_read2st64_b32 v[98:99], v5 offset0:6 offset1:7
    ds_read2st64_b32 v[100:101], v5 offset0:8 offset1:9
    ds_read2st64_b32 v[102:103], v5 offset0:10 offset1:11
    ds_read2st64_b32 v[116:117], v5 offset0:12 offset1:13
    ds_read2st64_b32 v[118:119], v5 offset0:14 offset1:15
    ds_read2st64_b32 v[120:121], v5 offset0:16 offset1:17
    ds_read2st64_b32 v[122:123], v5 offset0:18 offset1:19
    ds_read2st64_b32 v[124:125], v5 offset0:20 offset1:21
    ds_read2st64_b32 v[126:127], v5 offset0:22 offset1:23
    v_cmp_eq_u32 s[72:73], 1, v2
    v_cmp_eq_u32 s[74:75], 2, v2
    v_cmp_eq_u32 s[76:77], 3, v2
    s_mul_i32 s37, s32, 10
    s_add_u32 s37, s37, s3
    s_lshl_b32 s37, s37, 10
    s_add_u32 s37, s37, 7405568
    s_waitcnt lgkmcnt(0)
    v_add_f32 v92, v92, v95
    v_add_f32 v98, v98, v101
    v_add_f32 v92, v92, v98
    v_add_f32 v93, v93, v96
    v_add_f32 v99, v99, v102
    v_add_f32 v93, v93, v99
    v_add_f32 v94, v94, v97
    v_add_f32 v100, v100, v103
    v_add_f32 v94, v94, v100
    v_add_f32 v116, v116, v119
    v_add_f32 v122, v122, v125
    v_add_f32 v116, v116, v122
    v_add_f32 v117, v117, v120
    v_add_f32 v123, v123, v126
    v_add_f32 v117, v117, v123
    v_add_f32 v118, v118, v121
    v_add_f32 v124, v124, v127
    v_add_f32 v118, v118, v124
    v_fmac_f32 v92, s56, v94
    v_mul_f32 v112, v92, v8
    v_fmac_f32 v93, s57, v94
    v_mul_f32 v113, v93, v9
    v_fmac_f32 v116, s56, v118
    v_mul_f32 v120, v116, v8
    v_fmac_f32 v117, s57, v118
    v_mul_f32 v121, v117, v9
    v_cvt_pk_bf16_f32 v113, v112, v113
    v_lshlrev_b32 v112, 16, v113
    v_and_b32 v113, 0xffff0000, v113
    v_cvt_pk_bf16_f32 v121, v120, v121
    v_lshlrev_b32 v120, 16, v121
    v_and_b32 v121, 0xffff0000, v121
    v_mul_f32 v114, 0xbfb8aa3b, v112
    v_mul_f32 v115, 0xbfb8aa3b, v113
    v_exp_f32 v114, v114
    v_exp_f32 v115, v115
    v_add_f32 v114, 1.0, v114
    v_add_f32 v115, 1.0, v115
    v_rcp_f32 v114, v114
    v_rcp_f32 v115, v115
    v_mul_f32 v114, v114, v112
    v_mul_f32 v115, v115, v113
    v_cvt_pk_bf16_f32 v115, v114, v115
    v_lshlrev_b32 v114, 16, v115
    v_and_b32 v115, 0xffff0000, v115
    v_mul_f32 v114, v114, v120
    v_mul_f32 v115, v115, v121
    v_cvt_pk_bf16_f32 v114, v114, v115
    ds_write_b16 v6, v114
    ds_write_b16_d16_hi v6, v114 offset:128
    ds_read_b128 v[92:95], v7 offset:0
    ds_read_b128 v[96:99], v7 offset:64
    v_mov_b32 v101, s34
    v_mov_b32 v103, s34
    s_waitcnt vmcnt(0)
    ds_read_b64_tr_b16 v[28:29], v14 offset:4096
    ds_read_b64_tr_b16 v[30:31], v14 offset:4608
    ds_read_b64_tr_b16 v[32:33], v15 offset:4096
    ds_read_b64_tr_b16 v[34:35], v15 offset:4608
    ds_read_b64_tr_b16 v[36:37], v16 offset:4096
    ds_read_b64_tr_b16 v[38:39], v16 offset:4608
    ds_read_b64_tr_b16 v[40:41], v17 offset:4096
    ds_read_b64_tr_b16 v[42:43], v17 offset:4608
    ds_read_b64_tr_b16 v[44:45], v14 offset:8192
    ds_read_b64_tr_b16 v[46:47], v14 offset:8704
    ds_read_b64_tr_b16 v[48:49], v15 offset:8192
    ds_read_b64_tr_b16 v[50:51], v15 offset:8704
    ds_read_b64_tr_b16 v[52:53], v16 offset:8192
    ds_read_b64_tr_b16 v[54:55], v16 offset:8704
    ds_read_b64_tr_b16 v[56:57], v17 offset:8192
    ds_read_b64_tr_b16 v[58:59], v17 offset:8704
    s_waitcnt lgkmcnt(0)
    v_mfma_f32_16x16x32_bf16 v[112:115], v[92:95], v[28:31], 0
    v_mfma_f32_16x16x32_bf16 v[116:119], v[92:95], v[32:35], 0
    v_mfma_f32_16x16x32_bf16 v[120:123], v[92:95], v[36:39], 0
    v_mfma_f32_16x16x32_bf16 v[124:127], v[92:95], v[40:43], 0
    v_mfma_f32_16x16x32_bf16 v[112:115], v[96:99], v[44:47], v[112:115]
    v_mfma_f32_16x16x32_bf16 v[116:119], v[96:99], v[48:51], v[116:119]
    v_mfma_f32_16x16x32_bf16 v[120:123], v[96:99], v[52:55], v[120:123]
    v_mfma_f32_16x16x32_bf16 v[124:127], v[96:99], v[56:59], v[124:127]
    s_nop 5
    v_cndmask_b32 v100, v112, v116, s[72:73]
    v_cndmask_b32 v100, v100, v120, s[74:75]
    v_cndmask_b32 v100, v100, v124, s[76:77]
    v_cndmask_b32 v102, v113, v117, s[72:73]
    v_cndmask_b32 v102, v102, v121, s[74:75]
    v_cndmask_b32 v102, v102, v125, s[76:77]
    buffer_store_dwordx4 v[100:103], v13, s[28:31], s37 offen sc1
    s_sub_u32 s36, s3, 4
    s_cmp_ge_u32 s36, 2
    s_cbranch_scc1 Laux_end
    s_add_u32 s37, s37, 4096
    ds_read_b64_tr_b16 v[60:61], v14 offset:12288
    ds_read_b64_tr_b16 v[62:63], v14 offset:12800
    ds_read_b64_tr_b16 v[64:65], v15 offset:12288
    ds_read_b64_tr_b16 v[66:67], v15 offset:12800
    ds_read_b64_tr_b16 v[68:69], v16 offset:12288
    ds_read_b64_tr_b16 v[70:71], v16 offset:12800
    ds_read_b64_tr_b16 v[72:73], v17 offset:12288
    ds_read_b64_tr_b16 v[74:75], v17 offset:12800
    ds_read_b64_tr_b16 v[76:77], v14 offset:0
    ds_read_b64_tr_b16 v[78:79], v14 offset:512
    ds_read_b64_tr_b16 v[80:81], v15 offset:0
    ds_read_b64_tr_b16 v[82:83], v15 offset:512
    ds_read_b64_tr_b16 v[84:85], v16 offset:0
    ds_read_b64_tr_b16 v[86:87], v16 offset:512
    ds_read_b64_tr_b16 v[88:89], v17 offset:0
    ds_read_b64_tr_b16 v[90:91], v17 offset:512
    s_waitcnt lgkmcnt(0)
    v_mfma_f32_16x16x32_bf16 v[112:115], v[92:95], v[60:63], 0
    v_mfma_f32_16x16x32_bf16 v[116:119], v[92:95], v[64:67], 0
    v_mfma_f32_16x16x32_bf16 v[120:123], v[92:95], v[68:71], 0
    v_mfma_f32_16x16x32_bf16 v[124:127], v[92:95], v[72:75], 0
    v_mfma_f32_16x16x32_bf16 v[112:115], v[96:99], v[76:79], v[112:115]
    v_mfma_f32_16x16x32_bf16 v[116:119], v[96:99], v[80:83], v[116:119]
    v_mfma_f32_16x16x32_bf16 v[120:123], v[96:99], v[84:87], v[120:123]
    v_mfma_f32_16x16x32_bf16 v[124:127], v[96:99], v[88:91], v[124:127]
    s_nop 5
    v_cndmask_b32 v100, v112, v116, s[72:73]
    v_cndmask_b32 v100, v100, v120, s[74:75]
    v_cndmask_b32 v100, v100, v124, s[76:77]
    v_cndmask_b32 v102, v113, v117, s[72:73]
    v_cndmask_b32 v102, v102, v121, s[74:75]
    v_cndmask_b32 v102, v102, v125, s[76:77]
    buffer_store_dwordx4 v[100:103], v13, s[28:31], s37 offen sc1
Laux_end:
    s_endpgm
Lmst:
    s_cmp_lg_u32 s3, 0
    s_cbranch_scc1 Lhelp_i
    s_waitcnt lgkmcnt(0)
    s_mov_b64 s[28:29], s[24:25]
    s_mov_b32 s30, 268435456
    s_mov_b32 s31, 0x20000
    s_load_dword s34, s[28:29], 0
    s_waitcnt lgkmcnt(0)
    s_add_u32 s34, s34, 0x9e3779b8
    s_or_b32 s34, s34, 1
    s_mov_b64 exec, 1
    s_lshl_b32 s36, s2, 2
    s_add_u32 s36, s36, 8323072
    v_mov_b32 v4, s34
    v_mov_b32 v5, s36
    buffer_store_dword v4, v5, s[28:31], 0 offen sc1
    s_mov_b64 exec, -1
    s_cmp_lg_u32 s32, 32
    s_cbranch_scc1 Lend
Lmst_bc:
    v_and_b32 v4, 31, v1
    v_lshlrev_b32 v4, 7, v4
    v_add_u32 v4, 8126464, v4
Lpt_15:
    s_sub_u32 s35, s35, 1
    s_cbranch_scc1 Lend
    s_sleep 8
    buffer_load_dwordx4 v[8:11], v4, s[28:31], 0 offen sc1
    s_waitcnt vmcnt(0)
    v_cmp_ne_u32 vcc, s34, v9
    v_cmp_ne_u32 s[36:37], s34, v11
    s_nop 0
    s_or_b64 s[36:37], s[36:37], vcc
    s_cbranch_scc1 Lpt_15
    v_mov_b32 v4, v8
    s_nop 1
    v_max_u32_dpp v4, v4, v4 row_ror:8 row_mask:0xf bank_mask:0xf
    s_nop 1
    v_max_u32_dpp v4, v4, v4 row_ror:4 row_mask:0xf bank_mask:0xf
    s_nop 1
    v_max_u32_dpp v4, v4, v4 row_ror:2 row_mask:0xf bank_mask:0xf
    s_nop 1
    v_max_u32_dpp v4, v4, v4 row_ror:1 row_mask:0xf bank_mask:0xf
    s_nop 0
    v_readlane_b32 s40, v4, 0
    v_readlane_b32 s36, v4, 16
    v_readlane_b32 s37, v4, 32
    v_readlane_b32 s38, v4, 48
    s_max_u32 s40, s40, s36
    s_max_u32 s37, s37, s38
    s_max_u32 s40, s40, s37
    v_cmp_eq_u32 vcc, s40, v8
    s_nop 1
    v_cndmask_b32 v4, v8, v10, vcc
    s_nop 1
    v_max_u32_dpp v4, v4, v4 row_ror:8 row_mask:0xf bank_mask:0xf
    s_nop 1
    v_max_u32_dpp v4, v4, v4 row_ror:4 row_mask:0xf bank_mask:0xf
    s_nop 1
    v_max_u32_dpp v4, v4, v4 row_ror:2 row_mask:0xf bank_mask:0xf
    s_nop 1
    v_max_u32_dpp v4, v4, v4 row_ror:1 row_mask:0xf bank_mask:0xf
    s_nop 0
    v_readlane_b32 s41, v4, 0
    v_readlane_b32 s36, v4, 16
    v_readlane_b32 s37, v4, 32
    v_readlane_b32 s38, v4, 48
    s_max_u32 s41, s41, s36
    s_max_u32 s37, s37, s38
    s_max_u32 s41, s41, s37
    v_mov_b32 v8, s40
    v_mov_b32 v9, s34
    v_mov_b32 v10, s41
    v_mov_b32 v11, s34
    s_mov_b32 s36, 8257536
    buffer_store_dwordx4 v[8:11], v13, s[28:31], s36 offen offset:0 sc1
    buffer_store_dwordx4 v[8:11], v13, s[28:31], s36 offen offset:1024 sc1
    buffer_store_dwordx4 v[8:11], v13, s[28:31], s36 offen offset:2048 sc1
    s_mov_b32 s36, 8323072
Lmaster:
    s_sub_u32 s35, s35, 1
    s_cbranch_scc1 Lend
    s_sleep 16
    buffer_load_dwordx4 v[4:7], v13, s[28:31], s36 offen sc1
    s_waitcnt vmcnt(0)
    v_xor_b32 v4, s34, v4
    v_xor_b32 v5, s34, v5
    v_xor_b32 v6, s34, v6
    v_xor_b32 v7, s34, v7
    v_or3_b32 v4, v4, v5, v6
    v_or_b32 v4, v4, v7
    v_cmp_ne_u32 vcc, 0, v4
    s_nop 0
    s_cbranch_vccnz Lmaster
    s_mov_b64 exec, 1
    buffer_store_dword v9, v4, s[28:31], 0 offen sc1
    s_endpgm
Lhelp_r:
    s_add_u32 s72, s32, 0
    s_mov_b32 s73, 5
    s_mov_b32 s37, 4
    s_branch Lhelp
Lhelp_i:
    s_cmp_eq_u32 s32, 32
    s_cbranch_scc1 Lend
    s_cmp_eq_u32 s27, 0
    s_cbranch_scc1 Lend
    s_sub_u32 s72, s32, 33
    s_mov_b32 s73, 3
    s_mov_b32 s37, 9
Lhelp:
    s_lshl_b32 s38, s26, 6
    v_add_u32 v4, s38, v1
    v_mul_u32_u24 v4, 1280, v4
    s_waitcnt lgkmcnt(0)
    s_mov_b64 s[68:69], s[18:19]
    s_mov_b32 s70, 2211840
    s_mov_b32 s71, 0x20000
Lhelp2:
    s_mul_i32 s38, s72, 9363
    s_lshr_b32 s38, s38, 16
    s_mul_i32 s39, s38, 7
    s_sub_u32 s39, s72, s39
    s_mul_i32 s39, s39, 327680
    s_lshl_b32 s38, s38, 7
    s_sub_u32 s39, s39, s38
    s_add_u32 s39, s39, 1152
    v_add_u32 v6, s39, v4
    buffer_load_dword v5, v6, s[68:71], 0 offen
    s_add_u32 s72, s72, s73
    s_sub_u32 s37, s37, 1
    s_cmp_lg_u32 s37, 0
    s_cbranch_scc1 Lhelp2
Lend:
    s_endpgm
.section .rodata,"a"
.p2align 6
.amdhsa_kernel recurrent_scan__sliding_local_dilated__moe_arch_mod__prompt_kernel
  .amdhsa_next_free_vgpr 256
  .amdhsa_next_free_sgpr 102
  .amdhsa_accum_offset 128
  .amdhsa_group_segment_fixed_size 0
  .amdhsa_kernarg_size 88
  .amdhsa_user_sgpr_count 2
  .amdhsa_user_sgpr_kernarg_segment_ptr 1
  .amdhsa_system_sgpr_workgroup_id_x 1
  .amdhsa_float_denorm_mode_32 3
.end_amdhsa_kernel
```

```asm
; @launch grid=(256,1,1) block=(512,1,1) lds=163840
.amdgcn_target "amdgcn-amd-amdhsa--gfx950"
.text
.globl recurrent_scan__sliding_local_dilated__moe_arch_mod__prompt_kernel
.p2align 8
.type recurrent_scan__sliding_local_dilated__moe_arch_mod__prompt_kernel,@function
recurrent_scan__sliding_local_dilated__moe_arch_mod__prompt_kernel:
    s_load_dwordx16 s[4:19], s[0:1], 0
    s_load_dwordx4 s[20:23], s[0:1], 64
    s_load_dwordx2 s[24:25], s[0:1], 80
    v_lshrrev_b32 v4, 6, v0
    v_and_b32 v1, 63, v0
    s_cmp_ge_u32 s2, 256
    s_cbranch_scc1 Lend
    v_readfirstlane_b32 s3, v4
    s_getpc_b64 s[36:37]
Lpc:
    s_and_b32 s38, s2, 0xf8
    v_add_u32 v5, s38, v4
    v_and_b32 v6, 1, v0
    v_lshl_add_u32 v5, v5, 1, v6
    v_lshlrev_b32 v5, 7, v5
    v_min_u32 v5, Lend-Lpc, v5
    v_mov_b32 v7, s37
    v_add_co_u32 v6, vcc, s36, v5
    s_nop 1
    v_addc_co_u32 v7, vcc, 0, v7, vcc
    global_load_dword v0, v[6:7], off
    v_lshrrev_b32 v2, 4, v1
    v_and_b32 v3, 15, v1
    v_lshlrev_b32 v12, 2, v1
    v_lshlrev_b32 v13, 4, v1
    s_mov_b32 s35, 2000000
    s_and_b32 s36, s2, 7
    s_lshr_b32 s37, s2, 3
    s_and_b32 s38, s36, 1
    s_lshr_b32 s36, s36, 1
    s_add_u32 s39, s38, 4
    s_and_b32 s26, s3, 3
    s_lshr_b32 s27, s3, 2
    s_cmp_lt_u32 s37, s39
    s_cbranch_scc1 Laux
    s_lshr_b32 s33, s36, 1
    s_and_b32 s36, s36, 1
    s_mul_i32 s36, s36, 55
    s_mul_i32 s38, s38, 28
    s_add_u32 s36, s36, s38
    s_add_u32 s36, s36, s37
    s_sub_u32 s36, s36, s39
    s_mul_i32 s32, s36, 13108
    s_lshr_b32 s32, s32, 16
    s_mul_i32 s37, s32, 5
    s_sub_u32 s36, s36, s37
    s_mul_i32 s33, s33, 5
    s_add_u32 s33, s33, s36
    s_add_u32 s42, s33, s32
    s_mul_i32 s36, s42, 13108
    s_lshr_b32 s36, s36, 16
    s_mul_i32 s36, s36, 5
    s_sub_u32 s42, s42, s36
    s_and_b32 s43, s2, 7
    s_lshr_b32 s43, 0, s43
    s_and_b32 s43, s43, 1
    s_cmp_lg_u32 s3, 0
    s_cbranch_scc1 Lcomp
Lloader:
    s_setprio 3
    v_lshrrev_b32 v5, 3, v1
    v_and_b32 v6, 7, v1
    v_and_b32 v8, 1, v2
    v_lshlrev_b32 v8, 1, v8
    v_xor_b32 v8, v8, v6
    s_lshl_b32 s39, s33, 7
    v_lshl_add_u32 v50, v8, 4, s39
    v_mov_b32 v7, 3840
    v_mad_u32_u24 v28, v5, v7, v50
    v_xor_b32 v29, 64, v28
    v_add_u32 v29, 29696, v29
    v_add_u32 v30, 59392, v28
    v_add_u32 v31, 59392, v29
    v_add_u32 v32, 122880, v28
    v_add_u32 v33, 122880, v29
    v_add_u32 v34, 182272, v28
    v_add_u32 v35, 182272, v29
    s_lshl_b32 s79, s42, 2
    s_lshr_b32 s79, 0x86420, s79
    s_and_b32 s79, s79, 15
    s_xor_b32 s79, s79, s43
    s_mul_i32 s68, s79, 245760
    s_lshl_b32 s78, s79, 7
    s_waitcnt lgkmcnt(0)
    s_mov_b64 s[48:49], s[6:7]
    s_mov_b32 s50, 2457600
    s_mov_b32 s51, 0x20000
    s_add_u32 s52, s6, 1280
    s_addc_u32 s53, s7, 0
    s_mov_b32 s54, 2456320
    s_mov_b32 s55, 0x20000
    s_add_u32 s56, s6, 2560
    s_addc_u32 s57, s7, 0
    s_mov_b32 s58, 2455040
    s_mov_b32 s59, 0x20000
    s_mov_b32 m0, 0
    s_mul_i32 s38, s32, 96
    s_sub_u32 s38, s38, 16
    v_add_u32 v7, s38, v5
    buffer_load_dwordx4 v28, s[48:51], s68 offen lds
    v_xor_b32 v9, v6, v2
    v_lshlrev_b32 v9, 4, v9
    buffer_load_dwordx4 v29, s[48:51], s68 offen offset:1024 lds
    v_xor_b32 v10, 64, v9
    v_mov_b32 v11, 2052
    buffer_load_dwordx4 v30, s[48:51], s68 offen offset:2048 lds
    v_mov_b32 v8, 1280
    v_add_u32 v36, 0, v7
    buffer_load_dwordx4 v31, s[48:51], s68 offen offset:3072 lds
    v_med3_i32 v36, v36, 0, v11
    v_mad_u32_u24 v36, v36, v8, v9
    s_mov_b32 m0, 8192
    v_add_u32 v36, 4096, v36
    v_add_u32 v37, 8, v7
    buffer_load_dwordx4 v28, s[52:55], s68 offen lds
    v_med3_i32 v37, v37, 0, v11
    v_mad_u32_u24 v37, v37, v8, v10
    v_add_u32 v37, 3072, v37
    buffer_load_dwordx4 v29, s[52:55], s68 offen offset:1024 lds
    v_add_u32 v38, 16, v7
    v_med3_i32 v38, v38, 0, v11
    buffer_load_dwordx4 v30, s[52:55], s68 offen offset:2048 lds
    v_mad_u32_u24 v38, v38, v8, v9
    v_add_u32 v38, 2048, v38
    buffer_load_dwordx4 v31, s[52:55], s68 offen offset:3072 lds
    v_add_u32 v39, 24, v7
    v_med3_i32 v39, v39, 0, v11
    s_mov_b32 m0, 16384
    v_mad_u32_u24 v39, v39, v8, v10
    v_add_u32 v39, 1024, v39
    buffer_load_dwordx4 v28, s[56:59], s68 offen lds
    v_add_u32 v40, 32, v7
    v_med3_i32 v40, v40, 0, v11
    buffer_load_dwordx4 v29, s[56:59], s68 offen offset:1024 lds
    v_mad_u32_u24 v40, v40, v8, v9
    v_add_u32 v40, 4096, v40
    v_add_u32 v41, 40, v7
    buffer_load_dwordx4 v30, s[56:59], s68 offen offset:2048 lds
    v_med3_i32 v41, v41, 0, v11
    v_mad_u32_u24 v41, v41, v8, v10
    buffer_load_dwordx4 v31, s[56:59], s68 offen offset:3072 lds
    v_add_u32 v41, 3072, v41
    v_add_u32 v42, 48, v7
    s_mov_b32 m0, 4096
    v_med3_i32 v42, v42, 0, v11
    v_mad_u32_u24 v42, v42, v8, v9
    buffer_load_dwordx4 v32, s[48:51], s68 offen lds
    v_add_u32 v42, 2048, v42
    v_add_u32 v43, 56, v7
    buffer_load_dwordx4 v33, s[48:51], s68 offen offset:1024 lds
    v_med3_i32 v43, v43, 0, v11
    v_mad_u32_u24 v43, v43, v8, v10
    buffer_load_dwordx4 v34, s[48:51], s68 offen offset:2048 lds
    v_add_u32 v43, 1024, v43
    v_add_u32 v44, 64, v7
    v_med3_i32 v44, v44, 0, v11
    buffer_load_dwordx4 v35, s[48:51], s68 offen offset:3072 lds
    v_mad_u32_u24 v44, v44, v8, v9
    v_add_u32 v44, 4096, v44
    s_mov_b32 m0, 12288
    v_add_u32 v45, 72, v7
    v_med3_i32 v45, v45, 0, v11
    buffer_load_dwordx4 v32, s[52:55], s68 offen lds
    v_mad_u32_u24 v45, v45, v8, v10
    v_add_u32 v45, 3072, v45
    buffer_load_dwordx4 v33, s[52:55], s68 offen offset:1024 lds
    v_add_u32 v46, 80, v7
    v_med3_i32 v46, v46, 0, v11
    buffer_load_dwordx4 v34, s[52:55], s68 offen offset:2048 lds
    v_mad_u32_u24 v46, v46, v8, v9
    v_add_u32 v46, 2048, v46
    buffer_load_dwordx4 v35, s[52:55], s68 offen offset:3072 lds
    v_add_u32 v47, 88, v7
    v_med3_i32 v47, v47, 0, v11
    v_mad_u32_u24 v47, v47, v8, v10
    s_mov_b32 m0, 20480
    v_add_u32 v47, 1024, v47
    v_add_u32 v48, 96, v7
    buffer_load_dwordx4 v32, s[56:59], s68 offen lds
    v_med3_i32 v48, v48, 0, v11
    v_mad_u32_u24 v48, v48, v8, v9
    buffer_load_dwordx4 v33, s[56:59], s68 offen offset:1024 lds
    v_add_u32 v48, 4096, v48
    v_add_u32 v49, 104, v7
    buffer_load_dwordx4 v34, s[56:59], s68 offen offset:2048 lds
    v_med3_i32 v49, v49, 0, v11
    v_mad_u32_u24 v49, v49, v8, v10
    buffer_load_dwordx4 v35, s[56:59], s68 offen offset:3072 lds
    v_add_u32 v49, 3072, v49
    s_sub_u32 s44, s4, 4096
    s_subb_u32 s45, s5, 0
    s_mov_b32 s46, 2625536
    s_mov_b32 s47, 0x20000
    s_mov_b32 m0, 24576
    s_nop 0
    buffer_load_dwordx4 v36, s[44:47], s78 offen lds
    buffer_load_dwordx4 v37, s[44:47], s78 offen offset:1024 lds
    buffer_load_dwordx4 v38, s[44:47], s78 offen offset:2048 lds
    buffer_load_dwordx4 v39, s[44:47], s78 offen offset:3072 lds
    s_mov_b32 m0, 28672
    s_nop 0
    buffer_load_dwordx4 v40, s[44:47], s78 offen lds
    buffer_load_dwordx4 v41, s[44:47], s78 offen offset:1024 lds
    buffer_load_dwordx4 v42, s[44:47], s78 offen offset:2048 lds
    buffer_load_dwordx4 v43, s[44:47], s78 offen offset:3072 lds
    s_mov_b32 m0, 32768
    s_nop 0
    buffer_load_dwordx4 v44, s[44:47], s78 offen lds
    buffer_load_dwordx4 v45, s[44:47], s78 offen offset:1024 lds
    buffer_load_dwordx4 v46, s[44:47], s78 offen offset:2048 lds
    buffer_load_dwordx4 v47, s[44:47], s78 offen offset:3072 lds
    s_mov_b32 m0, 36864
    s_nop 0
    buffer_load_dwordx4 v48, s[44:47], s78 offen lds
    buffer_load_dwordx4 v49, s[44:47], s78 offen offset:1024 lds
    s_mov_b32 s80, 0x53864210
    s_mov_b32 s81, 0x97
    s_cmp_eq_u32 s42, 1
    s_cselect_b32 s80, 0x51086342, s80
    s_cselect_b32 s81, 0x97, s81
    s_cmp_eq_u32 s42, 2
    s_cselect_b32 s80, 0x31205864, s80
    s_cselect_b32 s81, 0x97, s81
    s_cmp_eq_u32 s42, 3
    s_cselect_b32 s80, 0x31472086, s80
    s_cselect_b32 s81, 0x95, s81
    s_cmp_eq_u32 s42, 4
    s_cselect_b32 s80, 0x31964208, s80
    s_cselect_b32 s81, 0x75, s81
    s_lshr_b64 s[80:81], s[80:81], 4
    s_and_b32 s79, s80, 15
    s_xor_b32 s79, s79, s43
    s_mov_b64 s[28:29], s[24:25]
    s_mov_b32 s30, 268435456
    s_mov_b32 s31, 0x20000
    s_load_dword s34, s[28:29], 0
    s_mov_b64 s[60:61], s[8:9]
    s_mov_b32 s62, 819200
    s_mov_b32 s63, 0x20000
    v_mov_b32 v51, 157984
    v_and_b32 v66, 7, v1
    v_max_u32 v66, 1, v66
    v_lshlrev_b32 v66, 2, v66
    v_add_u32 v66, 158016, v66
    s_mul_i32 s69, s79, 245760
    s_lshl_b32 s78, s79, 7
    s_mov_b32 m0, 63616
    s_nop 0
    buffer_load_dwordx4 v36, s[44:47], s78 offen lds
    buffer_load_dwordx4 v37, s[44:47], s78 offen offset:1024 lds
    buffer_load_dwordx4 v38, s[44:47], s78 offen offset:2048 lds
    buffer_load_dwordx4 v39, s[44:47], s78 offen offset:3072 lds
    s_mov_b32 m0, 39040
    s_nop 0
    buffer_load_dwordx4 v28, s[48:51], s69 offen lds
    buffer_load_dwordx4 v29, s[48:51], s69 offen offset:1024 lds
    buffer_load_dwordx4 v30, s[48:51], s69 offen offset:2048 lds
    buffer_load_dwordx4 v31, s[48:51], s69 offen offset:3072 lds
    s_mov_b32 m0, 67712
    s_nop 0
    buffer_load_dwordx4 v40, s[44:47], s78 offen lds
    buffer_load_dwordx4 v41, s[44:47], s78 offen offset:1024 lds
    buffer_load_dwordx4 v42, s[44:47], s78 offen offset:2048 lds
    buffer_load_dwordx4 v43, s[44:47], s78 offen offset:3072 lds
    s_mov_b32 m0, 47232
    s_nop 0
    buffer_load_dwordx4 v28, s[52:55], s69 offen lds
    buffer_load_dwordx4 v29, s[52:55], s69 offen offset:1024 lds
    buffer_load_dwordx4 v30, s[52:55], s69 offen offset:2048 lds
    buffer_load_dwordx4 v31, s[52:55], s69 offen offset:3072 lds
    s_mov_b32 m0, 71808
    s_nop 0
    buffer_load_dwordx4 v44, s[44:47], s78 offen lds
    buffer_load_dwordx4 v45, s[44:47], s78 offen offset:1024 lds
    buffer_load_dwordx4 v46, s[44:47], s78 offen offset:2048 lds
    buffer_load_dwordx4 v47, s[44:47], s78 offen offset:3072 lds
    s_mov_b32 m0, 55424
    s_nop 0
    buffer_load_dwordx4 v28, s[56:59], s69 offen lds
    buffer_load_dwordx4 v29, s[56:59], s69 offen offset:1024 lds
    buffer_load_dwordx4 v30, s[56:59], s69 offen offset:2048 lds
    buffer_load_dwordx4 v31, s[56:59], s69 offen offset:3072 lds
    s_mov_b32 m0, 75904
    s_nop 0
    buffer_load_dwordx4 v48, s[44:47], s78 offen lds
    s_waitcnt vmcnt(55)
    buffer_load_dwordx4 v49, s[44:47], s78 offen offset:1024 lds
    s_mov_b32 m0, 43136
    s_nop 0
    buffer_load_dwordx4 v32, s[48:51], s69 offen lds
    buffer_load_dwordx4 v33, s[48:51], s69 offen offset:1024 lds
    buffer_load_dwordx4 v34, s[48:51], s69 offen offset:2048 lds
    buffer_load_dwordx4 v35, s[48:51], s69 offen offset:3072 lds
    s_mov_b32 m0, 51328
    s_nop 0
    buffer_load_dwordx4 v32, s[52:55], s69 offen lds
    buffer_load_dwordx4 v33, s[52:55], s69 offen offset:1024 lds
    buffer_load_dwordx4 v34, s[52:55], s69 offen offset:2048 lds
    s_waitcnt vmcnt(55)
    buffer_load_dwordx4 v35, s[52:55], s69 offen offset:3072 lds
    s_mov_b32 m0, 59520
    s_nop 0
    buffer_load_dwordx4 v32, s[56:59], s69 offen lds
    buffer_load_dwordx4 v33, s[56:59], s69 offen offset:1024 lds
    buffer_load_dwordx4 v34, s[56:59], s69 offen offset:2048 lds
    buffer_load_dwordx4 v35, s[56:59], s69 offen offset:3072 lds
    s_waitcnt vmcnt(38) lgkmcnt(0)
    s_barrier
    s_add_u32 s34, s34, 0x9e3779b8
    s_or_b32 s34, s34, 1
    s_lshr_b64 s[80:81], s[80:81], 4
    s_and_b32 s79, s80, 15
    s_xor_b32 s79, s79, s43
    s_mul_i32 s70, s79, 245760
    s_lshl_b32 s78, s79, 7
    s_mov_b32 m0, 102656
    s_nop 0
    buffer_load_dwordx4 v36, s[44:47], s78 offen lds
    buffer_load_dwordx4 v37, s[44:47], s78 offen offset:1024 lds
    buffer_load_dwordx4 v38, s[44:47], s78 offen offset:2048 lds
    buffer_load_dwordx4 v39, s[44:47], s78 offen offset:3072 lds
    s_mov_b32 m0, 78080
    s_nop 0
    buffer_load_dwordx4 v28, s[48:51], s70 offen lds
    buffer_load_dwordx4 v29, s[48:51], s70 offen offset:1024 lds
    buffer_load_dwordx4 v30, s[48:51], s70 offen offset:2048 lds
    buffer_load_dwordx4 v31, s[48:51], s70 offen offset:3072 lds
    s_mov_b32 m0, 106752
    s_nop 0
    buffer_load_dwordx4 v40, s[44:47], s78 offen lds
    buffer_load_dwordx4 v41, s[44:47], s78 offen offset:1024 lds
    buffer_load_dwordx4 v42, s[44:47], s78 offen offset:2048 lds
    buffer_load_dwordx4 v43, s[44:47], s78 offen offset:3072 lds
    s_mov_b32 m0, 86272
    s_nop 0
    buffer_load_dwordx4 v28, s[52:55], s70 offen lds
    buffer_load_dwordx4 v29, s[52:55], s70 offen offset:1024 lds
    buffer_load_dwordx4 v30, s[52:55], s70 offen offset:2048 lds
    buffer_load_dwordx4 v31, s[52:55], s70 offen offset:3072 lds
    s_mov_b32 m0, 110848
    s_nop 0
    buffer_load_dwordx4 v44, s[44:47], s78 offen lds
    buffer_load_dwordx4 v45, s[44:47], s78 offen offset:1024 lds
    buffer_load_dwordx4 v46, s[44:47], s78 offen offset:2048 lds
    buffer_load_dwordx4 v47, s[44:47], s78 offen offset:3072 lds
    s_mov_b32 m0, 94464
    s_nop 0
    buffer_load_dwordx4 v28, s[56:59], s70 offen lds
    buffer_load_dwordx4 v29, s[56:59], s70 offen offset:1024 lds
    buffer_load_dwordx4 v30, s[56:59], s70 offen offset:2048 lds
    buffer_load_dwordx4 v31, s[56:59], s70 offen offset:3072 lds
    s_mov_b32 m0, 114944
    s_nop 0
    buffer_load_dwordx4 v48, s[44:47], s78 offen lds
    s_waitcnt vmcnt(55)
    buffer_load_dwordx4 v49, s[44:47], s78 offen offset:1024 lds
    s_mov_b32 m0, 82176
    s_nop 0
    buffer_load_dwordx4 v32, s[48:51], s70 offen lds
    buffer_load_dwordx4 v33, s[48:51], s70 offen offset:1024 lds
    buffer_load_dwordx4 v34, s[48:51], s70 offen offset:2048 lds
    buffer_load_dwordx4 v35, s[48:51], s70 offen offset:3072 lds
    s_mov_b32 m0, 90368
    s_nop 0
    buffer_load_dwordx4 v32, s[52:55], s70 offen lds
    buffer_load_dwordx4 v33, s[52:55], s70 offen offset:1024 lds
    buffer_load_dwordx4 v34, s[52:55], s70 offen offset:2048 lds
    s_waitcnt vmcnt(55)
    buffer_load_dwordx4 v35, s[52:55], s70 offen offset:3072 lds
    s_mov_b32 m0, 98560
    s_nop 0
    buffer_load_dwordx4 v32, s[56:59], s70 offen lds
    buffer_load_dwordx4 v33, s[56:59], s70 offen offset:1024 lds
    buffer_load_dwordx4 v34, s[56:59], s70 offen offset:2048 lds
    buffer_load_dwordx4 v35, s[56:59], s70 offen offset:3072 lds
    s_waitcnt vmcnt(38) lgkmcnt(0)
    s_barrier
    s_lshr_b64 s[80:81], s[80:81], 4
    s_and_b32 s79, s80, 15
    s_xor_b32 s79, s79, s43
    s_mul_i32 s71, s79, 245760
    s_lshl_b32 s78, s79, 7
    s_mov_b32 m0, 141696
    s_nop 0
    buffer_load_dwordx4 v36, s[44:47], s78 offen lds
    buffer_load_dwordx4 v37, s[44:47], s78 offen offset:1024 lds
    buffer_load_dwordx4 v38, s[44:47], s78 offen offset:2048 lds
    buffer_load_dwordx4 v39, s[44:47], s78 offen offset:3072 lds
    s_mov_b32 m0, 117120
    s_nop 0
    buffer_load_dwordx4 v28, s[48:51], s71 offen lds
    buffer_load_dwordx4 v29, s[48:51], s71 offen offset:1024 lds
    buffer_load_dwordx4 v30, s[48:51], s71 offen offset:2048 lds
    buffer_load_dwordx4 v31, s[48:51], s71 offen offset:3072 lds
    s_mov_b32 m0, 145792
    s_nop 0
    buffer_load_dwordx4 v40, s[44:47], s78 offen lds
    buffer_load_dwordx4 v41, s[44:47], s78 offen offset:1024 lds
    buffer_load_dwordx4 v42, s[44:47], s78 offen offset:2048 lds
    buffer_load_dwordx4 v43, s[44:47], s78 offen offset:3072 lds
    s_mov_b32 m0, 125312
    s_nop 0
    buffer_load_dwordx4 v28, s[52:55], s71 offen lds
    buffer_load_dwordx4 v29, s[52:55], s71 offen offset:1024 lds
    buffer_load_dwordx4 v30, s[52:55], s71 offen offset:2048 lds
    buffer_load_dwordx4 v31, s[52:55], s71 offen offset:3072 lds
    s_mov_b32 m0, 149888
    s_nop 0
    buffer_load_dwordx4 v44, s[44:47], s78 offen lds
    buffer_load_dwordx4 v45, s[44:47], s78 offen offset:1024 lds
    buffer_load_dwordx4 v46, s[44:47], s78 offen offset:2048 lds
    buffer_load_dwordx4 v47, s[44:47], s78 offen offset:3072 lds
    s_mov_b32 m0, 133504
    s_nop 0
    buffer_load_dwordx4 v28, s[56:59], s71 offen lds
    buffer_load_dwordx4 v29, s[56:59], s71 offen offset:1024 lds
    buffer_load_dwordx4 v30, s[56:59], s71 offen offset:2048 lds
    buffer_load_dwordx4 v31, s[56:59], s71 offen offset:3072 lds
    s_mov_b32 m0, 153984
    s_nop 0
    buffer_load_dwordx4 v48, s[44:47], s78 offen lds
    s_waitcnt vmcnt(55)
    buffer_load_dwordx4 v49, s[44:47], s78 offen offset:1024 lds
    s_mov_b32 m0, 121216
    s_nop 0
    buffer_load_dwordx4 v32, s[48:51], s71 offen lds
    buffer_load_dwordx4 v33, s[48:51], s71 offen offset:1024 lds
    buffer_load_dwordx4 v34, s[48:51], s71 offen offset:2048 lds
    buffer_load_dwordx4 v35, s[48:51], s71 offen offset:3072 lds
    s_mov_b32 m0, 129408
    s_nop 0
    buffer_load_dwordx4 v32, s[52:55], s71 offen lds
    buffer_load_dwordx4 v33, s[52:55], s71 offen offset:1024 lds
    buffer_load_dwordx4 v34, s[52:55], s71 offen offset:2048 lds
    s_waitcnt vmcnt(55)
    buffer_load_dwordx4 v35, s[52:55], s71 offen offset:3072 lds
    s_mov_b32 m0, 137600
    s_nop 0
    buffer_load_dwordx4 v32, s[56:59], s71 offen lds
    buffer_load_dwordx4 v33, s[56:59], s71 offen offset:1024 lds
    buffer_load_dwordx4 v34, s[56:59], s71 offen offset:2048 lds
    buffer_load_dwordx4 v35, s[56:59], s71 offen offset:3072 lds
    s_waitcnt vmcnt(38) lgkmcnt(0)
    s_barrier
    s_lshr_b64 s[80:81], s[80:81], 4
    s_and_b32 s79, s80, 15
    s_xor_b32 s79, s79, s43
    s_mul_i32 s72, s79, 245760
    s_lshl_b32 s78, s79, 7
    s_mov_b32 m0, 24576
    s_nop 0
    buffer_load_dwordx4 v36, s[44:47], s78 offen lds
    buffer_load_dwordx4 v37, s[44:47], s78 offen offset:1024 lds
    buffer_load_dwordx4 v38, s[44:47], s78 offen offset:2048 lds
    buffer_load_dwordx4 v39, s[44:47], s78 offen offset:3072 lds
    s_mov_b32 m0, 0
    s_nop 0
    buffer_load_dwordx4 v28, s[48:51], s72 offen lds
    buffer_load_dwordx4 v29, s[48:51], s72 offen offset:1024 lds
    buffer_load_dwordx4 v30, s[48:51], s72 offen offset:2048 lds
    buffer_load_dwordx4 v31, s[48:51], s72 offen offset:3072 lds
    s_mov_b32 m0, 28672
    s_nop 0
    buffer_load_dwordx4 v40, s[44:47], s78 offen lds
    buffer_load_dwordx4 v41, s[44:47], s78 offen offset:1024 lds
    buffer_load_dwordx4 v42, s[44:47], s78 offen offset:2048 lds
    buffer_load_dwordx4 v43, s[44:47], s78 offen offset:3072 lds
    s_mov_b32 m0, 8192
    s_nop 0
    buffer_load_dwordx4 v28, s[52:55], s72 offen lds
    buffer_load_dwordx4 v29, s[52:55], s72 offen offset:1024 lds
    buffer_load_dwordx4 v30, s[52:55], s72 offen offset:2048 lds
    buffer_load_dwordx4 v31, s[52:55], s72 offen offset:3072 lds
    s_mov_b32 m0, 32768
    s_nop 0
    buffer_load_dwordx4 v44, s[44:47], s78 offen lds
    buffer_load_dwordx4 v45, s[44:47], s78 offen offset:1024 lds
    buffer_load_dwordx4 v46, s[44:47], s78 offen offset:2048 lds
    buffer_load_dwordx4 v47, s[44:47], s78 offen offset:3072 lds
    s_mov_b32 m0, 16384
    s_nop 0
    buffer_load_dwordx4 v28, s[56:59], s72 offen lds
    buffer_load_dwordx4 v29, s[56:59], s72 offen offset:1024 lds
    buffer_load_dwordx4 v30, s[56:59], s72 offen offset:2048 lds
    buffer_load_dwordx4 v31, s[56:59], s72 offen offset:3072 lds
    s_mov_b32 m0, 36864
    s_nop 0
    buffer_load_dwordx4 v48, s[44:47], s78 offen lds
    s_waitcnt vmcnt(55)
    buffer_load_dwordx4 v49, s[44:47], s78 offen offset:1024 lds
    s_mov_b32 m0, 4096
    s_nop 0
    buffer_load_dwordx4 v32, s[48:51], s72 offen lds
    buffer_load_dwordx4 v33, s[48:51], s72 offen offset:1024 lds
    buffer_load_dwordx4 v34, s[48:51], s72 offen offset:2048 lds
    buffer_load_dwordx4 v35, s[48:51], s72 offen offset:3072 lds
    s_mov_b32 m0, 12288
    s_nop 0
    buffer_load_dwordx4 v32, s[52:55], s72 offen lds
    buffer_load_dwordx4 v33, s[52:55], s72 offen offset:1024 lds
    buffer_load_dwordx4 v34, s[52:55], s72 offen offset:2048 lds
    s_waitcnt vmcnt(55)
    buffer_load_dwordx4 v35, s[52:55], s72 offen offset:3072 lds
    s_mov_b32 m0, 20480
    s_nop 0
    buffer_load_dwordx4 v32, s[56:59], s72 offen lds
    buffer_load_dwordx4 v33, s[56:59], s72 offen offset:1024 lds
    buffer_load_dwordx4 v34, s[56:59], s72 offen offset:2048 lds
    buffer_load_dwordx4 v35, s[56:59], s72 offen offset:3072 lds
    s_waitcnt vmcnt(38) lgkmcnt(0)
    s_barrier
    s_lshr_b64 s[80:81], s[80:81], 4
    s_and_b32 s79, s80, 15
    s_xor_b32 s79, s79, s43
    s_mul_i32 s73, s79, 245760
    s_lshl_b32 s78, s79, 7
    s_mov_b32 m0, 63616
    s_nop 0
    buffer_load_dwordx4 v36, s[44:47], s78 offen lds
    buffer_load_dwordx4 v37, s[44:47], s78 offen offset:1024 lds
    buffer_load_dwordx4 v38, s[44:47], s78 offen offset:2048 lds
    buffer_load_dwordx4 v39, s[44:47], s78 offen offset:3072 lds
    s_mov_b32 m0, 39040
    s_nop 0
    buffer_load_dwordx4 v28, s[48:51], s73 offen lds
    buffer_load_dwordx4 v29, s[48:51], s73 offen offset:1024 lds
    buffer_load_dwordx4 v30, s[48:51], s73 offen offset:2048 lds
    buffer_load_dwordx4 v31, s[48:51], s73 offen offset:3072 lds
    s_mov_b32 m0, 67712
    s_nop 0
    buffer_load_dwordx4 v40, s[44:47], s78 offen lds
    buffer_load_dwordx4 v41, s[44:47], s78 offen offset:1024 lds
    buffer_load_dwordx4 v42, s[44:47], s78 offen offset:2048 lds
    buffer_load_dwordx4 v43, s[44:47], s78 offen offset:3072 lds
    s_mov_b32 m0, 47232
    s_nop 0
    buffer_load_dwordx4 v28, s[52:55], s73 offen lds
    buffer_load_dwordx4 v29, s[52:55], s73 offen offset:1024 lds
    buffer_load_dwordx4 v30, s[52:55], s73 offen offset:2048 lds
    buffer_load_dwordx4 v31, s[52:55], s73 offen offset:3072 lds
    s_mov_b32 m0, 71808
    s_nop 0
    buffer_load_dwordx4 v44, s[44:47], s78 offen lds
    buffer_load_dwordx4 v45, s[44:47], s78 offen offset:1024 lds
    buffer_load_dwordx4 v46, s[44:47], s78 offen offset:2048 lds
    buffer_load_dwordx4 v47, s[44:47], s78 offen offset:3072 lds
    s_mov_b32 m0, 55424
    s_nop 0
    buffer_load_dwordx4 v28, s[56:59], s73 offen lds
    buffer_load_dwordx4 v29, s[56:59], s73 offen offset:1024 lds
    buffer_load_dwordx4 v30, s[56:59], s73 offen offset:2048 lds
    buffer_load_dwordx4 v31, s[56:59], s73 offen offset:3072 lds
    s_mov_b32 m0, 75904
    s_nop 0
    buffer_load_dwordx4 v48, s[44:47], s78 offen lds
    s_waitcnt vmcnt(55)
    buffer_load_dwordx4 v49, s[44:47], s78 offen offset:1024 lds
    s_mov_b32 m0, 43136
    s_nop 0
    buffer_load_dwordx4 v32, s[48:51], s73 offen lds
    buffer_load_dwordx4 v33, s[48:51], s73 offen offset:1024 lds
    buffer_load_dwordx4 v34, s[48:51], s73 offen offset:2048 lds
    buffer_load_dwordx4 v35, s[48:51], s73 offen offset:3072 lds
    s_mov_b32 m0, 51328
    s_nop 0
    buffer_load_dwordx4 v32, s[52:55], s73 offen lds
    buffer_load_dwordx4 v33, s[52:55], s73 offen offset:1024 lds
    buffer_load_dwordx4 v34, s[52:55], s73 offen offset:2048 lds
    s_waitcnt vmcnt(55)
    buffer_load_dwordx4 v35, s[52:55], s73 offen offset:3072 lds
    s_mov_b32 m0, 59520
    s_nop 0
    buffer_load_dwordx4 v32, s[56:59], s73 offen lds
    buffer_load_dwordx4 v33, s[56:59], s73 offen offset:1024 lds
    buffer_load_dwordx4 v34, s[56:59], s73 offen offset:2048 lds
    buffer_load_dwordx4 v35, s[56:59], s73 offen offset:3072 lds
    s_waitcnt vmcnt(38) lgkmcnt(0)
    s_barrier
    s_lshr_b64 s[80:81], s[80:81], 4
    s_and_b32 s79, s80, 15
    s_xor_b32 s79, s79, s43
    s_mul_i32 s74, s79, 245760
    s_lshl_b32 s78, s79, 7
    s_mov_b32 m0, 102656
    s_nop 0
    buffer_load_dwordx4 v36, s[44:47], s78 offen lds
    buffer_load_dwordx4 v37, s[44:47], s78 offen offset:1024 lds
    buffer_load_dwordx4 v38, s[44:47], s78 offen offset:2048 lds
    buffer_load_dwordx4 v39, s[44:47], s78 offen offset:3072 lds
    s_mov_b32 m0, 78080
    s_nop 0
    buffer_load_dwordx4 v28, s[48:51], s74 offen lds
    buffer_load_dwordx4 v29, s[48:51], s74 offen offset:1024 lds
    buffer_load_dwordx4 v30, s[48:51], s74 offen offset:2048 lds
    buffer_load_dwordx4 v31, s[48:51], s74 offen offset:3072 lds
    s_mov_b32 m0, 106752
    s_nop 0
    buffer_load_dwordx4 v40, s[44:47], s78 offen lds
    buffer_load_dwordx4 v41, s[44:47], s78 offen offset:1024 lds
    buffer_load_dwordx4 v42, s[44:47], s78 offen offset:2048 lds
    buffer_load_dwordx4 v43, s[44:47], s78 offen offset:3072 lds
    s_mov_b32 m0, 86272
    s_nop 0
    buffer_load_dwordx4 v28, s[52:55], s74 offen lds
    buffer_load_dwordx4 v29, s[52:55], s74 offen offset:1024 lds
    buffer_load_dwordx4 v30, s[52:55], s74 offen offset:2048 lds
    buffer_load_dwordx4 v31, s[52:55], s74 offen offset:3072 lds
    s_mov_b32 m0, 110848
    s_nop 0
    buffer_load_dwordx4 v44, s[44:47], s78 offen lds
    buffer_load_dwordx4 v45, s[44:47], s78 offen offset:1024 lds
    buffer_load_dwordx4 v46, s[44:47], s78 offen offset:2048 lds
    buffer_load_dwordx4 v47, s[44:47], s78 offen offset:3072 lds
    s_mov_b32 m0, 82176
    s_nop 0
    buffer_load_dwordx4 v32, s[48:51], s74 offen lds
    buffer_load_dwordx4 v33, s[48:51], s74 offen offset:1024 lds
    buffer_load_dwordx4 v34, s[48:51], s74 offen offset:2048 lds
    buffer_load_dwordx4 v35, s[48:51], s74 offen offset:3072 lds
    s_mov_b32 m0, 114944
    s_nop 0
    buffer_load_dwordx4 v48, s[44:47], s78 offen lds
    s_waitcnt vmcnt(55)
    buffer_load_dwordx4 v49, s[44:47], s78 offen offset:1024 lds
    s_mov_b32 m0, 90368
    s_nop 0
    buffer_load_dwordx4 v32, s[52:55], s74 offen lds
    buffer_load_dwordx4 v33, s[52:55], s74 offen offset:1024 lds
    buffer_load_dwordx4 v34, s[52:55], s74 offen offset:2048 lds
    buffer_load_dwordx4 v35, s[52:55], s74 offen offset:3072 lds
    s_waitcnt vmcnt(30) lgkmcnt(0)
    s_barrier
    s_lshr_b64 s[80:81], s[80:81], 4
    s_and_b32 s79, s80, 15
    s_xor_b32 s79, s79, s43
    s_mul_i32 s75, s79, 245760
    s_lshl_b32 s78, s79, 7
    s_mov_b32 m0, 141696
    s_nop 0
    buffer_load_dwordx4 v36, s[44:47], s78 offen lds
    buffer_load_dwordx4 v37, s[44:47], s78 offen offset:1024 lds
    buffer_load_dwordx4 v38, s[44:47], s78 offen offset:2048 lds
    buffer_load_dwordx4 v39, s[44:47], s78 offen offset:3072 lds
    s_mov_b32 m0, 117120
    s_nop 0
    buffer_load_dwordx4 v28, s[48:51], s75 offen lds
    buffer_load_dwordx4 v29, s[48:51], s75 offen offset:1024 lds
    buffer_load_dwordx4 v30, s[48:51], s75 offen offset:2048 lds
    buffer_load_dwordx4 v31, s[48:51], s75 offen offset:3072 lds
    s_mov_b32 m0, 145792
    s_nop 0
    buffer_load_dwordx4 v40, s[44:47], s78 offen lds
    buffer_load_dwordx4 v41, s[44:47], s78 offen offset:1024 lds
    buffer_load_dwordx4 v42, s[44:47], s78 offen offset:2048 lds
    buffer_load_dwordx4 v43, s[44:47], s78 offen offset:3072 lds
    s_mov_b32 m0, 125312
    s_nop 0
    buffer_load_dwordx4 v28, s[52:55], s75 offen lds
    buffer_load_dwordx4 v29, s[52:55], s75 offen offset:1024 lds
    buffer_load_dwordx4 v30, s[52:55], s75 offen offset:2048 lds
    buffer_load_dwordx4 v31, s[52:55], s75 offen offset:3072 lds
    s_mov_b32 m0, 149888
    s_nop 0
    buffer_load_dwordx4 v44, s[44:47], s78 offen lds
    buffer_load_dwordx4 v45, s[44:47], s78 offen offset:1024 lds
    buffer_load_dwordx4 v46, s[44:47], s78 offen offset:2048 lds
    buffer_load_dwordx4 v47, s[44:47], s78 offen offset:3072 lds
    s_mov_b32 m0, 121216
    s_nop 0
    buffer_load_dwordx4 v32, s[48:51], s75 offen lds
    buffer_load_dwordx4 v33, s[48:51], s75 offen offset:1024 lds
    buffer_load_dwordx4 v34, s[48:51], s75 offen offset:2048 lds
    buffer_load_dwordx4 v35, s[48:51], s75 offen offset:3072 lds
    s_mov_b32 m0, 153984
    s_nop 0
    buffer_load_dwordx4 v48, s[44:47], s78 offen lds
    buffer_load_dwordx4 v49, s[44:47], s78 offen offset:1024 lds
    s_mov_b32 m0, 129408
    s_nop 0
    buffer_load_dwordx4 v32, s[52:55], s75 offen lds
    buffer_load_dwordx4 v33, s[52:55], s75 offen offset:1024 lds
    buffer_load_dwordx4 v34, s[52:55], s75 offen offset:2048 lds
    buffer_load_dwordx4 v35, s[52:55], s75 offen offset:3072 lds
    s_waitcnt vmcnt(30) lgkmcnt(0)
    s_barrier
    s_lshr_b64 s[80:81], s[80:81], 4
    s_and_b32 s79, s80, 15
    s_xor_b32 s79, s79, s43
    s_mul_i32 s76, s79, 245760
    s_lshl_b32 s78, s79, 7
    s_mov_b32 m0, 24576
    s_nop 0
    buffer_load_dwordx4 v36, s[44:47], s78 offen lds
    buffer_load_dwordx4 v37, s[44:47], s78 offen offset:1024 lds
    buffer_load_dwordx4 v38, s[44:47], s78 offen offset:2048 lds
    buffer_load_dwordx4 v39, s[44:47], s78 offen offset:3072 lds
    s_mov_b32 m0, 0
    s_nop 0
    buffer_load_dwordx4 v28, s[48:51], s76 offen lds
    buffer_load_dwordx4 v29, s[48:51], s76 offen offset:1024 lds
    buffer_load_dwordx4 v30, s[48:51], s76 offen offset:2048 lds
    buffer_load_dwordx4 v31, s[48:51], s76 offen offset:3072 lds
    s_mov_b32 m0, 28672
    s_nop 0
    buffer_load_dwordx4 v40, s[44:47], s78 offen lds
    buffer_load_dwordx4 v41, s[44:47], s78 offen offset:1024 lds
    buffer_load_dwordx4 v42, s[44:47], s78 offen offset:2048 lds
    buffer_load_dwordx4 v43, s[44:47], s78 offen offset:3072 lds
    s_mov_b32 m0, 8192
    s_nop 0
    buffer_load_dwordx4 v28, s[52:55], s76 offen lds
    buffer_load_dwordx4 v29, s[52:55], s76 offen offset:1024 lds
    buffer_load_dwordx4 v30, s[52:55], s76 offen offset:2048 lds
    buffer_load_dwordx4 v31, s[52:55], s76 offen offset:3072 lds
    s_mov_b32 m0, 32768
    s_nop 0
    buffer_load_dwordx4 v44, s[44:47], s78 offen lds
    buffer_load_dwordx4 v45, s[44:47], s78 offen offset:1024 lds
    buffer_load_dwordx4 v46, s[44:47], s78 offen offset:2048 lds
    buffer_load_dwordx4 v47, s[44:47], s78 offen offset:3072 lds
    s_mov_b32 m0, 4096
    s_nop 0
    buffer_load_dwordx4 v32, s[48:51], s76 offen lds
    buffer_load_dwordx4 v33, s[48:51], s76 offen offset:1024 lds
    buffer_load_dwordx4 v34, s[48:51], s76 offen offset:2048 lds
    buffer_load_dwordx4 v35, s[48:51], s76 offen offset:3072 lds
    s_mov_b32 m0, 36864
    s_nop 0
    buffer_load_dwordx4 v48, s[44:47], s78 offen lds
    buffer_load_dwordx4 v49, s[44:47], s78 offen offset:1024 lds
    s_mov_b32 m0, 12288
    s_nop 0
    buffer_load_dwordx4 v32, s[52:55], s76 offen lds
    buffer_load_dwordx4 v33, s[52:55], s76 offen offset:1024 lds
    buffer_load_dwordx4 v34, s[52:55], s76 offen offset:2048 lds
    buffer_load_dwordx4 v35, s[52:55], s76 offen offset:3072 lds
    s_waitcnt vmcnt(30) lgkmcnt(0)
    s_barrier
    s_lshr_b64 s[80:81], s[80:81], 4
    s_and_b32 s79, s80, 15
    s_xor_b32 s79, s79, s43
    s_mul_i32 s77, s79, 245760
    s_lshl_b32 s78, s79, 7
    s_mov_b32 m0, 63616
    s_nop 0
    buffer_load_dwordx4 v36, s[44:47], s78 offen lds
    buffer_load_dwordx4 v37, s[44:47], s78 offen offset:1024 lds
    buffer_load_dwordx4 v38, s[44:47], s78 offen offset:2048 lds
    buffer_load_dwordx4 v39, s[44:47], s78 offen offset:3072 lds
    s_mov_b32 m0, 39040
    s_nop 0
    buffer_load_dwordx4 v28, s[48:51], s77 offen lds
    buffer_load_dwordx4 v29, s[48:51], s77 offen offset:1024 lds
    buffer_load_dwordx4 v30, s[48:51], s77 offen offset:2048 lds
    buffer_load_dwordx4 v31, s[48:51], s77 offen offset:3072 lds
    s_mov_b32 m0, 67712
    s_nop 0
    buffer_load_dwordx4 v40, s[44:47], s78 offen lds
    buffer_load_dwordx4 v41, s[44:47], s78 offen offset:1024 lds
    buffer_load_dwordx4 v42, s[44:47], s78 offen offset:2048 lds
    buffer_load_dwordx4 v43, s[44:47], s78 offen offset:3072 lds
    s_mov_b32 m0, 47232
    s_nop 0
    buffer_load_dwordx4 v28, s[52:55], s77 offen lds
    buffer_load_dwordx4 v29, s[52:55], s77 offen offset:1024 lds
    buffer_load_dwordx4 v30, s[52:55], s77 offen offset:2048 lds
    buffer_load_dwordx4 v31, s[52:55], s77 offen offset:3072 lds
    s_mov_b32 m0, 71808
    s_nop 0
    buffer_load_dwordx4 v44, s[44:47], s78 offen lds
    buffer_load_dwordx4 v45, s[44:47], s78 offen offset:1024 lds
    buffer_load_dwordx4 v46, s[44:47], s78 offen offset:2048 lds
    buffer_load_dwordx4 v47, s[44:47], s78 offen offset:3072 lds
    s_mov_b32 m0, 43136
    s_nop 0
    buffer_load_dwordx4 v32, s[48:51], s77 offen lds
    buffer_load_dwordx4 v33, s[48:51], s77 offen offset:1024 lds
    buffer_load_dwordx4 v34, s[48:51], s77 offen offset:2048 lds
    buffer_load_dwordx4 v35, s[48:51], s77 offen offset:3072 lds
    s_mov_b32 m0, 75904
    s_nop 0
    buffer_load_dwordx4 v48, s[44:47], s78 offen lds
    buffer_load_dwordx4 v49, s[44:47], s78 offen offset:1024 lds
    s_mov_b32 m0, 51328
    s_nop 0
    buffer_load_dwordx4 v32, s[52:55], s77 offen lds
    buffer_load_dwordx4 v33, s[52:55], s77 offen offset:1024 lds
    buffer_load_dwordx4 v34, s[52:55], s77 offen offset:2048 lds
    buffer_load_dwordx4 v35, s[52:55], s77 offen offset:3072 lds
    s_waitcnt vmcnt(30) lgkmcnt(0)
    s_barrier
    s_lshr_b64 s[80:81], s[80:81], 4
    s_and_b32 s79, s80, 15
    s_xor_b32 s79, s79, s43
    s_mov_b32 m0, 94464
    s_nop 0
    buffer_load_dwordx4 v28, s[56:59], s74 offen lds
    buffer_load_dwordx4 v29, s[56:59], s74 offen offset:1024 lds
    buffer_load_dwordx4 v30, s[56:59], s74 offen offset:2048 lds
    buffer_load_dwordx4 v31, s[56:59], s74 offen offset:3072 lds
    s_mov_b32 m0, 98560
    s_nop 0
    buffer_load_dwordx4 v32, s[56:59], s74 offen lds
    buffer_load_dwordx4 v33, s[56:59], s74 offen offset:1024 lds
    buffer_load_dwordx4 v34, s[56:59], s74 offen offset:2048 lds
    buffer_load_dwordx4 v35, s[56:59], s74 offen offset:3072 lds
    s_mov_b32 m0, 133504
    s_nop 0
    buffer_load_dwordx4 v28, s[56:59], s75 offen lds
    buffer_load_dwordx4 v29, s[56:59], s75 offen offset:1024 lds
    buffer_load_dwordx4 v30, s[56:59], s75 offen offset:2048 lds
    buffer_load_dwordx4 v31, s[56:59], s75 offen offset:3072 lds
    s_waitcnt vmcnt(12) lgkmcnt(0)
    s_barrier
    s_mov_b32 m0, 137600
    s_nop 0
    buffer_load_dwordx4 v32, s[56:59], s75 offen lds
    buffer_load_dwordx4 v33, s[56:59], s75 offen offset:1024 lds
    buffer_load_dwordx4 v34, s[56:59], s75 offen offset:2048 lds
    buffer_load_dwordx4 v35, s[56:59], s75 offen offset:3072 lds
    s_mov_b32 m0, 16384
    s_nop 0
    buffer_load_dwordx4 v28, s[56:59], s76 offen lds
    buffer_load_dwordx4 v29, s[56:59], s76 offen offset:1024 lds
    buffer_load_dwordx4 v30, s[56:59], s76 offen offset:2048 lds
    buffer_load_dwordx4 v31, s[56:59], s76 offen offset:3072 lds
    s_mov_b32 m0, 20480
    s_nop 0
    buffer_load_dwordx4 v32, s[56:59], s76 offen lds
    buffer_load_dwordx4 v33, s[56:59], s76 offen offset:1024 lds
    buffer_load_dwordx4 v34, s[56:59], s76 offen offset:2048 lds
    buffer_load_dwordx4 v35, s[56:59], s76 offen offset:3072 lds
    s_mov_b32 m0, 55424
    s_nop 0
    buffer_load_dwordx4 v28, s[56:59], s77 offen lds
    buffer_load_dwordx4 v29, s[56:59], s77 offen offset:1024 lds
    buffer_load_dwordx4 v30, s[56:59], s77 offen offset:2048 lds
    buffer_load_dwordx4 v31, s[56:59], s77 offen offset:3072 lds
    s_mov_b32 m0, 59520
    s_nop 0
    buffer_load_dwordx4 v32, s[56:59], s77 offen lds
    buffer_load_dwordx4 v33, s[56:59], s77 offen offset:1024 lds
    buffer_load_dwordx4 v34, s[56:59], s77 offen offset:2048 lds
    buffer_load_dwordx4 v35, s[56:59], s77 offen offset:3072 lds
    s_mov_b32 s10, 20480
    v_lshrrev_b32 v52, 5, v1
    v_lshlrev_b32 v52, 3, v52
    v_add_u32 v53, 2, v52
    v_add_u32 v54, 4, v52
    v_add_u32 v55, 6, v52
    v_add_u32 v56, 16, v52
    v_add_u32 v57, 18, v52
    v_add_u32 v58, 20, v52
    v_add_u32 v59, 22, v52
    v_and_b32 v7, 3, v5
    v_mul_u32_u24 v7, 1280, v7
    v_add_u32 v60, v7, v50
    v_xor_b32 v61, 64, v60
    v_add_u32 v61, 4096, v61
    v_add_u32 v62, 8192, v60
    v_add_u32 v63, 8192, v61
    s_mov_b32 s5, 0xbfe10856
    s_mov_b32 s6, 0xaff80255
    s_mov_b32 s7, 0xabfe4015
    s_mov_b32 s8, 0xaa7fd005
    s_mov_b32 s9, 0x6adfb401
    s_cmp_eq_u32 s42, 1
    s_cselect_b32 s5, 0xabfe4015, s5
    s_cselect_b32 s6, 0xaa7fd005, s6
    s_cselect_b32 s7, 0x6adfb401, s7
    s_cselect_b32 s8, 0xbfe10856, s8
    s_cselect_b32 s9, 0xaff80255, s9
    s_cmp_eq_u32 s42, 2
    s_cselect_b32 s5, 0x6adfb401, s5
    s_cselect_b32 s6, 0xbfe10856, s6
    s_cselect_b32 s7, 0xaff80255, s7
    s_cselect_b32 s8, 0xabfe4015, s8
    s_cselect_b32 s9, 0xaa7fd005, s9
    s_cmp_eq_u32 s42, 3
    s_cselect_b32 s5, 0xaff80255, s5
    s_cselect_b32 s6, 0xabfe4015, s6
    s_cselect_b32 s7, 0xaa7fd005, s7
    s_cselect_b32 s8, 0x6adfb401, s8
    s_cselect_b32 s9, 0xbfe10856, s9
    s_cmp_eq_u32 s42, 4
    s_cselect_b32 s5, 0xaa7fd005, s5
    s_cselect_b32 s6, 0x6adfb401, s6
    s_cselect_b32 s7, 0xbfe10856, s7
    s_cselect_b32 s8, 0xaff80255, s8
    s_cselect_b32 s9, 0xabfe4015, s9
    s_mul_i32 s4, s42, 163840
    s_mov_b32 m0, 0
    v_bfe_u32 v64, s5, v52, 2
    v_mad_u32_u24 v64, v64, s10, v60
    buffer_load_dwordx4 v64, s[60:63], s4 offen lds
    v_bfe_u32 v65, s5, v53, 2
    v_mad_u32_u24 v65, v65, s10, v61
    buffer_load_dwordx4 v65, s[60:63], s4 offen offset:1024 lds
    v_bfe_u32 v64, s5, v54, 2
    v_mad_u32_u24 v64, v64, s10, v62
    buffer_load_dwordx4 v64, s[60:63], s4 offen offset:2048 lds
    v_bfe_u32 v65, s5, v55, 2
    v_mad_u32_u24 v65, v65, s10, v63
    buffer_load_dwordx4 v65, s[60:63], s4 offen offset:3072 lds
    s_mov_b32 m0, 4096
    v_bfe_u32 v64, s5, v56, 2
    v_mad_u32_u24 v64, v64, s10, v60
    buffer_load_dwordx4 v64, s[60:63], s4 offen lds
    v_bfe_u32 v65, s5, v57, 2
    v_mad_u32_u24 v65, v65, s10, v61
    buffer_load_dwordx4 v65, s[60:63], s4 offen offset:1024 lds
    v_bfe_u32 v64, s5, v58, 2
    v_mad_u32_u24 v64, v64, s10, v62
    buffer_load_dwordx4 v64, s[60:63], s4 offen offset:2048 lds
    v_bfe_u32 v65, s5, v59, 2
    v_mad_u32_u24 v65, v65, s10, v63
    buffer_load_dwordx4 v65, s[60:63], s4 offen offset:3072 lds
    s_add_u32 s4, s4, 81920
    s_cmp_eq_u32 s4, 819200
    s_cselect_b32 s4, 0, s4
    s_mov_b32 m0, 8192
    v_bfe_u32 v64, s6, v52, 2
    v_mad_u32_u24 v64, v64, s10, v60
    buffer_load_dwordx4 v64, s[60:63], s4 offen lds
    v_bfe_u32 v65, s6, v53, 2
    v_mad_u32_u24 v65, v65, s10, v61
    buffer_load_dwordx4 v65, s[60:63], s4 offen offset:1024 lds
    v_bfe_u32 v64, s6, v54, 2
    v_mad_u32_u24 v64, v64, s10, v62
    buffer_load_dwordx4 v64, s[60:63], s4 offen offset:2048 lds
    v_bfe_u32 v65, s6, v55, 2
    v_mad_u32_u24 v65, v65, s10, v63
    buffer_load_dwordx4 v65, s[60:63], s4 offen offset:3072 lds
    s_mov_b32 m0, 12288
    v_bfe_u32 v64, s6, v56, 2
    v_mad_u32_u24 v64, v64, s10, v60
    buffer_load_dwordx4 v64, s[60:63], s4 offen lds
    v_bfe_u32 v65, s6, v57, 2
    v_mad_u32_u24 v65, v65, s10, v61
    buffer_load_dwordx4 v65, s[60:63], s4 offen offset:1024 lds
    v_bfe_u32 v64, s6, v58, 2
    v_mad_u32_u24 v64, v64, s10, v62
    buffer_load_dwordx4 v64, s[60:63], s4 offen offset:2048 lds
    v_bfe_u32 v65, s6, v59, 2
    v_mad_u32_u24 v65, v65, s10, v63
    buffer_load_dwordx4 v65, s[60:63], s4 offen offset:3072 lds
    s_add_u32 s4, s4, 81920
    s_cmp_eq_u32 s4, 819200
    s_cselect_b32 s4, 0, s4
    s_waitcnt vmcnt(16)
    v_mov_b32 v5, 157980
    v_mov_b32 v6, 1
    s_mov_b64 exec, 1
    ds_add_u32 v5, v6
    s_mov_b64 exec, -1
    v_mov_b32 v5, 157972
    v_mov_b32 v6, 1
    s_mov_b64 exec, 1
    ds_add_u32 v5, v6
    s_mov_b64 exec, -1
    s_mov_b32 m0, 24576
    v_bfe_u32 v64, s7, v52, 2
    v_mad_u32_u24 v64, v64, s10, v60
    buffer_load_dwordx4 v64, s[60:63], s4 offen lds
    v_bfe_u32 v65, s7, v53, 2
    v_mad_u32_u24 v65, v65, s10, v61
    buffer_load_dwordx4 v65, s[60:63], s4 offen offset:1024 lds
    v_bfe_u32 v64, s7, v54, 2
    v_mad_u32_u24 v64, v64, s10, v62
    buffer_load_dwordx4 v64, s[60:63], s4 offen offset:2048 lds
    v_bfe_u32 v65, s7, v55, 2
    v_mad_u32_u24 v65, v65, s10, v63
    buffer_load_dwordx4 v65, s[60:63], s4 offen offset:3072 lds
    s_mov_b32 m0, 28672
    v_bfe_u32 v64, s7, v56, 2
    v_mad_u32_u24 v64, v64, s10, v60
    buffer_load_dwordx4 v64, s[60:63], s4 offen lds
    v_bfe_u32 v65, s7, v57, 2
    v_mad_u32_u24 v65, v65, s10, v61
    buffer_load_dwordx4 v65, s[60:63], s4 offen offset:1024 lds
    v_bfe_u32 v64, s7, v58, 2
    v_mad_u32_u24 v64, v64, s10, v62
    buffer_load_dwordx4 v64, s[60:63], s4 offen offset:2048 lds
    v_bfe_u32 v65, s7, v59, 2
    v_mad_u32_u24 v65, v65, s10, v63
    buffer_load_dwordx4 v65, s[60:63], s4 offen offset:3072 lds
    s_add_u32 s4, s4, 81920
    s_cmp_eq_u32 s4, 819200
    s_cselect_b32 s4, 0, s4
    s_mov_b32 m0, 123136
    v_bfe_u32 v64, s8, v52, 2
    v_mad_u32_u24 v64, v64, s10, v60
    buffer_load_dwordx4 v64, s[60:63], s4 offen lds
    v_bfe_u32 v65, s8, v53, 2
    v_mad_u32_u24 v65, v65, s10, v61
    buffer_load_dwordx4 v65, s[60:63], s4 offen offset:1024 lds
    v_bfe_u32 v64, s8, v54, 2
    v_mad_u32_u24 v64, v64, s10, v62
    buffer_load_dwordx4 v64, s[60:63], s4 offen offset:2048 lds
    v_bfe_u32 v65, s8, v55, 2
    v_mad_u32_u24 v65, v65, s10, v63
    buffer_load_dwordx4 v65, s[60:63], s4 offen offset:3072 lds
    s_mov_b32 m0, 127232
    v_bfe_u32 v64, s8, v56, 2
    v_mad_u32_u24 v64, v64, s10, v60
    buffer_load_dwordx4 v64, s[60:63], s4 offen lds
    v_bfe_u32 v65, s8, v57, 2
    v_mad_u32_u24 v65, v65, s10, v61
    buffer_load_dwordx4 v65, s[60:63], s4 offen offset:1024 lds
    v_bfe_u32 v64, s8, v58, 2
    v_mad_u32_u24 v64, v64, s10, v62
    buffer_load_dwordx4 v64, s[60:63], s4 offen offset:2048 lds
    v_bfe_u32 v65, s8, v59, 2
    v_mad_u32_u24 v65, v65, s10, v63
    buffer_load_dwordx4 v65, s[60:63], s4 offen offset:3072 lds
    s_add_u32 s4, s4, 81920
    s_cmp_eq_u32 s4, 819200
    s_cselect_b32 s4, 0, s4
    s_mov_b32 m0, 80000
    v_bfe_u32 v64, s9, v52, 2
    v_mad_u32_u24 v64, v64, s10, v60
    buffer_load_dwordx4 v64, s[60:63], s4 offen lds
    v_bfe_u32 v65, s9, v53, 2
    v_mad_u32_u24 v65, v65, s10, v61
    buffer_load_dwordx4 v65, s[60:63], s4 offen offset:1024 lds
    v_bfe_u32 v64, s9, v54, 2
    v_mad_u32_u24 v64, v64, s10, v62
    buffer_load_dwordx4 v64, s[60:63], s4 offen offset:2048 lds
    v_bfe_u32 v65, s9, v55, 2
    v_mad_u32_u24 v65, v65, s10, v63
    buffer_load_dwordx4 v65, s[60:63], s4 offen offset:3072 lds
    s_mov_b32 m0, 84096
    v_bfe_u32 v64, s9, v56, 2
    v_mad_u32_u24 v64, v64, s10, v60
    buffer_load_dwordx4 v64, s[60:63], s4 offen lds
    v_bfe_u32 v65, s9, v57, 2
    v_mad_u32_u24 v65, v65, s10, v61
    buffer_load_dwordx4 v65, s[60:63], s4 offen offset:1024 lds
    v_bfe_u32 v64, s9, v58, 2
    v_mad_u32_u24 v64, v64, s10, v62
    buffer_load_dwordx4 v64, s[60:63], s4 offen offset:2048 lds
    v_bfe_u32 v65, s9, v59, 2
    v_mad_u32_u24 v65, v65, s10, v63
    buffer_load_dwordx4 v65, s[60:63], s4 offen offset:3072 lds
    s_add_u32 s4, s4, 81920
    s_cmp_eq_u32 s4, 819200
    s_cselect_b32 s4, 0, s4
    s_waitcnt vmcnt(0)
    v_mov_b32 v7, 157980
    v_mov_b32 v6, 1
    s_mov_b64 exec, 1
    ds_add_u32 v7, v6
    s_mov_b64 exec, -1
Lcw_7:
    s_sub_u32 s35, s35, 1
    s_cbranch_scc1 Lend
    ds_read_b32 v6, v5
    s_waitcnt lgkmcnt(0)
    v_readfirstlane_b32 s38, v6
    s_nop 0
    s_cmp_lt_u32 s38, 8
    s_cbranch_scc1 Lcw_7
    s_lshl_b32 s36, s32, 7
    s_add_u32 s36, s36, 8257536
    v_mov_b32 v69, s36
    buffer_load_dwordx4 v[70:73], v69, s[28:31], 0 offen sc1
    v_mov_b32 v5, 157976
Lcw_8:
    s_sub_u32 s35, s35, 1
    s_cbranch_scc1 Lend
    ds_read_b32 v6, v5
    s_waitcnt lgkmcnt(0)
    v_readfirstlane_b32 s38, v6
    s_nop 0
    s_cmp_lt_u32 s38, 7
    s_cbranch_scc1 Lcw_8
    s_mov_b32 m0, 32768
    v_bfe_u32 v64, s5, v52, 2
    v_mad_u32_u24 v64, v64, s10, v60
    buffer_load_dwordx4 v64, s[60:63], s4 offen lds
    v_bfe_u32 v65, s5, v53, 2
    v_mad_u32_u24 v65, v65, s10, v61
    buffer_load_dwordx4 v65, s[60:63], s4 offen offset:1024 lds
    v_bfe_u32 v64, s5, v54, 2
    v_mad_u32_u24 v64, v64, s10, v62
    buffer_load_dwordx4 v64, s[60:63], s4 offen offset:2048 lds
    v_bfe_u32 v65, s5, v55, 2
    v_mad_u32_u24 v65, v65, s10, v63
    buffer_load_dwordx4 v65, s[60:63], s4 offen offset:3072 lds
    s_mov_b32 m0, 36864
    v_bfe_u32 v64, s5, v56, 2
    v_mad_u32_u24 v64, v64, s10, v60
    buffer_load_dwordx4 v64, s[60:63], s4 offen lds
    v_bfe_u32 v65, s5, v57, 2
    v_mad_u32_u24 v65, v65, s10, v61
    buffer_load_dwordx4 v65, s[60:63], s4 offen offset:1024 lds
    v_bfe_u32 v64, s5, v58, 2
    v_mad_u32_u24 v64, v64, s10, v62
    buffer_load_dwordx4 v64, s[60:63], s4 offen offset:2048 lds
    v_bfe_u32 v65, s5, v59, 2
    v_mad_u32_u24 v65, v65, s10, v63
    buffer_load_dwordx4 v65, s[60:63], s4 offen offset:3072 lds
    s_add_u32 s4, s4, 81920
    s_cmp_eq_u32 s4, 819200
    s_cselect_b32 s4, 0, s4
    s_mov_b32 m0, 40960
    v_bfe_u32 v64, s6, v52, 2
    v_mad_u32_u24 v64, v64, s10, v60
    buffer_load_dwordx4 v64, s[60:63], s4 offen lds
    v_bfe_u32 v65, s6, v53, 2
    v_mad_u32_u24 v65, v65, s10, v61
    buffer_load_dwordx4 v65, s[60:63], s4 offen offset:1024 lds
    v_bfe_u32 v64, s6, v54, 2
    v_mad_u32_u24 v64, v64, s10, v62
    buffer_load_dwordx4 v64, s[60:63], s4 offen offset:2048 lds
    v_bfe_u32 v65, s6, v55, 2
    v_mad_u32_u24 v65, v65, s10, v63
    buffer_load_dwordx4 v65, s[60:63], s4 offen offset:3072 lds
    s_mov_b32 m0, 45056
    v_bfe_u32 v64, s6, v56, 2
    v_mad_u32_u24 v64, v64, s10, v60
    buffer_load_dwordx4 v64, s[60:63], s4 offen lds
    v_bfe_u32 v65, s6, v57, 2
    v_mad_u32_u24 v65, v65, s10, v61
    buffer_load_dwordx4 v65, s[60:63], s4 offen offset:1024 lds
    v_bfe_u32 v64, s6, v58, 2
    v_mad_u32_u24 v64, v64, s10, v62
    buffer_load_dwordx4 v64, s[60:63], s4 offen offset:2048 lds
    v_bfe_u32 v65, s6, v59, 2
    v_mad_u32_u24 v65, v65, s10, v63
    buffer_load_dwordx4 v65, s[60:63], s4 offen offset:3072 lds
    s_add_u32 s4, s4, 81920
    s_cmp_eq_u32 s4, 819200
    s_cselect_b32 s4, 0, s4
    s_mov_b32 m0, 63616
    v_bfe_u32 v64, s7, v52, 2
    v_mad_u32_u24 v64, v64, s10, v60
    buffer_load_dwordx4 v64, s[60:63], s4 offen lds
    v_bfe_u32 v65, s7, v53, 2
    v_mad_u32_u24 v65, v65, s10, v61
    buffer_load_dwordx4 v65, s[60:63], s4 offen offset:1024 lds
    v_bfe_u32 v64, s7, v54, 2
    v_mad_u32_u24 v64, v64, s10, v62
    buffer_load_dwordx4 v64, s[60:63], s4 offen offset:2048 lds
    v_bfe_u32 v65, s7, v55, 2
    v_mad_u32_u24 v65, v65, s10, v63
    buffer_load_dwordx4 v65, s[60:63], s4 offen offset:3072 lds
    s_mov_b32 m0, 67712
    v_bfe_u32 v64, s7, v56, 2
    v_mad_u32_u24 v64, v64, s10, v60
    buffer_load_dwordx4 v64, s[60:63], s4 offen lds
    v_bfe_u32 v65, s7, v57, 2
    v_mad_u32_u24 v65, v65, s10, v61
    buffer_load_dwordx4 v65, s[60:63], s4 offen offset:1024 lds
    v_bfe_u32 v64, s7, v58, 2
    v_mad_u32_u24 v64, v64, s10, v62
    buffer_load_dwordx4 v64, s[60:63], s4 offen offset:2048 lds
    v_bfe_u32 v65, s7, v59, 2
    v_mad_u32_u24 v65, v65, s10, v63
    buffer_load_dwordx4 v65, s[60:63], s4 offen offset:3072 lds
    s_add_u32 s4, s4, 81920
    s_cmp_eq_u32 s4, 819200
    s_cselect_b32 s4, 0, s4
    s_mov_b32 m0, 71808
    v_bfe_u32 v64, s8, v52, 2
    v_mad_u32_u24 v64, v64, s10, v60
    buffer_load_dwordx4 v64, s[60:63], s4 offen lds
    v_bfe_u32 v65, s8, v53, 2
    v_mad_u32_u24 v65, v65, s10, v61
    buffer_load_dwordx4 v65, s[60:63], s4 offen offset:1024 lds
    v_bfe_u32 v64, s8, v54, 2
    v_mad_u32_u24 v64, v64, s10, v62
    buffer_load_dwordx4 v64, s[60:63], s4 offen offset:2048 lds
    v_bfe_u32 v65, s8, v55, 2
    v_mad_u32_u24 v65, v65, s10, v63
    buffer_load_dwordx4 v65, s[60:63], s4 offen offset:3072 lds
    s_mov_b32 m0, 75904
    v_bfe_u32 v64, s8, v56, 2
    v_mad_u32_u24 v64, v64, s10, v60
    buffer_load_dwordx4 v64, s[60:63], s4 offen lds
    v_bfe_u32 v65, s8, v57, 2
    v_mad_u32_u24 v65, v65, s10, v61
    buffer_load_dwordx4 v65, s[60:63], s4 offen offset:1024 lds
    v_bfe_u32 v64, s8, v58, 2
    v_mad_u32_u24 v64, v64, s10, v62
    buffer_load_dwordx4 v64, s[60:63], s4 offen offset:2048 lds
    v_bfe_u32 v65, s8, v59, 2
    v_mad_u32_u24 v65, v65, s10, v63
    buffer_load_dwordx4 v65, s[60:63], s4 offen offset:3072 lds
    s_add_u32 s4, s4, 81920
    s_cmp_eq_u32 s4, 819200
    s_cselect_b32 s4, 0, s4
    s_mov_b32 m0, 49152
    v_bfe_u32 v64, s9, v52, 2
    v_mad_u32_u24 v64, v64, s10, v60
    buffer_load_dwordx4 v64, s[60:63], s4 offen lds
    v_bfe_u32 v65, s9, v53, 2
    v_mad_u32_u24 v65, v65, s10, v61
    buffer_load_dwordx4 v65, s[60:63], s4 offen offset:1024 lds
    v_bfe_u32 v64, s9, v54, 2
    v_mad_u32_u24 v64, v64, s10, v62
    buffer_load_dwordx4 v64, s[60:63], s4 offen offset:2048 lds
    v_bfe_u32 v65, s9, v55, 2
    v_mad_u32_u24 v65, v65, s10, v63
    buffer_load_dwordx4 v65, s[60:63], s4 offen offset:3072 lds
    s_mov_b32 m0, 88192
    v_bfe_u32 v64, s9, v56, 2
    v_mad_u32_u24 v64, v64, s10, v60
    buffer_load_dwordx4 v64, s[60:63], s4 offen lds
    v_bfe_u32 v65, s9, v57, 2
    v_mad_u32_u24 v65, v65, s10, v61
    buffer_load_dwordx4 v65, s[60:63], s4 offen offset:1024 lds
    v_bfe_u32 v64, s9, v58, 2
    v_mad_u32_u24 v64, v64, s10, v62
    buffer_load_dwordx4 v64, s[60:63], s4 offen offset:2048 lds
    v_bfe_u32 v65, s9, v59, 2
    v_mad_u32_u24 v65, v65, s10, v63
    buffer_load_dwordx4 v65, s[60:63], s4 offen offset:3072 lds
    s_add_u32 s4, s4, 81920
    s_cmp_eq_u32 s4, 819200
    s_cselect_b32 s4, 0, s4
    s_waitcnt vmcnt(0)
Lbc:
    v_readfirstlane_b32 s11, v70
    v_readfirstlane_b32 s36, v71
    v_readfirstlane_b32 s12, v72
    v_readfirstlane_b32 s37, v73
    s_cmp_eq_u32 s36, s34
    s_cselect_b32 s37, s37, s36
    s_cmp_eq_u32 s37, s34
    s_cbranch_scc1 Lbc_ok
Lbc_re:
    s_sub_u32 s35, s35, 1
    s_cbranch_scc1 Lend
    buffer_load_dwordx4 v[70:73], v69, s[28:31], 0 offen sc1
    s_waitcnt vmcnt(0)
    s_branch Lbc
Lbc_ok:
    s_mul_i32 s36, s32, 96
    s_and_b32 s13, s11, 0x7ff
    s_sub_u32 s13, 2047, s13
    s_sub_u32 s37, s13, s36
    s_cmp_lt_u32 s37, 96
    s_cselect_b32 s13, s13, -1
    s_and_b32 s14, s12, 0x7ff
    s_sub_u32 s14, 2047, s14
    s_sub_u32 s37, s14, s36
    s_cmp_lt_u32 s37, 96
    s_cselect_b32 s14, s14, -1
    v_mov_b32 v4, s13
    v_mov_b32 v5, s14
    v_mov_b32 v6, 157960
    ds_write_b64 v6, v[4:5]
    s_and_b32 s37, s13, s14
    s_cmp_eq_u32 s37, -1
    s_cbranch_scc1 Lw0_done
    s_max_i32 s36, s13, 0
    s_mul_i32 s36, s36, 1280
    s_lshl_b32 s37, s33, 7
    s_add_u32 s36, s36, s37
    s_add_u32 s36, s36, 4096
    v_lshlrev_b32 v8, 1, v1
    buffer_load_ushort v124, v8, s[44:47], s36 offen
    s_max_i32 s36, s14, 0
    s_mul_i32 s36, s36, 1280
    s_lshl_b32 s37, s33, 7
    s_add_u32 s36, s36, s37
    s_add_u32 s36, s36, 4096
    v_lshlrev_b32 v8, 1, v1
    buffer_load_ushort v125, v8, s[44:47], s36 offen
    v_min_u32 v7, 26, v1
    v_mul_u32_u24 v7, 10240, v7
Ly_poll:
    s_sub_u32 s35, s35, 1
    s_cbranch_scc1 Lend
    s_sleep 4
    s_lshl_b32 s36, s33, 10
    s_add_u32 s36, s36, 7405568
    buffer_load_dword v4, v7, s[28:31], s36 offen offset:1020 sc1
    s_waitcnt vmcnt(0)
    v_cmp_ne_u32 vcc, s34, v4
    s_nop 0
    s_cbranch_vccnz Ly_poll
    buffer_load_dwordx4 v[16:19], v13, s[28:31], s36 offen sc1
    s_add_u32 s36, s36, 10240
    buffer_load_dwordx4 v[20:23], v13, s[28:31], s36 offen sc1
    s_add_u32 s36, s36, 10240
    buffer_load_dwordx4 v[24:27], v13, s[28:31], s36 offen sc1
    s_add_u32 s36, s36, 10240
    buffer_load_dwordx4 v[28:31], v13, s[28:31], s36 offen sc1
    s_add_u32 s36, s36, 10240
    buffer_load_dwordx4 v[32:35], v13, s[28:31], s36 offen sc1
    s_add_u32 s36, s36, 10240
    buffer_load_dwordx4 v[36:39], v13, s[28:31], s36 offen sc1
    s_add_u32 s36, s36, 10240
    buffer_load_dwordx4 v[40:43], v13, s[28:31], s36 offen sc1
    s_add_u32 s36, s36, 10240
    buffer_load_dwordx4 v[44:47], v13, s[28:31], s36 offen sc1
    s_add_u32 s36, s36, 10240
    buffer_load_dwordx4 v[48:51], v13, s[28:31], s36 offen sc1
    s_add_u32 s36, s36, 10240
    buffer_load_dwordx4 v[52:55], v13, s[28:31], s36 offen sc1
    s_add_u32 s36, s36, 10240
    buffer_load_dwordx4 v[56:59], v13, s[28:31], s36 offen sc1
    s_add_u32 s36, s36, 10240
    buffer_load_dwordx4 v[60:63], v13, s[28:31], s36 offen sc1
    s_add_u32 s36, s36, 10240
    buffer_load_dwordx4 v[64:67], v13, s[28:31], s36 offen sc1
    s_add_u32 s36, s36, 10240
    buffer_load_dwordx4 v[68:71], v13, s[28:31], s36 offen sc1
    s_add_u32 s36, s36, 10240
    buffer_load_dwordx4 v[72:75], v13, s[28:31], s36 offen sc1
    s_add_u32 s36, s36, 10240
    buffer_load_dwordx4 v[76:79], v13, s[28:31], s36 offen sc1
    s_add_u32 s36, s36, 10240
    buffer_load_dwordx4 v[80:83], v13, s[28:31], s36 offen sc1
    s_add_u32 s36, s36, 10240
    buffer_load_dwordx4 v[84:87], v13, s[28:31], s36 offen sc1
    s_add_u32 s36, s36, 10240
    buffer_load_dwordx4 v[88:91], v13, s[28:31], s36 offen sc1
    s_add_u32 s36, s36, 10240
    buffer_load_dwordx4 v[92:95], v13, s[28:31], s36 offen sc1
    s_add_u32 s36, s36, 10240
    buffer_load_dwordx4 v[96:99], v13, s[28:31], s36 offen sc1
    s_add_u32 s36, s36, 10240
    buffer_load_dwordx4 v[100:103], v13, s[28:31], s36 offen sc1
    s_add_u32 s36, s36, 10240
    buffer_load_dwordx4 v[104:107], v13, s[28:31], s36 offen sc1
    s_add_u32 s36, s36, 10240
    buffer_load_dwordx4 v[108:111], v13, s[28:31], s36 offen sc1
    s_add_u32 s36, s36, 10240
    buffer_load_dwordx4 v[112:115], v13, s[28:31], s36 offen sc1
    s_add_u32 s36, s36, 10240
    buffer_load_dwordx4 v[116:119], v13, s[28:31], s36 offen sc1
    s_add_u32 s36, s36, 10240
    buffer_load_dwordx4 v[120:123], v13, s[28:31], s36 offen sc1
    s_add_u32 s36, s36, 10240
    s_waitcnt vmcnt(0)
    v_xor_b32 v4, s34, v17
    v_xor_b32 v5, s34, v19
    v_or_b32 v4, v4, v5
    v_xor_b32 v5, s34, v21
    v_or_b32 v4, v4, v5
    v_xor_b32 v5, s34, v23
    v_or_b32 v4, v4, v5
    v_xor_b32 v5, s34, v25
    v_or_b32 v4, v4, v5
    v_xor_b32 v5, s34, v27
    v_or_b32 v4, v4, v5
    v_xor_b32 v5, s34, v29
    v_or_b32 v4, v4, v5
    v_xor_b32 v5, s34, v31
    v_or_b32 v4, v4, v5
    v_xor_b32 v5, s34, v33
    v_or_b32 v4, v4, v5
    v_xor_b32 v5, s34, v35
    v_or_b32 v4, v4, v5
    v_xor_b32 v5, s34, v37
    v_or_b32 v4, v4, v5
    v_xor_b32 v5, s34, v39
    v_or_b32 v4, v4, v5
    v_xor_b32 v5, s34, v41
    v_or_b32 v4, v4, v5
    v_xor_b32 v5, s34, v43
    v_or_b32 v4, v4, v5
    v_xor_b32 v5, s34, v45
    v_or_b32 v4, v4, v5
    v_xor_b32 v5, s34, v47
    v_or_b32 v4, v4, v5
    v_xor_b32 v5, s34, v49
    v_or_b32 v4, v4, v5
    v_xor_b32 v5, s34, v51
    v_or_b32 v4, v4, v5
    v_xor_b32 v5, s34, v53
    v_or_b32 v4, v4, v5
    v_xor_b32 v5, s34, v55
    v_or_b32 v4, v4, v5
    v_xor_b32 v5, s34, v57
    v_or_b32 v4, v4, v5
    v_xor_b32 v5, s34, v59
    v_or_b32 v4, v4, v5
    v_xor_b32 v5, s34, v61
    v_or_b32 v4, v4, v5
    v_xor_b32 v5, s34, v63
    v_or_b32 v4, v4, v5
    v_xor_b32 v5, s34, v65
    v_or_b32 v4, v4, v5
    v_xor_b32 v5, s34, v67
    v_or_b32 v4, v4, v5
    v_xor_b32 v5, s34, v69
    v_or_b32 v4, v4, v5
    v_xor_b32 v5, s34, v71
    v_or_b32 v4, v4, v5
    v_xor_b32 v5, s34, v73
    v_or_b32 v4, v4, v5
    v_xor_b32 v5, s34, v75
    v_or_b32 v4, v4, v5
    v_xor_b32 v5, s34, v77
    v_or_b32 v4, v4, v5
    v_xor_b32 v5, s34, v79
    v_or_b32 v4, v4, v5
    v_xor_b32 v5, s34, v81
    v_or_b32 v4, v4, v5
    v_xor_b32 v5, s34, v83
    v_or_b32 v4, v4, v5
    v_xor_b32 v5, s34, v85
    v_or_b32 v4, v4, v5
    v_xor_b32 v5, s34, v87
    v_or_b32 v4, v4, v5
    v_xor_b32 v5, s34, v89
    v_or_b32 v4, v4, v5
    v_xor_b32 v5, s34, v91
    v_or_b32 v4, v4, v5
    v_xor_b32 v5, s34, v93
    v_or_b32 v4, v4, v5
    v_xor_b32 v5, s34, v95
    v_or_b32 v4, v4, v5
    v_xor_b32 v5, s34, v97
    v_or_b32 v4, v4, v5
    v_xor_b32 v5, s34, v99
    v_or_b32 v4, v4, v5
    v_xor_b32 v5, s34, v101
    v_or_b32 v4, v4, v5
    v_xor_b32 v5, s34, v103
    v_or_b32 v4, v4, v5
    v_xor_b32 v5, s34, v105
    v_or_b32 v4, v4, v5
    v_xor_b32 v5, s34, v107
    v_or_b32 v4, v4, v5
    v_xor_b32 v5, s34, v109
    v_or_b32 v4, v4, v5
    v_xor_b32 v5, s34, v111
    v_or_b32 v4, v4, v5
    v_xor_b32 v5, s34, v113
    v_or_b32 v4, v4, v5
    v_xor_b32 v5, s34, v115
    v_or_b32 v4, v4, v5
    v_xor_b32 v5, s34, v117
    v_or_b32 v4, v4, v5
    v_xor_b32 v5, s34, v119
    v_or_b32 v4, v4, v5
    v_xor_b32 v5, s34, v121
    v_or_b32 v4, v4, v5
    v_xor_b32 v5, s34, v123
    v_or_b32 v4, v4, v5
    v_cmp_ne_u32 vcc, 0, v4
    s_nop 0
    s_cmp_lg_u64 vcc, 0
    s_cbranch_scc1 Ly_poll
    v_add_f32 v16, v16, v20
    v_add_f32 v18, v18, v22
    v_add_f32 v16, v16, v24
    v_add_f32 v18, v18, v26
    v_add_f32 v16, v16, v28
    v_add_f32 v18, v18, v30
    v_add_f32 v16, v16, v32
    v_add_f32 v18, v18, v34
    v_add_f32 v16, v16, v36
    v_add_f32 v18, v18, v38
    v_add_f32 v16, v16, v40
    v_add_f32 v18, v18, v42
    v_add_f32 v16, v16, v44
    v_add_f32 v18, v18, v46
    v_add_f32 v16, v16, v48
    v_add_f32 v18, v18, v50
    v_add_f32 v16, v16, v52
    v_add_f32 v18, v18, v54
    v_add_f32 v16, v16, v56
    v_add_f32 v18, v18, v58
    v_add_f32 v16, v16, v60
    v_add_f32 v18, v18, v62
    v_add_f32 v16, v16, v64
    v_add_f32 v18, v18, v66
    v_add_f32 v16, v16, v68
    v_add_f32 v18, v18, v70
    v_add_f32 v16, v16, v72
    v_add_f32 v18, v18, v74
    v_add_f32 v16, v16, v76
    v_add_f32 v18, v18, v78
    v_add_f32 v16, v16, v80
    v_add_f32 v18, v18, v82
    v_add_f32 v16, v16, v84
    v_add_f32 v18, v18, v86
    v_add_f32 v16, v16, v88
    v_add_f32 v18, v18, v90
    v_add_f32 v16, v16, v92
    v_add_f32 v18, v18, v94
    v_add_f32 v16, v16, v96
    v_add_f32 v18, v18, v98
    v_add_f32 v16, v16, v100
    v_add_f32 v18, v18, v102
    v_add_f32 v16, v16, v104
    v_add_f32 v18, v18, v106
    v_add_f32 v16, v16, v108
    v_add_f32 v18, v18, v110
    v_add_f32 v16, v16, v112
    v_add_f32 v18, v18, v114
    v_add_f32 v16, v16, v116
    v_add_f32 v18, v18, v118
    v_add_f32 v16, v16, v120
    v_add_f32 v18, v18, v122
    s_lshr_b32 s36, s11, 16
    s_cmp_ge_u32 s36, 0x8000
    s_cselect_b32 s37, 0x8000, -1
    s_xor_b32 s36, s36, s37
    s_lshl_b32 s36, s36, 16
    v_mov_b32 v4, s36
    v_mul_f32 v4, 0xbfb8aa3b, v4
    v_exp_f32 v4, v4
    s_nop 0
    v_add_f32 v4, 1.0, v4
    v_rcp_f32 v4, v4
    s_nop 0
    v_cvt_pk_bf16_f32 v4, v4, v4
    v_lshlrev_b32 v4, 16, v4
    v_cvt_pk_bf16_f32 v16, v16, v16
    v_lshlrev_b32 v16, 16, v16
    v_mul_f32 v16, v16, v4
    v_cvt_pk_bf16_f32 v16, v16, v16
    v_lshlrev_b32 v16, 16, v16
    s_lshr_b32 s36, s12, 16
    s_cmp_ge_u32 s36, 0x8000
    s_cselect_b32 s37, 0x8000, -1
    s_xor_b32 s36, s36, s37
    s_lshl_b32 s36, s36, 16
    v_mov_b32 v4, s36
    v_mul_f32 v4, 0xbfb8aa3b, v4
    v_exp_f32 v4, v4
    s_nop 0
    v_add_f32 v4, 1.0, v4
    v_rcp_f32 v4, v4
    s_nop 0
    v_cvt_pk_bf16_f32 v4, v4, v4
    v_lshlrev_b32 v4, 16, v4
    v_cvt_pk_bf16_f32 v18, v18, v18
    v_lshlrev_b32 v18, 16, v18
    v_mul_f32 v18, v18, v4
    v_cvt_pk_bf16_f32 v18, v18, v18
    v_lshlrev_b32 v18, 16, v18
    s_mul_i32 s36, s32, 96
    s_sub_u32 s36, s13, s36
    s_max_i32 s36, s36, 0
    s_lshl_b32 s36, s36, 2
    s_add_u32 s36, s36, 156288
    v_mov_b32 v4, s36
    ds_read2st64_b32 v[4:5], v4 offset0:0 offset1:2
    v_lshlrev_b32 v124, 16, v124
    s_waitcnt lgkmcnt(0)
    v_add_f32 v20, v124, v4
    v_cvt_pk_bf16_f32 v20, v20, v20
    v_lshlrev_b32 v20, 16, v20
    v_mul_f32 v20, v20, v5
    v_cvt_pk_bf16_f32 v20, v20, v20
    v_lshlrev_b32 v20, 16, v20
    v_add_f32 v20, v20, v16
    v_cvt_pk_bf16_f32 v20, v20, v20
    v_lshlrev_b32 v20, 16, v20
    v_mul_f32 v16, 0xbfb8aa3b, v20
    v_exp_f32 v16, v16
    s_nop 0
    v_add_f32 v16, 1.0, v16
    v_rcp_f32 v16, v16
    s_nop 0
    v_mul_f32 v16, v16, v20
    v_cvt_pk_bf16_f32 v16, v16, v16
    v_lshlrev_b32 v16, 16, v16
    s_mul_i32 s36, s32, 96
    s_sub_u32 s36, s14, s36
    s_max_i32 s36, s36, 0
    s_lshl_b32 s36, s36, 2
    s_add_u32 s36, s36, 156288
    v_mov_b32 v4, s36
    ds_read2st64_b32 v[4:5], v4 offset0:0 offset1:2
    v_lshlrev_b32 v125, 16, v125
    s_waitcnt lgkmcnt(0)
    v_add_f32 v22, v125, v4
    v_cvt_pk_bf16_f32 v22, v22, v22
    v_lshlrev_b32 v22, 16, v22
    v_mul_f32 v22, v22, v5
    v_cvt_pk_bf16_f32 v22, v22, v22
    v_lshlrev_b32 v22, 16, v22
    v_add_f32 v22, v22, v18
    v_cvt_pk_bf16_f32 v22, v22, v22
    v_lshlrev_b32 v22, 16, v22
    v_mul_f32 v18, 0xbfb8aa3b, v22
    v_exp_f32 v18, v18
    s_nop 0
    v_add_f32 v18, 1.0, v18
    v_rcp_f32 v18, v18
    s_nop 0
    v_mul_f32 v18, v18, v22
    v_cvt_pk_bf16_f32 v18, v18, v18
    v_lshlrev_b32 v18, 16, v18
    v_add_u32 v5, 158208, v12
    ds_write2st64_b32 v5, v16, v18 offset0:0 offset1:1
    v_mov_b32 v6, 157956
    v_mov_b32 v7, 1
    s_mov_b64 exec, 1
    ds_add_u32 v6, v7
    s_mov_b64 exec, -1
Lw0_done:
    s_endpgm
Lcomp:
    s_lshl_b32 s44, s26, 1
    s_add_u32 s44, s44, s27
    s_sub_u32 s36, s33, 5
    s_cmp_ge_u32 s33, 5
    s_cselect_b32 s40, s36, s33
    s_mov_b32 s41, 0xbfe10856
    s_cmp_eq_u32 s40, 1
    s_cselect_b32 s41, 0xaff80255, s41
    s_cmp_eq_u32 s40, 2
    s_cselect_b32 s41, 0xabfe4015, s41
    s_cmp_eq_u32 s40, 3
    s_cselect_b32 s41, 0xaa7fd005, s41
    s_cmp_eq_u32 s40, 4
    s_cselect_b32 s41, 0x6adfb401, s41
    s_lshl_b32 s37, s27, 13
    s_cmp_eq_u32 s44, 1
    s_cselect_b32 s37, 0, s37
    v_bfe_u32 v7, v1, 2, 2
    v_and_b32 v8, 3, v1
    v_lshl_add_u32 v18, v2, 3, v7
    v_lshlrev_b32 v18, 7, v18
    v_lshlrev_b32 v19, 2, v1
    v_and_b32 v19, 0x60, v19
    v_lshlrev_b32 v10, 1, v8
    v_add_u32 v9, s37, v18
    v_add_u32 v11, 0, v10
    v_bfe_u32 v11, s41, v11, 2
    v_lshl_add_u32 v11, v11, 2, v8
    v_lshlrev_b32 v11, 3, v11
    v_xad_u32 v20, v11, v19, v9
    v_add_u32 v11, 8, v10
    v_bfe_u32 v11, s41, v11, 2
    v_lshl_add_u32 v11, v11, 2, v8
    v_lshlrev_b32 v11, 3, v11
    v_xad_u32 v21, v11, v19, v9
    v_add_u32 v11, 16, v10
    v_bfe_u32 v11, s41, v11, 2
    v_lshl_add_u32 v11, v11, 2, v8
    v_lshlrev_b32 v11, 3, v11
    v_xad_u32 v22, v11, v19, v9
    v_add_u32 v11, 24, v10
    v_bfe_u32 v11, s41, v11, 2
    v_lshl_add_u32 v11, v11, 2, v8
    v_lshlrev_b32 v11, 3, v11
    v_xad_u32 v23, v11, v19, v9
    v_add_u32 v24, 78080, v20
    v_add_u32 v25, 78080, v21
    v_add_u32 v26, 78080, v22
    v_add_u32 v27, 78080, v23
    v_lshrrev_b32 v10, 1, v3
    v_xor_b32 v9, v10, v2
    v_lshlrev_b32 v9, 4, v9
    v_lshl_add_u32 v9, v3, 7, v9
    s_lshl_b32 s36, s44, 11
    s_xor_b32 s38, s36, 2048
    s_add_u32 s36, s36, 22528
    s_add_u32 s38, s38, 22528
    v_add_u32 v76, s36, v9
    v_add_u32 v78, s38, v9
    s_mul_i32 s39, s26, 6144
    s_add_u32 s39, s39, 98560
    v_add_u32 v125, s39, v13
    s_lshl_b32 s45, s44, 11
    s_add_u32 s45, s45, 139648
    s_waitcnt lgkmcnt(0)
    s_mov_b64 s[28:29], s[24:25]
    s_mov_b32 s30, 268435456
    s_mov_b32 s31, 0x20000
    s_load_dword s34, s[28:29], 0
    s_cmp_eq_u32 s44, 1
    s_cbranch_scc1 Lhalo
    v_xor_b32 v77, 64, v76
    v_xor_b32 v79, 64, v78
    v_add_u32 v80, 78080, v76
    v_add_u32 v81, 78080, v77
    v_add_u32 v82, 78080, v78
    v_add_u32 v83, 78080, v79
    s_cmp_eq_u32 s27, 0
    s_cselect_b64 vcc, 0, -1
    s_sub_u32 s37, 16384, s37
    v_cndmask_b32 v84, v20, v22, vcc
    v_cndmask_b32 v85, v21, v23, vcc
    v_add_u32 v84, s37, v84
    v_add_u32 v85, s37, v85
    v_add_u32 v86, 78080, v84
    v_add_u32 v87, 78080, v85
    v_lshrrev_b32 v8, 1, v2
    v_xor_b32 v8, v8, v10
    v_lshlrev_b32 v8, 4, v8
    v_lshl_add_u32 v8, v3, 7, v8
    v_and_b32 v7, 1, v2
    v_lshl_add_u32 v124, v7, 3, v8
    s_lshl_b32 s46, s42, 12
    s_mov_b32 s38, 0x84736210
    s_mov_b32 s39, 0x95
    s_cmp_eq_u32 s42, 1
    s_cselect_b32 s38, 0x83712065, s38
    s_cselect_b32 s39, 0x94, s39
    s_cmp_eq_u32 s42, 2
    s_cselect_b32 s38, 0x81307564, s38
    s_cselect_b32 s39, 0x92, s39
    s_cmp_eq_u32 s42, 3
    s_cselect_b32 s38, 0x40857362, s38
    s_cselect_b32 s39, 0x91, s39
    s_cmp_eq_u32 s42, 4
    s_cselect_b32 s38, 0x94837261, s38
    s_cselect_b32 s39, 0x50, s39
    s_xor_b32 s42, s33, s43
    s_lshl_b32 s42, s42, 2
    s_lshr_b64 s[38:39], s[38:39], s42
    s_and_b32 s42, s38, 15
    s_and_b32 s38, s42, 3
    s_mul_i32 s38, s38, 39040
    s_add_u32 s38, s38, s36
    v_add_u32 v4, s38, v124
    v_xor_b32 v5, 32, v4
    v_xor_b32 v6, 64, v4
    v_xor_b32 v7, 0x60, v4
    s_mov_b64 s[48:49], s[20:21]
    s_mov_b32 s50, 2621440
    s_mov_b32 s51, 0x20000
    v_mov_b32 v14, 0x3f803f80
    v_mov_b32 v15, 0x3f803f80
    v_mov_b32 v16, 0x3f803f80
    v_mov_b32 v17, 0x3f803f80
    s_mov_b32 s4, 0xaae00455
    s_cmp_eq_u32 s40, 1
    s_cselect_b32 s4, 0xaaf80155, s4
    s_cmp_eq_u32 s40, 2
    s_cselect_b32 s4, 0xaafe4055, s4
    s_cmp_eq_u32 s40, 3
    s_cselect_b32 s4, 0xaabfd055, s4
    s_cmp_eq_u32 s40, 4
    s_cselect_b32 s4, 0xaaeff455, s4
    v_lshlrev_b32 v10, 1, v2
    v_add_u32 v10, 8, v10
    v_bfe_u32 v10, s4, v10, 2
    v_cmp_eq_u32 s[6:7], 0, v10
    v_cmp_eq_u32 s[8:9], 3, v10
    v_cmp_eq_u32 s[10:11], 1, v10
    v_lshlrev_b32 v10, 1, v2
    v_add_u32 v10, 16, v10
    v_bfe_u32 v10, s4, v10, 2
    v_cmp_eq_u32 s[12:13], 0, v10
    v_cmp_eq_u32 s[14:15], 3, v10
    v_cmp_eq_u32 s[16:17], 2, v10
    s_mov_b32 s4, 0xaaaaaaaa
    s_mov_b32 s5, 0xaaaaaaaa
    s_mov_b32 s18, 0xfff0ffff
    s_mov_b32 s19, 0xf000ff00
    s_mov_b32 s20, 0xffc0fffc
    s_mov_b32 s21, 0xc000fc00
    v_mov_b32 v8, 0xffff
    v_not_b32 v9, v8
    v_cndmask_b32 v8, v8, v9, s[4:5]
    v_cndmask_b32 v118, 0, v8, s[18:19]
    v_cndmask_b32 v119, 0, v8, s[20:21]
    v_xor_b32 v116, v118, v8
    v_xor_b32 v117, v119, v8
    s_cmp_eq_u32 s32, 0
    s_cselect_b32 s36, s44, 0
    s_cmp_eq_u32 s36, 2
    s_cselect_b32 s22, 0xff800000, 0
    s_mul_i32 s36, s32, 6
    s_add_u32 s36, s36, s44
    s_sub_u32 s36, s36, 2
    s_lshl_b32 s24, s36, 7
    s_add_u32 s24, s24, 7340032
    s_mul_i32 s52, s36, 20480
    s_add_u32 s52, s52, 4194304
    s_lshl_b32 s36, s33, 11
    s_add_u32 s23, s36, s52
    s_add_u32 s53, s52, s46
    s_add_u32 s46, s46, 4096
    s_cmp_eq_u32 s46, 20480
    s_cselect_b32 s46, 0, s46
    s_add_u32 s54, s52, s46
    s_add_u32 s46, s46, 4096
    s_cmp_eq_u32 s46, 20480
    s_cselect_b32 s46, 0, s46
    s_add_u32 s55, s52, s46
    s_add_u32 s46, s46, 4096
    s_cmp_eq_u32 s46, 20480
    s_cselect_b32 s46, 0, s46
    s_add_u32 s56, s52, s46
    s_add_u32 s46, s46, 4096
    s_cmp_eq_u32 s46, 20480
    s_cselect_b32 s46, 0, s46
    s_add_u32 s57, s52, s46
    s_add_u32 s46, s46, 4096
    s_cmp_eq_u32 s46, 20480
    s_cselect_b32 s46, 0, s46
    s_mul_i32 s36, s32, 10
    s_add_u32 s36, s36, s33
    s_mul_i32 s58, s36, 6144
    s_lshl_b32 s36, s44, 10
    s_add_u32 s58, s58, s36
    s_add_u32 s58, s58, 1046528
    s_sub_u32 s59, s58, 6144
    s_add_u32 s60, s58, 6144
    s_cmp_eq_u32 s40, 0
    s_cselect_b32 s61, 0, -1
    s_cmp_eq_u32 s40, 4
    s_cselect_b32 s62, 0, -1
    s_lshl_b32 s36, s33, 2
    v_mov_b32 v97, s36
    s_mov_b32 s25, 0x3ea52b5c
    s_lshl_b32 s36, s44, 6
    s_add_u32 s36, s36, 156160
    v_lshl_add_u32 v94, v3, 2, s36
    v_and_b32 v8, 1, v1
    v_lshl_add_u32 v8, v2, 2, v8
    v_lshl_add_u32 v8, v8, 2, s36
    v_subrev_u32 v9, 64, v8
    v_cndmask_b32 v92, v9, v8, s[18:19]
    v_cndmask_b32 v93, v9, v8, s[20:21]
    v_lshlrev_b32 v95, 4, v2
    s_lshl_b32 s36, s27, 8
    s_add_u32 s36, s36, 157184
    v_add_u32 v95, s36, v95
    v_mov_b32 v96, 157968
    v_mov_b32 v100, -1
    v_mov_b32 v101, -1
    v_mov_b32 v102, -1
    v_mov_b32 v103, -1
    v_mov_b32 v127, 157984
    s_lshl_b32 s36, s3, 2
    s_add_u32 s36, s36, 158016
    v_mov_b32 v10, s36
    v_xor_b32 v11, 16, v10
    v_cndmask_b32 v127, v127, v11, s[4:5]
    s_waitcnt vmcnt(0)
    s_waitcnt lgkmcnt(0)
    s_barrier
    ds_read_b128 a[64:67], v76 offset:0
    ds_read_b128 a[68:71], v78 offset:0
    ds_read_b64_tr_b16 a[80:81], v20 offset:0
    ds_read_b64_tr_b16 a[82:83], v20 offset:512
    ds_read_b64_tr_b16 a[84:85], v21 offset:0
    ds_read_b64_tr_b16 a[86:87], v21 offset:512
    ds_read_b64_tr_b16 a[88:89], v22 offset:0
    ds_read_b64_tr_b16 a[90:91], v22 offset:512
    ds_read_b64_tr_b16 a[92:93], v23 offset:0
    ds_read_b64_tr_b16 a[94:95], v23 offset:512
    ds_read_b64_tr_b16 a[96:97], v84 offset:0
    ds_read_b64_tr_b16 a[98:99], v84 offset:512
    ds_read_b64_tr_b16 a[100:101], v85 offset:0
    ds_read_b64_tr_b16 a[102:103], v85 offset:512
    s_add_u32 s34, s34, 0x9e3779b8
    s_or_b32 s34, s34, 1
    s_cmp_eq_u32 s42, 0
    s_cbranch_scc1 Lxe0
Lxe0_b:
    s_setprio 1
    s_waitcnt lgkmcnt(10)
    v_mfma_f32_16x16x32_bf16 v[28:31], a[80:83], a[64:67], 0
    ds_read_b128 a[72:75], v77 offset:0
    ds_read_b128 a[76:79], v79 offset:0
    v_mfma_f32_16x16x32_bf16 v[44:47], a[80:83], a[68:71], 0
    ds_read_b64_tr_b16 a[104:105], v20 offset:4096
    s_waitcnt lgkmcnt(11)
    v_mfma_f32_16x16x32_bf16 v[32:35], a[84:87], a[64:67], 0
    ds_read_b64_tr_b16 a[106:107], v20 offset:4608
    v_mfma_f32_16x16x32_bf16 v[48:51], a[84:87], a[68:71], 0
    ds_read_b64_tr_b16 a[108:109], v21 offset:4096
    s_waitcnt lgkmcnt(11)
    v_mfma_f32_16x16x32_bf16 v[36:39], a[88:91], a[64:67], 0
    ds_read_b64_tr_b16 a[110:111], v21 offset:4608
    ds_read_b64_tr_b16 a[112:113], v22 offset:4096
    v_mfma_f32_16x16x32_bf16 v[52:55], a[88:91], a[68:71], 0
    ds_read_b64_tr_b16 a[114:115], v22 offset:4608
    s_setprio 0
    s_waitcnt lgkmcnt(12)
    v_mfma_f32_16x16x32_bf16 v[40:43], a[92:95], a[64:67], 0
    ds_read_b64_tr_b16 a[116:117], v23 offset:4096
    v_mfma_f32_16x16x32_bf16 v[56:59], a[92:95], a[68:71], 0
    ds_read_b64_tr_b16 a[118:119], v23 offset:4608
    s_waitcnt lgkmcnt(12)
    v_mfma_f32_16x16x32_bf16 v[60:63], a[64:67], a[96:99], 0
    ds_read_b64_tr_b16 a[120:121], v84 offset:4096
    v_mfma_f32_16x16x32_bf16 v[68:71], a[68:71], a[96:99], 0
    ds_read_b64_tr_b16 a[122:123], v84 offset:4608
    s_waitcnt lgkmcnt(12)
    v_mfma_f32_16x16x32_bf16 v[64:67], a[64:67], a[100:103], 0
    ds_read_b64_tr_b16 a[124:125], v85 offset:4096
    v_mfma_f32_16x16x32_bf16 v[72:75], a[68:71], a[100:103], 0
    ds_read_b64_tr_b16 a[126:127], v85 offset:4608
    s_barrier
    s_setprio 3
    s_waitcnt lgkmcnt(10)
    v_mfma_f32_16x16x32_bf16 v[28:31], a[104:107], a[72:75], v[28:31]
    ds_read_b128 a[64:67], v76 offset:39040
    ds_read_b128 a[68:71], v78 offset:39040
    v_mfma_f32_16x16x32_bf16 v[44:47], a[104:107], a[76:79], v[44:47]
    ds_read_b64_tr_b16 a[80:81], v20 offset:39040
    s_waitcnt lgkmcnt(11)
    v_mfma_f32_16x16x32_bf16 v[32:35], a[108:111], a[72:75], v[32:35]
    ds_read_b64_tr_b16 a[82:83], v20 offset:39552
    v_mfma_f32_16x16x32_bf16 v[48:51], a[108:111], a[76:79], v[48:51]
    ds_read_b64_tr_b16 a[84:85], v21 offset:39040
    s_waitcnt lgkmcnt(11)
    v_mfma_f32_16x16x32_bf16 v[36:39], a[112:115], a[72:75], v[36:39]
    ds_read_b64_tr_b16 a[86:87], v21 offset:39552
    v_mfma_f32_16x16x32_bf16 v[52:55], a[112:115], a[76:79], v[52:55]
    ds_read_b64_tr_b16 a[88:89], v22 offset:39040
    s_setprio 2
    s_waitcnt lgkmcnt(11)
    v_mfma_f32_16x16x32_bf16 v[40:43], a[116:119], a[72:75], v[40:43]
    ds_read_b64_tr_b16 a[90:91], v22 offset:39552
    ds_read_b64_tr_b16 a[92:93], v23 offset:39040
    v_mfma_f32_16x16x32_bf16 v[56:59], a[116:119], a[76:79], v[56:59]
    ds_read_b64_tr_b16 a[94:95], v23 offset:39552
    s_waitcnt lgkmcnt(12)
    v_mfma_f32_16x16x32_bf16 v[60:63], a[72:75], a[120:123], v[60:63]
    ds_read_b64_tr_b16 a[96:97], v84 offset:39040
    v_mfma_f32_16x16x32_bf16 v[68:71], a[76:79], a[120:123], v[68:71]
    ds_read_b64_tr_b16 a[98:99], v84 offset:39552
    s_waitcnt lgkmcnt(12)
    v_mfma_f32_16x16x32_bf16 v[64:67], a[72:75], a[124:127], v[64:67]
    ds_read_b64_tr_b16 a[100:101], v85 offset:39040
    v_mfma_f32_16x16x32_bf16 v[72:75], a[76:79], a[124:127], v[72:75]
    ds_read_b64_tr_b16 a[102:103], v85 offset:39552
    s_cmp_eq_u32 s42, 1
    s_cbranch_scc1 Lxe1
Lxe1_b:
    s_setprio 1
    s_waitcnt lgkmcnt(10)
    v_mfma_f32_16x16x32_bf16 v[28:31], a[80:83], a[64:67], v[28:31]
    ds_read_b128 a[72:75], v77 offset:39040
    ds_read_b128 a[76:79], v79 offset:39040
    v_mfma_f32_16x16x32_bf16 v[44:47], a[80:83], a[68:71], v[44:47]
    ds_read_b64_tr_b16 a[104:105], v20 offset:43136
    s_waitcnt lgkmcnt(11)
    v_mfma_f32_16x16x32_bf16 v[32:35], a[84:87], a[64:67], v[32:35]
    ds_read_b64_tr_b16 a[106:107], v20 offset:43648
    v_mfma_f32_16x16x32_bf16 v[48:51], a[84:87], a[68:71], v[48:51]
    ds_read_b64_tr_b16 a[108:109], v21 offset:43136
    s_waitcnt lgkmcnt(11)
    v_mfma_f32_16x16x32_bf16 v[36:39], a[88:91], a[64:67], v[36:39]
    ds_read_b64_tr_b16 a[110:111], v21 offset:43648
    ds_read_b64_tr_b16 a[112:113], v22 offset:43136
    v_mfma_f32_16x16x32_bf16 v[52:55], a[88:91], a[68:71], v[52:55]
    ds_read_b64_tr_b16 a[114:115], v22 offset:43648
    s_setprio 0
    s_waitcnt lgkmcnt(12)
    v_mfma_f32_16x16x32_bf16 v[40:43], a[92:95], a[64:67], v[40:43]
    ds_read_b64_tr_b16 a[116:117], v23 offset:43136
    v_mfma_f32_16x16x32_bf16 v[56:59], a[92:95], a[68:71], v[56:59]
    ds_read_b64_tr_b16 a[118:119], v23 offset:43648
    s_waitcnt lgkmcnt(12)
    v_mfma_f32_16x16x32_bf16 v[60:63], a[64:67], a[96:99], v[60:63]
    ds_read_b64_tr_b16 a[120:121], v84 offset:43136
    v_mfma_f32_16x16x32_bf16 v[68:71], a[68:71], a[96:99], v[68:71]
    ds_read_b64_tr_b16 a[122:123], v84 offset:43648
    s_waitcnt lgkmcnt(12)
    v_mfma_f32_16x16x32_bf16 v[64:67], a[64:67], a[100:103], v[64:67]
    ds_read_b64_tr_b16 a[124:125], v85 offset:43136
    v_mfma_f32_16x16x32_bf16 v[72:75], a[68:71], a[100:103], v[72:75]
    ds_read_b64_tr_b16 a[126:127], v85 offset:43648
    s_barrier
    s_setprio 3
    s_waitcnt lgkmcnt(10)
    v_mfma_f32_16x16x32_bf16 v[28:31], a[104:107], a[72:75], v[28:31]
    ds_read_b128 a[64:67], v80 offset:0
    ds_read_b128 a[68:71], v82 offset:0
    v_mfma_f32_16x16x32_bf16 v[44:47], a[104:107], a[76:79], v[44:47]
    ds_read_b64_tr_b16 a[80:81], v24 offset:0
    s_waitcnt lgkmcnt(11)
    v_mfma_f32_16x16x32_bf16 v[32:35], a[108:111], a[72:75], v[32:35]
    ds_read_b64_tr_b16 a[82:83], v24 offset:512
    v_mfma_f32_16x16x32_bf16 v[48:51], a[108:111], a[76:79], v[48:51]
    ds_read_b64_tr_b16 a[84:85], v25 offset:0
    s_waitcnt lgkmcnt(11)
    v_mfma_f32_16x16x32_bf16 v[36:39], a[112:115], a[72:75], v[36:39]
    ds_read_b64_tr_b16 a[86:87], v25 offset:512
    v_mfma_f32_16x16x32_bf16 v[52:55], a[112:115], a[76:79], v[52:55]
    ds_read_b64_tr_b16 a[88:89], v26 offset:0
    s_setprio 2
    s_waitcnt lgkmcnt(11)
    v_mfma_f32_16x16x32_bf16 v[40:43], a[116:119], a[72:75], v[40:43]
    ds_read_b64_tr_b16 a[90:91], v26 offset:512
    ds_read_b64_tr_b16 a[92:93], v27 offset:0
    v_mfma_f32_16x16x32_bf16 v[56:59], a[116:119], a[76:79], v[56:59]
    ds_read_b64_tr_b16 a[94:95], v27 offset:512
    s_waitcnt lgkmcnt(12)
    v_mfma_f32_16x16x32_bf16 v[60:63], a[72:75], a[120:123], v[60:63]
    ds_read_b64_tr_b16 a[96:97], v86 offset:0
    v_mfma_f32_16x16x32_bf16 v[68:71], a[76:79], a[120:123], v[68:71]
    ds_read_b64_tr_b16 a[98:99], v86 offset:512
    s_waitcnt lgkmcnt(12)
    v_mfma_f32_16x16x32_bf16 v[64:67], a[72:75], a[124:127], v[64:67]
    ds_read_b64_tr_b16 a[100:101], v87 offset:0
    v_mfma_f32_16x16x32_bf16 v[72:75], a[76:79], a[124:127], v[72:75]
    ds_read_b64_tr_b16 a[102:103], v87 offset:512
    buffer_store_dwordx4 v[100:103], v13, s[28:31], s58 offen sc1
    s_cmp_eq_u32 s42, 2
    s_cbranch_scc1 Lxe2
Lxe2_b:
    s_setprio 1
    s_waitcnt lgkmcnt(10)
    v_mfma_f32_16x16x32_bf16 v[28:31], a[80:83], a[64:67], v[28:31]
    ds_read_b128 a[72:75], v81 offset:0
    ds_read_b128 a[76:79], v83 offset:0
    v_mfma_f32_16x16x32_bf16 v[44:47], a[80:83], a[68:71], v[44:47]
    ds_read_b64_tr_b16 a[104:105], v24 offset:4096
    s_waitcnt lgkmcnt(11)
    v_mfma_f32_16x16x32_bf16 v[32:35], a[84:87], a[64:67], v[32:35]
    ds_read_b64_tr_b16 a[106:107], v24 offset:4608
    v_mfma_f32_16x16x32_bf16 v[48:51], a[84:87], a[68:71], v[48:51]
    ds_read_b64_tr_b16 a[108:109], v25 offset:4096
    s_waitcnt lgkmcnt(11)
    v_mfma_f32_16x16x32_bf16 v[36:39], a[88:91], a[64:67], v[36:39]
    ds_read_b64_tr_b16 a[110:111], v25 offset:4608
    ds_read_b64_tr_b16 a[112:113], v26 offset:4096
    v_mfma_f32_16x16x32_bf16 v[52:55], a[88:91], a[68:71], v[52:55]
    ds_read_b64_tr_b16 a[114:115], v26 offset:4608
    s_setprio 0
    s_waitcnt lgkmcnt(12)
    v_mfma_f32_16x16x32_bf16 v[40:43], a[92:95], a[64:67], v[40:43]
    ds_read_b64_tr_b16 a[116:117], v27 offset:4096
    v_mfma_f32_16x16x32_bf16 v[56:59], a[92:95], a[68:71], v[56:59]
    ds_read_b64_tr_b16 a[118:119], v27 offset:4608
    s_waitcnt lgkmcnt(12)
    v_mfma_f32_16x16x32_bf16 v[60:63], a[64:67], a[96:99], v[60:63]
    ds_read_b64_tr_b16 a[120:121], v86 offset:4096
    v_mfma_f32_16x16x32_bf16 v[68:71], a[68:71], a[96:99], v[68:71]
    ds_read_b64_tr_b16 a[122:123], v86 offset:4608
    s_waitcnt lgkmcnt(12)
    v_mfma_f32_16x16x32_bf16 v[64:67], a[64:67], a[100:103], v[64:67]
    ds_read_b64_tr_b16 a[124:125], v87 offset:4096
    v_mfma_f32_16x16x32_bf16 v[72:75], a[68:71], a[100:103], v[72:75]
    ds_read_b64_tr_b16 a[126:127], v87 offset:4608
    s_barrier
    s_setprio 3
    s_waitcnt lgkmcnt(10)
    v_mfma_f32_16x16x32_bf16 v[28:31], a[104:107], a[72:75], v[28:31]
    ds_read_b128 a[64:67], v80 offset:39040
    ds_read_b128 a[68:71], v82 offset:39040
    v_mfma_f32_16x16x32_bf16 v[44:47], a[104:107], a[76:79], v[44:47]
    ds_read_b64_tr_b16 a[80:81], v24 offset:39040
    s_waitcnt lgkmcnt(11)
    v_mfma_f32_16x16x32_bf16 v[32:35], a[108:111], a[72:75], v[32:35]
    ds_read_b64_tr_b16 a[82:83], v24 offset:39552
    v_mfma_f32_16x16x32_bf16 v[48:51], a[108:111], a[76:79], v[48:51]
    ds_read_b64_tr_b16 a[84:85], v25 offset:39040
    s_waitcnt lgkmcnt(11)
    v_mfma_f32_16x16x32_bf16 v[36:39], a[112:115], a[72:75], v[36:39]
    ds_read_b64_tr_b16 a[86:87], v25 offset:39552
    v_mfma_f32_16x16x32_bf16 v[52:55], a[112:115], a[76:79], v[52:55]
    ds_read_b64_tr_b16 a[88:89], v26 offset:39040
    s_setprio 2
    s_waitcnt lgkmcnt(11)
    v_mfma_f32_16x16x32_bf16 v[40:43], a[116:119], a[72:75], v[40:43]
    ds_read_b64_tr_b16 a[90:91], v26 offset:39552
    ds_read_b64_tr_b16 a[92:93], v27 offset:39040
    v_mfma_f32_16x16x32_bf16 v[56:59], a[116:119], a[76:79], v[56:59]
    ds_read_b64_tr_b16 a[94:95], v27 offset:39552
    s_waitcnt lgkmcnt(12)
    v_mfma_f32_16x16x32_bf16 v[60:63], a[72:75], a[120:123], v[60:63]
    ds_read_b64_tr_b16 a[96:97], v86 offset:39040
    v_mfma_f32_16x16x32_bf16 v[68:71], a[76:79], a[120:123], v[68:71]
    ds_read_b64_tr_b16 a[98:99], v86 offset:39552
    s_waitcnt lgkmcnt(12)
    v_mfma_f32_16x16x32_bf16 v[64:67], a[72:75], a[124:127], v[64:67]
    ds_read_b64_tr_b16 a[100:101], v87 offset:39040
    v_mfma_f32_16x16x32_bf16 v[72:75], a[76:79], a[124:127], v[72:75]
    ds_read_b64_tr_b16 a[102:103], v87 offset:39552
    s_cmp_eq_u32 s42, 3
    s_cbranch_scc1 Lxe3
Lxe3_b:
    s_setprio 1
    s_waitcnt lgkmcnt(10)
    v_mfma_f32_16x16x32_bf16 v[28:31], a[80:83], a[64:67], v[28:31]
    ds_read_b128 a[72:75], v81 offset:39040
    ds_read_b128 a[76:79], v83 offset:39040
    v_mfma_f32_16x16x32_bf16 v[44:47], a[80:83], a[68:71], v[44:47]
    ds_read_b64_tr_b16 a[104:105], v24 offset:43136
    s_waitcnt lgkmcnt(11)
    v_mfma_f32_16x16x32_bf16 v[32:35], a[84:87], a[64:67], v[32:35]
    ds_read_b64_tr_b16 a[106:107], v24 offset:43648
    v_mfma_f32_16x16x32_bf16 v[48:51], a[84:87], a[68:71], v[48:51]
    ds_read_b64_tr_b16 a[108:109], v25 offset:43136
    s_waitcnt lgkmcnt(11)
    v_mfma_f32_16x16x32_bf16 v[36:39], a[88:91], a[64:67], v[36:39]
    ds_read_b64_tr_b16 a[110:111], v25 offset:43648
    ds_read_b64_tr_b16 a[112:113], v26 offset:43136
    v_mfma_f32_16x16x32_bf16 v[52:55], a[88:91], a[68:71], v[52:55]
    ds_read_b64_tr_b16 a[114:115], v26 offset:43648
    s_setprio 0
    s_waitcnt lgkmcnt(12)
    v_mfma_f32_16x16x32_bf16 v[40:43], a[92:95], a[64:67], v[40:43]
    ds_read_b64_tr_b16 a[116:117], v27 offset:43136
    v_mfma_f32_16x16x32_bf16 v[56:59], a[92:95], a[68:71], v[56:59]
    ds_read_b64_tr_b16 a[118:119], v27 offset:43648
    s_waitcnt lgkmcnt(12)
    v_mfma_f32_16x16x32_bf16 v[60:63], a[64:67], a[96:99], v[60:63]
    ds_read_b64_tr_b16 a[120:121], v86 offset:43136
    v_mfma_f32_16x16x32_bf16 v[68:71], a[68:71], a[96:99], v[68:71]
    ds_read_b64_tr_b16 a[122:123], v86 offset:43648
    s_waitcnt lgkmcnt(12)
    v_mfma_f32_16x16x32_bf16 v[64:67], a[64:67], a[100:103], v[64:67]
    ds_read_b64_tr_b16 a[124:125], v87 offset:43136
    v_mfma_f32_16x16x32_bf16 v[72:75], a[68:71], a[100:103], v[72:75]
    ds_read_b64_tr_b16 a[126:127], v87 offset:43648
    s_barrier
    s_setprio 3
    s_waitcnt lgkmcnt(10)
    v_mfma_f32_16x16x32_bf16 v[28:31], a[104:107], a[72:75], v[28:31]
    ds_read_b128 a[64:67], v76 offset:0
    ds_read_b128 a[68:71], v78 offset:0
    v_mfma_f32_16x16x32_bf16 v[44:47], a[104:107], a[76:79], v[44:47]
    ds_read_b64_tr_b16 a[80:81], v20 offset:0
    s_waitcnt lgkmcnt(11)
    v_mfma_f32_16x16x32_bf16 v[32:35], a[108:111], a[72:75], v[32:35]
    ds_read_b64_tr_b16 a[82:83], v20 offset:512
    v_mfma_f32_16x16x32_bf16 v[48:51], a[108:111], a[76:79], v[48:51]
    ds_read_b64_tr_b16 a[84:85], v21 offset:0
    s_waitcnt lgkmcnt(11)
    v_mfma_f32_16x16x32_bf16 v[36:39], a[112:115], a[72:75], v[36:39]
    ds_read_b64_tr_b16 a[86:87], v21 offset:512
    v_mfma_f32_16x16x32_bf16 v[52:55], a[112:115], a[76:79], v[52:55]
    ds_read_b64_tr_b16 a[88:89], v22 offset:0
    s_setprio 2
    s_waitcnt lgkmcnt(11)
    v_mfma_f32_16x16x32_bf16 v[40:43], a[116:119], a[72:75], v[40:43]
    ds_read_b64_tr_b16 a[90:91], v22 offset:512
    ds_read_b64_tr_b16 a[92:93], v23 offset:0
    v_mfma_f32_16x16x32_bf16 v[56:59], a[116:119], a[76:79], v[56:59]
    ds_read_b64_tr_b16 a[94:95], v23 offset:512
    s_waitcnt lgkmcnt(12)
    v_mfma_f32_16x16x32_bf16 v[60:63], a[72:75], a[120:123], v[60:63]
    ds_read_b64_tr_b16 a[96:97], v84 offset:0
    v_mfma_f32_16x16x32_bf16 v[68:71], a[76:79], a[120:123], v[68:71]
    ds_read_b64_tr_b16 a[98:99], v84 offset:512
    s_waitcnt lgkmcnt(12)
    v_mfma_f32_16x16x32_bf16 v[64:67], a[72:75], a[124:127], v[64:67]
    ds_read_b64_tr_b16 a[100:101], v85 offset:0
    v_mfma_f32_16x16x32_bf16 v[72:75], a[76:79], a[124:127], v[72:75]
    ds_read_b64_tr_b16 a[102:103], v85 offset:512
    buffer_store_dwordx4 v[100:103], v13, s[28:31], s23 offen offset:0 sc1
    s_cmp_eq_u32 s42, 4
    s_cbranch_scc1 Lxe4
Lxe4_b:
    s_setprio 1
    s_waitcnt lgkmcnt(10)
    v_mfma_f32_16x16x32_bf16 v[28:31], a[80:83], a[64:67], v[28:31]
    ds_read_b128 a[72:75], v77 offset:0
    ds_read_b128 a[76:79], v79 offset:0
    v_mfma_f32_16x16x32_bf16 v[44:47], a[80:83], a[68:71], v[44:47]
    ds_read_b64_tr_b16 a[104:105], v20 offset:4096
    s_waitcnt lgkmcnt(11)
    v_mfma_f32_16x16x32_bf16 v[32:35], a[84:87], a[64:67], v[32:35]
    ds_read_b64_tr_b16 a[106:107], v20 offset:4608
    v_mfma_f32_16x16x32_bf16 v[48:51], a[84:87], a[68:71], v[48:51]
    ds_read_b64_tr_b16 a[108:109], v21 offset:4096
    s_waitcnt lgkmcnt(11)
    v_mfma_f32_16x16x32_bf16 v[36:39], a[88:91], a[64:67], v[36:39]
    ds_read_b64_tr_b16 a[110:111], v21 offset:4608
    ds_read_b64_tr_b16 a[112:113], v22 offset:4096
    v_mfma_f32_16x16x32_bf16 v[52:55], a[88:91], a[68:71], v[52:55]
    ds_read_b64_tr_b16 a[114:115], v22 offset:4608
    s_setprio 0
    s_waitcnt lgkmcnt(12)
    v_mfma_f32_16x16x32_bf16 v[40:43], a[92:95], a[64:67], v[40:43]
    ds_read_b64_tr_b16 a[116:117], v23 offset:4096
    v_mfma_f32_16x16x32_bf16 v[56:59], a[92:95], a[68:71], v[56:59]
    ds_read_b64_tr_b16 a[118:119], v23 offset:4608
    s_waitcnt lgkmcnt(12)
    v_mfma_f32_16x16x32_bf16 v[60:63], a[64:67], a[96:99], v[60:63]
    ds_read_b64_tr_b16 a[120:121], v84 offset:4096
    v_mfma_f32_16x16x32_bf16 v[68:71], a[68:71], a[96:99], v[68:71]
    ds_read_b64_tr_b16 a[122:123], v84 offset:4608
    s_waitcnt lgkmcnt(12)
    v_mfma_f32_16x16x32_bf16 v[64:67], a[64:67], a[100:103], v[64:67]
    ds_read_b64_tr_b16 a[124:125], v85 offset:4096
    v_mfma_f32_16x16x32_bf16 v[72:75], a[68:71], a[100:103], v[72:75]
    ds_read_b64_tr_b16 a[126:127], v85 offset:4608
    s_barrier
    s_setprio 3
    s_waitcnt lgkmcnt(10)
    v_mfma_f32_16x16x32_bf16 v[28:31], a[104:107], a[72:75], v[28:31]
    ds_read_b128 a[64:67], v76 offset:39040
    ds_read_b128 a[68:71], v78 offset:39040
    v_mfma_f32_16x16x32_bf16 v[44:47], a[104:107], a[76:79], v[44:47]
    ds_read_b64_tr_b16 a[80:81], v20 offset:39040
    s_waitcnt lgkmcnt(11)
    v_mfma_f32_16x16x32_bf16 v[32:35], a[108:111], a[72:75], v[32:35]
    ds_read_b64_tr_b16 a[82:83], v20 offset:39552
    v_mfma_f32_16x16x32_bf16 v[48:51], a[108:111], a[76:79], v[48:51]
    ds_read_b64_tr_b16 a[84:85], v21 offset:39040
    s_waitcnt lgkmcnt(11)
    v_mfma_f32_16x16x32_bf16 v[36:39], a[112:115], a[72:75], v[36:39]
    ds_read_b64_tr_b16 a[86:87], v21 offset:39552
    v_mfma_f32_16x16x32_bf16 v[52:55], a[112:115], a[76:79], v[52:55]
    ds_read_b64_tr_b16 a[88:89], v22 offset:39040
    s_setprio 2
    s_waitcnt lgkmcnt(11)
    v_mfma_f32_16x16x32_bf16 v[40:43], a[116:119], a[72:75], v[40:43]
    ds_read_b64_tr_b16 a[90:91], v22 offset:39552
    ds_read_b64_tr_b16 a[92:93], v23 offset:39040
    v_mfma_f32_16x16x32_bf16 v[56:59], a[116:119], a[76:79], v[56:59]
    ds_read_b64_tr_b16 a[94:95], v23 offset:39552
    s_waitcnt lgkmcnt(12)
    v_mfma_f32_16x16x32_bf16 v[60:63], a[72:75], a[120:123], v[60:63]
    ds_read_b64_tr_b16 a[96:97], v84 offset:39040
    v_mfma_f32_16x16x32_bf16 v[68:71], a[76:79], a[120:123], v[68:71]
    ds_read_b64_tr_b16 a[98:99], v84 offset:39552
    s_waitcnt lgkmcnt(12)
    v_mfma_f32_16x16x32_bf16 v[64:67], a[72:75], a[124:127], v[64:67]
    ds_read_b64_tr_b16 a[100:101], v85 offset:39040
    v_mfma_f32_16x16x32_bf16 v[72:75], a[76:79], a[124:127], v[72:75]
    ds_read_b64_tr_b16 a[102:103], v85 offset:39552
    s_cmp_eq_u32 s42, 5
    s_cbranch_scc1 Lxe5
Lxe5_b:
    s_setprio 1
    s_waitcnt lgkmcnt(10)
    v_mfma_f32_16x16x32_bf16 v[28:31], a[80:83], a[64:67], v[28:31]
    ds_read_b128 a[72:75], v77 offset:39040
    ds_read_b128 a[76:79], v79 offset:39040
    v_mfma_f32_16x16x32_bf16 v[44:47], a[80:83], a[68:71], v[44:47]
    ds_read_b64_tr_b16 a[104:105], v20 offset:43136
    s_waitcnt lgkmcnt(11)
    v_mfma_f32_16x16x32_bf16 v[32:35], a[84:87], a[64:67], v[32:35]
    ds_read_b64_tr_b16 a[106:107], v20 offset:43648
    v_mfma_f32_16x16x32_bf16 v[48:51], a[84:87], a[68:71], v[48:51]
    ds_read_b64_tr_b16 a[108:109], v21 offset:43136
    s_waitcnt lgkmcnt(11)
    v_mfma_f32_16x16x32_bf16 v[36:39], a[88:91], a[64:67], v[36:39]
    ds_read_b64_tr_b16 a[110:111], v21 offset:43648
    ds_read_b64_tr_b16 a[112:113], v22 offset:43136
    v_mfma_f32_16x16x32_bf16 v[52:55], a[88:91], a[68:71], v[52:55]
    ds_read_b64_tr_b16 a[114:115], v22 offset:43648
    s_setprio 0
    s_waitcnt lgkmcnt(12)
    v_mfma_f32_16x16x32_bf16 v[40:43], a[92:95], a[64:67], v[40:43]
    ds_read_b64_tr_b16 a[116:117], v23 offset:43136
    v_mfma_f32_16x16x32_bf16 v[56:59], a[92:95], a[68:71], v[56:59]
    ds_read_b64_tr_b16 a[118:119], v23 offset:43648
    s_waitcnt lgkmcnt(12)
    v_mfma_f32_16x16x32_bf16 v[60:63], a[64:67], a[96:99], v[60:63]
    ds_read_b64_tr_b16 a[120:121], v84 offset:43136
    v_mfma_f32_16x16x32_bf16 v[68:71], a[68:71], a[96:99], v[68:71]
    ds_read_b64_tr_b16 a[122:123], v84 offset:43648
    s_waitcnt lgkmcnt(12)
    v_mfma_f32_16x16x32_bf16 v[64:67], a[64:67], a[100:103], v[64:67]
    ds_read_b64_tr_b16 a[124:125], v85 offset:43136
    v_mfma_f32_16x16x32_bf16 v[72:75], a[68:71], a[100:103], v[72:75]
    ds_read_b64_tr_b16 a[126:127], v85 offset:43648
    s_barrier
    s_setprio 3
    s_waitcnt lgkmcnt(10)
    v_mfma_f32_16x16x32_bf16 v[28:31], a[104:107], a[72:75], v[28:31]
    ds_read_b128 a[0:3], v80 offset:0
    v_mfma_f32_16x16x32_bf16 v[44:47], a[104:107], a[76:79], v[44:47]
    ds_read_b128 a[4:7], v82 offset:0
    s_waitcnt lgkmcnt(10)
    v_mfma_f32_16x16x32_bf16 v[32:35], a[108:111], a[72:75], v[32:35]
    ds_read_b64_tr_b16 a[80:81], v24 offset:0
    v_mfma_f32_16x16x32_bf16 v[48:51], a[108:111], a[76:79], v[48:51]
    ds_read_b64_tr_b16 a[82:83], v24 offset:512
    s_waitcnt lgkmcnt(10)
    v_mfma_f32_16x16x32_bf16 v[36:39], a[112:115], a[72:75], v[36:39]
    ds_read_b64_tr_b16 a[84:85], v25 offset:0
    v_mfma_f32_16x16x32_bf16 v[52:55], a[112:115], a[76:79], v[52:55]
    s_setprio 2
    s_waitcnt lgkmcnt(9)
    v_mfma_f32_16x16x32_bf16 v[40:43], a[116:119], a[72:75], v[40:43]
    ds_read_b64_tr_b16 a[86:87], v25 offset:512
    v_mfma_f32_16x16x32_bf16 v[56:59], a[116:119], a[76:79], v[56:59]
    ds_read_b64_tr_b16 a[88:89], v26 offset:0
    s_waitcnt lgkmcnt(9)
    v_mfma_f32_16x16x32_bf16 v[60:63], a[72:75], a[120:123], v[60:63]
    ds_read_b64_tr_b16 a[90:91], v26 offset:512
    v_mfma_f32_16x16x32_bf16 v[68:71], a[76:79], a[120:123], v[68:71]
    ds_read_b64_tr_b16 a[92:93], v27 offset:0
    s_waitcnt lgkmcnt(9)
    v_mfma_f32_16x16x32_bf16 v[64:67], a[72:75], a[124:127], v[64:67]
    ds_read_b64_tr_b16 a[94:95], v27 offset:512
    v_mfma_f32_16x16x32_bf16 v[72:75], a[76:79], a[124:127], v[72:75]
    buffer_store_dwordx4 v[100:103], v13, s[28:31], s23 offen offset:1024 sc1
    s_cmp_eq_u32 s42, 6
    s_cbranch_scc1 Lxe6
Lxe6_b:
    s_setprio 1
    s_waitcnt lgkmcnt(6)
    v_mfma_f32_16x16x32_bf16 v[28:31], a[80:83], a[0:3], v[28:31]
    ds_read_b128 a[8:11], v81 offset:0
    ds_read_b128 a[12:15], v83 offset:0
    v_mfma_f32_16x16x32_bf16 v[44:47], a[80:83], a[4:7], v[44:47]
    ds_read_b64_tr_b16 a[104:105], v24 offset:4096
    s_waitcnt lgkmcnt(7)
    v_mfma_f32_16x16x32_bf16 v[32:35], a[84:87], a[0:3], v[32:35]
    ds_read_b64_tr_b16 a[106:107], v24 offset:4608
    ds_read_b64_tr_b16 a[108:109], v25 offset:4096
    v_mfma_f32_16x16x32_bf16 v[48:51], a[84:87], a[4:7], v[48:51]
    ds_read_b64_tr_b16 a[110:111], v25 offset:4608
    s_setprio 0
    s_waitcnt lgkmcnt(8)
    v_mfma_f32_16x16x32_bf16 v[36:39], a[88:91], a[0:3], v[36:39]
    v_mfma_f32_16x16x32_bf16 v[52:55], a[88:91], a[4:7], v[52:55]
    ds_read_b64_tr_b16 a[112:113], v26 offset:4096
    ds_read_b64_tr_b16 a[114:115], v26 offset:4608
    s_waitcnt lgkmcnt(8)
    v_mfma_f32_16x16x32_bf16 v[40:43], a[92:95], a[0:3], v[40:43]
    ds_read_b64_tr_b16 a[116:117], v27 offset:4096
    v_mfma_f32_16x16x32_bf16 v[56:59], a[92:95], a[4:7], v[56:59]
    ds_read_b64_tr_b16 a[118:119], v27 offset:4608
    s_barrier
    s_setprio 3
    s_waitcnt lgkmcnt(6)
    v_mfma_f32_16x16x32_bf16 v[28:31], a[104:107], a[8:11], v[28:31]
    ds_read_b128 a[16:19], v80 offset:39040
    ds_read_b128 a[20:23], v82 offset:39040
    v_mfma_f32_16x16x32_bf16 v[44:47], a[104:107], a[12:15], v[44:47]
    ds_read_b64_tr_b16 a[80:81], v24 offset:39040
    s_waitcnt lgkmcnt(7)
    v_mfma_f32_16x16x32_bf16 v[32:35], a[108:111], a[8:11], v[32:35]
    ds_read_b64_tr_b16 a[82:83], v24 offset:39552
    v_mfma_f32_16x16x32_bf16 v[48:51], a[108:111], a[12:15], v[48:51]
    ds_read_b64_tr_b16 a[84:85], v25 offset:39040
    s_setprio 2
    s_waitcnt lgkmcnt(7)
    v_mfma_f32_16x16x32_bf16 v[36:39], a[112:115], a[8:11], v[36:39]
    ds_read_b64_tr_b16 a[86:87], v25 offset:39552
    ds_read_b64_tr_b16 a[88:89], v26 offset:39040
    v_mfma_f32_16x16x32_bf16 v[52:55], a[112:115], a[12:15], v[52:55]
    ds_read_b64_tr_b16 a[90:91], v26 offset:39552
    s_waitcnt lgkmcnt(8)
    v_mfma_f32_16x16x32_bf16 v[40:43], a[116:119], a[8:11], v[40:43]
    ds_read_b64_tr_b16 a[92:93], v27 offset:39040
    v_mfma_f32_16x16x32_bf16 v[56:59], a[116:119], a[12:15], v[56:59]
    ds_read_b64_tr_b16 a[94:95], v27 offset:39552
    s_cmp_eq_u32 s42, 7
    s_cbranch_scc1 Lxe7
Lxe7_b:
    s_setprio 1
    s_waitcnt lgkmcnt(6)
    v_mfma_f32_16x16x32_bf16 v[28:31], a[80:83], a[16:19], v[28:31]
    ds_read_b128 a[24:27], v81 offset:39040
    ds_read_b128 a[28:31], v83 offset:39040
    v_mfma_f32_16x16x32_bf16 v[44:47], a[80:83], a[20:23], v[44:47]
    ds_read_b64_tr_b16 a[104:105], v24 offset:43136
    s_waitcnt lgkmcnt(7)
    v_mfma_f32_16x16x32_bf16 v[32:35], a[84:87], a[16:19], v[32:35]
    ds_read_b64_tr_b16 a[106:107], v24 offset:43648
    ds_read_b64_tr_b16 a[108:109], v25 offset:43136
    v_mfma_f32_16x16x32_bf16 v[48:51], a[84:87], a[20:23], v[48:51]
    ds_read_b64_tr_b16 a[110:111], v25 offset:43648
    s_setprio 0
    s_waitcnt lgkmcnt(8)
    v_mfma_f32_16x16x32_bf16 v[36:39], a[88:91], a[16:19], v[36:39]
    v_mfma_f32_16x16x32_bf16 v[52:55], a[88:91], a[20:23], v[52:55]
    ds_read_b64_tr_b16 a[112:113], v26 offset:43136
    ds_read_b64_tr_b16 a[114:115], v26 offset:43648
    s_waitcnt lgkmcnt(8)
    v_mfma_f32_16x16x32_bf16 v[40:43], a[92:95], a[16:19], v[40:43]
    ds_read_b64_tr_b16 a[116:117], v27 offset:43136
    v_mfma_f32_16x16x32_bf16 v[56:59], a[92:95], a[20:23], v[56:59]
    ds_read_b64_tr_b16 a[118:119], v27 offset:43648
    s_barrier
    s_setprio 3
    s_waitcnt lgkmcnt(6)
    v_mfma_f32_16x16x32_bf16 v[28:31], a[104:107], a[24:27], v[28:31]
    ds_read_b128 a[32:35], v76 offset:0
    ds_read_b128 a[36:39], v78 offset:0
    v_mfma_f32_16x16x32_bf16 v[44:47], a[104:107], a[28:31], v[44:47]
    ds_read_b64_tr_b16 a[80:81], v20 offset:0
    s_waitcnt lgkmcnt(7)
    v_mfma_f32_16x16x32_bf16 v[32:35], a[108:111], a[24:27], v[32:35]
    ds_read_b64_tr_b16 a[82:83], v20 offset:512
    v_mfma_f32_16x16x32_bf16 v[48:51], a[108:111], a[28:31], v[48:51]
    ds_read_b64_tr_b16 a[84:85], v21 offset:0
    s_setprio 2
    s_waitcnt lgkmcnt(7)
    v_mfma_f32_16x16x32_bf16 v[36:39], a[112:115], a[24:27], v[36:39]
    ds_read_b64_tr_b16 a[86:87], v21 offset:512
    ds_read_b64_tr_b16 a[88:89], v22 offset:0
    v_mfma_f32_16x16x32_bf16 v[52:55], a[112:115], a[28:31], v[52:55]
    ds_read_b64_tr_b16 a[90:91], v22 offset:512
    s_waitcnt lgkmcnt(8)
    v_mfma_f32_16x16x32_bf16 v[40:43], a[116:119], a[24:27], v[40:43]
    ds_read_b64_tr_b16 a[92:93], v23 offset:0
    v_mfma_f32_16x16x32_bf16 v[56:59], a[116:119], a[28:31], v[56:59]
    ds_read_b64_tr_b16 a[94:95], v23 offset:512
    s_cmp_eq_u32 s42, 8
    s_cbranch_scc1 Lxe8
Lxe8_b:
    s_setprio 1
    s_waitcnt lgkmcnt(6)
    v_mfma_f32_16x16x32_bf16 v[28:31], a[80:83], a[32:35], v[28:31]
    ds_read_b128 a[40:43], v77 offset:0
    ds_read_b128 a[44:47], v79 offset:0
    v_mfma_f32_16x16x32_bf16 v[44:47], a[80:83], a[36:39], v[44:47]
    ds_read_b64_tr_b16 a[104:105], v20 offset:4096
    s_waitcnt lgkmcnt(7)
    v_mfma_f32_16x16x32_bf16 v[32:35], a[84:87], a[32:35], v[32:35]
    ds_read_b64_tr_b16 a[106:107], v20 offset:4608
    v_mfma_f32_16x16x32_bf16 v[48:51], a[84:87], a[36:39], v[48:51]
    ds_read_b64_tr_b16 a[108:109], v21 offset:4096
    s_setprio 0
    s_waitcnt lgkmcnt(7)
    v_mfma_f32_16x16x32_bf16 v[36:39], a[88:91], a[32:35], v[36:39]
    ds_read_b64_tr_b16 a[110:111], v21 offset:4608
    ds_read_b64_tr_b16 a[112:113], v22 offset:4096
    v_mfma_f32_16x16x32_bf16 v[52:55], a[88:91], a[36:39], v[52:55]
    ds_read_b64_tr_b16 a[114:115], v22 offset:4608
    s_waitcnt lgkmcnt(8)
    v_mfma_f32_16x16x32_bf16 v[40:43], a[92:95], a[32:35], v[40:43]
    ds_read_b64_tr_b16 a[116:117], v23 offset:4096
    v_mfma_f32_16x16x32_bf16 v[56:59], a[92:95], a[36:39], v[56:59]
    ds_read_b64_tr_b16 a[118:119], v23 offset:4608
    s_waitcnt lgkmcnt(0)
    s_barrier
    s_setprio 3
    v_mfma_f32_16x16x32_bf16 v[28:31], a[104:107], a[40:43], v[28:31]
    ds_read_b128 a[48:51], v76 offset:39040
    ds_read_b128 a[52:55], v78 offset:39040
    v_mfma_f32_16x16x32_bf16 v[44:47], a[104:107], a[44:47], v[44:47]
    ds_read_b64_tr_b16 a[80:81], v20 offset:39040
    v_mfma_f32_16x16x32_bf16 v[32:35], a[108:111], a[40:43], v[32:35]
    ds_read_b64_tr_b16 a[82:83], v20 offset:39552
    v_mfma_f32_16x16x32_bf16 v[48:51], a[108:111], a[44:47], v[48:51]
    ds_read_b64_tr_b16 a[84:85], v21 offset:39040
    s_setprio 2
    v_mfma_f32_16x16x32_bf16 v[36:39], a[112:115], a[40:43], v[36:39]
    ds_read_b64_tr_b16 a[86:87], v21 offset:39552
    ds_read_b64_tr_b16 a[88:89], v22 offset:39040
    v_mfma_f32_16x16x32_bf16 v[52:55], a[112:115], a[44:47], v[52:55]
    ds_read_b64_tr_b16 a[90:91], v22 offset:39552
    v_mfma_f32_16x16x32_bf16 v[40:43], a[116:119], a[40:43], v[40:43]
    ds_read_b64_tr_b16 a[92:93], v23 offset:39040
    v_mfma_f32_16x16x32_bf16 v[56:59], a[116:119], a[44:47], v[56:59]
    ds_read_b64_tr_b16 a[94:95], v23 offset:39552
    v_mov_b32 v98, s34
    s_waitcnt vmcnt(0)
    s_mov_b64 exec, 1
    buffer_store_dword v98, v97, s[28:31], s24 offen sc1
    s_mov_b64 exec, -1
    s_cmp_eq_u32 s42, 9
    s_cbranch_scc1 Lxe9
Lxe9_b:
    s_setprio 1
    s_waitcnt lgkmcnt(6)
    v_mfma_f32_16x16x32_bf16 v[28:31], a[80:83], a[48:51], v[28:31]
    ds_read_b128 a[56:59], v77 offset:39040
    ds_read_b128 a[60:63], v79 offset:39040
    ds_read_b64_tr_b16 a[104:105], v20 offset:43136
    v_mfma_f32_16x16x32_bf16 v[44:47], a[80:83], a[52:55], v[44:47]
    ds_read_b64_tr_b16 a[106:107], v20 offset:43648
    ds_read_b64_tr_b16 a[108:109], v21 offset:43136
    s_waitcnt lgkmcnt(9)
    v_mfma_f32_16x16x32_bf16 v[32:35], a[84:87], a[48:51], v[32:35]
    ds_read_b64_tr_b16 a[110:111], v21 offset:43648
    ds_read_b64_tr_b16 a[112:113], v22 offset:43136
    ds_read_b64_tr_b16 a[114:115], v22 offset:43648
    v_mfma_f32_16x16x32_bf16 v[48:51], a[84:87], a[52:55], v[48:51]
    ds_read_b64_tr_b16 a[116:117], v23 offset:43136
    ds_read_b64_tr_b16 a[118:119], v23 offset:43648
    s_setprio 0
    s_waitcnt lgkmcnt(12)
    v_mfma_f32_16x16x32_bf16 v[36:39], a[88:91], a[48:51], v[36:39]
    ds_read_b32 v120, v94
    ds_read_b32 v121, v94 offset:512
    v_xor_b32 v94, 64, v94
    v_mfma_f32_16x16x32_bf16 v[52:55], a[88:91], a[52:55], v[52:55]
    ds_read_b32 v122, v94
    ds_read_b32 v123, v92 offset:512
    s_waitcnt lgkmcnt(14)
    v_mfma_f32_16x16x32_bf16 v[40:43], a[92:95], a[48:51], v[40:43]
    ds_read_b32 v126, v93 offset:520
    v_mov_b32 v24, v84
    v_mov_b32 v25, v85
    v_mfma_f32_16x16x32_bf16 v[56:59], a[92:95], a[52:55], v[56:59]
    v_mov_b32 v26, v86
    v_mov_b32 v27, v87
    s_waitcnt lgkmcnt(5)
    v_mfma_f32_16x16x32_bf16 v[44:47], a[104:107], a[60:63], v[44:47]
    v_mfma_f32_16x16x32_bf16 v[48:51], a[108:111], a[60:63], v[48:51]
    v_mfma_f32_16x16x32_bf16 v[52:55], a[112:115], a[60:63], v[52:55]
    v_mfma_f32_16x16x32_bf16 v[56:59], a[116:119], a[60:63], v[56:59]
    v_mfma_f32_16x16x32_bf16 v[28:31], a[104:107], a[56:59], v[28:31]
    v_mfma_f32_16x16x32_bf16 v[32:35], a[108:111], a[56:59], v[32:35]
    ds_read_b32 v7, v96
    ds_read_b128 v[76:79], v95 offset:0
    ds_read_b128 v[80:83], v95 offset:64
    ds_read_b128 v[84:87], v95 offset:128
    ds_read_b128 v[88:91], v95 offset:192
    v_mfma_f32_16x16x32_bf16 v[36:39], a[112:115], a[56:59], v[36:39]
    v_mfma_f32_16x16x32_bf16 v[40:43], a[116:119], a[56:59], v[40:43]
    s_waitcnt lgkmcnt(0)
Lqf:
    v_readfirstlane_b32 s38, v7
    s_nop 0
    s_cmp_eq_u32 s38, 0
    s_cbranch_scc1 Lqf_re
    s_cmp_eq_u32 s27, 0
    v_fmac_f32 v44, v76, v122
    v_fmac_f32 v45, v77, v122
    v_fmac_f32 v46, v78, v122
    v_fmac_f32 v47, v79, v122
    v_cvt_pk_bf16_f32 v44, v44, v45
    v_cvt_pk_bf16_f32 v45, v46, v47
    v_fmac_f32 v48, v80, v122
    v_fmac_f32 v49, v81, v122
    v_fmac_f32 v50, v82, v122
    v_fmac_f32 v51, v83, v122
    v_cvt_pk_bf16_f32 v46, v48, v49
    v_cvt_pk_bf16_f32 v47, v50, v51
    v_fmac_f32 v52, v84, v122
    v_fmac_f32 v53, v85, v122
    v_fmac_f32 v54, v86, v122
    v_fmac_f32 v55, v87, v122
    v_cvt_pk_bf16_f32 v48, v52, v53
    v_cvt_pk_bf16_f32 v49, v54, v55
    v_fmac_f32 v56, v88, v122
    v_fmac_f32 v57, v89, v122
    v_fmac_f32 v58, v90, v122
    v_fmac_f32 v59, v91, v122
    v_cvt_pk_bf16_f32 v50, v56, v57
    v_cvt_pk_bf16_f32 v51, v58, v59
    s_cbranch_scc1 Lh1
    s_setprio 3
    ds_write_b128 v125, v[44:47] offset:2048
    ds_write_b128 v125, v[48:51] offset:3072
    v_fmac_f32 v28, v76, v120
    v_fmac_f32 v29, v77, v120
    v_fmac_f32 v30, v78, v120
    v_fmac_f32 v31, v79, v120
    v_cvt_pk_bf16_f32 v52, v28, v29
    v_cvt_pk_bf16_f32 v53, v30, v31
    v_fmac_f32 v32, v80, v120
    v_fmac_f32 v33, v81, v120
    v_fmac_f32 v34, v82, v120
    v_fmac_f32 v35, v83, v120
    v_cvt_pk_bf16_f32 v54, v32, v33
    v_cvt_pk_bf16_f32 v55, v34, v35
    v_fmac_f32 v36, v84, v120
    v_fmac_f32 v37, v85, v120
    v_fmac_f32 v38, v86, v120
    v_fmac_f32 v39, v87, v120
    v_cvt_pk_bf16_f32 v56, v36, v37
    v_cvt_pk_bf16_f32 v57, v38, v39
    v_fmac_f32 v40, v88, v120
    v_fmac_f32 v41, v89, v120
    v_fmac_f32 v42, v90, v120
    v_fmac_f32 v43, v91, v120
    v_cvt_pk_bf16_f32 v58, v40, v41
    v_cvt_pk_bf16_f32 v59, v42, v43
    ds_write_b128 v125, v[52:55] offset:4096
    ds_write_b128 v125, v[56:59] offset:5120
    v_mov_b32 v5, 157972
    v_mov_b32 v6, 1
    s_mov_b64 exec, 1
    ds_add_u32 v5, v6
    s_mov_b64 exec, -1
    v_mov_b32 v8, s22
    v_mov_b32 v9, s22
    v_mov_b32 v10, s22
    v_mov_b32 v11, s22
Lcw_1:
    s_sub_u32 s35, s35, 1
    s_cbranch_scc1 Lend
    ds_read_b32 v6, v5
    s_waitcnt lgkmcnt(0)
    v_readfirstlane_b32 s38, v6
    s_nop 0
    s_cmp_lt_u32 s38, 8
    s_cbranch_scc1 Lcw_1
    ds_read_b128 v[28:31], v125 offset:0
    ds_read_b128 v[32:35], v125 offset:1024
Lh_join:
    buffer_load_dword v20, v12, s[28:31], s24 offen sc1
    ds_read_b64_tr_b16 a[64:65], v26 offset:0
    ds_read_b64_tr_b16 a[66:67], v26 offset:512
    ds_read_b64_tr_b16 a[68:69], v27 offset:0
    ds_read_b64_tr_b16 a[70:71], v27 offset:512
    ds_read_b64_tr_b16 a[72:73], v26 offset:4096
    ds_read_b64_tr_b16 a[74:75], v26 offset:4608
    ds_read_b64_tr_b16 a[76:77], v27 offset:4096
    ds_read_b64_tr_b16 a[78:79], v27 offset:4608
    s_waitcnt lgkmcnt(8)
    s_setprio 3
    v_cndmask_b32 v92, 0, v30, s[6:7]
    v_cndmask_b32 v93, 0, v31, s[6:7]
    v_cndmask_b32 v94, 0, v32, s[12:13]
    v_cndmask_b32 v95, 0, v33, s[12:13]
    v_cndmask_b32 v104, 0, v30, s[8:9]
    v_cndmask_b32 v105, 0, v31, s[8:9]
    v_mfma_f32_16x16x32_bf16 v[76:79], v[46:49], v[92:95], v[8:11]
    v_mfma_f32_16x16x32_bf16 v[80:83], v[54:57], v[92:95], 0
    v_cndmask_b32 v106, 0, v32, s[14:15]
    v_cndmask_b32 v107, 0, v33, s[14:15]
    v_mov_b32 v96, v28
    v_mov_b32 v97, v29
    v_mfma_f32_16x16x32_bf16 v[84:87], v[46:49], v[104:107], v[8:11]
    v_mfma_f32_16x16x32_bf16 v[88:91], v[54:57], v[104:107], 0
    v_cndmask_b32 v98, 0, v30, s[10:11]
    v_cndmask_b32 v99, 0, v31, s[10:11]
    v_cndmask_b32 v100, 0, v32, s[16:17]
    v_cndmask_b32 v101, 0, v33, s[16:17]
    v_mfma_f32_16x16x32_bf16 v[36:39], v[44:47], v[96:99], v[8:11]
    v_mfma_f32_16x16x32_bf16 v[40:43], v[52:55], v[96:99], 0
    v_cndmask_b32 v76, v76, v77, s[4:5]
    v_cndmask_b32 v80, v80, v81, s[4:5]
    v_cndmask_b32 v78, v78, v79, s[4:5]
    v_cndmask_b32 v82, v82, v83, s[4:5]
    v_cndmask_b32 v92, v76, v80, s[18:19]
    v_cndmask_b32 v94, v78, v82, s[20:21]
    v_min_u32 v4, -2, v92
    v_min_u32 v5, -2, v94
    v_cndmask_b32 v84, v84, v85, s[4:5]
    v_cndmask_b32 v88, v88, v89, s[4:5]
    v_cndmask_b32 v86, v86, v87, s[4:5]
    v_cndmask_b32 v90, v90, v91, s[4:5]
    v_cndmask_b32 v104, v84, v88, s[18:19]
    v_cndmask_b32 v106, v86, v90, s[20:21]
    v_min_u32 v6, -2, v104
    v_min_u32 v7, -2, v106
    buffer_store_dwordx4 v[4:7], v13, s[28:31], s58 offen sc1
    s_setprio 2
    ds_read_b64_tr_b16 a[80:81], v26 offset:39040
    ds_read_b64_tr_b16 a[82:83], v26 offset:39552
    ds_read_b64_tr_b16 a[84:85], v27 offset:39040
    ds_read_b64_tr_b16 a[86:87], v27 offset:39552
    ds_read_b64_tr_b16 a[88:89], v26 offset:43136
    ds_read_b64_tr_b16 a[90:91], v26 offset:43648
    ds_read_b64_tr_b16 a[92:93], v27 offset:43136
    ds_read_b64_tr_b16 a[94:95], v27 offset:43648
    ds_read_b64_tr_b16 a[96:97], v24 offset:0
    ds_read_b64_tr_b16 a[98:99], v24 offset:512
    ds_read_b64_tr_b16 a[100:101], v25 offset:0
    ds_read_b64_tr_b16 a[102:103], v25 offset:512
    ds_read_b64_tr_b16 a[104:105], v24 offset:4096
    ds_read_b64_tr_b16 a[106:107], v24 offset:4608
    ds_read_b64_tr_b16 a[108:109], v25 offset:4096
    ds_read_b64_tr_b16 a[110:111], v25 offset:4608
    ds_read_b64_tr_b16 a[112:113], v24 offset:39040
    ds_read_b64_tr_b16 a[114:115], v24 offset:39552
    ds_read_b64_tr_b16 a[116:117], v25 offset:39040
    ds_read_b64_tr_b16 a[118:119], v25 offset:39552
    ds_read_b64_tr_b16 a[120:121], v24 offset:43136
    ds_read_b64_tr_b16 a[122:123], v24 offset:43648
    ds_read_b64_tr_b16 a[124:125], v25 offset:43136
    ds_read_b64_tr_b16 a[126:127], v25 offset:43648
    s_waitcnt lgkmcnt(15)
    v_mfma_f32_16x16x32_bf16 v[60:63], a[0:3], a[64:67], v[60:63]
    v_mov_b32 v102, v34
    v_mov_b32 v103, v35
    v_mul_f32 v4, s25, v121
    v_mfma_f32_16x16x32_bf16 v[68:71], a[4:7], a[64:67], v[68:71]
    v_mfma_f32_16x16x32_bf16 v[76:79], v[48:51], v[100:103], v[8:11]
    v_mfma_f32_16x16x32_bf16 v[80:83], v[56:59], v[100:103], 0
    v_mul_f32 v123, v123, v4
    v_mfma_f32_16x16x32_bf16 v[64:67], a[0:3], a[68:71], v[64:67]
    v_mul_f32 v126, v126, v4
    v_cndmask_b32 v36, v36, v37, s[4:5]
    v_cndmask_b32 v40, v40, v41, s[4:5]
    v_mfma_f32_16x16x32_bf16 v[72:75], a[4:7], a[68:71], v[72:75]
    v_cndmask_b32 v38, v38, v39, s[4:5]
    v_cndmask_b32 v42, v42, v43, s[4:5]
    v_cndmask_b32 v96, v36, v40, s[18:19]
    v_mfma_f32_16x16x32_bf16 v[60:63], a[8:11], a[72:75], v[60:63]
    v_cndmask_b32 v98, v38, v42, s[20:21]
    v_cndmask_b32 v76, v76, v77, s[4:5]
    v_cndmask_b32 v80, v80, v81, s[4:5]
    v_mfma_f32_16x16x32_bf16 v[68:71], a[12:15], a[72:75], v[68:71]
    v_cndmask_b32 v78, v78, v79, s[4:5]
    v_cndmask_b32 v82, v82, v83, s[4:5]
    v_cndmask_b32 v100, v76, v80, s[18:19]
    v_mfma_f32_16x16x32_bf16 v[64:67], a[8:11], a[76:79], v[64:67]
    v_cndmask_b32 v102, v78, v82, s[20:21]
    v_mul_f32 v96, v96, v123
    v_mul_f32 v98, v98, v126
    v_mfma_f32_16x16x32_bf16 v[72:75], a[12:15], a[76:79], v[72:75]
    v_mul_f32 v100, v100, v123
    v_mul_f32 v102, v102, v126
    v_max_f32 v4, v96, v98
    v_mfma_f32_16x16x32_bf16 v[60:63], a[16:19], a[80:83], v[60:63]
    v_max_f32 v5, v100, v102
    v_mov_b32 v6, v4
    v_mov_b32 v7, v5
    v_mfma_f32_16x16x32_bf16 v[68:71], a[20:23], a[80:83], v[68:71]
    v_permlane32_swap_b32 v4, v6
    v_permlane32_swap_b32 v5, v7
    v_max_f32 v4, v4, v6
    v_mfma_f32_16x16x32_bf16 v[64:67], a[16:19], a[84:87], v[64:67]
    v_max_f32 v5, v5, v7
    v_mov_b32 v6, v4
    v_mov_b32 v7, v5
    v_mfma_f32_16x16x32_bf16 v[72:75], a[20:23], a[84:87], v[72:75]
    v_permlane16_swap_b32 v4, v6
    v_permlane16_swap_b32 v5, v7
    s_setprio 1
    v_mfma_f32_16x16x32_bf16 v[60:63], a[24:27], a[88:91], v[60:63]
    v_max_f32 v4, v4, v6
    v_max_f32 v5, v5, v7
    v_sub_f32 v96, v96, v4
    v_mfma_f32_16x16x32_bf16 v[68:71], a[28:31], a[88:91], v[68:71]
    v_sub_f32 v98, v98, v4
    v_sub_f32 v100, v100, v5
    v_sub_f32 v102, v102, v5
    v_mfma_f32_16x16x32_bf16 v[64:67], a[24:27], a[92:95], v[64:67]
    v_exp_f32 v96, v96
    v_exp_f32 v98, v98
    v_exp_f32 v100, v100
    v_mfma_f32_16x16x32_bf16 v[72:75], a[28:31], a[92:95], v[72:75]
    v_exp_f32 v102, v102
    v_cvt_pk_bf16_f32 v96, v96, v96
    s_waitcnt lgkmcnt(12)
    v_mfma_f32_16x16x32_bf16 v[60:63], a[32:35], a[96:99], v[60:63]
    v_cvt_pk_bf16_f32 v97, v98, v98
    v_cvt_pk_bf16_f32 v100, v100, v100
    v_cvt_pk_bf16_f32 v101, v102, v102
    v_mfma_f32_16x16x32_bf16 v[68:71], a[36:39], a[96:99], v[68:71]
    v_and_b32 v98, v96, v118
    v_and_b32 v99, v97, v119
    v_and_b32 v96, v96, v116
    v_mfma_f32_16x16x32_bf16 v[64:67], a[32:35], a[100:103], v[64:67]
    v_and_b32 v97, v97, v117
    v_and_b32 v102, v100, v118
    v_and_b32 v103, v101, v119
    v_mfma_f32_16x16x32_bf16 v[72:75], a[36:39], a[100:103], v[72:75]
    v_and_b32 v100, v100, v116
    v_and_b32 v101, v101, v117
    s_waitcnt lgkmcnt(8)
    v_mfma_f32_16x16x32_bf16 v[60:63], a[40:43], a[104:107], v[60:63]
    s_lshl_b32 s36, s44, 6
    s_add_u32 s36, s36, 156160
    v_lshl_add_u32 v48, v2, 4, s36
    v_xor_b32 v49, 64, v48
    ds_read_b128 v[28:31], v48 offset:0
    v_mfma_f32_16x16x32_bf16 v[68:71], a[44:47], a[104:107], v[68:71]
    ds_read_b128 v[32:35], v48 offset:512
    ds_read_b128 v[36:39], v49 offset:0
    ds_read_b128 v[40:43], v49 offset:512
    s_lshl_b32 s36, s27, 3
    s_add_u32 s36, s36, 157696
    v_mfma_f32_16x16x32_bf16 v[64:67], a[40:43], a[108:111], v[64:67]
    v_lshl_add_u32 v48, v3, 4, s36
    v_mov_b32 v49, 157952
    v_lshl_add_u32 v125, v1, 3, s45
    s_lshl_b32 s36, s27, 10
    v_add_u32 v50, s36, v125
    v_mfma_f32_16x16x32_bf16 v[72:75], a[44:47], a[108:111], v[72:75]
    s_lshl_b32 s37, s27, 12
    s_sub_u32 s37, 2048, s37
    v_add_u32 v51, s37, v50
    v_subrev_u32 v125, 2048, v125
    s_setprio 0
    s_waitcnt lgkmcnt(8)
    v_mfma_f32_16x16x32_bf16 v[60:63], a[48:51], a[112:115], v[60:63]
    v_mfma_f32_16x16x32_bf16 v[68:71], a[52:55], a[112:115], v[68:71]
    v_mfma_f32_16x16x32_bf16 v[64:67], a[48:51], a[116:119], v[64:67]
    v_mfma_f32_16x16x32_bf16 v[72:75], a[52:55], a[116:119], v[72:75]
    s_waitcnt vmcnt(1)
Lfl_chk:
    v_cmp_eq_u32 vcc, s34, v20
    s_nop 0
    s_and_b32 s36, vcc_lo, 0x3ff
    s_cmp_lg_u32 s36, 0x3ff
    s_cbranch_scc1 Lfl_re
    buffer_load_dwordx2 v[52:53], v13, s[28:31], s59 offen offset:8 sc1
    buffer_load_dwordx2 v[54:55], v13, s[28:31], s60 offen offset:0 sc1
    s_waitcnt lgkmcnt(4)
    v_mfma_f32_16x16x32_bf16 v[60:63], a[56:59], a[120:123], v[60:63]
    v_mfma_f32_16x16x32_bf16 v[68:71], a[60:63], a[120:123], v[68:71]
    v_mfma_f32_16x16x32_bf16 v[64:67], a[56:59], a[124:127], v[64:67]
    v_mfma_f32_16x16x32_bf16 v[72:75], a[60:63], a[124:127], v[72:75]
    ds_read_b32 v46, v49
    ds_read_b64 v[44:45], v48
    s_waitcnt lgkmcnt(0)
Lcsv:
    v_readfirstlane_b32 s38, v46
    s_nop 0
    s_cmp_eq_u32 s38, 0
    s_cbranch_scc1 Lcsv_re
    v_fmac_f32 v60, v28, v44
    v_fmac_f32 v61, v29, v44
    v_fmac_f32 v62, v30, v44
    v_fmac_f32 v63, v31, v44
    v_mul_f32 v60, v60, v32
    v_mul_f32 v61, v61, v33
    v_mul_f32 v62, v62, v34
    v_mul_f32 v63, v63, v35
    v_cvt_pk_bf16_f32 v60, v60, v61
    v_cvt_pk_bf16_f32 v61, v62, v63
    ds_write_b64 v50, v[60:61] offset:0
    v_fmac_f32 v64, v28, v45
    v_fmac_f32 v65, v29, v45
    v_fmac_f32 v66, v30, v45
    v_fmac_f32 v67, v31, v45
    v_mul_f32 v64, v64, v32
    v_mul_f32 v65, v65, v33
    v_mul_f32 v66, v66, v34
    v_mul_f32 v67, v67, v35
    v_cvt_pk_bf16_f32 v64, v64, v65
    v_cvt_pk_bf16_f32 v65, v66, v67
    ds_write_b64 v50, v[64:65] offset:512
    v_fmac_f32 v68, v36, v44
    v_fmac_f32 v69, v37, v44
    v_fmac_f32 v70, v38, v44
    v_fmac_f32 v71, v39, v44
    v_mul_f32 v68, v68, v40
    v_mul_f32 v69, v69, v41
    v_mul_f32 v70, v70, v42
    v_mul_f32 v71, v71, v43
    v_cvt_pk_bf16_f32 v68, v68, v69
    v_cvt_pk_bf16_f32 v69, v70, v71
    ds_write_b64 v51, v[68:69] offset:0
    v_fmac_f32 v72, v36, v45
    v_fmac_f32 v73, v37, v45
    v_fmac_f32 v74, v38, v45
    v_fmac_f32 v75, v39, v45
    v_mul_f32 v72, v72, v40
    v_mul_f32 v73, v73, v41
    v_mul_f32 v74, v74, v42
    v_mul_f32 v75, v75, v43
    v_cvt_pk_bf16_f32 v72, v72, v73
    v_cvt_pk_bf16_f32 v73, v74, v75
    ds_write_b64 v51, v[72:73] offset:512
    v_mov_b32 v8, 157976
    v_mov_b32 v9, 1
    s_mov_b64 exec, 1
    ds_add_u32 v8, v9
    s_mov_b64 exec, -1
    s_waitcnt vmcnt(0)
Lrx_chk:
    v_and_b32 v52, s61, v52
    v_and_b32 v53, s61, v53
    v_and_b32 v54, s62, v54
    v_and_b32 v55, s62, v55
    v_max3_u32 v4, v52, v53, v54
    v_max_u32 v4, v4, v55
    v_cmp_eq_u32 vcc, -1, v4
    s_nop 0
    s_cbranch_vccnz Lrx_re
    v_add_f32 v92, v92, v52
    v_add_f32 v94, v94, v53
    v_add_f32 v104, v104, v54
    v_add_f32 v106, v106, v55
Lcw_4:
    s_sub_u32 s35, s35, 1
    s_cbranch_scc1 Lend
    ds_read_b32 v9, v8
    s_waitcnt lgkmcnt(0)
    v_readfirstlane_b32 s38, v9
    s_nop 0
    s_cmp_lt_u32 s38, 7
    s_cbranch_scc1 Lcw_4
    s_setprio 2
    ds_read2st64_b64 v[60:63], v125 offset0:0 offset1:4
    ds_read2st64_b64 v[64:67], v125 offset0:1 offset1:5
    ds_read2st64_b64 v[68:71], v125 offset0:2 offset1:6
    ds_read2st64_b64 v[72:75], v125 offset0:3 offset1:7
    v_mul_f32 v92, v92, v123
    v_mul_f32 v94, v94, v126
    v_mul_f32 v104, v104, v123
    v_mul_f32 v106, v106, v126
    v_max_f32 v4, v92, v94
    v_max_f32 v5, v104, v106
    v_mov_b32 v6, v4
    v_mov_b32 v7, v5
    s_nop 0
    v_permlane32_swap_b32 v4, v6
    v_permlane32_swap_b32 v5, v7
    v_max_f32 v4, v4, v6
    v_max_f32 v5, v5, v7
    s_waitcnt lgkmcnt(0)
    v_mov_b32 v6, v4
    v_mfma_f32_16x16x32_bf16 v[80:83], v[14:17], v[96:99], 0
    v_mov_b32 v7, v5
    v_permlane16_swap_b32 v4, v6
    s_nop 0
    v_permlane16_swap_b32 v5, v7
    v_max_f32 v4, v4, v6
    v_mfma_f32_16x16x32_bf16 v[84:87], v[14:17], v[100:103], 0
    v_max_f32 v5, v5, v7
    v_sub_f32 v92, v92, v4
    v_sub_f32 v94, v94, v4
    v_sub_f32 v104, v104, v5
    v_mfma_f32_16x16x32_bf16 v[28:31], v[60:63], v[96:99], 0
    v_sub_f32 v106, v106, v5
    v_exp_f32 v92, v92
    v_exp_f32 v94, v94
    v_exp_f32 v104, v104
    v_exp_f32 v106, v106
    v_mfma_f32_16x16x32_bf16 v[32:35], v[64:67], v[96:99], 0
    v_cvt_pk_bf16_f32 v92, v92, v92
    v_cvt_pk_bf16_f32 v93, v94, v94
    v_cvt_pk_bf16_f32 v104, v104, v104
    v_cvt_pk_bf16_f32 v105, v106, v106
    v_mfma_f32_16x16x32_bf16 v[36:39], v[68:71], v[100:103], 0
    v_and_b32 v94, v92, v118
    v_and_b32 v95, v93, v119
    v_and_b32 v92, v92, v116
    v_and_b32 v93, v93, v117
    v_mfma_f32_16x16x32_bf16 v[40:43], v[72:75], v[100:103], 0
    v_and_b32 v106, v104, v118
    v_and_b32 v107, v105, v119
    v_and_b32 v104, v104, v116
    v_and_b32 v105, v105, v117
    v_mfma_f32_16x16x32_bf16 v[76:79], v[14:17], v[92:95], 0
    v_rcp_f32 v80, v80
    v_rcp_f32 v84, v84
    v_mfma_f32_16x16x32_bf16 v[88:91], v[14:17], v[104:107], 0
    v_mul_f32 v28, v28, v80
    v_mul_f32 v29, v29, v80
    v_mfma_f32_16x16x32_bf16 v[44:47], v[64:67], v[92:95], 0
    v_mul_f32 v30, v30, v80
    v_mfma_f32_16x16x32_bf16 v[48:51], v[68:71], v[92:95], 0
    v_mul_f32 v31, v31, v80
    v_cvt_pk_bf16_f32 v4, v28, v29
    v_mfma_f32_16x16x32_bf16 v[52:55], v[64:67], v[104:107], 0
    v_cvt_pk_bf16_f32 v5, v30, v31
    v_min_u32 v4, -2, v4
    v_mfma_f32_16x16x32_bf16 v[56:59], v[68:71], v[104:107], 0
    v_min_u32 v5, -2, v5
    v_mul_f32 v40, v40, v84
    v_mul_f32 v41, v41, v84
    v_mul_f32 v42, v42, v84
    v_mul_f32 v43, v43, v84
    v_cvt_pk_bf16_f32 v10, v40, v41
    v_cvt_pk_bf16_f32 v11, v42, v43
    v_min_u32 v10, -2, v10
    v_min_u32 v11, -2, v11
    v_rcp_f32 v76, v76
    v_rcp_f32 v88, v88
    v_cndmask_b32 v82, v80, v76, s[6:7]
    v_cndmask_b32 v82, v82, v88, s[8:9]
    v_cndmask_b32 v32, v32, v44, s[6:7]
    v_cndmask_b32 v33, v33, v45, s[6:7]
    v_cndmask_b32 v34, v34, v46, s[6:7]
    v_cndmask_b32 v35, v35, v47, s[6:7]
    v_cndmask_b32 v32, v32, v52, s[8:9]
    v_cndmask_b32 v33, v33, v53, s[8:9]
    v_cndmask_b32 v34, v34, v54, s[8:9]
    v_cndmask_b32 v35, v35, v55, s[8:9]
    v_mul_f32 v32, v32, v82
    v_mul_f32 v33, v33, v82
    v_mul_f32 v34, v34, v82
    v_mul_f32 v35, v35, v82
    v_cvt_pk_bf16_f32 v6, v32, v33
    v_cvt_pk_bf16_f32 v7, v34, v35
    v_min_u32 v6, -2, v6
    v_min_u32 v7, -2, v7
    buffer_store_dwordx4 v[4:7], v13, s[28:31], s23 offen offset:0 sc1
    v_cndmask_b32 v86, v84, v76, s[12:13]
    v_cndmask_b32 v86, v86, v88, s[14:15]
    v_cndmask_b32 v36, v36, v48, s[12:13]
    v_cndmask_b32 v37, v37, v49, s[12:13]
    v_cndmask_b32 v38, v38, v50, s[12:13]
    v_cndmask_b32 v39, v39, v51, s[12:13]
    v_cndmask_b32 v36, v36, v56, s[14:15]
    v_cndmask_b32 v37, v37, v57, s[14:15]
    v_cndmask_b32 v38, v38, v58, s[14:15]
    v_cndmask_b32 v39, v39, v59, s[14:15]
    v_mul_f32 v36, v36, v86
    v_mul_f32 v37, v37, v86
    v_mul_f32 v38, v38, v86
    v_mul_f32 v39, v39, v86
    v_cvt_pk_bf16_f32 v8, v36, v37
    v_cvt_pk_bf16_f32 v9, v38, v39
    v_min_u32 v8, -2, v8
    v_min_u32 v9, -2, v9
    buffer_store_dwordx4 v[8:11], v13, s[28:31], s23 offen offset:1024 sc1
    s_setprio 1
    s_nop 0
    v_mov_b32 v10, 157980
    v_and_b32 v6, 3, v1
    v_lshl_add_u32 v6, v6, 3, v19
    v_add_u32 v20, v6, v18
    v_xor_b32 v21, 32, v20
    v_xor_b32 v22, 64, v20
    v_xor_b32 v23, 96, v20
    v_add_u32 v24, 63616, v20
    v_add_u32 v25, 63616, v21
    v_add_u32 v26, 63616, v22
    v_add_u32 v27, 63616, v23
Lcw_3:
    s_sub_u32 s35, s35, 1
    s_cbranch_scc1 Lend
    ds_read_b32 v11, v10
    s_waitcnt lgkmcnt(0)
    v_readfirstlane_b32 s38, v11
    s_nop 0
    s_cmp_lt_u32 s38, 2
    s_cbranch_scc1 Lcw_3
    s_mul_i32 s36, s32, 96
    s_lshl_b32 s37, s44, 4
    s_add_u32 s36, s36, s37
    s_sub_u32 s36, s36, 32
    v_add_u32 v126, s36, v3
    v_lshrrev_b32 v6, 3, v1
    v_add_u32 v6, s36, v6
    v_mul_u32_u24 v6, 1280, v6
    v_and_b32 v7, 7, v1
    v_xor_b32 v7, v7, v2
    v_lshl_add_u32 v122, v7, 4, v6
    v_xor_b32 v123, 64, v122
    v_add_u32 v123, 10240, v123
    s_lshl_b32 s36, s44, 11
    s_add_u32 s36, s36, 102656
    v_add_u32 v124, s36, v124
    v_add_u32 v125, s36, v13
    s_lshl_b32 s24, s33, 7
    v_mov_b32 v10, 157960
    s_mov_b32 s41, 0
    s_mov_b32 s47, 3
    v_lshlrev_b32 v28, 16, v108
    ds_read_b64_tr_b16 a[0:1], v20 offset:0
    ds_read_b64_tr_b16 a[2:3], v20 offset:512
    ds_read_b64_tr_b16 a[4:5], v21 offset:0
    ds_read_b64_tr_b16 a[6:7], v21 offset:512
    ds_read_b64_tr_b16 a[8:9], v22 offset:0
    ds_read_b64_tr_b16 a[10:11], v22 offset:512
    ds_read_b64_tr_b16 a[12:13], v23 offset:0
    ds_read_b64_tr_b16 a[14:15], v23 offset:512
    v_and_b32 v29, 0xffff0000, v108
    v_lshlrev_b32 v30, 16, v109
    v_and_b32 v31, 0xffff0000, v109
    v_lshlrev_b32 v32, 16, v110
    v_and_b32 v33, 0xffff0000, v110
    v_lshlrev_b32 v34, 16, v111
    v_and_b32 v35, 0xffff0000, v111
    v_lshlrev_b32 v36, 16, v112
    v_and_b32 v37, 0xffff0000, v112
    v_lshlrev_b32 v38, 16, v113
    v_and_b32 v39, 0xffff0000, v113
    v_lshlrev_b32 v40, 16, v114
    v_and_b32 v41, 0xffff0000, v114
    v_lshlrev_b32 v42, 16, v115
    ds_read_b64_tr_b16 a[16:17], v20 offset:4096
    ds_read_b64_tr_b16 a[18:19], v20 offset:4608
    ds_read_b64_tr_b16 a[20:21], v21 offset:4096
    ds_read_b64_tr_b16 a[22:23], v21 offset:4608
    ds_read_b64_tr_b16 a[24:25], v22 offset:4096
    ds_read_b64_tr_b16 a[26:27], v22 offset:4608
    ds_read_b64_tr_b16 a[28:29], v23 offset:4096
    ds_read_b64_tr_b16 a[30:31], v23 offset:4608
    v_and_b32 v43, 0xffff0000, v115
    v_mul_f32 v4, v120, v121
    v_mul_f32 v5, 0xbfb8aa3b, v121
    v_mul_f32 v6, 0xbfb8aa3b, v4
    v_fma_f32 v44, v28, v5, v6
    v_fma_f32 v45, v29, v5, v6
    v_fma_f32 v46, v30, v5, v6
    v_fma_f32 v47, v31, v5, v6
    v_fma_f32 v48, v32, v5, v6
    v_fma_f32 v49, v33, v5, v6
    v_fma_f32 v50, v34, v5, v6
    v_fma_f32 v51, v35, v5, v6
    v_fma_f32 v52, v36, v5, v6
    v_fma_f32 v53, v37, v5, v6
    ds_read_b64_tr_b16 a[32:33], v20 offset:8192
    ds_read_b64_tr_b16 a[34:35], v20 offset:8704
    ds_read_b64_tr_b16 a[36:37], v21 offset:8192
    ds_read_b64_tr_b16 a[38:39], v21 offset:8704
    ds_read_b64_tr_b16 a[40:41], v22 offset:8192
    ds_read_b64_tr_b16 a[42:43], v22 offset:8704
    ds_read_b64_tr_b16 a[44:45], v23 offset:8192
    ds_read_b64_tr_b16 a[46:47], v23 offset:8704
    v_fma_f32 v54, v38, v5, v6
    v_fma_f32 v55, v39, v5, v6
    v_fma_f32 v56, v40, v5, v6
    v_fma_f32 v57, v41, v5, v6
    v_fma_f32 v58, v42, v5, v6
    v_fma_f32 v59, v43, v5, v6
    v_exp_f32 v44, v44
    v_exp_f32 v45, v45
    v_exp_f32 v46, v46
    v_exp_f32 v47, v47
    v_exp_f32 v48, v48
    v_exp_f32 v49, v49
    v_exp_f32 v50, v50
    v_exp_f32 v51, v51
    v_exp_f32 v52, v52
    ds_read_b64_tr_b16 a[48:49], v20 offset:12288
    ds_read_b64_tr_b16 a[50:51], v20 offset:12800
    ds_read_b64_tr_b16 a[52:53], v21 offset:12288
    ds_read_b64_tr_b16 a[54:55], v21 offset:12800
    ds_read_b64_tr_b16 a[56:57], v22 offset:12288
    ds_read_b64_tr_b16 a[58:59], v22 offset:12800
    ds_read_b64_tr_b16 a[60:61], v23 offset:12288
    ds_read_b64_tr_b16 a[62:63], v23 offset:12800
    v_exp_f32 v53, v53
    v_exp_f32 v54, v54
    v_exp_f32 v55, v55
    v_exp_f32 v56, v56
    v_exp_f32 v57, v57
    v_exp_f32 v58, v58
    v_exp_f32 v59, v59
    v_fma_f32 v92, v28, v121, v4
    v_fma_f32 v93, v29, v121, v4
    v_fma_f32 v94, v30, v121, v4
    v_fma_f32 v95, v31, v121, v4
    v_fma_f32 v96, v32, v121, v4
    v_fma_f32 v97, v33, v121, v4
    v_fma_f32 v98, v34, v121, v4
    ds_read_b64_tr_b16 a[64:65], v20 offset:24576
    ds_read_b64_tr_b16 a[66:67], v20 offset:25088
    ds_read_b64_tr_b16 a[68:69], v21 offset:24576
    ds_read_b64_tr_b16 a[70:71], v21 offset:25088
    ds_read_b64_tr_b16 a[72:73], v22 offset:24576
    ds_read_b64_tr_b16 a[74:75], v22 offset:25088
    ds_read_b64_tr_b16 a[76:77], v23 offset:24576
    ds_read_b64_tr_b16 a[78:79], v23 offset:25088
    v_fma_f32 v99, v35, v121, v4
    v_fma_f32 v100, v36, v121, v4
    v_fma_f32 v101, v37, v121, v4
    v_fma_f32 v102, v38, v121, v4
    v_fma_f32 v103, v39, v121, v4
    v_fma_f32 v104, v40, v121, v4
    v_fma_f32 v105, v41, v121, v4
    v_fma_f32 v106, v42, v121, v4
    v_fma_f32 v107, v43, v121, v4
    v_add_f32 v44, 1.0, v44
    v_add_f32 v45, 1.0, v45
    v_add_f32 v46, 1.0, v46
    v_add_f32 v47, 1.0, v47
    v_add_f32 v48, 1.0, v48
    ds_read_b64_tr_b16 a[80:81], v20 offset:28672
    ds_read_b64_tr_b16 a[82:83], v20 offset:29184
    ds_read_b64_tr_b16 a[84:85], v21 offset:28672
    ds_read_b64_tr_b16 a[86:87], v21 offset:29184
    ds_read_b64_tr_b16 a[88:89], v22 offset:28672
    ds_read_b64_tr_b16 a[90:91], v22 offset:29184
    ds_read_b64_tr_b16 a[92:93], v23 offset:28672
    ds_read_b64_tr_b16 a[94:95], v23 offset:29184
    v_add_f32 v49, 1.0, v49
    v_add_f32 v50, 1.0, v50
    v_add_f32 v51, 1.0, v51
    v_add_f32 v52, 1.0, v52
    v_add_f32 v53, 1.0, v53
    v_add_f32 v54, 1.0, v54
    v_add_f32 v55, 1.0, v55
    v_add_f32 v56, 1.0, v56
    v_add_f32 v57, 1.0, v57
    v_add_f32 v58, 1.0, v58
    v_add_f32 v59, 1.0, v59
    v_rcp_f32 v44, v44
    v_rcp_f32 v45, v45
    v_rcp_f32 v46, v46
    v_rcp_f32 v47, v47
    ds_read_b64_tr_b16 a[96:97], v24 offset:59520
    ds_read_b64_tr_b16 a[98:99], v24 offset:60032
    ds_read_b64_tr_b16 a[100:101], v25 offset:59520
    ds_read_b64_tr_b16 a[102:103], v25 offset:60032
    ds_read_b64_tr_b16 a[104:105], v26 offset:59520
    ds_read_b64_tr_b16 a[106:107], v26 offset:60032
    ds_read_b64_tr_b16 a[108:109], v27 offset:59520
    ds_read_b64_tr_b16 a[110:111], v27 offset:60032
    v_rcp_f32 v48, v48
    v_rcp_f32 v49, v49
    v_rcp_f32 v50, v50
    v_rcp_f32 v51, v51
    v_rcp_f32 v52, v52
    v_rcp_f32 v53, v53
    v_rcp_f32 v54, v54
    v_rcp_f32 v55, v55
    v_rcp_f32 v56, v56
    v_rcp_f32 v57, v57
    v_rcp_f32 v58, v58
    v_rcp_f32 v59, v59
    v_mul_f32 v44, v44, v92
    v_mul_f32 v45, v45, v93
    ds_read_b64_tr_b16 a[112:113], v24 offset:63616
    ds_read_b64_tr_b16 a[114:115], v24 offset:64128
    ds_read_b64_tr_b16 a[116:117], v25 offset:63616
    ds_read_b64_tr_b16 a[118:119], v25 offset:64128
    ds_read_b64_tr_b16 a[120:121], v26 offset:63616
    ds_read_b64_tr_b16 a[122:123], v26 offset:64128
    ds_read_b64_tr_b16 a[124:125], v27 offset:63616
    ds_read_b64_tr_b16 a[126:127], v27 offset:64128
    v_mul_f32 v46, v46, v94
    v_mul_f32 v47, v47, v95
    v_mul_f32 v48, v48, v96
    v_mul_f32 v49, v49, v97
    v_mul_f32 v50, v50, v98
    v_mul_f32 v51, v51, v99
    v_mul_f32 v52, v52, v100
    v_mul_f32 v53, v53, v101
    v_mul_f32 v54, v54, v102
    v_mul_f32 v55, v55, v103
    v_mul_f32 v56, v56, v104
    v_mul_f32 v57, v57, v105
    v_mul_f32 v58, v58, v106
    v_mul_f32 v59, v59, v107
    buffer_load_dwordx4 v[60:63], v13, s[28:31], s53 offen offset:0 sc1
    buffer_load_dwordx4 v[64:67], v13, s[28:31], s53 offen offset:1024 sc1
    buffer_load_dwordx4 v[68:71], v13, s[28:31], s53 offen offset:2048 sc1
    buffer_load_dwordx4 v[72:75], v13, s[28:31], s53 offen offset:3072 sc1
    buffer_load_dwordx4 v[76:79], v13, s[28:31], s54 offen offset:0 sc1
    buffer_load_dwordx4 v[80:83], v13, s[28:31], s54 offen offset:1024 sc1
    buffer_load_dwordx4 v[84:87], v13, s[28:31], s54 offen offset:2048 sc1
    buffer_load_dwordx4 v[88:91], v13, s[28:31], s54 offen offset:3072 sc1
    s_setprio 0
Lwo_go:
    s_setprio 3
    ds_read_b64 v[8:9], v10
    s_waitcnt vmcnt(6)
    v_max3_u32 v4, v60, v61, v62
    v_max3_u32 v5, v64, v65, v66
    v_max3_u32 v4, v4, v63, v67
    v_max_u32 v4, v4, v5
    v_cmp_eq_u32 vcc, -1, v4
    s_nop 0
    s_cbranch_vccnz Lre_0
Lck_0:
    s_waitcnt lgkmcnt(15)
    v_mfma_f32_16x16x32_bf16 v[108:111], a[0:3], v[60:63], 0
    ds_read_b64_tr_b16 a[0:1], v24 offset:16384
    ds_read_b64_tr_b16 a[2:3], v24 offset:16896
    buffer_load_dwordx4 v[92:95], v13, s[28:31], s55 offen offset:0 sc1
    v_mfma_f32_16x16x32_bf16 v[112:115], a[4:7], v[60:63], 0
    ds_read_b64_tr_b16 a[4:5], v25 offset:16384
    ds_read_b64_tr_b16 a[6:7], v25 offset:16896
    v_mfma_f32_16x16x32_bf16 v[116:119], a[8:11], v[60:63], 0
    ds_read_b64_tr_b16 a[8:9], v26 offset:16384
    ds_read_b64_tr_b16 a[10:11], v26 offset:16896
    buffer_load_dwordx4 v[96:99], v13, s[28:31], s55 offen offset:1024 sc1
    v_mfma_f32_16x16x32_bf16 v[14:17], a[12:15], v[60:63], 0
    ds_read_b64_tr_b16 a[12:13], v27 offset:16384
    ds_read_b64_tr_b16 a[14:15], v27 offset:16896
    v_mfma_f32_16x16x32_bf16 v[108:111], a[16:19], v[64:67], v[108:111]
    ds_read_b64_tr_b16 a[16:17], v24 offset:20480
    ds_read_b64_tr_b16 a[18:19], v24 offset:20992
    s_waitcnt vmcnt(6)
    v_max3_u32 v4, v68, v69, v70
    v_mfma_f32_16x16x32_bf16 v[112:115], a[20:23], v[64:67], v[112:115]
    ds_read_b64_tr_b16 a[20:21], v25 offset:20480
    ds_read_b64_tr_b16 a[22:23], v25 offset:20992
    v_max3_u32 v5, v72, v73, v74
    v_max3_u32 v4, v4, v71, v75
    v_mfma_f32_16x16x32_bf16 v[116:119], a[24:27], v[64:67], v[116:119]
    ds_read_b64_tr_b16 a[24:25], v26 offset:20480
    ds_read_b64_tr_b16 a[26:27], v26 offset:20992
    v_max_u32 v4, v4, v5
    v_cmp_eq_u32 vcc, -1, v4
    v_mfma_f32_16x16x32_bf16 v[14:17], a[28:31], v[64:67], v[14:17]
    ds_read_b64_tr_b16 a[28:29], v27 offset:20480
    ds_read_b64_tr_b16 a[30:31], v27 offset:20992
    s_cbranch_vccnz Lre_1
Lck_1:
    s_waitcnt lgkmcnt(15)
Linfo:
    v_readfirstlane_b32 s39, v8
    s_nop 0
    s_cmp_eq_u32 s39, -2
    s_cbranch_scc1 Linfo_re
    v_mfma_f32_16x16x32_bf16 v[108:111], a[32:35], v[68:71], v[108:111]
    ds_read_b64_tr_b16 a[32:33], v20 offset:32768
    ds_read_b64_tr_b16 a[34:35], v20 offset:33280
    buffer_load_dwordx4 v[100:103], v13, s[28:31], s55 offen offset:2048 sc1
    v_mfma_f32_16x16x32_bf16 v[112:115], a[36:39], v[68:71], v[112:115]
    ds_read_b64_tr_b16 a[36:37], v21 offset:32768
    ds_read_b64_tr_b16 a[38:39], v21 offset:33280
    v_mfma_f32_16x16x32_bf16 v[116:119], a[40:43], v[68:71], v[116:119]
    ds_read_b64_tr_b16 a[40:41], v22 offset:32768
    ds_read_b64_tr_b16 a[42:43], v22 offset:33280
    buffer_load_dwordx4 v[104:107], v13, s[28:31], s55 offen offset:3072 sc1
    v_mfma_f32_16x16x32_bf16 v[14:17], a[44:47], v[68:71], v[14:17]
    ds_read_b64_tr_b16 a[44:45], v23 offset:32768
    ds_read_b64_tr_b16 a[46:47], v23 offset:33280
    v_mfma_f32_16x16x32_bf16 v[108:111], a[48:51], v[72:75], v[108:111]
    ds_read_b64_tr_b16 a[48:49], v20 offset:36864
    ds_read_b64_tr_b16 a[50:51], v20 offset:37376
    s_waitcnt vmcnt(6)
    v_max3_u32 v4, v76, v77, v78
    v_mfma_f32_16x16x32_bf16 v[112:115], a[52:55], v[72:75], v[112:115]
    ds_read_b64_tr_b16 a[52:53], v21 offset:36864
    ds_read_b64_tr_b16 a[54:55], v21 offset:37376
    v_max3_u32 v5, v80, v81, v82
    v_max3_u32 v4, v4, v79, v83
    v_mfma_f32_16x16x32_bf16 v[116:119], a[56:59], v[72:75], v[116:119]
    ds_read_b64_tr_b16 a[56:57], v22 offset:36864
    ds_read_b64_tr_b16 a[58:59], v22 offset:37376
    v_max_u32 v4, v4, v5
    v_cmp_eq_u32 vcc, -1, v4
    v_mfma_f32_16x16x32_bf16 v[14:17], a[60:63], v[72:75], v[14:17]
    ds_read_b64_tr_b16 a[60:61], v23 offset:36864
    ds_read_b64_tr_b16 a[62:63], v23 offset:37376
    s_cbranch_vccnz Lre_2
Lck_2:
    v_mfma_f32_16x16x32_bf16 v[108:111], a[64:67], v[76:79], v[108:111]
    ds_read_b64_tr_b16 a[64:65], v20 offset:40960
    ds_read_b64_tr_b16 a[66:67], v20 offset:41472
    buffer_load_dwordx4 v[60:63], v13, s[28:31], s56 offen offset:0 sc1
    v_mfma_f32_16x16x32_bf16 v[112:115], a[68:71], v[76:79], v[112:115]
    ds_read_b64_tr_b16 a[68:69], v21 offset:40960
    ds_read_b64_tr_b16 a[70:71], v21 offset:41472
    v_mfma_f32_16x16x32_bf16 v[116:119], a[72:75], v[76:79], v[116:119]
    ds_read_b64_tr_b16 a[72:73], v22 offset:40960
    ds_read_b64_tr_b16 a[74:75], v22 offset:41472
    buffer_load_dwordx4 v[64:67], v13, s[28:31], s56 offen offset:1024 sc1
    v_mfma_f32_16x16x32_bf16 v[14:17], a[76:79], v[76:79], v[14:17]
    ds_read_b64_tr_b16 a[76:77], v23 offset:40960
    ds_read_b64_tr_b16 a[78:79], v23 offset:41472
    v_mfma_f32_16x16x32_bf16 v[108:111], a[80:83], v[80:83], v[108:111]
    ds_read_b64_tr_b16 a[80:81], v20 offset:45056
    ds_read_b64_tr_b16 a[82:83], v20 offset:45568
    s_waitcnt vmcnt(6)
    v_max3_u32 v4, v84, v85, v86
    v_mfma_f32_16x16x32_bf16 v[112:115], a[84:87], v[80:83], v[112:115]
    ds_read_b64_tr_b16 a[84:85], v21 offset:45056
    ds_read_b64_tr_b16 a[86:87], v21 offset:45568
    v_max3_u32 v5, v88, v89, v90
    v_max3_u32 v4, v4, v87, v91
    v_mfma_f32_16x16x32_bf16 v[116:119], a[88:91], v[80:83], v[116:119]
    ds_read_b64_tr_b16 a[88:89], v22 offset:45056
    ds_read_b64_tr_b16 a[90:91], v22 offset:45568
    v_max_u32 v4, v4, v5
    v_cmp_eq_u32 vcc, -1, v4
    v_mfma_f32_16x16x32_bf16 v[14:17], a[92:95], v[80:83], v[14:17]
    ds_read_b64_tr_b16 a[92:93], v23 offset:45056
    ds_read_b64_tr_b16 a[94:95], v23 offset:45568
    s_cbranch_vccnz Lre_3
Lck_3:
    s_setprio 2
    v_mfma_f32_16x16x32_bf16 v[108:111], a[96:99], v[84:87], v[108:111]
    ds_read_b64_tr_b16 a[96:97], v24 offset:0
    ds_read_b64_tr_b16 a[98:99], v24 offset:512
    buffer_load_dwordx4 v[68:71], v13, s[28:31], s56 offen offset:2048 sc1
    v_mfma_f32_16x16x32_bf16 v[112:115], a[100:103], v[84:87], v[112:115]
    ds_read_b64_tr_b16 a[100:101], v25 offset:0
    ds_read_b64_tr_b16 a[102:103], v25 offset:512
    v_mfma_f32_16x16x32_bf16 v[116:119], a[104:107], v[84:87], v[116:119]
    ds_read_b64_tr_b16 a[104:105], v26 offset:0
    ds_read_b64_tr_b16 a[106:107], v26 offset:512
    buffer_load_dwordx4 v[72:75], v13, s[28:31], s56 offen offset:3072 sc1
    v_mfma_f32_16x16x32_bf16 v[14:17], a[108:111], v[84:87], v[14:17]
    ds_read_b64_tr_b16 a[108:109], v27 offset:0
    ds_read_b64_tr_b16 a[110:111], v27 offset:512
    v_mfma_f32_16x16x32_bf16 v[108:111], a[112:115], v[88:91], v[108:111]
    ds_read_b64_tr_b16 a[112:113], v24 offset:4096
    ds_read_b64_tr_b16 a[114:115], v24 offset:4608
    s_waitcnt vmcnt(6)
    v_max3_u32 v4, v92, v93, v94
    v_mfma_f32_16x16x32_bf16 v[112:115], a[116:119], v[88:91], v[112:115]
    ds_read_b64_tr_b16 a[116:117], v25 offset:4096
    ds_read_b64_tr_b16 a[118:119], v25 offset:4608
    v_max3_u32 v5, v96, v97, v98
    v_max3_u32 v4, v4, v95, v99
    v_mfma_f32_16x16x32_bf16 v[116:119], a[120:123], v[88:91], v[116:119]
    ds_read_b64_tr_b16 a[120:121], v26 offset:4096
    ds_read_b64_tr_b16 a[122:123], v26 offset:4608
    v_max_u32 v4, v4, v5
    v_cmp_eq_u32 vcc, -1, v4
    v_mfma_f32_16x16x32_bf16 v[14:17], a[124:127], v[88:91], v[14:17]
    ds_read_b64_tr_b16 a[124:125], v27 offset:4096
    ds_read_b64_tr_b16 a[126:127], v27 offset:4608
    s_cbranch_vccnz Lre_4
Lck_4:
    s_waitcnt lgkmcnt(15)
    v_mfma_f32_16x16x32_bf16 v[108:111], a[0:3], v[92:95], v[108:111]
    ds_read_b64_tr_b16 a[0:1], v24 offset:8192
    ds_read_b64_tr_b16 a[2:3], v24 offset:8704
    buffer_load_dwordx4 v[76:79], v13, s[28:31], s57 offen offset:0 sc1
    v_mfma_f32_16x16x32_bf16 v[112:115], a[4:7], v[92:95], v[112:115]
    ds_read_b64_tr_b16 a[4:5], v25 offset:8192
    ds_read_b64_tr_b16 a[6:7], v25 offset:8704
    v_mfma_f32_16x16x32_bf16 v[116:119], a[8:11], v[92:95], v[116:119]
    ds_read_b64_tr_b16 a[8:9], v26 offset:8192
    ds_read_b64_tr_b16 a[10:11], v26 offset:8704
    buffer_load_dwordx4 v[80:83], v13, s[28:31], s57 offen offset:1024 sc1
    v_mfma_f32_16x16x32_bf16 v[14:17], a[12:15], v[92:95], v[14:17]
    ds_read_b64_tr_b16 a[12:13], v27 offset:8192
    ds_read_b64_tr_b16 a[14:15], v27 offset:8704
    v_mfma_f32_16x16x32_bf16 v[108:111], a[16:19], v[96:99], v[108:111]
    ds_read_b64_tr_b16 a[16:17], v24 offset:12288
    ds_read_b64_tr_b16 a[18:19], v24 offset:12800
    s_waitcnt vmcnt(6)
    v_max3_u32 v4, v100, v101, v102
    v_mfma_f32_16x16x32_bf16 v[112:115], a[20:23], v[96:99], v[112:115]
    ds_read_b64_tr_b16 a[20:21], v25 offset:12288
    ds_read_b64_tr_b16 a[22:23], v25 offset:12800
    v_max3_u32 v5, v104, v105, v106
    v_max3_u32 v4, v4, v103, v107
    v_mfma_f32_16x16x32_bf16 v[116:119], a[24:27], v[96:99], v[116:119]
    ds_read_b64_tr_b16 a[24:25], v26 offset:12288
    ds_read_b64_tr_b16 a[26:27], v26 offset:12800
    v_max_u32 v4, v4, v5
    v_cmp_eq_u32 vcc, -1, v4
    v_mfma_f32_16x16x32_bf16 v[14:17], a[28:31], v[96:99], v[14:17]
    ds_read_b64_tr_b16 a[28:29], v27 offset:12288
    ds_read_b64_tr_b16 a[30:31], v27 offset:12800
    s_cbranch_vccnz Lre_5
Lck_5:
    v_mfma_f32_16x16x32_bf16 v[108:111], a[32:35], v[100:103], v[108:111]
    ds_read_b64_tr_b16 a[32:33], v20 offset:49152
    ds_read_b64_tr_b16 a[34:35], v20 offset:49664
    buffer_load_dwordx4 v[84:87], v13, s[28:31], s57 offen offset:2048 sc1
    v_mfma_f32_16x16x32_bf16 v[112:115], a[36:39], v[100:103], v[112:115]
    ds_read_b64_tr_b16 a[36:37], v21 offset:49152
    ds_read_b64_tr_b16 a[38:39], v21 offset:49664
    v_mfma_f32_16x16x32_bf16 v[116:119], a[40:43], v[100:103], v[116:119]
    ds_read_b64_tr_b16 a[40:41], v22 offset:49152
    ds_read_b64_tr_b16 a[42:43], v22 offset:49664
    buffer_load_dwordx4 v[88:91], v13, s[28:31], s57 offen offset:3072 sc1
    v_mfma_f32_16x16x32_bf16 v[14:17], a[44:47], v[100:103], v[14:17]
    ds_read_b64_tr_b16 a[44:45], v23 offset:49152
    ds_read_b64_tr_b16 a[46:47], v23 offset:49664
    v_mfma_f32_16x16x32_bf16 v[108:111], a[48:51], v[104:107], v[108:111]
    ds_read_b64_tr_b16 a[48:49], v24 offset:24576
    ds_read_b64_tr_b16 a[50:51], v24 offset:25088
    s_waitcnt vmcnt(6)
    v_max3_u32 v4, v60, v61, v62
    v_mfma_f32_16x16x32_bf16 v[112:115], a[52:55], v[104:107], v[112:115]
    ds_read_b64_tr_b16 a[52:53], v25 offset:24576
    ds_read_b64_tr_b16 a[54:55], v25 offset:25088
    v_max3_u32 v5, v64, v65, v66
    v_max3_u32 v4, v4, v63, v67
    v_mfma_f32_16x16x32_bf16 v[116:119], a[56:59], v[104:107], v[116:119]
    ds_read_b64_tr_b16 a[56:57], v26 offset:24576
    ds_read_b64_tr_b16 a[58:59], v26 offset:25088
    v_max_u32 v4, v4, v5
    v_cmp_eq_u32 vcc, -1, v4
    v_mfma_f32_16x16x32_bf16 v[14:17], a[60:63], v[104:107], v[14:17]
    ds_read_b64_tr_b16 a[60:61], v27 offset:24576
    ds_read_b64_tr_b16 a[62:63], v27 offset:25088
    s_cbranch_vccnz Lre_6
Lck_6:
    s_setprio 1
    v_mfma_f32_16x16x32_bf16 v[108:111], a[64:67], v[60:63], v[108:111]
    v_mfma_f32_16x16x32_bf16 v[112:115], a[68:71], v[60:63], v[112:115]
    v_mfma_f32_16x16x32_bf16 v[116:119], a[72:75], v[60:63], v[116:119]
    v_mfma_f32_16x16x32_bf16 v[14:17], a[76:79], v[60:63], v[14:17]
    v_mfma_f32_16x16x32_bf16 v[108:111], a[80:83], v[64:67], v[108:111]
    s_waitcnt vmcnt(4)
    v_max3_u32 v4, v68, v69, v70
    v_mfma_f32_16x16x32_bf16 v[112:115], a[84:87], v[64:67], v[112:115]
    v_max3_u32 v5, v72, v73, v74
    v_max3_u32 v4, v4, v71, v75
    v_mfma_f32_16x16x32_bf16 v[116:119], a[88:91], v[64:67], v[116:119]
    v_max_u32 v4, v4, v5
    v_cmp_eq_u32 vcc, -1, v4
    v_mfma_f32_16x16x32_bf16 v[14:17], a[92:95], v[64:67], v[14:17]
    s_cbranch_vccnz Lre_7
Lck_7:
    s_waitcnt lgkmcnt(15)
    v_mfma_f32_16x16x32_bf16 v[108:111], a[96:99], v[68:71], v[108:111]
    v_mfma_f32_16x16x32_bf16 v[112:115], a[100:103], v[68:71], v[112:115]
    v_mfma_f32_16x16x32_bf16 v[116:119], a[104:107], v[68:71], v[116:119]
    v_mfma_f32_16x16x32_bf16 v[14:17], a[108:111], v[68:71], v[14:17]
    v_mfma_f32_16x16x32_bf16 v[108:111], a[112:115], v[72:75], v[108:111]
    s_waitcnt vmcnt(2)
    v_max3_u32 v4, v76, v77, v78
    v_mfma_f32_16x16x32_bf16 v[112:115], a[116:119], v[72:75], v[112:115]
    v_max3_u32 v5, v80, v81, v82
    v_max3_u32 v4, v4, v79, v83
    v_mfma_f32_16x16x32_bf16 v[116:119], a[120:123], v[72:75], v[116:119]
    v_max_u32 v4, v4, v5
    v_cmp_eq_u32 vcc, -1, v4
    v_mfma_f32_16x16x32_bf16 v[14:17], a[124:127], v[72:75], v[14:17]
    s_cbranch_vccnz Lre_8
Lck_8:
    s_setprio 0
    v_mfma_f32_16x16x32_bf16 v[108:111], a[0:3], v[76:79], v[108:111]
    v_mfma_f32_16x16x32_bf16 v[112:115], a[4:7], v[76:79], v[112:115]
    v_mfma_f32_16x16x32_bf16 v[116:119], a[8:11], v[76:79], v[116:119]
    v_mfma_f32_16x16x32_bf16 v[14:17], a[12:15], v[76:79], v[14:17]
    v_mfma_f32_16x16x32_bf16 v[108:111], a[16:19], v[80:83], v[108:111]
    s_waitcnt vmcnt(0)
    v_max3_u32 v4, v84, v85, v86
    v_mfma_f32_16x16x32_bf16 v[112:115], a[20:23], v[80:83], v[112:115]
    v_max3_u32 v5, v88, v89, v90
    v_max3_u32 v4, v4, v87, v91
    v_mfma_f32_16x16x32_bf16 v[116:119], a[24:27], v[80:83], v[116:119]
    v_max_u32 v4, v4, v5
    v_cmp_eq_u32 vcc, -1, v4
    v_mfma_f32_16x16x32_bf16 v[14:17], a[28:31], v[80:83], v[14:17]
    s_cbranch_vccnz Lre_9
Lck_9:
    s_waitcnt lgkmcnt(8)
    v_mfma_f32_16x16x32_bf16 v[108:111], a[32:35], v[84:87], v[108:111]
    v_mfma_f32_16x16x32_bf16 v[112:115], a[36:39], v[84:87], v[112:115]
    v_mfma_f32_16x16x32_bf16 v[116:119], a[40:43], v[84:87], v[116:119]
    v_mfma_f32_16x16x32_bf16 v[14:17], a[44:47], v[84:87], v[14:17]
    s_waitcnt lgkmcnt(0)
    v_mfma_f32_16x16x32_bf16 v[108:111], a[48:51], v[88:91], v[108:111]
    v_mfma_f32_16x16x32_bf16 v[112:115], a[52:55], v[88:91], v[112:115]
    v_mfma_f32_16x16x32_bf16 v[116:119], a[56:59], v[88:91], v[116:119]
    v_mfma_f32_16x16x32_bf16 v[14:17], a[60:63], v[88:91], v[14:17]
    v_xor_b32 v60, 32, v124
    v_xor_b32 v61, 64, v124
    v_xor_b32 v62, 96, v124
    v_cmp_eq_u32 s[36:37], v8, v126
    v_cmp_eq_u32 s[38:39], v9, v126
    s_nop 0
    s_or_b64 vcc, s[36:37], s[38:39]
    s_cbranch_scc1 Lfix
Lnofix:
    v_fma_f32 v108, v108, v44, v28
    v_fma_f32 v109, v109, v45, v29
    v_fma_f32 v110, v110, v46, v30
    v_fma_f32 v111, v111, v47, v31
    v_cvt_pk_bf16_f32 v68, v108, v109
    v_cvt_pk_bf16_f32 v69, v110, v111
    ds_write_b64 v124, v[68:69]
    v_fma_f32 v112, v112, v48, v32
    v_fma_f32 v113, v113, v49, v33
    v_fma_f32 v114, v114, v50, v34
    v_fma_f32 v115, v115, v51, v35
    v_cvt_pk_bf16_f32 v70, v112, v113
    v_cvt_pk_bf16_f32 v71, v114, v115
    ds_write_b64 v60, v[70:71]
    v_fma_f32 v116, v116, v52, v36
    v_fma_f32 v117, v117, v53, v37
    v_fma_f32 v118, v118, v54, v38
    v_fma_f32 v119, v119, v55, v39
    v_cvt_pk_bf16_f32 v72, v116, v117
    v_cvt_pk_bf16_f32 v73, v118, v119
    ds_write_b64 v61, v[72:73]
    v_fma_f32 v14, v14, v56, v40
    v_fma_f32 v15, v15, v57, v41
    v_fma_f32 v16, v16, v58, v42
    v_fma_f32 v17, v17, v59, v43
    v_cvt_pk_bf16_f32 v74, v14, v15
    v_cvt_pk_bf16_f32 v75, v16, v17
    ds_write_b64 v62, v[74:75]
    ds_read_b128 v[76:79], v125 offset:0
    ds_read_b128 v[80:83], v125 offset:1024
    s_waitcnt lgkmcnt(1)
    buffer_store_dwordx4 v[76:79], v122, s[48:51], s24 offen
    s_waitcnt lgkmcnt(0)
    buffer_store_dwordx4 v[80:83], v123, s[48:51], s24 offen
    s_endpgm
Lh1:
    ds_write_b128 v125, v[44:47] offset:0
    ds_write_b128 v125, v[48:51] offset:1024
    v_mov_b32 v5, 157972
    v_mov_b32 v6, 1
    s_mov_b64 exec, 1
    ds_add_u32 v5, v6
    s_mov_b64 exec, -1
    v_fmac_f32 v28, v76, v120
    v_fmac_f32 v29, v77, v120
    v_fmac_f32 v30, v78, v120
    v_fmac_f32 v31, v79, v120
    v_cvt_pk_bf16_f32 v28, v28, v29
    v_cvt_pk_bf16_f32 v29, v30, v31
    v_fmac_f32 v32, v80, v120
    v_fmac_f32 v33, v81, v120
    v_fmac_f32 v34, v82, v120
    v_fmac_f32 v35, v83, v120
    v_cvt_pk_bf16_f32 v30, v32, v33
    v_cvt_pk_bf16_f32 v31, v34, v35
    v_fmac_f32 v36, v84, v120
    v_fmac_f32 v37, v85, v120
    v_fmac_f32 v38, v86, v120
    v_fmac_f32 v39, v87, v120
    v_cvt_pk_bf16_f32 v32, v36, v37
    v_cvt_pk_bf16_f32 v33, v38, v39
    v_fmac_f32 v40, v88, v120
    v_fmac_f32 v41, v89, v120
    v_fmac_f32 v42, v90, v120
    v_fmac_f32 v43, v91, v120
    v_cvt_pk_bf16_f32 v34, v40, v41
    v_cvt_pk_bf16_f32 v35, v42, v43
    v_subrev_u32 v4, 6144, v125
    v_mov_b32 v8, s22
    v_mov_b32 v9, s22
    v_mov_b32 v10, s22
    v_mov_b32 v11, s22
Lcw_2:
    s_sub_u32 s35, s35, 1
    s_cbranch_scc1 Lend
    ds_read_b32 v6, v5
    s_waitcnt lgkmcnt(0)
    v_readfirstlane_b32 s38, v6
    s_nop 0
    s_cmp_lt_u32 s38, 8
    s_cbranch_scc1 Lcw_2
    ds_read_b128 v[52:55], v125 offset:2048
    ds_read_b128 v[56:59], v125 offset:3072
    ds_read_b128 v[44:47], v4 offset:4096
    ds_read_b128 v[48:51], v4 offset:5120
    s_branch Lh_join
Lqf_re:
    s_sub_u32 s35, s35, 1
    s_cbranch_scc1 Lend
    ds_read_b32 v7, v96
    ds_read_b128 v[76:79], v95 offset:0
    ds_read_b128 v[80:83], v95 offset:64
    ds_read_b128 v[84:87], v95 offset:128
    ds_read_b128 v[88:91], v95 offset:192
    s_waitcnt lgkmcnt(0)
    s_branch Lqf
Lcsv_re:
    s_sub_u32 s35, s35, 1
    s_cbranch_scc1 Lend
    ds_read_b32 v46, v49
    ds_read_b64 v[44:45], v48
    s_waitcnt lgkmcnt(0)
    s_branch Lcsv
Lrx_re:
    s_sub_u32 s35, s35, 1
    s_cbranch_scc1 Lend
    buffer_load_dwordx2 v[52:53], v13, s[28:31], s59 offen offset:8 sc1
    buffer_load_dwordx2 v[54:55], v13, s[28:31], s60 offen offset:0 sc1
    s_waitcnt vmcnt(0)
    s_branch Lrx_chk
Linfo_re:
    s_sub_u32 s35, s35, 1
    s_cbranch_scc1 Lend
    ds_read_b64 v[8:9], v10
    s_waitcnt lgkmcnt(0)
    s_branch Linfo
Lfl_re:
    s_sub_u32 s35, s35, 1
    s_cbranch_scc1 Lend
    buffer_load_dword v20, v12, s[28:31], s24 offen sc1
    s_waitcnt vmcnt(0)
    s_branch Lfl_chk
Lxe0:
    ds_read_b64 v[108:109], v4
    ds_read_b64 v[110:111], v5
    ds_read_b64 v[112:113], v6
    ds_read_b64 v[114:115], v7
    s_branch Lxe0_b
Lxe1:
    ds_read_b64 v[108:109], v4
    ds_read_b64 v[110:111], v5
    ds_read_b64 v[112:113], v6
    ds_read_b64 v[114:115], v7
    s_branch Lxe1_b
Lxe2:
    ds_read_b64 v[108:109], v4
    ds_read_b64 v[110:111], v5
    ds_read_b64 v[112:113], v6
    ds_read_b64 v[114:115], v7
    s_branch Lxe2_b
Lxe3:
    ds_read_b64 v[108:109], v4
    ds_read_b64 v[110:111], v5
    ds_read_b64 v[112:113], v6
    ds_read_b64 v[114:115], v7
    s_branch Lxe3_b
Lxe4:
    ds_read_b64 v[108:109], v4
    ds_read_b64 v[110:111], v5
    ds_read_b64 v[112:113], v6
    ds_read_b64 v[114:115], v7
    s_branch Lxe4_b
Lxe5:
    ds_read_b64 v[108:109], v4
    ds_read_b64 v[110:111], v5
    ds_read_b64 v[112:113], v6
    ds_read_b64 v[114:115], v7
    s_branch Lxe5_b
Lxe6:
    ds_read_b64 v[108:109], v4
    ds_read_b64 v[110:111], v5
    ds_read_b64 v[112:113], v6
    ds_read_b64 v[114:115], v7
    s_branch Lxe6_b
Lxe7:
    ds_read_b64 v[108:109], v4
    ds_read_b64 v[110:111], v5
    ds_read_b64 v[112:113], v6
    ds_read_b64 v[114:115], v7
    s_branch Lxe7_b
Lxe8:
    ds_read_b64 v[108:109], v4
    ds_read_b64 v[110:111], v5
    ds_read_b64 v[112:113], v6
    ds_read_b64 v[114:115], v7
    s_branch Lxe8_b
Lxe9:
    ds_read_b64 v[108:109], v4
    ds_read_b64 v[110:111], v5
    ds_read_b64 v[112:113], v6
    ds_read_b64 v[114:115], v7
    s_branch Lxe9_b
Lre_0:
    s_mov_b32 s41, 1
    s_sub_u32 s35, s35, 1
    s_cbranch_scc1 Lend
    s_sleep 2
    buffer_load_dwordx4 v[60:63], v13, s[28:31], s53 offen offset:0 sc1
    buffer_load_dwordx4 v[64:67], v13, s[28:31], s53 offen offset:1024 sc1
    s_waitcnt vmcnt(0)
    v_max3_u32 v4, v60, v61, v62
    v_max3_u32 v5, v64, v65, v66
    v_max3_u32 v4, v4, v63, v67
    v_max_u32 v4, v4, v5
    v_cmp_eq_u32 vcc, -1, v4
    s_nop 0
    s_cbranch_vccnz Lre_0
    buffer_load_dwordx4 v[68:71], v13, s[28:31], s53 offen offset:2048 sc1
    buffer_load_dwordx4 v[72:75], v13, s[28:31], s53 offen offset:3072 sc1
    buffer_load_dwordx4 v[76:79], v13, s[28:31], s54 offen offset:0 sc1
    buffer_load_dwordx4 v[80:83], v13, s[28:31], s54 offen offset:1024 sc1
    buffer_load_dwordx4 v[84:87], v13, s[28:31], s54 offen offset:2048 sc1
    buffer_load_dwordx4 v[88:91], v13, s[28:31], s54 offen offset:3072 sc1
    s_branch Lck_0
Lre_1:
    s_mov_b32 s41, 1
    s_sub_u32 s35, s35, 1
    s_cbranch_scc1 Lend
    s_sleep 2
    buffer_load_dwordx4 v[68:71], v13, s[28:31], s53 offen offset:2048 sc1
    buffer_load_dwordx4 v[72:75], v13, s[28:31], s53 offen offset:3072 sc1
    s_waitcnt vmcnt(0)
    v_max3_u32 v4, v68, v69, v70
    v_max3_u32 v5, v72, v73, v74
    v_max3_u32 v4, v4, v71, v75
    v_max_u32 v4, v4, v5
    v_cmp_eq_u32 vcc, -1, v4
    s_nop 0
    s_cbranch_vccnz Lre_1
    buffer_load_dwordx4 v[76:79], v13, s[28:31], s54 offen offset:0 sc1
    buffer_load_dwordx4 v[80:83], v13, s[28:31], s54 offen offset:1024 sc1
    buffer_load_dwordx4 v[84:87], v13, s[28:31], s54 offen offset:2048 sc1
    buffer_load_dwordx4 v[88:91], v13, s[28:31], s54 offen offset:3072 sc1
    buffer_load_dwordx4 v[92:95], v13, s[28:31], s55 offen offset:0 sc1
    buffer_load_dwordx4 v[96:99], v13, s[28:31], s55 offen offset:1024 sc1
    s_branch Lck_1
Lre_2:
    s_mov_b32 s41, 1
    s_sub_u32 s35, s35, 1
    s_cbranch_scc1 Lend
    s_sleep 2
    buffer_load_dwordx4 v[76:79], v13, s[28:31], s54 offen offset:0 sc1
    buffer_load_dwordx4 v[80:83], v13, s[28:31], s54 offen offset:1024 sc1
    s_waitcnt vmcnt(0)
    v_max3_u32 v4, v76, v77, v78
    v_max3_u32 v5, v80, v81, v82
    v_max3_u32 v4, v4, v79, v83
    v_max_u32 v4, v4, v5
    v_cmp_eq_u32 vcc, -1, v4
    s_nop 0
    s_cbranch_vccnz Lre_2
    buffer_load_dwordx4 v[84:87], v13, s[28:31], s54 offen offset:2048 sc1
    buffer_load_dwordx4 v[88:91], v13, s[28:31], s54 offen offset:3072 sc1
    buffer_load_dwordx4 v[92:95], v13, s[28:31], s55 offen offset:0 sc1
    buffer_load_dwordx4 v[96:99], v13, s[28:31], s55 offen offset:1024 sc1
    buffer_load_dwordx4 v[100:103], v13, s[28:31], s55 offen offset:2048 sc1
    buffer_load_dwordx4 v[104:107], v13, s[28:31], s55 offen offset:3072 sc1
    s_branch Lck_2
Lre_3:
    s_mov_b32 s41, 1
    s_sub_u32 s35, s35, 1
    s_cbranch_scc1 Lend
    s_sleep 2
    buffer_load_dwordx4 v[84:87], v13, s[28:31], s54 offen offset:2048 sc1
    buffer_load_dwordx4 v[88:91], v13, s[28:31], s54 offen offset:3072 sc1
    s_waitcnt vmcnt(0)
    v_max3_u32 v4, v84, v85, v86
    v_max3_u32 v5, v88, v89, v90
    v_max3_u32 v4, v4, v87, v91
    v_max_u32 v4, v4, v5
    v_cmp_eq_u32 vcc, -1, v4
    s_nop 0
    s_cbranch_vccnz Lre_3
    buffer_load_dwordx4 v[92:95], v13, s[28:31], s55 offen offset:0 sc1
    buffer_load_dwordx4 v[96:99], v13, s[28:31], s55 offen offset:1024 sc1
    buffer_load_dwordx4 v[100:103], v13, s[28:31], s55 offen offset:2048 sc1
    buffer_load_dwordx4 v[104:107], v13, s[28:31], s55 offen offset:3072 sc1
    buffer_load_dwordx4 v[60:63], v13, s[28:31], s56 offen offset:0 sc1
    buffer_load_dwordx4 v[64:67], v13, s[28:31], s56 offen offset:1024 sc1
    s_branch Lck_3
Lre_4:
    s_mov_b32 s41, 1
    s_sub_u32 s35, s35, 1
    s_cbranch_scc1 Lend
    s_sleep 2
    buffer_load_dwordx4 v[92:95], v13, s[28:31], s55 offen offset:0 sc1
    buffer_load_dwordx4 v[96:99], v13, s[28:31], s55 offen offset:1024 sc1
    s_waitcnt vmcnt(0)
    v_max3_u32 v4, v92, v93, v94
    v_max3_u32 v5, v96, v97, v98
    v_max3_u32 v4, v4, v95, v99
    v_max_u32 v4, v4, v5
    v_cmp_eq_u32 vcc, -1, v4
    s_nop 0
    s_cbranch_vccnz Lre_4
    buffer_load_dwordx4 v[100:103], v13, s[28:31], s55 offen offset:2048 sc1
    buffer_load_dwordx4 v[104:107], v13, s[28:31], s55 offen offset:3072 sc1
    buffer_load_dwordx4 v[60:63], v13, s[28:31], s56 offen offset:0 sc1
    buffer_load_dwordx4 v[64:67], v13, s[28:31], s56 offen offset:1024 sc1
    buffer_load_dwordx4 v[68:71], v13, s[28:31], s56 offen offset:2048 sc1
    buffer_load_dwordx4 v[72:75], v13, s[28:31], s56 offen offset:3072 sc1
    s_branch Lck_4
Lre_5:
    s_mov_b32 s41, 1
    s_sub_u32 s35, s35, 1
    s_cbranch_scc1 Lend
    s_sleep 2
    buffer_load_dwordx4 v[100:103], v13, s[28:31], s55 offen offset:2048 sc1
    buffer_load_dwordx4 v[104:107], v13, s[28:31], s55 offen offset:3072 sc1
    s_waitcnt vmcnt(0)
    v_max3_u32 v4, v100, v101, v102
    v_max3_u32 v5, v104, v105, v106
    v_max3_u32 v4, v4, v103, v107
    v_max_u32 v4, v4, v5
    v_cmp_eq_u32 vcc, -1, v4
    s_nop 0
    s_cbranch_vccnz Lre_5
    buffer_load_dwordx4 v[60:63], v13, s[28:31], s56 offen offset:0 sc1
    buffer_load_dwordx4 v[64:67], v13, s[28:31], s56 offen offset:1024 sc1
    buffer_load_dwordx4 v[68:71], v13, s[28:31], s56 offen offset:2048 sc1
    buffer_load_dwordx4 v[72:75], v13, s[28:31], s56 offen offset:3072 sc1
    buffer_load_dwordx4 v[76:79], v13, s[28:31], s57 offen offset:0 sc1
    buffer_load_dwordx4 v[80:83], v13, s[28:31], s57 offen offset:1024 sc1
    s_branch Lck_5
Lre_6:
    s_mov_b32 s41, 1
    s_sub_u32 s35, s35, 1
    s_cbranch_scc1 Lend
    s_sleep 2
    buffer_load_dwordx4 v[60:63], v13, s[28:31], s56 offen offset:0 sc1
    buffer_load_dwordx4 v[64:67], v13, s[28:31], s56 offen offset:1024 sc1
    s_waitcnt vmcnt(0)
    v_max3_u32 v4, v60, v61, v62
    v_max3_u32 v5, v64, v65, v66
    v_max3_u32 v4, v4, v63, v67
    v_max_u32 v4, v4, v5
    v_cmp_eq_u32 vcc, -1, v4
    s_nop 0
    s_cbranch_vccnz Lre_6
    buffer_load_dwordx4 v[68:71], v13, s[28:31], s56 offen offset:2048 sc1
    buffer_load_dwordx4 v[72:75], v13, s[28:31], s56 offen offset:3072 sc1
    buffer_load_dwordx4 v[76:79], v13, s[28:31], s57 offen offset:0 sc1
    buffer_load_dwordx4 v[80:83], v13, s[28:31], s57 offen offset:1024 sc1
    buffer_load_dwordx4 v[84:87], v13, s[28:31], s57 offen offset:2048 sc1
    buffer_load_dwordx4 v[88:91], v13, s[28:31], s57 offen offset:3072 sc1
    s_branch Lck_6
Lre_7:
    s_mov_b32 s41, 1
    s_sub_u32 s35, s35, 1
    s_cbranch_scc1 Lend
    s_sleep 2
    buffer_load_dwordx4 v[68:71], v13, s[28:31], s56 offen offset:2048 sc1
    buffer_load_dwordx4 v[72:75], v13, s[28:31], s56 offen offset:3072 sc1
    s_waitcnt vmcnt(0)
    v_max3_u32 v4, v68, v69, v70
    v_max3_u32 v5, v72, v73, v74
    v_max3_u32 v4, v4, v71, v75
    v_max_u32 v4, v4, v5
    v_cmp_eq_u32 vcc, -1, v4
    s_nop 0
    s_cbranch_vccnz Lre_7
    buffer_load_dwordx4 v[76:79], v13, s[28:31], s57 offen offset:0 sc1
    buffer_load_dwordx4 v[80:83], v13, s[28:31], s57 offen offset:1024 sc1
    buffer_load_dwordx4 v[84:87], v13, s[28:31], s57 offen offset:2048 sc1
    buffer_load_dwordx4 v[88:91], v13, s[28:31], s57 offen offset:3072 sc1
    s_branch Lck_7
Lre_8:
    s_mov_b32 s41, 1
    s_sub_u32 s35, s35, 1
    s_cbranch_scc1 Lend
    s_sleep 2
    buffer_load_dwordx4 v[76:79], v13, s[28:31], s57 offen offset:0 sc1
    buffer_load_dwordx4 v[80:83], v13, s[28:31], s57 offen offset:1024 sc1
    s_waitcnt vmcnt(0)
    v_max3_u32 v4, v76, v77, v78
    v_max3_u32 v5, v80, v81, v82
    v_max3_u32 v4, v4, v79, v83
    v_max_u32 v4, v4, v5
    v_cmp_eq_u32 vcc, -1, v4
    s_nop 0
    s_cbranch_vccnz Lre_8
    buffer_load_dwordx4 v[84:87], v13, s[28:31], s57 offen offset:2048 sc1
    buffer_load_dwordx4 v[88:91], v13, s[28:31], s57 offen offset:3072 sc1
    s_branch Lck_8
Lre_9:
    s_mov_b32 s41, 1
    s_sub_u32 s35, s35, 1
    s_cbranch_scc1 Lend
    s_sleep 2
    buffer_load_dwordx4 v[84:87], v13, s[28:31], s57 offen offset:2048 sc1
    buffer_load_dwordx4 v[88:91], v13, s[28:31], s57 offen offset:3072 sc1
    s_waitcnt vmcnt(0)
    v_max3_u32 v4, v84, v85, v86
    v_max3_u32 v5, v88, v89, v90
    v_max3_u32 v4, v4, v87, v91
    v_max_u32 v4, v4, v5
    v_cmp_eq_u32 vcc, -1, v4
    s_nop 0
    s_cbranch_vccnz Lre_9
    s_branch Lck_9
Lfix:
    s_mov_b64 vcc, s[38:39]
    v_lshlrev_b32 v6, 4, v2
    v_add_u32 v6, 158208, v6
    v_mov_b32 v10, 157956
Lcw_5:
    s_sub_u32 s35, s35, 1
    s_cbranch_scc1 Lend
    ds_read_b32 v11, v10
    s_waitcnt lgkmcnt(0)
    v_readfirstlane_b32 s38, v11
    s_nop 0
    s_cmp_lt_u32 s38, 1
    s_cbranch_scc1 Lcw_5
    s_mov_b64 exec, s[36:37]
    ds_read_b128 v[44:47], v6 offset:0
    ds_read_b128 v[48:51], v6 offset:64
    ds_read_b128 v[52:55], v6 offset:128
    ds_read_b128 v[56:59], v6 offset:192
    s_mov_b64 exec, vcc
    ds_read_b128 v[44:47], v6 offset:256
    ds_read_b128 v[48:51], v6 offset:320
    ds_read_b128 v[52:55], v6 offset:384
    ds_read_b128 v[56:59], v6 offset:448
    s_mov_b64 exec, -1
    s_waitcnt lgkmcnt(0)
    s_branch Lnofix
Lhalo:
    s_mov_b32 vcc_lo, 0x00010001
    s_mov_b32 vcc_hi, 0x00010001
    v_mov_b32 v11, 38912
    v_cndmask_b32 v76, v76, v11, vcc
    v_xor_b32 v77, 64, v76
    v_add_u32 v80, 78080, v76
    v_add_u32 v81, 78080, v77
    v_mov_b32 v14, 0x3f803f80
    v_mov_b32 v15, 0x3f803f80
    v_mov_b32 v16, 0x3f803f80
    v_mov_b32 v17, 0x3f803f80
    v_and_b32 v4, 7, v1
    v_lshlrev_b32 v4, 4, v4
    v_mul_u32_u24 v5, 39040, v2
    v_add_u32 v4, v4, v5
    ds_write_b128 v4, v[14:17] offset:38912
    v_mov_b32 v4, 157952
    v_mov_b32 v8, 0
    v_mov_b32 v9, 0
    v_mov_b32 v10, -2
    v_mov_b32 v11, -2
    ds_write_b128 v4, v[8:11]
    v_min_u32 v5, 23, v1
    v_lshl_add_u32 v5, v5, 2, v4
    ds_write_b32 v5, v8 offset:16
    s_mul_i32 s36, s32, 96
    s_sub_u32 s36, s36, 16
    v_add_u32 v96, s36, v1
    v_min_u32 v5, 47, v1
    v_add3_u32 v97, s36, v5, 64
    v_mov_b32 v6, 2047
    v_med3_i32 v96, v96, 0, v6
    v_med3_i32 v97, v97, 0, v6
    v_lshlrev_b32 v96, 3, v96
    v_lshlrev_b32 v97, 3, v97
    s_mov_b32 s46, 8192000
    v_mov_b32 v127, 157984
    s_lshl_b32 s36, s3, 2
    s_add_u32 s36, s36, 158016
    v_mov_b32 v10, s36
    s_mov_b32 vcc_lo, 0x00010001
    s_mov_b32 vcc_hi, 0x00010001
    v_cndmask_b32 v116, 0, v14, vcc
    v_cndmask_b32 v117, 0, v15, vcc
    v_cndmask_b32 v118, 0, v16, vcc
    v_cndmask_b32 v119, 0, v17, vcc
    s_waitcnt vmcnt(0)
    s_waitcnt lgkmcnt(0)
    s_barrier
    s_add_u32 s34, s34, 0x9e3779b8
    s_or_b32 s34, s34, 1
    ds_read_b128 v[108:111], v76 offset:0
    ds_read_b128 v[112:115], v77 offset:0
    ds_read_b64_tr_b16 a[0:1], v20 offset:0
    ds_read_b64_tr_b16 a[2:3], v20 offset:512
    ds_read_b64_tr_b16 a[4:5], v21 offset:0
    ds_read_b64_tr_b16 a[6:7], v21 offset:512
    ds_read_b64_tr_b16 a[8:9], v22 offset:0
    ds_read_b64_tr_b16 a[10:11], v22 offset:512
    ds_read_b64_tr_b16 a[12:13], v23 offset:0
    ds_read_b64_tr_b16 a[14:15], v23 offset:512
    ds_read_b64_tr_b16 a[16:17], v20 offset:8192
    ds_read_b64_tr_b16 a[18:19], v20 offset:8704
    ds_read_b64_tr_b16 a[20:21], v21 offset:8192
    ds_read_b64_tr_b16 a[22:23], v21 offset:8704
    ds_read_b64_tr_b16 a[24:25], v22 offset:8192
    ds_read_b64_tr_b16 a[26:27], v22 offset:8704
    s_waitcnt lgkmcnt(12)
    v_mfma_f32_16x16x32_bf16 v[28:31], a[0:3], v[116:119], 0
    ds_read_b64_tr_b16 a[28:29], v23 offset:8192
    ds_read_b64_tr_b16 a[30:31], v23 offset:8704
    s_waitcnt lgkmcnt(12)
    v_mfma_f32_16x16x32_bf16 v[32:35], a[4:7], v[116:119], 0
    ds_read_b64_tr_b16 a[32:33], v20 offset:16384
    ds_read_b64_tr_b16 a[34:35], v20 offset:16896
    s_waitcnt lgkmcnt(12)
    v_mfma_f32_16x16x32_bf16 v[36:39], a[8:11], v[116:119], 0
    ds_read_b64_tr_b16 a[36:37], v21 offset:16384
    ds_read_b64_tr_b16 a[38:39], v21 offset:16896
    s_waitcnt lgkmcnt(12)
    v_mfma_f32_16x16x32_bf16 v[40:43], a[12:15], v[116:119], 0
    ds_read_b64_tr_b16 a[40:41], v22 offset:16384
    ds_read_b64_tr_b16 a[42:43], v22 offset:16896
    s_waitcnt lgkmcnt(12)
    v_mfma_f32_16x16x32_bf16 v[44:47], a[16:19], v[108:111], 0
    ds_read_b64_tr_b16 a[44:45], v23 offset:16384
    ds_read_b64_tr_b16 a[46:47], v23 offset:16896
    s_waitcnt lgkmcnt(12)
    v_mfma_f32_16x16x32_bf16 v[48:51], a[20:23], v[108:111], 0
    ds_read_b64_tr_b16 a[48:49], v20 offset:4096
    ds_read_b64_tr_b16 a[50:51], v20 offset:4608
    s_waitcnt lgkmcnt(12)
    v_mfma_f32_16x16x32_bf16 v[52:55], a[24:27], v[108:111], 0
    ds_read_b64_tr_b16 a[52:53], v21 offset:4096
    ds_read_b64_tr_b16 a[54:55], v21 offset:4608
    s_waitcnt lgkmcnt(12)
    v_mfma_f32_16x16x32_bf16 v[56:59], a[28:31], v[108:111], 0
    ds_read_b64_tr_b16 a[56:57], v22 offset:4096
    ds_read_b64_tr_b16 a[58:59], v22 offset:4608
    s_waitcnt lgkmcnt(12)
    v_mfma_f32_16x16x32_bf16 v[60:63], v[108:111], a[32:35], 0
    ds_read_b64_tr_b16 a[60:61], v23 offset:4096
    ds_read_b64_tr_b16 a[62:63], v23 offset:4608
    s_waitcnt lgkmcnt(12)
    v_mfma_f32_16x16x32_bf16 v[64:67], v[108:111], a[36:39], 0
    ds_read_b64_tr_b16 a[64:65], v20 offset:12288
    ds_read_b64_tr_b16 a[66:67], v20 offset:12800
    s_waitcnt lgkmcnt(12)
    v_mfma_f32_16x16x32_bf16 v[68:71], v[108:111], a[40:43], 0
    ds_read_b64_tr_b16 a[68:69], v21 offset:12288
    ds_read_b64_tr_b16 a[70:71], v21 offset:12800
    s_waitcnt lgkmcnt(12)
    v_mfma_f32_16x16x32_bf16 v[72:75], v[108:111], a[44:47], 0
    ds_read_b64_tr_b16 a[72:73], v22 offset:12288
    ds_read_b64_tr_b16 a[74:75], v22 offset:12800
    s_waitcnt lgkmcnt(12)
    v_mfma_f32_16x16x32_bf16 v[28:31], a[48:51], v[116:119], v[28:31]
    ds_read_b64_tr_b16 a[76:77], v23 offset:12288
    ds_read_b64_tr_b16 a[78:79], v23 offset:12800
    s_waitcnt lgkmcnt(12)
    v_mfma_f32_16x16x32_bf16 v[32:35], a[52:55], v[116:119], v[32:35]
    ds_read_b64_tr_b16 a[80:81], v20 offset:20480
    ds_read_b64_tr_b16 a[82:83], v20 offset:20992
    s_waitcnt lgkmcnt(12)
    v_mfma_f32_16x16x32_bf16 v[36:39], a[56:59], v[116:119], v[36:39]
    ds_read_b64_tr_b16 a[84:85], v21 offset:20480
    ds_read_b64_tr_b16 a[86:87], v21 offset:20992
    s_waitcnt lgkmcnt(12)
    v_mfma_f32_16x16x32_bf16 v[40:43], a[60:63], v[116:119], v[40:43]
    ds_read_b64_tr_b16 a[88:89], v22 offset:20480
    ds_read_b64_tr_b16 a[90:91], v22 offset:20992
    s_waitcnt lgkmcnt(12)
    v_mfma_f32_16x16x32_bf16 v[44:47], a[64:67], v[112:115], v[44:47]
    ds_read_b64_tr_b16 a[92:93], v23 offset:20480
    ds_read_b64_tr_b16 a[94:95], v23 offset:20992
    s_waitcnt lgkmcnt(12)
    v_mfma_f32_16x16x32_bf16 v[48:51], a[68:71], v[112:115], v[48:51]
    s_waitcnt lgkmcnt(10)
    v_mfma_f32_16x16x32_bf16 v[52:55], a[72:75], v[112:115], v[52:55]
    s_waitcnt lgkmcnt(8)
    v_mfma_f32_16x16x32_bf16 v[56:59], a[76:79], v[112:115], v[56:59]
    s_waitcnt lgkmcnt(6)
    v_mfma_f32_16x16x32_bf16 v[60:63], v[112:115], a[80:83], v[60:63]
    s_waitcnt lgkmcnt(4)
    v_mfma_f32_16x16x32_bf16 v[64:67], v[112:115], a[84:87], v[64:67]
    s_waitcnt lgkmcnt(2)
    v_mfma_f32_16x16x32_bf16 v[68:71], v[112:115], a[88:91], v[68:71]
    s_waitcnt lgkmcnt(0)
    v_mfma_f32_16x16x32_bf16 v[72:75], v[112:115], a[92:95], v[72:75]
    s_barrier
    ds_read_b128 v[108:111], v76 offset:39040
    ds_read_b128 v[112:115], v77 offset:39040
    ds_read_b64_tr_b16 a[0:1], v20 offset:39040
    ds_read_b64_tr_b16 a[2:3], v20 offset:39552
    ds_read_b64_tr_b16 a[4:5], v21 offset:39040
    ds_read_b64_tr_b16 a[6:7], v21 offset:39552
    ds_read_b64_tr_b16 a[8:9], v22 offset:39040
    ds_read_b64_tr_b16 a[10:11], v22 offset:39552
    ds_read_b64_tr_b16 a[12:13], v23 offset:39040
    ds_read_b64_tr_b16 a[14:15], v23 offset:39552
    ds_read_b64_tr_b16 a[16:17], v20 offset:47232
    ds_read_b64_tr_b16 a[18:19], v20 offset:47744
    ds_read_b64_tr_b16 a[20:21], v21 offset:47232
    ds_read_b64_tr_b16 a[22:23], v21 offset:47744
    ds_read_b64_tr_b16 a[24:25], v22 offset:47232
    ds_read_b64_tr_b16 a[26:27], v22 offset:47744
    s_waitcnt lgkmcnt(12)
    v_mfma_f32_16x16x32_bf16 v[28:31], a[0:3], v[116:119], v[28:31]
    ds_read_b64_tr_b16 a[28:29], v23 offset:47232
    ds_read_b64_tr_b16 a[30:31], v23 offset:47744
    s_waitcnt lgkmcnt(12)
    v_mfma_f32_16x16x32_bf16 v[32:35], a[4:7], v[116:119], v[32:35]
    ds_read_b64_tr_b16 a[32:33], v20 offset:55424
    ds_read_b64_tr_b16 a[34:35], v20 offset:55936
    s_waitcnt lgkmcnt(12)
    v_mfma_f32_16x16x32_bf16 v[36:39], a[8:11], v[116:119], v[36:39]
    ds_read_b64_tr_b16 a[36:37], v21 offset:55424
    ds_read_b64_tr_b16 a[38:39], v21 offset:55936
    s_waitcnt lgkmcnt(12)
    v_mfma_f32_16x16x32_bf16 v[40:43], a[12:15], v[116:119], v[40:43]
    ds_read_b64_tr_b16 a[40:41], v22 offset:55424
    ds_read_b64_tr_b16 a[42:43], v22 offset:55936
    s_waitcnt lgkmcnt(12)
    v_mfma_f32_16x16x32_bf16 v[44:47], a[16:19], v[108:111], v[44:47]
    ds_read_b64_tr_b16 a[44:45], v23 offset:55424
    ds_read_b64_tr_b16 a[46:47], v23 offset:55936
    s_waitcnt lgkmcnt(12)
    v_mfma_f32_16x16x32_bf16 v[48:51], a[20:23], v[108:111], v[48:51]
    ds_read_b64_tr_b16 a[48:49], v20 offset:43136
    ds_read_b64_tr_b16 a[50:51], v20 offset:43648
    s_waitcnt lgkmcnt(12)
    v_mfma_f32_16x16x32_bf16 v[52:55], a[24:27], v[108:111], v[52:55]
    ds_read_b64_tr_b16 a[52:53], v21 offset:43136
    ds_read_b64_tr_b16 a[54:55], v21 offset:43648
    s_waitcnt lgkmcnt(12)
    v_mfma_f32_16x16x32_bf16 v[56:59], a[28:31], v[108:111], v[56:59]
    ds_read_b64_tr_b16 a[56:57], v22 offset:43136
    ds_read_b64_tr_b16 a[58:59], v22 offset:43648
    s_waitcnt lgkmcnt(12)
    v_mfma_f32_16x16x32_bf16 v[60:63], v[108:111], a[32:35], v[60:63]
    ds_read_b64_tr_b16 a[60:61], v23 offset:43136
    ds_read_b64_tr_b16 a[62:63], v23 offset:43648
    s_waitcnt lgkmcnt(12)
    v_mfma_f32_16x16x32_bf16 v[64:67], v[108:111], a[36:39], v[64:67]
    ds_read_b64_tr_b16 a[64:65], v20 offset:51328
    ds_read_b64_tr_b16 a[66:67], v20 offset:51840
    s_waitcnt lgkmcnt(12)
    v_mfma_f32_16x16x32_bf16 v[68:71], v[108:111], a[40:43], v[68:71]
    ds_read_b64_tr_b16 a[68:69], v21 offset:51328
    ds_read_b64_tr_b16 a[70:71], v21 offset:51840
    s_waitcnt lgkmcnt(12)
    v_mfma_f32_16x16x32_bf16 v[72:75], v[108:111], a[44:47], v[72:75]
    ds_read_b64_tr_b16 a[72:73], v22 offset:51328
    ds_read_b64_tr_b16 a[74:75], v22 offset:51840
    s_waitcnt lgkmcnt(12)
    v_mfma_f32_16x16x32_bf16 v[28:31], a[48:51], v[116:119], v[28:31]
    ds_read_b64_tr_b16 a[76:77], v23 offset:51328
    ds_read_b64_tr_b16 a[78:79], v23 offset:51840
    s_waitcnt lgkmcnt(12)
    v_mfma_f32_16x16x32_bf16 v[32:35], a[52:55], v[116:119], v[32:35]
    ds_read_b64_tr_b16 a[80:81], v20 offset:59520
    ds_read_b64_tr_b16 a[82:83], v20 offset:60032
    s_waitcnt lgkmcnt(12)
    v_mfma_f32_16x16x32_bf16 v[36:39], a[56:59], v[116:119], v[36:39]
    ds_read_b64_tr_b16 a[84:85], v21 offset:59520
    ds_read_b64_tr_b16 a[86:87], v21 offset:60032
    s_waitcnt lgkmcnt(12)
    v_mfma_f32_16x16x32_bf16 v[40:43], a[60:63], v[116:119], v[40:43]
    ds_read_b64_tr_b16 a[88:89], v22 offset:59520
    ds_read_b64_tr_b16 a[90:91], v22 offset:60032
    s_waitcnt lgkmcnt(12)
    v_mfma_f32_16x16x32_bf16 v[44:47], a[64:67], v[112:115], v[44:47]
    ds_read_b64_tr_b16 a[92:93], v23 offset:59520
    ds_read_b64_tr_b16 a[94:95], v23 offset:60032
    s_waitcnt lgkmcnt(12)
    v_mfma_f32_16x16x32_bf16 v[48:51], a[68:71], v[112:115], v[48:51]
    s_waitcnt lgkmcnt(10)
    v_mfma_f32_16x16x32_bf16 v[52:55], a[72:75], v[112:115], v[52:55]
    s_waitcnt lgkmcnt(8)
    v_mfma_f32_16x16x32_bf16 v[56:59], a[76:79], v[112:115], v[56:59]
    s_waitcnt lgkmcnt(6)
    v_mfma_f32_16x16x32_bf16 v[60:63], v[112:115], a[80:83], v[60:63]
    s_waitcnt lgkmcnt(4)
    v_mfma_f32_16x16x32_bf16 v[64:67], v[112:115], a[84:87], v[64:67]
    s_waitcnt lgkmcnt(2)
    v_mfma_f32_16x16x32_bf16 v[68:71], v[112:115], a[88:91], v[68:71]
    s_waitcnt lgkmcnt(0)
    v_mfma_f32_16x16x32_bf16 v[72:75], v[112:115], a[92:95], v[72:75]
    s_mov_b64 exec, 1
    s_lshl_b32 s36, s2, 2
    s_add_u32 s36, s36, 8323072
    v_mov_b32 v4, s34
    v_mov_b32 v5, s36
    buffer_store_dword v4, v5, s[28:31], 0 offen sc1
    s_mov_b64 exec, -1
    s_barrier
    ds_read_b128 v[108:111], v80 offset:0
    ds_read_b128 v[112:115], v81 offset:0
    ds_read_b64_tr_b16 a[0:1], v24 offset:0
    ds_read_b64_tr_b16 a[2:3], v24 offset:512
    ds_read_b64_tr_b16 a[4:5], v25 offset:0
    ds_read_b64_tr_b16 a[6:7], v25 offset:512
    ds_read_b64_tr_b16 a[8:9], v26 offset:0
    ds_read_b64_tr_b16 a[10:11], v26 offset:512
    ds_read_b64_tr_b16 a[12:13], v27 offset:0
    ds_read_b64_tr_b16 a[14:15], v27 offset:512
    ds_read_b64_tr_b16 a[16:17], v24 offset:8192
    ds_read_b64_tr_b16 a[18:19], v24 offset:8704
    ds_read_b64_tr_b16 a[20:21], v25 offset:8192
    ds_read_b64_tr_b16 a[22:23], v25 offset:8704
    ds_read_b64_tr_b16 a[24:25], v26 offset:8192
    ds_read_b64_tr_b16 a[26:27], v26 offset:8704
    s_waitcnt lgkmcnt(12)
    v_mfma_f32_16x16x32_bf16 v[28:31], a[0:3], v[116:119], v[28:31]
    ds_read_b64_tr_b16 a[28:29], v27 offset:8192
    ds_read_b64_tr_b16 a[30:31], v27 offset:8704
    s_waitcnt lgkmcnt(12)
    v_mfma_f32_16x16x32_bf16 v[32:35], a[4:7], v[116:119], v[32:35]
    ds_read_b64_tr_b16 a[32:33], v24 offset:16384
    ds_read_b64_tr_b16 a[34:35], v24 offset:16896
    s_waitcnt lgkmcnt(12)
    v_mfma_f32_16x16x32_bf16 v[36:39], a[8:11], v[116:119], v[36:39]
    ds_read_b64_tr_b16 a[36:37], v25 offset:16384
    ds_read_b64_tr_b16 a[38:39], v25 offset:16896
    s_waitcnt lgkmcnt(12)
    v_mfma_f32_16x16x32_bf16 v[40:43], a[12:15], v[116:119], v[40:43]
    ds_read_b64_tr_b16 a[40:41], v26 offset:16384
    ds_read_b64_tr_b16 a[42:43], v26 offset:16896
    s_waitcnt lgkmcnt(12)
    v_mfma_f32_16x16x32_bf16 v[44:47], a[16:19], v[108:111], v[44:47]
    ds_read_b64_tr_b16 a[44:45], v27 offset:16384
    ds_read_b64_tr_b16 a[46:47], v27 offset:16896
    s_waitcnt lgkmcnt(12)
    v_mfma_f32_16x16x32_bf16 v[48:51], a[20:23], v[108:111], v[48:51]
    ds_read_b64_tr_b16 a[48:49], v24 offset:4096
    ds_read_b64_tr_b16 a[50:51], v24 offset:4608
    s_waitcnt lgkmcnt(12)
    v_mfma_f32_16x16x32_bf16 v[52:55], a[24:27], v[108:111], v[52:55]
    ds_read_b64_tr_b16 a[52:53], v25 offset:4096
    ds_read_b64_tr_b16 a[54:55], v25 offset:4608
    s_waitcnt lgkmcnt(12)
    v_mfma_f32_16x16x32_bf16 v[56:59], a[28:31], v[108:111], v[56:59]
    ds_read_b64_tr_b16 a[56:57], v26 offset:4096
    ds_read_b64_tr_b16 a[58:59], v26 offset:4608
    s_waitcnt lgkmcnt(12)
    v_mfma_f32_16x16x32_bf16 v[60:63], v[108:111], a[32:35], v[60:63]
    ds_read_b64_tr_b16 a[60:61], v27 offset:4096
    ds_read_b64_tr_b16 a[62:63], v27 offset:4608
    s_waitcnt lgkmcnt(12)
    v_mfma_f32_16x16x32_bf16 v[64:67], v[108:111], a[36:39], v[64:67]
    ds_read_b64_tr_b16 a[64:65], v24 offset:12288
    ds_read_b64_tr_b16 a[66:67], v24 offset:12800
    s_waitcnt lgkmcnt(12)
    v_mfma_f32_16x16x32_bf16 v[68:71], v[108:111], a[40:43], v[68:71]
    ds_read_b64_tr_b16 a[68:69], v25 offset:12288
    ds_read_b64_tr_b16 a[70:71], v25 offset:12800
    s_waitcnt lgkmcnt(12)
    v_mfma_f32_16x16x32_bf16 v[72:75], v[108:111], a[44:47], v[72:75]
    ds_read_b64_tr_b16 a[72:73], v26 offset:12288
    ds_read_b64_tr_b16 a[74:75], v26 offset:12800
    s_waitcnt lgkmcnt(12)
    v_mfma_f32_16x16x32_bf16 v[28:31], a[48:51], v[116:119], v[28:31]
    ds_read_b64_tr_b16 a[76:77], v27 offset:12288
    ds_read_b64_tr_b16 a[78:79], v27 offset:12800
    s_waitcnt lgkmcnt(12)
    v_mfma_f32_16x16x32_bf16 v[32:35], a[52:55], v[116:119], v[32:35]
    ds_read_b64_tr_b16 a[80:81], v24 offset:20480
    ds_read_b64_tr_b16 a[82:83], v24 offset:20992
    s_waitcnt lgkmcnt(12)
    v_mfma_f32_16x16x32_bf16 v[36:39], a[56:59], v[116:119], v[36:39]
    ds_read_b64_tr_b16 a[84:85], v25 offset:20480
    ds_read_b64_tr_b16 a[86:87], v25 offset:20992
    s_waitcnt lgkmcnt(12)
    v_mfma_f32_16x16x32_bf16 v[40:43], a[60:63], v[116:119], v[40:43]
    ds_read_b64_tr_b16 a[88:89], v26 offset:20480
    ds_read_b64_tr_b16 a[90:91], v26 offset:20992
    s_waitcnt lgkmcnt(12)
    v_mfma_f32_16x16x32_bf16 v[44:47], a[64:67], v[112:115], v[44:47]
    ds_read_b64_tr_b16 a[92:93], v27 offset:20480
    ds_read_b64_tr_b16 a[94:95], v27 offset:20992
    s_waitcnt lgkmcnt(12)
    v_mfma_f32_16x16x32_bf16 v[48:51], a[68:71], v[112:115], v[48:51]
    s_waitcnt lgkmcnt(10)
    v_mfma_f32_16x16x32_bf16 v[52:55], a[72:75], v[112:115], v[52:55]
    s_waitcnt lgkmcnt(8)
    v_mfma_f32_16x16x32_bf16 v[56:59], a[76:79], v[112:115], v[56:59]
    s_waitcnt lgkmcnt(6)
    v_mfma_f32_16x16x32_bf16 v[60:63], v[112:115], a[80:83], v[60:63]
    s_waitcnt lgkmcnt(4)
    v_mfma_f32_16x16x32_bf16 v[64:67], v[112:115], a[84:87], v[64:67]
    s_waitcnt lgkmcnt(2)
    v_mfma_f32_16x16x32_bf16 v[68:71], v[112:115], a[88:91], v[68:71]
    s_waitcnt lgkmcnt(0)
    v_mfma_f32_16x16x32_bf16 v[72:75], v[112:115], a[92:95], v[72:75]
    s_barrier
    ds_read_b128 v[108:111], v80 offset:39040
    ds_read_b128 v[112:115], v81 offset:39040
    ds_read_b64_tr_b16 a[0:1], v24 offset:39040
    ds_read_b64_tr_b16 a[2:3], v24 offset:39552
    ds_read_b64_tr_b16 a[4:5], v25 offset:39040
    ds_read_b64_tr_b16 a[6:7], v25 offset:39552
    ds_read_b64_tr_b16 a[8:9], v26 offset:39040
    ds_read_b64_tr_b16 a[10:11], v26 offset:39552
    ds_read_b64_tr_b16 a[12:13], v27 offset:39040
    ds_read_b64_tr_b16 a[14:15], v27 offset:39552
    ds_read_b64_tr_b16 a[16:17], v24 offset:47232
    ds_read_b64_tr_b16 a[18:19], v24 offset:47744
    ds_read_b64_tr_b16 a[20:21], v25 offset:47232
    ds_read_b64_tr_b16 a[22:23], v25 offset:47744
    ds_read_b64_tr_b16 a[24:25], v26 offset:47232
    ds_read_b64_tr_b16 a[26:27], v26 offset:47744
    s_waitcnt lgkmcnt(12)
    v_mfma_f32_16x16x32_bf16 v[28:31], a[0:3], v[116:119], v[28:31]
    ds_read_b64_tr_b16 a[28:29], v27 offset:47232
    ds_read_b64_tr_b16 a[30:31], v27 offset:47744
    s_waitcnt lgkmcnt(12)
    v_mfma_f32_16x16x32_bf16 v[32:35], a[4:7], v[116:119], v[32:35]
    ds_read_b64_tr_b16 a[32:33], v24 offset:55424
    ds_read_b64_tr_b16 a[34:35], v24 offset:55936
    s_waitcnt lgkmcnt(12)
    v_mfma_f32_16x16x32_bf16 v[36:39], a[8:11], v[116:119], v[36:39]
    ds_read_b64_tr_b16 a[36:37], v25 offset:55424
    ds_read_b64_tr_b16 a[38:39], v25 offset:55936
    s_waitcnt lgkmcnt(12)
    v_mfma_f32_16x16x32_bf16 v[40:43], a[12:15], v[116:119], v[40:43]
    ds_read_b64_tr_b16 a[40:41], v26 offset:55424
    ds_read_b64_tr_b16 a[42:43], v26 offset:55936
    s_waitcnt lgkmcnt(12)
    v_mfma_f32_16x16x32_bf16 v[44:47], a[16:19], v[108:111], v[44:47]
    ds_read_b64_tr_b16 a[44:45], v27 offset:55424
    ds_read_b64_tr_b16 a[46:47], v27 offset:55936
    s_waitcnt lgkmcnt(12)
    v_mfma_f32_16x16x32_bf16 v[48:51], a[20:23], v[108:111], v[48:51]
    ds_read_b64_tr_b16 a[48:49], v24 offset:43136
    ds_read_b64_tr_b16 a[50:51], v24 offset:43648
    s_waitcnt lgkmcnt(12)
    v_mfma_f32_16x16x32_bf16 v[52:55], a[24:27], v[108:111], v[52:55]
    ds_read_b64_tr_b16 a[52:53], v25 offset:43136
    ds_read_b64_tr_b16 a[54:55], v25 offset:43648
    s_waitcnt lgkmcnt(12)
    v_mfma_f32_16x16x32_bf16 v[56:59], a[28:31], v[108:111], v[56:59]
    ds_read_b64_tr_b16 a[56:57], v26 offset:43136
    ds_read_b64_tr_b16 a[58:59], v26 offset:43648
    s_waitcnt lgkmcnt(12)
    v_mfma_f32_16x16x32_bf16 v[60:63], v[108:111], a[32:35], v[60:63]
    ds_read_b64_tr_b16 a[60:61], v27 offset:43136
    ds_read_b64_tr_b16 a[62:63], v27 offset:43648
    s_waitcnt lgkmcnt(12)
    v_mfma_f32_16x16x32_bf16 v[64:67], v[108:111], a[36:39], v[64:67]
    ds_read_b64_tr_b16 a[64:65], v24 offset:51328
    ds_read_b64_tr_b16 a[66:67], v24 offset:51840
    s_waitcnt lgkmcnt(12)
    v_mfma_f32_16x16x32_bf16 v[68:71], v[108:111], a[40:43], v[68:71]
    ds_read_b64_tr_b16 a[68:69], v25 offset:51328
    ds_read_b64_tr_b16 a[70:71], v25 offset:51840
    s_waitcnt lgkmcnt(12)
    v_mfma_f32_16x16x32_bf16 v[72:75], v[108:111], a[44:47], v[72:75]
    ds_read_b64_tr_b16 a[72:73], v26 offset:51328
    ds_read_b64_tr_b16 a[74:75], v26 offset:51840
    s_waitcnt lgkmcnt(12)
    v_mfma_f32_16x16x32_bf16 v[28:31], a[48:51], v[116:119], v[28:31]
    ds_read_b64_tr_b16 a[76:77], v27 offset:51328
    ds_read_b64_tr_b16 a[78:79], v27 offset:51840
    s_waitcnt lgkmcnt(12)
    v_mfma_f32_16x16x32_bf16 v[32:35], a[52:55], v[116:119], v[32:35]
    ds_read_b64_tr_b16 a[80:81], v24 offset:59520
    ds_read_b64_tr_b16 a[82:83], v24 offset:60032
    s_waitcnt lgkmcnt(12)
    v_mfma_f32_16x16x32_bf16 v[36:39], a[56:59], v[116:119], v[36:39]
    ds_read_b64_tr_b16 a[84:85], v25 offset:59520
    ds_read_b64_tr_b16 a[86:87], v25 offset:60032
    s_waitcnt lgkmcnt(12)
    v_mfma_f32_16x16x32_bf16 v[40:43], a[60:63], v[116:119], v[40:43]
    ds_read_b64_tr_b16 a[88:89], v26 offset:59520
    ds_read_b64_tr_b16 a[90:91], v26 offset:60032
    s_waitcnt lgkmcnt(12)
    v_mfma_f32_16x16x32_bf16 v[44:47], a[64:67], v[112:115], v[44:47]
    ds_read_b64_tr_b16 a[92:93], v27 offset:59520
    ds_read_b64_tr_b16 a[94:95], v27 offset:60032
    s_waitcnt lgkmcnt(12)
    v_mfma_f32_16x16x32_bf16 v[48:51], a[68:71], v[112:115], v[48:51]
    s_waitcnt lgkmcnt(10)
    v_mfma_f32_16x16x32_bf16 v[52:55], a[72:75], v[112:115], v[52:55]
    s_waitcnt lgkmcnt(8)
    v_mfma_f32_16x16x32_bf16 v[56:59], a[76:79], v[112:115], v[56:59]
    s_waitcnt lgkmcnt(6)
    v_mfma_f32_16x16x32_bf16 v[60:63], v[112:115], a[80:83], v[60:63]
    s_waitcnt lgkmcnt(4)
    v_mfma_f32_16x16x32_bf16 v[64:67], v[112:115], a[84:87], v[64:67]
    s_waitcnt lgkmcnt(2)
    v_mfma_f32_16x16x32_bf16 v[68:71], v[112:115], a[88:91], v[68:71]
    s_waitcnt lgkmcnt(0)
    v_mfma_f32_16x16x32_bf16 v[72:75], v[112:115], a[92:95], v[72:75]
    v_add_u32 v4, 156224, v12
    v_min_u32 v5, 47, v1
    v_lshlrev_b32 v5, 2, v5
    v_add_u32 v5, 156480, v5
    v_lshlrev_b32 v6, 4, v2
    v_add_u32 v6, 157184, v6
    v_mov_b32 v7, 157968
    v_lshlrev_b32 v11, 2, v3
    v_add_u32 v11, 156224, v11
    s_barrier
    ds_read_b128 v[108:111], v76 offset:0
    ds_read_b128 v[112:115], v77 offset:0
    ds_read_b64_tr_b16 a[0:1], v20 offset:0
    ds_read_b64_tr_b16 a[2:3], v20 offset:512
    ds_read_b64_tr_b16 a[4:5], v21 offset:0
    ds_read_b64_tr_b16 a[6:7], v21 offset:512
    ds_read_b64_tr_b16 a[8:9], v22 offset:0
    ds_read_b64_tr_b16 a[10:11], v22 offset:512
    ds_read_b64_tr_b16 a[12:13], v23 offset:0
    ds_read_b64_tr_b16 a[14:15], v23 offset:512
    ds_read_b64_tr_b16 a[16:17], v20 offset:8192
    ds_read_b64_tr_b16 a[18:19], v20 offset:8704
    ds_read_b64_tr_b16 a[20:21], v21 offset:8192
    ds_read_b64_tr_b16 a[22:23], v21 offset:8704
    ds_read_b64_tr_b16 a[24:25], v22 offset:8192
    ds_read_b64_tr_b16 a[26:27], v22 offset:8704
    s_waitcnt lgkmcnt(12)
    v_mfma_f32_16x16x32_bf16 v[28:31], a[0:3], v[116:119], v[28:31]
    ds_read_b64_tr_b16 a[28:29], v23 offset:8192
    ds_read_b64_tr_b16 a[30:31], v23 offset:8704
    s_waitcnt lgkmcnt(12)
    v_mfma_f32_16x16x32_bf16 v[32:35], a[4:7], v[116:119], v[32:35]
    ds_read_b64_tr_b16 a[32:33], v20 offset:16384
    ds_read_b64_tr_b16 a[34:35], v20 offset:16896
    s_waitcnt lgkmcnt(12)
    v_mfma_f32_16x16x32_bf16 v[36:39], a[8:11], v[116:119], v[36:39]
    ds_read_b64_tr_b16 a[36:37], v21 offset:16384
    ds_read_b64_tr_b16 a[38:39], v21 offset:16896
    s_waitcnt lgkmcnt(12)
    v_mfma_f32_16x16x32_bf16 v[40:43], a[12:15], v[116:119], v[40:43]
    ds_read_b64_tr_b16 a[40:41], v22 offset:16384
    ds_read_b64_tr_b16 a[42:43], v22 offset:16896
    s_waitcnt lgkmcnt(12)
    v_mfma_f32_16x16x32_bf16 v[44:47], a[16:19], v[108:111], v[44:47]
    ds_read_b64_tr_b16 a[44:45], v23 offset:16384
    ds_read_b64_tr_b16 a[46:47], v23 offset:16896
    s_waitcnt lgkmcnt(12)
    v_mfma_f32_16x16x32_bf16 v[48:51], a[20:23], v[108:111], v[48:51]
    ds_read_b64_tr_b16 a[48:49], v20 offset:4096
    ds_read_b64_tr_b16 a[50:51], v20 offset:4608
    s_waitcnt lgkmcnt(12)
    v_mfma_f32_16x16x32_bf16 v[52:55], a[24:27], v[108:111], v[52:55]
    ds_read_b64_tr_b16 a[52:53], v21 offset:4096
    ds_read_b64_tr_b16 a[54:55], v21 offset:4608
    s_waitcnt lgkmcnt(12)
    v_mfma_f32_16x16x32_bf16 v[56:59], a[28:31], v[108:111], v[56:59]
    ds_read_b64_tr_b16 a[56:57], v22 offset:4096
    ds_read_b64_tr_b16 a[58:59], v22 offset:4608
    s_waitcnt lgkmcnt(12)
    v_mfma_f32_16x16x32_bf16 v[60:63], v[108:111], a[32:35], v[60:63]
    ds_read_b64_tr_b16 a[60:61], v23 offset:4096
    ds_read_b64_tr_b16 a[62:63], v23 offset:4608
    s_waitcnt lgkmcnt(12)
    v_mfma_f32_16x16x32_bf16 v[64:67], v[108:111], a[36:39], v[64:67]
    ds_read_b64_tr_b16 a[64:65], v20 offset:12288
    ds_read_b64_tr_b16 a[66:67], v20 offset:12800
    s_waitcnt lgkmcnt(12)
    v_mfma_f32_16x16x32_bf16 v[68:71], v[108:111], a[40:43], v[68:71]
    ds_read_b64_tr_b16 a[68:69], v21 offset:12288
    ds_read_b64_tr_b16 a[70:71], v21 offset:12800
    s_waitcnt lgkmcnt(12)
    v_mfma_f32_16x16x32_bf16 v[72:75], v[108:111], a[44:47], v[72:75]
    ds_read_b64_tr_b16 a[72:73], v22 offset:12288
    ds_read_b64_tr_b16 a[74:75], v22 offset:12800
    s_waitcnt lgkmcnt(12)
    v_mfma_f32_16x16x32_bf16 v[28:31], a[48:51], v[116:119], v[28:31]
    ds_read_b64_tr_b16 a[76:77], v23 offset:12288
    ds_read_b64_tr_b16 a[78:79], v23 offset:12800
    s_waitcnt lgkmcnt(12)
    v_mfma_f32_16x16x32_bf16 v[32:35], a[52:55], v[116:119], v[32:35]
    ds_read_b64_tr_b16 a[80:81], v20 offset:20480
    ds_read_b64_tr_b16 a[82:83], v20 offset:20992
    s_waitcnt lgkmcnt(12)
    v_mfma_f32_16x16x32_bf16 v[36:39], a[56:59], v[116:119], v[36:39]
    ds_read_b64_tr_b16 a[84:85], v21 offset:20480
    ds_read_b64_tr_b16 a[86:87], v21 offset:20992
    s_waitcnt lgkmcnt(12)
    v_mfma_f32_16x16x32_bf16 v[40:43], a[60:63], v[116:119], v[40:43]
    ds_read_b64_tr_b16 a[88:89], v22 offset:20480
    ds_read_b64_tr_b16 a[90:91], v22 offset:20992
    s_waitcnt lgkmcnt(12)
    v_mfma_f32_16x16x32_bf16 v[44:47], a[64:67], v[112:115], v[44:47]
    ds_read_b64_tr_b16 a[92:93], v23 offset:20480
    ds_read_b64_tr_b16 a[94:95], v23 offset:20992
    s_waitcnt lgkmcnt(12)
    v_mfma_f32_16x16x32_bf16 v[48:51], a[68:71], v[112:115], v[48:51]
    s_waitcnt lgkmcnt(10)
    v_mfma_f32_16x16x32_bf16 v[52:55], a[72:75], v[112:115], v[52:55]
    s_waitcnt lgkmcnt(8)
    v_mfma_f32_16x16x32_bf16 v[56:59], a[76:79], v[112:115], v[56:59]
    s_waitcnt lgkmcnt(6)
    v_mfma_f32_16x16x32_bf16 v[60:63], v[112:115], a[80:83], v[60:63]
    s_waitcnt lgkmcnt(4)
    v_mfma_f32_16x16x32_bf16 v[64:67], v[112:115], a[84:87], v[64:67]
    s_waitcnt lgkmcnt(2)
    v_mfma_f32_16x16x32_bf16 v[68:71], v[112:115], a[88:91], v[68:71]
    s_waitcnt lgkmcnt(0)
    v_mfma_f32_16x16x32_bf16 v[72:75], v[112:115], a[92:95], v[72:75]
    s_barrier
    ds_read_b128 v[108:111], v76 offset:39040
    ds_read_b128 v[112:115], v77 offset:39040
    ds_read_b64_tr_b16 a[0:1], v20 offset:39040
    ds_read_b64_tr_b16 a[2:3], v20 offset:39552
    ds_read_b64_tr_b16 a[4:5], v21 offset:39040
    ds_read_b64_tr_b16 a[6:7], v21 offset:39552
    ds_read_b64_tr_b16 a[8:9], v22 offset:39040
    ds_read_b64_tr_b16 a[10:11], v22 offset:39552
    ds_read_b64_tr_b16 a[12:13], v23 offset:39040
    ds_read_b64_tr_b16 a[14:15], v23 offset:39552
    ds_read_b64_tr_b16 a[16:17], v20 offset:47232
    ds_read_b64_tr_b16 a[18:19], v20 offset:47744
    ds_read_b64_tr_b16 a[20:21], v21 offset:47232
    ds_read_b64_tr_b16 a[22:23], v21 offset:47744
    ds_read_b64_tr_b16 a[24:25], v22 offset:47232
    ds_read_b64_tr_b16 a[26:27], v22 offset:47744
    s_waitcnt lgkmcnt(12)
    v_mfma_f32_16x16x32_bf16 v[28:31], a[0:3], v[116:119], v[28:31]
    ds_read_b64_tr_b16 a[28:29], v23 offset:47232
    ds_read_b64_tr_b16 a[30:31], v23 offset:47744
    s_waitcnt lgkmcnt(12)
    v_mfma_f32_16x16x32_bf16 v[32:35], a[4:7], v[116:119], v[32:35]
    ds_read_b64_tr_b16 a[32:33], v20 offset:55424
    ds_read_b64_tr_b16 a[34:35], v20 offset:55936
    s_waitcnt lgkmcnt(12)
    v_mfma_f32_16x16x32_bf16 v[36:39], a[8:11], v[116:119], v[36:39]
    ds_read_b64_tr_b16 a[36:37], v21 offset:55424
    ds_read_b64_tr_b16 a[38:39], v21 offset:55936
    s_waitcnt lgkmcnt(12)
    v_mfma_f32_16x16x32_bf16 v[40:43], a[12:15], v[116:119], v[40:43]
    ds_read_b64_tr_b16 a[40:41], v22 offset:55424
    ds_read_b64_tr_b16 a[42:43], v22 offset:55936
    s_waitcnt lgkmcnt(12)
    v_mfma_f32_16x16x32_bf16 v[44:47], a[16:19], v[108:111], v[44:47]
    ds_read_b64_tr_b16 a[44:45], v23 offset:55424
    ds_read_b64_tr_b16 a[46:47], v23 offset:55936
    s_waitcnt lgkmcnt(12)
    v_mfma_f32_16x16x32_bf16 v[48:51], a[20:23], v[108:111], v[48:51]
    ds_read_b64_tr_b16 a[48:49], v20 offset:43136
    ds_read_b64_tr_b16 a[50:51], v20 offset:43648
    s_waitcnt lgkmcnt(12)
    v_mfma_f32_16x16x32_bf16 v[52:55], a[24:27], v[108:111], v[52:55]
    ds_read_b64_tr_b16 a[52:53], v21 offset:43136
    ds_read_b64_tr_b16 a[54:55], v21 offset:43648
    s_waitcnt lgkmcnt(12)
    v_mfma_f32_16x16x32_bf16 v[56:59], a[28:31], v[108:111], v[56:59]
    ds_read_b64_tr_b16 a[56:57], v22 offset:43136
    ds_read_b64_tr_b16 a[58:59], v22 offset:43648
    s_waitcnt lgkmcnt(12)
    v_mfma_f32_16x16x32_bf16 v[60:63], v[108:111], a[32:35], v[60:63]
    ds_read_b64_tr_b16 a[60:61], v23 offset:43136
    ds_read_b64_tr_b16 a[62:63], v23 offset:43648
    s_waitcnt lgkmcnt(12)
    v_mfma_f32_16x16x32_bf16 v[64:67], v[108:111], a[36:39], v[64:67]
    ds_read_b64_tr_b16 a[64:65], v20 offset:51328
    ds_read_b64_tr_b16 a[66:67], v20 offset:51840
    s_waitcnt lgkmcnt(12)
    v_mfma_f32_16x16x32_bf16 v[68:71], v[108:111], a[40:43], v[68:71]
    ds_read_b64_tr_b16 a[68:69], v21 offset:51328
    ds_read_b64_tr_b16 a[70:71], v21 offset:51840
    s_waitcnt lgkmcnt(12)
    v_mfma_f32_16x16x32_bf16 v[72:75], v[108:111], a[44:47], v[72:75]
    ds_read_b64_tr_b16 a[72:73], v22 offset:51328
    ds_read_b64_tr_b16 a[74:75], v22 offset:51840
    s_waitcnt lgkmcnt(12)
    v_mfma_f32_16x16x32_bf16 v[28:31], a[48:51], v[116:119], v[28:31]
    ds_read_b64_tr_b16 a[76:77], v23 offset:51328
    ds_read_b64_tr_b16 a[78:79], v23 offset:51840
    s_waitcnt lgkmcnt(12)
    v_mfma_f32_16x16x32_bf16 v[32:35], a[52:55], v[116:119], v[32:35]
    ds_read_b64_tr_b16 a[80:81], v20 offset:59520
    ds_read_b64_tr_b16 a[82:83], v20 offset:60032
    s_waitcnt lgkmcnt(12)
    v_mfma_f32_16x16x32_bf16 v[36:39], a[56:59], v[116:119], v[36:39]
    ds_read_b64_tr_b16 a[84:85], v21 offset:59520
    ds_read_b64_tr_b16 a[86:87], v21 offset:60032
    s_waitcnt lgkmcnt(12)
    v_mfma_f32_16x16x32_bf16 v[40:43], a[60:63], v[116:119], v[40:43]
    ds_read_b64_tr_b16 a[88:89], v22 offset:59520
    ds_read_b64_tr_b16 a[90:91], v22 offset:60032
    s_waitcnt lgkmcnt(12)
    v_mfma_f32_16x16x32_bf16 v[44:47], a[64:67], v[112:115], v[44:47]
    ds_read_b64_tr_b16 a[92:93], v23 offset:59520
    ds_read_b64_tr_b16 a[94:95], v23 offset:60032
    s_waitcnt lgkmcnt(12)
    v_mfma_f32_16x16x32_bf16 v[48:51], a[68:71], v[112:115], v[48:51]
    s_waitcnt lgkmcnt(10)
    v_mfma_f32_16x16x32_bf16 v[52:55], a[72:75], v[112:115], v[52:55]
    s_waitcnt lgkmcnt(8)
    v_mfma_f32_16x16x32_bf16 v[56:59], a[76:79], v[112:115], v[56:59]
    s_waitcnt lgkmcnt(6)
    v_mfma_f32_16x16x32_bf16 v[60:63], v[112:115], a[80:83], v[60:63]
    s_waitcnt lgkmcnt(4)
    v_mfma_f32_16x16x32_bf16 v[64:67], v[112:115], a[84:87], v[64:67]
    s_waitcnt lgkmcnt(2)
    v_mfma_f32_16x16x32_bf16 v[68:71], v[112:115], a[88:91], v[68:71]
    s_waitcnt lgkmcnt(0)
    v_mfma_f32_16x16x32_bf16 v[72:75], v[112:115], a[92:95], v[72:75]
    s_barrier
    ds_read_b128 a[96:99], v80 offset:0
    ds_read_b128 a[100:103], v81 offset:0
    ds_read_b64_tr_b16 a[0:1], v24 offset:0
    ds_read_b64_tr_b16 a[2:3], v24 offset:512
    ds_read_b64_tr_b16 a[4:5], v25 offset:0
    ds_read_b64_tr_b16 a[6:7], v25 offset:512
    ds_read_b64_tr_b16 a[8:9], v26 offset:0
    ds_read_b64_tr_b16 a[10:11], v26 offset:512
    ds_read_b64_tr_b16 a[12:13], v27 offset:0
    ds_read_b64_tr_b16 a[14:15], v27 offset:512
    ds_read_b64_tr_b16 a[16:17], v24 offset:8192
    ds_read_b64_tr_b16 a[18:19], v24 offset:8704
    ds_read_b64_tr_b16 a[20:21], v25 offset:8192
    ds_read_b64_tr_b16 a[22:23], v25 offset:8704
    ds_read_b64_tr_b16 a[24:25], v26 offset:8192
    ds_read_b64_tr_b16 a[26:27], v26 offset:8704
    s_waitcnt lgkmcnt(12)
    v_mfma_f32_16x16x32_bf16 v[28:31], a[0:3], v[116:119], v[28:31]
    ds_read_b64_tr_b16 a[28:29], v27 offset:8192
    ds_read_b64_tr_b16 a[30:31], v27 offset:8704
    s_waitcnt lgkmcnt(12)
    v_mfma_f32_16x16x32_bf16 v[32:35], a[4:7], v[116:119], v[32:35]
    ds_read_b64_tr_b16 a[48:49], v24 offset:4096
    ds_read_b64_tr_b16 a[50:51], v24 offset:4608
    s_waitcnt lgkmcnt(12)
    v_mfma_f32_16x16x32_bf16 v[36:39], a[8:11], v[116:119], v[36:39]
    ds_read_b64_tr_b16 a[52:53], v25 offset:4096
    ds_read_b64_tr_b16 a[54:55], v25 offset:4608
    s_waitcnt lgkmcnt(12)
    v_mfma_f32_16x16x32_bf16 v[40:43], a[12:15], v[116:119], v[40:43]
    ds_read_b64_tr_b16 a[56:57], v26 offset:4096
    ds_read_b64_tr_b16 a[58:59], v26 offset:4608
    s_waitcnt lgkmcnt(12)
    v_mfma_f32_16x16x32_bf16 v[44:47], a[16:19], a[96:99], v[44:47]
    ds_read_b64_tr_b16 a[60:61], v27 offset:4096
    ds_read_b64_tr_b16 a[62:63], v27 offset:4608
    s_waitcnt lgkmcnt(12)
    v_mfma_f32_16x16x32_bf16 v[48:51], a[20:23], a[96:99], v[48:51]
    ds_read_b64_tr_b16 a[64:65], v24 offset:12288
    ds_read_b64_tr_b16 a[66:67], v24 offset:12800
    s_waitcnt lgkmcnt(12)
    v_mfma_f32_16x16x32_bf16 v[52:55], a[24:27], a[96:99], v[52:55]
    ds_read_b64_tr_b16 a[68:69], v25 offset:12288
    ds_read_b64_tr_b16 a[70:71], v25 offset:12800
    s_waitcnt lgkmcnt(12)
    v_mfma_f32_16x16x32_bf16 v[56:59], a[28:31], a[96:99], v[56:59]
    ds_read_b64_tr_b16 a[72:73], v26 offset:12288
    ds_read_b64_tr_b16 a[74:75], v26 offset:12800
    s_waitcnt lgkmcnt(12)
    v_mfma_f32_16x16x32_bf16 v[28:31], a[48:51], v[116:119], v[28:31]
    ds_read_b64_tr_b16 a[76:77], v27 offset:12288
    ds_read_b64_tr_b16 a[78:79], v27 offset:12800
    s_waitcnt lgkmcnt(12)
    v_mfma_f32_16x16x32_bf16 v[32:35], a[52:55], v[116:119], v[32:35]
    s_waitcnt lgkmcnt(10)
    v_mfma_f32_16x16x32_bf16 v[36:39], a[56:59], v[116:119], v[36:39]
    s_waitcnt lgkmcnt(8)
    v_mfma_f32_16x16x32_bf16 v[40:43], a[60:63], v[116:119], v[40:43]
    s_waitcnt lgkmcnt(6)
    v_mfma_f32_16x16x32_bf16 v[44:47], a[64:67], a[100:103], v[44:47]
    s_waitcnt lgkmcnt(4)
    v_mfma_f32_16x16x32_bf16 v[48:51], a[68:71], a[100:103], v[48:51]
    s_waitcnt lgkmcnt(2)
    v_mfma_f32_16x16x32_bf16 v[52:55], a[72:75], a[100:103], v[52:55]
    s_waitcnt lgkmcnt(0)
    v_mfma_f32_16x16x32_bf16 v[56:59], a[76:79], a[100:103], v[56:59]
    s_barrier
    ds_read_b128 a[104:107], v80 offset:39040
    ds_read_b128 a[108:111], v81 offset:39040
    ds_read_b64_tr_b16 a[0:1], v24 offset:39040
    ds_read_b64_tr_b16 a[2:3], v24 offset:39552
    ds_read_b64_tr_b16 a[4:5], v25 offset:39040
    ds_read_b64_tr_b16 a[6:7], v25 offset:39552
    ds_read_b64_tr_b16 a[8:9], v26 offset:39040
    ds_read_b64_tr_b16 a[10:11], v26 offset:39552
    ds_read_b64_tr_b16 a[12:13], v27 offset:39040
    ds_read_b64_tr_b16 a[14:15], v27 offset:39552
    ds_read_b64_tr_b16 a[16:17], v24 offset:47232
    ds_read_b64_tr_b16 a[18:19], v24 offset:47744
    ds_read_b64_tr_b16 a[20:21], v25 offset:47232
    ds_read_b64_tr_b16 a[22:23], v25 offset:47744
    ds_read_b64_tr_b16 a[24:25], v26 offset:47232
    ds_read_b64_tr_b16 a[26:27], v26 offset:47744
    s_waitcnt lgkmcnt(12)
    v_mfma_f32_16x16x32_bf16 v[28:31], a[0:3], v[116:119], v[28:31]
    ds_read_b64_tr_b16 a[28:29], v27 offset:47232
    ds_read_b64_tr_b16 a[30:31], v27 offset:47744
    s_waitcnt lgkmcnt(12)
    v_mfma_f32_16x16x32_bf16 v[32:35], a[4:7], v[116:119], v[32:35]
    ds_read_b64_tr_b16 a[48:49], v24 offset:43136
    ds_read_b64_tr_b16 a[50:51], v24 offset:43648
    s_waitcnt lgkmcnt(12)
    v_mfma_f32_16x16x32_bf16 v[36:39], a[8:11], v[116:119], v[36:39]
    ds_read_b64_tr_b16 a[52:53], v25 offset:43136
    ds_read_b64_tr_b16 a[54:55], v25 offset:43648
    s_waitcnt lgkmcnt(12)
    v_mfma_f32_16x16x32_bf16 v[40:43], a[12:15], v[116:119], v[40:43]
    ds_read_b64_tr_b16 a[56:57], v26 offset:43136
    ds_read_b64_tr_b16 a[58:59], v26 offset:43648
    s_waitcnt lgkmcnt(12)
    v_mfma_f32_16x16x32_bf16 v[44:47], a[16:19], a[104:107], v[44:47]
    ds_read_b64_tr_b16 a[60:61], v27 offset:43136
    ds_read_b64_tr_b16 a[62:63], v27 offset:43648
    s_waitcnt lgkmcnt(12)
    v_mfma_f32_16x16x32_bf16 v[48:51], a[20:23], a[104:107], v[48:51]
    ds_read_b64_tr_b16 a[64:65], v24 offset:51328
    ds_read_b64_tr_b16 a[66:67], v24 offset:51840
    s_waitcnt lgkmcnt(12)
    v_mfma_f32_16x16x32_bf16 v[52:55], a[24:27], a[104:107], v[52:55]
    ds_read_b64_tr_b16 a[68:69], v25 offset:51328
    ds_read_b64_tr_b16 a[70:71], v25 offset:51840
    s_waitcnt lgkmcnt(12)
    v_mfma_f32_16x16x32_bf16 v[56:59], a[28:31], a[104:107], v[56:59]
    ds_read_b64_tr_b16 a[72:73], v26 offset:51328
    ds_read_b64_tr_b16 a[74:75], v26 offset:51840
    s_waitcnt lgkmcnt(12)
    v_mfma_f32_16x16x32_bf16 v[28:31], a[48:51], v[116:119], v[28:31]
    ds_read_b64_tr_b16 a[76:77], v27 offset:51328
    ds_read_b64_tr_b16 a[78:79], v27 offset:51840
    s_waitcnt lgkmcnt(12)
    v_mfma_f32_16x16x32_bf16 v[32:35], a[52:55], v[116:119], v[32:35]
    s_waitcnt lgkmcnt(10)
    v_mfma_f32_16x16x32_bf16 v[36:39], a[56:59], v[116:119], v[36:39]
    s_waitcnt lgkmcnt(8)
    v_mfma_f32_16x16x32_bf16 v[40:43], a[60:63], v[116:119], v[40:43]
    s_waitcnt lgkmcnt(6)
    v_mfma_f32_16x16x32_bf16 v[44:47], a[64:67], a[108:111], v[44:47]
    s_waitcnt lgkmcnt(4)
    v_mfma_f32_16x16x32_bf16 v[48:51], a[68:71], a[108:111], v[48:51]
    s_waitcnt lgkmcnt(2)
    v_mfma_f32_16x16x32_bf16 v[52:55], a[72:75], a[108:111], v[52:55]
    s_waitcnt lgkmcnt(0)
    v_mfma_f32_16x16x32_bf16 v[56:59], a[76:79], a[108:111], v[56:59]
    buffer_load_dwordx2 v[92:93], v96, s[28:31], s46 offen sc1
    buffer_load_dwordx2 v[94:95], v97, s[28:31], s46 offen sc1
    s_barrier
    ds_read_b128 a[112:115], v76 offset:0
    ds_read_b128 a[116:119], v77 offset:0
    ds_read_b64_tr_b16 a[0:1], v20 offset:0
    ds_read_b64_tr_b16 a[2:3], v20 offset:512
    ds_read_b64_tr_b16 a[4:5], v21 offset:0
    ds_read_b64_tr_b16 a[6:7], v21 offset:512
    ds_read_b64_tr_b16 a[8:9], v22 offset:0
    ds_read_b64_tr_b16 a[10:11], v22 offset:512
    ds_read_b64_tr_b16 a[12:13], v23 offset:0
    ds_read_b64_tr_b16 a[14:15], v23 offset:512
    ds_read_b64_tr_b16 a[16:17], v20 offset:8192
    ds_read_b64_tr_b16 a[18:19], v20 offset:8704
    ds_read_b64_tr_b16 a[20:21], v21 offset:8192
    ds_read_b64_tr_b16 a[22:23], v21 offset:8704
    ds_read_b64_tr_b16 a[24:25], v22 offset:8192
    ds_read_b64_tr_b16 a[26:27], v22 offset:8704
    s_waitcnt lgkmcnt(12)
    v_mfma_f32_16x16x32_bf16 v[28:31], a[0:3], v[116:119], v[28:31]
    ds_read_b64_tr_b16 a[28:29], v23 offset:8192
    ds_read_b64_tr_b16 a[30:31], v23 offset:8704
    s_waitcnt lgkmcnt(12)
    v_mfma_f32_16x16x32_bf16 v[32:35], a[4:7], v[116:119], v[32:35]
    ds_read_b64_tr_b16 a[48:49], v20 offset:4096
    ds_read_b64_tr_b16 a[50:51], v20 offset:4608
    s_waitcnt lgkmcnt(12)
    v_mfma_f32_16x16x32_bf16 v[36:39], a[8:11], v[116:119], v[36:39]
    ds_read_b64_tr_b16 a[52:53], v21 offset:4096
    ds_read_b64_tr_b16 a[54:55], v21 offset:4608
    s_waitcnt lgkmcnt(12)
    v_mfma_f32_16x16x32_bf16 v[40:43], a[12:15], v[116:119], v[40:43]
    ds_read_b64_tr_b16 a[56:57], v22 offset:4096
    ds_read_b64_tr_b16 a[58:59], v22 offset:4608
    s_waitcnt lgkmcnt(12)
    v_mfma_f32_16x16x32_bf16 v[44:47], a[16:19], a[112:115], v[44:47]
    ds_read_b64_tr_b16 a[60:61], v23 offset:4096
    ds_read_b64_tr_b16 a[62:63], v23 offset:4608
    s_waitcnt lgkmcnt(12)
    v_mfma_f32_16x16x32_bf16 v[48:51], a[20:23], a[112:115], v[48:51]
    ds_read_b64_tr_b16 a[64:65], v20 offset:12288
    ds_read_b64_tr_b16 a[66:67], v20 offset:12800
    s_waitcnt lgkmcnt(12)
    v_mfma_f32_16x16x32_bf16 v[52:55], a[24:27], a[112:115], v[52:55]
    ds_read_b64_tr_b16 a[68:69], v21 offset:12288
    ds_read_b64_tr_b16 a[70:71], v21 offset:12800
    s_waitcnt lgkmcnt(12)
    v_mfma_f32_16x16x32_bf16 v[56:59], a[28:31], a[112:115], v[56:59]
    ds_read_b64_tr_b16 a[72:73], v22 offset:12288
    ds_read_b64_tr_b16 a[74:75], v22 offset:12800
    s_waitcnt lgkmcnt(12)
    v_mfma_f32_16x16x32_bf16 v[28:31], a[48:51], v[116:119], v[28:31]
    ds_read_b64_tr_b16 a[76:77], v23 offset:12288
    ds_read_b64_tr_b16 a[78:79], v23 offset:12800
    s_waitcnt lgkmcnt(12)
    v_mfma_f32_16x16x32_bf16 v[32:35], a[52:55], v[116:119], v[32:35]
    s_waitcnt lgkmcnt(10)
    v_mfma_f32_16x16x32_bf16 v[36:39], a[56:59], v[116:119], v[36:39]
    s_waitcnt vmcnt(0)
Lst_chk:
    v_cmp_ne_u32 vcc, s34, v93
    v_cmp_ne_u32 s[36:37], s34, v95
    s_nop 0
    s_or_b64 s[36:37], s[36:37], vcc
    s_cbranch_scc1 Lst_re
    v_lshlrev_b32 v93, 16, v92
    s_waitcnt lgkmcnt(8)
    v_mfma_f32_16x16x32_bf16 v[40:43], a[60:63], v[116:119], v[40:43]
    v_and_b32 v92, 0xffff0000, v92
    v_rcp_f32 v93, v93
    s_waitcnt lgkmcnt(6)
    v_mfma_f32_16x16x32_bf16 v[44:47], a[64:67], a[116:119], v[44:47]
    v_lshlrev_b32 v95, 16, v94
    v_and_b32 v94, 0xffff0000, v94
    s_waitcnt lgkmcnt(4)
    v_mfma_f32_16x16x32_bf16 v[48:51], a[68:71], a[116:119], v[48:51]
    v_rcp_f32 v95, v95
    ds_write2st64_b32 v4, v92, v93 offset0:0 offset1:2
    s_waitcnt lgkmcnt(3)
    v_mfma_f32_16x16x32_bf16 v[52:55], a[72:75], a[116:119], v[52:55]
    ds_write2st64_b32 v5, v94, v95 offset0:0 offset1:2
    ds_read_b32 v120, v11
    s_waitcnt lgkmcnt(3)
    v_mfma_f32_16x16x32_bf16 v[56:59], a[76:79], a[116:119], v[56:59]
    s_waitcnt lgkmcnt(0)
    s_barrier
    ds_read_b128 a[120:123], v76 offset:39040
    ds_read_b128 a[124:127], v77 offset:39040
    ds_read_b64_tr_b16 a[0:1], v20 offset:39040
    ds_read_b64_tr_b16 a[2:3], v20 offset:39552
    ds_read_b64_tr_b16 a[4:5], v21 offset:39040
    ds_read_b64_tr_b16 a[6:7], v21 offset:39552
    ds_read_b64_tr_b16 a[8:9], v22 offset:39040
    ds_read_b64_tr_b16 a[10:11], v22 offset:39552
    ds_read_b64_tr_b16 a[12:13], v23 offset:39040
    ds_read_b64_tr_b16 a[14:15], v23 offset:39552
    ds_read_b64_tr_b16 a[16:17], v20 offset:47232
    ds_read_b64_tr_b16 a[18:19], v20 offset:47744
    ds_read_b64_tr_b16 a[20:21], v21 offset:47232
    ds_read_b64_tr_b16 a[22:23], v21 offset:47744
    ds_read_b64_tr_b16 a[24:25], v22 offset:47232
    ds_read_b64_tr_b16 a[26:27], v22 offset:47744
    s_waitcnt lgkmcnt(12)
    v_mfma_f32_16x16x32_bf16 v[28:31], a[0:3], v[116:119], v[28:31]
    ds_read_b64_tr_b16 a[28:29], v23 offset:47232
    ds_read_b64_tr_b16 a[30:31], v23 offset:47744
    s_waitcnt lgkmcnt(12)
    v_mfma_f32_16x16x32_bf16 v[32:35], a[4:7], v[116:119], v[32:35]
    ds_read_b64_tr_b16 a[48:49], v20 offset:43136
    ds_read_b64_tr_b16 a[50:51], v20 offset:43648
    s_waitcnt lgkmcnt(12)
    v_mfma_f32_16x16x32_bf16 v[36:39], a[8:11], v[116:119], v[36:39]
    ds_read_b64_tr_b16 a[52:53], v21 offset:43136
    ds_read_b64_tr_b16 a[54:55], v21 offset:43648
    s_waitcnt lgkmcnt(12)
    v_mfma_f32_16x16x32_bf16 v[40:43], a[12:15], v[116:119], v[40:43]
    ds_read_b64_tr_b16 a[56:57], v22 offset:43136
    ds_read_b64_tr_b16 a[58:59], v22 offset:43648
    s_waitcnt lgkmcnt(12)
    v_mfma_f32_16x16x32_bf16 v[44:47], a[16:19], a[120:123], v[44:47]
    ds_read_b64_tr_b16 a[60:61], v23 offset:43136
    ds_read_b64_tr_b16 a[62:63], v23 offset:43648
    s_waitcnt lgkmcnt(12)
    v_mfma_f32_16x16x32_bf16 v[48:51], a[20:23], a[120:123], v[48:51]
    ds_read_b64_tr_b16 a[64:65], v20 offset:51328
    ds_read_b64_tr_b16 a[66:67], v20 offset:51840
    s_waitcnt lgkmcnt(12)
    v_mfma_f32_16x16x32_bf16 v[52:55], a[24:27], a[120:123], v[52:55]
    ds_read_b64_tr_b16 a[68:69], v21 offset:51328
    ds_read_b64_tr_b16 a[70:71], v21 offset:51840
    s_waitcnt lgkmcnt(12)
    v_mfma_f32_16x16x32_bf16 v[56:59], a[28:31], a[120:123], v[56:59]
    ds_read_b64_tr_b16 a[72:73], v22 offset:51328
    ds_read_b64_tr_b16 a[74:75], v22 offset:51840
    s_waitcnt lgkmcnt(12)
    v_mfma_f32_16x16x32_bf16 v[28:31], a[48:51], v[116:119], v[28:31]
    ds_read_b64_tr_b16 a[76:77], v23 offset:51328
    ds_read_b64_tr_b16 a[78:79], v23 offset:51840
    s_waitcnt lgkmcnt(12)
    v_mfma_f32_16x16x32_bf16 v[32:35], a[52:55], v[116:119], v[32:35]
    s_waitcnt lgkmcnt(10)
    v_mfma_f32_16x16x32_bf16 v[36:39], a[56:59], v[116:119], v[36:39]
    s_waitcnt lgkmcnt(8)
    v_mfma_f32_16x16x32_bf16 v[40:43], a[60:63], v[116:119], v[40:43]
    s_waitcnt lgkmcnt(6)
    v_mfma_f32_16x16x32_bf16 v[44:47], a[64:67], a[124:127], v[44:47]
    s_waitcnt lgkmcnt(4)
    v_mfma_f32_16x16x32_bf16 v[48:51], a[68:71], a[124:127], v[48:51]
    s_waitcnt lgkmcnt(2)
    v_mfma_f32_16x16x32_bf16 v[52:55], a[72:75], a[124:127], v[52:55]
    s_waitcnt lgkmcnt(0)
    v_mfma_f32_16x16x32_bf16 v[56:59], a[76:79], a[124:127], v[56:59]
    s_mov_b32 exec_lo, 0x00010001
    s_mov_b32 exec_hi, 0x00010001
    ds_write_b128 v6, v[28:31] offset:0
    ds_write_b128 v6, v[32:35] offset:64
    ds_write_b128 v6, v[36:39] offset:128
    ds_write_b128 v6, v[40:43] offset:192
    ds_write_b128 v6, v[44:47] offset:256
    ds_write_b128 v6, v[48:51] offset:320
    ds_write_b128 v6, v[52:55] offset:384
    ds_write_b128 v6, v[56:59] offset:448
    ds_write_b32 v7, v7
    s_mov_b64 exec, -1
    ds_read_b128 v[76:79], v6 offset:256
    ds_read_b128 v[80:83], v6 offset:320
    ds_read_b128 v[84:87], v6 offset:384
    ds_read_b128 v[88:91], v6 offset:448
    s_waitcnt lgkmcnt(0)
    v_fmac_f32 v44, v76, v120
    v_fmac_f32 v45, v77, v120
    v_fmac_f32 v46, v78, v120
    v_fmac_f32 v47, v79, v120
    v_cvt_pk_bf16_f32 v44, v44, v45
    v_cvt_pk_bf16_f32 v45, v46, v47
    v_fmac_f32 v48, v80, v120
    v_fmac_f32 v49, v81, v120
    v_fmac_f32 v50, v82, v120
    v_fmac_f32 v51, v83, v120
    v_cvt_pk_bf16_f32 v46, v48, v49
    v_cvt_pk_bf16_f32 v47, v50, v51
    v_fmac_f32 v52, v84, v120
    v_fmac_f32 v53, v85, v120
    v_fmac_f32 v54, v86, v120
    v_fmac_f32 v55, v87, v120
    v_cvt_pk_bf16_f32 v48, v52, v53
    v_cvt_pk_bf16_f32 v49, v54, v55
    v_fmac_f32 v56, v88, v120
    v_fmac_f32 v57, v89, v120
    v_fmac_f32 v58, v90, v120
    v_fmac_f32 v59, v91, v120
    v_cvt_pk_bf16_f32 v50, v56, v57
    v_cvt_pk_bf16_f32 v51, v58, v59
    ds_write_b128 v125, v[44:47] offset:4096
    ds_write_b128 v125, v[48:51] offset:5120
    v_mov_b32 v5, 157972
    v_mov_b32 v6, 1
    s_mov_b64 exec, 1
    ds_add_u32 v5, v6
    s_mov_b64 exec, -1
    v_mov_b32 v5, 157980
Lcw_6:
    s_sub_u32 s35, s35, 1
    s_cbranch_scc1 Lend
    ds_read_b32 v6, v5
    s_waitcnt lgkmcnt(0)
    v_readfirstlane_b32 s38, v6
    s_nop 0
    s_cmp_lt_u32 s38, 1
    s_cbranch_scc1 Lcw_6
    ds_read_b64_tr_b16 a[0:1], v24 offset:16384
    ds_read_b64_tr_b16 a[2:3], v24 offset:16896
    ds_read_b64_tr_b16 a[4:5], v25 offset:16384
    ds_read_b64_tr_b16 a[6:7], v25 offset:16896
    ds_read_b64_tr_b16 a[8:9], v26 offset:16384
    ds_read_b64_tr_b16 a[10:11], v26 offset:16896
    ds_read_b64_tr_b16 a[12:13], v27 offset:16384
    ds_read_b64_tr_b16 a[14:15], v27 offset:16896
    ds_read_b64_tr_b16 a[16:17], v24 offset:20480
    ds_read_b64_tr_b16 a[18:19], v24 offset:20992
    ds_read_b64_tr_b16 a[20:21], v25 offset:20480
    ds_read_b64_tr_b16 a[22:23], v25 offset:20992
    ds_read_b64_tr_b16 a[24:25], v26 offset:20480
    ds_read_b64_tr_b16 a[26:27], v26 offset:20992
    ds_read_b64_tr_b16 a[28:29], v27 offset:20480
    ds_read_b64_tr_b16 a[30:31], v27 offset:20992
    ds_read_b64_tr_b16 a[32:33], v24 offset:55424
    ds_read_b64_tr_b16 a[34:35], v24 offset:55936
    ds_read_b64_tr_b16 a[36:37], v25 offset:55424
    ds_read_b64_tr_b16 a[38:39], v25 offset:55936
    ds_read_b64_tr_b16 a[40:41], v26 offset:55424
    ds_read_b64_tr_b16 a[42:43], v26 offset:55936
    ds_read_b64_tr_b16 a[44:45], v27 offset:55424
    ds_read_b64_tr_b16 a[46:47], v27 offset:55936
    ds_read_b64_tr_b16 a[48:49], v24 offset:59520
    ds_read_b64_tr_b16 a[50:51], v24 offset:60032
    ds_read_b64_tr_b16 a[52:53], v25 offset:59520
    ds_read_b64_tr_b16 a[54:55], v25 offset:60032
    ds_read_b64_tr_b16 a[56:57], v26 offset:59520
    ds_read_b64_tr_b16 a[58:59], v26 offset:60032
    ds_read_b64_tr_b16 a[60:61], v27 offset:59520
    ds_read_b64_tr_b16 a[62:63], v27 offset:60032
    ds_read_b64_tr_b16 a[64:65], v20 offset:16384
    ds_read_b64_tr_b16 a[66:67], v20 offset:16896
    ds_read_b64_tr_b16 a[68:69], v21 offset:16384
    ds_read_b64_tr_b16 a[70:71], v21 offset:16896
    ds_read_b64_tr_b16 a[72:73], v22 offset:16384
    ds_read_b64_tr_b16 a[74:75], v22 offset:16896
    ds_read_b64_tr_b16 a[76:77], v23 offset:16384
    ds_read_b64_tr_b16 a[78:79], v23 offset:16896
    ds_read_b64_tr_b16 a[80:81], v20 offset:20480
    ds_read_b64_tr_b16 a[82:83], v20 offset:20992
    ds_read_b64_tr_b16 a[84:85], v21 offset:20480
    ds_read_b64_tr_b16 a[86:87], v21 offset:20992
    ds_read_b64_tr_b16 a[88:89], v22 offset:20480
    ds_read_b64_tr_b16 a[90:91], v22 offset:20992
    ds_read_b64_tr_b16 a[92:93], v23 offset:20480
    ds_read_b64_tr_b16 a[94:95], v23 offset:20992
    s_waitcnt lgkmcnt(15)
    v_mfma_f32_16x16x32_bf16 v[60:63], a[96:99], a[0:3], v[60:63]
    v_mfma_f32_16x16x32_bf16 v[64:67], a[96:99], a[4:7], v[64:67]
    v_mfma_f32_16x16x32_bf16 v[68:71], a[96:99], a[8:11], v[68:71]
    v_mfma_f32_16x16x32_bf16 v[72:75], a[96:99], a[12:15], v[72:75]
    ds_read_b64_tr_b16 a[0:1], v20 offset:55424
    ds_read_b64_tr_b16 a[2:3], v20 offset:55936
    ds_read_b64_tr_b16 a[4:5], v21 offset:55424
    ds_read_b64_tr_b16 a[6:7], v21 offset:55936
    ds_read_b64_tr_b16 a[8:9], v22 offset:55424
    ds_read_b64_tr_b16 a[10:11], v22 offset:55936
    ds_read_b64_tr_b16 a[12:13], v23 offset:55424
    ds_read_b64_tr_b16 a[14:15], v23 offset:55936
    v_mfma_f32_16x16x32_bf16 v[60:63], a[100:103], a[16:19], v[60:63]
    v_mfma_f32_16x16x32_bf16 v[64:67], a[100:103], a[20:23], v[64:67]
    v_mfma_f32_16x16x32_bf16 v[68:71], a[100:103], a[24:27], v[68:71]
    v_mfma_f32_16x16x32_bf16 v[72:75], a[100:103], a[28:31], v[72:75]
    ds_read_b64_tr_b16 a[16:17], v20 offset:59520
    ds_read_b64_tr_b16 a[18:19], v20 offset:60032
    ds_read_b64_tr_b16 a[20:21], v21 offset:59520
    ds_read_b64_tr_b16 a[22:23], v21 offset:60032
    ds_read_b64_tr_b16 a[24:25], v22 offset:59520
    ds_read_b64_tr_b16 a[26:27], v22 offset:60032
    ds_read_b64_tr_b16 a[28:29], v23 offset:59520
    ds_read_b64_tr_b16 a[30:31], v23 offset:60032
    v_mfma_f32_16x16x32_bf16 v[60:63], a[104:107], a[32:35], v[60:63]
    v_mfma_f32_16x16x32_bf16 v[64:67], a[104:107], a[36:39], v[64:67]
    v_mfma_f32_16x16x32_bf16 v[68:71], a[104:107], a[40:43], v[68:71]
    v_mfma_f32_16x16x32_bf16 v[72:75], a[104:107], a[44:47], v[72:75]
    v_mfma_f32_16x16x32_bf16 v[60:63], a[108:111], a[48:51], v[60:63]
    v_mfma_f32_16x16x32_bf16 v[64:67], a[108:111], a[52:55], v[64:67]
    v_mfma_f32_16x16x32_bf16 v[68:71], a[108:111], a[56:59], v[68:71]
    v_mfma_f32_16x16x32_bf16 v[72:75], a[108:111], a[60:63], v[72:75]
    s_waitcnt lgkmcnt(15)
    v_mfma_f32_16x16x32_bf16 v[60:63], a[112:115], a[64:67], v[60:63]
    v_mfma_f32_16x16x32_bf16 v[64:67], a[112:115], a[68:71], v[64:67]
    v_mfma_f32_16x16x32_bf16 v[68:71], a[112:115], a[72:75], v[68:71]
    v_mfma_f32_16x16x32_bf16 v[72:75], a[112:115], a[76:79], v[72:75]
    v_mfma_f32_16x16x32_bf16 v[60:63], a[116:119], a[80:83], v[60:63]
    v_mfma_f32_16x16x32_bf16 v[64:67], a[116:119], a[84:87], v[64:67]
    v_mfma_f32_16x16x32_bf16 v[68:71], a[116:119], a[88:91], v[68:71]
    v_mfma_f32_16x16x32_bf16 v[72:75], a[116:119], a[92:95], v[72:75]
    s_waitcnt lgkmcnt(8)
    v_mfma_f32_16x16x32_bf16 v[60:63], a[120:123], a[0:3], v[60:63]
    v_mfma_f32_16x16x32_bf16 v[64:67], a[120:123], a[4:7], v[64:67]
    v_mfma_f32_16x16x32_bf16 v[68:71], a[120:123], a[8:11], v[68:71]
    v_mfma_f32_16x16x32_bf16 v[72:75], a[120:123], a[12:15], v[72:75]
    s_waitcnt lgkmcnt(0)
    v_mfma_f32_16x16x32_bf16 v[60:63], a[124:127], a[16:19], v[60:63]
    v_mfma_f32_16x16x32_bf16 v[64:67], a[124:127], a[20:23], v[64:67]
    v_mfma_f32_16x16x32_bf16 v[68:71], a[124:127], a[24:27], v[68:71]
    v_mfma_f32_16x16x32_bf16 v[72:75], a[124:127], a[28:31], v[72:75]
    v_lshlrev_b32 v5, 4, v3
    v_add_u32 v5, 157696, v5
    v_mov_b32 v6, 157952
    v_lshlrev_b32 v4, 4, v2
    v_add_u32 v4, 156224, v4
    v_lshl_add_u32 v125, v1, 3, s45
    s_mov_b64 exec, 0xffff
    ds_write_b32 v5, v60 offset:0
    ds_write_b32 v5, v64 offset:4
    ds_write_b32 v5, v68 offset:8
    ds_write_b32 v5, v72 offset:12
    ds_write_b32 v6, v6
    s_mov_b64 exec, -1
    ds_read_b128 v[36:39], v5
    ds_read_b128 v[28:31], v4
    ds_read_b128 v[32:35], v4 offset:512
    s_waitcnt lgkmcnt(0)
    v_fmac_f32 v60, v28, v36
    v_fmac_f32 v61, v29, v36
    v_fmac_f32 v62, v30, v36
    v_fmac_f32 v63, v31, v36
    v_mul_f32 v60, v60, v32
    v_mul_f32 v61, v61, v33
    v_mul_f32 v62, v62, v34
    v_mul_f32 v63, v63, v35
    v_cvt_pk_bf16_f32 v60, v60, v61
    v_cvt_pk_bf16_f32 v61, v62, v63
    ds_write_b64 v125, v[60:61] offset:0
    v_fmac_f32 v64, v28, v37
    v_fmac_f32 v65, v29, v37
    v_fmac_f32 v66, v30, v37
    v_fmac_f32 v67, v31, v37
    v_mul_f32 v64, v64, v32
    v_mul_f32 v65, v65, v33
    v_mul_f32 v66, v66, v34
    v_mul_f32 v67, v67, v35
    v_cvt_pk_bf16_f32 v64, v64, v65
    v_cvt_pk_bf16_f32 v65, v66, v67
    ds_write_b64 v125, v[64:65] offset:512
    v_fmac_f32 v68, v28, v38
    v_fmac_f32 v69, v29, v38
    v_fmac_f32 v70, v30, v38
    v_fmac_f32 v71, v31, v38
    v_mul_f32 v68, v68, v32
    v_mul_f32 v69, v69, v33
    v_mul_f32 v70, v70, v34
    v_mul_f32 v71, v71, v35
    v_cvt_pk_bf16_f32 v68, v68, v69
    v_cvt_pk_bf16_f32 v69, v70, v71
    ds_write_b64 v125, v[68:69] offset:1024
    v_fmac_f32 v72, v28, v39
    v_fmac_f32 v73, v29, v39
    v_fmac_f32 v74, v30, v39
    v_fmac_f32 v75, v31, v39
    v_mul_f32 v72, v72, v32
    v_mul_f32 v73, v73, v33
    v_mul_f32 v74, v74, v34
    v_mul_f32 v75, v75, v35
    v_cvt_pk_bf16_f32 v72, v72, v73
    v_cvt_pk_bf16_f32 v73, v74, v75
    ds_write_b64 v125, v[72:73] offset:1536
    v_mov_b32 v8, 157976
    v_mov_b32 v9, 1
    s_mov_b64 exec, 1
    ds_add_u32 v8, v9
    s_mov_b64 exec, -1
    s_endpgm
Lst_re:
    s_sub_u32 s35, s35, 1
    s_cbranch_scc1 Lend
    buffer_load_dwordx2 v[92:93], v96, s[28:31], s46 offen sc1
    buffer_load_dwordx2 v[94:95], v97, s[28:31], s46 offen sc1
    s_waitcnt vmcnt(0)
    s_branch Lst_chk
Laux:
    s_lshl_b32 s32, s37, 3
    s_lshl_b32 s39, s38, 2
    s_add_u32 s32, s32, s36
    s_cmp_lt_u32 s37, 4
    s_cselect_b32 s39, s39, 0
    s_add_u32 s32, s32, s39
    s_and_b32 s33, s2, 3
    s_lshl_b32 s33, s33, 3
    s_and_b32 s39, s2, 4
    s_add_u32 s33, s33, s39
    s_add_u32 s33, s33, s37
    s_cmp_ge_u32 s32, 32
    s_cbranch_scc1 Lmst
    v_lshrrev_b32 v5, 3, v1
    v_and_b32 v6, 7, v1
    s_lshl_b32 s40, s3, 14
    s_cmp_eq_u32 s27, 0
    s_cbranch_scc0 Laux_u
    s_lshl_b32 s36, s33, 6
    s_lshl_b32 s37, s26, 4
    s_add_u32 s36, s36, s37
    v_add_u32 v7, s36, v5
    v_mul_u32_u24 v7, 1280, v7
    v_xor_b32 v8, v6, v2
    v_lshl_add_u32 v92, v8, 4, v7
    v_add_u32 v92, 4096, v92
    v_xor_b32 v93, 64, v92
    v_add_u32 v93, 9216, v93
    v_subrev_u32 v94, 1920, v92
    v_subrev_u32 v95, 1920, v93
    s_waitcnt lgkmcnt(0)
    s_sub_u32 s52, s4, 4096
    s_subb_u32 s53, s5, 0
    s_mov_b32 s54, 2625536
    s_mov_b32 s55, 0x20000
    s_mov_b64 s[60:61], s[12:13]
    s_mov_b32 s62, 1280
    s_mov_b32 s63, 0x20000
    s_mov_b32 m0, 131072
    s_nop 0
    buffer_load_dwordx4 v13, s[60:63], 0 offen lds
    s_mov_b64 exec, 0xffff
    buffer_load_dwordx4 v13, s[60:63], 0 offen offset:1024 lds
    s_mov_b64 exec, -1
    s_add_u32 m0, s40, 0
    s_mov_b32 s41, 0
    buffer_load_dwordx4 v92, s[52:55], s41 offen lds
    buffer_load_dwordx4 v93, s[52:55], s41 offen offset:1024 lds
    buffer_load_dwordx4 v94, s[52:55], s41 offen offset:2048 lds
    buffer_load_dwordx4 v95, s[52:55], s41 offen offset:3072 lds
    s_add_u32 m0, s40, 4096
    s_mov_b32 s41, 256
    buffer_load_dwordx4 v92, s[52:55], s41 offen lds
    buffer_load_dwordx4 v93, s[52:55], s41 offen offset:1024 lds
    buffer_load_dwordx4 v94, s[52:55], s41 offen offset:2048 lds
    buffer_load_dwordx4 v95, s[52:55], s41 offen offset:3072 lds
    s_add_u32 m0, s40, 8192
    s_mov_b32 s41, 512
    buffer_load_dwordx4 v92, s[52:55], s41 offen lds
    buffer_load_dwordx4 v93, s[52:55], s41 offen offset:1024 lds
    buffer_load_dwordx4 v94, s[52:55], s41 offen offset:2048 lds
    buffer_load_dwordx4 v95, s[52:55], s41 offen offset:3072 lds
    s_add_u32 m0, s40, 12288
    s_mov_b32 s41, 768
    buffer_load_dwordx4 v92, s[52:55], s41 offen lds
    buffer_load_dwordx4 v93, s[52:55], s41 offen offset:1024 lds
    buffer_load_dwordx4 v94, s[52:55], s41 offen offset:2048 lds
    buffer_load_dwordx4 v95, s[52:55], s41 offen offset:3072 lds
    s_mov_b64 s[28:29], s[24:25]
    s_mov_b32 s30, 268435456
    s_mov_b32 s31, 0x20000
    s_load_dword s34, s[28:29], 0
    s_mov_b64 s[44:45], s[14:15]
    s_mov_b32 s46, 2211840
    s_mov_b32 s47, 0x20000
    s_mov_b64 s[48:49], s[18:19]
    s_mov_b32 s50, 2211840
    s_mov_b32 s51, 0x20000
    v_and_b32 v8, 1, v2
    v_lshlrev_b32 v8, 1, v8
    v_xor_b32 v8, v8, v6
    v_lshlrev_b32 v8, 4, v8
    v_mul_u32_u24 v9, 3456, v5
    s_lshl_b32 s38, s32, 7
    v_add3_u32 v18, v9, v8, s38
    v_xor_b32 v19, 64, v18
    v_add_u32 v19, 26624, v19
    v_add_u32 v20, 53248, v18
    v_add_u32 v21, 53248, v19
    s_mul_i32 s42, s26, 110592
    v_mul_u32_u24 v9, 1280, v5
    v_add_u32 v22, v9, v8
    v_xor_b32 v23, 64, v22
    v_add_u32 v23, 9216, v23
    v_add_u32 v24, 18432, v22
    v_add_u32 v25, 18432, v23
    s_mul_i32 s43, s32, 81920
    s_lshl_b32 s38, s3, 7
    s_add_u32 s43, s43, s38
    v_mov_b32 v96, 0x3f803f80
    v_mov_b32 v97, 0x3f803f80
    v_mov_b32 v98, 0x3f803f80
    v_mov_b32 v99, 0x3f803f80
    v_lshlrev_b32 v100, 4, v2
    v_add_u32 v100, 131072, v100
    v_lshrrev_b32 v10, 1, v3
    v_xor_b32 v10, v10, v2
    v_lshlrev_b32 v10, 4, v10
    v_lshl_add_u32 v10, v3, 7, v10
    v_add_u32 v102, s40, v10
    v_xor_b32 v103, 64, v102
    s_mov_b32 s58, 0xaaaaaaaa
    s_mov_b32 s59, 0xaaaaaaaa
    s_mov_b32 s64, 0xcccccccc
    s_mov_b32 s65, 0xcccccccc
    v_lshrrev_b32 v101, 2, v3
    v_lshl_add_u32 v101, v101, 4, v3
    v_lshlrev_b32 v101, 2, v101
    s_lshl_b32 s36, s26, 4
    v_add_u32 v10, s36, v3
    s_lshl_b32 s37, s33, 6
    s_sub_u32 s37, 2047, s37
    v_sub_u32 v106, s37, v10
    v_lshlrev_b32 v107, 2, v10
    v_add_u32 v107, 132608, v107
    s_lshl_b32 s36, s33, 9
    s_add_u32 s36, s36, 8192000
    v_lshl_add_u32 v108, v10, 3, s36
    v_bfe_u32 v10, v1, 2, 2
    v_and_b32 v8, 3, v1
    v_lshl_add_u32 v14, v2, 3, v10
    v_lshlrev_b32 v14, 7, v14
    v_lshlrev_b32 v9, 2, v1
    v_and_b32 v9, 0x60, v9
    v_add3_u32 v14, v14, v9, s40
    v_lshl_add_u32 v14, v8, 3, v14
    v_xor_b32 v15, 32, v14
    v_xor_b32 v16, 64, v14
    v_xor_b32 v17, 96, v14
    s_lshl_b32 s36, s26, 6
    s_add_u32 s36, s36, 141312
    v_lshl_add_u32 v26, v2, 4, s36
    v_min_u32 v8, 2, v3
    v_mul_u32_u24 v8, 1536, v8
    v_add_u32 v26, v26, v8
    v_add_u32 v4, 132864, v12
    v_mov_b32 v5, 0
    ds_write_b32 v4, v5
    s_waitcnt lgkmcnt(0)
    s_add_u32 s34, s34, 0x9e3779b8
    s_or_b32 s34, s34, 1
    s_waitcnt vmcnt(12)
    ds_read_b128 a[80:83], v102 offset:0
    ds_read_b128 a[84:87], v100 offset:0
    ds_read_b128 a[88:91], v103 offset:0
    ds_read_b128 a[92:95], v100 offset:64
    ds_read_b128 a[96:99], v102 offset:2048
    ds_read_b128 a[100:103], v100 offset:128
    ds_read_b128 a[104:107], v103 offset:2048
    ds_read_b128 a[108:111], v100 offset:192
    s_waitcnt lgkmcnt(0)
    s_add_u32 m0, s40, 0
    s_mov_b32 s41, 1024
    buffer_load_dwordx4 v92, s[52:55], s41 offen lds
    buffer_load_dwordx4 v93, s[52:55], s41 offen offset:1024 lds
    buffer_load_dwordx4 v94, s[52:55], s41 offen offset:2048 lds
    buffer_load_dwordx4 v95, s[52:55], s41 offen offset:3072 lds
    s_barrier
    v_mfma_f32_16x16x32_bf16 v[116:119], a[80:83], a[80:83], 0
    v_mfma_f32_16x16x32_bf16 v[112:115], v[96:99], a[80:83], 0
    v_mfma_f32_16x16x32_bf16 v[120:123], a[84:87], a[80:83], 0
    v_mfma_f32_16x16x32_bf16 v[124:127], a[84:87], v[96:99], 0
    v_mfma_f32_16x16x32_bf16 v[116:119], a[88:91], a[88:91], v[116:119]
    v_mfma_f32_16x16x32_bf16 v[112:115], v[96:99], a[88:91], v[112:115]
    v_mfma_f32_16x16x32_bf16 v[120:123], a[92:95], a[88:91], v[120:123]
    v_mfma_f32_16x16x32_bf16 v[124:127], a[92:95], v[96:99], v[124:127]
    v_mfma_f32_16x16x32_bf16 v[116:119], a[96:99], a[96:99], v[116:119]
    v_mfma_f32_16x16x32_bf16 v[112:115], v[96:99], a[96:99], v[112:115]
    v_mfma_f32_16x16x32_bf16 v[120:123], a[100:103], a[96:99], v[120:123]
    v_mfma_f32_16x16x32_bf16 v[124:127], a[100:103], v[96:99], v[124:127]
    v_mfma_f32_16x16x32_bf16 v[116:119], a[104:107], a[104:107], v[116:119]
    v_mfma_f32_16x16x32_bf16 v[112:115], v[96:99], a[104:107], v[112:115]
    v_mfma_f32_16x16x32_bf16 v[120:123], a[108:111], a[104:107], v[120:123]
    v_mfma_f32_16x16x32_bf16 v[124:127], a[108:111], v[96:99], v[124:127]
    s_waitcnt vmcnt(12)
    ds_read_b128 a[80:83], v102 offset:4096
    ds_read_b128 a[84:87], v100 offset:256
    ds_read_b128 a[88:91], v103 offset:4096
    ds_read_b128 a[92:95], v100 offset:320
    ds_read_b128 a[96:99], v102 offset:6144
    ds_read_b128 a[100:103], v100 offset:384
    ds_read_b128 a[104:107], v103 offset:6144
    ds_read_b128 a[108:111], v100 offset:448
    s_waitcnt lgkmcnt(0)
    v_mfma_f32_16x16x32_bf16 v[116:119], a[80:83], a[80:83], v[116:119]
    v_mfma_f32_16x16x32_bf16 v[112:115], v[96:99], a[80:83], v[112:115]
    v_mfma_f32_16x16x32_bf16 v[120:123], a[84:87], a[80:83], v[120:123]
    v_mfma_f32_16x16x32_bf16 v[124:127], a[84:87], v[96:99], v[124:127]
    v_mfma_f32_16x16x32_bf16 v[116:119], a[88:91], a[88:91], v[116:119]
    v_mfma_f32_16x16x32_bf16 v[112:115], v[96:99], a[88:91], v[112:115]
    v_mfma_f32_16x16x32_bf16 v[120:123], a[92:95], a[88:91], v[120:123]
    v_mfma_f32_16x16x32_bf16 v[124:127], a[92:95], v[96:99], v[124:127]
    v_mfma_f32_16x16x32_bf16 v[116:119], a[96:99], a[96:99], v[116:119]
    v_mfma_f32_16x16x32_bf16 v[112:115], v[96:99], a[96:99], v[112:115]
    v_mfma_f32_16x16x32_bf16 v[120:123], a[100:103], a[96:99], v[120:123]
    v_mfma_f32_16x16x32_bf16 v[124:127], a[100:103], v[96:99], v[124:127]
    v_mfma_f32_16x16x32_bf16 v[116:119], a[104:107], a[104:107], v[116:119]
    v_mfma_f32_16x16x32_bf16 v[112:115], v[96:99], a[104:107], v[112:115]
    v_mfma_f32_16x16x32_bf16 v[120:123], a[108:111], a[104:107], v[120:123]
    v_mfma_f32_16x16x32_bf16 v[124:127], a[108:111], v[96:99], v[124:127]
    s_waitcnt vmcnt(8)
    ds_read_b128 a[80:83], v102 offset:8192
    ds_read_b128 a[84:87], v100 offset:512
    ds_read_b128 a[88:91], v103 offset:8192
    ds_read_b128 a[92:95], v100 offset:576
    ds_read_b128 a[96:99], v102 offset:10240
    ds_read_b128 a[100:103], v100 offset:640
    ds_read_b128 a[104:107], v103 offset:10240
    ds_read_b128 a[108:111], v100 offset:704
    s_waitcnt lgkmcnt(0)
    v_mfma_f32_16x16x32_bf16 v[116:119], a[80:83], a[80:83], v[116:119]
    v_mfma_f32_16x16x32_bf16 v[112:115], v[96:99], a[80:83], v[112:115]
    v_mfma_f32_16x16x32_bf16 v[120:123], a[84:87], a[80:83], v[120:123]
    v_mfma_f32_16x16x32_bf16 v[124:127], a[84:87], v[96:99], v[124:127]
    v_mfma_f32_16x16x32_bf16 v[116:119], a[88:91], a[88:91], v[116:119]
    v_mfma_f32_16x16x32_bf16 v[112:115], v[96:99], a[88:91], v[112:115]
    v_mfma_f32_16x16x32_bf16 v[120:123], a[92:95], a[88:91], v[120:123]
    v_mfma_f32_16x16x32_bf16 v[124:127], a[92:95], v[96:99], v[124:127]
    v_mfma_f32_16x16x32_bf16 v[116:119], a[96:99], a[96:99], v[116:119]
    v_mfma_f32_16x16x32_bf16 v[112:115], v[96:99], a[96:99], v[112:115]
    v_mfma_f32_16x16x32_bf16 v[120:123], a[100:103], a[96:99], v[120:123]
    v_mfma_f32_16x16x32_bf16 v[124:127], a[100:103], v[96:99], v[124:127]
    v_mfma_f32_16x16x32_bf16 v[116:119], a[104:107], a[104:107], v[116:119]
    v_mfma_f32_16x16x32_bf16 v[112:115], v[96:99], a[104:107], v[112:115]
    v_mfma_f32_16x16x32_bf16 v[120:123], a[108:111], a[104:107], v[120:123]
    v_mfma_f32_16x16x32_bf16 v[124:127], a[108:111], v[96:99], v[124:127]
    s_waitcnt vmcnt(4)
    ds_read_b128 a[80:83], v102 offset:12288
    ds_read_b128 a[84:87], v100 offset:768
    ds_read_b128 a[88:91], v103 offset:12288
    ds_read_b128 a[92:95], v100 offset:832
    ds_read_b128 a[96:99], v102 offset:14336
    ds_read_b128 a[100:103], v100 offset:896
    ds_read_b128 a[104:107], v103 offset:14336
    ds_read_b128 a[108:111], v100 offset:960
    s_waitcnt lgkmcnt(0)
    v_mfma_f32_16x16x32_bf16 v[116:119], a[80:83], a[80:83], v[116:119]
    v_mfma_f32_16x16x32_bf16 v[112:115], v[96:99], a[80:83], v[112:115]
    v_mfma_f32_16x16x32_bf16 v[120:123], a[84:87], a[80:83], v[120:123]
    v_mfma_f32_16x16x32_bf16 v[124:127], a[84:87], v[96:99], v[124:127]
    v_mfma_f32_16x16x32_bf16 v[116:119], a[88:91], a[88:91], v[116:119]
    v_mfma_f32_16x16x32_bf16 v[112:115], v[96:99], a[88:91], v[112:115]
    v_mfma_f32_16x16x32_bf16 v[120:123], a[92:95], a[88:91], v[120:123]
    v_mfma_f32_16x16x32_bf16 v[124:127], a[92:95], v[96:99], v[124:127]
    v_mfma_f32_16x16x32_bf16 v[116:119], a[96:99], a[96:99], v[116:119]
    v_mfma_f32_16x16x32_bf16 v[112:115], v[96:99], a[96:99], v[112:115]
    v_mfma_f32_16x16x32_bf16 v[120:123], a[100:103], a[96:99], v[120:123]
    v_mfma_f32_16x16x32_bf16 v[124:127], a[100:103], v[96:99], v[124:127]
    v_mfma_f32_16x16x32_bf16 v[116:119], a[104:107], a[104:107], v[116:119]
    v_mfma_f32_16x16x32_bf16 v[112:115], v[96:99], a[104:107], v[112:115]
    v_mfma_f32_16x16x32_bf16 v[120:123], a[108:111], a[104:107], v[120:123]
    v_mfma_f32_16x16x32_bf16 v[124:127], a[108:111], v[96:99], v[124:127]
    s_waitcnt vmcnt(0)
    ds_read_b128 a[80:83], v102 offset:0
    ds_read_b128 a[84:87], v100 offset:1024
    ds_read_b128 a[88:91], v103 offset:0
    ds_read_b128 a[92:95], v100 offset:1088
    ds_read_b128 a[96:99], v102 offset:2048
    ds_read_b128 a[100:103], v100 offset:1152
    ds_read_b128 a[104:107], v103 offset:2048
    ds_read_b128 a[108:111], v100 offset:1216
    s_waitcnt lgkmcnt(0)
    v_mfma_f32_16x16x32_bf16 v[116:119], a[80:83], a[80:83], v[116:119]
    v_mfma_f32_16x16x32_bf16 v[112:115], v[96:99], a[80:83], v[112:115]
    v_mfma_f32_16x16x32_bf16 v[120:123], a[84:87], a[80:83], v[120:123]
    v_mfma_f32_16x16x32_bf16 v[124:127], a[84:87], v[96:99], v[124:127]
    v_mfma_f32_16x16x32_bf16 v[116:119], a[88:91], a[88:91], v[116:119]
    v_mfma_f32_16x16x32_bf16 v[112:115], v[96:99], a[88:91], v[112:115]
    v_mfma_f32_16x16x32_bf16 v[120:123], a[92:95], a[88:91], v[120:123]
    v_mfma_f32_16x16x32_bf16 v[124:127], a[92:95], v[96:99], v[124:127]
    v_mfma_f32_16x16x32_bf16 v[116:119], a[96:99], a[96:99], v[116:119]
    v_mfma_f32_16x16x32_bf16 v[112:115], v[96:99], a[96:99], v[112:115]
    v_mfma_f32_16x16x32_bf16 v[120:123], a[100:103], a[96:99], v[120:123]
    v_mfma_f32_16x16x32_bf16 v[124:127], a[100:103], v[96:99], v[124:127]
    v_mfma_f32_16x16x32_bf16 v[116:119], a[104:107], a[104:107], v[116:119]
    v_mfma_f32_16x16x32_bf16 v[112:115], v[96:99], a[104:107], v[112:115]
    v_mfma_f32_16x16x32_bf16 v[120:123], a[108:111], a[104:107], v[120:123]
    v_mfma_f32_16x16x32_bf16 v[124:127], a[108:111], v[96:99], v[124:127]
    s_nop 4
    v_cndmask_b32 v4, v116, v117, s[58:59]
    v_cndmask_b32 v5, v118, v119, s[58:59]
    v_cndmask_b32 v4, v4, v5, s[64:65]
    ds_bpermute_b32 v4, v101, v4
    v_mul_f32 v5, 0xbacccccd, v112
    v_cvt_pk_bf16_f32 v104, v5, v5
    v_lshlrev_b32 v104, 16, v104
    v_mul_f32 v5, v5, v5
    v_mov_b32 v6, 0x3acccccd
    s_waitcnt lgkmcnt(0)
    v_fma_f32 v4, v4, v6, -v5
    v_max_f32 v4, 0, v4
    v_cvt_pk_bf16_f32 v4, v4, v4
    v_lshlrev_b32 v4, 16, v4
    v_add_f32 v4, 0x3727c5ac, v4
    v_cvt_pk_bf16_f32 v4, v4, v4
    v_lshlrev_b32 v4, 16, v4
    v_sqrt_f32 v4, v4
    s_nop 0
    v_cvt_pk_bf16_f32 v4, v4, v4
    v_lshlrev_b32 v4, 16, v4
    v_rcp_f32 v105, v4
    v_lshrrev_b32 v8, 16, v4
    v_fma_f32 v4, v104, v124, v120
    v_mul_f32 v4, v4, v105
    v_cvt_pk_bf16_f32 v4, v4, v4
    v_ashrrev_i32 v5, 31, v4
    v_or_b32 v5, 0x80000000, v5
    v_xor_b32 v4, v4, v5
    v_and_b32 v4, 0xffff0000, v4
    v_or_b32 v4, v4, v106
    ds_write_b32 v107, v4
    v_mov_b32 v11, 132864
    v_mov_b32 v7, 1
    s_mov_b64 exec, 1
    ds_add_u32 v11, v7
    s_mov_b64 exec, -1
    v_or_b32 v8, v8, v104
    v_mov_b32 v9, s34
    s_mov_b64 exec, 0xffff
    buffer_store_dwordx2 v[8:9], v108, s[28:31], 0 offen sc1
    s_mov_b64 exec, -1
    s_cmp_lg_u32 s26, 0
    s_cbranch_scc1 Lpub_done
    s_setprio 3
Lcw_9:
    s_sub_u32 s35, s35, 1
    s_cbranch_scc1 Lend
    ds_read_b32 v7, v11
    s_waitcnt lgkmcnt(0)
    v_readfirstlane_b32 s38, v7
    s_nop 0
    s_cmp_lt_u32 s38, 4
    s_cbranch_scc1 Lcw_9
    v_add_u32 v5, 132608, v12
    ds_read_b32 v6, v5
    s_waitcnt lgkmcnt(0)
    v_mov_b32 v4, v6
    s_nop 1
    v_max_u32_dpp v4, v4, v4 row_ror:8 row_mask:0xf bank_mask:0xf
    s_nop 1
    v_max_u32_dpp v4, v4, v4 row_ror:4 row_mask:0xf bank_mask:0xf
    s_nop 1
    v_max_u32_dpp v4, v4, v4 row_ror:2 row_mask:0xf bank_mask:0xf
    s_nop 1
    v_max_u32_dpp v4, v4, v4 row_ror:1 row_mask:0xf bank_mask:0xf
    s_nop 0
    v_readlane_b32 s66, v4, 0
    v_readlane_b32 s36, v4, 16
    v_readlane_b32 s37, v4, 32
    v_readlane_b32 s38, v4, 48
    s_max_u32 s66, s66, s36
    s_max_u32 s37, s37, s38
    s_max_u32 s66, s66, s37
    v_cmp_eq_u32 vcc, s66, v6
    s_nop 1
    v_cndmask_b32 v4, v6, 0, vcc
    s_nop 1
    v_max_u32_dpp v4, v4, v4 row_ror:8 row_mask:0xf bank_mask:0xf
    s_nop 1
    v_max_u32_dpp v4, v4, v4 row_ror:4 row_mask:0xf bank_mask:0xf
    s_nop 1
    v_max_u32_dpp v4, v4, v4 row_ror:2 row_mask:0xf bank_mask:0xf
    s_nop 1
    v_max_u32_dpp v4, v4, v4 row_ror:1 row_mask:0xf bank_mask:0xf
    s_nop 0
    v_readlane_b32 s67, v4, 0
    v_readlane_b32 s36, v4, 16
    v_readlane_b32 s37, v4, 32
    v_readlane_b32 s38, v4, 48
    s_max_u32 s67, s67, s36
    s_max_u32 s37, s37, s38
    s_max_u32 s67, s67, s37
    v_mov_b32 v112, s66
    v_mov_b32 v113, s34
    v_mov_b32 v114, s67
    v_mov_b32 v115, s34
    s_lshl_b32 s36, s32, 7
    s_add_u32 s36, s36, 8126464
    s_mov_b64 exec, 0xff
    buffer_store_dwordx4 v[112:115], v13, s[28:31], s36 offen sc1
    s_mov_b64 exec, -1
    v_mov_b32 v11, 132864
    v_mov_b32 v7, 1
    s_mov_b64 exec, 1
    ds_add_u32 v11, v7
    s_mov_b64 exec, -1
    s_mov_b64 exec, 1
    s_lshl_b32 s36, s2, 2
    s_add_u32 s36, s36, 8323072
    v_mov_b32 v4, s34
    v_mov_b32 v5, s36
    buffer_store_dword v4, v5, s[28:31], 0 offen sc1
    s_mov_b64 exec, -1
    s_setprio 0
Lpub_done:
Lcw_10:
    s_sub_u32 s35, s35, 1
    s_cbranch_scc1 Lend
    ds_read_b32 v7, v11
    s_waitcnt lgkmcnt(0)
    v_readfirstlane_b32 s38, v7
    s_nop 0
    s_cmp_lt_u32 s38, 5
    s_cbranch_scc1 Lcw_10
    s_cmp_ge_u32 s32, 27
    s_cbranch_scc1 Lhelp_r
    s_add_u32 m0, s40, 0
    s_add_u32 s41, s42, 0
    buffer_load_dwordx4 v18, s[44:47], s41 offen nt lds
    buffer_load_dwordx4 v19, s[44:47], s41 offen offset:1024 nt lds
    buffer_load_dwordx4 v20, s[44:47], s41 offen offset:2048 nt lds
    buffer_load_dwordx4 v21, s[44:47], s41 offen offset:3072 nt lds
    s_add_u32 m0, s40, 4096
    s_add_u32 s41, s42, 442368
    buffer_load_dwordx4 v18, s[44:47], s41 offen nt lds
    buffer_load_dwordx4 v19, s[44:47], s41 offen offset:1024 nt lds
    buffer_load_dwordx4 v20, s[44:47], s41 offen offset:2048 nt lds
    buffer_load_dwordx4 v21, s[44:47], s41 offen offset:3072 nt lds
    s_add_u32 m0, s40, 8192
    s_add_u32 s41, s42, 884736
    buffer_load_dwordx4 v18, s[44:47], s41 offen nt lds
    buffer_load_dwordx4 v19, s[44:47], s41 offen offset:1024 nt lds
    buffer_load_dwordx4 v20, s[44:47], s41 offen offset:2048 nt lds
    buffer_load_dwordx4 v21, s[44:47], s41 offen offset:3072 nt lds
    s_add_u32 m0, s40, 12288
    s_add_u32 s41, s42, 1327104
    buffer_load_dwordx4 v18, s[44:47], s41 offen nt lds
    buffer_load_dwordx4 v19, s[44:47], s41 offen offset:1024 nt lds
    buffer_load_dwordx4 v20, s[44:47], s41 offen offset:2048 nt lds
    buffer_load_dwordx4 v21, s[44:47], s41 offen offset:3072 nt lds
    s_waitcnt vmcnt(12)
    ds_read_b64_tr_b16 a[0:1], v14 offset:0
    ds_read_b64_tr_b16 a[2:3], v14 offset:512
    ds_read_b64_tr_b16 a[4:5], v15 offset:0
    ds_read_b64_tr_b16 a[6:7], v15 offset:512
    ds_read_b64_tr_b16 a[8:9], v16 offset:0
    ds_read_b64_tr_b16 a[10:11], v16 offset:512
    ds_read_b64_tr_b16 a[12:13], v17 offset:0
    ds_read_b64_tr_b16 a[14:15], v17 offset:512
    s_waitcnt lgkmcnt(0)
    s_add_u32 m0, s40, 0
    s_add_u32 s41, s42, 1769472
    buffer_load_dwordx4 v18, s[44:47], s41 offen nt lds
    buffer_load_dwordx4 v19, s[44:47], s41 offen offset:1024 nt lds
    buffer_load_dwordx4 v20, s[44:47], s41 offen offset:2048 nt lds
    buffer_load_dwordx4 v21, s[44:47], s41 offen offset:3072 nt lds
    v_mov_b32 v11, 132864
    v_mov_b32 v7, 1
    s_mov_b64 exec, 1
    ds_add_u32 v11, v7
    s_mov_b64 exec, -1
    s_waitcnt vmcnt(12)
    ds_read_b64_tr_b16 a[16:17], v14 offset:4096
    ds_read_b64_tr_b16 a[18:19], v14 offset:4608
    ds_read_b64_tr_b16 a[20:21], v15 offset:4096
    ds_read_b64_tr_b16 a[22:23], v15 offset:4608
    ds_read_b64_tr_b16 a[24:25], v16 offset:4096
    ds_read_b64_tr_b16 a[26:27], v16 offset:4608
    ds_read_b64_tr_b16 a[28:29], v17 offset:4096
    ds_read_b64_tr_b16 a[30:31], v17 offset:4608
    s_waitcnt lgkmcnt(0)
    s_add_u32 m0, s40, 4096
    s_add_u32 s41, s43, 0
    buffer_load_dwordx4 v22, s[48:51], s41 offen nt lds
    buffer_load_dwordx4 v23, s[48:51], s41 offen offset:1024 nt lds
    buffer_load_dwordx4 v24, s[48:51], s41 offen offset:2048 nt lds
    buffer_load_dwordx4 v25, s[48:51], s41 offen offset:3072 nt lds
    s_waitcnt vmcnt(12)
    ds_read_b64_tr_b16 a[32:33], v14 offset:8192
    ds_read_b64_tr_b16 a[34:35], v14 offset:8704
    ds_read_b64_tr_b16 a[36:37], v15 offset:8192
    ds_read_b64_tr_b16 a[38:39], v15 offset:8704
    ds_read_b64_tr_b16 a[40:41], v16 offset:8192
    ds_read_b64_tr_b16 a[42:43], v16 offset:8704
    ds_read_b64_tr_b16 a[44:45], v17 offset:8192
    ds_read_b64_tr_b16 a[46:47], v17 offset:8704
    s_waitcnt lgkmcnt(0)
    s_add_u32 m0, s40, 8192
    s_add_u32 s41, s43, 40960
    buffer_load_dwordx4 v22, s[48:51], s41 offen nt lds
    buffer_load_dwordx4 v23, s[48:51], s41 offen offset:1024 nt lds
    buffer_load_dwordx4 v24, s[48:51], s41 offen offset:2048 nt lds
    buffer_load_dwordx4 v25, s[48:51], s41 offen offset:3072 nt lds
    s_waitcnt vmcnt(12)
    ds_read_b64_tr_b16 a[48:49], v14 offset:12288
    ds_read_b64_tr_b16 a[50:51], v14 offset:12800
    ds_read_b64_tr_b16 a[52:53], v15 offset:12288
    ds_read_b64_tr_b16 a[54:55], v15 offset:12800
    ds_read_b64_tr_b16 a[56:57], v16 offset:12288
    ds_read_b64_tr_b16 a[58:59], v16 offset:12800
    ds_read_b64_tr_b16 a[60:61], v17 offset:12288
    ds_read_b64_tr_b16 a[62:63], v17 offset:12800
    s_waitcnt vmcnt(8)
    ds_read_b64_tr_b16 a[64:65], v14 offset:0
    ds_read_b64_tr_b16 a[66:67], v14 offset:512
    ds_read_b64_tr_b16 a[68:69], v15 offset:0
    ds_read_b64_tr_b16 a[70:71], v15 offset:512
    ds_read_b64_tr_b16 a[72:73], v16 offset:0
    ds_read_b64_tr_b16 a[74:75], v16 offset:512
    ds_read_b64_tr_b16 a[76:77], v17 offset:0
    ds_read_b64_tr_b16 a[78:79], v17 offset:512
    s_branch Laux_mm
Laux_u:
    s_cmp_ge_u32 s32, 27
    s_cbranch_scc1 Lend
    v_and_b32 v8, 1, v2
    v_lshlrev_b32 v8, 1, v8
    v_xor_b32 v8, v8, v6
    v_lshlrev_b32 v8, 4, v8
    v_mul_u32_u24 v9, 3456, v5
    s_lshl_b32 s38, s32, 7
    v_add3_u32 v18, v9, v8, s38
    v_xor_b32 v19, 64, v18
    v_add_u32 v19, 26624, v19
    v_add_u32 v20, 53248, v18
    v_add_u32 v21, 53248, v19
    s_mul_i32 s42, s26, 110592
    v_mul_u32_u24 v9, 1280, v5
    v_add_u32 v22, v9, v8
    v_xor_b32 v23, 64, v22
    v_add_u32 v23, 9216, v23
    v_add_u32 v24, 18432, v22
    v_add_u32 v25, 18432, v23
    s_mul_i32 s43, s32, 81920
    s_lshl_b32 s38, s3, 7
    s_add_u32 s43, s43, s38
    s_waitcnt lgkmcnt(0)
    s_mov_b64 s[44:45], s[16:17]
    s_mov_b32 s46, 2211840
    s_mov_b32 s47, 0x20000
    s_mov_b64 s[28:29], s[24:25]
    s_mov_b32 s30, 268435456
    s_mov_b32 s31, 0x20000
    s_load_dword s34, s[28:29], 0
    s_mov_b64 s[52:53], s[4:5]
    s_mov_b32 s54, 2621440
    s_mov_b32 s55, 0x20000
    s_mov_b64 s[48:49], s[18:19]
    s_mov_b32 s50, 2211840
    s_mov_b32 s51, 0x20000
    s_mov_b64 s[68:69], s[18:19]
    s_mov_b32 s70, 2211840
    s_mov_b32 s71, 0x20000
    s_cmp_ge_u32 s26, 2
    s_cselect_b32 s70, 0, s70
    v_bfe_u32 v10, v1, 2, 2
    v_and_b32 v8, 3, v1
    v_lshl_add_u32 v14, v2, 3, v10
    v_lshlrev_b32 v14, 7, v14
    v_lshlrev_b32 v9, 2, v1
    v_and_b32 v9, 0x60, v9
    v_add3_u32 v14, v14, v9, s40
    v_lshl_add_u32 v14, v8, 3, v14
    v_xor_b32 v15, 32, v14
    v_xor_b32 v16, 64, v14
    v_xor_b32 v17, 96, v14
    s_lshl_b32 s36, s26, 6
    s_add_u32 s36, s36, 141312
    v_lshl_add_u32 v26, v2, 4, s36
    v_min_u32 v8, 2, v3
    v_mul_u32_u24 v8, 1536, v8
    v_add_u32 v26, v26, v8
    s_waitcnt lgkmcnt(0)
    s_add_u32 s34, s34, 0x9e3779b8
    s_or_b32 s34, s34, 1
    s_cmp_lg_u32 s3, 7
    s_cbranch_scc1 Lnop7
    s_setprio 3
Lnop7:
    s_barrier
    s_add_u32 m0, s40, 0
    s_add_u32 s41, s42, 0
    buffer_load_dwordx4 v18, s[44:47], s41 offen nt lds
    buffer_load_dwordx4 v19, s[44:47], s41 offen offset:1024 nt lds
    buffer_load_dwordx4 v20, s[44:47], s41 offen offset:2048 nt lds
    buffer_load_dwordx4 v21, s[44:47], s41 offen offset:3072 nt lds
    s_add_u32 m0, s40, 4096
    s_add_u32 s41, s42, 442368
    buffer_load_dwordx4 v18, s[44:47], s41 offen nt lds
    buffer_load_dwordx4 v19, s[44:47], s41 offen offset:1024 nt lds
    buffer_load_dwordx4 v20, s[44:47], s41 offen offset:2048 nt lds
    buffer_load_dwordx4 v21, s[44:47], s41 offen offset:3072 nt lds
    s_add_u32 m0, s40, 8192
    s_add_u32 s41, s42, 884736
    buffer_load_dwordx4 v18, s[44:47], s41 offen nt lds
    buffer_load_dwordx4 v19, s[44:47], s41 offen offset:1024 nt lds
    buffer_load_dwordx4 v20, s[44:47], s41 offen offset:2048 nt lds
    buffer_load_dwordx4 v21, s[44:47], s41 offen offset:3072 nt lds
    s_add_u32 m0, s40, 12288
    s_add_u32 s41, s42, 1327104
    buffer_load_dwordx4 v18, s[44:47], s41 offen nt lds
    buffer_load_dwordx4 v19, s[44:47], s41 offen offset:1024 nt lds
    buffer_load_dwordx4 v20, s[44:47], s41 offen offset:2048 nt lds
    buffer_load_dwordx4 v21, s[44:47], s41 offen offset:3072 nt lds
    v_mov_b32 v11, 132864
Lcw_11:
    s_sub_u32 s35, s35, 1
    s_cbranch_scc1 Lend
    s_sleep 4
    ds_read_b32 v7, v11
    s_waitcnt lgkmcnt(0)
    v_readfirstlane_b32 s38, v7
    s_nop 0
    s_cmp_lt_u32 s38, 5
    s_cbranch_scc1 Lcw_11
    s_waitcnt vmcnt(12)
    ds_read_b64_tr_b16 a[0:1], v14 offset:0
    ds_read_b64_tr_b16 a[2:3], v14 offset:512
    ds_read_b64_tr_b16 a[4:5], v15 offset:0
    ds_read_b64_tr_b16 a[6:7], v15 offset:512
    ds_read_b64_tr_b16 a[8:9], v16 offset:0
    ds_read_b64_tr_b16 a[10:11], v16 offset:512
    ds_read_b64_tr_b16 a[12:13], v17 offset:0
    ds_read_b64_tr_b16 a[14:15], v17 offset:512
    s_waitcnt lgkmcnt(0)
    s_add_u32 m0, s40, 0
    s_add_u32 s41, s42, 1769472
    buffer_load_dwordx4 v18, s[44:47], s41 offen nt lds
    buffer_load_dwordx4 v19, s[44:47], s41 offen offset:1024 nt lds
    buffer_load_dwordx4 v20, s[44:47], s41 offen offset:2048 nt lds
    buffer_load_dwordx4 v21, s[44:47], s41 offen offset:3072 nt lds
    s_waitcnt vmcnt(12)
    ds_read_b64_tr_b16 a[16:17], v14 offset:4096
    ds_read_b64_tr_b16 a[18:19], v14 offset:4608
    ds_read_b64_tr_b16 a[20:21], v15 offset:4096
    ds_read_b64_tr_b16 a[22:23], v15 offset:4608
    ds_read_b64_tr_b16 a[24:25], v16 offset:4096
    ds_read_b64_tr_b16 a[26:27], v16 offset:4608
    ds_read_b64_tr_b16 a[28:29], v17 offset:4096
    ds_read_b64_tr_b16 a[30:31], v17 offset:4608
    s_waitcnt vmcnt(8)
    ds_read_b64_tr_b16 a[32:33], v14 offset:8192
    ds_read_b64_tr_b16 a[34:35], v14 offset:8704
    ds_read_b64_tr_b16 a[36:37], v15 offset:8192
    ds_read_b64_tr_b16 a[38:39], v15 offset:8704
    ds_read_b64_tr_b16 a[40:41], v16 offset:8192
    ds_read_b64_tr_b16 a[42:43], v16 offset:8704
    ds_read_b64_tr_b16 a[44:45], v17 offset:8192
    ds_read_b64_tr_b16 a[46:47], v17 offset:8704
    s_waitcnt vmcnt(4)
    ds_read_b64_tr_b16 a[48:49], v14 offset:12288
    ds_read_b64_tr_b16 a[50:51], v14 offset:12800
    ds_read_b64_tr_b16 a[52:53], v15 offset:12288
    ds_read_b64_tr_b16 a[54:55], v15 offset:12800
    ds_read_b64_tr_b16 a[56:57], v16 offset:12288
    ds_read_b64_tr_b16 a[58:59], v16 offset:12800
    ds_read_b64_tr_b16 a[60:61], v17 offset:12288
    ds_read_b64_tr_b16 a[62:63], v17 offset:12800
    s_waitcnt vmcnt(0)
    ds_read_b64_tr_b16 a[64:65], v14 offset:0
    ds_read_b64_tr_b16 a[66:67], v14 offset:512
    ds_read_b64_tr_b16 a[68:69], v15 offset:0
    ds_read_b64_tr_b16 a[70:71], v15 offset:512
    ds_read_b64_tr_b16 a[72:73], v16 offset:0
    ds_read_b64_tr_b16 a[74:75], v16 offset:512
    ds_read_b64_tr_b16 a[76:77], v17 offset:0
    ds_read_b64_tr_b16 a[78:79], v17 offset:512
    s_cmp_lg_u32 s3, 7
    s_cbranch_scc1 Lnofx
    v_mov_b32 v92, 0x3f803f80
    v_mov_b32 v93, 0x3f803f80
    v_mov_b32 v94, 0x3f803f80
    v_mov_b32 v95, 0x3f803f80
    v_add_u32 v4, 144384, v13
    ds_write_b128 v4, v[92:95]
    ds_write_b128 v4, v[92:95] offset:1024
    v_and_b32 v120, 31, v1
    v_lshlrev_b32 v120, 7, v120
    v_add_u32 v120, 8126464, v120
Lpt_12:
    s_sub_u32 s35, s35, 1
    s_cbranch_scc1 Lend
    s_sleep 2
    buffer_load_dwordx4 v[124:127], v120, s[28:31], 0 offen sc1
    s_waitcnt vmcnt(0)
    v_cmp_ne_u32 vcc, s34, v125
    v_cmp_ne_u32 s[36:37], s34, v127
    s_nop 0
    s_or_b64 s[36:37], s[36:37], vcc
    s_cbranch_scc1 Lpt_12
    v_mov_b32 v120, v124
    s_nop 1
    v_max_u32_dpp v120, v120, v120 row_ror:8 row_mask:0xf bank_mask:0xf
    s_nop 1
    v_max_u32_dpp v120, v120, v120 row_ror:4 row_mask:0xf bank_mask:0xf
    s_nop 1
    v_max_u32_dpp v120, v120, v120 row_ror:2 row_mask:0xf bank_mask:0xf
    s_nop 1
    v_max_u32_dpp v120, v120, v120 row_ror:1 row_mask:0xf bank_mask:0xf
    s_nop 0
    v_readlane_b32 s56, v120, 0
    v_readlane_b32 s36, v120, 16
    v_readlane_b32 s37, v120, 32
    v_readlane_b32 s38, v120, 48
    s_max_u32 s56, s56, s36
    s_max_u32 s37, s37, s38
    s_max_u32 s56, s56, s37
    v_cmp_eq_u32 vcc, s56, v124
    s_nop 1
    v_cndmask_b32 v120, v124, v126, vcc
    s_nop 1
    v_max_u32_dpp v120, v120, v120 row_ror:8 row_mask:0xf bank_mask:0xf
    s_nop 1
    v_max_u32_dpp v120, v120, v120 row_ror:4 row_mask:0xf bank_mask:0xf
    s_nop 1
    v_max_u32_dpp v120, v120, v120 row_ror:2 row_mask:0xf bank_mask:0xf
    s_nop 1
    v_max_u32_dpp v120, v120, v120 row_ror:1 row_mask:0xf bank_mask:0xf
    s_nop 0
    v_readlane_b32 s57, v120, 0
    v_readlane_b32 s36, v120, 16
    v_readlane_b32 s37, v120, 32
    v_readlane_b32 s38, v120, 48
    s_max_u32 s57, s57, s36
    s_max_u32 s37, s37, s38
    s_max_u32 s57, s57, s37
    s_and_b32 s36, s56, 0x7ff
    s_sub_u32 s36, 2047, s36
    s_and_b32 s37, s57, 0x7ff
    s_sub_u32 s37, 2047, s37
    s_mul_i32 s38, s36, 1280
    s_mul_i32 s39, s37, 1280
    s_mov_b32 m0, 141312
    v_mov_b32 v4, s36
    buffer_load_dwordx4 v13, s[52:55], s38 offen lds
    s_mov_b32 m0, 142848
    v_mov_b32 v5, s37
    buffer_load_dwordx4 v13, s[52:55], s39 offen lds
    s_mov_b64 exec, 0xffff
    buffer_load_dwordx4 v13, s[52:55], s39 offen offset:1024 lds
    s_mov_b32 m0, 141312
    s_mov_b32 vcc_lo, 0xaaaaaaaa
    buffer_load_dwordx4 v13, s[52:55], s38 offen offset:1024 lds
    s_mov_b64 exec, 3
    v_cndmask_b32 v4, v4, v5, vcc
    v_lshlrev_b32 v118, 3, v4
    v_add_u32 v118, 8192000, v118
    v_add_u32 v9, 132872, v12
Lxs_chk:
    s_sub_u32 s35, s35, 1
    s_cbranch_scc1 Lend
    buffer_load_dwordx2 v[116:117], v118, s[28:31], 0 offen sc1
    s_waitcnt vmcnt(0)
    v_cmp_ne_u32 vcc, s34, v117
    s_nop 0
    s_cbranch_vccnz Lxs_chk
    ds_write_b32 v9, v116
    s_mov_b64 exec, -1
    v_mov_b32 v10, 132868
    v_mov_b32 v7, 1
    s_mov_b64 exec, 1
    ds_add_u32 v10, v7
    s_mov_b64 exec, -1
Lnofx:
Lcw_13:
    s_sub_u32 s35, s35, 1
    s_cbranch_scc1 Lend
    s_sleep 2
    ds_read_b32 v7, v11
    s_waitcnt lgkmcnt(0)
    v_readfirstlane_b32 s38, v7
    s_nop 0
    s_cmp_lt_u32 s38, 9
    s_cbranch_scc1 Lcw_13
    s_add_u32 m0, s40, 4096
    s_add_u32 s41, s43, 0
    buffer_load_dwordx4 v22, s[48:51], s41 offen nt lds
    buffer_load_dwordx4 v23, s[48:51], s41 offen offset:1024 nt lds
    buffer_load_dwordx4 v24, s[48:51], s41 offen offset:2048 nt lds
    buffer_load_dwordx4 v25, s[48:51], s41 offen offset:3072 nt lds
    s_add_u32 m0, s40, 8192
    s_add_u32 s41, s43, 40960
    buffer_load_dwordx4 v22, s[48:51], s41 offen nt lds
    buffer_load_dwordx4 v23, s[48:51], s41 offen offset:1024 nt lds
    buffer_load_dwordx4 v24, s[48:51], s41 offen offset:2048 nt lds
    buffer_load_dwordx4 v25, s[48:51], s41 offen offset:3072 nt lds
    s_add_u32 m0, s40, 12288
    s_add_u32 s41, s43, 512
    buffer_load_dwordx4 v22, s[68:71], s41 offen nt lds
    buffer_load_dwordx4 v23, s[68:71], s41 offen offset:1024 nt lds
    buffer_load_dwordx4 v24, s[68:71], s41 offen offset:2048 nt lds
    buffer_load_dwordx4 v25, s[68:71], s41 offen offset:3072 nt lds
    s_add_u32 m0, s40, 0
    s_add_u32 s41, s43, 41472
    buffer_load_dwordx4 v22, s[68:71], s41 offen nt lds
    buffer_load_dwordx4 v23, s[68:71], s41 offen offset:1024 nt lds
    buffer_load_dwordx4 v24, s[68:71], s41 offen offset:2048 nt lds
    buffer_load_dwordx4 v25, s[68:71], s41 offen offset:3072 nt lds
Laux_mm:
    v_mov_b32 v10, 132868
Lcw_14:
    s_sub_u32 s35, s35, 1
    s_cbranch_scc1 Lend
    s_sleep 1
    ds_read_b32 v7, v10
    s_waitcnt lgkmcnt(0)
    v_readfirstlane_b32 s38, v7
    s_nop 0
    s_cmp_lt_u32 s38, 1
    s_cbranch_scc1 Lcw_14
    ds_read_b128 v[92:95], v26 offset:0
    ds_read_b128 v[96:99], v26 offset:256
    ds_read_b128 v[100:103], v26 offset:512
    ds_read_b128 v[104:107], v26 offset:768
    ds_read_b128 v[108:111], v26 offset:1024
    ds_read_b64 v[116:117], v10 offset:4
    s_waitcnt lgkmcnt(0)
    v_readfirstlane_b32 s56, v116
    v_readfirstlane_b32 s57, v117
    v_mfma_f32_16x16x32_bf16 v[112:115], a[0:3], v[92:95], 0
    v_mfma_f32_16x16x32_bf16 v[116:119], a[4:7], v[92:95], 0
    v_mfma_f32_16x16x32_bf16 v[120:123], a[8:11], v[92:95], 0
    v_mfma_f32_16x16x32_bf16 v[124:127], a[12:15], v[92:95], 0
    v_mfma_f32_16x16x32_bf16 v[112:115], a[16:19], v[96:99], v[112:115]
    v_mfma_f32_16x16x32_bf16 v[116:119], a[20:23], v[96:99], v[116:119]
    v_mfma_f32_16x16x32_bf16 v[120:123], a[24:27], v[96:99], v[120:123]
    v_mfma_f32_16x16x32_bf16 v[124:127], a[28:31], v[96:99], v[124:127]
    v_mfma_f32_16x16x32_bf16 v[112:115], a[32:35], v[100:103], v[112:115]
    v_mfma_f32_16x16x32_bf16 v[116:119], a[36:39], v[100:103], v[116:119]
    v_mfma_f32_16x16x32_bf16 v[120:123], a[40:43], v[100:103], v[120:123]
    v_mfma_f32_16x16x32_bf16 v[124:127], a[44:47], v[100:103], v[124:127]
    v_mfma_f32_16x16x32_bf16 v[112:115], a[48:51], v[104:107], v[112:115]
    v_mfma_f32_16x16x32_bf16 v[116:119], a[52:55], v[104:107], v[116:119]
    v_mfma_f32_16x16x32_bf16 v[120:123], a[56:59], v[104:107], v[120:123]
    v_mfma_f32_16x16x32_bf16 v[124:127], a[60:63], v[104:107], v[124:127]
    v_mfma_f32_16x16x32_bf16 v[112:115], a[64:67], v[108:111], v[112:115]
    v_mfma_f32_16x16x32_bf16 v[116:119], a[68:71], v[108:111], v[116:119]
    v_mfma_f32_16x16x32_bf16 v[120:123], a[72:75], v[108:111], v[120:123]
    v_mfma_f32_16x16x32_bf16 v[124:127], a[76:79], v[108:111], v[124:127]
    s_mul_i32 s36, s3, 768
    s_add_u32 s36, s36, 133120
    v_lshlrev_b32 v4, 8, v3
    v_lshl_add_u32 v4, v2, 4, v4
    v_add_u32 v4, s36, v4
    v_add_u32 v5, 133120, v12
    s_lshl_b32 s37, s3, 8
    s_add_u32 s37, s37, 139264
    v_lshl_add_u32 v6, v1, 1, s37
    v_and_b32 v7, 1, v1
    v_lshlrev_b32 v7, 7, v7
    v_lshl_add_u32 v7, v2, 4, v7
    v_add_u32 v7, s37, v7
    s_lshl_b32 s38, s56, 16
    s_lshl_b32 s39, s57, 16
    v_rcp_f32 v8, s38
    v_rcp_f32 v9, s39
    s_and_b32 s56, s56, 0xffff0000
    s_and_b32 s57, s57, 0xffff0000
    s_mov_b32 exec_lo, 0x00070007
    s_mov_b32 exec_hi, 0x00070007
    ds_write_b128 v4, v[112:115] offset:0
    ds_write_b128 v4, v[116:119] offset:64
    ds_write_b128 v4, v[120:123] offset:128
    ds_write_b128 v4, v[124:127] offset:192
    s_mov_b64 exec, -1
    s_waitcnt lgkmcnt(0)
    s_barrier
    ds_read2st64_b32 v[92:93], v5 offset0:0 offset1:1
    ds_read2st64_b32 v[94:95], v5 offset0:2 offset1:3
    ds_read2st64_b32 v[96:97], v5 offset0:4 offset1:5
    ds_read2st64_b32 v[98:99], v5 offset0:6 offset1:7
    ds_read2st64_b32 v[100:101], v5 offset0:8 offset1:9
    ds_read2st64_b32 v[102:103], v5 offset0:10 offset1:11
    ds_read2st64_b32 v[116:117], v5 offset0:12 offset1:13
    ds_read2st64_b32 v[118:119], v5 offset0:14 offset1:15
    ds_read2st64_b32 v[120:121], v5 offset0:16 offset1:17
    ds_read2st64_b32 v[122:123], v5 offset0:18 offset1:19
    ds_read2st64_b32 v[124:125], v5 offset0:20 offset1:21
    ds_read2st64_b32 v[126:127], v5 offset0:22 offset1:23
    v_cmp_eq_u32 s[72:73], 1, v2
    v_cmp_eq_u32 s[74:75], 2, v2
    v_cmp_eq_u32 s[76:77], 3, v2
    s_mul_i32 s37, s32, 10
    s_add_u32 s37, s37, s3
    s_lshl_b32 s37, s37, 10
    s_add_u32 s37, s37, 7405568
    s_waitcnt lgkmcnt(0)
    v_add_f32 v92, v92, v95
    v_add_f32 v98, v98, v101
    v_add_f32 v92, v92, v98
    v_add_f32 v93, v93, v96
    v_add_f32 v99, v99, v102
    v_add_f32 v93, v93, v99
    v_add_f32 v94, v94, v97
    v_add_f32 v100, v100, v103
    v_add_f32 v94, v94, v100
    v_add_f32 v116, v116, v119
    v_add_f32 v122, v122, v125
    v_add_f32 v116, v116, v122
    v_add_f32 v117, v117, v120
    v_add_f32 v123, v123, v126
    v_add_f32 v117, v117, v123
    v_add_f32 v118, v118, v121
    v_add_f32 v124, v124, v127
    v_add_f32 v118, v118, v124
    v_fmac_f32 v92, s56, v94
    v_mul_f32 v112, v92, v8
    v_fmac_f32 v93, s57, v94
    v_mul_f32 v113, v93, v9
    v_fmac_f32 v116, s56, v118
    v_mul_f32 v120, v116, v8
    v_fmac_f32 v117, s57, v118
    v_mul_f32 v121, v117, v9
    v_cvt_pk_bf16_f32 v113, v112, v113
    v_lshlrev_b32 v112, 16, v113
    v_and_b32 v113, 0xffff0000, v113
    v_cvt_pk_bf16_f32 v121, v120, v121
    v_lshlrev_b32 v120, 16, v121
    v_and_b32 v121, 0xffff0000, v121
    v_mul_f32 v114, 0xbfb8aa3b, v112
    v_mul_f32 v115, 0xbfb8aa3b, v113
    v_exp_f32 v114, v114
    v_exp_f32 v115, v115
    v_add_f32 v114, 1.0, v114
    v_add_f32 v115, 1.0, v115
    v_rcp_f32 v114, v114
    v_rcp_f32 v115, v115
    v_mul_f32 v114, v114, v112
    v_mul_f32 v115, v115, v113
    v_cvt_pk_bf16_f32 v115, v114, v115
    v_lshlrev_b32 v114, 16, v115
    v_and_b32 v115, 0xffff0000, v115
    v_mul_f32 v114, v114, v120
    v_mul_f32 v115, v115, v121
    v_cvt_pk_bf16_f32 v114, v114, v115
    ds_write_b16 v6, v114
    ds_write_b16_d16_hi v6, v114 offset:128
    ds_read_b128 v[92:95], v7 offset:0
    ds_read_b128 v[96:99], v7 offset:64
    v_mov_b32 v101, s34
    v_mov_b32 v103, s34
    s_waitcnt vmcnt(0)
    ds_read_b64_tr_b16 v[28:29], v14 offset:4096
    ds_read_b64_tr_b16 v[30:31], v14 offset:4608
    ds_read_b64_tr_b16 v[32:33], v15 offset:4096
    ds_read_b64_tr_b16 v[34:35], v15 offset:4608
    ds_read_b64_tr_b16 v[36:37], v16 offset:4096
    ds_read_b64_tr_b16 v[38:39], v16 offset:4608
    ds_read_b64_tr_b16 v[40:41], v17 offset:4096
    ds_read_b64_tr_b16 v[42:43], v17 offset:4608
    ds_read_b64_tr_b16 v[44:45], v14 offset:8192
    ds_read_b64_tr_b16 v[46:47], v14 offset:8704
    ds_read_b64_tr_b16 v[48:49], v15 offset:8192
    ds_read_b64_tr_b16 v[50:51], v15 offset:8704
    ds_read_b64_tr_b16 v[52:53], v16 offset:8192
    ds_read_b64_tr_b16 v[54:55], v16 offset:8704
    ds_read_b64_tr_b16 v[56:57], v17 offset:8192
    ds_read_b64_tr_b16 v[58:59], v17 offset:8704
    s_waitcnt lgkmcnt(0)
    v_mfma_f32_16x16x32_bf16 v[112:115], v[92:95], v[28:31], 0
    v_mfma_f32_16x16x32_bf16 v[116:119], v[92:95], v[32:35], 0
    v_mfma_f32_16x16x32_bf16 v[120:123], v[92:95], v[36:39], 0
    v_mfma_f32_16x16x32_bf16 v[124:127], v[92:95], v[40:43], 0
    v_mfma_f32_16x16x32_bf16 v[112:115], v[96:99], v[44:47], v[112:115]
    v_mfma_f32_16x16x32_bf16 v[116:119], v[96:99], v[48:51], v[116:119]
    v_mfma_f32_16x16x32_bf16 v[120:123], v[96:99], v[52:55], v[120:123]
    v_mfma_f32_16x16x32_bf16 v[124:127], v[96:99], v[56:59], v[124:127]
    s_nop 5
    v_cndmask_b32 v100, v112, v116, s[72:73]
    v_cndmask_b32 v100, v100, v120, s[74:75]
    v_cndmask_b32 v100, v100, v124, s[76:77]
    v_cndmask_b32 v102, v113, v117, s[72:73]
    v_cndmask_b32 v102, v102, v121, s[74:75]
    v_cndmask_b32 v102, v102, v125, s[76:77]
    buffer_store_dwordx4 v[100:103], v13, s[28:31], s37 offen sc1
    s_sub_u32 s36, s3, 4
    s_cmp_ge_u32 s36, 2
    s_cbranch_scc1 Laux_end
    s_add_u32 s37, s37, 4096
    ds_read_b64_tr_b16 v[60:61], v14 offset:12288
    ds_read_b64_tr_b16 v[62:63], v14 offset:12800
    ds_read_b64_tr_b16 v[64:65], v15 offset:12288
    ds_read_b64_tr_b16 v[66:67], v15 offset:12800
    ds_read_b64_tr_b16 v[68:69], v16 offset:12288
    ds_read_b64_tr_b16 v[70:71], v16 offset:12800
    ds_read_b64_tr_b16 v[72:73], v17 offset:12288
    ds_read_b64_tr_b16 v[74:75], v17 offset:12800
    ds_read_b64_tr_b16 v[76:77], v14 offset:0
    ds_read_b64_tr_b16 v[78:79], v14 offset:512
    ds_read_b64_tr_b16 v[80:81], v15 offset:0
    ds_read_b64_tr_b16 v[82:83], v15 offset:512
    ds_read_b64_tr_b16 v[84:85], v16 offset:0
    ds_read_b64_tr_b16 v[86:87], v16 offset:512
    ds_read_b64_tr_b16 v[88:89], v17 offset:0
    ds_read_b64_tr_b16 v[90:91], v17 offset:512
    s_waitcnt lgkmcnt(0)
    v_mfma_f32_16x16x32_bf16 v[112:115], v[92:95], v[60:63], 0
    v_mfma_f32_16x16x32_bf16 v[116:119], v[92:95], v[64:67], 0
    v_mfma_f32_16x16x32_bf16 v[120:123], v[92:95], v[68:71], 0
    v_mfma_f32_16x16x32_bf16 v[124:127], v[92:95], v[72:75], 0
    v_mfma_f32_16x16x32_bf16 v[112:115], v[96:99], v[76:79], v[112:115]
    v_mfma_f32_16x16x32_bf16 v[116:119], v[96:99], v[80:83], v[116:119]
    v_mfma_f32_16x16x32_bf16 v[120:123], v[96:99], v[84:87], v[120:123]
    v_mfma_f32_16x16x32_bf16 v[124:127], v[96:99], v[88:91], v[124:127]
    s_nop 5
    v_cndmask_b32 v100, v112, v116, s[72:73]
    v_cndmask_b32 v100, v100, v120, s[74:75]
    v_cndmask_b32 v100, v100, v124, s[76:77]
    v_cndmask_b32 v102, v113, v117, s[72:73]
    v_cndmask_b32 v102, v102, v121, s[74:75]
    v_cndmask_b32 v102, v102, v125, s[76:77]
    buffer_store_dwordx4 v[100:103], v13, s[28:31], s37 offen sc1
Laux_end:
    s_endpgm
Lmst:
    s_cmp_lg_u32 s3, 0
    s_cbranch_scc1 Lhelp_i
    s_waitcnt lgkmcnt(0)
    s_mov_b64 s[28:29], s[24:25]
    s_mov_b32 s30, 268435456
    s_mov_b32 s31, 0x20000
    s_load_dword s34, s[28:29], 0
    s_waitcnt lgkmcnt(0)
    s_add_u32 s34, s34, 0x9e3779b8
    s_or_b32 s34, s34, 1
    s_mov_b64 exec, 1
    s_lshl_b32 s36, s2, 2
    s_add_u32 s36, s36, 8323072
    v_mov_b32 v4, s34
    v_mov_b32 v5, s36
    buffer_store_dword v4, v5, s[28:31], 0 offen sc1
    s_mov_b64 exec, -1
    s_cmp_lg_u32 s32, 32
    s_cbranch_scc1 Lend
Lmst_bc:
    v_and_b32 v4, 31, v1
    v_lshlrev_b32 v4, 7, v4
    v_add_u32 v4, 8126464, v4
Lpt_15:
    s_sub_u32 s35, s35, 1
    s_cbranch_scc1 Lend
    s_sleep 8
    buffer_load_dwordx4 v[8:11], v4, s[28:31], 0 offen sc1
    s_waitcnt vmcnt(0)
    v_cmp_ne_u32 vcc, s34, v9
    v_cmp_ne_u32 s[36:37], s34, v11
    s_nop 0
    s_or_b64 s[36:37], s[36:37], vcc
    s_cbranch_scc1 Lpt_15
    v_mov_b32 v4, v8
    s_nop 1
    v_max_u32_dpp v4, v4, v4 row_ror:8 row_mask:0xf bank_mask:0xf
    s_nop 1
    v_max_u32_dpp v4, v4, v4 row_ror:4 row_mask:0xf bank_mask:0xf
    s_nop 1
    v_max_u32_dpp v4, v4, v4 row_ror:2 row_mask:0xf bank_mask:0xf
    s_nop 1
    v_max_u32_dpp v4, v4, v4 row_ror:1 row_mask:0xf bank_mask:0xf
    s_nop 0
    v_readlane_b32 s40, v4, 0
    v_readlane_b32 s36, v4, 16
    v_readlane_b32 s37, v4, 32
    v_readlane_b32 s38, v4, 48
    s_max_u32 s40, s40, s36
    s_max_u32 s37, s37, s38
    s_max_u32 s40, s40, s37
    v_cmp_eq_u32 vcc, s40, v8
    s_nop 1
    v_cndmask_b32 v4, v8, v10, vcc
    s_nop 1
    v_max_u32_dpp v4, v4, v4 row_ror:8 row_mask:0xf bank_mask:0xf
    s_nop 1
    v_max_u32_dpp v4, v4, v4 row_ror:4 row_mask:0xf bank_mask:0xf
    s_nop 1
    v_max_u32_dpp v4, v4, v4 row_ror:2 row_mask:0xf bank_mask:0xf
    s_nop 1
    v_max_u32_dpp v4, v4, v4 row_ror:1 row_mask:0xf bank_mask:0xf
    s_nop 0
    v_readlane_b32 s41, v4, 0
    v_readlane_b32 s36, v4, 16
    v_readlane_b32 s37, v4, 32
    v_readlane_b32 s38, v4, 48
    s_max_u32 s41, s41, s36
    s_max_u32 s37, s37, s38
    s_max_u32 s41, s41, s37
    v_mov_b32 v8, s40
    v_mov_b32 v9, s34
    v_mov_b32 v10, s41
    v_mov_b32 v11, s34
    s_mov_b32 s36, 8257536
    buffer_store_dwordx4 v[8:11], v13, s[28:31], s36 offen offset:0 sc1
    buffer_store_dwordx4 v[8:11], v13, s[28:31], s36 offen offset:1024 sc1
    buffer_store_dwordx4 v[8:11], v13, s[28:31], s36 offen offset:2048 sc1
    s_mov_b32 s36, 8323072
Lmaster:
    s_sub_u32 s35, s35, 1
    s_cbranch_scc1 Lend
    s_sleep 16
    buffer_load_dwordx4 v[4:7], v13, s[28:31], s36 offen sc1
    s_waitcnt vmcnt(0)
    v_xor_b32 v4, s34, v4
    v_xor_b32 v5, s34, v5
    v_xor_b32 v6, s34, v6
    v_xor_b32 v7, s34, v7
    v_or3_b32 v4, v4, v5, v6
    v_or_b32 v4, v4, v7
    v_cmp_ne_u32 vcc, 0, v4
    s_nop 0
    s_cbranch_vccnz Lmaster
    s_mov_b64 exec, 1
    buffer_store_dword v9, v4, s[28:31], 0 offen sc1
    s_endpgm
Lhelp_r:
    s_add_u32 s72, s32, 0
    s_mov_b32 s73, 5
    s_mov_b32 s37, 4
    s_branch Lhelp
Lhelp_i:
    s_cmp_eq_u32 s32, 32
    s_cbranch_scc1 Lend
    s_cmp_eq_u32 s27, 0
    s_cbranch_scc1 Lend
    s_sub_u32 s72, s32, 33
    s_mov_b32 s73, 3
    s_mov_b32 s37, 9
Lhelp:
    s_lshl_b32 s38, s26, 6
    v_add_u32 v4, s38, v1
    v_mul_u32_u24 v4, 1280, v4
    s_waitcnt lgkmcnt(0)
    s_mov_b64 s[68:69], s[18:19]
    s_mov_b32 s70, 2211840
    s_mov_b32 s71, 0x20000
Lhelp2:
    s_mul_i32 s38, s72, 9363
    s_lshr_b32 s38, s38, 16
    s_mul_i32 s39, s38, 7
    s_sub_u32 s39, s72, s39
    s_mul_i32 s39, s39, 327680
    s_lshl_b32 s38, s38, 7
    s_sub_u32 s39, s39, s38
    s_add_u32 s39, s39, 1152
    v_add_u32 v6, s39, v4
    buffer_load_dword v5, v6, s[68:71], 0 offen
    s_add_u32 s72, s72, s73
    s_sub_u32 s37, s37, 1
    s_cmp_lg_u32 s37, 0
    s_cbranch_scc1 Lhelp2
Lend:
    s_endpgm
.section .rodata,"a"
.p2align 6
.amdhsa_kernel recurrent_scan__sliding_local_dilated__moe_arch_mod__prompt_kernel
  .amdhsa_next_free_vgpr 256
  .amdhsa_next_free_sgpr 102
  .amdhsa_accum_offset 128
  .amdhsa_group_segment_fixed_size 0
  .amdhsa_kernarg_size 88
  .amdhsa_user_sgpr_count 2
  .amdhsa_user_sgpr_kernarg_segment_ptr 1
  .amdhsa_system_sgpr_workgroup_id_x 1
  .amdhsa_float_denorm_mode_32 3
.end_amdhsa_kernel
```

```asm
; @launch grid=(256,1,1) block=(512,1,1) lds=163840
.amdgcn_target "amdgcn-amd-amdhsa--gfx950"
.text
.globl recurrent_scan__sliding_local_dilated__moe_arch_mod__prompt_kernel
.p2align 8
.type recurrent_scan__sliding_local_dilated__moe_arch_mod__prompt_kernel,@function
recurrent_scan__sliding_local_dilated__moe_arch_mod__prompt_kernel:
    s_load_dwordx16 s[4:19], s[0:1], 0
    s_load_dwordx4 s[20:23], s[0:1], 64
    s_load_dwordx2 s[24:25], s[0:1], 80
    v_lshrrev_b32 v4, 6, v0
    v_and_b32 v1, 63, v0
    s_cmp_ge_u32 s2, 256
    s_cbranch_scc1 Lend
    v_readfirstlane_b32 s3, v4
    s_getpc_b64 s[36:37]
Lpc:
    s_and_b32 s38, s2, 0xf8
    v_add_u32 v5, s38, v4
    v_and_b32 v6, 1, v0
    v_lshl_add_u32 v5, v5, 1, v6
    v_lshlrev_b32 v5, 7, v5
    v_min_u32 v5, Lend-Lpc, v5
    v_mov_b32 v7, s37
    v_add_co_u32 v6, vcc, s36, v5
    s_nop 1
    v_addc_co_u32 v7, vcc, 0, v7, vcc
    global_load_dword v0, v[6:7], off
    v_lshrrev_b32 v2, 4, v1
    v_and_b32 v3, 15, v1
    v_lshlrev_b32 v12, 2, v1
    v_lshlrev_b32 v13, 4, v1
    s_mov_b32 s35, 2000000
    s_and_b32 s36, s2, 7
    s_lshr_b32 s37, s2, 3
    s_and_b32 s38, s36, 1
    s_lshr_b32 s36, s36, 1
    s_add_u32 s39, s38, 4
    s_and_b32 s26, s3, 3
    s_lshr_b32 s27, s3, 2
    s_cmp_lt_u32 s37, s39
    s_cbranch_scc1 Laux
    s_lshr_b32 s33, s36, 1
    s_and_b32 s36, s36, 1
    s_mul_i32 s36, s36, 55
    s_mul_i32 s38, s38, 28
    s_add_u32 s36, s36, s38
    s_add_u32 s36, s36, s37
    s_sub_u32 s36, s36, s39
    s_mul_i32 s32, s36, 13108
    s_lshr_b32 s32, s32, 16
    s_mul_i32 s37, s32, 5
    s_sub_u32 s36, s36, s37
    s_mul_i32 s33, s33, 5
    s_add_u32 s33, s33, s36
    s_add_u32 s42, s33, s32
    s_mul_i32 s36, s42, 13108
    s_lshr_b32 s36, s36, 16
    s_mul_i32 s36, s36, 5
    s_sub_u32 s42, s42, s36
    s_and_b32 s43, s2, 7
    s_lshl_b32 s43, s43, 2
    s_lshr_b32 s43, 0x30858530, s43
    s_and_b32 s43, s43, 15
    s_cmp_lg_u32 s3, 0
    s_cbranch_scc1 Lcomp
Lloader:
    s_setprio 3
    v_lshrrev_b32 v5, 3, v1
    v_and_b32 v6, 7, v1
    v_and_b32 v8, 1, v2
    v_lshlrev_b32 v8, 1, v8
    v_xor_b32 v8, v8, v6
    s_lshl_b32 s39, s33, 7
    v_lshl_add_u32 v50, v8, 4, s39
    v_mov_b32 v7, 3840
    v_mad_u32_u24 v28, v5, v7, v50
    v_xor_b32 v29, 64, v28
    v_add_u32 v29, 29696, v29
    v_add_u32 v30, 59392, v28
    v_add_u32 v31, 59392, v29
    v_add_u32 v32, 122880, v28
    v_add_u32 v33, 122880, v29
    v_add_u32 v34, 182272, v28
    v_add_u32 v35, 182272, v29
    s_lshl_b32 s79, s42, 2
    s_lshr_b32 s79, 0x21100, s79
    s_and_b32 s79, s79, 15
    s_add_u32 s79, s79, s43
    s_sub_u32 s38, s79, 10
    s_cmp_ge_u32 s79, 10
    s_cselect_b32 s79, s38, s79
    s_mul_i32 s68, s79, 245760
    s_lshl_b32 s78, s79, 7
    s_waitcnt lgkmcnt(0)
    s_mov_b64 s[48:49], s[6:7]
    s_mov_b32 s50, 2457600
    s_mov_b32 s51, 0x20000
    s_add_u32 s52, s6, 1280
    s_addc_u32 s53, s7, 0
    s_mov_b32 s54, 2456320
    s_mov_b32 s55, 0x20000
    s_add_u32 s56, s6, 2560
    s_addc_u32 s57, s7, 0
    s_mov_b32 s58, 2455040
    s_mov_b32 s59, 0x20000
    s_mov_b32 m0, 0
    s_mul_i32 s38, s32, 96
    s_sub_u32 s38, s38, 16
    v_add_u32 v7, s38, v5
    buffer_load_dwordx4 v28, s[48:51], s68 offen lds
    v_xor_b32 v9, v6, v2
    v_lshlrev_b32 v9, 4, v9
    buffer_load_dwordx4 v29, s[48:51], s68 offen offset:1024 lds
    v_xor_b32 v10, 64, v9
    v_mov_b32 v11, 2052
    buffer_load_dwordx4 v30, s[48:51], s68 offen offset:2048 lds
    v_mov_b32 v8, 1280
    v_add_u32 v36, 0, v7
    buffer_load_dwordx4 v31, s[48:51], s68 offen offset:3072 lds
    v_med3_i32 v36, v36, 0, v11
    v_mad_u32_u24 v36, v36, v8, v9
    s_mov_b32 m0, 8192
    v_add_u32 v36, 4096, v36
    v_add_u32 v37, 8, v7
    buffer_load_dwordx4 v28, s[52:55], s68 offen lds
    v_med3_i32 v37, v37, 0, v11
    v_mad_u32_u24 v37, v37, v8, v10
    v_add_u32 v37, 3072, v37
    buffer_load_dwordx4 v29, s[52:55], s68 offen offset:1024 lds
    v_add_u32 v38, 16, v7
    v_med3_i32 v38, v38, 0, v11
    buffer_load_dwordx4 v30, s[52:55], s68 offen offset:2048 lds
    v_mad_u32_u24 v38, v38, v8, v9
    v_add_u32 v38, 2048, v38
    buffer_load_dwordx4 v31, s[52:55], s68 offen offset:3072 lds
    v_add_u32 v39, 24, v7
    v_med3_i32 v39, v39, 0, v11
    s_mov_b32 m0, 16384
    v_mad_u32_u24 v39, v39, v8, v10
    v_add_u32 v39, 1024, v39
    buffer_load_dwordx4 v28, s[56:59], s68 offen lds
    v_add_u32 v40, 32, v7
    v_med3_i32 v40, v40, 0, v11
    buffer_load_dwordx4 v29, s[56:59], s68 offen offset:1024 lds
    v_mad_u32_u24 v40, v40, v8, v9
    v_add_u32 v40, 4096, v40
    v_add_u32 v41, 40, v7
    buffer_load_dwordx4 v30, s[56:59], s68 offen offset:2048 lds
    v_med3_i32 v41, v41, 0, v11
    v_mad_u32_u24 v41, v41, v8, v10
    buffer_load_dwordx4 v31, s[56:59], s68 offen offset:3072 lds
    v_add_u32 v41, 3072, v41
    v_add_u32 v42, 48, v7
    s_mov_b32 m0, 4096
    v_med3_i32 v42, v42, 0, v11
    v_mad_u32_u24 v42, v42, v8, v9
    buffer_load_dwordx4 v32, s[48:51], s68 offen lds
    v_add_u32 v42, 2048, v42
    v_add_u32 v43, 56, v7
    buffer_load_dwordx4 v33, s[48:51], s68 offen offset:1024 lds
    v_med3_i32 v43, v43, 0, v11
    v_mad_u32_u24 v43, v43, v8, v10
    buffer_load_dwordx4 v34, s[48:51], s68 offen offset:2048 lds
    v_add_u32 v43, 1024, v43
    v_add_u32 v44, 64, v7
    v_med3_i32 v44, v44, 0, v11
    buffer_load_dwordx4 v35, s[48:51], s68 offen offset:3072 lds
    v_mad_u32_u24 v44, v44, v8, v9
    v_add_u32 v44, 4096, v44
    s_mov_b32 m0, 12288
    v_add_u32 v45, 72, v7
    v_med3_i32 v45, v45, 0, v11
    buffer_load_dwordx4 v32, s[52:55], s68 offen lds
    v_mad_u32_u24 v45, v45, v8, v10
    v_add_u32 v45, 3072, v45
    buffer_load_dwordx4 v33, s[52:55], s68 offen offset:1024 lds
    v_add_u32 v46, 80, v7
    v_med3_i32 v46, v46, 0, v11
    buffer_load_dwordx4 v34, s[52:55], s68 offen offset:2048 lds
    v_mad_u32_u24 v46, v46, v8, v9
    v_add_u32 v46, 2048, v46
    buffer_load_dwordx4 v35, s[52:55], s68 offen offset:3072 lds
    v_add_u32 v47, 88, v7
    v_med3_i32 v47, v47, 0, v11
    v_mad_u32_u24 v47, v47, v8, v10
    s_mov_b32 m0, 20480
    v_add_u32 v47, 1024, v47
    v_add_u32 v48, 96, v7
    buffer_load_dwordx4 v32, s[56:59], s68 offen lds
    v_med3_i32 v48, v48, 0, v11
    v_mad_u32_u24 v48, v48, v8, v9
    buffer_load_dwordx4 v33, s[56:59], s68 offen offset:1024 lds
    v_add_u32 v48, 4096, v48
    v_add_u32 v49, 104, v7
    buffer_load_dwordx4 v34, s[56:59], s68 offen offset:2048 lds
    v_med3_i32 v49, v49, 0, v11
    v_mad_u32_u24 v49, v49, v8, v10
    buffer_load_dwordx4 v35, s[56:59], s68 offen offset:3072 lds
    v_add_u32 v49, 3072, v49
    s_sub_u32 s44, s4, 4096
    s_subb_u32 s45, s5, 0
    s_mov_b32 s46, 2625536
    s_mov_b32 s47, 0x20000
    s_mov_b32 m0, 24576
    s_nop 0
    buffer_load_dwordx4 v36, s[44:47], s78 offen lds
    buffer_load_dwordx4 v37, s[44:47], s78 offen offset:1024 lds
    buffer_load_dwordx4 v38, s[44:47], s78 offen offset:2048 lds
    buffer_load_dwordx4 v39, s[44:47], s78 offen offset:3072 lds
    s_mov_b32 m0, 28672
    s_nop 0
    buffer_load_dwordx4 v40, s[44:47], s78 offen lds
    buffer_load_dwordx4 v41, s[44:47], s78 offen offset:1024 lds
    buffer_load_dwordx4 v42, s[44:47], s78 offen offset:2048 lds
    buffer_load_dwordx4 v43, s[44:47], s78 offen offset:3072 lds
    s_mov_b32 m0, 32768
    s_nop 0
    buffer_load_dwordx4 v44, s[44:47], s78 offen lds
    buffer_load_dwordx4 v45, s[44:47], s78 offen offset:1024 lds
    buffer_load_dwordx4 v46, s[44:47], s78 offen offset:2048 lds
    buffer_load_dwordx4 v47, s[44:47], s78 offen offset:3072 lds
    s_mov_b32 m0, 36864
    s_nop 0
    buffer_load_dwordx4 v48, s[44:47], s78 offen lds
    buffer_load_dwordx4 v49, s[44:47], s78 offen offset:1024 lds
    s_mov_b32 s80, 0x65482310
    s_mov_b32 s81, 0x97
    s_cmp_eq_u32 s42, 1
    s_cselect_b32 s80, 0x65392410, s80
    s_cselect_b32 s81, 0x87, s81
    s_cmp_eq_u32 s42, 2
    s_cselect_b32 s80, 0x75436021, s80
    s_cselect_b32 s81, 0x98, s81
    s_cmp_eq_u32 s42, 3
    s_cselect_b32 s80, 0x76432501, s80
    s_cselect_b32 s81, 0x98, s81
    s_cmp_eq_u32 s42, 4
    s_cselect_b32 s80, 0x63547102, s80
    s_cselect_b32 s81, 0x98, s81
    s_lshr_b64 s[80:81], s[80:81], 4
    s_and_b32 s79, s80, 15
    s_add_u32 s79, s79, s43
    s_sub_u32 s38, s79, 10
    s_cmp_ge_u32 s79, 10
    s_cselect_b32 s79, s38, s79
    s_mov_b64 s[28:29], s[24:25]
    s_mov_b32 s30, 268435456
    s_mov_b32 s31, 0x20000
    s_load_dword s34, s[28:29], 0
    s_mov_b64 s[60:61], s[8:9]
    s_mov_b32 s62, 819200
    s_mov_b32 s63, 0x20000
    v_mov_b32 v51, 157984
    v_and_b32 v66, 7, v1
    v_max_u32 v66, 1, v66
    v_lshlrev_b32 v66, 2, v66
    v_add_u32 v66, 158016, v66
    s_mul_i32 s69, s79, 245760
    s_lshl_b32 s78, s79, 7
    s_mov_b32 m0, 63616
    s_nop 0
    buffer_load_dwordx4 v36, s[44:47], s78 offen lds
    buffer_load_dwordx4 v37, s[44:47], s78 offen offset:1024 lds
    buffer_load_dwordx4 v38, s[44:47], s78 offen offset:2048 lds
    buffer_load_dwordx4 v39, s[44:47], s78 offen offset:3072 lds
    s_mov_b32 m0, 39040
    s_nop 0
    buffer_load_dwordx4 v28, s[48:51], s69 offen lds
    buffer_load_dwordx4 v29, s[48:51], s69 offen offset:1024 lds
    buffer_load_dwordx4 v30, s[48:51], s69 offen offset:2048 lds
    buffer_load_dwordx4 v31, s[48:51], s69 offen offset:3072 lds
    s_mov_b32 m0, 67712
    s_nop 0
    buffer_load_dwordx4 v40, s[44:47], s78 offen lds
    buffer_load_dwordx4 v41, s[44:47], s78 offen offset:1024 lds
    buffer_load_dwordx4 v42, s[44:47], s78 offen offset:2048 lds
    buffer_load_dwordx4 v43, s[44:47], s78 offen offset:3072 lds
    s_mov_b32 m0, 47232
    s_nop 0
    buffer_load_dwordx4 v28, s[52:55], s69 offen lds
    buffer_load_dwordx4 v29, s[52:55], s69 offen offset:1024 lds
    buffer_load_dwordx4 v30, s[52:55], s69 offen offset:2048 lds
    buffer_load_dwordx4 v31, s[52:55], s69 offen offset:3072 lds
    s_mov_b32 m0, 71808
    s_nop 0
    buffer_load_dwordx4 v44, s[44:47], s78 offen lds
    buffer_load_dwordx4 v45, s[44:47], s78 offen offset:1024 lds
    buffer_load_dwordx4 v46, s[44:47], s78 offen offset:2048 lds
    buffer_load_dwordx4 v47, s[44:47], s78 offen offset:3072 lds
    s_mov_b32 m0, 55424
    s_nop 0
    buffer_load_dwordx4 v28, s[56:59], s69 offen lds
    buffer_load_dwordx4 v29, s[56:59], s69 offen offset:1024 lds
    buffer_load_dwordx4 v30, s[56:59], s69 offen offset:2048 lds
    buffer_load_dwordx4 v31, s[56:59], s69 offen offset:3072 lds
    s_mov_b32 m0, 75904
    s_nop 0
    buffer_load_dwordx4 v48, s[44:47], s78 offen lds
    s_waitcnt vmcnt(55)
    buffer_load_dwordx4 v49, s[44:47], s78 offen offset:1024 lds
    s_mov_b32 m0, 43136
    s_nop 0
    buffer_load_dwordx4 v32, s[48:51], s69 offen lds
    buffer_load_dwordx4 v33, s[48:51], s69 offen offset:1024 lds
    buffer_load_dwordx4 v34, s[48:51], s69 offen offset:2048 lds
    buffer_load_dwordx4 v35, s[48:51], s69 offen offset:3072 lds
    s_mov_b32 m0, 51328
    s_nop 0
    buffer_load_dwordx4 v32, s[52:55], s69 offen lds
    buffer_load_dwordx4 v33, s[52:55], s69 offen offset:1024 lds
    buffer_load_dwordx4 v34, s[52:55], s69 offen offset:2048 lds
    s_waitcnt vmcnt(55)
    buffer_load_dwordx4 v35, s[52:55], s69 offen offset:3072 lds
    s_mov_b32 m0, 59520
    s_nop 0
    buffer_load_dwordx4 v32, s[56:59], s69 offen lds
    buffer_load_dwordx4 v33, s[56:59], s69 offen offset:1024 lds
    buffer_load_dwordx4 v34, s[56:59], s69 offen offset:2048 lds
    buffer_load_dwordx4 v35, s[56:59], s69 offen offset:3072 lds
    s_waitcnt vmcnt(38) lgkmcnt(0)
    s_barrier
    s_add_u32 s34, s34, 0x9e3779b8
    s_or_b32 s34, s34, 1
    s_lshr_b64 s[80:81], s[80:81], 4
    s_and_b32 s79, s80, 15
    s_add_u32 s79, s79, s43
    s_sub_u32 s38, s79, 10
    s_cmp_ge_u32 s79, 10
    s_cselect_b32 s79, s38, s79
    s_mul_i32 s70, s79, 245760
    s_lshl_b32 s78, s79, 7
    s_mov_b32 m0, 102656
    s_nop 0
    buffer_load_dwordx4 v36, s[44:47], s78 offen lds
    buffer_load_dwordx4 v37, s[44:47], s78 offen offset:1024 lds
    buffer_load_dwordx4 v38, s[44:47], s78 offen offset:2048 lds
    buffer_load_dwordx4 v39, s[44:47], s78 offen offset:3072 lds
    s_mov_b32 m0, 78080
    s_nop 0
    buffer_load_dwordx4 v28, s[48:51], s70 offen lds
    buffer_load_dwordx4 v29, s[48:51], s70 offen offset:1024 lds
    buffer_load_dwordx4 v30, s[48:51], s70 offen offset:2048 lds
    buffer_load_dwordx4 v31, s[48:51], s70 offen offset:3072 lds
    s_mov_b32 m0, 106752
    s_nop 0
    buffer_load_dwordx4 v40, s[44:47], s78 offen lds
    buffer_load_dwordx4 v41, s[44:47], s78 offen offset:1024 lds
    buffer_load_dwordx4 v42, s[44:47], s78 offen offset:2048 lds
    buffer_load_dwordx4 v43, s[44:47], s78 offen offset:3072 lds
    s_mov_b32 m0, 86272
    s_nop 0
    buffer_load_dwordx4 v28, s[52:55], s70 offen lds
    buffer_load_dwordx4 v29, s[52:55], s70 offen offset:1024 lds
    buffer_load_dwordx4 v30, s[52:55], s70 offen offset:2048 lds
    buffer_load_dwordx4 v31, s[52:55], s70 offen offset:3072 lds
    s_mov_b32 m0, 110848
    s_nop 0
    buffer_load_dwordx4 v44, s[44:47], s78 offen lds
    buffer_load_dwordx4 v45, s[44:47], s78 offen offset:1024 lds
    buffer_load_dwordx4 v46, s[44:47], s78 offen offset:2048 lds
    buffer_load_dwordx4 v47, s[44:47], s78 offen offset:3072 lds
    s_mov_b32 m0, 94464
    s_nop 0
    buffer_load_dwordx4 v28, s[56:59], s70 offen lds
    buffer_load_dwordx4 v29, s[56:59], s70 offen offset:1024 lds
    buffer_load_dwordx4 v30, s[56:59], s70 offen offset:2048 lds
    buffer_load_dwordx4 v31, s[56:59], s70 offen offset:3072 lds
    s_mov_b32 m0, 114944
    s_nop 0
    buffer_load_dwordx4 v48, s[44:47], s78 offen lds
    s_waitcnt vmcnt(55)
    buffer_load_dwordx4 v49, s[44:47], s78 offen offset:1024 lds
    s_mov_b32 m0, 82176
    s_nop 0
    buffer_load_dwordx4 v32, s[48:51], s70 offen lds
    buffer_load_dwordx4 v33, s[48:51], s70 offen offset:1024 lds
    buffer_load_dwordx4 v34, s[48:51], s70 offen offset:2048 lds
    buffer_load_dwordx4 v35, s[48:51], s70 offen offset:3072 lds
    s_mov_b32 m0, 90368
    s_nop 0
    buffer_load_dwordx4 v32, s[52:55], s70 offen lds
    buffer_load_dwordx4 v33, s[52:55], s70 offen offset:1024 lds
    buffer_load_dwordx4 v34, s[52:55], s70 offen offset:2048 lds
    s_waitcnt vmcnt(55)
    buffer_load_dwordx4 v35, s[52:55], s70 offen offset:3072 lds
    s_mov_b32 m0, 98560
    s_nop 0
    buffer_load_dwordx4 v32, s[56:59], s70 offen lds
    buffer_load_dwordx4 v33, s[56:59], s70 offen offset:1024 lds
    buffer_load_dwordx4 v34, s[56:59], s70 offen offset:2048 lds
    buffer_load_dwordx4 v35, s[56:59], s70 offen offset:3072 lds
    s_waitcnt vmcnt(38) lgkmcnt(0)
    s_barrier
    s_lshr_b64 s[80:81], s[80:81], 4
    s_and_b32 s79, s80, 15
    s_add_u32 s79, s79, s43
    s_sub_u32 s38, s79, 10
    s_cmp_ge_u32 s79, 10
    s_cselect_b32 s79, s38, s79
    s_mul_i32 s71, s79, 245760
    s_lshl_b32 s78, s79, 7
    s_mov_b32 m0, 141696
    s_nop 0
    buffer_load_dwordx4 v36, s[44:47], s78 offen lds
    buffer_load_dwordx4 v37, s[44:47], s78 offen offset:1024 lds
    buffer_load_dwordx4 v38, s[44:47], s78 offen offset:2048 lds
    buffer_load_dwordx4 v39, s[44:47], s78 offen offset:3072 lds
    s_mov_b32 m0, 117120
    s_nop 0
    buffer_load_dwordx4 v28, s[48:51], s71 offen lds
    buffer_load_dwordx4 v29, s[48:51], s71 offen offset:1024 lds
    buffer_load_dwordx4 v30, s[48:51], s71 offen offset:2048 lds
    buffer_load_dwordx4 v31, s[48:51], s71 offen offset:3072 lds
    s_mov_b32 m0, 145792
    s_nop 0
    buffer_load_dwordx4 v40, s[44:47], s78 offen lds
    buffer_load_dwordx4 v41, s[44:47], s78 offen offset:1024 lds
    buffer_load_dwordx4 v42, s[44:47], s78 offen offset:2048 lds
    buffer_load_dwordx4 v43, s[44:47], s78 offen offset:3072 lds
    s_mov_b32 m0, 125312
    s_nop 0
    buffer_load_dwordx4 v28, s[52:55], s71 offen lds
    buffer_load_dwordx4 v29, s[52:55], s71 offen offset:1024 lds
    buffer_load_dwordx4 v30, s[52:55], s71 offen offset:2048 lds
    buffer_load_dwordx4 v31, s[52:55], s71 offen offset:3072 lds
    s_mov_b32 m0, 149888
    s_nop 0
    buffer_load_dwordx4 v44, s[44:47], s78 offen lds
    buffer_load_dwordx4 v45, s[44:47], s78 offen offset:1024 lds
    buffer_load_dwordx4 v46, s[44:47], s78 offen offset:2048 lds
    buffer_load_dwordx4 v47, s[44:47], s78 offen offset:3072 lds
    s_mov_b32 m0, 133504
    s_nop 0
    buffer_load_dwordx4 v28, s[56:59], s71 offen lds
    buffer_load_dwordx4 v29, s[56:59], s71 offen offset:1024 lds
    buffer_load_dwordx4 v30, s[56:59], s71 offen offset:2048 lds
    buffer_load_dwordx4 v31, s[56:59], s71 offen offset:3072 lds
    s_mov_b32 m0, 153984
    s_nop 0
    buffer_load_dwordx4 v48, s[44:47], s78 offen lds
    s_waitcnt vmcnt(55)
    buffer_load_dwordx4 v49, s[44:47], s78 offen offset:1024 lds
    s_mov_b32 m0, 121216
    s_nop 0
    buffer_load_dwordx4 v32, s[48:51], s71 offen lds
    buffer_load_dwordx4 v33, s[48:51], s71 offen offset:1024 lds
    buffer_load_dwordx4 v34, s[48:51], s71 offen offset:2048 lds
    buffer_load_dwordx4 v35, s[48:51], s71 offen offset:3072 lds
    s_mov_b32 m0, 129408
    s_nop 0
    buffer_load_dwordx4 v32, s[52:55], s71 offen lds
    buffer_load_dwordx4 v33, s[52:55], s71 offen offset:1024 lds
    buffer_load_dwordx4 v34, s[52:55], s71 offen offset:2048 lds
    s_waitcnt vmcnt(55)
    buffer_load_dwordx4 v35, s[52:55], s71 offen offset:3072 lds
    s_mov_b32 m0, 137600
    s_nop 0
    buffer_load_dwordx4 v32, s[56:59], s71 offen lds
    buffer_load_dwordx4 v33, s[56:59], s71 offen offset:1024 lds
    buffer_load_dwordx4 v34, s[56:59], s71 offen offset:2048 lds
    buffer_load_dwordx4 v35, s[56:59], s71 offen offset:3072 lds
    s_waitcnt vmcnt(38) lgkmcnt(0)
    s_barrier
    s_lshr_b64 s[80:81], s[80:81], 4
    s_and_b32 s79, s80, 15
    s_add_u32 s79, s79, s43
    s_sub_u32 s38, s79, 10
    s_cmp_ge_u32 s79, 10
    s_cselect_b32 s79, s38, s79
    s_mul_i32 s72, s79, 245760
    s_lshl_b32 s78, s79, 7
    s_mov_b32 m0, 24576
    s_nop 0
    buffer_load_dwordx4 v36, s[44:47], s78 offen lds
    buffer_load_dwordx4 v37, s[44:47], s78 offen offset:1024 lds
    buffer_load_dwordx4 v38, s[44:47], s78 offen offset:2048 lds
    buffer_load_dwordx4 v39, s[44:47], s78 offen offset:3072 lds
    s_mov_b32 m0, 0
    s_nop 0
    buffer_load_dwordx4 v28, s[48:51], s72 offen lds
    buffer_load_dwordx4 v29, s[48:51], s72 offen offset:1024 lds
    buffer_load_dwordx4 v30, s[48:51], s72 offen offset:2048 lds
    buffer_load_dwordx4 v31, s[48:51], s72 offen offset:3072 lds
    s_mov_b32 m0, 28672
    s_nop 0
    buffer_load_dwordx4 v40, s[44:47], s78 offen lds
    buffer_load_dwordx4 v41, s[44:47], s78 offen offset:1024 lds
    buffer_load_dwordx4 v42, s[44:47], s78 offen offset:2048 lds
    buffer_load_dwordx4 v43, s[44:47], s78 offen offset:3072 lds
    s_mov_b32 m0, 8192
    s_nop 0
    buffer_load_dwordx4 v28, s[52:55], s72 offen lds
    buffer_load_dwordx4 v29, s[52:55], s72 offen offset:1024 lds
    buffer_load_dwordx4 v30, s[52:55], s72 offen offset:2048 lds
    buffer_load_dwordx4 v31, s[52:55], s72 offen offset:3072 lds
    s_mov_b32 m0, 32768
    s_nop 0
    buffer_load_dwordx4 v44, s[44:47], s78 offen lds
    buffer_load_dwordx4 v45, s[44:47], s78 offen offset:1024 lds
    buffer_load_dwordx4 v46, s[44:47], s78 offen offset:2048 lds
    buffer_load_dwordx4 v47, s[44:47], s78 offen offset:3072 lds
    s_mov_b32 m0, 16384
    s_nop 0
    buffer_load_dwordx4 v28, s[56:59], s72 offen lds
    buffer_load_dwordx4 v29, s[56:59], s72 offen offset:1024 lds
    buffer_load_dwordx4 v30, s[56:59], s72 offen offset:2048 lds
    buffer_load_dwordx4 v31, s[56:59], s72 offen offset:3072 lds
    s_mov_b32 m0, 36864
    s_nop 0
    buffer_load_dwordx4 v48, s[44:47], s78 offen lds
    s_waitcnt vmcnt(55)
    buffer_load_dwordx4 v49, s[44:47], s78 offen offset:1024 lds
    s_mov_b32 m0, 4096
    s_nop 0
    buffer_load_dwordx4 v32, s[48:51], s72 offen lds
    buffer_load_dwordx4 v33, s[48:51], s72 offen offset:1024 lds
    buffer_load_dwordx4 v34, s[48:51], s72 offen offset:2048 lds
    buffer_load_dwordx4 v35, s[48:51], s72 offen offset:3072 lds
    s_mov_b32 m0, 12288
    s_nop 0
    buffer_load_dwordx4 v32, s[52:55], s72 offen lds
    buffer_load_dwordx4 v33, s[52:55], s72 offen offset:1024 lds
    buffer_load_dwordx4 v34, s[52:55], s72 offen offset:2048 lds
    s_waitcnt vmcnt(55)
    buffer_load_dwordx4 v35, s[52:55], s72 offen offset:3072 lds
    s_mov_b32 m0, 20480
    s_nop 0
    buffer_load_dwordx4 v32, s[56:59], s72 offen lds
    buffer_load_dwordx4 v33, s[56:59], s72 offen offset:1024 lds
    buffer_load_dwordx4 v34, s[56:59], s72 offen offset:2048 lds
    buffer_load_dwordx4 v35, s[56:59], s72 offen offset:3072 lds
    s_waitcnt vmcnt(38) lgkmcnt(0)
    s_barrier
    s_lshr_b64 s[80:81], s[80:81], 4
    s_and_b32 s79, s80, 15
    s_add_u32 s79, s79, s43
    s_sub_u32 s38, s79, 10
    s_cmp_ge_u32 s79, 10
    s_cselect_b32 s79, s38, s79
    s_mul_i32 s73, s79, 245760
    s_lshl_b32 s78, s79, 7
    s_mov_b32 m0, 63616
    s_nop 0
    buffer_load_dwordx4 v36, s[44:47], s78 offen lds
    buffer_load_dwordx4 v37, s[44:47], s78 offen offset:1024 lds
    buffer_load_dwordx4 v38, s[44:47], s78 offen offset:2048 lds
    buffer_load_dwordx4 v39, s[44:47], s78 offen offset:3072 lds
    s_mov_b32 m0, 39040
    s_nop 0
    buffer_load_dwordx4 v28, s[48:51], s73 offen lds
    buffer_load_dwordx4 v29, s[48:51], s73 offen offset:1024 lds
    buffer_load_dwordx4 v30, s[48:51], s73 offen offset:2048 lds
    buffer_load_dwordx4 v31, s[48:51], s73 offen offset:3072 lds
    s_mov_b32 m0, 67712
    s_nop 0
    buffer_load_dwordx4 v40, s[44:47], s78 offen lds
    buffer_load_dwordx4 v41, s[44:47], s78 offen offset:1024 lds
    buffer_load_dwordx4 v42, s[44:47], s78 offen offset:2048 lds
    buffer_load_dwordx4 v43, s[44:47], s78 offen offset:3072 lds
    s_mov_b32 m0, 47232
    s_nop 0
    buffer_load_dwordx4 v28, s[52:55], s73 offen lds
    buffer_load_dwordx4 v29, s[52:55], s73 offen offset:1024 lds
    buffer_load_dwordx4 v30, s[52:55], s73 offen offset:2048 lds
    buffer_load_dwordx4 v31, s[52:55], s73 offen offset:3072 lds
    s_mov_b32 m0, 71808
    s_nop 0
    buffer_load_dwordx4 v44, s[44:47], s78 offen lds
    buffer_load_dwordx4 v45, s[44:47], s78 offen offset:1024 lds
    buffer_load_dwordx4 v46, s[44:47], s78 offen offset:2048 lds
    buffer_load_dwordx4 v47, s[44:47], s78 offen offset:3072 lds
    s_mov_b32 m0, 55424
    s_nop 0
    buffer_load_dwordx4 v28, s[56:59], s73 offen lds
    buffer_load_dwordx4 v29, s[56:59], s73 offen offset:1024 lds
    buffer_load_dwordx4 v30, s[56:59], s73 offen offset:2048 lds
    buffer_load_dwordx4 v31, s[56:59], s73 offen offset:3072 lds
    s_mov_b32 m0, 75904
    s_nop 0
    buffer_load_dwordx4 v48, s[44:47], s78 offen lds
    s_waitcnt vmcnt(55)
    buffer_load_dwordx4 v49, s[44:47], s78 offen offset:1024 lds
    s_mov_b32 m0, 43136
    s_nop 0
    buffer_load_dwordx4 v32, s[48:51], s73 offen lds
    buffer_load_dwordx4 v33, s[48:51], s73 offen offset:1024 lds
    buffer_load_dwordx4 v34, s[48:51], s73 offen offset:2048 lds
    buffer_load_dwordx4 v35, s[48:51], s73 offen offset:3072 lds
    s_mov_b32 m0, 51328
    s_nop 0
    buffer_load_dwordx4 v32, s[52:55], s73 offen lds
    buffer_load_dwordx4 v33, s[52:55], s73 offen offset:1024 lds
    buffer_load_dwordx4 v34, s[52:55], s73 offen offset:2048 lds
    s_waitcnt vmcnt(55)
    buffer_load_dwordx4 v35, s[52:55], s73 offen offset:3072 lds
    s_mov_b32 m0, 59520
    s_nop 0
    buffer_load_dwordx4 v32, s[56:59], s73 offen lds
    buffer_load_dwordx4 v33, s[56:59], s73 offen offset:1024 lds
    buffer_load_dwordx4 v34, s[56:59], s73 offen offset:2048 lds
    buffer_load_dwordx4 v35, s[56:59], s73 offen offset:3072 lds
    s_waitcnt vmcnt(38) lgkmcnt(0)
    s_barrier
    s_lshr_b64 s[80:81], s[80:81], 4
    s_and_b32 s79, s80, 15
    s_add_u32 s79, s79, s43
    s_sub_u32 s38, s79, 10
    s_cmp_ge_u32 s79, 10
    s_cselect_b32 s79, s38, s79
    s_mul_i32 s74, s79, 245760
    s_lshl_b32 s78, s79, 7
    s_mov_b32 m0, 102656
    s_nop 0
    buffer_load_dwordx4 v36, s[44:47], s78 offen lds
    buffer_load_dwordx4 v37, s[44:47], s78 offen offset:1024 lds
    buffer_load_dwordx4 v38, s[44:47], s78 offen offset:2048 lds
    buffer_load_dwordx4 v39, s[44:47], s78 offen offset:3072 lds
    s_mov_b32 m0, 78080
    s_nop 0
    buffer_load_dwordx4 v28, s[48:51], s74 offen lds
    buffer_load_dwordx4 v29, s[48:51], s74 offen offset:1024 lds
    buffer_load_dwordx4 v30, s[48:51], s74 offen offset:2048 lds
    buffer_load_dwordx4 v31, s[48:51], s74 offen offset:3072 lds
    s_mov_b32 m0, 106752
    s_nop 0
    buffer_load_dwordx4 v40, s[44:47], s78 offen lds
    buffer_load_dwordx4 v41, s[44:47], s78 offen offset:1024 lds
    buffer_load_dwordx4 v42, s[44:47], s78 offen offset:2048 lds
    buffer_load_dwordx4 v43, s[44:47], s78 offen offset:3072 lds
    s_mov_b32 m0, 86272
    s_nop 0
    buffer_load_dwordx4 v28, s[52:55], s74 offen lds
    buffer_load_dwordx4 v29, s[52:55], s74 offen offset:1024 lds
    buffer_load_dwordx4 v30, s[52:55], s74 offen offset:2048 lds
    buffer_load_dwordx4 v31, s[52:55], s74 offen offset:3072 lds
    s_mov_b32 m0, 110848
    s_nop 0
    buffer_load_dwordx4 v44, s[44:47], s78 offen lds
    buffer_load_dwordx4 v45, s[44:47], s78 offen offset:1024 lds
    buffer_load_dwordx4 v46, s[44:47], s78 offen offset:2048 lds
    buffer_load_dwordx4 v47, s[44:47], s78 offen offset:3072 lds
    s_mov_b32 m0, 82176
    s_nop 0
    buffer_load_dwordx4 v32, s[48:51], s74 offen lds
    buffer_load_dwordx4 v33, s[48:51], s74 offen offset:1024 lds
    buffer_load_dwordx4 v34, s[48:51], s74 offen offset:2048 lds
    buffer_load_dwordx4 v35, s[48:51], s74 offen offset:3072 lds
    s_mov_b32 m0, 114944
    s_nop 0
    buffer_load_dwordx4 v48, s[44:47], s78 offen lds
    s_waitcnt vmcnt(55)
    buffer_load_dwordx4 v49, s[44:47], s78 offen offset:1024 lds
    s_mov_b32 m0, 90368
    s_nop 0
    buffer_load_dwordx4 v32, s[52:55], s74 offen lds
    buffer_load_dwordx4 v33, s[52:55], s74 offen offset:1024 lds
    buffer_load_dwordx4 v34, s[52:55], s74 offen offset:2048 lds
    buffer_load_dwordx4 v35, s[52:55], s74 offen offset:3072 lds
    s_waitcnt vmcnt(30) lgkmcnt(0)
    s_barrier
    s_lshr_b64 s[80:81], s[80:81], 4
    s_and_b32 s79, s80, 15
    s_add_u32 s79, s79, s43
    s_sub_u32 s38, s79, 10
    s_cmp_ge_u32 s79, 10
    s_cselect_b32 s79, s38, s79
    s_mul_i32 s75, s79, 245760
    s_lshl_b32 s78, s79, 7
    s_mov_b32 m0, 141696
    s_nop 0
    buffer_load_dwordx4 v36, s[44:47], s78 offen lds
    buffer_load_dwordx4 v37, s[44:47], s78 offen offset:1024 lds
    buffer_load_dwordx4 v38, s[44:47], s78 offen offset:2048 lds
    buffer_load_dwordx4 v39, s[44:47], s78 offen offset:3072 lds
    s_mov_b32 m0, 117120
    s_nop 0
    buffer_load_dwordx4 v28, s[48:51], s75 offen lds
    buffer_load_dwordx4 v29, s[48:51], s75 offen offset:1024 lds
    buffer_load_dwordx4 v30, s[48:51], s75 offen offset:2048 lds
    buffer_load_dwordx4 v31, s[48:51], s75 offen offset:3072 lds
    s_mov_b32 m0, 145792
    s_nop 0
    buffer_load_dwordx4 v40, s[44:47], s78 offen lds
    buffer_load_dwordx4 v41, s[44:47], s78 offen offset:1024 lds
    buffer_load_dwordx4 v42, s[44:47], s78 offen offset:2048 lds
    buffer_load_dwordx4 v43, s[44:47], s78 offen offset:3072 lds
    s_mov_b32 m0, 125312
    s_nop 0
    buffer_load_dwordx4 v28, s[52:55], s75 offen lds
    buffer_load_dwordx4 v29, s[52:55], s75 offen offset:1024 lds
    buffer_load_dwordx4 v30, s[52:55], s75 offen offset:2048 lds
    buffer_load_dwordx4 v31, s[52:55], s75 offen offset:3072 lds
    s_mov_b32 m0, 149888
    s_nop 0
    buffer_load_dwordx4 v44, s[44:47], s78 offen lds
    buffer_load_dwordx4 v45, s[44:47], s78 offen offset:1024 lds
    buffer_load_dwordx4 v46, s[44:47], s78 offen offset:2048 lds
    buffer_load_dwordx4 v47, s[44:47], s78 offen offset:3072 lds
    s_mov_b32 m0, 121216
    s_nop 0
    buffer_load_dwordx4 v32, s[48:51], s75 offen lds
    buffer_load_dwordx4 v33, s[48:51], s75 offen offset:1024 lds
    buffer_load_dwordx4 v34, s[48:51], s75 offen offset:2048 lds
    buffer_load_dwordx4 v35, s[48:51], s75 offen offset:3072 lds
    s_mov_b32 m0, 153984
    s_nop 0
    buffer_load_dwordx4 v48, s[44:47], s78 offen lds
    buffer_load_dwordx4 v49, s[44:47], s78 offen offset:1024 lds
    s_mov_b32 m0, 129408
    s_nop 0
    buffer_load_dwordx4 v32, s[52:55], s75 offen lds
    buffer_load_dwordx4 v33, s[52:55], s75 offen offset:1024 lds
    buffer_load_dwordx4 v34, s[52:55], s75 offen offset:2048 lds
    buffer_load_dwordx4 v35, s[52:55], s75 offen offset:3072 lds
    s_waitcnt vmcnt(30) lgkmcnt(0)
    s_barrier
    s_lshr_b64 s[80:81], s[80:81], 4
    s_and_b32 s79, s80, 15
    s_add_u32 s79, s79, s43
    s_sub_u32 s38, s79, 10
    s_cmp_ge_u32 s79, 10
    s_cselect_b32 s79, s38, s79
    s_mul_i32 s76, s79, 245760
    s_lshl_b32 s78, s79, 7
    s_mov_b32 m0, 24576
    s_nop 0
    buffer_load_dwordx4 v36, s[44:47], s78 offen lds
    buffer_load_dwordx4 v37, s[44:47], s78 offen offset:1024 lds
    buffer_load_dwordx4 v38, s[44:47], s78 offen offset:2048 lds
    buffer_load_dwordx4 v39, s[44:47], s78 offen offset:3072 lds
    s_mov_b32 m0, 0
    s_nop 0
    buffer_load_dwordx4 v28, s[48:51], s76 offen lds
    buffer_load_dwordx4 v29, s[48:51], s76 offen offset:1024 lds
    buffer_load_dwordx4 v30, s[48:51], s76 offen offset:2048 lds
    buffer_load_dwordx4 v31, s[48:51], s76 offen offset:3072 lds
    s_mov_b32 m0, 28672
    s_nop 0
    buffer_load_dwordx4 v40, s[44:47], s78 offen lds
    buffer_load_dwordx4 v41, s[44:47], s78 offen offset:1024 lds
    buffer_load_dwordx4 v42, s[44:47], s78 offen offset:2048 lds
    buffer_load_dwordx4 v43, s[44:47], s78 offen offset:3072 lds
    s_mov_b32 m0, 8192
    s_nop 0
    buffer_load_dwordx4 v28, s[52:55], s76 offen lds
    buffer_load_dwordx4 v29, s[52:55], s76 offen offset:1024 lds
    buffer_load_dwordx4 v30, s[52:55], s76 offen offset:2048 lds
    buffer_load_dwordx4 v31, s[52:55], s76 offen offset:3072 lds
    s_mov_b32 m0, 32768
    s_nop 0
    buffer_load_dwordx4 v44, s[44:47], s78 offen lds
    buffer_load_dwordx4 v45, s[44:47], s78 offen offset:1024 lds
    buffer_load_dwordx4 v46, s[44:47], s78 offen offset:2048 lds
    buffer_load_dwordx4 v47, s[44:47], s78 offen offset:3072 lds
    s_mov_b32 m0, 4096
    s_nop 0
    buffer_load_dwordx4 v32, s[48:51], s76 offen lds
    buffer_load_dwordx4 v33, s[48:51], s76 offen offset:1024 lds
    buffer_load_dwordx4 v34, s[48:51], s76 offen offset:2048 lds
    buffer_load_dwordx4 v35, s[48:51], s76 offen offset:3072 lds
    s_mov_b32 m0, 36864
    s_nop 0
    buffer_load_dwordx4 v48, s[44:47], s78 offen lds
    buffer_load_dwordx4 v49, s[44:47], s78 offen offset:1024 lds
    s_mov_b32 m0, 12288
    s_nop 0
    buffer_load_dwordx4 v32, s[52:55], s76 offen lds
    buffer_load_dwordx4 v33, s[52:55], s76 offen offset:1024 lds
    buffer_load_dwordx4 v34, s[52:55], s76 offen offset:2048 lds
    buffer_load_dwordx4 v35, s[52:55], s76 offen offset:3072 lds
    s_waitcnt vmcnt(30) lgkmcnt(0)
    s_barrier
    s_lshr_b64 s[80:81], s[80:81], 4
    s_and_b32 s79, s80, 15
    s_add_u32 s79, s79, s43
    s_sub_u32 s38, s79, 10
    s_cmp_ge_u32 s79, 10
    s_cselect_b32 s79, s38, s79
    s_mul_i32 s77, s79, 245760
    s_lshl_b32 s78, s79, 7
    s_mov_b32 m0, 63616
    s_nop 0
    buffer_load_dwordx4 v36, s[44:47], s78 offen lds
    buffer_load_dwordx4 v37, s[44:47], s78 offen offset:1024 lds
    buffer_load_dwordx4 v38, s[44:47], s78 offen offset:2048 lds
    buffer_load_dwordx4 v39, s[44:47], s78 offen offset:3072 lds
    s_mov_b32 m0, 39040
    s_nop 0
    buffer_load_dwordx4 v28, s[48:51], s77 offen lds
    buffer_load_dwordx4 v29, s[48:51], s77 offen offset:1024 lds
    buffer_load_dwordx4 v30, s[48:51], s77 offen offset:2048 lds
    buffer_load_dwordx4 v31, s[48:51], s77 offen offset:3072 lds
    s_mov_b32 m0, 67712
    s_nop 0
    buffer_load_dwordx4 v40, s[44:47], s78 offen lds
    buffer_load_dwordx4 v41, s[44:47], s78 offen offset:1024 lds
    buffer_load_dwordx4 v42, s[44:47], s78 offen offset:2048 lds
    buffer_load_dwordx4 v43, s[44:47], s78 offen offset:3072 lds
    s_mov_b32 m0, 47232
    s_nop 0
    buffer_load_dwordx4 v28, s[52:55], s77 offen lds
    buffer_load_dwordx4 v29, s[52:55], s77 offen offset:1024 lds
    buffer_load_dwordx4 v30, s[52:55], s77 offen offset:2048 lds
    buffer_load_dwordx4 v31, s[52:55], s77 offen offset:3072 lds
    s_mov_b32 m0, 71808
    s_nop 0
    buffer_load_dwordx4 v44, s[44:47], s78 offen lds
    buffer_load_dwordx4 v45, s[44:47], s78 offen offset:1024 lds
    buffer_load_dwordx4 v46, s[44:47], s78 offen offset:2048 lds
    buffer_load_dwordx4 v47, s[44:47], s78 offen offset:3072 lds
    s_mov_b32 m0, 43136
    s_nop 0
    buffer_load_dwordx4 v32, s[48:51], s77 offen lds
    buffer_load_dwordx4 v33, s[48:51], s77 offen offset:1024 lds
    buffer_load_dwordx4 v34, s[48:51], s77 offen offset:2048 lds
    buffer_load_dwordx4 v35, s[48:51], s77 offen offset:3072 lds
    s_mov_b32 m0, 75904
    s_nop 0
    buffer_load_dwordx4 v48, s[44:47], s78 offen lds
    buffer_load_dwordx4 v49, s[44:47], s78 offen offset:1024 lds
    s_mov_b32 m0, 51328
    s_nop 0
    buffer_load_dwordx4 v32, s[52:55], s77 offen lds
    buffer_load_dwordx4 v33, s[52:55], s77 offen offset:1024 lds
    buffer_load_dwordx4 v34, s[52:55], s77 offen offset:2048 lds
    buffer_load_dwordx4 v35, s[52:55], s77 offen offset:3072 lds
    s_waitcnt vmcnt(30) lgkmcnt(0)
    s_barrier
    s_lshr_b64 s[80:81], s[80:81], 4
    s_and_b32 s79, s80, 15
    s_add_u32 s79, s79, s43
    s_sub_u32 s38, s79, 10
    s_cmp_ge_u32 s79, 10
    s_cselect_b32 s79, s38, s79
    s_mov_b32 m0, 94464
    s_nop 0
    buffer_load_dwordx4 v28, s[56:59], s74 offen lds
    buffer_load_dwordx4 v29, s[56:59], s74 offen offset:1024 lds
    buffer_load_dwordx4 v30, s[56:59], s74 offen offset:2048 lds
    buffer_load_dwordx4 v31, s[56:59], s74 offen offset:3072 lds
    s_mov_b32 m0, 98560
    s_nop 0
    buffer_load_dwordx4 v32, s[56:59], s74 offen lds
    buffer_load_dwordx4 v33, s[56:59], s74 offen offset:1024 lds
    buffer_load_dwordx4 v34, s[56:59], s74 offen offset:2048 lds
    buffer_load_dwordx4 v35, s[56:59], s74 offen offset:3072 lds
    s_mov_b32 m0, 133504
    s_nop 0
    buffer_load_dwordx4 v28, s[56:59], s75 offen lds
    buffer_load_dwordx4 v29, s[56:59], s75 offen offset:1024 lds
    buffer_load_dwordx4 v30, s[56:59], s75 offen offset:2048 lds
    buffer_load_dwordx4 v31, s[56:59], s75 offen offset:3072 lds
    s_waitcnt vmcnt(12) lgkmcnt(0)
    s_barrier
    s_mov_b32 m0, 137600
    s_nop 0
    buffer_load_dwordx4 v32, s[56:59], s75 offen lds
    buffer_load_dwordx4 v33, s[56:59], s75 offen offset:1024 lds
    buffer_load_dwordx4 v34, s[56:59], s75 offen offset:2048 lds
    buffer_load_dwordx4 v35, s[56:59], s75 offen offset:3072 lds
    s_mov_b32 m0, 16384
    s_nop 0
    buffer_load_dwordx4 v28, s[56:59], s76 offen lds
    buffer_load_dwordx4 v29, s[56:59], s76 offen offset:1024 lds
    buffer_load_dwordx4 v30, s[56:59], s76 offen offset:2048 lds
    buffer_load_dwordx4 v31, s[56:59], s76 offen offset:3072 lds
    s_mov_b32 m0, 20480
    s_nop 0
    buffer_load_dwordx4 v32, s[56:59], s76 offen lds
    buffer_load_dwordx4 v33, s[56:59], s76 offen offset:1024 lds
    buffer_load_dwordx4 v34, s[56:59], s76 offen offset:2048 lds
    buffer_load_dwordx4 v35, s[56:59], s76 offen offset:3072 lds
    s_mov_b32 m0, 55424
    s_nop 0
    buffer_load_dwordx4 v28, s[56:59], s77 offen lds
    buffer_load_dwordx4 v29, s[56:59], s77 offen offset:1024 lds
    buffer_load_dwordx4 v30, s[56:59], s77 offen offset:2048 lds
    buffer_load_dwordx4 v31, s[56:59], s77 offen offset:3072 lds
    s_mov_b32 m0, 59520
    s_nop 0
    buffer_load_dwordx4 v32, s[56:59], s77 offen lds
    buffer_load_dwordx4 v33, s[56:59], s77 offen offset:1024 lds
    buffer_load_dwordx4 v34, s[56:59], s77 offen offset:2048 lds
    buffer_load_dwordx4 v35, s[56:59], s77 offen offset:3072 lds
    s_mov_b32 s10, 20480
    v_lshrrev_b32 v52, 5, v1
    v_lshlrev_b32 v52, 3, v52
    v_add_u32 v53, 2, v52
    v_add_u32 v54, 4, v52
    v_add_u32 v55, 6, v52
    v_add_u32 v56, 16, v52
    v_add_u32 v57, 18, v52
    v_add_u32 v58, 20, v52
    v_add_u32 v59, 22, v52
    v_and_b32 v7, 3, v5
    v_mul_u32_u24 v7, 1280, v7
    v_add_u32 v60, v7, v50
    v_xor_b32 v61, 64, v60
    v_add_u32 v61, 4096, v61
    v_add_u32 v62, 8192, v60
    v_add_u32 v63, 8192, v61
    s_mov_b32 s5, 0xbfe10856
    s_mov_b32 s6, 0xaff80255
    s_mov_b32 s7, 0xabfe4015
    s_mov_b32 s8, 0xaa7fd005
    s_mov_b32 s9, 0x6adfb401
    s_cmp_eq_u32 s42, 1
    s_cselect_b32 s5, 0xabfe4015, s5
    s_cselect_b32 s6, 0xaa7fd005, s6
    s_cselect_b32 s7, 0x6adfb401, s7
    s_cselect_b32 s8, 0xbfe10856, s8
    s_cselect_b32 s9, 0xaff80255, s9
    s_cmp_eq_u32 s42, 2
    s_cselect_b32 s5, 0x6adfb401, s5
    s_cselect_b32 s6, 0xbfe10856, s6
    s_cselect_b32 s7, 0xaff80255, s7
    s_cselect_b32 s8, 0xabfe4015, s8
    s_cselect_b32 s9, 0xaa7fd005, s9
    s_cmp_eq_u32 s42, 3
    s_cselect_b32 s5, 0xaff80255, s5
    s_cselect_b32 s6, 0xabfe4015, s6
    s_cselect_b32 s7, 0xaa7fd005, s7
    s_cselect_b32 s8, 0x6adfb401, s8
    s_cselect_b32 s9, 0xbfe10856, s9
    s_cmp_eq_u32 s42, 4
    s_cselect_b32 s5, 0xaa7fd005, s5
    s_cselect_b32 s6, 0x6adfb401, s6
    s_cselect_b32 s7, 0xbfe10856, s7
    s_cselect_b32 s8, 0xaff80255, s8
    s_cselect_b32 s9, 0xabfe4015, s9
    s_mul_i32 s4, s42, 163840
    s_mov_b32 m0, 0
    v_bfe_u32 v64, s5, v52, 2
    v_mad_u32_u24 v64, v64, s10, v60
    buffer_load_dwordx4 v64, s[60:63], s4 offen lds
    v_bfe_u32 v65, s5, v53, 2
    v_mad_u32_u24 v65, v65, s10, v61
    buffer_load_dwordx4 v65, s[60:63], s4 offen offset:1024 lds
    v_bfe_u32 v64, s5, v54, 2
    v_mad_u32_u24 v64, v64, s10, v62
    buffer_load_dwordx4 v64, s[60:63], s4 offen offset:2048 lds
    v_bfe_u32 v65, s5, v55, 2
    v_mad_u32_u24 v65, v65, s10, v63
    buffer_load_dwordx4 v65, s[60:63], s4 offen offset:3072 lds
    s_mov_b32 m0, 4096
    v_bfe_u32 v64, s5, v56, 2
    v_mad_u32_u24 v64, v64, s10, v60
    buffer_load_dwordx4 v64, s[60:63], s4 offen lds
    v_bfe_u32 v65, s5, v57, 2
    v_mad_u32_u24 v65, v65, s10, v61
    buffer_load_dwordx4 v65, s[60:63], s4 offen offset:1024 lds
    v_bfe_u32 v64, s5, v58, 2
    v_mad_u32_u24 v64, v64, s10, v62
    buffer_load_dwordx4 v64, s[60:63], s4 offen offset:2048 lds
    v_bfe_u32 v65, s5, v59, 2
    v_mad_u32_u24 v65, v65, s10, v63
    buffer_load_dwordx4 v65, s[60:63], s4 offen offset:3072 lds
    s_add_u32 s4, s4, 81920
    s_cmp_eq_u32 s4, 819200
    s_cselect_b32 s4, 0, s4
    s_mov_b32 m0, 8192
    v_bfe_u32 v64, s6, v52, 2
    v_mad_u32_u24 v64, v64, s10, v60
    buffer_load_dwordx4 v64, s[60:63], s4 offen lds
    v_bfe_u32 v65, s6, v53, 2
    v_mad_u32_u24 v65, v65, s10, v61
    buffer_load_dwordx4 v65, s[60:63], s4 offen offset:1024 lds
    v_bfe_u32 v64, s6, v54, 2
    v_mad_u32_u24 v64, v64, s10, v62
    buffer_load_dwordx4 v64, s[60:63], s4 offen offset:2048 lds
    v_bfe_u32 v65, s6, v55, 2
    v_mad_u32_u24 v65, v65, s10, v63
    buffer_load_dwordx4 v65, s[60:63], s4 offen offset:3072 lds
    s_mov_b32 m0, 12288
    v_bfe_u32 v64, s6, v56, 2
    v_mad_u32_u24 v64, v64, s10, v60
    buffer_load_dwordx4 v64, s[60:63], s4 offen lds
    v_bfe_u32 v65, s6, v57, 2
    v_mad_u32_u24 v65, v65, s10, v61
    buffer_load_dwordx4 v65, s[60:63], s4 offen offset:1024 lds
    v_bfe_u32 v64, s6, v58, 2
    v_mad_u32_u24 v64, v64, s10, v62
    buffer_load_dwordx4 v64, s[60:63], s4 offen offset:2048 lds
    v_bfe_u32 v65, s6, v59, 2
    v_mad_u32_u24 v65, v65, s10, v63
    buffer_load_dwordx4 v65, s[60:63], s4 offen offset:3072 lds
    s_add_u32 s4, s4, 81920
    s_cmp_eq_u32 s4, 819200
    s_cselect_b32 s4, 0, s4
    s_waitcnt vmcnt(16)
    v_mov_b32 v5, 157980
    v_mov_b32 v6, 1
    s_mov_b64 exec, 1
    ds_add_u32 v5, v6
    s_mov_b64 exec, -1
    v_mov_b32 v5, 157972
    v_mov_b32 v6, 1
    s_mov_b64 exec, 1
    ds_add_u32 v5, v6
    s_mov_b64 exec, -1
    s_mov_b32 m0, 24576
    v_bfe_u32 v64, s7, v52, 2
    v_mad_u32_u24 v64, v64, s10, v60
    buffer_load_dwordx4 v64, s[60:63], s4 offen lds
    v_bfe_u32 v65, s7, v53, 2
    v_mad_u32_u24 v65, v65, s10, v61
    buffer_load_dwordx4 v65, s[60:63], s4 offen offset:1024 lds
    v_bfe_u32 v64, s7, v54, 2
    v_mad_u32_u24 v64, v64, s10, v62
    buffer_load_dwordx4 v64, s[60:63], s4 offen offset:2048 lds
    v_bfe_u32 v65, s7, v55, 2
    v_mad_u32_u24 v65, v65, s10, v63
    buffer_load_dwordx4 v65, s[60:63], s4 offen offset:3072 lds
    s_mov_b32 m0, 28672
    v_bfe_u32 v64, s7, v56, 2
    v_mad_u32_u24 v64, v64, s10, v60
    buffer_load_dwordx4 v64, s[60:63], s4 offen lds
    v_bfe_u32 v65, s7, v57, 2
    v_mad_u32_u24 v65, v65, s10, v61
    buffer_load_dwordx4 v65, s[60:63], s4 offen offset:1024 lds
    v_bfe_u32 v64, s7, v58, 2
    v_mad_u32_u24 v64, v64, s10, v62
    buffer_load_dwordx4 v64, s[60:63], s4 offen offset:2048 lds
    v_bfe_u32 v65, s7, v59, 2
    v_mad_u32_u24 v65, v65, s10, v63
    buffer_load_dwordx4 v65, s[60:63], s4 offen offset:3072 lds
    s_add_u32 s4, s4, 81920
    s_cmp_eq_u32 s4, 819200
    s_cselect_b32 s4, 0, s4
    s_mov_b32 m0, 123136
    v_bfe_u32 v64, s8, v52, 2
    v_mad_u32_u24 v64, v64, s10, v60
    buffer_load_dwordx4 v64, s[60:63], s4 offen lds
    v_bfe_u32 v65, s8, v53, 2
    v_mad_u32_u24 v65, v65, s10, v61
    buffer_load_dwordx4 v65, s[60:63], s4 offen offset:1024 lds
    v_bfe_u32 v64, s8, v54, 2
    v_mad_u32_u24 v64, v64, s10, v62
    buffer_load_dwordx4 v64, s[60:63], s4 offen offset:2048 lds
    v_bfe_u32 v65, s8, v55, 2
    v_mad_u32_u24 v65, v65, s10, v63
    buffer_load_dwordx4 v65, s[60:63], s4 offen offset:3072 lds
    s_mov_b32 m0, 127232
    v_bfe_u32 v64, s8, v56, 2
    v_mad_u32_u24 v64, v64, s10, v60
    buffer_load_dwordx4 v64, s[60:63], s4 offen lds
    v_bfe_u32 v65, s8, v57, 2
    v_mad_u32_u24 v65, v65, s10, v61
    buffer_load_dwordx4 v65, s[60:63], s4 offen offset:1024 lds
    v_bfe_u32 v64, s8, v58, 2
    v_mad_u32_u24 v64, v64, s10, v62
    buffer_load_dwordx4 v64, s[60:63], s4 offen offset:2048 lds
    v_bfe_u32 v65, s8, v59, 2
    v_mad_u32_u24 v65, v65, s10, v63
    buffer_load_dwordx4 v65, s[60:63], s4 offen offset:3072 lds
    s_add_u32 s4, s4, 81920
    s_cmp_eq_u32 s4, 819200
    s_cselect_b32 s4, 0, s4
    s_mov_b32 m0, 80000
    v_bfe_u32 v64, s9, v52, 2
    v_mad_u32_u24 v64, v64, s10, v60
    buffer_load_dwordx4 v64, s[60:63], s4 offen lds
    v_bfe_u32 v65, s9, v53, 2
    v_mad_u32_u24 v65, v65, s10, v61
    buffer_load_dwordx4 v65, s[60:63], s4 offen offset:1024 lds
    v_bfe_u32 v64, s9, v54, 2
    v_mad_u32_u24 v64, v64, s10, v62
    buffer_load_dwordx4 v64, s[60:63], s4 offen offset:2048 lds
    v_bfe_u32 v65, s9, v55, 2
    v_mad_u32_u24 v65, v65, s10, v63
    buffer_load_dwordx4 v65, s[60:63], s4 offen offset:3072 lds
    s_mov_b32 m0, 84096
    v_bfe_u32 v64, s9, v56, 2
    v_mad_u32_u24 v64, v64, s10, v60
    buffer_load_dwordx4 v64, s[60:63], s4 offen lds
    v_bfe_u32 v65, s9, v57, 2
    v_mad_u32_u24 v65, v65, s10, v61
    buffer_load_dwordx4 v65, s[60:63], s4 offen offset:1024 lds
    v_bfe_u32 v64, s9, v58, 2
    v_mad_u32_u24 v64, v64, s10, v62
    buffer_load_dwordx4 v64, s[60:63], s4 offen offset:2048 lds
    v_bfe_u32 v65, s9, v59, 2
    v_mad_u32_u24 v65, v65, s10, v63
    buffer_load_dwordx4 v65, s[60:63], s4 offen offset:3072 lds
    s_add_u32 s4, s4, 81920
    s_cmp_eq_u32 s4, 819200
    s_cselect_b32 s4, 0, s4
    s_waitcnt vmcnt(0)
    v_mov_b32 v7, 157980
    v_mov_b32 v6, 1
    s_mov_b64 exec, 1
    ds_add_u32 v7, v6
    s_mov_b64 exec, -1
Lcw_7:
    s_sub_u32 s35, s35, 1
    s_cbranch_scc1 Lend
    ds_read_b32 v6, v5
    s_waitcnt lgkmcnt(0)
    v_readfirstlane_b32 s38, v6
    s_nop 0
    s_cmp_lt_u32 s38, 8
    s_cbranch_scc1 Lcw_7
    s_lshl_b32 s36, s32, 7
    s_add_u32 s36, s36, 8257536
    v_mov_b32 v69, s36
    buffer_load_dwordx4 v[70:73], v69, s[28:31], 0 offen sc1
    v_mov_b32 v5, 157976
Lcw_8:
    s_sub_u32 s35, s35, 1
    s_cbranch_scc1 Lend
    ds_read_b32 v6, v5
    s_waitcnt lgkmcnt(0)
    v_readfirstlane_b32 s38, v6
    s_nop 0
    s_cmp_lt_u32 s38, 7
    s_cbranch_scc1 Lcw_8
    s_mov_b32 m0, 32768
    v_bfe_u32 v64, s5, v52, 2
    v_mad_u32_u24 v64, v64, s10, v60
    buffer_load_dwordx4 v64, s[60:63], s4 offen lds
    v_bfe_u32 v65, s5, v53, 2
    v_mad_u32_u24 v65, v65, s10, v61
    buffer_load_dwordx4 v65, s[60:63], s4 offen offset:1024 lds
    v_bfe_u32 v64, s5, v54, 2
    v_mad_u32_u24 v64, v64, s10, v62
    buffer_load_dwordx4 v64, s[60:63], s4 offen offset:2048 lds
    v_bfe_u32 v65, s5, v55, 2
    v_mad_u32_u24 v65, v65, s10, v63
    buffer_load_dwordx4 v65, s[60:63], s4 offen offset:3072 lds
    s_mov_b32 m0, 36864
    v_bfe_u32 v64, s5, v56, 2
    v_mad_u32_u24 v64, v64, s10, v60
    buffer_load_dwordx4 v64, s[60:63], s4 offen lds
    v_bfe_u32 v65, s5, v57, 2
    v_mad_u32_u24 v65, v65, s10, v61
    buffer_load_dwordx4 v65, s[60:63], s4 offen offset:1024 lds
    v_bfe_u32 v64, s5, v58, 2
    v_mad_u32_u24 v64, v64, s10, v62
    buffer_load_dwordx4 v64, s[60:63], s4 offen offset:2048 lds
    v_bfe_u32 v65, s5, v59, 2
    v_mad_u32_u24 v65, v65, s10, v63
    buffer_load_dwordx4 v65, s[60:63], s4 offen offset:3072 lds
    s_add_u32 s4, s4, 81920
    s_cmp_eq_u32 s4, 819200
    s_cselect_b32 s4, 0, s4
    s_mov_b32 m0, 40960
    v_bfe_u32 v64, s6, v52, 2
    v_mad_u32_u24 v64, v64, s10, v60
    buffer_load_dwordx4 v64, s[60:63], s4 offen lds
    v_bfe_u32 v65, s6, v53, 2
    v_mad_u32_u24 v65, v65, s10, v61
    buffer_load_dwordx4 v65, s[60:63], s4 offen offset:1024 lds
    v_bfe_u32 v64, s6, v54, 2
    v_mad_u32_u24 v64, v64, s10, v62
    buffer_load_dwordx4 v64, s[60:63], s4 offen offset:2048 lds
    v_bfe_u32 v65, s6, v55, 2
    v_mad_u32_u24 v65, v65, s10, v63
    buffer_load_dwordx4 v65, s[60:63], s4 offen offset:3072 lds
    s_mov_b32 m0, 45056
    v_bfe_u32 v64, s6, v56, 2
    v_mad_u32_u24 v64, v64, s10, v60
    buffer_load_dwordx4 v64, s[60:63], s4 offen lds
    v_bfe_u32 v65, s6, v57, 2
    v_mad_u32_u24 v65, v65, s10, v61
    buffer_load_dwordx4 v65, s[60:63], s4 offen offset:1024 lds
    v_bfe_u32 v64, s6, v58, 2
    v_mad_u32_u24 v64, v64, s10, v62
    buffer_load_dwordx4 v64, s[60:63], s4 offen offset:2048 lds
    v_bfe_u32 v65, s6, v59, 2
    v_mad_u32_u24 v65, v65, s10, v63
    buffer_load_dwordx4 v65, s[60:63], s4 offen offset:3072 lds
    s_add_u32 s4, s4, 81920
    s_cmp_eq_u32 s4, 819200
    s_cselect_b32 s4, 0, s4
    s_mov_b32 m0, 63616
    v_bfe_u32 v64, s7, v52, 2
    v_mad_u32_u24 v64, v64, s10, v60
    buffer_load_dwordx4 v64, s[60:63], s4 offen lds
    v_bfe_u32 v65, s7, v53, 2
    v_mad_u32_u24 v65, v65, s10, v61
    buffer_load_dwordx4 v65, s[60:63], s4 offen offset:1024 lds
    v_bfe_u32 v64, s7, v54, 2
    v_mad_u32_u24 v64, v64, s10, v62
    buffer_load_dwordx4 v64, s[60:63], s4 offen offset:2048 lds
    v_bfe_u32 v65, s7, v55, 2
    v_mad_u32_u24 v65, v65, s10, v63
    buffer_load_dwordx4 v65, s[60:63], s4 offen offset:3072 lds
    s_mov_b32 m0, 67712
    v_bfe_u32 v64, s7, v56, 2
    v_mad_u32_u24 v64, v64, s10, v60
    buffer_load_dwordx4 v64, s[60:63], s4 offen lds
    v_bfe_u32 v65, s7, v57, 2
    v_mad_u32_u24 v65, v65, s10, v61
    buffer_load_dwordx4 v65, s[60:63], s4 offen offset:1024 lds
    v_bfe_u32 v64, s7, v58, 2
    v_mad_u32_u24 v64, v64, s10, v62
    buffer_load_dwordx4 v64, s[60:63], s4 offen offset:2048 lds
    v_bfe_u32 v65, s7, v59, 2
    v_mad_u32_u24 v65, v65, s10, v63
    buffer_load_dwordx4 v65, s[60:63], s4 offen offset:3072 lds
    s_add_u32 s4, s4, 81920
    s_cmp_eq_u32 s4, 819200
    s_cselect_b32 s4, 0, s4
    s_mov_b32 m0, 71808
    v_bfe_u32 v64, s8, v52, 2
    v_mad_u32_u24 v64, v64, s10, v60
    buffer_load_dwordx4 v64, s[60:63], s4 offen lds
    v_bfe_u32 v65, s8, v53, 2
    v_mad_u32_u24 v65, v65, s10, v61
    buffer_load_dwordx4 v65, s[60:63], s4 offen offset:1024 lds
    v_bfe_u32 v64, s8, v54, 2
    v_mad_u32_u24 v64, v64, s10, v62
    buffer_load_dwordx4 v64, s[60:63], s4 offen offset:2048 lds
    v_bfe_u32 v65, s8, v55, 2
    v_mad_u32_u24 v65, v65, s10, v63
    buffer_load_dwordx4 v65, s[60:63], s4 offen offset:3072 lds
    s_mov_b32 m0, 75904
    v_bfe_u32 v64, s8, v56, 2
    v_mad_u32_u24 v64, v64, s10, v60
    buffer_load_dwordx4 v64, s[60:63], s4 offen lds
    v_bfe_u32 v65, s8, v57, 2
    v_mad_u32_u24 v65, v65, s10, v61
    buffer_load_dwordx4 v65, s[60:63], s4 offen offset:1024 lds
    v_bfe_u32 v64, s8, v58, 2
    v_mad_u32_u24 v64, v64, s10, v62
    buffer_load_dwordx4 v64, s[60:63], s4 offen offset:2048 lds
    v_bfe_u32 v65, s8, v59, 2
    v_mad_u32_u24 v65, v65, s10, v63
    buffer_load_dwordx4 v65, s[60:63], s4 offen offset:3072 lds
    s_add_u32 s4, s4, 81920
    s_cmp_eq_u32 s4, 819200
    s_cselect_b32 s4, 0, s4
    s_mov_b32 m0, 49152
    v_bfe_u32 v64, s9, v52, 2
    v_mad_u32_u24 v64, v64, s10, v60
    buffer_load_dwordx4 v64, s[60:63], s4 offen lds
    v_bfe_u32 v65, s9, v53, 2
    v_mad_u32_u24 v65, v65, s10, v61
    buffer_load_dwordx4 v65, s[60:63], s4 offen offset:1024 lds
    v_bfe_u32 v64, s9, v54, 2
    v_mad_u32_u24 v64, v64, s10, v62
    buffer_load_dwordx4 v64, s[60:63], s4 offen offset:2048 lds
    v_bfe_u32 v65, s9, v55, 2
    v_mad_u32_u24 v65, v65, s10, v63
    buffer_load_dwordx4 v65, s[60:63], s4 offen offset:3072 lds
    s_mov_b32 m0, 88192
    v_bfe_u32 v64, s9, v56, 2
    v_mad_u32_u24 v64, v64, s10, v60
    buffer_load_dwordx4 v64, s[60:63], s4 offen lds
    v_bfe_u32 v65, s9, v57, 2
    v_mad_u32_u24 v65, v65, s10, v61
    buffer_load_dwordx4 v65, s[60:63], s4 offen offset:1024 lds
    v_bfe_u32 v64, s9, v58, 2
    v_mad_u32_u24 v64, v64, s10, v62
    buffer_load_dwordx4 v64, s[60:63], s4 offen offset:2048 lds
    v_bfe_u32 v65, s9, v59, 2
    v_mad_u32_u24 v65, v65, s10, v63
    buffer_load_dwordx4 v65, s[60:63], s4 offen offset:3072 lds
    s_add_u32 s4, s4, 81920
    s_cmp_eq_u32 s4, 819200
    s_cselect_b32 s4, 0, s4
    s_waitcnt vmcnt(0)
Lbc:
    v_readfirstlane_b32 s11, v70
    v_readfirstlane_b32 s36, v71
    v_readfirstlane_b32 s12, v72
    v_readfirstlane_b32 s37, v73
    s_cmp_eq_u32 s36, s34
    s_cselect_b32 s37, s37, s36
    s_cmp_eq_u32 s37, s34
    s_cbranch_scc1 Lbc_ok
Lbc_re:
    s_sub_u32 s35, s35, 1
    s_cbranch_scc1 Lend
    buffer_load_dwordx4 v[70:73], v69, s[28:31], 0 offen sc1
    s_waitcnt vmcnt(0)
    s_branch Lbc
Lbc_ok:
    s_mul_i32 s36, s32, 96
    s_and_b32 s13, s11, 0x7ff
    s_sub_u32 s13, 2047, s13
    s_sub_u32 s37, s13, s36
    s_cmp_lt_u32 s37, 96
    s_cselect_b32 s13, s13, -1
    s_and_b32 s14, s12, 0x7ff
    s_sub_u32 s14, 2047, s14
    s_sub_u32 s37, s14, s36
    s_cmp_lt_u32 s37, 96
    s_cselect_b32 s14, s14, -1
    v_mov_b32 v4, s13
    v_mov_b32 v5, s14
    v_mov_b32 v6, 157960
    ds_write_b64 v6, v[4:5]
    s_and_b32 s37, s13, s14
    s_cmp_eq_u32 s37, -1
    s_cbranch_scc1 Lw0_done
    s_max_i32 s36, s13, 0
    s_mul_i32 s36, s36, 1280
    s_lshl_b32 s37, s33, 7
    s_add_u32 s36, s36, s37
    s_add_u32 s36, s36, 4096
    v_lshlrev_b32 v8, 1, v1
    buffer_load_ushort v124, v8, s[44:47], s36 offen
    s_max_i32 s36, s14, 0
    s_mul_i32 s36, s36, 1280
    s_lshl_b32 s37, s33, 7
    s_add_u32 s36, s36, s37
    s_add_u32 s36, s36, 4096
    v_lshlrev_b32 v8, 1, v1
    buffer_load_ushort v125, v8, s[44:47], s36 offen
    v_min_u32 v7, 26, v1
    v_mul_u32_u24 v7, 10240, v7
Ly_poll:
    s_sub_u32 s35, s35, 1
    s_cbranch_scc1 Lend
    s_sleep 4
    s_lshl_b32 s36, s33, 10
    s_add_u32 s36, s36, 7405568
    buffer_load_dword v4, v7, s[28:31], s36 offen offset:1020 sc1
    s_waitcnt vmcnt(0)
    v_cmp_ne_u32 vcc, s34, v4
    s_nop 0
    s_cbranch_vccnz Ly_poll
    buffer_load_dwordx4 v[16:19], v13, s[28:31], s36 offen sc1
    s_add_u32 s36, s36, 10240
    buffer_load_dwordx4 v[20:23], v13, s[28:31], s36 offen sc1
    s_add_u32 s36, s36, 10240
    buffer_load_dwordx4 v[24:27], v13, s[28:31], s36 offen sc1
    s_add_u32 s36, s36, 10240
    buffer_load_dwordx4 v[28:31], v13, s[28:31], s36 offen sc1
    s_add_u32 s36, s36, 10240
    buffer_load_dwordx4 v[32:35], v13, s[28:31], s36 offen sc1
    s_add_u32 s36, s36, 10240
    buffer_load_dwordx4 v[36:39], v13, s[28:31], s36 offen sc1
    s_add_u32 s36, s36, 10240
    buffer_load_dwordx4 v[40:43], v13, s[28:31], s36 offen sc1
    s_add_u32 s36, s36, 10240
    buffer_load_dwordx4 v[44:47], v13, s[28:31], s36 offen sc1
    s_add_u32 s36, s36, 10240
    buffer_load_dwordx4 v[48:51], v13, s[28:31], s36 offen sc1
    s_add_u32 s36, s36, 10240
    buffer_load_dwordx4 v[52:55], v13, s[28:31], s36 offen sc1
    s_add_u32 s36, s36, 10240
    buffer_load_dwordx4 v[56:59], v13, s[28:31], s36 offen sc1
    s_add_u32 s36, s36, 10240
    buffer_load_dwordx4 v[60:63], v13, s[28:31], s36 offen sc1
    s_add_u32 s36, s36, 10240
    buffer_load_dwordx4 v[64:67], v13, s[28:31], s36 offen sc1
    s_add_u32 s36, s36, 10240
    buffer_load_dwordx4 v[68:71], v13, s[28:31], s36 offen sc1
    s_add_u32 s36, s36, 10240
    buffer_load_dwordx4 v[72:75], v13, s[28:31], s36 offen sc1
    s_add_u32 s36, s36, 10240
    buffer_load_dwordx4 v[76:79], v13, s[28:31], s36 offen sc1
    s_add_u32 s36, s36, 10240
    buffer_load_dwordx4 v[80:83], v13, s[28:31], s36 offen sc1
    s_add_u32 s36, s36, 10240
    buffer_load_dwordx4 v[84:87], v13, s[28:31], s36 offen sc1
    s_add_u32 s36, s36, 10240
    buffer_load_dwordx4 v[88:91], v13, s[28:31], s36 offen sc1
    s_add_u32 s36, s36, 10240
    buffer_load_dwordx4 v[92:95], v13, s[28:31], s36 offen sc1
    s_add_u32 s36, s36, 10240
    buffer_load_dwordx4 v[96:99], v13, s[28:31], s36 offen sc1
    s_add_u32 s36, s36, 10240
    buffer_load_dwordx4 v[100:103], v13, s[28:31], s36 offen sc1
    s_add_u32 s36, s36, 10240
    buffer_load_dwordx4 v[104:107], v13, s[28:31], s36 offen sc1
    s_add_u32 s36, s36, 10240
    buffer_load_dwordx4 v[108:111], v13, s[28:31], s36 offen sc1
    s_add_u32 s36, s36, 10240
    buffer_load_dwordx4 v[112:115], v13, s[28:31], s36 offen sc1
    s_add_u32 s36, s36, 10240
    buffer_load_dwordx4 v[116:119], v13, s[28:31], s36 offen sc1
    s_add_u32 s36, s36, 10240
    buffer_load_dwordx4 v[120:123], v13, s[28:31], s36 offen sc1
    s_add_u32 s36, s36, 10240
    s_waitcnt vmcnt(0)
    v_xor_b32 v4, s34, v17
    v_xor_b32 v5, s34, v19
    v_or_b32 v4, v4, v5
    v_xor_b32 v5, s34, v21
    v_or_b32 v4, v4, v5
    v_xor_b32 v5, s34, v23
    v_or_b32 v4, v4, v5
    v_xor_b32 v5, s34, v25
    v_or_b32 v4, v4, v5
    v_xor_b32 v5, s34, v27
    v_or_b32 v4, v4, v5
    v_xor_b32 v5, s34, v29
    v_or_b32 v4, v4, v5
    v_xor_b32 v5, s34, v31
    v_or_b32 v4, v4, v5
    v_xor_b32 v5, s34, v33
    v_or_b32 v4, v4, v5
    v_xor_b32 v5, s34, v35
    v_or_b32 v4, v4, v5
    v_xor_b32 v5, s34, v37
    v_or_b32 v4, v4, v5
    v_xor_b32 v5, s34, v39
    v_or_b32 v4, v4, v5
    v_xor_b32 v5, s34, v41
    v_or_b32 v4, v4, v5
    v_xor_b32 v5, s34, v43
    v_or_b32 v4, v4, v5
    v_xor_b32 v5, s34, v45
    v_or_b32 v4, v4, v5
    v_xor_b32 v5, s34, v47
    v_or_b32 v4, v4, v5
    v_xor_b32 v5, s34, v49
    v_or_b32 v4, v4, v5
    v_xor_b32 v5, s34, v51
    v_or_b32 v4, v4, v5
    v_xor_b32 v5, s34, v53
    v_or_b32 v4, v4, v5
    v_xor_b32 v5, s34, v55
    v_or_b32 v4, v4, v5
    v_xor_b32 v5, s34, v57
    v_or_b32 v4, v4, v5
    v_xor_b32 v5, s34, v59
    v_or_b32 v4, v4, v5
    v_xor_b32 v5, s34, v61
    v_or_b32 v4, v4, v5
    v_xor_b32 v5, s34, v63
    v_or_b32 v4, v4, v5
    v_xor_b32 v5, s34, v65
    v_or_b32 v4, v4, v5
    v_xor_b32 v5, s34, v67
    v_or_b32 v4, v4, v5
    v_xor_b32 v5, s34, v69
    v_or_b32 v4, v4, v5
    v_xor_b32 v5, s34, v71
    v_or_b32 v4, v4, v5
    v_xor_b32 v5, s34, v73
    v_or_b32 v4, v4, v5
    v_xor_b32 v5, s34, v75
    v_or_b32 v4, v4, v5
    v_xor_b32 v5, s34, v77
    v_or_b32 v4, v4, v5
    v_xor_b32 v5, s34, v79
    v_or_b32 v4, v4, v5
    v_xor_b32 v5, s34, v81
    v_or_b32 v4, v4, v5
    v_xor_b32 v5, s34, v83
    v_or_b32 v4, v4, v5
    v_xor_b32 v5, s34, v85
    v_or_b32 v4, v4, v5
    v_xor_b32 v5, s34, v87
    v_or_b32 v4, v4, v5
    v_xor_b32 v5, s34, v89
    v_or_b32 v4, v4, v5
    v_xor_b32 v5, s34, v91
    v_or_b32 v4, v4, v5
    v_xor_b32 v5, s34, v93
    v_or_b32 v4, v4, v5
    v_xor_b32 v5, s34, v95
    v_or_b32 v4, v4, v5
    v_xor_b32 v5, s34, v97
    v_or_b32 v4, v4, v5
    v_xor_b32 v5, s34, v99
    v_or_b32 v4, v4, v5
    v_xor_b32 v5, s34, v101
    v_or_b32 v4, v4, v5
    v_xor_b32 v5, s34, v103
    v_or_b32 v4, v4, v5
    v_xor_b32 v5, s34, v105
    v_or_b32 v4, v4, v5
    v_xor_b32 v5, s34, v107
    v_or_b32 v4, v4, v5
    v_xor_b32 v5, s34, v109
    v_or_b32 v4, v4, v5
    v_xor_b32 v5, s34, v111
    v_or_b32 v4, v4, v5
    v_xor_b32 v5, s34, v113
    v_or_b32 v4, v4, v5
    v_xor_b32 v5, s34, v115
    v_or_b32 v4, v4, v5
    v_xor_b32 v5, s34, v117
    v_or_b32 v4, v4, v5
    v_xor_b32 v5, s34, v119
    v_or_b32 v4, v4, v5
    v_xor_b32 v5, s34, v121
    v_or_b32 v4, v4, v5
    v_xor_b32 v5, s34, v123
    v_or_b32 v4, v4, v5
    v_cmp_ne_u32 vcc, 0, v4
    s_nop 0
    s_cmp_lg_u64 vcc, 0
    s_cbranch_scc1 Ly_poll
    v_add_f32 v16, v16, v20
    v_add_f32 v18, v18, v22
    v_add_f32 v16, v16, v24
    v_add_f32 v18, v18, v26
    v_add_f32 v16, v16, v28
    v_add_f32 v18, v18, v30
    v_add_f32 v16, v16, v32
    v_add_f32 v18, v18, v34
    v_add_f32 v16, v16, v36
    v_add_f32 v18, v18, v38
    v_add_f32 v16, v16, v40
    v_add_f32 v18, v18, v42
    v_add_f32 v16, v16, v44
    v_add_f32 v18, v18, v46
    v_add_f32 v16, v16, v48
    v_add_f32 v18, v18, v50
    v_add_f32 v16, v16, v52
    v_add_f32 v18, v18, v54
    v_add_f32 v16, v16, v56
    v_add_f32 v18, v18, v58
    v_add_f32 v16, v16, v60
    v_add_f32 v18, v18, v62
    v_add_f32 v16, v16, v64
    v_add_f32 v18, v18, v66
    v_add_f32 v16, v16, v68
    v_add_f32 v18, v18, v70
    v_add_f32 v16, v16, v72
    v_add_f32 v18, v18, v74
    v_add_f32 v16, v16, v76
    v_add_f32 v18, v18, v78
    v_add_f32 v16, v16, v80
    v_add_f32 v18, v18, v82
    v_add_f32 v16, v16, v84
    v_add_f32 v18, v18, v86
    v_add_f32 v16, v16, v88
    v_add_f32 v18, v18, v90
    v_add_f32 v16, v16, v92
    v_add_f32 v18, v18, v94
    v_add_f32 v16, v16, v96
    v_add_f32 v18, v18, v98
    v_add_f32 v16, v16, v100
    v_add_f32 v18, v18, v102
    v_add_f32 v16, v16, v104
    v_add_f32 v18, v18, v106
    v_add_f32 v16, v16, v108
    v_add_f32 v18, v18, v110
    v_add_f32 v16, v16, v112
    v_add_f32 v18, v18, v114
    v_add_f32 v16, v16, v116
    v_add_f32 v18, v18, v118
    v_add_f32 v16, v16, v120
    v_add_f32 v18, v18, v122
    s_lshr_b32 s36, s11, 16
    s_cmp_ge_u32 s36, 0x8000
    s_cselect_b32 s37, 0x8000, -1
    s_xor_b32 s36, s36, s37
    s_lshl_b32 s36, s36, 16
    v_mov_b32 v4, s36
    v_mul_f32 v4, 0xbfb8aa3b, v4
    v_exp_f32 v4, v4
    s_nop 0
    v_add_f32 v4, 1.0, v4
    v_rcp_f32 v4, v4
    s_nop 0
    v_cvt_pk_bf16_f32 v4, v4, v4
    v_lshlrev_b32 v4, 16, v4
    v_cvt_pk_bf16_f32 v16, v16, v16
    v_lshlrev_b32 v16, 16, v16
    v_mul_f32 v16, v16, v4
    v_cvt_pk_bf16_f32 v16, v16, v16
    v_lshlrev_b32 v16, 16, v16
    s_lshr_b32 s36, s12, 16
    s_cmp_ge_u32 s36, 0x8000
    s_cselect_b32 s37, 0x8000, -1
    s_xor_b32 s36, s36, s37
    s_lshl_b32 s36, s36, 16
    v_mov_b32 v4, s36
    v_mul_f32 v4, 0xbfb8aa3b, v4
    v_exp_f32 v4, v4
    s_nop 0
    v_add_f32 v4, 1.0, v4
    v_rcp_f32 v4, v4
    s_nop 0
    v_cvt_pk_bf16_f32 v4, v4, v4
    v_lshlrev_b32 v4, 16, v4
    v_cvt_pk_bf16_f32 v18, v18, v18
    v_lshlrev_b32 v18, 16, v18
    v_mul_f32 v18, v18, v4
    v_cvt_pk_bf16_f32 v18, v18, v18
    v_lshlrev_b32 v18, 16, v18
    s_mul_i32 s36, s32, 96
    s_sub_u32 s36, s13, s36
    s_max_i32 s36, s36, 0
    s_lshl_b32 s36, s36, 2
    s_add_u32 s36, s36, 156288
    v_mov_b32 v4, s36
    ds_read2st64_b32 v[4:5], v4 offset0:0 offset1:2
    v_lshlrev_b32 v124, 16, v124
    s_waitcnt lgkmcnt(0)
    v_add_f32 v20, v124, v4
    v_cvt_pk_bf16_f32 v20, v20, v20
    v_lshlrev_b32 v20, 16, v20
    v_mul_f32 v20, v20, v5
    v_cvt_pk_bf16_f32 v20, v20, v20
    v_lshlrev_b32 v20, 16, v20
    v_add_f32 v20, v20, v16
    v_cvt_pk_bf16_f32 v20, v20, v20
    v_lshlrev_b32 v20, 16, v20
    v_mul_f32 v16, 0xbfb8aa3b, v20
    v_exp_f32 v16, v16
    s_nop 0
    v_add_f32 v16, 1.0, v16
    v_rcp_f32 v16, v16
    s_nop 0
    v_mul_f32 v16, v16, v20
    v_cvt_pk_bf16_f32 v16, v16, v16
    v_lshlrev_b32 v16, 16, v16
    s_mul_i32 s36, s32, 96
    s_sub_u32 s36, s14, s36
    s_max_i32 s36, s36, 0
    s_lshl_b32 s36, s36, 2
    s_add_u32 s36, s36, 156288
    v_mov_b32 v4, s36
    ds_read2st64_b32 v[4:5], v4 offset0:0 offset1:2
    v_lshlrev_b32 v125, 16, v125
    s_waitcnt lgkmcnt(0)
    v_add_f32 v22, v125, v4
    v_cvt_pk_bf16_f32 v22, v22, v22
    v_lshlrev_b32 v22, 16, v22
    v_mul_f32 v22, v22, v5
    v_cvt_pk_bf16_f32 v22, v22, v22
    v_lshlrev_b32 v22, 16, v22
    v_add_f32 v22, v22, v18
    v_cvt_pk_bf16_f32 v22, v22, v22
    v_lshlrev_b32 v22, 16, v22
    v_mul_f32 v18, 0xbfb8aa3b, v22
    v_exp_f32 v18, v18
    s_nop 0
    v_add_f32 v18, 1.0, v18
    v_rcp_f32 v18, v18
    s_nop 0
    v_mul_f32 v18, v18, v22
    v_cvt_pk_bf16_f32 v18, v18, v18
    v_lshlrev_b32 v18, 16, v18
    v_add_u32 v5, 158208, v12
    ds_write2st64_b32 v5, v16, v18 offset0:0 offset1:1
    v_mov_b32 v6, 157956
    v_mov_b32 v7, 1
    s_mov_b64 exec, 1
    ds_add_u32 v6, v7
    s_mov_b64 exec, -1
Lw0_done:
    s_endpgm
Lcomp:
    s_lshl_b32 s44, s26, 1
    s_add_u32 s44, s44, s27
    s_sub_u32 s36, s33, 5
    s_cmp_ge_u32 s33, 5
    s_cselect_b32 s40, s36, s33
    s_mov_b32 s41, 0xbfe10856
    s_cmp_eq_u32 s40, 1
    s_cselect_b32 s41, 0xaff80255, s41
    s_cmp_eq_u32 s40, 2
    s_cselect_b32 s41, 0xabfe4015, s41
    s_cmp_eq_u32 s40, 3
    s_cselect_b32 s41, 0xaa7fd005, s41
    s_cmp_eq_u32 s40, 4
    s_cselect_b32 s41, 0x6adfb401, s41
    s_lshl_b32 s37, s27, 13
    s_cmp_eq_u32 s44, 1
    s_cselect_b32 s37, 0, s37
    v_bfe_u32 v7, v1, 2, 2
    v_and_b32 v8, 3, v1
    v_lshl_add_u32 v18, v2, 3, v7
    v_lshlrev_b32 v18, 7, v18
    v_lshlrev_b32 v19, 2, v1
    v_and_b32 v19, 0x60, v19
    v_lshlrev_b32 v10, 1, v8
    v_add_u32 v9, s37, v18
    v_add_u32 v11, 0, v10
    v_bfe_u32 v11, s41, v11, 2
    v_lshl_add_u32 v11, v11, 2, v8
    v_lshlrev_b32 v11, 3, v11
    v_xad_u32 v20, v11, v19, v9
    v_add_u32 v11, 8, v10
    v_bfe_u32 v11, s41, v11, 2
    v_lshl_add_u32 v11, v11, 2, v8
    v_lshlrev_b32 v11, 3, v11
    v_xad_u32 v21, v11, v19, v9
    v_add_u32 v11, 16, v10
    v_bfe_u32 v11, s41, v11, 2
    v_lshl_add_u32 v11, v11, 2, v8
    v_lshlrev_b32 v11, 3, v11
    v_xad_u32 v22, v11, v19, v9
    v_add_u32 v11, 24, v10
    v_bfe_u32 v11, s41, v11, 2
    v_lshl_add_u32 v11, v11, 2, v8
    v_lshlrev_b32 v11, 3, v11
    v_xad_u32 v23, v11, v19, v9
    v_add_u32 v24, 78080, v20
    v_add_u32 v25, 78080, v21
    v_add_u32 v26, 78080, v22
    v_add_u32 v27, 78080, v23
    v_lshrrev_b32 v10, 1, v3
    v_xor_b32 v9, v10, v2
    v_lshlrev_b32 v9, 4, v9
    v_lshl_add_u32 v9, v3, 7, v9
    s_lshl_b32 s36, s44, 11
    s_xor_b32 s38, s36, 2048
    s_add_u32 s36, s36, 22528
    s_add_u32 s38, s38, 22528
    v_add_u32 v76, s36, v9
    v_add_u32 v78, s38, v9
    s_mul_i32 s39, s26, 6144
    s_add_u32 s39, s39, 98560
    v_add_u32 v125, s39, v13
    s_lshl_b32 s45, s44, 11
    s_add_u32 s45, s45, 139648
    s_waitcnt lgkmcnt(0)
    s_mov_b64 s[28:29], s[24:25]
    s_mov_b32 s30, 268435456
    s_mov_b32 s31, 0x20000
    s_load_dword s34, s[28:29], 0
    s_cmp_eq_u32 s44, 1
    s_cbranch_scc1 Lhalo
    v_xor_b32 v77, 64, v76
    v_xor_b32 v79, 64, v78
    v_add_u32 v80, 78080, v76
    v_add_u32 v81, 78080, v77
    v_add_u32 v82, 78080, v78
    v_add_u32 v83, 78080, v79
    s_cmp_eq_u32 s27, 0
    s_cselect_b64 vcc, 0, -1
    s_sub_u32 s37, 16384, s37
    v_cndmask_b32 v84, v20, v22, vcc
    v_cndmask_b32 v85, v21, v23, vcc
    v_add_u32 v84, s37, v84
    v_add_u32 v85, s37, v85
    v_add_u32 v86, 78080, v84
    v_add_u32 v87, 78080, v85
    v_lshrrev_b32 v8, 1, v2
    v_xor_b32 v8, v8, v10
    v_lshlrev_b32 v8, 4, v8
    v_lshl_add_u32 v8, v3, 7, v8
    v_and_b32 v7, 1, v2
    v_lshl_add_u32 v124, v7, 3, v8
    s_lshl_b32 s46, s42, 12
    s_mov_b32 s38, 0x87652310
    s_mov_b32 s39, 0x94
    s_cmp_eq_u32 s42, 1
    s_cselect_b32 s38, 0x87625310, s38
    s_cselect_b32 s39, 0x49, s39
    s_cmp_eq_u32 s42, 2
    s_cselect_b32 s38, 0x73654102, s38
    s_cselect_b32 s39, 0x98, s39
    s_cmp_eq_u32 s42, 3
    s_cselect_b32 s38, 0x76254301, s38
    s_cselect_b32 s39, 0x98, s39
    s_cmp_eq_u32 s42, 4
    s_cselect_b32 s38, 0x37546021, s38
    s_cselect_b32 s39, 0x98, s39
    s_sub_u32 s42, s33, s43
    s_cselect_b32 s43, 10, 0
    s_add_u32 s42, s42, s43
    s_lshl_b32 s42, s42, 2
    s_lshr_b64 s[38:39], s[38:39], s42
    s_and_b32 s42, s38, 15
    s_and_b32 s38, s42, 3
    s_mul_i32 s38, s38, 39040
    s_add_u32 s38, s38, s36
    v_add_u32 v4, s38, v124
    v_xor_b32 v5, 32, v4
    v_xor_b32 v6, 64, v4
    v_xor_b32 v7, 0x60, v4
    s_mov_b64 s[48:49], s[20:21]
    s_mov_b32 s50, 2621440
    s_mov_b32 s51, 0x20000
    v_mov_b32 v14, 0x3f803f80
    v_mov_b32 v15, 0x3f803f80
    v_mov_b32 v16, 0x3f803f80
    v_mov_b32 v17, 0x3f803f80
    s_mov_b32 s4, 0xaae00455
    s_cmp_eq_u32 s40, 1
    s_cselect_b32 s4, 0xaaf80155, s4
    s_cmp_eq_u32 s40, 2
    s_cselect_b32 s4, 0xaafe4055, s4
    s_cmp_eq_u32 s40, 3
    s_cselect_b32 s4, 0xaabfd055, s4
    s_cmp_eq_u32 s40, 4
    s_cselect_b32 s4, 0xaaeff455, s4
    v_lshlrev_b32 v10, 1, v2
    v_add_u32 v10, 8, v10
    v_bfe_u32 v10, s4, v10, 2
    v_cmp_eq_u32 s[6:7], 0, v10
    v_cmp_eq_u32 s[8:9], 3, v10
    v_cmp_eq_u32 s[10:11], 1, v10
    v_lshlrev_b32 v10, 1, v2
    v_add_u32 v10, 16, v10
    v_bfe_u32 v10, s4, v10, 2
    v_cmp_eq_u32 s[12:13], 0, v10
    v_cmp_eq_u32 s[14:15], 3, v10
    v_cmp_eq_u32 s[16:17], 2, v10
    s_mov_b32 s4, 0xaaaaaaaa
    s_mov_b32 s5, 0xaaaaaaaa
    s_mov_b32 s18, 0xfff0ffff
    s_mov_b32 s19, 0xf000ff00
    s_mov_b32 s20, 0xffc0fffc
    s_mov_b32 s21, 0xc000fc00
    v_mov_b32 v8, 0xffff
    v_not_b32 v9, v8
    v_cndmask_b32 v8, v8, v9, s[4:5]
    v_cndmask_b32 v118, 0, v8, s[18:19]
    v_cndmask_b32 v119, 0, v8, s[20:21]
    v_xor_b32 v116, v118, v8
    v_xor_b32 v117, v119, v8
    s_cmp_eq_u32 s32, 0
    s_cselect_b32 s36, s44, 0
    s_cmp_eq_u32 s36, 2
    s_cselect_b32 s22, 0xff800000, 0
    s_mul_i32 s36, s32, 6
    s_add_u32 s36, s36, s44
    s_sub_u32 s36, s36, 2
    s_lshl_b32 s24, s36, 7
    s_add_u32 s24, s24, 7340032
    s_mul_i32 s52, s36, 20480
    s_add_u32 s52, s52, 4194304
    s_lshl_b32 s36, s33, 11
    s_add_u32 s23, s36, s52
    s_add_u32 s53, s52, s46
    s_add_u32 s46, s46, 4096
    s_cmp_eq_u32 s46, 20480
    s_cselect_b32 s46, 0, s46
    s_add_u32 s54, s52, s46
    s_add_u32 s46, s46, 4096
    s_cmp_eq_u32 s46, 20480
    s_cselect_b32 s46, 0, s46
    s_add_u32 s55, s52, s46
    s_add_u32 s46, s46, 4096
    s_cmp_eq_u32 s46, 20480
    s_cselect_b32 s46, 0, s46
    s_add_u32 s56, s52, s46
    s_add_u32 s46, s46, 4096
    s_cmp_eq_u32 s46, 20480
    s_cselect_b32 s46, 0, s46
    s_add_u32 s57, s52, s46
    s_add_u32 s46, s46, 4096
    s_cmp_eq_u32 s46, 20480
    s_cselect_b32 s46, 0, s46
    s_mul_i32 s36, s32, 10
    s_add_u32 s36, s36, s33
    s_mul_i32 s58, s36, 6144
    s_lshl_b32 s36, s44, 10
    s_add_u32 s58, s58, s36
    s_add_u32 s58, s58, 1046528
    s_sub_u32 s59, s58, 6144
    s_add_u32 s60, s58, 6144
    s_cmp_eq_u32 s40, 0
    s_cselect_b32 s61, 0, -1
    s_cmp_eq_u32 s40, 4
    s_cselect_b32 s62, 0, -1
    s_lshl_b32 s36, s33, 2
    v_mov_b32 v97, s36
    s_mov_b32 s25, 0x3ea52b5c
    s_lshl_b32 s36, s44, 6
    s_add_u32 s36, s36, 156160
    v_lshl_add_u32 v94, v3, 2, s36
    v_and_b32 v8, 1, v1
    v_lshl_add_u32 v8, v2, 2, v8
    v_lshl_add_u32 v8, v8, 2, s36
    v_subrev_u32 v9, 64, v8
    v_cndmask_b32 v92, v9, v8, s[18:19]
    v_cndmask_b32 v93, v9, v8, s[20:21]
    v_lshlrev_b32 v95, 4, v2
    s_lshl_b32 s36, s27, 8
    s_add_u32 s36, s36, 157184
    v_add_u32 v95, s36, v95
    v_mov_b32 v96, 157968
    v_mov_b32 v100, -1
    v_mov_b32 v101, -1
    v_mov_b32 v102, -1
    v_mov_b32 v103, -1
    v_mov_b32 v127, 157984
    s_lshl_b32 s36, s3, 2
    s_add_u32 s36, s36, 158016
    v_mov_b32 v10, s36
    v_xor_b32 v11, 16, v10
    v_cndmask_b32 v127, v127, v11, s[4:5]
    s_waitcnt vmcnt(0)
    s_waitcnt lgkmcnt(0)
    s_barrier
    ds_read_b128 a[64:67], v76 offset:0
    ds_read_b128 a[68:71], v78 offset:0
    ds_read_b64_tr_b16 a[80:81], v20 offset:0
    ds_read_b64_tr_b16 a[82:83], v20 offset:512
    ds_read_b64_tr_b16 a[84:85], v21 offset:0
    ds_read_b64_tr_b16 a[86:87], v21 offset:512
    ds_read_b64_tr_b16 a[88:89], v22 offset:0
    ds_read_b64_tr_b16 a[90:91], v22 offset:512
    ds_read_b64_tr_b16 a[92:93], v23 offset:0
    ds_read_b64_tr_b16 a[94:95], v23 offset:512
    ds_read_b64_tr_b16 a[96:97], v84 offset:0
    ds_read_b64_tr_b16 a[98:99], v84 offset:512
    ds_read_b64_tr_b16 a[100:101], v85 offset:0
    ds_read_b64_tr_b16 a[102:103], v85 offset:512
    s_add_u32 s34, s34, 0x9e3779b8
    s_or_b32 s34, s34, 1
    s_cmp_eq_u32 s42, 0
    s_cbranch_scc1 Lxe0
Lxe0_b:
    s_setprio 1
    s_waitcnt lgkmcnt(10)
    v_mfma_f32_16x16x32_bf16 v[28:31], a[80:83], a[64:67], 0
    ds_read_b128 a[72:75], v77 offset:0
    ds_read_b128 a[76:79], v79 offset:0
    v_mfma_f32_16x16x32_bf16 v[44:47], a[80:83], a[68:71], 0
    ds_read_b64_tr_b16 a[104:105], v20 offset:4096
    s_waitcnt lgkmcnt(11)
    v_mfma_f32_16x16x32_bf16 v[32:35], a[84:87], a[64:67], 0
    ds_read_b64_tr_b16 a[106:107], v20 offset:4608
    v_mfma_f32_16x16x32_bf16 v[48:51], a[84:87], a[68:71], 0
    ds_read_b64_tr_b16 a[108:109], v21 offset:4096
    s_waitcnt lgkmcnt(11)
    v_mfma_f32_16x16x32_bf16 v[36:39], a[88:91], a[64:67], 0
    ds_read_b64_tr_b16 a[110:111], v21 offset:4608
    ds_read_b64_tr_b16 a[112:113], v22 offset:4096
    v_mfma_f32_16x16x32_bf16 v[52:55], a[88:91], a[68:71], 0
    ds_read_b64_tr_b16 a[114:115], v22 offset:4608
    s_setprio 0
    s_waitcnt lgkmcnt(12)
    v_mfma_f32_16x16x32_bf16 v[40:43], a[92:95], a[64:67], 0
    ds_read_b64_tr_b16 a[116:117], v23 offset:4096
    v_mfma_f32_16x16x32_bf16 v[56:59], a[92:95], a[68:71], 0
    ds_read_b64_tr_b16 a[118:119], v23 offset:4608
    s_waitcnt lgkmcnt(12)
    v_mfma_f32_16x16x32_bf16 v[60:63], a[64:67], a[96:99], 0
    ds_read_b64_tr_b16 a[120:121], v84 offset:4096
    v_mfma_f32_16x16x32_bf16 v[68:71], a[68:71], a[96:99], 0
    ds_read_b64_tr_b16 a[122:123], v84 offset:4608
    s_waitcnt lgkmcnt(12)
    v_mfma_f32_16x16x32_bf16 v[64:67], a[64:67], a[100:103], 0
    ds_read_b64_tr_b16 a[124:125], v85 offset:4096
    v_mfma_f32_16x16x32_bf16 v[72:75], a[68:71], a[100:103], 0
    ds_read_b64_tr_b16 a[126:127], v85 offset:4608
    s_barrier
    s_setprio 3
    s_waitcnt lgkmcnt(10)
    v_mfma_f32_16x16x32_bf16 v[28:31], a[104:107], a[72:75], v[28:31]
    ds_read_b128 a[64:67], v76 offset:39040
    ds_read_b128 a[68:71], v78 offset:39040
    v_mfma_f32_16x16x32_bf16 v[44:47], a[104:107], a[76:79], v[44:47]
    ds_read_b64_tr_b16 a[80:81], v20 offset:39040
    s_waitcnt lgkmcnt(11)
    v_mfma_f32_16x16x32_bf16 v[32:35], a[108:111], a[72:75], v[32:35]
    ds_read_b64_tr_b16 a[82:83], v20 offset:39552
    v_mfma_f32_16x16x32_bf16 v[48:51], a[108:111], a[76:79], v[48:51]
    ds_read_b64_tr_b16 a[84:85], v21 offset:39040
    s_waitcnt lgkmcnt(11)
    v_mfma_f32_16x16x32_bf16 v[36:39], a[112:115], a[72:75], v[36:39]
    ds_read_b64_tr_b16 a[86:87], v21 offset:39552
    v_mfma_f32_16x16x32_bf16 v[52:55], a[112:115], a[76:79], v[52:55]
    ds_read_b64_tr_b16 a[88:89], v22 offset:39040
    s_setprio 2
    s_waitcnt lgkmcnt(11)
    v_mfma_f32_16x16x32_bf16 v[40:43], a[116:119], a[72:75], v[40:43]
    ds_read_b64_tr_b16 a[90:91], v22 offset:39552
    ds_read_b64_tr_b16 a[92:93], v23 offset:39040
    v_mfma_f32_16x16x32_bf16 v[56:59], a[116:119], a[76:79], v[56:59]
    ds_read_b64_tr_b16 a[94:95], v23 offset:39552
    s_waitcnt lgkmcnt(12)
    v_mfma_f32_16x16x32_bf16 v[60:63], a[72:75], a[120:123], v[60:63]
    ds_read_b64_tr_b16 a[96:97], v84 offset:39040
    v_mfma_f32_16x16x32_bf16 v[68:71], a[76:79], a[120:123], v[68:71]
    ds_read_b64_tr_b16 a[98:99], v84 offset:39552
    s_waitcnt lgkmcnt(12)
    v_mfma_f32_16x16x32_bf16 v[64:67], a[72:75], a[124:127], v[64:67]
    ds_read_b64_tr_b16 a[100:101], v85 offset:39040
    v_mfma_f32_16x16x32_bf16 v[72:75], a[76:79], a[124:127], v[72:75]
    ds_read_b64_tr_b16 a[102:103], v85 offset:39552
    s_cmp_eq_u32 s42, 1
    s_cbranch_scc1 Lxe1
Lxe1_b:
    s_setprio 1
    s_waitcnt lgkmcnt(10)
    v_mfma_f32_16x16x32_bf16 v[28:31], a[80:83], a[64:67], v[28:31]
    ds_read_b128 a[72:75], v77 offset:39040
    ds_read_b128 a[76:79], v79 offset:39040
    v_mfma_f32_16x16x32_bf16 v[44:47], a[80:83], a[68:71], v[44:47]
    ds_read_b64_tr_b16 a[104:105], v20 offset:43136
    s_waitcnt lgkmcnt(11)
    v_mfma_f32_16x16x32_bf16 v[32:35], a[84:87], a[64:67], v[32:35]
    ds_read_b64_tr_b16 a[106:107], v20 offset:43648
    v_mfma_f32_16x16x32_bf16 v[48:51], a[84:87], a[68:71], v[48:51]
    ds_read_b64_tr_b16 a[108:109], v21 offset:43136
    s_waitcnt lgkmcnt(11)
    v_mfma_f32_16x16x32_bf16 v[36:39], a[88:91], a[64:67], v[36:39]
    ds_read_b64_tr_b16 a[110:111], v21 offset:43648
    ds_read_b64_tr_b16 a[112:113], v22 offset:43136
    v_mfma_f32_16x16x32_bf16 v[52:55], a[88:91], a[68:71], v[52:55]
    ds_read_b64_tr_b16 a[114:115], v22 offset:43648
    s_setprio 0
    s_waitcnt lgkmcnt(12)
    v_mfma_f32_16x16x32_bf16 v[40:43], a[92:95], a[64:67], v[40:43]
    ds_read_b64_tr_b16 a[116:117], v23 offset:43136
    v_mfma_f32_16x16x32_bf16 v[56:59], a[92:95], a[68:71], v[56:59]
    ds_read_b64_tr_b16 a[118:119], v23 offset:43648
    s_waitcnt lgkmcnt(12)
    v_mfma_f32_16x16x32_bf16 v[60:63], a[64:67], a[96:99], v[60:63]
    ds_read_b64_tr_b16 a[120:121], v84 offset:43136
    v_mfma_f32_16x16x32_bf16 v[68:71], a[68:71], a[96:99], v[68:71]
    ds_read_b64_tr_b16 a[122:123], v84 offset:43648
    s_waitcnt lgkmcnt(12)
    v_mfma_f32_16x16x32_bf16 v[64:67], a[64:67], a[100:103], v[64:67]
    ds_read_b64_tr_b16 a[124:125], v85 offset:43136
    v_mfma_f32_16x16x32_bf16 v[72:75], a[68:71], a[100:103], v[72:75]
    ds_read_b64_tr_b16 a[126:127], v85 offset:43648
    s_barrier
    s_setprio 3
    s_waitcnt lgkmcnt(10)
    v_mfma_f32_16x16x32_bf16 v[28:31], a[104:107], a[72:75], v[28:31]
    ds_read_b128 a[64:67], v80 offset:0
    ds_read_b128 a[68:71], v82 offset:0
    v_mfma_f32_16x16x32_bf16 v[44:47], a[104:107], a[76:79], v[44:47]
    ds_read_b64_tr_b16 a[80:81], v24 offset:0
    s_waitcnt lgkmcnt(11)
    v_mfma_f32_16x16x32_bf16 v[32:35], a[108:111], a[72:75], v[32:35]
    ds_read_b64_tr_b16 a[82:83], v24 offset:512
    v_mfma_f32_16x16x32_bf16 v[48:51], a[108:111], a[76:79], v[48:51]
    ds_read_b64_tr_b16 a[84:85], v25 offset:0
    s_waitcnt lgkmcnt(11)
    v_mfma_f32_16x16x32_bf16 v[36:39], a[112:115], a[72:75], v[36:39]
    ds_read_b64_tr_b16 a[86:87], v25 offset:512
    v_mfma_f32_16x16x32_bf16 v[52:55], a[112:115], a[76:79], v[52:55]
    ds_read_b64_tr_b16 a[88:89], v26 offset:0
    s_setprio 2
    s_waitcnt lgkmcnt(11)
    v_mfma_f32_16x16x32_bf16 v[40:43], a[116:119], a[72:75], v[40:43]
    ds_read_b64_tr_b16 a[90:91], v26 offset:512
    ds_read_b64_tr_b16 a[92:93], v27 offset:0
    v_mfma_f32_16x16x32_bf16 v[56:59], a[116:119], a[76:79], v[56:59]
    ds_read_b64_tr_b16 a[94:95], v27 offset:512
    s_waitcnt lgkmcnt(12)
    v_mfma_f32_16x16x32_bf16 v[60:63], a[72:75], a[120:123], v[60:63]
    ds_read_b64_tr_b16 a[96:97], v86 offset:0
    v_mfma_f32_16x16x32_bf16 v[68:71], a[76:79], a[120:123], v[68:71]
    ds_read_b64_tr_b16 a[98:99], v86 offset:512
    s_waitcnt lgkmcnt(12)
    v_mfma_f32_16x16x32_bf16 v[64:67], a[72:75], a[124:127], v[64:67]
    ds_read_b64_tr_b16 a[100:101], v87 offset:0
    v_mfma_f32_16x16x32_bf16 v[72:75], a[76:79], a[124:127], v[72:75]
    ds_read_b64_tr_b16 a[102:103], v87 offset:512
    buffer_store_dwordx4 v[100:103], v13, s[28:31], s58 offen sc1
    s_cmp_eq_u32 s42, 2
    s_cbranch_scc1 Lxe2
Lxe2_b:
    s_setprio 1
    s_waitcnt lgkmcnt(10)
    v_mfma_f32_16x16x32_bf16 v[28:31], a[80:83], a[64:67], v[28:31]
    ds_read_b128 a[72:75], v81 offset:0
    ds_read_b128 a[76:79], v83 offset:0
    v_mfma_f32_16x16x32_bf16 v[44:47], a[80:83], a[68:71], v[44:47]
    ds_read_b64_tr_b16 a[104:105], v24 offset:4096
    s_waitcnt lgkmcnt(11)
    v_mfma_f32_16x16x32_bf16 v[32:35], a[84:87], a[64:67], v[32:35]
    ds_read_b64_tr_b16 a[106:107], v24 offset:4608
    v_mfma_f32_16x16x32_bf16 v[48:51], a[84:87], a[68:71], v[48:51]
    ds_read_b64_tr_b16 a[108:109], v25 offset:4096
    s_waitcnt lgkmcnt(11)
    v_mfma_f32_16x16x32_bf16 v[36:39], a[88:91], a[64:67], v[36:39]
    ds_read_b64_tr_b16 a[110:111], v25 offset:4608
    ds_read_b64_tr_b16 a[112:113], v26 offset:4096
    v_mfma_f32_16x16x32_bf16 v[52:55], a[88:91], a[68:71], v[52:55]
    ds_read_b64_tr_b16 a[114:115], v26 offset:4608
    s_setprio 0
    s_waitcnt lgkmcnt(12)
    v_mfma_f32_16x16x32_bf16 v[40:43], a[92:95], a[64:67], v[40:43]
    ds_read_b64_tr_b16 a[116:117], v27 offset:4096
    v_mfma_f32_16x16x32_bf16 v[56:59], a[92:95], a[68:71], v[56:59]
    ds_read_b64_tr_b16 a[118:119], v27 offset:4608
    s_waitcnt lgkmcnt(12)
    v_mfma_f32_16x16x32_bf16 v[60:63], a[64:67], a[96:99], v[60:63]
    ds_read_b64_tr_b16 a[120:121], v86 offset:4096
    v_mfma_f32_16x16x32_bf16 v[68:71], a[68:71], a[96:99], v[68:71]
    ds_read_b64_tr_b16 a[122:123], v86 offset:4608
    s_waitcnt lgkmcnt(12)
    v_mfma_f32_16x16x32_bf16 v[64:67], a[64:67], a[100:103], v[64:67]
    ds_read_b64_tr_b16 a[124:125], v87 offset:4096
    v_mfma_f32_16x16x32_bf16 v[72:75], a[68:71], a[100:103], v[72:75]
    ds_read_b64_tr_b16 a[126:127], v87 offset:4608
    s_barrier
    s_setprio 3
    s_waitcnt lgkmcnt(10)
    v_mfma_f32_16x16x32_bf16 v[28:31], a[104:107], a[72:75], v[28:31]
    ds_read_b128 a[64:67], v80 offset:39040
    ds_read_b128 a[68:71], v82 offset:39040
    v_mfma_f32_16x16x32_bf16 v[44:47], a[104:107], a[76:79], v[44:47]
    ds_read_b64_tr_b16 a[80:81], v24 offset:39040
    s_waitcnt lgkmcnt(11)
    v_mfma_f32_16x16x32_bf16 v[32:35], a[108:111], a[72:75], v[32:35]
    ds_read_b64_tr_b16 a[82:83], v24 offset:39552
    v_mfma_f32_16x16x32_bf16 v[48:51], a[108:111], a[76:79], v[48:51]
    ds_read_b64_tr_b16 a[84:85], v25 offset:39040
    s_waitcnt lgkmcnt(11)
    v_mfma_f32_16x16x32_bf16 v[36:39], a[112:115], a[72:75], v[36:39]
    ds_read_b64_tr_b16 a[86:87], v25 offset:39552
    v_mfma_f32_16x16x32_bf16 v[52:55], a[112:115], a[76:79], v[52:55]
    ds_read_b64_tr_b16 a[88:89], v26 offset:39040
    s_setprio 2
    s_waitcnt lgkmcnt(11)
    v_mfma_f32_16x16x32_bf16 v[40:43], a[116:119], a[72:75], v[40:43]
    ds_read_b64_tr_b16 a[90:91], v26 offset:39552
    ds_read_b64_tr_b16 a[92:93], v27 offset:39040
    v_mfma_f32_16x16x32_bf16 v[56:59], a[116:119], a[76:79], v[56:59]
    ds_read_b64_tr_b16 a[94:95], v27 offset:39552
    s_waitcnt lgkmcnt(12)
    v_mfma_f32_16x16x32_bf16 v[60:63], a[72:75], a[120:123], v[60:63]
    ds_read_b64_tr_b16 a[96:97], v86 offset:39040
    v_mfma_f32_16x16x32_bf16 v[68:71], a[76:79], a[120:123], v[68:71]
    ds_read_b64_tr_b16 a[98:99], v86 offset:39552
    s_waitcnt lgkmcnt(12)
    v_mfma_f32_16x16x32_bf16 v[64:67], a[72:75], a[124:127], v[64:67]
    ds_read_b64_tr_b16 a[100:101], v87 offset:39040
    v_mfma_f32_16x16x32_bf16 v[72:75], a[76:79], a[124:127], v[72:75]
    ds_read_b64_tr_b16 a[102:103], v87 offset:39552
    s_cmp_eq_u32 s42, 3
    s_cbranch_scc1 Lxe3
Lxe3_b:
    s_setprio 1
    s_waitcnt lgkmcnt(10)
    v_mfma_f32_16x16x32_bf16 v[28:31], a[80:83], a[64:67], v[28:31]
    ds_read_b128 a[72:75], v81 offset:39040
    ds_read_b128 a[76:79], v83 offset:39040
    v_mfma_f32_16x16x32_bf16 v[44:47], a[80:83], a[68:71], v[44:47]
    ds_read_b64_tr_b16 a[104:105], v24 offset:43136
    s_waitcnt lgkmcnt(11)
    v_mfma_f32_16x16x32_bf16 v[32:35], a[84:87], a[64:67], v[32:35]
    ds_read_b64_tr_b16 a[106:107], v24 offset:43648
    v_mfma_f32_16x16x32_bf16 v[48:51], a[84:87], a[68:71], v[48:51]
    ds_read_b64_tr_b16 a[108:109], v25 offset:43136
    s_waitcnt lgkmcnt(11)
    v_mfma_f32_16x16x32_bf16 v[36:39], a[88:91], a[64:67], v[36:39]
    ds_read_b64_tr_b16 a[110:111], v25 offset:43648
    ds_read_b64_tr_b16 a[112:113], v26 offset:43136
    v_mfma_f32_16x16x32_bf16 v[52:55], a[88:91], a[68:71], v[52:55]
    ds_read_b64_tr_b16 a[114:115], v26 offset:43648
    s_setprio 0
    s_waitcnt lgkmcnt(12)
    v_mfma_f32_16x16x32_bf16 v[40:43], a[92:95], a[64:67], v[40:43]
    ds_read_b64_tr_b16 a[116:117], v27 offset:43136
    v_mfma_f32_16x16x32_bf16 v[56:59], a[92:95], a[68:71], v[56:59]
    ds_read_b64_tr_b16 a[118:119], v27 offset:43648
    s_waitcnt lgkmcnt(12)
    v_mfma_f32_16x16x32_bf16 v[60:63], a[64:67], a[96:99], v[60:63]
    ds_read_b64_tr_b16 a[120:121], v86 offset:43136
    v_mfma_f32_16x16x32_bf16 v[68:71], a[68:71], a[96:99], v[68:71]
    ds_read_b64_tr_b16 a[122:123], v86 offset:43648
    s_waitcnt lgkmcnt(12)
    v_mfma_f32_16x16x32_bf16 v[64:67], a[64:67], a[100:103], v[64:67]
    ds_read_b64_tr_b16 a[124:125], v87 offset:43136
    v_mfma_f32_16x16x32_bf16 v[72:75], a[68:71], a[100:103], v[72:75]
    ds_read_b64_tr_b16 a[126:127], v87 offset:43648
    s_barrier
    s_setprio 3
    s_waitcnt lgkmcnt(10)
    v_mfma_f32_16x16x32_bf16 v[28:31], a[104:107], a[72:75], v[28:31]
    ds_read_b128 a[64:67], v76 offset:0
    ds_read_b128 a[68:71], v78 offset:0
    v_mfma_f32_16x16x32_bf16 v[44:47], a[104:107], a[76:79], v[44:47]
    ds_read_b64_tr_b16 a[80:81], v20 offset:0
    s_waitcnt lgkmcnt(11)
    v_mfma_f32_16x16x32_bf16 v[32:35], a[108:111], a[72:75], v[32:35]
    ds_read_b64_tr_b16 a[82:83], v20 offset:512
    v_mfma_f32_16x16x32_bf16 v[48:51], a[108:111], a[76:79], v[48:51]
    ds_read_b64_tr_b16 a[84:85], v21 offset:0
    s_waitcnt lgkmcnt(11)
    v_mfma_f32_16x16x32_bf16 v[36:39], a[112:115], a[72:75], v[36:39]
    ds_read_b64_tr_b16 a[86:87], v21 offset:512
    v_mfma_f32_16x16x32_bf16 v[52:55], a[112:115], a[76:79], v[52:55]
    ds_read_b64_tr_b16 a[88:89], v22 offset:0
    s_setprio 2
    s_waitcnt lgkmcnt(11)
    v_mfma_f32_16x16x32_bf16 v[40:43], a[116:119], a[72:75], v[40:43]
    ds_read_b64_tr_b16 a[90:91], v22 offset:512
    ds_read_b64_tr_b16 a[92:93], v23 offset:0
    v_mfma_f32_16x16x32_bf16 v[56:59], a[116:119], a[76:79], v[56:59]
    ds_read_b64_tr_b16 a[94:95], v23 offset:512
    s_waitcnt lgkmcnt(12)
    v_mfma_f32_16x16x32_bf16 v[60:63], a[72:75], a[120:123], v[60:63]
    ds_read_b64_tr_b16 a[96:97], v84 offset:0
    v_mfma_f32_16x16x32_bf16 v[68:71], a[76:79], a[120:123], v[68:71]
    ds_read_b64_tr_b16 a[98:99], v84 offset:512
    s_waitcnt lgkmcnt(12)
    v_mfma_f32_16x16x32_bf16 v[64:67], a[72:75], a[124:127], v[64:67]
    ds_read_b64_tr_b16 a[100:101], v85 offset:0
    v_mfma_f32_16x16x32_bf16 v[72:75], a[76:79], a[124:127], v[72:75]
    ds_read_b64_tr_b16 a[102:103], v85 offset:512
    buffer_store_dwordx4 v[100:103], v13, s[28:31], s23 offen offset:0 sc1
    s_cmp_eq_u32 s42, 4
    s_cbranch_scc1 Lxe4
Lxe4_b:
    s_setprio 1
    s_waitcnt lgkmcnt(10)
    v_mfma_f32_16x16x32_bf16 v[28:31], a[80:83], a[64:67], v[28:31]
    ds_read_b128 a[72:75], v77 offset:0
    ds_read_b128 a[76:79], v79 offset:0
    v_mfma_f32_16x16x32_bf16 v[44:47], a[80:83], a[68:71], v[44:47]
    ds_read_b64_tr_b16 a[104:105], v20 offset:4096
    s_waitcnt lgkmcnt(11)
    v_mfma_f32_16x16x32_bf16 v[32:35], a[84:87], a[64:67], v[32:35]
    ds_read_b64_tr_b16 a[106:107], v20 offset:4608
    v_mfma_f32_16x16x32_bf16 v[48:51], a[84:87], a[68:71], v[48:51]
    ds_read_b64_tr_b16 a[108:109], v21 offset:4096
    s_waitcnt lgkmcnt(11)
    v_mfma_f32_16x16x32_bf16 v[36:39], a[88:91], a[64:67], v[36:39]
    ds_read_b64_tr_b16 a[110:111], v21 offset:4608
    ds_read_b64_tr_b16 a[112:113], v22 offset:4096
    v_mfma_f32_16x16x32_bf16 v[52:55], a[88:91], a[68:71], v[52:55]
    ds_read_b64_tr_b16 a[114:115], v22 offset:4608
    s_setprio 0
    s_waitcnt lgkmcnt(12)
    v_mfma_f32_16x16x32_bf16 v[40:43], a[92:95], a[64:67], v[40:43]
    ds_read_b64_tr_b16 a[116:117], v23 offset:4096
    v_mfma_f32_16x16x32_bf16 v[56:59], a[92:95], a[68:71], v[56:59]
    ds_read_b64_tr_b16 a[118:119], v23 offset:4608
    s_waitcnt lgkmcnt(12)
    v_mfma_f32_16x16x32_bf16 v[60:63], a[64:67], a[96:99], v[60:63]
    ds_read_b64_tr_b16 a[120:121], v84 offset:4096
    v_mfma_f32_16x16x32_bf16 v[68:71], a[68:71], a[96:99], v[68:71]
    ds_read_b64_tr_b16 a[122:123], v84 offset:4608
    s_waitcnt lgkmcnt(12)
    v_mfma_f32_16x16x32_bf16 v[64:67], a[64:67], a[100:103], v[64:67]
    ds_read_b64_tr_b16 a[124:125], v85 offset:4096
    v_mfma_f32_16x16x32_bf16 v[72:75], a[68:71], a[100:103], v[72:75]
    ds_read_b64_tr_b16 a[126:127], v85 offset:4608
    s_barrier
    s_setprio 3
    s_waitcnt lgkmcnt(10)
    v_mfma_f32_16x16x32_bf16 v[28:31], a[104:107], a[72:75], v[28:31]
    ds_read_b128 a[64:67], v76 offset:39040
    ds_read_b128 a[68:71], v78 offset:39040
    v_mfma_f32_16x16x32_bf16 v[44:47], a[104:107], a[76:79], v[44:47]
    ds_read_b64_tr_b16 a[80:81], v20 offset:39040
    s_waitcnt lgkmcnt(11)
    v_mfma_f32_16x16x32_bf16 v[32:35], a[108:111], a[72:75], v[32:35]
    ds_read_b64_tr_b16 a[82:83], v20 offset:39552
    v_mfma_f32_16x16x32_bf16 v[48:51], a[108:111], a[76:79], v[48:51]
    ds_read_b64_tr_b16 a[84:85], v21 offset:39040
    s_waitcnt lgkmcnt(11)
    v_mfma_f32_16x16x32_bf16 v[36:39], a[112:115], a[72:75], v[36:39]
    ds_read_b64_tr_b16 a[86:87], v21 offset:39552
    v_mfma_f32_16x16x32_bf16 v[52:55], a[112:115], a[76:79], v[52:55]
    ds_read_b64_tr_b16 a[88:89], v22 offset:39040
    s_setprio 2
    s_waitcnt lgkmcnt(11)
    v_mfma_f32_16x16x32_bf16 v[40:43], a[116:119], a[72:75], v[40:43]
    ds_read_b64_tr_b16 a[90:91], v22 offset:39552
    ds_read_b64_tr_b16 a[92:93], v23 offset:39040
    v_mfma_f32_16x16x32_bf16 v[56:59], a[116:119], a[76:79], v[56:59]
    ds_read_b64_tr_b16 a[94:95], v23 offset:39552
    s_waitcnt lgkmcnt(12)
    v_mfma_f32_16x16x32_bf16 v[60:63], a[72:75], a[120:123], v[60:63]
    ds_read_b64_tr_b16 a[96:97], v84 offset:39040
    v_mfma_f32_16x16x32_bf16 v[68:71], a[76:79], a[120:123], v[68:71]
    ds_read_b64_tr_b16 a[98:99], v84 offset:39552
    s_waitcnt lgkmcnt(12)
    v_mfma_f32_16x16x32_bf16 v[64:67], a[72:75], a[124:127], v[64:67]
    ds_read_b64_tr_b16 a[100:101], v85 offset:39040
    v_mfma_f32_16x16x32_bf16 v[72:75], a[76:79], a[124:127], v[72:75]
    ds_read_b64_tr_b16 a[102:103], v85 offset:39552
    s_cmp_eq_u32 s42, 5
    s_cbranch_scc1 Lxe5
Lxe5_b:
    s_setprio 1
    s_waitcnt lgkmcnt(10)
    v_mfma_f32_16x16x32_bf16 v[28:31], a[80:83], a[64:67], v[28:31]
    ds_read_b128 a[72:75], v77 offset:39040
    ds_read_b128 a[76:79], v79 offset:39040
    v_mfma_f32_16x16x32_bf16 v[44:47], a[80:83], a[68:71], v[44:47]
    ds_read_b64_tr_b16 a[104:105], v20 offset:43136
    s_waitcnt lgkmcnt(11)
    v_mfma_f32_16x16x32_bf16 v[32:35], a[84:87], a[64:67], v[32:35]
    ds_read_b64_tr_b16 a[106:107], v20 offset:43648
    v_mfma_f32_16x16x32_bf16 v[48:51], a[84:87], a[68:71], v[48:51]
    ds_read_b64_tr_b16 a[108:109], v21 offset:43136
    s_waitcnt lgkmcnt(11)
    v_mfma_f32_16x16x32_bf16 v[36:39], a[88:91], a[64:67], v[36:39]
    ds_read_b64_tr_b16 a[110:111], v21 offset:43648
    ds_read_b64_tr_b16 a[112:113], v22 offset:43136
    v_mfma_f32_16x16x32_bf16 v[52:55], a[88:91], a[68:71], v[52:55]
    ds_read_b64_tr_b16 a[114:115], v22 offset:43648
    s_setprio 0
    s_waitcnt lgkmcnt(12)
    v_mfma_f32_16x16x32_bf16 v[40:43], a[92:95], a[64:67], v[40:43]
    ds_read_b64_tr_b16 a[116:117], v23 offset:43136
    v_mfma_f32_16x16x32_bf16 v[56:59], a[92:95], a[68:71], v[56:59]
    ds_read_b64_tr_b16 a[118:119], v23 offset:43648
    s_waitcnt lgkmcnt(12)
    v_mfma_f32_16x16x32_bf16 v[60:63], a[64:67], a[96:99], v[60:63]
    ds_read_b64_tr_b16 a[120:121], v84 offset:43136
    v_mfma_f32_16x16x32_bf16 v[68:71], a[68:71], a[96:99], v[68:71]
    ds_read_b64_tr_b16 a[122:123], v84 offset:43648
    s_waitcnt lgkmcnt(12)
    v_mfma_f32_16x16x32_bf16 v[64:67], a[64:67], a[100:103], v[64:67]
    ds_read_b64_tr_b16 a[124:125], v85 offset:43136
    v_mfma_f32_16x16x32_bf16 v[72:75], a[68:71], a[100:103], v[72:75]
    ds_read_b64_tr_b16 a[126:127], v85 offset:43648
    s_barrier
    s_setprio 3
    s_waitcnt lgkmcnt(10)
    v_mfma_f32_16x16x32_bf16 v[28:31], a[104:107], a[72:75], v[28:31]
    ds_read_b128 a[0:3], v80 offset:0
    v_mfma_f32_16x16x32_bf16 v[44:47], a[104:107], a[76:79], v[44:47]
    ds_read_b128 a[4:7], v82 offset:0
    s_waitcnt lgkmcnt(10)
    v_mfma_f32_16x16x32_bf16 v[32:35], a[108:111], a[72:75], v[32:35]
    ds_read_b64_tr_b16 a[80:81], v24 offset:0
    v_mfma_f32_16x16x32_bf16 v[48:51], a[108:111], a[76:79], v[48:51]
    ds_read_b64_tr_b16 a[82:83], v24 offset:512
    s_waitcnt lgkmcnt(10)
    v_mfma_f32_16x16x32_bf16 v[36:39], a[112:115], a[72:75], v[36:39]
    ds_read_b64_tr_b16 a[84:85], v25 offset:0
    v_mfma_f32_16x16x32_bf16 v[52:55], a[112:115], a[76:79], v[52:55]
    s_setprio 2
    s_waitcnt lgkmcnt(9)
    v_mfma_f32_16x16x32_bf16 v[40:43], a[116:119], a[72:75], v[40:43]
    ds_read_b64_tr_b16 a[86:87], v25 offset:512
    v_mfma_f32_16x16x32_bf16 v[56:59], a[116:119], a[76:79], v[56:59]
    ds_read_b64_tr_b16 a[88:89], v26 offset:0
    s_waitcnt lgkmcnt(9)
    v_mfma_f32_16x16x32_bf16 v[60:63], a[72:75], a[120:123], v[60:63]
    ds_read_b64_tr_b16 a[90:91], v26 offset:512
    v_mfma_f32_16x16x32_bf16 v[68:71], a[76:79], a[120:123], v[68:71]
    ds_read_b64_tr_b16 a[92:93], v27 offset:0
    s_waitcnt lgkmcnt(9)
    v_mfma_f32_16x16x32_bf16 v[64:67], a[72:75], a[124:127], v[64:67]
    ds_read_b64_tr_b16 a[94:95], v27 offset:512
    v_mfma_f32_16x16x32_bf16 v[72:75], a[76:79], a[124:127], v[72:75]
    buffer_store_dwordx4 v[100:103], v13, s[28:31], s23 offen offset:1024 sc1
    s_cmp_eq_u32 s42, 6
    s_cbranch_scc1 Lxe6
Lxe6_b:
    s_setprio 1
    s_waitcnt lgkmcnt(6)
    v_mfma_f32_16x16x32_bf16 v[28:31], a[80:83], a[0:3], v[28:31]
    ds_read_b128 a[8:11], v81 offset:0
    ds_read_b128 a[12:15], v83 offset:0
    v_mfma_f32_16x16x32_bf16 v[44:47], a[80:83], a[4:7], v[44:47]
    ds_read_b64_tr_b16 a[104:105], v24 offset:4096
    s_waitcnt lgkmcnt(7)
    v_mfma_f32_16x16x32_bf16 v[32:35], a[84:87], a[0:3], v[32:35]
    ds_read_b64_tr_b16 a[106:107], v24 offset:4608
    ds_read_b64_tr_b16 a[108:109], v25 offset:4096
    v_mfma_f32_16x16x32_bf16 v[48:51], a[84:87], a[4:7], v[48:51]
    ds_read_b64_tr_b16 a[110:111], v25 offset:4608
    s_setprio 0
    s_waitcnt lgkmcnt(8)
    v_mfma_f32_16x16x32_bf16 v[36:39], a[88:91], a[0:3], v[36:39]
    v_mfma_f32_16x16x32_bf16 v[52:55], a[88:91], a[4:7], v[52:55]
    ds_read_b64_tr_b16 a[112:113], v26 offset:4096
    ds_read_b64_tr_b16 a[114:115], v26 offset:4608
    s_waitcnt lgkmcnt(8)
    v_mfma_f32_16x16x32_bf16 v[40:43], a[92:95], a[0:3], v[40:43]
    ds_read_b64_tr_b16 a[116:117], v27 offset:4096
    v_mfma_f32_16x16x32_bf16 v[56:59], a[92:95], a[4:7], v[56:59]
    ds_read_b64_tr_b16 a[118:119], v27 offset:4608
    s_barrier
    s_setprio 3
    s_waitcnt lgkmcnt(6)
    v_mfma_f32_16x16x32_bf16 v[28:31], a[104:107], a[8:11], v[28:31]
    ds_read_b128 a[16:19], v80 offset:39040
    ds_read_b128 a[20:23], v82 offset:39040
    v_mfma_f32_16x16x32_bf16 v[44:47], a[104:107], a[12:15], v[44:47]
    ds_read_b64_tr_b16 a[80:81], v24 offset:39040
    s_waitcnt lgkmcnt(7)
    v_mfma_f32_16x16x32_bf16 v[32:35], a[108:111], a[8:11], v[32:35]
    ds_read_b64_tr_b16 a[82:83], v24 offset:39552
    v_mfma_f32_16x16x32_bf16 v[48:51], a[108:111], a[12:15], v[48:51]
    ds_read_b64_tr_b16 a[84:85], v25 offset:39040
    s_setprio 2
    s_waitcnt lgkmcnt(7)
    v_mfma_f32_16x16x32_bf16 v[36:39], a[112:115], a[8:11], v[36:39]
    ds_read_b64_tr_b16 a[86:87], v25 offset:39552
    ds_read_b64_tr_b16 a[88:89], v26 offset:39040
    v_mfma_f32_16x16x32_bf16 v[52:55], a[112:115], a[12:15], v[52:55]
    ds_read_b64_tr_b16 a[90:91], v26 offset:39552
    s_waitcnt lgkmcnt(8)
    v_mfma_f32_16x16x32_bf16 v[40:43], a[116:119], a[8:11], v[40:43]
    ds_read_b64_tr_b16 a[92:93], v27 offset:39040
    v_mfma_f32_16x16x32_bf16 v[56:59], a[116:119], a[12:15], v[56:59]
    ds_read_b64_tr_b16 a[94:95], v27 offset:39552
    s_cmp_eq_u32 s42, 7
    s_cbranch_scc1 Lxe7
Lxe7_b:
    s_setprio 1
    s_waitcnt lgkmcnt(6)
    v_mfma_f32_16x16x32_bf16 v[28:31], a[80:83], a[16:19], v[28:31]
    ds_read_b128 a[24:27], v81 offset:39040
    ds_read_b128 a[28:31], v83 offset:39040
    v_mfma_f32_16x16x32_bf16 v[44:47], a[80:83], a[20:23], v[44:47]
    ds_read_b64_tr_b16 a[104:105], v24 offset:43136
    s_waitcnt lgkmcnt(7)
    v_mfma_f32_16x16x32_bf16 v[32:35], a[84:87], a[16:19], v[32:35]
    ds_read_b64_tr_b16 a[106:107], v24 offset:43648
    ds_read_b64_tr_b16 a[108:109], v25 offset:43136
    v_mfma_f32_16x16x32_bf16 v[48:51], a[84:87], a[20:23], v[48:51]
    ds_read_b64_tr_b16 a[110:111], v25 offset:43648
    s_setprio 0
    s_waitcnt lgkmcnt(8)
    v_mfma_f32_16x16x32_bf16 v[36:39], a[88:91], a[16:19], v[36:39]
    v_mfma_f32_16x16x32_bf16 v[52:55], a[88:91], a[20:23], v[52:55]
    ds_read_b64_tr_b16 a[112:113], v26 offset:43136
    ds_read_b64_tr_b16 a[114:115], v26 offset:43648
    s_waitcnt lgkmcnt(8)
    v_mfma_f32_16x16x32_bf16 v[40:43], a[92:95], a[16:19], v[40:43]
    ds_read_b64_tr_b16 a[116:117], v27 offset:43136
    v_mfma_f32_16x16x32_bf16 v[56:59], a[92:95], a[20:23], v[56:59]
    ds_read_b64_tr_b16 a[118:119], v27 offset:43648
    s_barrier
    s_setprio 3
    s_waitcnt lgkmcnt(6)
    v_mfma_f32_16x16x32_bf16 v[28:31], a[104:107], a[24:27], v[28:31]
    ds_read_b128 a[32:35], v76 offset:0
    ds_read_b128 a[36:39], v78 offset:0
    v_mfma_f32_16x16x32_bf16 v[44:47], a[104:107], a[28:31], v[44:47]
    ds_read_b64_tr_b16 a[80:81], v20 offset:0
    s_waitcnt lgkmcnt(7)
    v_mfma_f32_16x16x32_bf16 v[32:35], a[108:111], a[24:27], v[32:35]
    ds_read_b64_tr_b16 a[82:83], v20 offset:512
    v_mfma_f32_16x16x32_bf16 v[48:51], a[108:111], a[28:31], v[48:51]
    ds_read_b64_tr_b16 a[84:85], v21 offset:0
    s_setprio 2
    s_waitcnt lgkmcnt(7)
    v_mfma_f32_16x16x32_bf16 v[36:39], a[112:115], a[24:27], v[36:39]
    ds_read_b64_tr_b16 a[86:87], v21 offset:512
    ds_read_b64_tr_b16 a[88:89], v22 offset:0
    v_mfma_f32_16x16x32_bf16 v[52:55], a[112:115], a[28:31], v[52:55]
    ds_read_b64_tr_b16 a[90:91], v22 offset:512
    s_waitcnt lgkmcnt(8)
    v_mfma_f32_16x16x32_bf16 v[40:43], a[116:119], a[24:27], v[40:43]
    ds_read_b64_tr_b16 a[92:93], v23 offset:0
    v_mfma_f32_16x16x32_bf16 v[56:59], a[116:119], a[28:31], v[56:59]
    ds_read_b64_tr_b16 a[94:95], v23 offset:512
    s_cmp_eq_u32 s42, 8
    s_cbranch_scc1 Lxe8
Lxe8_b:
    s_setprio 1
    s_waitcnt lgkmcnt(6)
    v_mfma_f32_16x16x32_bf16 v[28:31], a[80:83], a[32:35], v[28:31]
    ds_read_b128 a[40:43], v77 offset:0
    ds_read_b128 a[44:47], v79 offset:0
    v_mfma_f32_16x16x32_bf16 v[44:47], a[80:83], a[36:39], v[44:47]
    ds_read_b64_tr_b16 a[104:105], v20 offset:4096
    s_waitcnt lgkmcnt(7)
    v_mfma_f32_16x16x32_bf16 v[32:35], a[84:87], a[32:35], v[32:35]
    ds_read_b64_tr_b16 a[106:107], v20 offset:4608
    v_mfma_f32_16x16x32_bf16 v[48:51], a[84:87], a[36:39], v[48:51]
    ds_read_b64_tr_b16 a[108:109], v21 offset:4096
    s_setprio 0
    s_waitcnt lgkmcnt(7)
    v_mfma_f32_16x16x32_bf16 v[36:39], a[88:91], a[32:35], v[36:39]
    ds_read_b64_tr_b16 a[110:111], v21 offset:4608
    ds_read_b64_tr_b16 a[112:113], v22 offset:4096
    v_mfma_f32_16x16x32_bf16 v[52:55], a[88:91], a[36:39], v[52:55]
    ds_read_b64_tr_b16 a[114:115], v22 offset:4608
    s_waitcnt lgkmcnt(8)
    v_mfma_f32_16x16x32_bf16 v[40:43], a[92:95], a[32:35], v[40:43]
    ds_read_b64_tr_b16 a[116:117], v23 offset:4096
    v_mfma_f32_16x16x32_bf16 v[56:59], a[92:95], a[36:39], v[56:59]
    ds_read_b64_tr_b16 a[118:119], v23 offset:4608
    s_waitcnt lgkmcnt(0)
    s_barrier
    s_setprio 3
    v_mfma_f32_16x16x32_bf16 v[28:31], a[104:107], a[40:43], v[28:31]
    ds_read_b128 a[48:51], v76 offset:39040
    ds_read_b128 a[52:55], v78 offset:39040
    v_mfma_f32_16x16x32_bf16 v[44:47], a[104:107], a[44:47], v[44:47]
    ds_read_b64_tr_b16 a[80:81], v20 offset:39040
    v_mfma_f32_16x16x32_bf16 v[32:35], a[108:111], a[40:43], v[32:35]
    ds_read_b64_tr_b16 a[82:83], v20 offset:39552
    v_mfma_f32_16x16x32_bf16 v[48:51], a[108:111], a[44:47], v[48:51]
    ds_read_b64_tr_b16 a[84:85], v21 offset:39040
    s_setprio 2
    v_mfma_f32_16x16x32_bf16 v[36:39], a[112:115], a[40:43], v[36:39]
    ds_read_b64_tr_b16 a[86:87], v21 offset:39552
    ds_read_b64_tr_b16 a[88:89], v22 offset:39040
    v_mfma_f32_16x16x32_bf16 v[52:55], a[112:115], a[44:47], v[52:55]
    ds_read_b64_tr_b16 a[90:91], v22 offset:39552
    v_mfma_f32_16x16x32_bf16 v[40:43], a[116:119], a[40:43], v[40:43]
    ds_read_b64_tr_b16 a[92:93], v23 offset:39040
    v_mfma_f32_16x16x32_bf16 v[56:59], a[116:119], a[44:47], v[56:59]
    ds_read_b64_tr_b16 a[94:95], v23 offset:39552
    v_mov_b32 v98, s34
    s_waitcnt vmcnt(0)
    s_mov_b64 exec, 1
    buffer_store_dword v98, v97, s[28:31], s24 offen sc1
    s_mov_b64 exec, -1
    s_cmp_eq_u32 s42, 9
    s_cbranch_scc1 Lxe9
Lxe9_b:
    s_setprio 1
    s_waitcnt lgkmcnt(6)
    v_mfma_f32_16x16x32_bf16 v[28:31], a[80:83], a[48:51], v[28:31]
    ds_read_b128 a[56:59], v77 offset:39040
    ds_read_b128 a[60:63], v79 offset:39040
    ds_read_b64_tr_b16 a[104:105], v20 offset:43136
    v_mfma_f32_16x16x32_bf16 v[44:47], a[80:83], a[52:55], v[44:47]
    ds_read_b64_tr_b16 a[106:107], v20 offset:43648
    ds_read_b64_tr_b16 a[108:109], v21 offset:43136
    s_waitcnt lgkmcnt(9)
    v_mfma_f32_16x16x32_bf16 v[32:35], a[84:87], a[48:51], v[32:35]
    ds_read_b64_tr_b16 a[110:111], v21 offset:43648
    ds_read_b64_tr_b16 a[112:113], v22 offset:43136
    ds_read_b64_tr_b16 a[114:115], v22 offset:43648
    v_mfma_f32_16x16x32_bf16 v[48:51], a[84:87], a[52:55], v[48:51]
    ds_read_b64_tr_b16 a[116:117], v23 offset:43136
    ds_read_b64_tr_b16 a[118:119], v23 offset:43648
    s_setprio 0
    s_waitcnt lgkmcnt(12)
    v_mfma_f32_16x16x32_bf16 v[36:39], a[88:91], a[48:51], v[36:39]
    ds_read_b32 v120, v94
    ds_read_b32 v121, v94 offset:512
    v_xor_b32 v94, 64, v94
    v_mfma_f32_16x16x32_bf16 v[52:55], a[88:91], a[52:55], v[52:55]
    ds_read_b32 v122, v94
    ds_read_b32 v123, v92 offset:512
    s_waitcnt lgkmcnt(14)
    v_mfma_f32_16x16x32_bf16 v[40:43], a[92:95], a[48:51], v[40:43]
    ds_read_b32 v126, v93 offset:520
    v_mov_b32 v24, v84
    v_mov_b32 v25, v85
    v_mfma_f32_16x16x32_bf16 v[56:59], a[92:95], a[52:55], v[56:59]
    v_mov_b32 v26, v86
    v_mov_b32 v27, v87
    s_waitcnt lgkmcnt(5)
    v_mfma_f32_16x16x32_bf16 v[44:47], a[104:107], a[60:63], v[44:47]
    v_mfma_f32_16x16x32_bf16 v[48:51], a[108:111], a[60:63], v[48:51]
    v_mfma_f32_16x16x32_bf16 v[52:55], a[112:115], a[60:63], v[52:55]
    v_mfma_f32_16x16x32_bf16 v[56:59], a[116:119], a[60:63], v[56:59]
    v_mfma_f32_16x16x32_bf16 v[28:31], a[104:107], a[56:59], v[28:31]
    v_mfma_f32_16x16x32_bf16 v[32:35], a[108:111], a[56:59], v[32:35]
    ds_read_b32 v7, v96
    ds_read_b128 v[76:79], v95 offset:0
    ds_read_b128 v[80:83], v95 offset:64
    ds_read_b128 v[84:87], v95 offset:128
    ds_read_b128 v[88:91], v95 offset:192
    v_mfma_f32_16x16x32_bf16 v[36:39], a[112:115], a[56:59], v[36:39]
    v_mfma_f32_16x16x32_bf16 v[40:43], a[116:119], a[56:59], v[40:43]
    s_waitcnt lgkmcnt(0)
Lqf:
    v_readfirstlane_b32 s38, v7
    s_nop 0
    s_cmp_eq_u32 s38, 0
    s_cbranch_scc1 Lqf_re
    s_cmp_eq_u32 s27, 0
    v_fmac_f32 v44, v76, v122
    v_fmac_f32 v45, v77, v122
    v_fmac_f32 v46, v78, v122
    v_fmac_f32 v47, v79, v122
    v_cvt_pk_bf16_f32 v44, v44, v45
    v_cvt_pk_bf16_f32 v45, v46, v47
    v_fmac_f32 v48, v80, v122
    v_fmac_f32 v49, v81, v122
    v_fmac_f32 v50, v82, v122
    v_fmac_f32 v51, v83, v122
    v_cvt_pk_bf16_f32 v46, v48, v49
    v_cvt_pk_bf16_f32 v47, v50, v51
    v_fmac_f32 v52, v84, v122
    v_fmac_f32 v53, v85, v122
    v_fmac_f32 v54, v86, v122
    v_fmac_f32 v55, v87, v122
    v_cvt_pk_bf16_f32 v48, v52, v53
    v_cvt_pk_bf16_f32 v49, v54, v55
    v_fmac_f32 v56, v88, v122
    v_fmac_f32 v57, v89, v122
    v_fmac_f32 v58, v90, v122
    v_fmac_f32 v59, v91, v122
    v_cvt_pk_bf16_f32 v50, v56, v57
    v_cvt_pk_bf16_f32 v51, v58, v59
    s_cbranch_scc1 Lh1
    s_setprio 3
    ds_write_b128 v125, v[44:47] offset:2048
    ds_write_b128 v125, v[48:51] offset:3072
    v_fmac_f32 v28, v76, v120
    v_fmac_f32 v29, v77, v120
    v_fmac_f32 v30, v78, v120
    v_fmac_f32 v31, v79, v120
    v_cvt_pk_bf16_f32 v52, v28, v29
    v_cvt_pk_bf16_f32 v53, v30, v31
    v_fmac_f32 v32, v80, v120
    v_fmac_f32 v33, v81, v120
    v_fmac_f32 v34, v82, v120
    v_fmac_f32 v35, v83, v120
    v_cvt_pk_bf16_f32 v54, v32, v33
    v_cvt_pk_bf16_f32 v55, v34, v35
    v_fmac_f32 v36, v84, v120
    v_fmac_f32 v37, v85, v120
    v_fmac_f32 v38, v86, v120
    v_fmac_f32 v39, v87, v120
    v_cvt_pk_bf16_f32 v56, v36, v37
    v_cvt_pk_bf16_f32 v57, v38, v39
    v_fmac_f32 v40, v88, v120
    v_fmac_f32 v41, v89, v120
    v_fmac_f32 v42, v90, v120
    v_fmac_f32 v43, v91, v120
    v_cvt_pk_bf16_f32 v58, v40, v41
    v_cvt_pk_bf16_f32 v59, v42, v43
    ds_write_b128 v125, v[52:55] offset:4096
    ds_write_b128 v125, v[56:59] offset:5120
    v_mov_b32 v5, 157972
    v_mov_b32 v6, 1
    s_mov_b64 exec, 1
    ds_add_u32 v5, v6
    s_mov_b64 exec, -1
    v_mov_b32 v8, s22
    v_mov_b32 v9, s22
    v_mov_b32 v10, s22
    v_mov_b32 v11, s22
Lcw_1:
    s_sub_u32 s35, s35, 1
    s_cbranch_scc1 Lend
    ds_read_b32 v6, v5
    s_waitcnt lgkmcnt(0)
    v_readfirstlane_b32 s38, v6
    s_nop 0
    s_cmp_lt_u32 s38, 8
    s_cbranch_scc1 Lcw_1
    ds_read_b128 v[28:31], v125 offset:0
    ds_read_b128 v[32:35], v125 offset:1024
Lh_join:
    buffer_load_dword v20, v12, s[28:31], s24 offen sc1
    ds_read_b64_tr_b16 a[64:65], v26 offset:0
    ds_read_b64_tr_b16 a[66:67], v26 offset:512
    ds_read_b64_tr_b16 a[68:69], v27 offset:0
    ds_read_b64_tr_b16 a[70:71], v27 offset:512
    ds_read_b64_tr_b16 a[72:73], v26 offset:4096
    ds_read_b64_tr_b16 a[74:75], v26 offset:4608
    ds_read_b64_tr_b16 a[76:77], v27 offset:4096
    ds_read_b64_tr_b16 a[78:79], v27 offset:4608
    s_waitcnt lgkmcnt(8)
    s_setprio 3
    v_cndmask_b32 v92, 0, v30, s[6:7]
    v_cndmask_b32 v93, 0, v31, s[6:7]
    v_cndmask_b32 v94, 0, v32, s[12:13]
    v_cndmask_b32 v95, 0, v33, s[12:13]
    v_cndmask_b32 v104, 0, v30, s[8:9]
    v_cndmask_b32 v105, 0, v31, s[8:9]
    v_mfma_f32_16x16x32_bf16 v[76:79], v[46:49], v[92:95], v[8:11]
    v_mfma_f32_16x16x32_bf16 v[80:83], v[54:57], v[92:95], 0
    v_cndmask_b32 v106, 0, v32, s[14:15]
    v_cndmask_b32 v107, 0, v33, s[14:15]
    v_mov_b32 v96, v28
    v_mov_b32 v97, v29
    v_mfma_f32_16x16x32_bf16 v[84:87], v[46:49], v[104:107], v[8:11]
    v_mfma_f32_16x16x32_bf16 v[88:91], v[54:57], v[104:107], 0
    v_cndmask_b32 v98, 0, v30, s[10:11]
    v_cndmask_b32 v99, 0, v31, s[10:11]
    v_cndmask_b32 v100, 0, v32, s[16:17]
    v_cndmask_b32 v101, 0, v33, s[16:17]
    v_mfma_f32_16x16x32_bf16 v[36:39], v[44:47], v[96:99], v[8:11]
    v_mfma_f32_16x16x32_bf16 v[40:43], v[52:55], v[96:99], 0
    v_cndmask_b32 v76, v76, v77, s[4:5]
    v_cndmask_b32 v80, v80, v81, s[4:5]
    v_cndmask_b32 v78, v78, v79, s[4:5]
    v_cndmask_b32 v82, v82, v83, s[4:5]
    v_cndmask_b32 v92, v76, v80, s[18:19]
    v_cndmask_b32 v94, v78, v82, s[20:21]
    v_min_u32 v4, -2, v92
    v_min_u32 v5, -2, v94
    v_cndmask_b32 v84, v84, v85, s[4:5]
    v_cndmask_b32 v88, v88, v89, s[4:5]
    v_cndmask_b32 v86, v86, v87, s[4:5]
    v_cndmask_b32 v90, v90, v91, s[4:5]
    v_cndmask_b32 v104, v84, v88, s[18:19]
    v_cndmask_b32 v106, v86, v90, s[20:21]
    v_min_u32 v6, -2, v104
    v_min_u32 v7, -2, v106
    buffer_store_dwordx4 v[4:7], v13, s[28:31], s58 offen sc1
    s_setprio 2
    ds_read_b64_tr_b16 a[80:81], v26 offset:39040
    ds_read_b64_tr_b16 a[82:83], v26 offset:39552
    ds_read_b64_tr_b16 a[84:85], v27 offset:39040
    ds_read_b64_tr_b16 a[86:87], v27 offset:39552
    ds_read_b64_tr_b16 a[88:89], v26 offset:43136
    ds_read_b64_tr_b16 a[90:91], v26 offset:43648
    ds_read_b64_tr_b16 a[92:93], v27 offset:43136
    ds_read_b64_tr_b16 a[94:95], v27 offset:43648
    ds_read_b64_tr_b16 a[96:97], v24 offset:0
    ds_read_b64_tr_b16 a[98:99], v24 offset:512
    ds_read_b64_tr_b16 a[100:101], v25 offset:0
    ds_read_b64_tr_b16 a[102:103], v25 offset:512
    ds_read_b64_tr_b16 a[104:105], v24 offset:4096
    ds_read_b64_tr_b16 a[106:107], v24 offset:4608
    ds_read_b64_tr_b16 a[108:109], v25 offset:4096
    ds_read_b64_tr_b16 a[110:111], v25 offset:4608
    ds_read_b64_tr_b16 a[112:113], v24 offset:39040
    ds_read_b64_tr_b16 a[114:115], v24 offset:39552
    ds_read_b64_tr_b16 a[116:117], v25 offset:39040
    ds_read_b64_tr_b16 a[118:119], v25 offset:39552
    ds_read_b64_tr_b16 a[120:121], v24 offset:43136
    ds_read_b64_tr_b16 a[122:123], v24 offset:43648
    ds_read_b64_tr_b16 a[124:125], v25 offset:43136
    ds_read_b64_tr_b16 a[126:127], v25 offset:43648
    s_waitcnt lgkmcnt(15)
    v_mfma_f32_16x16x32_bf16 v[60:63], a[0:3], a[64:67], v[60:63]
    v_mov_b32 v102, v34
    v_mov_b32 v103, v35
    v_mul_f32 v4, s25, v121
    v_mfma_f32_16x16x32_bf16 v[68:71], a[4:7], a[64:67], v[68:71]
    v_mfma_f32_16x16x32_bf16 v[76:79], v[48:51], v[100:103], v[8:11]
    v_mfma_f32_16x16x32_bf16 v[80:83], v[56:59], v[100:103], 0
    v_mul_f32 v123, v123, v4
    v_mfma_f32_16x16x32_bf16 v[64:67], a[0:3], a[68:71], v[64:67]
    v_mul_f32 v126, v126, v4
    v_cndmask_b32 v36, v36, v37, s[4:5]
    v_cndmask_b32 v40, v40, v41, s[4:5]
    v_mfma_f32_16x16x32_bf16 v[72:75], a[4:7], a[68:71], v[72:75]
    v_cndmask_b32 v38, v38, v39, s[4:5]
    v_cndmask_b32 v42, v42, v43, s[4:5]
    v_cndmask_b32 v96, v36, v40, s[18:19]
    v_mfma_f32_16x16x32_bf16 v[60:63], a[8:11], a[72:75], v[60:63]
    v_cndmask_b32 v98, v38, v42, s[20:21]
    v_cndmask_b32 v76, v76, v77, s[4:5]
    v_cndmask_b32 v80, v80, v81, s[4:5]
    v_mfma_f32_16x16x32_bf16 v[68:71], a[12:15], a[72:75], v[68:71]
    v_cndmask_b32 v78, v78, v79, s[4:5]
    v_cndmask_b32 v82, v82, v83, s[4:5]
    v_cndmask_b32 v100, v76, v80, s[18:19]
    v_mfma_f32_16x16x32_bf16 v[64:67], a[8:11], a[76:79], v[64:67]
    v_cndmask_b32 v102, v78, v82, s[20:21]
    v_mul_f32 v96, v96, v123
    v_mul_f32 v98, v98, v126
    v_mfma_f32_16x16x32_bf16 v[72:75], a[12:15], a[76:79], v[72:75]
    v_mul_f32 v100, v100, v123
    v_mul_f32 v102, v102, v126
    v_max_f32 v4, v96, v98
    v_mfma_f32_16x16x32_bf16 v[60:63], a[16:19], a[80:83], v[60:63]
    v_max_f32 v5, v100, v102
    v_mov_b32 v6, v4
    v_mov_b32 v7, v5
    v_mfma_f32_16x16x32_bf16 v[68:71], a[20:23], a[80:83], v[68:71]
    v_permlane32_swap_b32 v4, v6
    v_permlane32_swap_b32 v5, v7
    v_max_f32 v4, v4, v6
    v_mfma_f32_16x16x32_bf16 v[64:67], a[16:19], a[84:87], v[64:67]
    v_max_f32 v5, v5, v7
    v_mov_b32 v6, v4
    v_mov_b32 v7, v5
    v_mfma_f32_16x16x32_bf16 v[72:75], a[20:23], a[84:87], v[72:75]
    v_permlane16_swap_b32 v4, v6
    v_permlane16_swap_b32 v5, v7
    s_setprio 1
    v_mfma_f32_16x16x32_bf16 v[60:63], a[24:27], a[88:91], v[60:63]
    v_max_f32 v4, v4, v6
    v_max_f32 v5, v5, v7
    v_sub_f32 v96, v96, v4
    v_mfma_f32_16x16x32_bf16 v[68:71], a[28:31], a[88:91], v[68:71]
    v_sub_f32 v98, v98, v4
    v_sub_f32 v100, v100, v5
    v_sub_f32 v102, v102, v5
    v_mfma_f32_16x16x32_bf16 v[64:67], a[24:27], a[92:95], v[64:67]
    v_exp_f32 v96, v96
    v_exp_f32 v98, v98
    v_exp_f32 v100, v100
    v_mfma_f32_16x16x32_bf16 v[72:75], a[28:31], a[92:95], v[72:75]
    v_exp_f32 v102, v102
    v_cvt_pk_bf16_f32 v96, v96, v96
    s_waitcnt lgkmcnt(12)
    v_mfma_f32_16x16x32_bf16 v[60:63], a[32:35], a[96:99], v[60:63]
    v_cvt_pk_bf16_f32 v97, v98, v98
    v_cvt_pk_bf16_f32 v100, v100, v100
    v_cvt_pk_bf16_f32 v101, v102, v102
    v_mfma_f32_16x16x32_bf16 v[68:71], a[36:39], a[96:99], v[68:71]
    v_and_b32 v98, v96, v118
    v_and_b32 v99, v97, v119
    v_and_b32 v96, v96, v116
    v_mfma_f32_16x16x32_bf16 v[64:67], a[32:35], a[100:103], v[64:67]
    v_and_b32 v97, v97, v117
    v_and_b32 v102, v100, v118
    v_and_b32 v103, v101, v119
    v_mfma_f32_16x16x32_bf16 v[72:75], a[36:39], a[100:103], v[72:75]
    v_and_b32 v100, v100, v116
    v_and_b32 v101, v101, v117
    s_waitcnt lgkmcnt(8)
    v_mfma_f32_16x16x32_bf16 v[60:63], a[40:43], a[104:107], v[60:63]
    s_lshl_b32 s36, s44, 6
    s_add_u32 s36, s36, 156160
    v_lshl_add_u32 v48, v2, 4, s36
    v_xor_b32 v49, 64, v48
    ds_read_b128 v[28:31], v48 offset:0
    v_mfma_f32_16x16x32_bf16 v[68:71], a[44:47], a[104:107], v[68:71]
    ds_read_b128 v[32:35], v48 offset:512
    ds_read_b128 v[36:39], v49 offset:0
    ds_read_b128 v[40:43], v49 offset:512
    s_lshl_b32 s36, s27, 3
    s_add_u32 s36, s36, 157696
    v_mfma_f32_16x16x32_bf16 v[64:67], a[40:43], a[108:111], v[64:67]
    v_lshl_add_u32 v48, v3, 4, s36
    v_mov_b32 v49, 157952
    v_lshl_add_u32 v125, v1, 3, s45
    s_lshl_b32 s36, s27, 10
    v_add_u32 v50, s36, v125
    v_mfma_f32_16x16x32_bf16 v[72:75], a[44:47], a[108:111], v[72:75]
    s_lshl_b32 s37, s27, 12
    s_sub_u32 s37, 2048, s37
    v_add_u32 v51, s37, v50
    v_subrev_u32 v125, 2048, v125
    s_setprio 0
    s_waitcnt lgkmcnt(8)
    v_mfma_f32_16x16x32_bf16 v[60:63], a[48:51], a[112:115], v[60:63]
    v_mfma_f32_16x16x32_bf16 v[68:71], a[52:55], a[112:115], v[68:71]
    v_mfma_f32_16x16x32_bf16 v[64:67], a[48:51], a[116:119], v[64:67]
    v_mfma_f32_16x16x32_bf16 v[72:75], a[52:55], a[116:119], v[72:75]
    s_waitcnt vmcnt(1)
Lfl_chk:
    v_cmp_eq_u32 vcc, s34, v20
    s_nop 0
    s_and_b32 s36, vcc_lo, 0x3ff
    s_cmp_lg_u32 s36, 0x3ff
    s_cbranch_scc1 Lfl_re
    buffer_load_dwordx2 v[52:53], v13, s[28:31], s59 offen offset:8 sc1
    buffer_load_dwordx2 v[54:55], v13, s[28:31], s60 offen offset:0 sc1
    s_waitcnt lgkmcnt(4)
    v_mfma_f32_16x16x32_bf16 v[60:63], a[56:59], a[120:123], v[60:63]
    v_mfma_f32_16x16x32_bf16 v[68:71], a[60:63], a[120:123], v[68:71]
    v_mfma_f32_16x16x32_bf16 v[64:67], a[56:59], a[124:127], v[64:67]
    v_mfma_f32_16x16x32_bf16 v[72:75], a[60:63], a[124:127], v[72:75]
    ds_read_b32 v46, v49
    ds_read_b64 v[44:45], v48
    s_waitcnt lgkmcnt(0)
Lcsv:
    v_readfirstlane_b32 s38, v46
    s_nop 0
    s_cmp_eq_u32 s38, 0
    s_cbranch_scc1 Lcsv_re
    v_fmac_f32 v60, v28, v44
    v_fmac_f32 v61, v29, v44
    v_fmac_f32 v62, v30, v44
    v_fmac_f32 v63, v31, v44
    v_mul_f32 v60, v60, v32
    v_mul_f32 v61, v61, v33
    v_mul_f32 v62, v62, v34
    v_mul_f32 v63, v63, v35
    v_cvt_pk_bf16_f32 v60, v60, v61
    v_cvt_pk_bf16_f32 v61, v62, v63
    ds_write_b64 v50, v[60:61] offset:0
    v_fmac_f32 v64, v28, v45
    v_fmac_f32 v65, v29, v45
    v_fmac_f32 v66, v30, v45
    v_fmac_f32 v67, v31, v45
    v_mul_f32 v64, v64, v32
    v_mul_f32 v65, v65, v33
    v_mul_f32 v66, v66, v34
    v_mul_f32 v67, v67, v35
    v_cvt_pk_bf16_f32 v64, v64, v65
    v_cvt_pk_bf16_f32 v65, v66, v67
    ds_write_b64 v50, v[64:65] offset:512
    v_fmac_f32 v68, v36, v44
    v_fmac_f32 v69, v37, v44
    v_fmac_f32 v70, v38, v44
    v_fmac_f32 v71, v39, v44
    v_mul_f32 v68, v68, v40
    v_mul_f32 v69, v69, v41
    v_mul_f32 v70, v70, v42
    v_mul_f32 v71, v71, v43
    v_cvt_pk_bf16_f32 v68, v68, v69
    v_cvt_pk_bf16_f32 v69, v70, v71
    ds_write_b64 v51, v[68:69] offset:0
    v_fmac_f32 v72, v36, v45
    v_fmac_f32 v73, v37, v45
    v_fmac_f32 v74, v38, v45
    v_fmac_f32 v75, v39, v45
    v_mul_f32 v72, v72, v40
    v_mul_f32 v73, v73, v41
    v_mul_f32 v74, v74, v42
    v_mul_f32 v75, v75, v43
    v_cvt_pk_bf16_f32 v72, v72, v73
    v_cvt_pk_bf16_f32 v73, v74, v75
    ds_write_b64 v51, v[72:73] offset:512
    v_mov_b32 v8, 157976
    v_mov_b32 v9, 1
    s_mov_b64 exec, 1
    ds_add_u32 v8, v9
    s_mov_b64 exec, -1
    s_waitcnt vmcnt(0)
Lrx_chk:
    v_and_b32 v52, s61, v52
    v_and_b32 v53, s61, v53
    v_and_b32 v54, s62, v54
    v_and_b32 v55, s62, v55
    v_max3_u32 v4, v52, v53, v54
    v_max_u32 v4, v4, v55
    v_cmp_eq_u32 vcc, -1, v4
    s_nop 0
    s_cbranch_vccnz Lrx_re
    v_add_f32 v92, v92, v52
    v_add_f32 v94, v94, v53
    v_add_f32 v104, v104, v54
    v_add_f32 v106, v106, v55
Lcw_4:
    s_sub_u32 s35, s35, 1
    s_cbranch_scc1 Lend
    ds_read_b32 v9, v8
    s_waitcnt lgkmcnt(0)
    v_readfirstlane_b32 s38, v9
    s_nop 0
    s_cmp_lt_u32 s38, 7
    s_cbranch_scc1 Lcw_4
    s_setprio 2
    ds_read2st64_b64 v[60:63], v125 offset0:0 offset1:4
    ds_read2st64_b64 v[64:67], v125 offset0:1 offset1:5
    ds_read2st64_b64 v[68:71], v125 offset0:2 offset1:6
    ds_read2st64_b64 v[72:75], v125 offset0:3 offset1:7
    v_mul_f32 v92, v92, v123
    v_mul_f32 v94, v94, v126
    v_mul_f32 v104, v104, v123
    v_mul_f32 v106, v106, v126
    v_max_f32 v4, v92, v94
    v_max_f32 v5, v104, v106
    v_mov_b32 v6, v4
    v_mov_b32 v7, v5
    s_nop 0
    v_permlane32_swap_b32 v4, v6
    v_permlane32_swap_b32 v5, v7
    v_max_f32 v4, v4, v6
    v_max_f32 v5, v5, v7
    s_waitcnt lgkmcnt(0)
    v_mov_b32 v6, v4
    v_mfma_f32_16x16x32_bf16 v[80:83], v[14:17], v[96:99], 0
    v_mov_b32 v7, v5
    v_permlane16_swap_b32 v4, v6
    s_nop 0
    v_permlane16_swap_b32 v5, v7
    v_max_f32 v4, v4, v6
    v_mfma_f32_16x16x32_bf16 v[84:87], v[14:17], v[100:103], 0
    v_max_f32 v5, v5, v7
    v_sub_f32 v92, v92, v4
    v_sub_f32 v94, v94, v4
    v_sub_f32 v104, v104, v5
    v_mfma_f32_16x16x32_bf16 v[28:31], v[60:63], v[96:99], 0
    v_sub_f32 v106, v106, v5
    v_exp_f32 v92, v92
    v_exp_f32 v94, v94
    v_exp_f32 v104, v104
    v_exp_f32 v106, v106
    v_mfma_f32_16x16x32_bf16 v[32:35], v[64:67], v[96:99], 0
    v_cvt_pk_bf16_f32 v92, v92, v92
    v_cvt_pk_bf16_f32 v93, v94, v94
    v_cvt_pk_bf16_f32 v104, v104, v104
    v_cvt_pk_bf16_f32 v105, v106, v106
    v_mfma_f32_16x16x32_bf16 v[36:39], v[68:71], v[100:103], 0
    v_and_b32 v94, v92, v118
    v_and_b32 v95, v93, v119
    v_and_b32 v92, v92, v116
    v_and_b32 v93, v93, v117
    v_mfma_f32_16x16x32_bf16 v[40:43], v[72:75], v[100:103], 0
    v_and_b32 v106, v104, v118
    v_and_b32 v107, v105, v119
    v_and_b32 v104, v104, v116
    v_and_b32 v105, v105, v117
    v_mfma_f32_16x16x32_bf16 v[76:79], v[14:17], v[92:95], 0
    v_rcp_f32 v80, v80
    v_rcp_f32 v84, v84
    v_mfma_f32_16x16x32_bf16 v[88:91], v[14:17], v[104:107], 0
    v_mul_f32 v28, v28, v80
    v_mul_f32 v29, v29, v80
    v_mfma_f32_16x16x32_bf16 v[44:47], v[64:67], v[92:95], 0
    v_mul_f32 v30, v30, v80
    v_mfma_f32_16x16x32_bf16 v[48:51], v[68:71], v[92:95], 0
    v_mul_f32 v31, v31, v80
    v_cvt_pk_bf16_f32 v4, v28, v29
    v_mfma_f32_16x16x32_bf16 v[52:55], v[64:67], v[104:107], 0
    v_cvt_pk_bf16_f32 v5, v30, v31
    v_min_u32 v4, -2, v4
    v_mfma_f32_16x16x32_bf16 v[56:59], v[68:71], v[104:107], 0
    v_min_u32 v5, -2, v5
    v_mul_f32 v40, v40, v84
    v_mul_f32 v41, v41, v84
    v_mul_f32 v42, v42, v84
    v_mul_f32 v43, v43, v84
    v_cvt_pk_bf16_f32 v10, v40, v41
    v_cvt_pk_bf16_f32 v11, v42, v43
    v_min_u32 v10, -2, v10
    v_min_u32 v11, -2, v11
    v_rcp_f32 v76, v76
    v_rcp_f32 v88, v88
    v_cndmask_b32 v82, v80, v76, s[6:7]
    v_cndmask_b32 v82, v82, v88, s[8:9]
    v_cndmask_b32 v32, v32, v44, s[6:7]
    v_cndmask_b32 v33, v33, v45, s[6:7]
    v_cndmask_b32 v34, v34, v46, s[6:7]
    v_cndmask_b32 v35, v35, v47, s[6:7]
    v_cndmask_b32 v32, v32, v52, s[8:9]
    v_cndmask_b32 v33, v33, v53, s[8:9]
    v_cndmask_b32 v34, v34, v54, s[8:9]
    v_cndmask_b32 v35, v35, v55, s[8:9]
    v_mul_f32 v32, v32, v82
    v_mul_f32 v33, v33, v82
    v_mul_f32 v34, v34, v82
    v_mul_f32 v35, v35, v82
    v_cvt_pk_bf16_f32 v6, v32, v33
    v_cvt_pk_bf16_f32 v7, v34, v35
    v_min_u32 v6, -2, v6
    v_min_u32 v7, -2, v7
    buffer_store_dwordx4 v[4:7], v13, s[28:31], s23 offen offset:0 sc1
    v_cndmask_b32 v86, v84, v76, s[12:13]
    v_cndmask_b32 v86, v86, v88, s[14:15]
    v_cndmask_b32 v36, v36, v48, s[12:13]
    v_cndmask_b32 v37, v37, v49, s[12:13]
    v_cndmask_b32 v38, v38, v50, s[12:13]
    v_cndmask_b32 v39, v39, v51, s[12:13]
    v_cndmask_b32 v36, v36, v56, s[14:15]
    v_cndmask_b32 v37, v37, v57, s[14:15]
    v_cndmask_b32 v38, v38, v58, s[14:15]
    v_cndmask_b32 v39, v39, v59, s[14:15]
    v_mul_f32 v36, v36, v86
    v_mul_f32 v37, v37, v86
    v_mul_f32 v38, v38, v86
    v_mul_f32 v39, v39, v86
    v_cvt_pk_bf16_f32 v8, v36, v37
    v_cvt_pk_bf16_f32 v9, v38, v39
    v_min_u32 v8, -2, v8
    v_min_u32 v9, -2, v9
    buffer_store_dwordx4 v[8:11], v13, s[28:31], s23 offen offset:1024 sc1
    s_setprio 1
    s_nop 0
    v_mov_b32 v10, 157980
    v_and_b32 v6, 3, v1
    v_lshl_add_u32 v6, v6, 3, v19
    v_add_u32 v20, v6, v18
    v_xor_b32 v21, 32, v20
    v_xor_b32 v22, 64, v20
    v_xor_b32 v23, 96, v20
    v_add_u32 v24, 63616, v20
    v_add_u32 v25, 63616, v21
    v_add_u32 v26, 63616, v22
    v_add_u32 v27, 63616, v23
Lcw_3:
    s_sub_u32 s35, s35, 1
    s_cbranch_scc1 Lend
    ds_read_b32 v11, v10
    s_waitcnt lgkmcnt(0)
    v_readfirstlane_b32 s38, v11
    s_nop 0
    s_cmp_lt_u32 s38, 2
    s_cbranch_scc1 Lcw_3
    s_mul_i32 s36, s32, 96
    s_lshl_b32 s37, s44, 4
    s_add_u32 s36, s36, s37
    s_sub_u32 s36, s36, 32
    v_add_u32 v126, s36, v3
    v_lshrrev_b32 v6, 3, v1
    v_add_u32 v6, s36, v6
    v_mul_u32_u24 v6, 1280, v6
    v_and_b32 v7, 7, v1
    v_xor_b32 v7, v7, v2
    v_lshl_add_u32 v122, v7, 4, v6
    v_xor_b32 v123, 64, v122
    v_add_u32 v123, 10240, v123
    s_lshl_b32 s36, s44, 11
    s_add_u32 s36, s36, 102656
    v_add_u32 v124, s36, v124
    v_add_u32 v125, s36, v13
    s_lshl_b32 s24, s33, 7
    v_mov_b32 v10, 157960
    s_mov_b32 s41, 0
    s_mov_b32 s47, 3
    v_lshlrev_b32 v28, 16, v108
    ds_read_b64_tr_b16 a[0:1], v20 offset:0
    ds_read_b64_tr_b16 a[2:3], v20 offset:512
    ds_read_b64_tr_b16 a[4:5], v21 offset:0
    ds_read_b64_tr_b16 a[6:7], v21 offset:512
    ds_read_b64_tr_b16 a[8:9], v22 offset:0
    ds_read_b64_tr_b16 a[10:11], v22 offset:512
    ds_read_b64_tr_b16 a[12:13], v23 offset:0
    ds_read_b64_tr_b16 a[14:15], v23 offset:512
    v_and_b32 v29, 0xffff0000, v108
    v_lshlrev_b32 v30, 16, v109
    v_and_b32 v31, 0xffff0000, v109
    v_lshlrev_b32 v32, 16, v110
    v_and_b32 v33, 0xffff0000, v110
    v_lshlrev_b32 v34, 16, v111
    v_and_b32 v35, 0xffff0000, v111
    v_lshlrev_b32 v36, 16, v112
    v_and_b32 v37, 0xffff0000, v112
    v_lshlrev_b32 v38, 16, v113
    v_and_b32 v39, 0xffff0000, v113
    v_lshlrev_b32 v40, 16, v114
    v_and_b32 v41, 0xffff0000, v114
    v_lshlrev_b32 v42, 16, v115
    ds_read_b64_tr_b16 a[16:17], v20 offset:4096
    ds_read_b64_tr_b16 a[18:19], v20 offset:4608
    ds_read_b64_tr_b16 a[20:21], v21 offset:4096
    ds_read_b64_tr_b16 a[22:23], v21 offset:4608
    ds_read_b64_tr_b16 a[24:25], v22 offset:4096
    ds_read_b64_tr_b16 a[26:27], v22 offset:4608
    ds_read_b64_tr_b16 a[28:29], v23 offset:4096
    ds_read_b64_tr_b16 a[30:31], v23 offset:4608
    v_and_b32 v43, 0xffff0000, v115
    v_mul_f32 v4, v120, v121
    v_mul_f32 v5, 0xbfb8aa3b, v121
    v_mul_f32 v6, 0xbfb8aa3b, v4
    v_fma_f32 v44, v28, v5, v6
    v_fma_f32 v45, v29, v5, v6
    v_fma_f32 v46, v30, v5, v6
    v_fma_f32 v47, v31, v5, v6
    v_fma_f32 v48, v32, v5, v6
    v_fma_f32 v49, v33, v5, v6
    v_fma_f32 v50, v34, v5, v6
    v_fma_f32 v51, v35, v5, v6
    v_fma_f32 v52, v36, v5, v6
    v_fma_f32 v53, v37, v5, v6
    ds_read_b64_tr_b16 a[32:33], v20 offset:8192
    ds_read_b64_tr_b16 a[34:35], v20 offset:8704
    ds_read_b64_tr_b16 a[36:37], v21 offset:8192
    ds_read_b64_tr_b16 a[38:39], v21 offset:8704
    ds_read_b64_tr_b16 a[40:41], v22 offset:8192
    ds_read_b64_tr_b16 a[42:43], v22 offset:8704
    ds_read_b64_tr_b16 a[44:45], v23 offset:8192
    ds_read_b64_tr_b16 a[46:47], v23 offset:8704
    v_fma_f32 v54, v38, v5, v6
    v_fma_f32 v55, v39, v5, v6
    v_fma_f32 v56, v40, v5, v6
    v_fma_f32 v57, v41, v5, v6
    v_fma_f32 v58, v42, v5, v6
    v_fma_f32 v59, v43, v5, v6
    v_exp_f32 v44, v44
    v_exp_f32 v45, v45
    v_exp_f32 v46, v46
    v_exp_f32 v47, v47
    v_exp_f32 v48, v48
    v_exp_f32 v49, v49
    v_exp_f32 v50, v50
    v_exp_f32 v51, v51
    v_exp_f32 v52, v52
    ds_read_b64_tr_b16 a[48:49], v20 offset:12288
    ds_read_b64_tr_b16 a[50:51], v20 offset:12800
    ds_read_b64_tr_b16 a[52:53], v21 offset:12288
    ds_read_b64_tr_b16 a[54:55], v21 offset:12800
    ds_read_b64_tr_b16 a[56:57], v22 offset:12288
    ds_read_b64_tr_b16 a[58:59], v22 offset:12800
    ds_read_b64_tr_b16 a[60:61], v23 offset:12288
    ds_read_b64_tr_b16 a[62:63], v23 offset:12800
    v_exp_f32 v53, v53
    v_exp_f32 v54, v54
    v_exp_f32 v55, v55
    v_exp_f32 v56, v56
    v_exp_f32 v57, v57
    v_exp_f32 v58, v58
    v_exp_f32 v59, v59
    v_fma_f32 v92, v28, v121, v4
    v_fma_f32 v93, v29, v121, v4
    v_fma_f32 v94, v30, v121, v4
    v_fma_f32 v95, v31, v121, v4
    v_fma_f32 v96, v32, v121, v4
    v_fma_f32 v97, v33, v121, v4
    v_fma_f32 v98, v34, v121, v4
    ds_read_b64_tr_b16 a[64:65], v20 offset:24576
    ds_read_b64_tr_b16 a[66:67], v20 offset:25088
    ds_read_b64_tr_b16 a[68:69], v21 offset:24576
    ds_read_b64_tr_b16 a[70:71], v21 offset:25088
    ds_read_b64_tr_b16 a[72:73], v22 offset:24576
    ds_read_b64_tr_b16 a[74:75], v22 offset:25088
    ds_read_b64_tr_b16 a[76:77], v23 offset:24576
    ds_read_b64_tr_b16 a[78:79], v23 offset:25088
    v_fma_f32 v99, v35, v121, v4
    v_fma_f32 v100, v36, v121, v4
    v_fma_f32 v101, v37, v121, v4
    v_fma_f32 v102, v38, v121, v4
    v_fma_f32 v103, v39, v121, v4
    v_fma_f32 v104, v40, v121, v4
    v_fma_f32 v105, v41, v121, v4
    v_fma_f32 v106, v42, v121, v4
    v_fma_f32 v107, v43, v121, v4
    v_add_f32 v44, 1.0, v44
    v_add_f32 v45, 1.0, v45
    v_add_f32 v46, 1.0, v46
    v_add_f32 v47, 1.0, v47
    v_add_f32 v48, 1.0, v48
    ds_read_b64_tr_b16 a[80:81], v20 offset:28672
    ds_read_b64_tr_b16 a[82:83], v20 offset:29184
    ds_read_b64_tr_b16 a[84:85], v21 offset:28672
    ds_read_b64_tr_b16 a[86:87], v21 offset:29184
    ds_read_b64_tr_b16 a[88:89], v22 offset:28672
    ds_read_b64_tr_b16 a[90:91], v22 offset:29184
    ds_read_b64_tr_b16 a[92:93], v23 offset:28672
    ds_read_b64_tr_b16 a[94:95], v23 offset:29184
    v_add_f32 v49, 1.0, v49
    v_add_f32 v50, 1.0, v50
    v_add_f32 v51, 1.0, v51
    v_add_f32 v52, 1.0, v52
    v_add_f32 v53, 1.0, v53
    v_add_f32 v54, 1.0, v54
    v_add_f32 v55, 1.0, v55
    v_add_f32 v56, 1.0, v56
    v_add_f32 v57, 1.0, v57
    v_add_f32 v58, 1.0, v58
    v_add_f32 v59, 1.0, v59
    v_rcp_f32 v44, v44
    v_rcp_f32 v45, v45
    v_rcp_f32 v46, v46
    v_rcp_f32 v47, v47
    ds_read_b64_tr_b16 a[96:97], v24 offset:59520
    ds_read_b64_tr_b16 a[98:99], v24 offset:60032
    ds_read_b64_tr_b16 a[100:101], v25 offset:59520
    ds_read_b64_tr_b16 a[102:103], v25 offset:60032
    ds_read_b64_tr_b16 a[104:105], v26 offset:59520
    ds_read_b64_tr_b16 a[106:107], v26 offset:60032
    ds_read_b64_tr_b16 a[108:109], v27 offset:59520
    ds_read_b64_tr_b16 a[110:111], v27 offset:60032
    v_rcp_f32 v48, v48
    v_rcp_f32 v49, v49
    v_rcp_f32 v50, v50
    v_rcp_f32 v51, v51
    v_rcp_f32 v52, v52
    v_rcp_f32 v53, v53
    v_rcp_f32 v54, v54
    v_rcp_f32 v55, v55
    v_rcp_f32 v56, v56
    v_rcp_f32 v57, v57
    v_rcp_f32 v58, v58
    v_rcp_f32 v59, v59
    v_mul_f32 v44, v44, v92
    v_mul_f32 v45, v45, v93
    ds_read_b64_tr_b16 a[112:113], v24 offset:63616
    ds_read_b64_tr_b16 a[114:115], v24 offset:64128
    ds_read_b64_tr_b16 a[116:117], v25 offset:63616
    ds_read_b64_tr_b16 a[118:119], v25 offset:64128
    ds_read_b64_tr_b16 a[120:121], v26 offset:63616
    ds_read_b64_tr_b16 a[122:123], v26 offset:64128
    ds_read_b64_tr_b16 a[124:125], v27 offset:63616
    ds_read_b64_tr_b16 a[126:127], v27 offset:64128
    v_mul_f32 v46, v46, v94
    v_mul_f32 v47, v47, v95
    v_mul_f32 v48, v48, v96
    v_mul_f32 v49, v49, v97
    v_mul_f32 v50, v50, v98
    v_mul_f32 v51, v51, v99
    v_mul_f32 v52, v52, v100
    v_mul_f32 v53, v53, v101
    v_mul_f32 v54, v54, v102
    v_mul_f32 v55, v55, v103
    v_mul_f32 v56, v56, v104
    v_mul_f32 v57, v57, v105
    v_mul_f32 v58, v58, v106
    v_mul_f32 v59, v59, v107
    buffer_load_dwordx4 v[60:63], v13, s[28:31], s53 offen offset:0 sc1
    buffer_load_dwordx4 v[64:67], v13, s[28:31], s53 offen offset:1024 sc1
    buffer_load_dwordx4 v[68:71], v13, s[28:31], s53 offen offset:2048 sc1
    buffer_load_dwordx4 v[72:75], v13, s[28:31], s53 offen offset:3072 sc1
    buffer_load_dwordx4 v[76:79], v13, s[28:31], s54 offen offset:0 sc1
    buffer_load_dwordx4 v[80:83], v13, s[28:31], s54 offen offset:1024 sc1
    buffer_load_dwordx4 v[84:87], v13, s[28:31], s54 offen offset:2048 sc1
    buffer_load_dwordx4 v[88:91], v13, s[28:31], s54 offen offset:3072 sc1
    s_setprio 0
Lwo_go:
    s_setprio 3
    ds_read_b64 v[8:9], v10
    s_waitcnt vmcnt(6)
    v_max3_u32 v4, v60, v61, v62
    v_max3_u32 v5, v64, v65, v66
    v_max3_u32 v4, v4, v63, v67
    v_max_u32 v4, v4, v5
    v_cmp_eq_u32 vcc, -1, v4
    s_nop 0
    s_cbranch_vccnz Lre_0
Lck_0:
    s_waitcnt lgkmcnt(15)
    v_mfma_f32_16x16x32_bf16 v[108:111], a[0:3], v[60:63], 0
    ds_read_b64_tr_b16 a[0:1], v24 offset:16384
    ds_read_b64_tr_b16 a[2:3], v24 offset:16896
    buffer_load_dwordx4 v[92:95], v13, s[28:31], s55 offen offset:0 sc1
    v_mfma_f32_16x16x32_bf16 v[112:115], a[4:7], v[60:63], 0
    ds_read_b64_tr_b16 a[4:5], v25 offset:16384
    ds_read_b64_tr_b16 a[6:7], v25 offset:16896
    v_mfma_f32_16x16x32_bf16 v[116:119], a[8:11], v[60:63], 0
    ds_read_b64_tr_b16 a[8:9], v26 offset:16384
    ds_read_b64_tr_b16 a[10:11], v26 offset:16896
    buffer_load_dwordx4 v[96:99], v13, s[28:31], s55 offen offset:1024 sc1
    v_mfma_f32_16x16x32_bf16 v[14:17], a[12:15], v[60:63], 0
    ds_read_b64_tr_b16 a[12:13], v27 offset:16384
    ds_read_b64_tr_b16 a[14:15], v27 offset:16896
    v_mfma_f32_16x16x32_bf16 v[108:111], a[16:19], v[64:67], v[108:111]
    ds_read_b64_tr_b16 a[16:17], v24 offset:20480
    ds_read_b64_tr_b16 a[18:19], v24 offset:20992
    s_waitcnt vmcnt(6)
    v_max3_u32 v4, v68, v69, v70
    v_mfma_f32_16x16x32_bf16 v[112:115], a[20:23], v[64:67], v[112:115]
    ds_read_b64_tr_b16 a[20:21], v25 offset:20480
    ds_read_b64_tr_b16 a[22:23], v25 offset:20992
    v_max3_u32 v5, v72, v73, v74
    v_max3_u32 v4, v4, v71, v75
    v_mfma_f32_16x16x32_bf16 v[116:119], a[24:27], v[64:67], v[116:119]
    ds_read_b64_tr_b16 a[24:25], v26 offset:20480
    ds_read_b64_tr_b16 a[26:27], v26 offset:20992
    v_max_u32 v4, v4, v5
    v_cmp_eq_u32 vcc, -1, v4
    v_mfma_f32_16x16x32_bf16 v[14:17], a[28:31], v[64:67], v[14:17]
    ds_read_b64_tr_b16 a[28:29], v27 offset:20480
    ds_read_b64_tr_b16 a[30:31], v27 offset:20992
    s_cbranch_vccnz Lre_1
Lck_1:
    s_waitcnt lgkmcnt(15)
Linfo:
    v_readfirstlane_b32 s39, v8
    s_nop 0
    s_cmp_eq_u32 s39, -2
    s_cbranch_scc1 Linfo_re
    v_mfma_f32_16x16x32_bf16 v[108:111], a[32:35], v[68:71], v[108:111]
    ds_read_b64_tr_b16 a[32:33], v20 offset:32768
    ds_read_b64_tr_b16 a[34:35], v20 offset:33280
    buffer_load_dwordx4 v[100:103], v13, s[28:31], s55 offen offset:2048 sc1
    v_mfma_f32_16x16x32_bf16 v[112:115], a[36:39], v[68:71], v[112:115]
    ds_read_b64_tr_b16 a[36:37], v21 offset:32768
    ds_read_b64_tr_b16 a[38:39], v21 offset:33280
    v_mfma_f32_16x16x32_bf16 v[116:119], a[40:43], v[68:71], v[116:119]
    ds_read_b64_tr_b16 a[40:41], v22 offset:32768
    ds_read_b64_tr_b16 a[42:43], v22 offset:33280
    buffer_load_dwordx4 v[104:107], v13, s[28:31], s55 offen offset:3072 sc1
    v_mfma_f32_16x16x32_bf16 v[14:17], a[44:47], v[68:71], v[14:17]
    ds_read_b64_tr_b16 a[44:45], v23 offset:32768
    ds_read_b64_tr_b16 a[46:47], v23 offset:33280
    v_mfma_f32_16x16x32_bf16 v[108:111], a[48:51], v[72:75], v[108:111]
    ds_read_b64_tr_b16 a[48:49], v20 offset:36864
    ds_read_b64_tr_b16 a[50:51], v20 offset:37376
    s_waitcnt vmcnt(6)
    v_max3_u32 v4, v76, v77, v78
    v_mfma_f32_16x16x32_bf16 v[112:115], a[52:55], v[72:75], v[112:115]
    ds_read_b64_tr_b16 a[52:53], v21 offset:36864
    ds_read_b64_tr_b16 a[54:55], v21 offset:37376
    v_max3_u32 v5, v80, v81, v82
    v_max3_u32 v4, v4, v79, v83
    v_mfma_f32_16x16x32_bf16 v[116:119], a[56:59], v[72:75], v[116:119]
    ds_read_b64_tr_b16 a[56:57], v22 offset:36864
    ds_read_b64_tr_b16 a[58:59], v22 offset:37376
    v_max_u32 v4, v4, v5
    v_cmp_eq_u32 vcc, -1, v4
    v_mfma_f32_16x16x32_bf16 v[14:17], a[60:63], v[72:75], v[14:17]
    ds_read_b64_tr_b16 a[60:61], v23 offset:36864
    ds_read_b64_tr_b16 a[62:63], v23 offset:37376
    s_cbranch_vccnz Lre_2
Lck_2:
    v_mfma_f32_16x16x32_bf16 v[108:111], a[64:67], v[76:79], v[108:111]
    ds_read_b64_tr_b16 a[64:65], v20 offset:40960
    ds_read_b64_tr_b16 a[66:67], v20 offset:41472
    buffer_load_dwordx4 v[60:63], v13, s[28:31], s56 offen offset:0 sc1
    v_mfma_f32_16x16x32_bf16 v[112:115], a[68:71], v[76:79], v[112:115]
    ds_read_b64_tr_b16 a[68:69], v21 offset:40960
    ds_read_b64_tr_b16 a[70:71], v21 offset:41472
    v_mfma_f32_16x16x32_bf16 v[116:119], a[72:75], v[76:79], v[116:119]
    ds_read_b64_tr_b16 a[72:73], v22 offset:40960
    ds_read_b64_tr_b16 a[74:75], v22 offset:41472
    buffer_load_dwordx4 v[64:67], v13, s[28:31], s56 offen offset:1024 sc1
    v_mfma_f32_16x16x32_bf16 v[14:17], a[76:79], v[76:79], v[14:17]
    ds_read_b64_tr_b16 a[76:77], v23 offset:40960
    ds_read_b64_tr_b16 a[78:79], v23 offset:41472
    v_mfma_f32_16x16x32_bf16 v[108:111], a[80:83], v[80:83], v[108:111]
    ds_read_b64_tr_b16 a[80:81], v20 offset:45056
    ds_read_b64_tr_b16 a[82:83], v20 offset:45568
    s_waitcnt vmcnt(6)
    v_max3_u32 v4, v84, v85, v86
    v_mfma_f32_16x16x32_bf16 v[112:115], a[84:87], v[80:83], v[112:115]
    ds_read_b64_tr_b16 a[84:85], v21 offset:45056
    ds_read_b64_tr_b16 a[86:87], v21 offset:45568
    v_max3_u32 v5, v88, v89, v90
    v_max3_u32 v4, v4, v87, v91
    v_mfma_f32_16x16x32_bf16 v[116:119], a[88:91], v[80:83], v[116:119]
    ds_read_b64_tr_b16 a[88:89], v22 offset:45056
    ds_read_b64_tr_b16 a[90:91], v22 offset:45568
    v_max_u32 v4, v4, v5
    v_cmp_eq_u32 vcc, -1, v4
    v_mfma_f32_16x16x32_bf16 v[14:17], a[92:95], v[80:83], v[14:17]
    ds_read_b64_tr_b16 a[92:93], v23 offset:45056
    ds_read_b64_tr_b16 a[94:95], v23 offset:45568
    s_cbranch_vccnz Lre_3
Lck_3:
    s_setprio 2
    v_mfma_f32_16x16x32_bf16 v[108:111], a[96:99], v[84:87], v[108:111]
    ds_read_b64_tr_b16 a[96:97], v24 offset:0
    ds_read_b64_tr_b16 a[98:99], v24 offset:512
    buffer_load_dwordx4 v[68:71], v13, s[28:31], s56 offen offset:2048 sc1
    v_mfma_f32_16x16x32_bf16 v[112:115], a[100:103], v[84:87], v[112:115]
    ds_read_b64_tr_b16 a[100:101], v25 offset:0
    ds_read_b64_tr_b16 a[102:103], v25 offset:512
    v_mfma_f32_16x16x32_bf16 v[116:119], a[104:107], v[84:87], v[116:119]
    ds_read_b64_tr_b16 a[104:105], v26 offset:0
    ds_read_b64_tr_b16 a[106:107], v26 offset:512
    buffer_load_dwordx4 v[72:75], v13, s[28:31], s56 offen offset:3072 sc1
    v_mfma_f32_16x16x32_bf16 v[14:17], a[108:111], v[84:87], v[14:17]
    ds_read_b64_tr_b16 a[108:109], v27 offset:0
    ds_read_b64_tr_b16 a[110:111], v27 offset:512
    v_mfma_f32_16x16x32_bf16 v[108:111], a[112:115], v[88:91], v[108:111]
    ds_read_b64_tr_b16 a[112:113], v24 offset:4096
    ds_read_b64_tr_b16 a[114:115], v24 offset:4608
    s_waitcnt vmcnt(6)
    v_max3_u32 v4, v92, v93, v94
    v_mfma_f32_16x16x32_bf16 v[112:115], a[116:119], v[88:91], v[112:115]
    ds_read_b64_tr_b16 a[116:117], v25 offset:4096
    ds_read_b64_tr_b16 a[118:119], v25 offset:4608
    v_max3_u32 v5, v96, v97, v98
    v_max3_u32 v4, v4, v95, v99
    v_mfma_f32_16x16x32_bf16 v[116:119], a[120:123], v[88:91], v[116:119]
    ds_read_b64_tr_b16 a[120:121], v26 offset:4096
    ds_read_b64_tr_b16 a[122:123], v26 offset:4608
    v_max_u32 v4, v4, v5
    v_cmp_eq_u32 vcc, -1, v4
    v_mfma_f32_16x16x32_bf16 v[14:17], a[124:127], v[88:91], v[14:17]
    ds_read_b64_tr_b16 a[124:125], v27 offset:4096
    ds_read_b64_tr_b16 a[126:127], v27 offset:4608
    s_cbranch_vccnz Lre_4
Lck_4:
    s_waitcnt lgkmcnt(15)
    v_mfma_f32_16x16x32_bf16 v[108:111], a[0:3], v[92:95], v[108:111]
    ds_read_b64_tr_b16 a[0:1], v24 offset:8192
    ds_read_b64_tr_b16 a[2:3], v24 offset:8704
    buffer_load_dwordx4 v[76:79], v13, s[28:31], s57 offen offset:0 sc1
    v_mfma_f32_16x16x32_bf16 v[112:115], a[4:7], v[92:95], v[112:115]
    ds_read_b64_tr_b16 a[4:5], v25 offset:8192
    ds_read_b64_tr_b16 a[6:7], v25 offset:8704
    v_mfma_f32_16x16x32_bf16 v[116:119], a[8:11], v[92:95], v[116:119]
    ds_read_b64_tr_b16 a[8:9], v26 offset:8192
    ds_read_b64_tr_b16 a[10:11], v26 offset:8704
    buffer_load_dwordx4 v[80:83], v13, s[28:31], s57 offen offset:1024 sc1
    v_mfma_f32_16x16x32_bf16 v[14:17], a[12:15], v[92:95], v[14:17]
    ds_read_b64_tr_b16 a[12:13], v27 offset:8192
    ds_read_b64_tr_b16 a[14:15], v27 offset:8704
    v_mfma_f32_16x16x32_bf16 v[108:111], a[16:19], v[96:99], v[108:111]
    ds_read_b64_tr_b16 a[16:17], v24 offset:12288
    ds_read_b64_tr_b16 a[18:19], v24 offset:12800
    s_waitcnt vmcnt(6)
    v_max3_u32 v4, v100, v101, v102
    v_mfma_f32_16x16x32_bf16 v[112:115], a[20:23], v[96:99], v[112:115]
    ds_read_b64_tr_b16 a[20:21], v25 offset:12288
    ds_read_b64_tr_b16 a[22:23], v25 offset:12800
    v_max3_u32 v5, v104, v105, v106
    v_max3_u32 v4, v4, v103, v107
    v_mfma_f32_16x16x32_bf16 v[116:119], a[24:27], v[96:99], v[116:119]
    ds_read_b64_tr_b16 a[24:25], v26 offset:12288
    ds_read_b64_tr_b16 a[26:27], v26 offset:12800
    v_max_u32 v4, v4, v5
    v_cmp_eq_u32 vcc, -1, v4
    v_mfma_f32_16x16x32_bf16 v[14:17], a[28:31], v[96:99], v[14:17]
    ds_read_b64_tr_b16 a[28:29], v27 offset:12288
    ds_read_b64_tr_b16 a[30:31], v27 offset:12800
    s_cbranch_vccnz Lre_5
Lck_5:
    v_mfma_f32_16x16x32_bf16 v[108:111], a[32:35], v[100:103], v[108:111]
    ds_read_b64_tr_b16 a[32:33], v20 offset:49152
    ds_read_b64_tr_b16 a[34:35], v20 offset:49664
    buffer_load_dwordx4 v[84:87], v13, s[28:31], s57 offen offset:2048 sc1
    v_mfma_f32_16x16x32_bf16 v[112:115], a[36:39], v[100:103], v[112:115]
    ds_read_b64_tr_b16 a[36:37], v21 offset:49152
    ds_read_b64_tr_b16 a[38:39], v21 offset:49664
    v_mfma_f32_16x16x32_bf16 v[116:119], a[40:43], v[100:103], v[116:119]
    ds_read_b64_tr_b16 a[40:41], v22 offset:49152
    ds_read_b64_tr_b16 a[42:43], v22 offset:49664
    buffer_load_dwordx4 v[88:91], v13, s[28:31], s57 offen offset:3072 sc1
    v_mfma_f32_16x16x32_bf16 v[14:17], a[44:47], v[100:103], v[14:17]
    ds_read_b64_tr_b16 a[44:45], v23 offset:49152
    ds_read_b64_tr_b16 a[46:47], v23 offset:49664
    v_mfma_f32_16x16x32_bf16 v[108:111], a[48:51], v[104:107], v[108:111]
    ds_read_b64_tr_b16 a[48:49], v24 offset:24576
    ds_read_b64_tr_b16 a[50:51], v24 offset:25088
    s_waitcnt vmcnt(6)
    v_max3_u32 v4, v60, v61, v62
    v_mfma_f32_16x16x32_bf16 v[112:115], a[52:55], v[104:107], v[112:115]
    ds_read_b64_tr_b16 a[52:53], v25 offset:24576
    ds_read_b64_tr_b16 a[54:55], v25 offset:25088
    v_max3_u32 v5, v64, v65, v66
    v_max3_u32 v4, v4, v63, v67
    v_mfma_f32_16x16x32_bf16 v[116:119], a[56:59], v[104:107], v[116:119]
    ds_read_b64_tr_b16 a[56:57], v26 offset:24576
    ds_read_b64_tr_b16 a[58:59], v26 offset:25088
    v_max_u32 v4, v4, v5
    v_cmp_eq_u32 vcc, -1, v4
    v_mfma_f32_16x16x32_bf16 v[14:17], a[60:63], v[104:107], v[14:17]
    ds_read_b64_tr_b16 a[60:61], v27 offset:24576
    ds_read_b64_tr_b16 a[62:63], v27 offset:25088
    s_cbranch_vccnz Lre_6
Lck_6:
    s_setprio 1
    v_mfma_f32_16x16x32_bf16 v[108:111], a[64:67], v[60:63], v[108:111]
    v_mfma_f32_16x16x32_bf16 v[112:115], a[68:71], v[60:63], v[112:115]
    v_mfma_f32_16x16x32_bf16 v[116:119], a[72:75], v[60:63], v[116:119]
    v_mfma_f32_16x16x32_bf16 v[14:17], a[76:79], v[60:63], v[14:17]
    v_mfma_f32_16x16x32_bf16 v[108:111], a[80:83], v[64:67], v[108:111]
    s_waitcnt vmcnt(4)
    v_max3_u32 v4, v68, v69, v70
    v_mfma_f32_16x16x32_bf16 v[112:115], a[84:87], v[64:67], v[112:115]
    v_max3_u32 v5, v72, v73, v74
    v_max3_u32 v4, v4, v71, v75
    v_mfma_f32_16x16x32_bf16 v[116:119], a[88:91], v[64:67], v[116:119]
    v_max_u32 v4, v4, v5
    v_cmp_eq_u32 vcc, -1, v4
    v_mfma_f32_16x16x32_bf16 v[14:17], a[92:95], v[64:67], v[14:17]
    s_cbranch_vccnz Lre_7
Lck_7:
    s_waitcnt lgkmcnt(15)
    v_mfma_f32_16x16x32_bf16 v[108:111], a[96:99], v[68:71], v[108:111]
    v_mfma_f32_16x16x32_bf16 v[112:115], a[100:103], v[68:71], v[112:115]
    v_mfma_f32_16x16x32_bf16 v[116:119], a[104:107], v[68:71], v[116:119]
    v_mfma_f32_16x16x32_bf16 v[14:17], a[108:111], v[68:71], v[14:17]
    v_mfma_f32_16x16x32_bf16 v[108:111], a[112:115], v[72:75], v[108:111]
    s_waitcnt vmcnt(2)
    v_max3_u32 v4, v76, v77, v78
    v_mfma_f32_16x16x32_bf16 v[112:115], a[116:119], v[72:75], v[112:115]
    v_max3_u32 v5, v80, v81, v82
    v_max3_u32 v4, v4, v79, v83
    v_mfma_f32_16x16x32_bf16 v[116:119], a[120:123], v[72:75], v[116:119]
    v_max_u32 v4, v4, v5
    v_cmp_eq_u32 vcc, -1, v4
    v_mfma_f32_16x16x32_bf16 v[14:17], a[124:127], v[72:75], v[14:17]
    s_cbranch_vccnz Lre_8
Lck_8:
    s_setprio 0
    v_mfma_f32_16x16x32_bf16 v[108:111], a[0:3], v[76:79], v[108:111]
    v_mfma_f32_16x16x32_bf16 v[112:115], a[4:7], v[76:79], v[112:115]
    v_mfma_f32_16x16x32_bf16 v[116:119], a[8:11], v[76:79], v[116:119]
    v_mfma_f32_16x16x32_bf16 v[14:17], a[12:15], v[76:79], v[14:17]
    v_mfma_f32_16x16x32_bf16 v[108:111], a[16:19], v[80:83], v[108:111]
    s_waitcnt vmcnt(0)
    v_max3_u32 v4, v84, v85, v86
    v_mfma_f32_16x16x32_bf16 v[112:115], a[20:23], v[80:83], v[112:115]
    v_max3_u32 v5, v88, v89, v90
    v_max3_u32 v4, v4, v87, v91
    v_mfma_f32_16x16x32_bf16 v[116:119], a[24:27], v[80:83], v[116:119]
    v_max_u32 v4, v4, v5
    v_cmp_eq_u32 vcc, -1, v4
    v_mfma_f32_16x16x32_bf16 v[14:17], a[28:31], v[80:83], v[14:17]
    s_cbranch_vccnz Lre_9
Lck_9:
    s_waitcnt lgkmcnt(8)
    v_mfma_f32_16x16x32_bf16 v[108:111], a[32:35], v[84:87], v[108:111]
    v_mfma_f32_16x16x32_bf16 v[112:115], a[36:39], v[84:87], v[112:115]
    v_mfma_f32_16x16x32_bf16 v[116:119], a[40:43], v[84:87], v[116:119]
    v_mfma_f32_16x16x32_bf16 v[14:17], a[44:47], v[84:87], v[14:17]
    s_waitcnt lgkmcnt(0)
    v_mfma_f32_16x16x32_bf16 v[108:111], a[48:51], v[88:91], v[108:111]
    v_mfma_f32_16x16x32_bf16 v[112:115], a[52:55], v[88:91], v[112:115]
    v_mfma_f32_16x16x32_bf16 v[116:119], a[56:59], v[88:91], v[116:119]
    v_mfma_f32_16x16x32_bf16 v[14:17], a[60:63], v[88:91], v[14:17]
    v_xor_b32 v60, 32, v124
    v_xor_b32 v61, 64, v124
    v_xor_b32 v62, 96, v124
    v_cmp_eq_u32 s[36:37], v8, v126
    v_cmp_eq_u32 s[38:39], v9, v126
    s_nop 0
    s_or_b64 vcc, s[36:37], s[38:39]
    s_cbranch_scc1 Lfix
Lnofix:
    v_fma_f32 v108, v108, v44, v28
    v_fma_f32 v109, v109, v45, v29
    v_fma_f32 v110, v110, v46, v30
    v_fma_f32 v111, v111, v47, v31
    v_cvt_pk_bf16_f32 v68, v108, v109
    v_cvt_pk_bf16_f32 v69, v110, v111
    ds_write_b64 v124, v[68:69]
    v_fma_f32 v112, v112, v48, v32
    v_fma_f32 v113, v113, v49, v33
    v_fma_f32 v114, v114, v50, v34
    v_fma_f32 v115, v115, v51, v35
    v_cvt_pk_bf16_f32 v70, v112, v113
    v_cvt_pk_bf16_f32 v71, v114, v115
    ds_write_b64 v60, v[70:71]
    v_fma_f32 v116, v116, v52, v36
    v_fma_f32 v117, v117, v53, v37
    v_fma_f32 v118, v118, v54, v38
    v_fma_f32 v119, v119, v55, v39
    v_cvt_pk_bf16_f32 v72, v116, v117
    v_cvt_pk_bf16_f32 v73, v118, v119
    ds_write_b64 v61, v[72:73]
    v_fma_f32 v14, v14, v56, v40
    v_fma_f32 v15, v15, v57, v41
    v_fma_f32 v16, v16, v58, v42
    v_fma_f32 v17, v17, v59, v43
    v_cvt_pk_bf16_f32 v74, v14, v15
    v_cvt_pk_bf16_f32 v75, v16, v17
    ds_write_b64 v62, v[74:75]
    ds_read_b128 v[76:79], v125 offset:0
    ds_read_b128 v[80:83], v125 offset:1024
    s_waitcnt lgkmcnt(1)
    buffer_store_dwordx4 v[76:79], v122, s[48:51], s24 offen
    s_waitcnt lgkmcnt(0)
    buffer_store_dwordx4 v[80:83], v123, s[48:51], s24 offen
    s_endpgm
Lh1:
    ds_write_b128 v125, v[44:47] offset:0
    ds_write_b128 v125, v[48:51] offset:1024
    v_mov_b32 v5, 157972
    v_mov_b32 v6, 1
    s_mov_b64 exec, 1
    ds_add_u32 v5, v6
    s_mov_b64 exec, -1
    v_fmac_f32 v28, v76, v120
    v_fmac_f32 v29, v77, v120
    v_fmac_f32 v30, v78, v120
    v_fmac_f32 v31, v79, v120
    v_cvt_pk_bf16_f32 v28, v28, v29
    v_cvt_pk_bf16_f32 v29, v30, v31
    v_fmac_f32 v32, v80, v120
    v_fmac_f32 v33, v81, v120
    v_fmac_f32 v34, v82, v120
    v_fmac_f32 v35, v83, v120
    v_cvt_pk_bf16_f32 v30, v32, v33
    v_cvt_pk_bf16_f32 v31, v34, v35
    v_fmac_f32 v36, v84, v120
    v_fmac_f32 v37, v85, v120
    v_fmac_f32 v38, v86, v120
    v_fmac_f32 v39, v87, v120
    v_cvt_pk_bf16_f32 v32, v36, v37
    v_cvt_pk_bf16_f32 v33, v38, v39
    v_fmac_f32 v40, v88, v120
    v_fmac_f32 v41, v89, v120
    v_fmac_f32 v42, v90, v120
    v_fmac_f32 v43, v91, v120
    v_cvt_pk_bf16_f32 v34, v40, v41
    v_cvt_pk_bf16_f32 v35, v42, v43
    v_subrev_u32 v4, 6144, v125
    v_mov_b32 v8, s22
    v_mov_b32 v9, s22
    v_mov_b32 v10, s22
    v_mov_b32 v11, s22
Lcw_2:
    s_sub_u32 s35, s35, 1
    s_cbranch_scc1 Lend
    ds_read_b32 v6, v5
    s_waitcnt lgkmcnt(0)
    v_readfirstlane_b32 s38, v6
    s_nop 0
    s_cmp_lt_u32 s38, 8
    s_cbranch_scc1 Lcw_2
    ds_read_b128 v[52:55], v125 offset:2048
    ds_read_b128 v[56:59], v125 offset:3072
    ds_read_b128 v[44:47], v4 offset:4096
    ds_read_b128 v[48:51], v4 offset:5120
    s_branch Lh_join
Lqf_re:
    s_sub_u32 s35, s35, 1
    s_cbranch_scc1 Lend
    ds_read_b32 v7, v96
    ds_read_b128 v[76:79], v95 offset:0
    ds_read_b128 v[80:83], v95 offset:64
    ds_read_b128 v[84:87], v95 offset:128
    ds_read_b128 v[88:91], v95 offset:192
    s_waitcnt lgkmcnt(0)
    s_branch Lqf
Lcsv_re:
    s_sub_u32 s35, s35, 1
    s_cbranch_scc1 Lend
    ds_read_b32 v46, v49
    ds_read_b64 v[44:45], v48
    s_waitcnt lgkmcnt(0)
    s_branch Lcsv
Lrx_re:
    s_sub_u32 s35, s35, 1
    s_cbranch_scc1 Lend
    buffer_load_dwordx2 v[52:53], v13, s[28:31], s59 offen offset:8 sc1
    buffer_load_dwordx2 v[54:55], v13, s[28:31], s60 offen offset:0 sc1
    s_waitcnt vmcnt(0)
    s_branch Lrx_chk
Linfo_re:
    s_sub_u32 s35, s35, 1
    s_cbranch_scc1 Lend
    ds_read_b64 v[8:9], v10
    s_waitcnt lgkmcnt(0)
    s_branch Linfo
Lfl_re:
    s_sub_u32 s35, s35, 1
    s_cbranch_scc1 Lend
    buffer_load_dword v20, v12, s[28:31], s24 offen sc1
    s_waitcnt vmcnt(0)
    s_branch Lfl_chk
Lxe0:
    ds_read_b64 v[108:109], v4
    ds_read_b64 v[110:111], v5
    ds_read_b64 v[112:113], v6
    ds_read_b64 v[114:115], v7
    s_branch Lxe0_b
Lxe1:
    ds_read_b64 v[108:109], v4
    ds_read_b64 v[110:111], v5
    ds_read_b64 v[112:113], v6
    ds_read_b64 v[114:115], v7
    s_branch Lxe1_b
Lxe2:
    ds_read_b64 v[108:109], v4
    ds_read_b64 v[110:111], v5
    ds_read_b64 v[112:113], v6
    ds_read_b64 v[114:115], v7
    s_branch Lxe2_b
Lxe3:
    ds_read_b64 v[108:109], v4
    ds_read_b64 v[110:111], v5
    ds_read_b64 v[112:113], v6
    ds_read_b64 v[114:115], v7
    s_branch Lxe3_b
Lxe4:
    ds_read_b64 v[108:109], v4
    ds_read_b64 v[110:111], v5
    ds_read_b64 v[112:113], v6
    ds_read_b64 v[114:115], v7
    s_branch Lxe4_b
Lxe5:
    ds_read_b64 v[108:109], v4
    ds_read_b64 v[110:111], v5
    ds_read_b64 v[112:113], v6
    ds_read_b64 v[114:115], v7
    s_branch Lxe5_b
Lxe6:
    ds_read_b64 v[108:109], v4
    ds_read_b64 v[110:111], v5
    ds_read_b64 v[112:113], v6
    ds_read_b64 v[114:115], v7
    s_branch Lxe6_b
Lxe7:
    ds_read_b64 v[108:109], v4
    ds_read_b64 v[110:111], v5
    ds_read_b64 v[112:113], v6
    ds_read_b64 v[114:115], v7
    s_branch Lxe7_b
Lxe8:
    ds_read_b64 v[108:109], v4
    ds_read_b64 v[110:111], v5
    ds_read_b64 v[112:113], v6
    ds_read_b64 v[114:115], v7
    s_branch Lxe8_b
Lxe9:
    ds_read_b64 v[108:109], v4
    ds_read_b64 v[110:111], v5
    ds_read_b64 v[112:113], v6
    ds_read_b64 v[114:115], v7
    s_branch Lxe9_b
Lre_0:
    s_mov_b32 s41, 1
    s_sub_u32 s35, s35, 1
    s_cbranch_scc1 Lend
    s_sleep 2
    buffer_load_dwordx4 v[60:63], v13, s[28:31], s53 offen offset:0 sc1
    buffer_load_dwordx4 v[64:67], v13, s[28:31], s53 offen offset:1024 sc1
    s_waitcnt vmcnt(0)
    v_max3_u32 v4, v60, v61, v62
    v_max3_u32 v5, v64, v65, v66
    v_max3_u32 v4, v4, v63, v67
    v_max_u32 v4, v4, v5
    v_cmp_eq_u32 vcc, -1, v4
    s_nop 0
    s_cbranch_vccnz Lre_0
    buffer_load_dwordx4 v[68:71], v13, s[28:31], s53 offen offset:2048 sc1
    buffer_load_dwordx4 v[72:75], v13, s[28:31], s53 offen offset:3072 sc1
    buffer_load_dwordx4 v[76:79], v13, s[28:31], s54 offen offset:0 sc1
    buffer_load_dwordx4 v[80:83], v13, s[28:31], s54 offen offset:1024 sc1
    buffer_load_dwordx4 v[84:87], v13, s[28:31], s54 offen offset:2048 sc1
    buffer_load_dwordx4 v[88:91], v13, s[28:31], s54 offen offset:3072 sc1
    s_branch Lck_0
Lre_1:
    s_mov_b32 s41, 1
    s_sub_u32 s35, s35, 1
    s_cbranch_scc1 Lend
    s_sleep 2
    buffer_load_dwordx4 v[68:71], v13, s[28:31], s53 offen offset:2048 sc1
    buffer_load_dwordx4 v[72:75], v13, s[28:31], s53 offen offset:3072 sc1
    s_waitcnt vmcnt(0)
    v_max3_u32 v4, v68, v69, v70
    v_max3_u32 v5, v72, v73, v74
    v_max3_u32 v4, v4, v71, v75
    v_max_u32 v4, v4, v5
    v_cmp_eq_u32 vcc, -1, v4
    s_nop 0
    s_cbranch_vccnz Lre_1
    buffer_load_dwordx4 v[76:79], v13, s[28:31], s54 offen offset:0 sc1
    buffer_load_dwordx4 v[80:83], v13, s[28:31], s54 offen offset:1024 sc1
    buffer_load_dwordx4 v[84:87], v13, s[28:31], s54 offen offset:2048 sc1
    buffer_load_dwordx4 v[88:91], v13, s[28:31], s54 offen offset:3072 sc1
    buffer_load_dwordx4 v[92:95], v13, s[28:31], s55 offen offset:0 sc1
    buffer_load_dwordx4 v[96:99], v13, s[28:31], s55 offen offset:1024 sc1
    s_branch Lck_1
Lre_2:
    s_mov_b32 s41, 1
    s_sub_u32 s35, s35, 1
    s_cbranch_scc1 Lend
    s_sleep 2
    buffer_load_dwordx4 v[76:79], v13, s[28:31], s54 offen offset:0 sc1
    buffer_load_dwordx4 v[80:83], v13, s[28:31], s54 offen offset:1024 sc1
    s_waitcnt vmcnt(0)
    v_max3_u32 v4, v76, v77, v78
    v_max3_u32 v5, v80, v81, v82
    v_max3_u32 v4, v4, v79, v83
    v_max_u32 v4, v4, v5
    v_cmp_eq_u32 vcc, -1, v4
    s_nop 0
    s_cbranch_vccnz Lre_2
    buffer_load_dwordx4 v[84:87], v13, s[28:31], s54 offen offset:2048 sc1
    buffer_load_dwordx4 v[88:91], v13, s[28:31], s54 offen offset:3072 sc1
    buffer_load_dwordx4 v[92:95], v13, s[28:31], s55 offen offset:0 sc1
    buffer_load_dwordx4 v[96:99], v13, s[28:31], s55 offen offset:1024 sc1
    buffer_load_dwordx4 v[100:103], v13, s[28:31], s55 offen offset:2048 sc1
    buffer_load_dwordx4 v[104:107], v13, s[28:31], s55 offen offset:3072 sc1
    s_branch Lck_2
Lre_3:
    s_mov_b32 s41, 1
    s_sub_u32 s35, s35, 1
    s_cbranch_scc1 Lend
    s_sleep 2
    buffer_load_dwordx4 v[84:87], v13, s[28:31], s54 offen offset:2048 sc1
    buffer_load_dwordx4 v[88:91], v13, s[28:31], s54 offen offset:3072 sc1
    s_waitcnt vmcnt(0)
    v_max3_u32 v4, v84, v85, v86
    v_max3_u32 v5, v88, v89, v90
    v_max3_u32 v4, v4, v87, v91
    v_max_u32 v4, v4, v5
    v_cmp_eq_u32 vcc, -1, v4
    s_nop 0
    s_cbranch_vccnz Lre_3
    buffer_load_dwordx4 v[92:95], v13, s[28:31], s55 offen offset:0 sc1
    buffer_load_dwordx4 v[96:99], v13, s[28:31], s55 offen offset:1024 sc1
    buffer_load_dwordx4 v[100:103], v13, s[28:31], s55 offen offset:2048 sc1
    buffer_load_dwordx4 v[104:107], v13, s[28:31], s55 offen offset:3072 sc1
    buffer_load_dwordx4 v[60:63], v13, s[28:31], s56 offen offset:0 sc1
    buffer_load_dwordx4 v[64:67], v13, s[28:31], s56 offen offset:1024 sc1
    s_branch Lck_3
Lre_4:
    s_mov_b32 s41, 1
    s_sub_u32 s35, s35, 1
    s_cbranch_scc1 Lend
    s_sleep 2
    buffer_load_dwordx4 v[92:95], v13, s[28:31], s55 offen offset:0 sc1
    buffer_load_dwordx4 v[96:99], v13, s[28:31], s55 offen offset:1024 sc1
    s_waitcnt vmcnt(0)
    v_max3_u32 v4, v92, v93, v94
    v_max3_u32 v5, v96, v97, v98
    v_max3_u32 v4, v4, v95, v99
    v_max_u32 v4, v4, v5
    v_cmp_eq_u32 vcc, -1, v4
    s_nop 0
    s_cbranch_vccnz Lre_4
    buffer_load_dwordx4 v[100:103], v13, s[28:31], s55 offen offset:2048 sc1
    buffer_load_dwordx4 v[104:107], v13, s[28:31], s55 offen offset:3072 sc1
    buffer_load_dwordx4 v[60:63], v13, s[28:31], s56 offen offset:0 sc1
    buffer_load_dwordx4 v[64:67], v13, s[28:31], s56 offen offset:1024 sc1
    buffer_load_dwordx4 v[68:71], v13, s[28:31], s56 offen offset:2048 sc1
    buffer_load_dwordx4 v[72:75], v13, s[28:31], s56 offen offset:3072 sc1
    s_branch Lck_4
Lre_5:
    s_mov_b32 s41, 1
    s_sub_u32 s35, s35, 1
    s_cbranch_scc1 Lend
    s_sleep 2
    buffer_load_dwordx4 v[100:103], v13, s[28:31], s55 offen offset:2048 sc1
    buffer_load_dwordx4 v[104:107], v13, s[28:31], s55 offen offset:3072 sc1
    s_waitcnt vmcnt(0)
    v_max3_u32 v4, v100, v101, v102
    v_max3_u32 v5, v104, v105, v106
    v_max3_u32 v4, v4, v103, v107
    v_max_u32 v4, v4, v5
    v_cmp_eq_u32 vcc, -1, v4
    s_nop 0
    s_cbranch_vccnz Lre_5
    buffer_load_dwordx4 v[60:63], v13, s[28:31], s56 offen offset:0 sc1
    buffer_load_dwordx4 v[64:67], v13, s[28:31], s56 offen offset:1024 sc1
    buffer_load_dwordx4 v[68:71], v13, s[28:31], s56 offen offset:2048 sc1
    buffer_load_dwordx4 v[72:75], v13, s[28:31], s56 offen offset:3072 sc1
    buffer_load_dwordx4 v[76:79], v13, s[28:31], s57 offen offset:0 sc1
    buffer_load_dwordx4 v[80:83], v13, s[28:31], s57 offen offset:1024 sc1
    s_branch Lck_5
Lre_6:
    s_mov_b32 s41, 1
    s_sub_u32 s35, s35, 1
    s_cbranch_scc1 Lend
    s_sleep 2
    buffer_load_dwordx4 v[60:63], v13, s[28:31], s56 offen offset:0 sc1
    buffer_load_dwordx4 v[64:67], v13, s[28:31], s56 offen offset:1024 sc1
    s_waitcnt vmcnt(0)
    v_max3_u32 v4, v60, v61, v62
    v_max3_u32 v5, v64, v65, v66
    v_max3_u32 v4, v4, v63, v67
    v_max_u32 v4, v4, v5
    v_cmp_eq_u32 vcc, -1, v4
    s_nop 0
    s_cbranch_vccnz Lre_6
    buffer_load_dwordx4 v[68:71], v13, s[28:31], s56 offen offset:2048 sc1
    buffer_load_dwordx4 v[72:75], v13, s[28:31], s56 offen offset:3072 sc1
    buffer_load_dwordx4 v[76:79], v13, s[28:31], s57 offen offset:0 sc1
    buffer_load_dwordx4 v[80:83], v13, s[28:31], s57 offen offset:1024 sc1
    buffer_load_dwordx4 v[84:87], v13, s[28:31], s57 offen offset:2048 sc1
    buffer_load_dwordx4 v[88:91], v13, s[28:31], s57 offen offset:3072 sc1
    s_branch Lck_6
Lre_7:
    s_mov_b32 s41, 1
    s_sub_u32 s35, s35, 1
    s_cbranch_scc1 Lend
    s_sleep 2
    buffer_load_dwordx4 v[68:71], v13, s[28:31], s56 offen offset:2048 sc1
    buffer_load_dwordx4 v[72:75], v13, s[28:31], s56 offen offset:3072 sc1
    s_waitcnt vmcnt(0)
    v_max3_u32 v4, v68, v69, v70
    v_max3_u32 v5, v72, v73, v74
    v_max3_u32 v4, v4, v71, v75
    v_max_u32 v4, v4, v5
    v_cmp_eq_u32 vcc, -1, v4
    s_nop 0
    s_cbranch_vccnz Lre_7
    buffer_load_dwordx4 v[76:79], v13, s[28:31], s57 offen offset:0 sc1
    buffer_load_dwordx4 v[80:83], v13, s[28:31], s57 offen offset:1024 sc1
    buffer_load_dwordx4 v[84:87], v13, s[28:31], s57 offen offset:2048 sc1
    buffer_load_dwordx4 v[88:91], v13, s[28:31], s57 offen offset:3072 sc1
    s_branch Lck_7
Lre_8:
    s_mov_b32 s41, 1
    s_sub_u32 s35, s35, 1
    s_cbranch_scc1 Lend
    s_sleep 2
    buffer_load_dwordx4 v[76:79], v13, s[28:31], s57 offen offset:0 sc1
    buffer_load_dwordx4 v[80:83], v13, s[28:31], s57 offen offset:1024 sc1
    s_waitcnt vmcnt(0)
    v_max3_u32 v4, v76, v77, v78
    v_max3_u32 v5, v80, v81, v82
    v_max3_u32 v4, v4, v79, v83
    v_max_u32 v4, v4, v5
    v_cmp_eq_u32 vcc, -1, v4
    s_nop 0
    s_cbranch_vccnz Lre_8
    buffer_load_dwordx4 v[84:87], v13, s[28:31], s57 offen offset:2048 sc1
    buffer_load_dwordx4 v[88:91], v13, s[28:31], s57 offen offset:3072 sc1
    s_branch Lck_8
Lre_9:
    s_mov_b32 s41, 1
    s_sub_u32 s35, s35, 1
    s_cbranch_scc1 Lend
    s_sleep 2
    buffer_load_dwordx4 v[84:87], v13, s[28:31], s57 offen offset:2048 sc1
    buffer_load_dwordx4 v[88:91], v13, s[28:31], s57 offen offset:3072 sc1
    s_waitcnt vmcnt(0)
    v_max3_u32 v4, v84, v85, v86
    v_max3_u32 v5, v88, v89, v90
    v_max3_u32 v4, v4, v87, v91
    v_max_u32 v4, v4, v5
    v_cmp_eq_u32 vcc, -1, v4
    s_nop 0
    s_cbranch_vccnz Lre_9
    s_branch Lck_9
Lfix:
    s_mov_b64 vcc, s[38:39]
    v_lshlrev_b32 v6, 4, v2
    v_add_u32 v6, 158208, v6
    v_mov_b32 v10, 157956
Lcw_5:
    s_sub_u32 s35, s35, 1
    s_cbranch_scc1 Lend
    ds_read_b32 v11, v10
    s_waitcnt lgkmcnt(0)
    v_readfirstlane_b32 s38, v11
    s_nop 0
    s_cmp_lt_u32 s38, 1
    s_cbranch_scc1 Lcw_5
    s_mov_b64 exec, s[36:37]
    ds_read_b128 v[44:47], v6 offset:0
    ds_read_b128 v[48:51], v6 offset:64
    ds_read_b128 v[52:55], v6 offset:128
    ds_read_b128 v[56:59], v6 offset:192
    s_mov_b64 exec, vcc
    ds_read_b128 v[44:47], v6 offset:256
    ds_read_b128 v[48:51], v6 offset:320
    ds_read_b128 v[52:55], v6 offset:384
    ds_read_b128 v[56:59], v6 offset:448
    s_mov_b64 exec, -1
    s_waitcnt lgkmcnt(0)
    s_branch Lnofix
Lhalo:
    s_mov_b32 vcc_lo, 0x00010001
    s_mov_b32 vcc_hi, 0x00010001
    v_mov_b32 v11, 38912
    v_cndmask_b32 v76, v76, v11, vcc
    v_xor_b32 v77, 64, v76
    v_add_u32 v80, 78080, v76
    v_add_u32 v81, 78080, v77
    v_mov_b32 v14, 0x3f803f80
    v_mov_b32 v15, 0x3f803f80
    v_mov_b32 v16, 0x3f803f80
    v_mov_b32 v17, 0x3f803f80
    v_and_b32 v4, 7, v1
    v_lshlrev_b32 v4, 4, v4
    v_mul_u32_u24 v5, 39040, v2
    v_add_u32 v4, v4, v5
    ds_write_b128 v4, v[14:17] offset:38912
    v_mov_b32 v4, 157952
    v_mov_b32 v8, 0
    v_mov_b32 v9, 0
    v_mov_b32 v10, -2
    v_mov_b32 v11, -2
    ds_write_b128 v4, v[8:11]
    v_min_u32 v5, 23, v1
    v_lshl_add_u32 v5, v5, 2, v4
    ds_write_b32 v5, v8 offset:16
    s_mul_i32 s36, s32, 96
    s_sub_u32 s36, s36, 16
    v_add_u32 v96, s36, v1
    v_min_u32 v5, 47, v1
    v_add3_u32 v97, s36, v5, 64
    v_mov_b32 v6, 2047
    v_med3_i32 v96, v96, 0, v6
    v_med3_i32 v97, v97, 0, v6
    v_lshlrev_b32 v96, 3, v96
    v_lshlrev_b32 v97, 3, v97
    s_mov_b32 s46, 8192000
    v_mov_b32 v127, 157984
    s_lshl_b32 s36, s3, 2
    s_add_u32 s36, s36, 158016
    v_mov_b32 v10, s36
    s_mov_b32 vcc_lo, 0x00010001
    s_mov_b32 vcc_hi, 0x00010001
    v_cndmask_b32 v116, 0, v14, vcc
    v_cndmask_b32 v117, 0, v15, vcc
    v_cndmask_b32 v118, 0, v16, vcc
    v_cndmask_b32 v119, 0, v17, vcc
    s_waitcnt vmcnt(0)
    s_waitcnt lgkmcnt(0)
    s_barrier
    s_add_u32 s34, s34, 0x9e3779b8
    s_or_b32 s34, s34, 1
    ds_read_b128 v[108:111], v76 offset:0
    ds_read_b128 v[112:115], v77 offset:0
    ds_read_b64_tr_b16 a[0:1], v20 offset:0
    ds_read_b64_tr_b16 a[2:3], v20 offset:512
    ds_read_b64_tr_b16 a[4:5], v21 offset:0
    ds_read_b64_tr_b16 a[6:7], v21 offset:512
    ds_read_b64_tr_b16 a[8:9], v22 offset:0
    ds_read_b64_tr_b16 a[10:11], v22 offset:512
    ds_read_b64_tr_b16 a[12:13], v23 offset:0
    ds_read_b64_tr_b16 a[14:15], v23 offset:512
    ds_read_b64_tr_b16 a[16:17], v20 offset:8192
    ds_read_b64_tr_b16 a[18:19], v20 offset:8704
    ds_read_b64_tr_b16 a[20:21], v21 offset:8192
    ds_read_b64_tr_b16 a[22:23], v21 offset:8704
    ds_read_b64_tr_b16 a[24:25], v22 offset:8192
    ds_read_b64_tr_b16 a[26:27], v22 offset:8704
    s_waitcnt lgkmcnt(12)
    v_mfma_f32_16x16x32_bf16 v[28:31], a[0:3], v[116:119], 0
    ds_read_b64_tr_b16 a[28:29], v23 offset:8192
    ds_read_b64_tr_b16 a[30:31], v23 offset:8704
    s_waitcnt lgkmcnt(12)
    v_mfma_f32_16x16x32_bf16 v[32:35], a[4:7], v[116:119], 0
    ds_read_b64_tr_b16 a[32:33], v20 offset:16384
    ds_read_b64_tr_b16 a[34:35], v20 offset:16896
    s_waitcnt lgkmcnt(12)
    v_mfma_f32_16x16x32_bf16 v[36:39], a[8:11], v[116:119], 0
    ds_read_b64_tr_b16 a[36:37], v21 offset:16384
    ds_read_b64_tr_b16 a[38:39], v21 offset:16896
    s_waitcnt lgkmcnt(12)
    v_mfma_f32_16x16x32_bf16 v[40:43], a[12:15], v[116:119], 0
    ds_read_b64_tr_b16 a[40:41], v22 offset:16384
    ds_read_b64_tr_b16 a[42:43], v22 offset:16896
    s_waitcnt lgkmcnt(12)
    v_mfma_f32_16x16x32_bf16 v[44:47], a[16:19], v[108:111], 0
    ds_read_b64_tr_b16 a[44:45], v23 offset:16384
    ds_read_b64_tr_b16 a[46:47], v23 offset:16896
    s_waitcnt lgkmcnt(12)
    v_mfma_f32_16x16x32_bf16 v[48:51], a[20:23], v[108:111], 0
    ds_read_b64_tr_b16 a[48:49], v20 offset:4096
    ds_read_b64_tr_b16 a[50:51], v20 offset:4608
    s_waitcnt lgkmcnt(12)
    v_mfma_f32_16x16x32_bf16 v[52:55], a[24:27], v[108:111], 0
    ds_read_b64_tr_b16 a[52:53], v21 offset:4096
    ds_read_b64_tr_b16 a[54:55], v21 offset:4608
    s_waitcnt lgkmcnt(12)
    v_mfma_f32_16x16x32_bf16 v[56:59], a[28:31], v[108:111], 0
    ds_read_b64_tr_b16 a[56:57], v22 offset:4096
    ds_read_b64_tr_b16 a[58:59], v22 offset:4608
    s_waitcnt lgkmcnt(12)
    v_mfma_f32_16x16x32_bf16 v[60:63], v[108:111], a[32:35], 0
    ds_read_b64_tr_b16 a[60:61], v23 offset:4096
    ds_read_b64_tr_b16 a[62:63], v23 offset:4608
    s_waitcnt lgkmcnt(12)
    v_mfma_f32_16x16x32_bf16 v[64:67], v[108:111], a[36:39], 0
    ds_read_b64_tr_b16 a[64:65], v20 offset:12288
    ds_read_b64_tr_b16 a[66:67], v20 offset:12800
    s_waitcnt lgkmcnt(12)
    v_mfma_f32_16x16x32_bf16 v[68:71], v[108:111], a[40:43], 0
    ds_read_b64_tr_b16 a[68:69], v21 offset:12288
    ds_read_b64_tr_b16 a[70:71], v21 offset:12800
    s_waitcnt lgkmcnt(12)
    v_mfma_f32_16x16x32_bf16 v[72:75], v[108:111], a[44:47], 0
    ds_read_b64_tr_b16 a[72:73], v22 offset:12288
    ds_read_b64_tr_b16 a[74:75], v22 offset:12800
    s_waitcnt lgkmcnt(12)
    v_mfma_f32_16x16x32_bf16 v[28:31], a[48:51], v[116:119], v[28:31]
    ds_read_b64_tr_b16 a[76:77], v23 offset:12288
    ds_read_b64_tr_b16 a[78:79], v23 offset:12800
    s_waitcnt lgkmcnt(12)
    v_mfma_f32_16x16x32_bf16 v[32:35], a[52:55], v[116:119], v[32:35]
    ds_read_b64_tr_b16 a[80:81], v20 offset:20480
    ds_read_b64_tr_b16 a[82:83], v20 offset:20992
    s_waitcnt lgkmcnt(12)
    v_mfma_f32_16x16x32_bf16 v[36:39], a[56:59], v[116:119], v[36:39]
    ds_read_b64_tr_b16 a[84:85], v21 offset:20480
    ds_read_b64_tr_b16 a[86:87], v21 offset:20992
    s_waitcnt lgkmcnt(12)
    v_mfma_f32_16x16x32_bf16 v[40:43], a[60:63], v[116:119], v[40:43]
    ds_read_b64_tr_b16 a[88:89], v22 offset:20480
    ds_read_b64_tr_b16 a[90:91], v22 offset:20992
    s_waitcnt lgkmcnt(12)
    v_mfma_f32_16x16x32_bf16 v[44:47], a[64:67], v[112:115], v[44:47]
    ds_read_b64_tr_b16 a[92:93], v23 offset:20480
    ds_read_b64_tr_b16 a[94:95], v23 offset:20992
    s_waitcnt lgkmcnt(12)
    v_mfma_f32_16x16x32_bf16 v[48:51], a[68:71], v[112:115], v[48:51]
    s_waitcnt lgkmcnt(10)
    v_mfma_f32_16x16x32_bf16 v[52:55], a[72:75], v[112:115], v[52:55]
    s_waitcnt lgkmcnt(8)
    v_mfma_f32_16x16x32_bf16 v[56:59], a[76:79], v[112:115], v[56:59]
    s_waitcnt lgkmcnt(6)
    v_mfma_f32_16x16x32_bf16 v[60:63], v[112:115], a[80:83], v[60:63]
    s_waitcnt lgkmcnt(4)
    v_mfma_f32_16x16x32_bf16 v[64:67], v[112:115], a[84:87], v[64:67]
    s_waitcnt lgkmcnt(2)
    v_mfma_f32_16x16x32_bf16 v[68:71], v[112:115], a[88:91], v[68:71]
    s_waitcnt lgkmcnt(0)
    v_mfma_f32_16x16x32_bf16 v[72:75], v[112:115], a[92:95], v[72:75]
    s_barrier
    ds_read_b128 v[108:111], v76 offset:39040
    ds_read_b128 v[112:115], v77 offset:39040
    ds_read_b64_tr_b16 a[0:1], v20 offset:39040
    ds_read_b64_tr_b16 a[2:3], v20 offset:39552
    ds_read_b64_tr_b16 a[4:5], v21 offset:39040
    ds_read_b64_tr_b16 a[6:7], v21 offset:39552
    ds_read_b64_tr_b16 a[8:9], v22 offset:39040
    ds_read_b64_tr_b16 a[10:11], v22 offset:39552
    ds_read_b64_tr_b16 a[12:13], v23 offset:39040
    ds_read_b64_tr_b16 a[14:15], v23 offset:39552
    ds_read_b64_tr_b16 a[16:17], v20 offset:47232
    ds_read_b64_tr_b16 a[18:19], v20 offset:47744
    ds_read_b64_tr_b16 a[20:21], v21 offset:47232
    ds_read_b64_tr_b16 a[22:23], v21 offset:47744
    ds_read_b64_tr_b16 a[24:25], v22 offset:47232
    ds_read_b64_tr_b16 a[26:27], v22 offset:47744
    s_waitcnt lgkmcnt(12)
    v_mfma_f32_16x16x32_bf16 v[28:31], a[0:3], v[116:119], v[28:31]
    ds_read_b64_tr_b16 a[28:29], v23 offset:47232
    ds_read_b64_tr_b16 a[30:31], v23 offset:47744
    s_waitcnt lgkmcnt(12)
    v_mfma_f32_16x16x32_bf16 v[32:35], a[4:7], v[116:119], v[32:35]
    ds_read_b64_tr_b16 a[32:33], v20 offset:55424
    ds_read_b64_tr_b16 a[34:35], v20 offset:55936
    s_waitcnt lgkmcnt(12)
    v_mfma_f32_16x16x32_bf16 v[36:39], a[8:11], v[116:119], v[36:39]
    ds_read_b64_tr_b16 a[36:37], v21 offset:55424
    ds_read_b64_tr_b16 a[38:39], v21 offset:55936
    s_waitcnt lgkmcnt(12)
    v_mfma_f32_16x16x32_bf16 v[40:43], a[12:15], v[116:119], v[40:43]
    ds_read_b64_tr_b16 a[40:41], v22 offset:55424
    ds_read_b64_tr_b16 a[42:43], v22 offset:55936
    s_waitcnt lgkmcnt(12)
    v_mfma_f32_16x16x32_bf16 v[44:47], a[16:19], v[108:111], v[44:47]
    ds_read_b64_tr_b16 a[44:45], v23 offset:55424
    ds_read_b64_tr_b16 a[46:47], v23 offset:55936
    s_waitcnt lgkmcnt(12)
    v_mfma_f32_16x16x32_bf16 v[48:51], a[20:23], v[108:111], v[48:51]
    ds_read_b64_tr_b16 a[48:49], v20 offset:43136
    ds_read_b64_tr_b16 a[50:51], v20 offset:43648
    s_waitcnt lgkmcnt(12)
    v_mfma_f32_16x16x32_bf16 v[52:55], a[24:27], v[108:111], v[52:55]
    ds_read_b64_tr_b16 a[52:53], v21 offset:43136
    ds_read_b64_tr_b16 a[54:55], v21 offset:43648
    s_waitcnt lgkmcnt(12)
    v_mfma_f32_16x16x32_bf16 v[56:59], a[28:31], v[108:111], v[56:59]
    ds_read_b64_tr_b16 a[56:57], v22 offset:43136
    ds_read_b64_tr_b16 a[58:59], v22 offset:43648
    s_waitcnt lgkmcnt(12)
    v_mfma_f32_16x16x32_bf16 v[60:63], v[108:111], a[32:35], v[60:63]
    ds_read_b64_tr_b16 a[60:61], v23 offset:43136
    ds_read_b64_tr_b16 a[62:63], v23 offset:43648
    s_waitcnt lgkmcnt(12)
    v_mfma_f32_16x16x32_bf16 v[64:67], v[108:111], a[36:39], v[64:67]
    ds_read_b64_tr_b16 a[64:65], v20 offset:51328
    ds_read_b64_tr_b16 a[66:67], v20 offset:51840
    s_waitcnt lgkmcnt(12)
    v_mfma_f32_16x16x32_bf16 v[68:71], v[108:111], a[40:43], v[68:71]
    ds_read_b64_tr_b16 a[68:69], v21 offset:51328
    ds_read_b64_tr_b16 a[70:71], v21 offset:51840
    s_waitcnt lgkmcnt(12)
    v_mfma_f32_16x16x32_bf16 v[72:75], v[108:111], a[44:47], v[72:75]
    ds_read_b64_tr_b16 a[72:73], v22 offset:51328
    ds_read_b64_tr_b16 a[74:75], v22 offset:51840
    s_waitcnt lgkmcnt(12)
    v_mfma_f32_16x16x32_bf16 v[28:31], a[48:51], v[116:119], v[28:31]
    ds_read_b64_tr_b16 a[76:77], v23 offset:51328
    ds_read_b64_tr_b16 a[78:79], v23 offset:51840
    s_waitcnt lgkmcnt(12)
    v_mfma_f32_16x16x32_bf16 v[32:35], a[52:55], v[116:119], v[32:35]
    ds_read_b64_tr_b16 a[80:81], v20 offset:59520
    ds_read_b64_tr_b16 a[82:83], v20 offset:60032
    s_waitcnt lgkmcnt(12)
    v_mfma_f32_16x16x32_bf16 v[36:39], a[56:59], v[116:119], v[36:39]
    ds_read_b64_tr_b16 a[84:85], v21 offset:59520
    ds_read_b64_tr_b16 a[86:87], v21 offset:60032
    s_waitcnt lgkmcnt(12)
    v_mfma_f32_16x16x32_bf16 v[40:43], a[60:63], v[116:119], v[40:43]
    ds_read_b64_tr_b16 a[88:89], v22 offset:59520
    ds_read_b64_tr_b16 a[90:91], v22 offset:60032
    s_waitcnt lgkmcnt(12)
    v_mfma_f32_16x16x32_bf16 v[44:47], a[64:67], v[112:115], v[44:47]
    ds_read_b64_tr_b16 a[92:93], v23 offset:59520
    ds_read_b64_tr_b16 a[94:95], v23 offset:60032
    s_waitcnt lgkmcnt(12)
    v_mfma_f32_16x16x32_bf16 v[48:51], a[68:71], v[112:115], v[48:51]
    s_waitcnt lgkmcnt(10)
    v_mfma_f32_16x16x32_bf16 v[52:55], a[72:75], v[112:115], v[52:55]
    s_waitcnt lgkmcnt(8)
    v_mfma_f32_16x16x32_bf16 v[56:59], a[76:79], v[112:115], v[56:59]
    s_waitcnt lgkmcnt(6)
    v_mfma_f32_16x16x32_bf16 v[60:63], v[112:115], a[80:83], v[60:63]
    s_waitcnt lgkmcnt(4)
    v_mfma_f32_16x16x32_bf16 v[64:67], v[112:115], a[84:87], v[64:67]
    s_waitcnt lgkmcnt(2)
    v_mfma_f32_16x16x32_bf16 v[68:71], v[112:115], a[88:91], v[68:71]
    s_waitcnt lgkmcnt(0)
    v_mfma_f32_16x16x32_bf16 v[72:75], v[112:115], a[92:95], v[72:75]
    s_mov_b64 exec, 1
    s_lshl_b32 s36, s2, 2
    s_add_u32 s36, s36, 8323072
    v_mov_b32 v4, s34
    v_mov_b32 v5, s36
    buffer_store_dword v4, v5, s[28:31], 0 offen sc1
    s_mov_b64 exec, -1
    s_barrier
    ds_read_b128 v[108:111], v80 offset:0
    ds_read_b128 v[112:115], v81 offset:0
    ds_read_b64_tr_b16 a[0:1], v24 offset:0
    ds_read_b64_tr_b16 a[2:3], v24 offset:512
    ds_read_b64_tr_b16 a[4:5], v25 offset:0
    ds_read_b64_tr_b16 a[6:7], v25 offset:512
    ds_read_b64_tr_b16 a[8:9], v26 offset:0
    ds_read_b64_tr_b16 a[10:11], v26 offset:512
    ds_read_b64_tr_b16 a[12:13], v27 offset:0
    ds_read_b64_tr_b16 a[14:15], v27 offset:512
    ds_read_b64_tr_b16 a[16:17], v24 offset:8192
    ds_read_b64_tr_b16 a[18:19], v24 offset:8704
    ds_read_b64_tr_b16 a[20:21], v25 offset:8192
    ds_read_b64_tr_b16 a[22:23], v25 offset:8704
    ds_read_b64_tr_b16 a[24:25], v26 offset:8192
    ds_read_b64_tr_b16 a[26:27], v26 offset:8704
    s_waitcnt lgkmcnt(12)
    v_mfma_f32_16x16x32_bf16 v[28:31], a[0:3], v[116:119], v[28:31]
    ds_read_b64_tr_b16 a[28:29], v27 offset:8192
    ds_read_b64_tr_b16 a[30:31], v27 offset:8704
    s_waitcnt lgkmcnt(12)
    v_mfma_f32_16x16x32_bf16 v[32:35], a[4:7], v[116:119], v[32:35]
    ds_read_b64_tr_b16 a[32:33], v24 offset:16384
    ds_read_b64_tr_b16 a[34:35], v24 offset:16896
    s_waitcnt lgkmcnt(12)
    v_mfma_f32_16x16x32_bf16 v[36:39], a[8:11], v[116:119], v[36:39]
    ds_read_b64_tr_b16 a[36:37], v25 offset:16384
    ds_read_b64_tr_b16 a[38:39], v25 offset:16896
    s_waitcnt lgkmcnt(12)
    v_mfma_f32_16x16x32_bf16 v[40:43], a[12:15], v[116:119], v[40:43]
    ds_read_b64_tr_b16 a[40:41], v26 offset:16384
    ds_read_b64_tr_b16 a[42:43], v26 offset:16896
    s_waitcnt lgkmcnt(12)
    v_mfma_f32_16x16x32_bf16 v[44:47], a[16:19], v[108:111], v[44:47]
    ds_read_b64_tr_b16 a[44:45], v27 offset:16384
    ds_read_b64_tr_b16 a[46:47], v27 offset:16896
    s_waitcnt lgkmcnt(12)
    v_mfma_f32_16x16x32_bf16 v[48:51], a[20:23], v[108:111], v[48:51]
    ds_read_b64_tr_b16 a[48:49], v24 offset:4096
    ds_read_b64_tr_b16 a[50:51], v24 offset:4608
    s_waitcnt lgkmcnt(12)
    v_mfma_f32_16x16x32_bf16 v[52:55], a[24:27], v[108:111], v[52:55]
    ds_read_b64_tr_b16 a[52:53], v25 offset:4096
    ds_read_b64_tr_b16 a[54:55], v25 offset:4608
    s_waitcnt lgkmcnt(12)
    v_mfma_f32_16x16x32_bf16 v[56:59], a[28:31], v[108:111], v[56:59]
    ds_read_b64_tr_b16 a[56:57], v26 offset:4096
    ds_read_b64_tr_b16 a[58:59], v26 offset:4608
    s_waitcnt lgkmcnt(12)
    v_mfma_f32_16x16x32_bf16 v[60:63], v[108:111], a[32:35], v[60:63]
    ds_read_b64_tr_b16 a[60:61], v27 offset:4096
    ds_read_b64_tr_b16 a[62:63], v27 offset:4608
    s_waitcnt lgkmcnt(12)
    v_mfma_f32_16x16x32_bf16 v[64:67], v[108:111], a[36:39], v[64:67]
    ds_read_b64_tr_b16 a[64:65], v24 offset:12288
    ds_read_b64_tr_b16 a[66:67], v24 offset:12800
    s_waitcnt lgkmcnt(12)
    v_mfma_f32_16x16x32_bf16 v[68:71], v[108:111], a[40:43], v[68:71]
    ds_read_b64_tr_b16 a[68:69], v25 offset:12288
    ds_read_b64_tr_b16 a[70:71], v25 offset:12800
    s_waitcnt lgkmcnt(12)
    v_mfma_f32_16x16x32_bf16 v[72:75], v[108:111], a[44:47], v[72:75]
    ds_read_b64_tr_b16 a[72:73], v26 offset:12288
    ds_read_b64_tr_b16 a[74:75], v26 offset:12800
    s_waitcnt lgkmcnt(12)
    v_mfma_f32_16x16x32_bf16 v[28:31], a[48:51], v[116:119], v[28:31]
    ds_read_b64_tr_b16 a[76:77], v27 offset:12288
    ds_read_b64_tr_b16 a[78:79], v27 offset:12800
    s_waitcnt lgkmcnt(12)
    v_mfma_f32_16x16x32_bf16 v[32:35], a[52:55], v[116:119], v[32:35]
    ds_read_b64_tr_b16 a[80:81], v24 offset:20480
    ds_read_b64_tr_b16 a[82:83], v24 offset:20992
    s_waitcnt lgkmcnt(12)
    v_mfma_f32_16x16x32_bf16 v[36:39], a[56:59], v[116:119], v[36:39]
    ds_read_b64_tr_b16 a[84:85], v25 offset:20480
    ds_read_b64_tr_b16 a[86:87], v25 offset:20992
    s_waitcnt lgkmcnt(12)
    v_mfma_f32_16x16x32_bf16 v[40:43], a[60:63], v[116:119], v[40:43]
    ds_read_b64_tr_b16 a[88:89], v26 offset:20480
    ds_read_b64_tr_b16 a[90:91], v26 offset:20992
    s_waitcnt lgkmcnt(12)
    v_mfma_f32_16x16x32_bf16 v[44:47], a[64:67], v[112:115], v[44:47]
    ds_read_b64_tr_b16 a[92:93], v27 offset:20480
    ds_read_b64_tr_b16 a[94:95], v27 offset:20992
    s_waitcnt lgkmcnt(12)
    v_mfma_f32_16x16x32_bf16 v[48:51], a[68:71], v[112:115], v[48:51]
    s_waitcnt lgkmcnt(10)
    v_mfma_f32_16x16x32_bf16 v[52:55], a[72:75], v[112:115], v[52:55]
    s_waitcnt lgkmcnt(8)
    v_mfma_f32_16x16x32_bf16 v[56:59], a[76:79], v[112:115], v[56:59]
    s_waitcnt lgkmcnt(6)
    v_mfma_f32_16x16x32_bf16 v[60:63], v[112:115], a[80:83], v[60:63]
    s_waitcnt lgkmcnt(4)
    v_mfma_f32_16x16x32_bf16 v[64:67], v[112:115], a[84:87], v[64:67]
    s_waitcnt lgkmcnt(2)
    v_mfma_f32_16x16x32_bf16 v[68:71], v[112:115], a[88:91], v[68:71]
    s_waitcnt lgkmcnt(0)
    v_mfma_f32_16x16x32_bf16 v[72:75], v[112:115], a[92:95], v[72:75]
    s_barrier
    ds_read_b128 v[108:111], v80 offset:39040
    ds_read_b128 v[112:115], v81 offset:39040
    ds_read_b64_tr_b16 a[0:1], v24 offset:39040
    ds_read_b64_tr_b16 a[2:3], v24 offset:39552
    ds_read_b64_tr_b16 a[4:5], v25 offset:39040
    ds_read_b64_tr_b16 a[6:7], v25 offset:39552
    ds_read_b64_tr_b16 a[8:9], v26 offset:39040
    ds_read_b64_tr_b16 a[10:11], v26 offset:39552
    ds_read_b64_tr_b16 a[12:13], v27 offset:39040
    ds_read_b64_tr_b16 a[14:15], v27 offset:39552
    ds_read_b64_tr_b16 a[16:17], v24 offset:47232
    ds_read_b64_tr_b16 a[18:19], v24 offset:47744
    ds_read_b64_tr_b16 a[20:21], v25 offset:47232
    ds_read_b64_tr_b16 a[22:23], v25 offset:47744
    ds_read_b64_tr_b16 a[24:25], v26 offset:47232
    ds_read_b64_tr_b16 a[26:27], v26 offset:47744
    s_waitcnt lgkmcnt(12)
    v_mfma_f32_16x16x32_bf16 v[28:31], a[0:3], v[116:119], v[28:31]
    ds_read_b64_tr_b16 a[28:29], v27 offset:47232
    ds_read_b64_tr_b16 a[30:31], v27 offset:47744
    s_waitcnt lgkmcnt(12)
    v_mfma_f32_16x16x32_bf16 v[32:35], a[4:7], v[116:119], v[32:35]
    ds_read_b64_tr_b16 a[32:33], v24 offset:55424
    ds_read_b64_tr_b16 a[34:35], v24 offset:55936
    s_waitcnt lgkmcnt(12)
    v_mfma_f32_16x16x32_bf16 v[36:39], a[8:11], v[116:119], v[36:39]
    ds_read_b64_tr_b16 a[36:37], v25 offset:55424
    ds_read_b64_tr_b16 a[38:39], v25 offset:55936
    s_waitcnt lgkmcnt(12)
    v_mfma_f32_16x16x32_bf16 v[40:43], a[12:15], v[116:119], v[40:43]
    ds_read_b64_tr_b16 a[40:41], v26 offset:55424
    ds_read_b64_tr_b16 a[42:43], v26 offset:55936
    s_waitcnt lgkmcnt(12)
    v_mfma_f32_16x16x32_bf16 v[44:47], a[16:19], v[108:111], v[44:47]
    ds_read_b64_tr_b16 a[44:45], v27 offset:55424
    ds_read_b64_tr_b16 a[46:47], v27 offset:55936
    s_waitcnt lgkmcnt(12)
    v_mfma_f32_16x16x32_bf16 v[48:51], a[20:23], v[108:111], v[48:51]
    ds_read_b64_tr_b16 a[48:49], v24 offset:43136
    ds_read_b64_tr_b16 a[50:51], v24 offset:43648
    s_waitcnt lgkmcnt(12)
    v_mfma_f32_16x16x32_bf16 v[52:55], a[24:27], v[108:111], v[52:55]
    ds_read_b64_tr_b16 a[52:53], v25 offset:43136
    ds_read_b64_tr_b16 a[54:55], v25 offset:43648
    s_waitcnt lgkmcnt(12)
    v_mfma_f32_16x16x32_bf16 v[56:59], a[28:31], v[108:111], v[56:59]
    ds_read_b64_tr_b16 a[56:57], v26 offset:43136
    ds_read_b64_tr_b16 a[58:59], v26 offset:43648
    s_waitcnt lgkmcnt(12)
    v_mfma_f32_16x16x32_bf16 v[60:63], v[108:111], a[32:35], v[60:63]
    ds_read_b64_tr_b16 a[60:61], v27 offset:43136
    ds_read_b64_tr_b16 a[62:63], v27 offset:43648
    s_waitcnt lgkmcnt(12)
    v_mfma_f32_16x16x32_bf16 v[64:67], v[108:111], a[36:39], v[64:67]
    ds_read_b64_tr_b16 a[64:65], v24 offset:51328
    ds_read_b64_tr_b16 a[66:67], v24 offset:51840
    s_waitcnt lgkmcnt(12)
    v_mfma_f32_16x16x32_bf16 v[68:71], v[108:111], a[40:43], v[68:71]
    ds_read_b64_tr_b16 a[68:69], v25 offset:51328
    ds_read_b64_tr_b16 a[70:71], v25 offset:51840
    s_waitcnt lgkmcnt(12)
    v_mfma_f32_16x16x32_bf16 v[72:75], v[108:111], a[44:47], v[72:75]
    ds_read_b64_tr_b16 a[72:73], v26 offset:51328
    ds_read_b64_tr_b16 a[74:75], v26 offset:51840
    s_waitcnt lgkmcnt(12)
    v_mfma_f32_16x16x32_bf16 v[28:31], a[48:51], v[116:119], v[28:31]
    ds_read_b64_tr_b16 a[76:77], v27 offset:51328
    ds_read_b64_tr_b16 a[78:79], v27 offset:51840
    s_waitcnt lgkmcnt(12)
    v_mfma_f32_16x16x32_bf16 v[32:35], a[52:55], v[116:119], v[32:35]
    ds_read_b64_tr_b16 a[80:81], v24 offset:59520
    ds_read_b64_tr_b16 a[82:83], v24 offset:60032
    s_waitcnt lgkmcnt(12)
    v_mfma_f32_16x16x32_bf16 v[36:39], a[56:59], v[116:119], v[36:39]
    ds_read_b64_tr_b16 a[84:85], v25 offset:59520
    ds_read_b64_tr_b16 a[86:87], v25 offset:60032
    s_waitcnt lgkmcnt(12)
    v_mfma_f32_16x16x32_bf16 v[40:43], a[60:63], v[116:119], v[40:43]
    ds_read_b64_tr_b16 a[88:89], v26 offset:59520
    ds_read_b64_tr_b16 a[90:91], v26 offset:60032
    s_waitcnt lgkmcnt(12)
    v_mfma_f32_16x16x32_bf16 v[44:47], a[64:67], v[112:115], v[44:47]
    ds_read_b64_tr_b16 a[92:93], v27 offset:59520
    ds_read_b64_tr_b16 a[94:95], v27 offset:60032
    s_waitcnt lgkmcnt(12)
    v_mfma_f32_16x16x32_bf16 v[48:51], a[68:71], v[112:115], v[48:51]
    s_waitcnt lgkmcnt(10)
    v_mfma_f32_16x16x32_bf16 v[52:55], a[72:75], v[112:115], v[52:55]
    s_waitcnt lgkmcnt(8)
    v_mfma_f32_16x16x32_bf16 v[56:59], a[76:79], v[112:115], v[56:59]
    s_waitcnt lgkmcnt(6)
    v_mfma_f32_16x16x32_bf16 v[60:63], v[112:115], a[80:83], v[60:63]
    s_waitcnt lgkmcnt(4)
    v_mfma_f32_16x16x32_bf16 v[64:67], v[112:115], a[84:87], v[64:67]
    s_waitcnt lgkmcnt(2)
    v_mfma_f32_16x16x32_bf16 v[68:71], v[112:115], a[88:91], v[68:71]
    s_waitcnt lgkmcnt(0)
    v_mfma_f32_16x16x32_bf16 v[72:75], v[112:115], a[92:95], v[72:75]
    v_add_u32 v4, 156224, v12
    v_min_u32 v5, 47, v1
    v_lshlrev_b32 v5, 2, v5
    v_add_u32 v5, 156480, v5
    v_lshlrev_b32 v6, 4, v2
    v_add_u32 v6, 157184, v6
    v_mov_b32 v7, 157968
    v_lshlrev_b32 v11, 2, v3
    v_add_u32 v11, 156224, v11
    s_barrier
    ds_read_b128 v[108:111], v76 offset:0
    ds_read_b128 v[112:115], v77 offset:0
    ds_read_b64_tr_b16 a[0:1], v20 offset:0
    ds_read_b64_tr_b16 a[2:3], v20 offset:512
    ds_read_b64_tr_b16 a[4:5], v21 offset:0
    ds_read_b64_tr_b16 a[6:7], v21 offset:512
    ds_read_b64_tr_b16 a[8:9], v22 offset:0
    ds_read_b64_tr_b16 a[10:11], v22 offset:512
    ds_read_b64_tr_b16 a[12:13], v23 offset:0
    ds_read_b64_tr_b16 a[14:15], v23 offset:512
    ds_read_b64_tr_b16 a[16:17], v20 offset:8192
    ds_read_b64_tr_b16 a[18:19], v20 offset:8704
    ds_read_b64_tr_b16 a[20:21], v21 offset:8192
    ds_read_b64_tr_b16 a[22:23], v21 offset:8704
    ds_read_b64_tr_b16 a[24:25], v22 offset:8192
    ds_read_b64_tr_b16 a[26:27], v22 offset:8704
    s_waitcnt lgkmcnt(12)
    v_mfma_f32_16x16x32_bf16 v[28:31], a[0:3], v[116:119], v[28:31]
    ds_read_b64_tr_b16 a[28:29], v23 offset:8192
    ds_read_b64_tr_b16 a[30:31], v23 offset:8704
    s_waitcnt lgkmcnt(12)
    v_mfma_f32_16x16x32_bf16 v[32:35], a[4:7], v[116:119], v[32:35]
    ds_read_b64_tr_b16 a[32:33], v20 offset:16384
    ds_read_b64_tr_b16 a[34:35], v20 offset:16896
    s_waitcnt lgkmcnt(12)
    v_mfma_f32_16x16x32_bf16 v[36:39], a[8:11], v[116:119], v[36:39]
    ds_read_b64_tr_b16 a[36:37], v21 offset:16384
    ds_read_b64_tr_b16 a[38:39], v21 offset:16896
    s_waitcnt lgkmcnt(12)
    v_mfma_f32_16x16x32_bf16 v[40:43], a[12:15], v[116:119], v[40:43]
    ds_read_b64_tr_b16 a[40:41], v22 offset:16384
    ds_read_b64_tr_b16 a[42:43], v22 offset:16896
    s_waitcnt lgkmcnt(12)
    v_mfma_f32_16x16x32_bf16 v[44:47], a[16:19], v[108:111], v[44:47]
    ds_read_b64_tr_b16 a[44:45], v23 offset:16384
    ds_read_b64_tr_b16 a[46:47], v23 offset:16896
    s_waitcnt lgkmcnt(12)
    v_mfma_f32_16x16x32_bf16 v[48:51], a[20:23], v[108:111], v[48:51]
    ds_read_b64_tr_b16 a[48:49], v20 offset:4096
    ds_read_b64_tr_b16 a[50:51], v20 offset:4608
    s_waitcnt lgkmcnt(12)
    v_mfma_f32_16x16x32_bf16 v[52:55], a[24:27], v[108:111], v[52:55]
    ds_read_b64_tr_b16 a[52:53], v21 offset:4096
    ds_read_b64_tr_b16 a[54:55], v21 offset:4608
    s_waitcnt lgkmcnt(12)
    v_mfma_f32_16x16x32_bf16 v[56:59], a[28:31], v[108:111], v[56:59]
    ds_read_b64_tr_b16 a[56:57], v22 offset:4096
    ds_read_b64_tr_b16 a[58:59], v22 offset:4608
    s_waitcnt lgkmcnt(12)
    v_mfma_f32_16x16x32_bf16 v[60:63], v[108:111], a[32:35], v[60:63]
    ds_read_b64_tr_b16 a[60:61], v23 offset:4096
    ds_read_b64_tr_b16 a[62:63], v23 offset:4608
    s_waitcnt lgkmcnt(12)
    v_mfma_f32_16x16x32_bf16 v[64:67], v[108:111], a[36:39], v[64:67]
    ds_read_b64_tr_b16 a[64:65], v20 offset:12288
    ds_read_b64_tr_b16 a[66:67], v20 offset:12800
    s_waitcnt lgkmcnt(12)
    v_mfma_f32_16x16x32_bf16 v[68:71], v[108:111], a[40:43], v[68:71]
    ds_read_b64_tr_b16 a[68:69], v21 offset:12288
    ds_read_b64_tr_b16 a[70:71], v21 offset:12800
    s_waitcnt lgkmcnt(12)
    v_mfma_f32_16x16x32_bf16 v[72:75], v[108:111], a[44:47], v[72:75]
    ds_read_b64_tr_b16 a[72:73], v22 offset:12288
    ds_read_b64_tr_b16 a[74:75], v22 offset:12800
    s_waitcnt lgkmcnt(12)
    v_mfma_f32_16x16x32_bf16 v[28:31], a[48:51], v[116:119], v[28:31]
    ds_read_b64_tr_b16 a[76:77], v23 offset:12288
    ds_read_b64_tr_b16 a[78:79], v23 offset:12800
    s_waitcnt lgkmcnt(12)
    v_mfma_f32_16x16x32_bf16 v[32:35], a[52:55], v[116:119], v[32:35]
    ds_read_b64_tr_b16 a[80:81], v20 offset:20480
    ds_read_b64_tr_b16 a[82:83], v20 offset:20992
    s_waitcnt lgkmcnt(12)
    v_mfma_f32_16x16x32_bf16 v[36:39], a[56:59], v[116:119], v[36:39]
    ds_read_b64_tr_b16 a[84:85], v21 offset:20480
    ds_read_b64_tr_b16 a[86:87], v21 offset:20992
    s_waitcnt lgkmcnt(12)
    v_mfma_f32_16x16x32_bf16 v[40:43], a[60:63], v[116:119], v[40:43]
    ds_read_b64_tr_b16 a[88:89], v22 offset:20480
    ds_read_b64_tr_b16 a[90:91], v22 offset:20992
    s_waitcnt lgkmcnt(12)
    v_mfma_f32_16x16x32_bf16 v[44:47], a[64:67], v[112:115], v[44:47]
    ds_read_b64_tr_b16 a[92:93], v23 offset:20480
    ds_read_b64_tr_b16 a[94:95], v23 offset:20992
    s_waitcnt lgkmcnt(12)
    v_mfma_f32_16x16x32_bf16 v[48:51], a[68:71], v[112:115], v[48:51]
    s_waitcnt lgkmcnt(10)
    v_mfma_f32_16x16x32_bf16 v[52:55], a[72:75], v[112:115], v[52:55]
    s_waitcnt lgkmcnt(8)
    v_mfma_f32_16x16x32_bf16 v[56:59], a[76:79], v[112:115], v[56:59]
    s_waitcnt lgkmcnt(6)
    v_mfma_f32_16x16x32_bf16 v[60:63], v[112:115], a[80:83], v[60:63]
    s_waitcnt lgkmcnt(4)
    v_mfma_f32_16x16x32_bf16 v[64:67], v[112:115], a[84:87], v[64:67]
    s_waitcnt lgkmcnt(2)
    v_mfma_f32_16x16x32_bf16 v[68:71], v[112:115], a[88:91], v[68:71]
    s_waitcnt lgkmcnt(0)
    v_mfma_f32_16x16x32_bf16 v[72:75], v[112:115], a[92:95], v[72:75]
    s_barrier
    ds_read_b128 v[108:111], v76 offset:39040
    ds_read_b128 v[112:115], v77 offset:39040
    ds_read_b64_tr_b16 a[0:1], v20 offset:39040
    ds_read_b64_tr_b16 a[2:3], v20 offset:39552
    ds_read_b64_tr_b16 a[4:5], v21 offset:39040
    ds_read_b64_tr_b16 a[6:7], v21 offset:39552
    ds_read_b64_tr_b16 a[8:9], v22 offset:39040
    ds_read_b64_tr_b16 a[10:11], v22 offset:39552
    ds_read_b64_tr_b16 a[12:13], v23 offset:39040
    ds_read_b64_tr_b16 a[14:15], v23 offset:39552
    ds_read_b64_tr_b16 a[16:17], v20 offset:47232
    ds_read_b64_tr_b16 a[18:19], v20 offset:47744
    ds_read_b64_tr_b16 a[20:21], v21 offset:47232
    ds_read_b64_tr_b16 a[22:23], v21 offset:47744
    ds_read_b64_tr_b16 a[24:25], v22 offset:47232
    ds_read_b64_tr_b16 a[26:27], v22 offset:47744
    s_waitcnt lgkmcnt(12)
    v_mfma_f32_16x16x32_bf16 v[28:31], a[0:3], v[116:119], v[28:31]
    ds_read_b64_tr_b16 a[28:29], v23 offset:47232
    ds_read_b64_tr_b16 a[30:31], v23 offset:47744
    s_waitcnt lgkmcnt(12)
    v_mfma_f32_16x16x32_bf16 v[32:35], a[4:7], v[116:119], v[32:35]
    ds_read_b64_tr_b16 a[32:33], v20 offset:55424
    ds_read_b64_tr_b16 a[34:35], v20 offset:55936
    s_waitcnt lgkmcnt(12)
    v_mfma_f32_16x16x32_bf16 v[36:39], a[8:11], v[116:119], v[36:39]
    ds_read_b64_tr_b16 a[36:37], v21 offset:55424
    ds_read_b64_tr_b16 a[38:39], v21 offset:55936
    s_waitcnt lgkmcnt(12)
    v_mfma_f32_16x16x32_bf16 v[40:43], a[12:15], v[116:119], v[40:43]
    ds_read_b64_tr_b16 a[40:41], v22 offset:55424
    ds_read_b64_tr_b16 a[42:43], v22 offset:55936
    s_waitcnt lgkmcnt(12)
    v_mfma_f32_16x16x32_bf16 v[44:47], a[16:19], v[108:111], v[44:47]
    ds_read_b64_tr_b16 a[44:45], v23 offset:55424
    ds_read_b64_tr_b16 a[46:47], v23 offset:55936
    s_waitcnt lgkmcnt(12)
    v_mfma_f32_16x16x32_bf16 v[48:51], a[20:23], v[108:111], v[48:51]
    ds_read_b64_tr_b16 a[48:49], v20 offset:43136
    ds_read_b64_tr_b16 a[50:51], v20 offset:43648
    s_waitcnt lgkmcnt(12)
    v_mfma_f32_16x16x32_bf16 v[52:55], a[24:27], v[108:111], v[52:55]
    ds_read_b64_tr_b16 a[52:53], v21 offset:43136
    ds_read_b64_tr_b16 a[54:55], v21 offset:43648
    s_waitcnt lgkmcnt(12)
    v_mfma_f32_16x16x32_bf16 v[56:59], a[28:31], v[108:111], v[56:59]
    ds_read_b64_tr_b16 a[56:57], v22 offset:43136
    ds_read_b64_tr_b16 a[58:59], v22 offset:43648
    s_waitcnt lgkmcnt(12)
    v_mfma_f32_16x16x32_bf16 v[60:63], v[108:111], a[32:35], v[60:63]
    ds_read_b64_tr_b16 a[60:61], v23 offset:43136
    ds_read_b64_tr_b16 a[62:63], v23 offset:43648
    s_waitcnt lgkmcnt(12)
    v_mfma_f32_16x16x32_bf16 v[64:67], v[108:111], a[36:39], v[64:67]
    ds_read_b64_tr_b16 a[64:65], v20 offset:51328
    ds_read_b64_tr_b16 a[66:67], v20 offset:51840
    s_waitcnt lgkmcnt(12)
    v_mfma_f32_16x16x32_bf16 v[68:71], v[108:111], a[40:43], v[68:71]
    ds_read_b64_tr_b16 a[68:69], v21 offset:51328
    ds_read_b64_tr_b16 a[70:71], v21 offset:51840
    s_waitcnt lgkmcnt(12)
    v_mfma_f32_16x16x32_bf16 v[72:75], v[108:111], a[44:47], v[72:75]
    ds_read_b64_tr_b16 a[72:73], v22 offset:51328
    ds_read_b64_tr_b16 a[74:75], v22 offset:51840
    s_waitcnt lgkmcnt(12)
    v_mfma_f32_16x16x32_bf16 v[28:31], a[48:51], v[116:119], v[28:31]
    ds_read_b64_tr_b16 a[76:77], v23 offset:51328
    ds_read_b64_tr_b16 a[78:79], v23 offset:51840
    s_waitcnt lgkmcnt(12)
    v_mfma_f32_16x16x32_bf16 v[32:35], a[52:55], v[116:119], v[32:35]
    ds_read_b64_tr_b16 a[80:81], v20 offset:59520
    ds_read_b64_tr_b16 a[82:83], v20 offset:60032
    s_waitcnt lgkmcnt(12)
    v_mfma_f32_16x16x32_bf16 v[36:39], a[56:59], v[116:119], v[36:39]
    ds_read_b64_tr_b16 a[84:85], v21 offset:59520
    ds_read_b64_tr_b16 a[86:87], v21 offset:60032
    s_waitcnt lgkmcnt(12)
    v_mfma_f32_16x16x32_bf16 v[40:43], a[60:63], v[116:119], v[40:43]
    ds_read_b64_tr_b16 a[88:89], v22 offset:59520
    ds_read_b64_tr_b16 a[90:91], v22 offset:60032
    s_waitcnt lgkmcnt(12)
    v_mfma_f32_16x16x32_bf16 v[44:47], a[64:67], v[112:115], v[44:47]
    ds_read_b64_tr_b16 a[92:93], v23 offset:59520
    ds_read_b64_tr_b16 a[94:95], v23 offset:60032
    s_waitcnt lgkmcnt(12)
    v_mfma_f32_16x16x32_bf16 v[48:51], a[68:71], v[112:115], v[48:51]
    s_waitcnt lgkmcnt(10)
    v_mfma_f32_16x16x32_bf16 v[52:55], a[72:75], v[112:115], v[52:55]
    s_waitcnt lgkmcnt(8)
    v_mfma_f32_16x16x32_bf16 v[56:59], a[76:79], v[112:115], v[56:59]
    s_waitcnt lgkmcnt(6)
    v_mfma_f32_16x16x32_bf16 v[60:63], v[112:115], a[80:83], v[60:63]
    s_waitcnt lgkmcnt(4)
    v_mfma_f32_16x16x32_bf16 v[64:67], v[112:115], a[84:87], v[64:67]
    s_waitcnt lgkmcnt(2)
    v_mfma_f32_16x16x32_bf16 v[68:71], v[112:115], a[88:91], v[68:71]
    s_waitcnt lgkmcnt(0)
    v_mfma_f32_16x16x32_bf16 v[72:75], v[112:115], a[92:95], v[72:75]
    s_barrier
    ds_read_b128 a[96:99], v80 offset:0
    ds_read_b128 a[100:103], v81 offset:0
    ds_read_b64_tr_b16 a[0:1], v24 offset:0
    ds_read_b64_tr_b16 a[2:3], v24 offset:512
    ds_read_b64_tr_b16 a[4:5], v25 offset:0
    ds_read_b64_tr_b16 a[6:7], v25 offset:512
    ds_read_b64_tr_b16 a[8:9], v26 offset:0
    ds_read_b64_tr_b16 a[10:11], v26 offset:512
    ds_read_b64_tr_b16 a[12:13], v27 offset:0
    ds_read_b64_tr_b16 a[14:15], v27 offset:512
    ds_read_b64_tr_b16 a[16:17], v24 offset:8192
    ds_read_b64_tr_b16 a[18:19], v24 offset:8704
    ds_read_b64_tr_b16 a[20:21], v25 offset:8192
    ds_read_b64_tr_b16 a[22:23], v25 offset:8704
    ds_read_b64_tr_b16 a[24:25], v26 offset:8192
    ds_read_b64_tr_b16 a[26:27], v26 offset:8704
    s_waitcnt lgkmcnt(12)
    v_mfma_f32_16x16x32_bf16 v[28:31], a[0:3], v[116:119], v[28:31]
    ds_read_b64_tr_b16 a[28:29], v27 offset:8192
    ds_read_b64_tr_b16 a[30:31], v27 offset:8704
    s_waitcnt lgkmcnt(12)
    v_mfma_f32_16x16x32_bf16 v[32:35], a[4:7], v[116:119], v[32:35]
    ds_read_b64_tr_b16 a[48:49], v24 offset:4096
    ds_read_b64_tr_b16 a[50:51], v24 offset:4608
    s_waitcnt lgkmcnt(12)
    v_mfma_f32_16x16x32_bf16 v[36:39], a[8:11], v[116:119], v[36:39]
    ds_read_b64_tr_b16 a[52:53], v25 offset:4096
    ds_read_b64_tr_b16 a[54:55], v25 offset:4608
    s_waitcnt lgkmcnt(12)
    v_mfma_f32_16x16x32_bf16 v[40:43], a[12:15], v[116:119], v[40:43]
    ds_read_b64_tr_b16 a[56:57], v26 offset:4096
    ds_read_b64_tr_b16 a[58:59], v26 offset:4608
    s_waitcnt lgkmcnt(12)
    v_mfma_f32_16x16x32_bf16 v[44:47], a[16:19], a[96:99], v[44:47]
    ds_read_b64_tr_b16 a[60:61], v27 offset:4096
    ds_read_b64_tr_b16 a[62:63], v27 offset:4608
    s_waitcnt lgkmcnt(12)
    v_mfma_f32_16x16x32_bf16 v[48:51], a[20:23], a[96:99], v[48:51]
    ds_read_b64_tr_b16 a[64:65], v24 offset:12288
    ds_read_b64_tr_b16 a[66:67], v24 offset:12800
    s_waitcnt lgkmcnt(12)
    v_mfma_f32_16x16x32_bf16 v[52:55], a[24:27], a[96:99], v[52:55]
    ds_read_b64_tr_b16 a[68:69], v25 offset:12288
    ds_read_b64_tr_b16 a[70:71], v25 offset:12800
    s_waitcnt lgkmcnt(12)
    v_mfma_f32_16x16x32_bf16 v[56:59], a[28:31], a[96:99], v[56:59]
    ds_read_b64_tr_b16 a[72:73], v26 offset:12288
    ds_read_b64_tr_b16 a[74:75], v26 offset:12800
    s_waitcnt lgkmcnt(12)
    v_mfma_f32_16x16x32_bf16 v[28:31], a[48:51], v[116:119], v[28:31]
    ds_read_b64_tr_b16 a[76:77], v27 offset:12288
    ds_read_b64_tr_b16 a[78:79], v27 offset:12800
    s_waitcnt lgkmcnt(12)
    v_mfma_f32_16x16x32_bf16 v[32:35], a[52:55], v[116:119], v[32:35]
    s_waitcnt lgkmcnt(10)
    v_mfma_f32_16x16x32_bf16 v[36:39], a[56:59], v[116:119], v[36:39]
    s_waitcnt lgkmcnt(8)
    v_mfma_f32_16x16x32_bf16 v[40:43], a[60:63], v[116:119], v[40:43]
    s_waitcnt lgkmcnt(6)
    v_mfma_f32_16x16x32_bf16 v[44:47], a[64:67], a[100:103], v[44:47]
    s_waitcnt lgkmcnt(4)
    v_mfma_f32_16x16x32_bf16 v[48:51], a[68:71], a[100:103], v[48:51]
    s_waitcnt lgkmcnt(2)
    v_mfma_f32_16x16x32_bf16 v[52:55], a[72:75], a[100:103], v[52:55]
    s_waitcnt lgkmcnt(0)
    v_mfma_f32_16x16x32_bf16 v[56:59], a[76:79], a[100:103], v[56:59]
    s_barrier
    ds_read_b128 a[104:107], v80 offset:39040
    ds_read_b128 a[108:111], v81 offset:39040
    ds_read_b64_tr_b16 a[0:1], v24 offset:39040
    ds_read_b64_tr_b16 a[2:3], v24 offset:39552
    ds_read_b64_tr_b16 a[4:5], v25 offset:39040
    ds_read_b64_tr_b16 a[6:7], v25 offset:39552
    ds_read_b64_tr_b16 a[8:9], v26 offset:39040
    ds_read_b64_tr_b16 a[10:11], v26 offset:39552
    ds_read_b64_tr_b16 a[12:13], v27 offset:39040
    ds_read_b64_tr_b16 a[14:15], v27 offset:39552
    ds_read_b64_tr_b16 a[16:17], v24 offset:47232
    ds_read_b64_tr_b16 a[18:19], v24 offset:47744
    ds_read_b64_tr_b16 a[20:21], v25 offset:47232
    ds_read_b64_tr_b16 a[22:23], v25 offset:47744
    ds_read_b64_tr_b16 a[24:25], v26 offset:47232
    ds_read_b64_tr_b16 a[26:27], v26 offset:47744
    s_waitcnt lgkmcnt(12)
    v_mfma_f32_16x16x32_bf16 v[28:31], a[0:3], v[116:119], v[28:31]
    ds_read_b64_tr_b16 a[28:29], v27 offset:47232
    ds_read_b64_tr_b16 a[30:31], v27 offset:47744
    s_waitcnt lgkmcnt(12)
    v_mfma_f32_16x16x32_bf16 v[32:35], a[4:7], v[116:119], v[32:35]
    ds_read_b64_tr_b16 a[48:49], v24 offset:43136
    ds_read_b64_tr_b16 a[50:51], v24 offset:43648
    s_waitcnt lgkmcnt(12)
    v_mfma_f32_16x16x32_bf16 v[36:39], a[8:11], v[116:119], v[36:39]
    ds_read_b64_tr_b16 a[52:53], v25 offset:43136
    ds_read_b64_tr_b16 a[54:55], v25 offset:43648
    s_waitcnt lgkmcnt(12)
    v_mfma_f32_16x16x32_bf16 v[40:43], a[12:15], v[116:119], v[40:43]
    ds_read_b64_tr_b16 a[56:57], v26 offset:43136
    ds_read_b64_tr_b16 a[58:59], v26 offset:43648
    s_waitcnt lgkmcnt(12)
    v_mfma_f32_16x16x32_bf16 v[44:47], a[16:19], a[104:107], v[44:47]
    ds_read_b64_tr_b16 a[60:61], v27 offset:43136
    ds_read_b64_tr_b16 a[62:63], v27 offset:43648
    s_waitcnt lgkmcnt(12)
    v_mfma_f32_16x16x32_bf16 v[48:51], a[20:23], a[104:107], v[48:51]
    ds_read_b64_tr_b16 a[64:65], v24 offset:51328
    ds_read_b64_tr_b16 a[66:67], v24 offset:51840
    s_waitcnt lgkmcnt(12)
    v_mfma_f32_16x16x32_bf16 v[52:55], a[24:27], a[104:107], v[52:55]
    ds_read_b64_tr_b16 a[68:69], v25 offset:51328
    ds_read_b64_tr_b16 a[70:71], v25 offset:51840
    s_waitcnt lgkmcnt(12)
    v_mfma_f32_16x16x32_bf16 v[56:59], a[28:31], a[104:107], v[56:59]
    ds_read_b64_tr_b16 a[72:73], v26 offset:51328
    ds_read_b64_tr_b16 a[74:75], v26 offset:51840
    s_waitcnt lgkmcnt(12)
    v_mfma_f32_16x16x32_bf16 v[28:31], a[48:51], v[116:119], v[28:31]
    ds_read_b64_tr_b16 a[76:77], v27 offset:51328
    ds_read_b64_tr_b16 a[78:79], v27 offset:51840
    s_waitcnt lgkmcnt(12)
    v_mfma_f32_16x16x32_bf16 v[32:35], a[52:55], v[116:119], v[32:35]
    s_waitcnt lgkmcnt(10)
    v_mfma_f32_16x16x32_bf16 v[36:39], a[56:59], v[116:119], v[36:39]
    s_waitcnt lgkmcnt(8)
    v_mfma_f32_16x16x32_bf16 v[40:43], a[60:63], v[116:119], v[40:43]
    s_waitcnt lgkmcnt(6)
    v_mfma_f32_16x16x32_bf16 v[44:47], a[64:67], a[108:111], v[44:47]
    s_waitcnt lgkmcnt(4)
    v_mfma_f32_16x16x32_bf16 v[48:51], a[68:71], a[108:111], v[48:51]
    s_waitcnt lgkmcnt(2)
    v_mfma_f32_16x16x32_bf16 v[52:55], a[72:75], a[108:111], v[52:55]
    s_waitcnt lgkmcnt(0)
    v_mfma_f32_16x16x32_bf16 v[56:59], a[76:79], a[108:111], v[56:59]
    buffer_load_dwordx2 v[92:93], v96, s[28:31], s46 offen sc1
    buffer_load_dwordx2 v[94:95], v97, s[28:31], s46 offen sc1
    s_barrier
    ds_read_b128 a[112:115], v76 offset:0
    ds_read_b128 a[116:119], v77 offset:0
    ds_read_b64_tr_b16 a[0:1], v20 offset:0
    ds_read_b64_tr_b16 a[2:3], v20 offset:512
    ds_read_b64_tr_b16 a[4:5], v21 offset:0
    ds_read_b64_tr_b16 a[6:7], v21 offset:512
    ds_read_b64_tr_b16 a[8:9], v22 offset:0
    ds_read_b64_tr_b16 a[10:11], v22 offset:512
    ds_read_b64_tr_b16 a[12:13], v23 offset:0
    ds_read_b64_tr_b16 a[14:15], v23 offset:512
    ds_read_b64_tr_b16 a[16:17], v20 offset:8192
    ds_read_b64_tr_b16 a[18:19], v20 offset:8704
    ds_read_b64_tr_b16 a[20:21], v21 offset:8192
    ds_read_b64_tr_b16 a[22:23], v21 offset:8704
    ds_read_b64_tr_b16 a[24:25], v22 offset:8192
    ds_read_b64_tr_b16 a[26:27], v22 offset:8704
    s_waitcnt lgkmcnt(12)
    v_mfma_f32_16x16x32_bf16 v[28:31], a[0:3], v[116:119], v[28:31]
    ds_read_b64_tr_b16 a[28:29], v23 offset:8192
    ds_read_b64_tr_b16 a[30:31], v23 offset:8704
    s_waitcnt lgkmcnt(12)
    v_mfma_f32_16x16x32_bf16 v[32:35], a[4:7], v[116:119], v[32:35]
    ds_read_b64_tr_b16 a[48:49], v20 offset:4096
    ds_read_b64_tr_b16 a[50:51], v20 offset:4608
    s_waitcnt lgkmcnt(12)
    v_mfma_f32_16x16x32_bf16 v[36:39], a[8:11], v[116:119], v[36:39]
    ds_read_b64_tr_b16 a[52:53], v21 offset:4096
    ds_read_b64_tr_b16 a[54:55], v21 offset:4608
    s_waitcnt lgkmcnt(12)
    v_mfma_f32_16x16x32_bf16 v[40:43], a[12:15], v[116:119], v[40:43]
    ds_read_b64_tr_b16 a[56:57], v22 offset:4096
    ds_read_b64_tr_b16 a[58:59], v22 offset:4608
    s_waitcnt lgkmcnt(12)
    v_mfma_f32_16x16x32_bf16 v[44:47], a[16:19], a[112:115], v[44:47]
    ds_read_b64_tr_b16 a[60:61], v23 offset:4096
    ds_read_b64_tr_b16 a[62:63], v23 offset:4608
    s_waitcnt lgkmcnt(12)
    v_mfma_f32_16x16x32_bf16 v[48:51], a[20:23], a[112:115], v[48:51]
    ds_read_b64_tr_b16 a[64:65], v20 offset:12288
    ds_read_b64_tr_b16 a[66:67], v20 offset:12800
    s_waitcnt lgkmcnt(12)
    v_mfma_f32_16x16x32_bf16 v[52:55], a[24:27], a[112:115], v[52:55]
    ds_read_b64_tr_b16 a[68:69], v21 offset:12288
    ds_read_b64_tr_b16 a[70:71], v21 offset:12800
    s_waitcnt lgkmcnt(12)
    v_mfma_f32_16x16x32_bf16 v[56:59], a[28:31], a[112:115], v[56:59]
    ds_read_b64_tr_b16 a[72:73], v22 offset:12288
    ds_read_b64_tr_b16 a[74:75], v22 offset:12800
    s_waitcnt lgkmcnt(12)
    v_mfma_f32_16x16x32_bf16 v[28:31], a[48:51], v[116:119], v[28:31]
    ds_read_b64_tr_b16 a[76:77], v23 offset:12288
    ds_read_b64_tr_b16 a[78:79], v23 offset:12800
    s_waitcnt lgkmcnt(12)
    v_mfma_f32_16x16x32_bf16 v[32:35], a[52:55], v[116:119], v[32:35]
    s_waitcnt lgkmcnt(10)
    v_mfma_f32_16x16x32_bf16 v[36:39], a[56:59], v[116:119], v[36:39]
    s_waitcnt vmcnt(0)
Lst_chk:
    v_cmp_ne_u32 vcc, s34, v93
    v_cmp_ne_u32 s[36:37], s34, v95
    s_nop 0
    s_or_b64 s[36:37], s[36:37], vcc
    s_cbranch_scc1 Lst_re
    v_lshlrev_b32 v93, 16, v92
    s_waitcnt lgkmcnt(8)
    v_mfma_f32_16x16x32_bf16 v[40:43], a[60:63], v[116:119], v[40:43]
    v_and_b32 v92, 0xffff0000, v92
    v_rcp_f32 v93, v93
    s_waitcnt lgkmcnt(6)
    v_mfma_f32_16x16x32_bf16 v[44:47], a[64:67], a[116:119], v[44:47]
    v_lshlrev_b32 v95, 16, v94
    v_and_b32 v94, 0xffff0000, v94
    s_waitcnt lgkmcnt(4)
    v_mfma_f32_16x16x32_bf16 v[48:51], a[68:71], a[116:119], v[48:51]
    v_rcp_f32 v95, v95
    ds_write2st64_b32 v4, v92, v93 offset0:0 offset1:2
    s_waitcnt lgkmcnt(3)
    v_mfma_f32_16x16x32_bf16 v[52:55], a[72:75], a[116:119], v[52:55]
    ds_write2st64_b32 v5, v94, v95 offset0:0 offset1:2
    ds_read_b32 v120, v11
    s_waitcnt lgkmcnt(3)
    v_mfma_f32_16x16x32_bf16 v[56:59], a[76:79], a[116:119], v[56:59]
    s_waitcnt lgkmcnt(0)
    s_barrier
    ds_read_b128 a[120:123], v76 offset:39040
    ds_read_b128 a[124:127], v77 offset:39040
    ds_read_b64_tr_b16 a[0:1], v20 offset:39040
    ds_read_b64_tr_b16 a[2:3], v20 offset:39552
    ds_read_b64_tr_b16 a[4:5], v21 offset:39040
    ds_read_b64_tr_b16 a[6:7], v21 offset:39552
    ds_read_b64_tr_b16 a[8:9], v22 offset:39040
    ds_read_b64_tr_b16 a[10:11], v22 offset:39552
    ds_read_b64_tr_b16 a[12:13], v23 offset:39040
    ds_read_b64_tr_b16 a[14:15], v23 offset:39552
    ds_read_b64_tr_b16 a[16:17], v20 offset:47232
    ds_read_b64_tr_b16 a[18:19], v20 offset:47744
    ds_read_b64_tr_b16 a[20:21], v21 offset:47232
    ds_read_b64_tr_b16 a[22:23], v21 offset:47744
    ds_read_b64_tr_b16 a[24:25], v22 offset:47232
    ds_read_b64_tr_b16 a[26:27], v22 offset:47744
    s_waitcnt lgkmcnt(12)
    v_mfma_f32_16x16x32_bf16 v[28:31], a[0:3], v[116:119], v[28:31]
    ds_read_b64_tr_b16 a[28:29], v23 offset:47232
    ds_read_b64_tr_b16 a[30:31], v23 offset:47744
    s_waitcnt lgkmcnt(12)
    v_mfma_f32_16x16x32_bf16 v[32:35], a[4:7], v[116:119], v[32:35]
    ds_read_b64_tr_b16 a[48:49], v20 offset:43136
    ds_read_b64_tr_b16 a[50:51], v20 offset:43648
    s_waitcnt lgkmcnt(12)
    v_mfma_f32_16x16x32_bf16 v[36:39], a[8:11], v[116:119], v[36:39]
    ds_read_b64_tr_b16 a[52:53], v21 offset:43136
    ds_read_b64_tr_b16 a[54:55], v21 offset:43648
    s_waitcnt lgkmcnt(12)
    v_mfma_f32_16x16x32_bf16 v[40:43], a[12:15], v[116:119], v[40:43]
    ds_read_b64_tr_b16 a[56:57], v22 offset:43136
    ds_read_b64_tr_b16 a[58:59], v22 offset:43648
    s_waitcnt lgkmcnt(12)
    v_mfma_f32_16x16x32_bf16 v[44:47], a[16:19], a[120:123], v[44:47]
    ds_read_b64_tr_b16 a[60:61], v23 offset:43136
    ds_read_b64_tr_b16 a[62:63], v23 offset:43648
    s_waitcnt lgkmcnt(12)
    v_mfma_f32_16x16x32_bf16 v[48:51], a[20:23], a[120:123], v[48:51]
    ds_read_b64_tr_b16 a[64:65], v20 offset:51328
    ds_read_b64_tr_b16 a[66:67], v20 offset:51840
    s_waitcnt lgkmcnt(12)
    v_mfma_f32_16x16x32_bf16 v[52:55], a[24:27], a[120:123], v[52:55]
    ds_read_b64_tr_b16 a[68:69], v21 offset:51328
    ds_read_b64_tr_b16 a[70:71], v21 offset:51840
    s_waitcnt lgkmcnt(12)
    v_mfma_f32_16x16x32_bf16 v[56:59], a[28:31], a[120:123], v[56:59]
    ds_read_b64_tr_b16 a[72:73], v22 offset:51328
    ds_read_b64_tr_b16 a[74:75], v22 offset:51840
    s_waitcnt lgkmcnt(12)
    v_mfma_f32_16x16x32_bf16 v[28:31], a[48:51], v[116:119], v[28:31]
    ds_read_b64_tr_b16 a[76:77], v23 offset:51328
    ds_read_b64_tr_b16 a[78:79], v23 offset:51840
    s_waitcnt lgkmcnt(12)
    v_mfma_f32_16x16x32_bf16 v[32:35], a[52:55], v[116:119], v[32:35]
    s_waitcnt lgkmcnt(10)
    v_mfma_f32_16x16x32_bf16 v[36:39], a[56:59], v[116:119], v[36:39]
    s_waitcnt lgkmcnt(8)
    v_mfma_f32_16x16x32_bf16 v[40:43], a[60:63], v[116:119], v[40:43]
    s_waitcnt lgkmcnt(6)
    v_mfma_f32_16x16x32_bf16 v[44:47], a[64:67], a[124:127], v[44:47]
    s_waitcnt lgkmcnt(4)
    v_mfma_f32_16x16x32_bf16 v[48:51], a[68:71], a[124:127], v[48:51]
    s_waitcnt lgkmcnt(2)
    v_mfma_f32_16x16x32_bf16 v[52:55], a[72:75], a[124:127], v[52:55]
    s_waitcnt lgkmcnt(0)
    v_mfma_f32_16x16x32_bf16 v[56:59], a[76:79], a[124:127], v[56:59]
    s_mov_b32 exec_lo, 0x00010001
    s_mov_b32 exec_hi, 0x00010001
    ds_write_b128 v6, v[28:31] offset:0
    ds_write_b128 v6, v[32:35] offset:64
    ds_write_b128 v6, v[36:39] offset:128
    ds_write_b128 v6, v[40:43] offset:192
    ds_write_b128 v6, v[44:47] offset:256
    ds_write_b128 v6, v[48:51] offset:320
    ds_write_b128 v6, v[52:55] offset:384
    ds_write_b128 v6, v[56:59] offset:448
    ds_write_b32 v7, v7
    s_mov_b64 exec, -1
    ds_read_b128 v[76:79], v6 offset:256
    ds_read_b128 v[80:83], v6 offset:320
    ds_read_b128 v[84:87], v6 offset:384
    ds_read_b128 v[88:91], v6 offset:448
    s_waitcnt lgkmcnt(0)
    v_fmac_f32 v44, v76, v120
    v_fmac_f32 v45, v77, v120
    v_fmac_f32 v46, v78, v120
    v_fmac_f32 v47, v79, v120
    v_cvt_pk_bf16_f32 v44, v44, v45
    v_cvt_pk_bf16_f32 v45, v46, v47
    v_fmac_f32 v48, v80, v120
    v_fmac_f32 v49, v81, v120
    v_fmac_f32 v50, v82, v120
    v_fmac_f32 v51, v83, v120
    v_cvt_pk_bf16_f32 v46, v48, v49
    v_cvt_pk_bf16_f32 v47, v50, v51
    v_fmac_f32 v52, v84, v120
    v_fmac_f32 v53, v85, v120
    v_fmac_f32 v54, v86, v120
    v_fmac_f32 v55, v87, v120
    v_cvt_pk_bf16_f32 v48, v52, v53
    v_cvt_pk_bf16_f32 v49, v54, v55
    v_fmac_f32 v56, v88, v120
    v_fmac_f32 v57, v89, v120
    v_fmac_f32 v58, v90, v120
    v_fmac_f32 v59, v91, v120
    v_cvt_pk_bf16_f32 v50, v56, v57
    v_cvt_pk_bf16_f32 v51, v58, v59
    ds_write_b128 v125, v[44:47] offset:4096
    ds_write_b128 v125, v[48:51] offset:5120
    v_mov_b32 v5, 157972
    v_mov_b32 v6, 1
    s_mov_b64 exec, 1
    ds_add_u32 v5, v6
    s_mov_b64 exec, -1
    v_mov_b32 v5, 157980
Lcw_6:
    s_sub_u32 s35, s35, 1
    s_cbranch_scc1 Lend
    ds_read_b32 v6, v5
    s_waitcnt lgkmcnt(0)
    v_readfirstlane_b32 s38, v6
    s_nop 0
    s_cmp_lt_u32 s38, 1
    s_cbranch_scc1 Lcw_6
    ds_read_b64_tr_b16 a[0:1], v24 offset:16384
    ds_read_b64_tr_b16 a[2:3], v24 offset:16896
    ds_read_b64_tr_b16 a[4:5], v25 offset:16384
    ds_read_b64_tr_b16 a[6:7], v25 offset:16896
    ds_read_b64_tr_b16 a[8:9], v26 offset:16384
    ds_read_b64_tr_b16 a[10:11], v26 offset:16896
    ds_read_b64_tr_b16 a[12:13], v27 offset:16384
    ds_read_b64_tr_b16 a[14:15], v27 offset:16896
    ds_read_b64_tr_b16 a[16:17], v24 offset:20480
    ds_read_b64_tr_b16 a[18:19], v24 offset:20992
    ds_read_b64_tr_b16 a[20:21], v25 offset:20480
    ds_read_b64_tr_b16 a[22:23], v25 offset:20992
    ds_read_b64_tr_b16 a[24:25], v26 offset:20480
    ds_read_b64_tr_b16 a[26:27], v26 offset:20992
    ds_read_b64_tr_b16 a[28:29], v27 offset:20480
    ds_read_b64_tr_b16 a[30:31], v27 offset:20992
    ds_read_b64_tr_b16 a[32:33], v24 offset:55424
    ds_read_b64_tr_b16 a[34:35], v24 offset:55936
    ds_read_b64_tr_b16 a[36:37], v25 offset:55424
    ds_read_b64_tr_b16 a[38:39], v25 offset:55936
    ds_read_b64_tr_b16 a[40:41], v26 offset:55424
    ds_read_b64_tr_b16 a[42:43], v26 offset:55936
    ds_read_b64_tr_b16 a[44:45], v27 offset:55424
    ds_read_b64_tr_b16 a[46:47], v27 offset:55936
    ds_read_b64_tr_b16 a[48:49], v24 offset:59520
    ds_read_b64_tr_b16 a[50:51], v24 offset:60032
    ds_read_b64_tr_b16 a[52:53], v25 offset:59520
    ds_read_b64_tr_b16 a[54:55], v25 offset:60032
    ds_read_b64_tr_b16 a[56:57], v26 offset:59520
    ds_read_b64_tr_b16 a[58:59], v26 offset:60032
    ds_read_b64_tr_b16 a[60:61], v27 offset:59520
    ds_read_b64_tr_b16 a[62:63], v27 offset:60032
    ds_read_b64_tr_b16 a[64:65], v20 offset:16384
    ds_read_b64_tr_b16 a[66:67], v20 offset:16896
    ds_read_b64_tr_b16 a[68:69], v21 offset:16384
    ds_read_b64_tr_b16 a[70:71], v21 offset:16896
    ds_read_b64_tr_b16 a[72:73], v22 offset:16384
    ds_read_b64_tr_b16 a[74:75], v22 offset:16896
    ds_read_b64_tr_b16 a[76:77], v23 offset:16384
    ds_read_b64_tr_b16 a[78:79], v23 offset:16896
    ds_read_b64_tr_b16 a[80:81], v20 offset:20480
    ds_read_b64_tr_b16 a[82:83], v20 offset:20992
    ds_read_b64_tr_b16 a[84:85], v21 offset:20480
    ds_read_b64_tr_b16 a[86:87], v21 offset:20992
    ds_read_b64_tr_b16 a[88:89], v22 offset:20480
    ds_read_b64_tr_b16 a[90:91], v22 offset:20992
    ds_read_b64_tr_b16 a[92:93], v23 offset:20480
    ds_read_b64_tr_b16 a[94:95], v23 offset:20992
    s_waitcnt lgkmcnt(15)
    v_mfma_f32_16x16x32_bf16 v[60:63], a[96:99], a[0:3], v[60:63]
    v_mfma_f32_16x16x32_bf16 v[64:67], a[96:99], a[4:7], v[64:67]
    v_mfma_f32_16x16x32_bf16 v[68:71], a[96:99], a[8:11], v[68:71]
    v_mfma_f32_16x16x32_bf16 v[72:75], a[96:99], a[12:15], v[72:75]
    ds_read_b64_tr_b16 a[0:1], v20 offset:55424
    ds_read_b64_tr_b16 a[2:3], v20 offset:55936
    ds_read_b64_tr_b16 a[4:5], v21 offset:55424
    ds_read_b64_tr_b16 a[6:7], v21 offset:55936
    ds_read_b64_tr_b16 a[8:9], v22 offset:55424
    ds_read_b64_tr_b16 a[10:11], v22 offset:55936
    ds_read_b64_tr_b16 a[12:13], v23 offset:55424
    ds_read_b64_tr_b16 a[14:15], v23 offset:55936
    v_mfma_f32_16x16x32_bf16 v[60:63], a[100:103], a[16:19], v[60:63]
    v_mfma_f32_16x16x32_bf16 v[64:67], a[100:103], a[20:23], v[64:67]
    v_mfma_f32_16x16x32_bf16 v[68:71], a[100:103], a[24:27], v[68:71]
    v_mfma_f32_16x16x32_bf16 v[72:75], a[100:103], a[28:31], v[72:75]
    ds_read_b64_tr_b16 a[16:17], v20 offset:59520
    ds_read_b64_tr_b16 a[18:19], v20 offset:60032
    ds_read_b64_tr_b16 a[20:21], v21 offset:59520
    ds_read_b64_tr_b16 a[22:23], v21 offset:60032
    ds_read_b64_tr_b16 a[24:25], v22 offset:59520
    ds_read_b64_tr_b16 a[26:27], v22 offset:60032
    ds_read_b64_tr_b16 a[28:29], v23 offset:59520
    ds_read_b64_tr_b16 a[30:31], v23 offset:60032
    v_mfma_f32_16x16x32_bf16 v[60:63], a[104:107], a[32:35], v[60:63]
    v_mfma_f32_16x16x32_bf16 v[64:67], a[104:107], a[36:39], v[64:67]
    v_mfma_f32_16x16x32_bf16 v[68:71], a[104:107], a[40:43], v[68:71]
    v_mfma_f32_16x16x32_bf16 v[72:75], a[104:107], a[44:47], v[72:75]
    v_mfma_f32_16x16x32_bf16 v[60:63], a[108:111], a[48:51], v[60:63]
    v_mfma_f32_16x16x32_bf16 v[64:67], a[108:111], a[52:55], v[64:67]
    v_mfma_f32_16x16x32_bf16 v[68:71], a[108:111], a[56:59], v[68:71]
    v_mfma_f32_16x16x32_bf16 v[72:75], a[108:111], a[60:63], v[72:75]
    s_waitcnt lgkmcnt(15)
    v_mfma_f32_16x16x32_bf16 v[60:63], a[112:115], a[64:67], v[60:63]
    v_mfma_f32_16x16x32_bf16 v[64:67], a[112:115], a[68:71], v[64:67]
    v_mfma_f32_16x16x32_bf16 v[68:71], a[112:115], a[72:75], v[68:71]
    v_mfma_f32_16x16x32_bf16 v[72:75], a[112:115], a[76:79], v[72:75]
    v_mfma_f32_16x16x32_bf16 v[60:63], a[116:119], a[80:83], v[60:63]
    v_mfma_f32_16x16x32_bf16 v[64:67], a[116:119], a[84:87], v[64:67]
    v_mfma_f32_16x16x32_bf16 v[68:71], a[116:119], a[88:91], v[68:71]
    v_mfma_f32_16x16x32_bf16 v[72:75], a[116:119], a[92:95], v[72:75]
    s_waitcnt lgkmcnt(8)
    v_mfma_f32_16x16x32_bf16 v[60:63], a[120:123], a[0:3], v[60:63]
    v_mfma_f32_16x16x32_bf16 v[64:67], a[120:123], a[4:7], v[64:67]
    v_mfma_f32_16x16x32_bf16 v[68:71], a[120:123], a[8:11], v[68:71]
    v_mfma_f32_16x16x32_bf16 v[72:75], a[120:123], a[12:15], v[72:75]
    s_waitcnt lgkmcnt(0)
    v_mfma_f32_16x16x32_bf16 v[60:63], a[124:127], a[16:19], v[60:63]
    v_mfma_f32_16x16x32_bf16 v[64:67], a[124:127], a[20:23], v[64:67]
    v_mfma_f32_16x16x32_bf16 v[68:71], a[124:127], a[24:27], v[68:71]
    v_mfma_f32_16x16x32_bf16 v[72:75], a[124:127], a[28:31], v[72:75]
    v_lshlrev_b32 v5, 4, v3
    v_add_u32 v5, 157696, v5
    v_mov_b32 v6, 157952
    v_lshlrev_b32 v4, 4, v2
    v_add_u32 v4, 156224, v4
    v_lshl_add_u32 v125, v1, 3, s45
    s_mov_b64 exec, 0xffff
    ds_write_b32 v5, v60 offset:0
    ds_write_b32 v5, v64 offset:4
    ds_write_b32 v5, v68 offset:8
    ds_write_b32 v5, v72 offset:12
    ds_write_b32 v6, v6
    s_mov_b64 exec, -1
    ds_read_b128 v[36:39], v5
    ds_read_b128 v[28:31], v4
    ds_read_b128 v[32:35], v4 offset:512
    s_waitcnt lgkmcnt(0)
    v_fmac_f32 v60, v28, v36
    v_fmac_f32 v61, v29, v36
    v_fmac_f32 v62, v30, v36
    v_fmac_f32 v63, v31, v36
    v_mul_f32 v60, v60, v32
    v_mul_f32 v61, v61, v33
    v_mul_f32 v62, v62, v34
    v_mul_f32 v63, v63, v35
    v_cvt_pk_bf16_f32 v60, v60, v61
    v_cvt_pk_bf16_f32 v61, v62, v63
    ds_write_b64 v125, v[60:61] offset:0
    v_fmac_f32 v64, v28, v37
    v_fmac_f32 v65, v29, v37
    v_fmac_f32 v66, v30, v37
    v_fmac_f32 v67, v31, v37
    v_mul_f32 v64, v64, v32
    v_mul_f32 v65, v65, v33
    v_mul_f32 v66, v66, v34
    v_mul_f32 v67, v67, v35
    v_cvt_pk_bf16_f32 v64, v64, v65
    v_cvt_pk_bf16_f32 v65, v66, v67
    ds_write_b64 v125, v[64:65] offset:512
    v_fmac_f32 v68, v28, v38
    v_fmac_f32 v69, v29, v38
    v_fmac_f32 v70, v30, v38
    v_fmac_f32 v71, v31, v38
    v_mul_f32 v68, v68, v32
    v_mul_f32 v69, v69, v33
    v_mul_f32 v70, v70, v34
    v_mul_f32 v71, v71, v35
    v_cvt_pk_bf16_f32 v68, v68, v69
    v_cvt_pk_bf16_f32 v69, v70, v71
    ds_write_b64 v125, v[68:69] offset:1024
    v_fmac_f32 v72, v28, v39
    v_fmac_f32 v73, v29, v39
    v_fmac_f32 v74, v30, v39
    v_fmac_f32 v75, v31, v39
    v_mul_f32 v72, v72, v32
    v_mul_f32 v73, v73, v33
    v_mul_f32 v74, v74, v34
    v_mul_f32 v75, v75, v35
    v_cvt_pk_bf16_f32 v72, v72, v73
    v_cvt_pk_bf16_f32 v73, v74, v75
    ds_write_b64 v125, v[72:73] offset:1536
    v_mov_b32 v8, 157976
    v_mov_b32 v9, 1
    s_mov_b64 exec, 1
    ds_add_u32 v8, v9
    s_mov_b64 exec, -1
    s_endpgm
Lst_re:
    s_sub_u32 s35, s35, 1
    s_cbranch_scc1 Lend
    buffer_load_dwordx2 v[92:93], v96, s[28:31], s46 offen sc1
    buffer_load_dwordx2 v[94:95], v97, s[28:31], s46 offen sc1
    s_waitcnt vmcnt(0)
    s_branch Lst_chk
Laux:
    s_lshl_b32 s32, s37, 3
    s_lshl_b32 s39, s38, 2
    s_add_u32 s32, s32, s36
    s_cmp_lt_u32 s37, 4
    s_cselect_b32 s39, s39, 0
    s_add_u32 s32, s32, s39
    s_and_b32 s33, s2, 3
    s_lshl_b32 s33, s33, 3
    s_and_b32 s39, s2, 4
    s_add_u32 s33, s33, s39
    s_add_u32 s33, s33, s37
    s_cmp_ge_u32 s32, 32
    s_cbranch_scc1 Lmst
    v_lshrrev_b32 v5, 3, v1
    v_and_b32 v6, 7, v1
    s_lshl_b32 s40, s3, 14
    s_cmp_eq_u32 s27, 0
    s_cbranch_scc0 Laux_u
    s_lshl_b32 s36, s33, 6
    s_lshl_b32 s37, s26, 4
    s_add_u32 s36, s36, s37
    v_add_u32 v7, s36, v5
    v_mul_u32_u24 v7, 1280, v7
    v_xor_b32 v8, v6, v2
    v_lshl_add_u32 v92, v8, 4, v7
    v_add_u32 v92, 4096, v92
    v_xor_b32 v93, 64, v92
    v_add_u32 v93, 9216, v93
    v_subrev_u32 v94, 1920, v92
    v_subrev_u32 v95, 1920, v93
    s_waitcnt lgkmcnt(0)
    s_sub_u32 s52, s4, 4096
    s_subb_u32 s53, s5, 0
    s_mov_b32 s54, 2625536
    s_mov_b32 s55, 0x20000
    s_mov_b64 s[60:61], s[12:13]
    s_mov_b32 s62, 1280
    s_mov_b32 s63, 0x20000
    s_mov_b32 m0, 131072
    s_nop 0
    buffer_load_dwordx4 v13, s[60:63], 0 offen lds
    s_mov_b64 exec, 0xffff
    buffer_load_dwordx4 v13, s[60:63], 0 offen offset:1024 lds
    s_mov_b64 exec, -1
    s_add_u32 m0, s40, 0
    s_mov_b32 s41, 0
    buffer_load_dwordx4 v92, s[52:55], s41 offen lds
    buffer_load_dwordx4 v93, s[52:55], s41 offen offset:1024 lds
    buffer_load_dwordx4 v94, s[52:55], s41 offen offset:2048 lds
    buffer_load_dwordx4 v95, s[52:55], s41 offen offset:3072 lds
    s_add_u32 m0, s40, 4096
    s_mov_b32 s41, 256
    buffer_load_dwordx4 v92, s[52:55], s41 offen lds
    buffer_load_dwordx4 v93, s[52:55], s41 offen offset:1024 lds
    buffer_load_dwordx4 v94, s[52:55], s41 offen offset:2048 lds
    buffer_load_dwordx4 v95, s[52:55], s41 offen offset:3072 lds
    s_add_u32 m0, s40, 8192
    s_mov_b32 s41, 512
    buffer_load_dwordx4 v92, s[52:55], s41 offen lds
    buffer_load_dwordx4 v93, s[52:55], s41 offen offset:1024 lds
    buffer_load_dwordx4 v94, s[52:55], s41 offen offset:2048 lds
    buffer_load_dwordx4 v95, s[52:55], s41 offen offset:3072 lds
    s_add_u32 m0, s40, 12288
    s_mov_b32 s41, 768
    buffer_load_dwordx4 v92, s[52:55], s41 offen lds
    buffer_load_dwordx4 v93, s[52:55], s41 offen offset:1024 lds
    buffer_load_dwordx4 v94, s[52:55], s41 offen offset:2048 lds
    buffer_load_dwordx4 v95, s[52:55], s41 offen offset:3072 lds
    s_mov_b64 s[28:29], s[24:25]
    s_mov_b32 s30, 268435456
    s_mov_b32 s31, 0x20000
    s_load_dword s34, s[28:29], 0
    s_mov_b64 s[44:45], s[14:15]
    s_mov_b32 s46, 2211840
    s_mov_b32 s47, 0x20000
    s_mov_b64 s[48:49], s[18:19]
    s_mov_b32 s50, 2211840
    s_mov_b32 s51, 0x20000
    v_and_b32 v8, 1, v2
    v_lshlrev_b32 v8, 1, v8
    v_xor_b32 v8, v8, v6
    v_lshlrev_b32 v8, 4, v8
    v_mul_u32_u24 v9, 3456, v5
    s_lshl_b32 s38, s32, 7
    v_add3_u32 v18, v9, v8, s38
    v_xor_b32 v19, 64, v18
    v_add_u32 v19, 26624, v19
    v_add_u32 v20, 53248, v18
    v_add_u32 v21, 53248, v19
    s_mul_i32 s42, s26, 110592
    v_mul_u32_u24 v9, 1280, v5
    v_add_u32 v22, v9, v8
    v_xor_b32 v23, 64, v22
    v_add_u32 v23, 9216, v23
    v_add_u32 v24, 18432, v22
    v_add_u32 v25, 18432, v23
    s_mul_i32 s43, s32, 81920
    s_lshl_b32 s38, s3, 7
    s_add_u32 s43, s43, s38
    v_mov_b32 v96, 0x3f803f80
    v_mov_b32 v97, 0x3f803f80
    v_mov_b32 v98, 0x3f803f80
    v_mov_b32 v99, 0x3f803f80
    v_lshlrev_b32 v100, 4, v2
    v_add_u32 v100, 131072, v100
    v_lshrrev_b32 v10, 1, v3
    v_xor_b32 v10, v10, v2
    v_lshlrev_b32 v10, 4, v10
    v_lshl_add_u32 v10, v3, 7, v10
    v_add_u32 v102, s40, v10
    v_xor_b32 v103, 64, v102
    s_mov_b32 s58, 0xaaaaaaaa
    s_mov_b32 s59, 0xaaaaaaaa
    s_mov_b32 s64, 0xcccccccc
    s_mov_b32 s65, 0xcccccccc
    v_lshrrev_b32 v101, 2, v3
    v_lshl_add_u32 v101, v101, 4, v3
    v_lshlrev_b32 v101, 2, v101
    s_lshl_b32 s36, s26, 4
    v_add_u32 v10, s36, v3
    s_lshl_b32 s37, s33, 6
    s_sub_u32 s37, 2047, s37
    v_sub_u32 v106, s37, v10
    v_lshlrev_b32 v107, 2, v10
    v_add_u32 v107, 132608, v107
    s_lshl_b32 s36, s33, 9
    s_add_u32 s36, s36, 8192000
    v_lshl_add_u32 v108, v10, 3, s36
    v_bfe_u32 v10, v1, 2, 2
    v_and_b32 v8, 3, v1
    v_lshl_add_u32 v14, v2, 3, v10
    v_lshlrev_b32 v14, 7, v14
    v_lshlrev_b32 v9, 2, v1
    v_and_b32 v9, 0x60, v9
    v_add3_u32 v14, v14, v9, s40
    v_lshl_add_u32 v14, v8, 3, v14
    v_xor_b32 v15, 32, v14
    v_xor_b32 v16, 64, v14
    v_xor_b32 v17, 96, v14
    s_lshl_b32 s36, s26, 6
    s_add_u32 s36, s36, 141312
    v_lshl_add_u32 v26, v2, 4, s36
    v_min_u32 v8, 2, v3
    v_mul_u32_u24 v8, 1536, v8
    v_add_u32 v26, v26, v8
    v_add_u32 v4, 132864, v12
    v_mov_b32 v5, 0
    ds_write_b32 v4, v5
    s_waitcnt lgkmcnt(0)
    s_add_u32 s34, s34, 0x9e3779b8
    s_or_b32 s34, s34, 1
    s_waitcnt vmcnt(12)
    ds_read_b128 a[80:83], v102 offset:0
    ds_read_b128 a[84:87], v100 offset:0
    ds_read_b128 a[88:91], v103 offset:0
    ds_read_b128 a[92:95], v100 offset:64
    ds_read_b128 a[96:99], v102 offset:2048
    ds_read_b128 a[100:103], v100 offset:128
    ds_read_b128 a[104:107], v103 offset:2048
    ds_read_b128 a[108:111], v100 offset:192
    s_waitcnt lgkmcnt(0)
    s_add_u32 m0, s40, 0
    s_mov_b32 s41, 1024
    buffer_load_dwordx4 v92, s[52:55], s41 offen lds
    buffer_load_dwordx4 v93, s[52:55], s41 offen offset:1024 lds
    buffer_load_dwordx4 v94, s[52:55], s41 offen offset:2048 lds
    buffer_load_dwordx4 v95, s[52:55], s41 offen offset:3072 lds
    s_barrier
    v_mfma_f32_16x16x32_bf16 v[116:119], a[80:83], a[80:83], 0
    v_mfma_f32_16x16x32_bf16 v[112:115], v[96:99], a[80:83], 0
    v_mfma_f32_16x16x32_bf16 v[120:123], a[84:87], a[80:83], 0
    v_mfma_f32_16x16x32_bf16 v[124:127], a[84:87], v[96:99], 0
    v_mfma_f32_16x16x32_bf16 v[116:119], a[88:91], a[88:91], v[116:119]
    v_mfma_f32_16x16x32_bf16 v[112:115], v[96:99], a[88:91], v[112:115]
    v_mfma_f32_16x16x32_bf16 v[120:123], a[92:95], a[88:91], v[120:123]
    v_mfma_f32_16x16x32_bf16 v[124:127], a[92:95], v[96:99], v[124:127]
    v_mfma_f32_16x16x32_bf16 v[116:119], a[96:99], a[96:99], v[116:119]
    v_mfma_f32_16x16x32_bf16 v[112:115], v[96:99], a[96:99], v[112:115]
    v_mfma_f32_16x16x32_bf16 v[120:123], a[100:103], a[96:99], v[120:123]
    v_mfma_f32_16x16x32_bf16 v[124:127], a[100:103], v[96:99], v[124:127]
    v_mfma_f32_16x16x32_bf16 v[116:119], a[104:107], a[104:107], v[116:119]
    v_mfma_f32_16x16x32_bf16 v[112:115], v[96:99], a[104:107], v[112:115]
    v_mfma_f32_16x16x32_bf16 v[120:123], a[108:111], a[104:107], v[120:123]
    v_mfma_f32_16x16x32_bf16 v[124:127], a[108:111], v[96:99], v[124:127]
    s_waitcnt vmcnt(12)
    ds_read_b128 a[80:83], v102 offset:4096
    ds_read_b128 a[84:87], v100 offset:256
    ds_read_b128 a[88:91], v103 offset:4096
    ds_read_b128 a[92:95], v100 offset:320
    ds_read_b128 a[96:99], v102 offset:6144
    ds_read_b128 a[100:103], v100 offset:384
    ds_read_b128 a[104:107], v103 offset:6144
    ds_read_b128 a[108:111], v100 offset:448
    s_waitcnt lgkmcnt(0)
    v_mfma_f32_16x16x32_bf16 v[116:119], a[80:83], a[80:83], v[116:119]
    v_mfma_f32_16x16x32_bf16 v[112:115], v[96:99], a[80:83], v[112:115]
    v_mfma_f32_16x16x32_bf16 v[120:123], a[84:87], a[80:83], v[120:123]
    v_mfma_f32_16x16x32_bf16 v[124:127], a[84:87], v[96:99], v[124:127]
    v_mfma_f32_16x16x32_bf16 v[116:119], a[88:91], a[88:91], v[116:119]
    v_mfma_f32_16x16x32_bf16 v[112:115], v[96:99], a[88:91], v[112:115]
    v_mfma_f32_16x16x32_bf16 v[120:123], a[92:95], a[88:91], v[120:123]
    v_mfma_f32_16x16x32_bf16 v[124:127], a[92:95], v[96:99], v[124:127]
    v_mfma_f32_16x16x32_bf16 v[116:119], a[96:99], a[96:99], v[116:119]
    v_mfma_f32_16x16x32_bf16 v[112:115], v[96:99], a[96:99], v[112:115]
    v_mfma_f32_16x16x32_bf16 v[120:123], a[100:103], a[96:99], v[120:123]
    v_mfma_f32_16x16x32_bf16 v[124:127], a[100:103], v[96:99], v[124:127]
    v_mfma_f32_16x16x32_bf16 v[116:119], a[104:107], a[104:107], v[116:119]
    v_mfma_f32_16x16x32_bf16 v[112:115], v[96:99], a[104:107], v[112:115]
    v_mfma_f32_16x16x32_bf16 v[120:123], a[108:111], a[104:107], v[120:123]
    v_mfma_f32_16x16x32_bf16 v[124:127], a[108:111], v[96:99], v[124:127]
    s_waitcnt vmcnt(8)
    ds_read_b128 a[80:83], v102 offset:8192
    ds_read_b128 a[84:87], v100 offset:512
    ds_read_b128 a[88:91], v103 offset:8192
    ds_read_b128 a[92:95], v100 offset:576
    ds_read_b128 a[96:99], v102 offset:10240
    ds_read_b128 a[100:103], v100 offset:640
    ds_read_b128 a[104:107], v103 offset:10240
    ds_read_b128 a[108:111], v100 offset:704
    s_waitcnt lgkmcnt(0)
    v_mfma_f32_16x16x32_bf16 v[116:119], a[80:83], a[80:83], v[116:119]
    v_mfma_f32_16x16x32_bf16 v[112:115], v[96:99], a[80:83], v[112:115]
    v_mfma_f32_16x16x32_bf16 v[120:123], a[84:87], a[80:83], v[120:123]
    v_mfma_f32_16x16x32_bf16 v[124:127], a[84:87], v[96:99], v[124:127]
    v_mfma_f32_16x16x32_bf16 v[116:119], a[88:91], a[88:91], v[116:119]
    v_mfma_f32_16x16x32_bf16 v[112:115], v[96:99], a[88:91], v[112:115]
    v_mfma_f32_16x16x32_bf16 v[120:123], a[92:95], a[88:91], v[120:123]
    v_mfma_f32_16x16x32_bf16 v[124:127], a[92:95], v[96:99], v[124:127]
    v_mfma_f32_16x16x32_bf16 v[116:119], a[96:99], a[96:99], v[116:119]
    v_mfma_f32_16x16x32_bf16 v[112:115], v[96:99], a[96:99], v[112:115]
    v_mfma_f32_16x16x32_bf16 v[120:123], a[100:103], a[96:99], v[120:123]
    v_mfma_f32_16x16x32_bf16 v[124:127], a[100:103], v[96:99], v[124:127]
    v_mfma_f32_16x16x32_bf16 v[116:119], a[104:107], a[104:107], v[116:119]
    v_mfma_f32_16x16x32_bf16 v[112:115], v[96:99], a[104:107], v[112:115]
    v_mfma_f32_16x16x32_bf16 v[120:123], a[108:111], a[104:107], v[120:123]
    v_mfma_f32_16x16x32_bf16 v[124:127], a[108:111], v[96:99], v[124:127]
    s_waitcnt vmcnt(4)
    ds_read_b128 a[80:83], v102 offset:12288
    ds_read_b128 a[84:87], v100 offset:768
    ds_read_b128 a[88:91], v103 offset:12288
    ds_read_b128 a[92:95], v100 offset:832
    ds_read_b128 a[96:99], v102 offset:14336
    ds_read_b128 a[100:103], v100 offset:896
    ds_read_b128 a[104:107], v103 offset:14336
    ds_read_b128 a[108:111], v100 offset:960
    s_waitcnt lgkmcnt(0)
    v_mfma_f32_16x16x32_bf16 v[116:119], a[80:83], a[80:83], v[116:119]
    v_mfma_f32_16x16x32_bf16 v[112:115], v[96:99], a[80:83], v[112:115]
    v_mfma_f32_16x16x32_bf16 v[120:123], a[84:87], a[80:83], v[120:123]
    v_mfma_f32_16x16x32_bf16 v[124:127], a[84:87], v[96:99], v[124:127]
    v_mfma_f32_16x16x32_bf16 v[116:119], a[88:91], a[88:91], v[116:119]
    v_mfma_f32_16x16x32_bf16 v[112:115], v[96:99], a[88:91], v[112:115]
    v_mfma_f32_16x16x32_bf16 v[120:123], a[92:95], a[88:91], v[120:123]
    v_mfma_f32_16x16x32_bf16 v[124:127], a[92:95], v[96:99], v[124:127]
    v_mfma_f32_16x16x32_bf16 v[116:119], a[96:99], a[96:99], v[116:119]
    v_mfma_f32_16x16x32_bf16 v[112:115], v[96:99], a[96:99], v[112:115]
    v_mfma_f32_16x16x32_bf16 v[120:123], a[100:103], a[96:99], v[120:123]
    v_mfma_f32_16x16x32_bf16 v[124:127], a[100:103], v[96:99], v[124:127]
    v_mfma_f32_16x16x32_bf16 v[116:119], a[104:107], a[104:107], v[116:119]
    v_mfma_f32_16x16x32_bf16 v[112:115], v[96:99], a[104:107], v[112:115]
    v_mfma_f32_16x16x32_bf16 v[120:123], a[108:111], a[104:107], v[120:123]
    v_mfma_f32_16x16x32_bf16 v[124:127], a[108:111], v[96:99], v[124:127]
    s_waitcnt vmcnt(0)
    ds_read_b128 a[80:83], v102 offset:0
    ds_read_b128 a[84:87], v100 offset:1024
    ds_read_b128 a[88:91], v103 offset:0
    ds_read_b128 a[92:95], v100 offset:1088
    ds_read_b128 a[96:99], v102 offset:2048
    ds_read_b128 a[100:103], v100 offset:1152
    ds_read_b128 a[104:107], v103 offset:2048
    ds_read_b128 a[108:111], v100 offset:1216
    s_waitcnt lgkmcnt(0)
    v_mfma_f32_16x16x32_bf16 v[116:119], a[80:83], a[80:83], v[116:119]
    v_mfma_f32_16x16x32_bf16 v[112:115], v[96:99], a[80:83], v[112:115]
    v_mfma_f32_16x16x32_bf16 v[120:123], a[84:87], a[80:83], v[120:123]
    v_mfma_f32_16x16x32_bf16 v[124:127], a[84:87], v[96:99], v[124:127]
    v_mfma_f32_16x16x32_bf16 v[116:119], a[88:91], a[88:91], v[116:119]
    v_mfma_f32_16x16x32_bf16 v[112:115], v[96:99], a[88:91], v[112:115]
    v_mfma_f32_16x16x32_bf16 v[120:123], a[92:95], a[88:91], v[120:123]
    v_mfma_f32_16x16x32_bf16 v[124:127], a[92:95], v[96:99], v[124:127]
    v_mfma_f32_16x16x32_bf16 v[116:119], a[96:99], a[96:99], v[116:119]
    v_mfma_f32_16x16x32_bf16 v[112:115], v[96:99], a[96:99], v[112:115]
    v_mfma_f32_16x16x32_bf16 v[120:123], a[100:103], a[96:99], v[120:123]
    v_mfma_f32_16x16x32_bf16 v[124:127], a[100:103], v[96:99], v[124:127]
    v_mfma_f32_16x16x32_bf16 v[116:119], a[104:107], a[104:107], v[116:119]
    v_mfma_f32_16x16x32_bf16 v[112:115], v[96:99], a[104:107], v[112:115]
    v_mfma_f32_16x16x32_bf16 v[120:123], a[108:111], a[104:107], v[120:123]
    v_mfma_f32_16x16x32_bf16 v[124:127], a[108:111], v[96:99], v[124:127]
    s_nop 4
    v_cndmask_b32 v4, v116, v117, s[58:59]
    v_cndmask_b32 v5, v118, v119, s[58:59]
    v_cndmask_b32 v4, v4, v5, s[64:65]
    ds_bpermute_b32 v4, v101, v4
    v_mul_f32 v5, 0xbacccccd, v112
    v_cvt_pk_bf16_f32 v104, v5, v5
    v_lshlrev_b32 v104, 16, v104
    v_mul_f32 v5, v5, v5
    v_mov_b32 v6, 0x3acccccd
    s_waitcnt lgkmcnt(0)
    v_fma_f32 v4, v4, v6, -v5
    v_max_f32 v4, 0, v4
    v_cvt_pk_bf16_f32 v4, v4, v4
    v_lshlrev_b32 v4, 16, v4
    v_add_f32 v4, 0x3727c5ac, v4
    v_cvt_pk_bf16_f32 v4, v4, v4
    v_lshlrev_b32 v4, 16, v4
    v_sqrt_f32 v4, v4
    s_nop 0
    v_cvt_pk_bf16_f32 v4, v4, v4
    v_lshlrev_b32 v4, 16, v4
    v_rcp_f32 v105, v4
    v_lshrrev_b32 v8, 16, v4
    v_fma_f32 v4, v104, v124, v120
    v_mul_f32 v4, v4, v105
    v_cvt_pk_bf16_f32 v4, v4, v4
    v_ashrrev_i32 v5, 31, v4
    v_or_b32 v5, 0x80000000, v5
    v_xor_b32 v4, v4, v5
    v_and_b32 v4, 0xffff0000, v4
    v_or_b32 v4, v4, v106
    ds_write_b32 v107, v4
    v_mov_b32 v11, 132864
    v_mov_b32 v7, 1
    s_mov_b64 exec, 1
    ds_add_u32 v11, v7
    s_mov_b64 exec, -1
    v_or_b32 v8, v8, v104
    v_mov_b32 v9, s34
    s_mov_b64 exec, 0xffff
    buffer_store_dwordx2 v[8:9], v108, s[28:31], 0 offen sc1
    s_mov_b64 exec, -1
    s_cmp_lg_u32 s26, 0
    s_cbranch_scc1 Lpub_done
    s_setprio 3
Lcw_9:
    s_sub_u32 s35, s35, 1
    s_cbranch_scc1 Lend
    ds_read_b32 v7, v11
    s_waitcnt lgkmcnt(0)
    v_readfirstlane_b32 s38, v7
    s_nop 0
    s_cmp_lt_u32 s38, 4
    s_cbranch_scc1 Lcw_9
    v_add_u32 v5, 132608, v12
    ds_read_b32 v6, v5
    s_waitcnt lgkmcnt(0)
    v_mov_b32 v4, v6
    s_nop 1
    v_max_u32_dpp v4, v4, v4 row_ror:8 row_mask:0xf bank_mask:0xf
    s_nop 1
    v_max_u32_dpp v4, v4, v4 row_ror:4 row_mask:0xf bank_mask:0xf
    s_nop 1
    v_max_u32_dpp v4, v4, v4 row_ror:2 row_mask:0xf bank_mask:0xf
    s_nop 1
    v_max_u32_dpp v4, v4, v4 row_ror:1 row_mask:0xf bank_mask:0xf
    s_nop 0
    v_readlane_b32 s66, v4, 0
    v_readlane_b32 s36, v4, 16
    v_readlane_b32 s37, v4, 32
    v_readlane_b32 s38, v4, 48
    s_max_u32 s66, s66, s36
    s_max_u32 s37, s37, s38
    s_max_u32 s66, s66, s37
    v_cmp_eq_u32 vcc, s66, v6
    s_nop 1
    v_cndmask_b32 v4, v6, 0, vcc
    s_nop 1
    v_max_u32_dpp v4, v4, v4 row_ror:8 row_mask:0xf bank_mask:0xf
    s_nop 1
    v_max_u32_dpp v4, v4, v4 row_ror:4 row_mask:0xf bank_mask:0xf
    s_nop 1
    v_max_u32_dpp v4, v4, v4 row_ror:2 row_mask:0xf bank_mask:0xf
    s_nop 1
    v_max_u32_dpp v4, v4, v4 row_ror:1 row_mask:0xf bank_mask:0xf
    s_nop 0
    v_readlane_b32 s67, v4, 0
    v_readlane_b32 s36, v4, 16
    v_readlane_b32 s37, v4, 32
    v_readlane_b32 s38, v4, 48
    s_max_u32 s67, s67, s36
    s_max_u32 s37, s37, s38
    s_max_u32 s67, s67, s37
    v_mov_b32 v112, s66
    v_mov_b32 v113, s34
    v_mov_b32 v114, s67
    v_mov_b32 v115, s34
    s_lshl_b32 s36, s32, 7
    s_add_u32 s36, s36, 8126464
    s_mov_b64 exec, 0xff
    buffer_store_dwordx4 v[112:115], v13, s[28:31], s36 offen sc1
    s_mov_b64 exec, -1
    v_mov_b32 v11, 132864
    v_mov_b32 v7, 1
    s_mov_b64 exec, 1
    ds_add_u32 v11, v7
    s_mov_b64 exec, -1
    s_mov_b64 exec, 1
    s_lshl_b32 s36, s2, 2
    s_add_u32 s36, s36, 8323072
    v_mov_b32 v4, s34
    v_mov_b32 v5, s36
    buffer_store_dword v4, v5, s[28:31], 0 offen sc1
    s_mov_b64 exec, -1
    s_setprio 0
Lpub_done:
Lcw_10:
    s_sub_u32 s35, s35, 1
    s_cbranch_scc1 Lend
    ds_read_b32 v7, v11
    s_waitcnt lgkmcnt(0)
    v_readfirstlane_b32 s38, v7
    s_nop 0
    s_cmp_lt_u32 s38, 5
    s_cbranch_scc1 Lcw_10
    s_cmp_ge_u32 s32, 27
    s_cbranch_scc1 Lhelp_r
    s_add_u32 m0, s40, 0
    s_add_u32 s41, s42, 0
    buffer_load_dwordx4 v18, s[44:47], s41 offen nt lds
    buffer_load_dwordx4 v19, s[44:47], s41 offen offset:1024 nt lds
    buffer_load_dwordx4 v20, s[44:47], s41 offen offset:2048 nt lds
    buffer_load_dwordx4 v21, s[44:47], s41 offen offset:3072 nt lds
    s_add_u32 m0, s40, 4096
    s_add_u32 s41, s42, 442368
    buffer_load_dwordx4 v18, s[44:47], s41 offen nt lds
    buffer_load_dwordx4 v19, s[44:47], s41 offen offset:1024 nt lds
    buffer_load_dwordx4 v20, s[44:47], s41 offen offset:2048 nt lds
    buffer_load_dwordx4 v21, s[44:47], s41 offen offset:3072 nt lds
    s_add_u32 m0, s40, 8192
    s_add_u32 s41, s42, 884736
    buffer_load_dwordx4 v18, s[44:47], s41 offen nt lds
    buffer_load_dwordx4 v19, s[44:47], s41 offen offset:1024 nt lds
    buffer_load_dwordx4 v20, s[44:47], s41 offen offset:2048 nt lds
    buffer_load_dwordx4 v21, s[44:47], s41 offen offset:3072 nt lds
    s_add_u32 m0, s40, 12288
    s_add_u32 s41, s42, 1327104
    buffer_load_dwordx4 v18, s[44:47], s41 offen nt lds
    buffer_load_dwordx4 v19, s[44:47], s41 offen offset:1024 nt lds
    buffer_load_dwordx4 v20, s[44:47], s41 offen offset:2048 nt lds
    buffer_load_dwordx4 v21, s[44:47], s41 offen offset:3072 nt lds
    s_waitcnt vmcnt(12)
    ds_read_b64_tr_b16 a[0:1], v14 offset:0
    ds_read_b64_tr_b16 a[2:3], v14 offset:512
    ds_read_b64_tr_b16 a[4:5], v15 offset:0
    ds_read_b64_tr_b16 a[6:7], v15 offset:512
    ds_read_b64_tr_b16 a[8:9], v16 offset:0
    ds_read_b64_tr_b16 a[10:11], v16 offset:512
    ds_read_b64_tr_b16 a[12:13], v17 offset:0
    ds_read_b64_tr_b16 a[14:15], v17 offset:512
    s_waitcnt lgkmcnt(0)
    s_add_u32 m0, s40, 0
    s_add_u32 s41, s42, 1769472
    buffer_load_dwordx4 v18, s[44:47], s41 offen nt lds
    buffer_load_dwordx4 v19, s[44:47], s41 offen offset:1024 nt lds
    buffer_load_dwordx4 v20, s[44:47], s41 offen offset:2048 nt lds
    buffer_load_dwordx4 v21, s[44:47], s41 offen offset:3072 nt lds
    v_mov_b32 v11, 132864
    v_mov_b32 v7, 1
    s_mov_b64 exec, 1
    ds_add_u32 v11, v7
    s_mov_b64 exec, -1
    s_waitcnt vmcnt(12)
    ds_read_b64_tr_b16 a[16:17], v14 offset:4096
    ds_read_b64_tr_b16 a[18:19], v14 offset:4608
    ds_read_b64_tr_b16 a[20:21], v15 offset:4096
    ds_read_b64_tr_b16 a[22:23], v15 offset:4608
    ds_read_b64_tr_b16 a[24:25], v16 offset:4096
    ds_read_b64_tr_b16 a[26:27], v16 offset:4608
    ds_read_b64_tr_b16 a[28:29], v17 offset:4096
    ds_read_b64_tr_b16 a[30:31], v17 offset:4608
    s_waitcnt lgkmcnt(0)
    s_add_u32 m0, s40, 4096
    s_add_u32 s41, s43, 0
    buffer_load_dwordx4 v22, s[48:51], s41 offen nt lds
    buffer_load_dwordx4 v23, s[48:51], s41 offen offset:1024 nt lds
    buffer_load_dwordx4 v24, s[48:51], s41 offen offset:2048 nt lds
    buffer_load_dwordx4 v25, s[48:51], s41 offen offset:3072 nt lds
    s_waitcnt vmcnt(12)
    ds_read_b64_tr_b16 a[32:33], v14 offset:8192
    ds_read_b64_tr_b16 a[34:35], v14 offset:8704
    ds_read_b64_tr_b16 a[36:37], v15 offset:8192
    ds_read_b64_tr_b16 a[38:39], v15 offset:8704
    ds_read_b64_tr_b16 a[40:41], v16 offset:8192
    ds_read_b64_tr_b16 a[42:43], v16 offset:8704
    ds_read_b64_tr_b16 a[44:45], v17 offset:8192
    ds_read_b64_tr_b16 a[46:47], v17 offset:8704
    s_waitcnt lgkmcnt(0)
    s_add_u32 m0, s40, 8192
    s_add_u32 s41, s43, 40960
    buffer_load_dwordx4 v22, s[48:51], s41 offen nt lds
    buffer_load_dwordx4 v23, s[48:51], s41 offen offset:1024 nt lds
    buffer_load_dwordx4 v24, s[48:51], s41 offen offset:2048 nt lds
    buffer_load_dwordx4 v25, s[48:51], s41 offen offset:3072 nt lds
    s_waitcnt vmcnt(12)
    ds_read_b64_tr_b16 a[48:49], v14 offset:12288
    ds_read_b64_tr_b16 a[50:51], v14 offset:12800
    ds_read_b64_tr_b16 a[52:53], v15 offset:12288
    ds_read_b64_tr_b16 a[54:55], v15 offset:12800
    ds_read_b64_tr_b16 a[56:57], v16 offset:12288
    ds_read_b64_tr_b16 a[58:59], v16 offset:12800
    ds_read_b64_tr_b16 a[60:61], v17 offset:12288
    ds_read_b64_tr_b16 a[62:63], v17 offset:12800
    s_waitcnt vmcnt(8)
    ds_read_b64_tr_b16 a[64:65], v14 offset:0
    ds_read_b64_tr_b16 a[66:67], v14 offset:512
    ds_read_b64_tr_b16 a[68:69], v15 offset:0
    ds_read_b64_tr_b16 a[70:71], v15 offset:512
    ds_read_b64_tr_b16 a[72:73], v16 offset:0
    ds_read_b64_tr_b16 a[74:75], v16 offset:512
    ds_read_b64_tr_b16 a[76:77], v17 offset:0
    ds_read_b64_tr_b16 a[78:79], v17 offset:512
    s_branch Laux_mm
Laux_u:
    s_cmp_ge_u32 s32, 27
    s_cbranch_scc1 Lend
    v_and_b32 v8, 1, v2
    v_lshlrev_b32 v8, 1, v8
    v_xor_b32 v8, v8, v6
    v_lshlrev_b32 v8, 4, v8
    v_mul_u32_u24 v9, 3456, v5
    s_lshl_b32 s38, s32, 7
    v_add3_u32 v18, v9, v8, s38
    v_xor_b32 v19, 64, v18
    v_add_u32 v19, 26624, v19
    v_add_u32 v20, 53248, v18
    v_add_u32 v21, 53248, v19
    s_mul_i32 s42, s26, 110592
    v_mul_u32_u24 v9, 1280, v5
    v_add_u32 v22, v9, v8
    v_xor_b32 v23, 64, v22
    v_add_u32 v23, 9216, v23
    v_add_u32 v24, 18432, v22
    v_add_u32 v25, 18432, v23
    s_mul_i32 s43, s32, 81920
    s_lshl_b32 s38, s3, 7
    s_add_u32 s43, s43, s38
    s_waitcnt lgkmcnt(0)
    s_mov_b64 s[44:45], s[16:17]
    s_mov_b32 s46, 2211840
    s_mov_b32 s47, 0x20000
    s_mov_b64 s[28:29], s[24:25]
    s_mov_b32 s30, 268435456
    s_mov_b32 s31, 0x20000
    s_load_dword s34, s[28:29], 0
    s_mov_b64 s[52:53], s[4:5]
    s_mov_b32 s54, 2621440
    s_mov_b32 s55, 0x20000
    s_mov_b64 s[48:49], s[18:19]
    s_mov_b32 s50, 2211840
    s_mov_b32 s51, 0x20000
    s_mov_b64 s[68:69], s[18:19]
    s_mov_b32 s70, 2211840
    s_mov_b32 s71, 0x20000
    s_cmp_ge_u32 s26, 2
    s_cselect_b32 s70, 0, s70
    v_bfe_u32 v10, v1, 2, 2
    v_and_b32 v8, 3, v1
    v_lshl_add_u32 v14, v2, 3, v10
    v_lshlrev_b32 v14, 7, v14
    v_lshlrev_b32 v9, 2, v1
    v_and_b32 v9, 0x60, v9
    v_add3_u32 v14, v14, v9, s40
    v_lshl_add_u32 v14, v8, 3, v14
    v_xor_b32 v15, 32, v14
    v_xor_b32 v16, 64, v14
    v_xor_b32 v17, 96, v14
    s_lshl_b32 s36, s26, 6
    s_add_u32 s36, s36, 141312
    v_lshl_add_u32 v26, v2, 4, s36
    v_min_u32 v8, 2, v3
    v_mul_u32_u24 v8, 1536, v8
    v_add_u32 v26, v26, v8
    s_waitcnt lgkmcnt(0)
    s_add_u32 s34, s34, 0x9e3779b8
    s_or_b32 s34, s34, 1
    s_cmp_lg_u32 s3, 7
    s_cbranch_scc1 Lnop7
    s_setprio 3
Lnop7:
    s_barrier
    s_add_u32 m0, s40, 0
    s_add_u32 s41, s42, 0
    buffer_load_dwordx4 v18, s[44:47], s41 offen nt lds
    buffer_load_dwordx4 v19, s[44:47], s41 offen offset:1024 nt lds
    buffer_load_dwordx4 v20, s[44:47], s41 offen offset:2048 nt lds
    buffer_load_dwordx4 v21, s[44:47], s41 offen offset:3072 nt lds
    s_add_u32 m0, s40, 4096
    s_add_u32 s41, s42, 442368
    buffer_load_dwordx4 v18, s[44:47], s41 offen nt lds
    buffer_load_dwordx4 v19, s[44:47], s41 offen offset:1024 nt lds
    buffer_load_dwordx4 v20, s[44:47], s41 offen offset:2048 nt lds
    buffer_load_dwordx4 v21, s[44:47], s41 offen offset:3072 nt lds
    s_add_u32 m0, s40, 8192
    s_add_u32 s41, s42, 884736
    buffer_load_dwordx4 v18, s[44:47], s41 offen nt lds
    buffer_load_dwordx4 v19, s[44:47], s41 offen offset:1024 nt lds
    buffer_load_dwordx4 v20, s[44:47], s41 offen offset:2048 nt lds
    buffer_load_dwordx4 v21, s[44:47], s41 offen offset:3072 nt lds
    s_add_u32 m0, s40, 12288
    s_add_u32 s41, s42, 1327104
    buffer_load_dwordx4 v18, s[44:47], s41 offen nt lds
    buffer_load_dwordx4 v19, s[44:47], s41 offen offset:1024 nt lds
    buffer_load_dwordx4 v20, s[44:47], s41 offen offset:2048 nt lds
    buffer_load_dwordx4 v21, s[44:47], s41 offen offset:3072 nt lds
    v_mov_b32 v11, 132864
Lcw_11:
    s_sub_u32 s35, s35, 1
    s_cbranch_scc1 Lend
    s_sleep 4
    ds_read_b32 v7, v11
    s_waitcnt lgkmcnt(0)
    v_readfirstlane_b32 s38, v7
    s_nop 0
    s_cmp_lt_u32 s38, 5
    s_cbranch_scc1 Lcw_11
    s_waitcnt vmcnt(12)
    ds_read_b64_tr_b16 a[0:1], v14 offset:0
    ds_read_b64_tr_b16 a[2:3], v14 offset:512
    ds_read_b64_tr_b16 a[4:5], v15 offset:0
    ds_read_b64_tr_b16 a[6:7], v15 offset:512
    ds_read_b64_tr_b16 a[8:9], v16 offset:0
    ds_read_b64_tr_b16 a[10:11], v16 offset:512
    ds_read_b64_tr_b16 a[12:13], v17 offset:0
    ds_read_b64_tr_b16 a[14:15], v17 offset:512
    s_waitcnt lgkmcnt(0)
    s_add_u32 m0, s40, 0
    s_add_u32 s41, s42, 1769472
    buffer_load_dwordx4 v18, s[44:47], s41 offen nt lds
    buffer_load_dwordx4 v19, s[44:47], s41 offen offset:1024 nt lds
    buffer_load_dwordx4 v20, s[44:47], s41 offen offset:2048 nt lds
    buffer_load_dwordx4 v21, s[44:47], s41 offen offset:3072 nt lds
    s_waitcnt vmcnt(12)
    ds_read_b64_tr_b16 a[16:17], v14 offset:4096
    ds_read_b64_tr_b16 a[18:19], v14 offset:4608
    ds_read_b64_tr_b16 a[20:21], v15 offset:4096
    ds_read_b64_tr_b16 a[22:23], v15 offset:4608
    ds_read_b64_tr_b16 a[24:25], v16 offset:4096
    ds_read_b64_tr_b16 a[26:27], v16 offset:4608
    ds_read_b64_tr_b16 a[28:29], v17 offset:4096
    ds_read_b64_tr_b16 a[30:31], v17 offset:4608
    s_waitcnt vmcnt(8)
    ds_read_b64_tr_b16 a[32:33], v14 offset:8192
    ds_read_b64_tr_b16 a[34:35], v14 offset:8704
    ds_read_b64_tr_b16 a[36:37], v15 offset:8192
    ds_read_b64_tr_b16 a[38:39], v15 offset:8704
    ds_read_b64_tr_b16 a[40:41], v16 offset:8192
    ds_read_b64_tr_b16 a[42:43], v16 offset:8704
    ds_read_b64_tr_b16 a[44:45], v17 offset:8192
    ds_read_b64_tr_b16 a[46:47], v17 offset:8704
    s_waitcnt vmcnt(4)
    ds_read_b64_tr_b16 a[48:49], v14 offset:12288
    ds_read_b64_tr_b16 a[50:51], v14 offset:12800
    ds_read_b64_tr_b16 a[52:53], v15 offset:12288
    ds_read_b64_tr_b16 a[54:55], v15 offset:12800
    ds_read_b64_tr_b16 a[56:57], v16 offset:12288
    ds_read_b64_tr_b16 a[58:59], v16 offset:12800
    ds_read_b64_tr_b16 a[60:61], v17 offset:12288
    ds_read_b64_tr_b16 a[62:63], v17 offset:12800
    s_waitcnt vmcnt(0)
    ds_read_b64_tr_b16 a[64:65], v14 offset:0
    ds_read_b64_tr_b16 a[66:67], v14 offset:512
    ds_read_b64_tr_b16 a[68:69], v15 offset:0
    ds_read_b64_tr_b16 a[70:71], v15 offset:512
    ds_read_b64_tr_b16 a[72:73], v16 offset:0
    ds_read_b64_tr_b16 a[74:75], v16 offset:512
    ds_read_b64_tr_b16 a[76:77], v17 offset:0
    ds_read_b64_tr_b16 a[78:79], v17 offset:512
    s_cmp_lg_u32 s3, 7
    s_cbranch_scc1 Lnofx
    v_mov_b32 v92, 0x3f803f80
    v_mov_b32 v93, 0x3f803f80
    v_mov_b32 v94, 0x3f803f80
    v_mov_b32 v95, 0x3f803f80
    v_add_u32 v4, 144384, v13
    ds_write_b128 v4, v[92:95]
    ds_write_b128 v4, v[92:95] offset:1024
    v_and_b32 v120, 31, v1
    v_lshlrev_b32 v120, 7, v120
    v_add_u32 v120, 8126464, v120
Lpt_12:
    s_sub_u32 s35, s35, 1
    s_cbranch_scc1 Lend
    s_sleep 2
    buffer_load_dwordx4 v[124:127], v120, s[28:31], 0 offen sc1
    s_waitcnt vmcnt(0)
    v_cmp_ne_u32 vcc, s34, v125
    v_cmp_ne_u32 s[36:37], s34, v127
    s_nop 0
    s_or_b64 s[36:37], s[36:37], vcc
    s_cbranch_scc1 Lpt_12
    v_mov_b32 v120, v124
    s_nop 1
    v_max_u32_dpp v120, v120, v120 row_ror:8 row_mask:0xf bank_mask:0xf
    s_nop 1
    v_max_u32_dpp v120, v120, v120 row_ror:4 row_mask:0xf bank_mask:0xf
    s_nop 1
    v_max_u32_dpp v120, v120, v120 row_ror:2 row_mask:0xf bank_mask:0xf
    s_nop 1
    v_max_u32_dpp v120, v120, v120 row_ror:1 row_mask:0xf bank_mask:0xf
    s_nop 0
    v_readlane_b32 s56, v120, 0
    v_readlane_b32 s36, v120, 16
    v_readlane_b32 s37, v120, 32
    v_readlane_b32 s38, v120, 48
    s_max_u32 s56, s56, s36
    s_max_u32 s37, s37, s38
    s_max_u32 s56, s56, s37
    v_cmp_eq_u32 vcc, s56, v124
    s_nop 1
    v_cndmask_b32 v120, v124, v126, vcc
    s_nop 1
    v_max_u32_dpp v120, v120, v120 row_ror:8 row_mask:0xf bank_mask:0xf
    s_nop 1
    v_max_u32_dpp v120, v120, v120 row_ror:4 row_mask:0xf bank_mask:0xf
    s_nop 1
    v_max_u32_dpp v120, v120, v120 row_ror:2 row_mask:0xf bank_mask:0xf
    s_nop 1
    v_max_u32_dpp v120, v120, v120 row_ror:1 row_mask:0xf bank_mask:0xf
    s_nop 0
    v_readlane_b32 s57, v120, 0
    v_readlane_b32 s36, v120, 16
    v_readlane_b32 s37, v120, 32
    v_readlane_b32 s38, v120, 48
    s_max_u32 s57, s57, s36
    s_max_u32 s37, s37, s38
    s_max_u32 s57, s57, s37
    s_and_b32 s36, s56, 0x7ff
    s_sub_u32 s36, 2047, s36
    s_and_b32 s37, s57, 0x7ff
    s_sub_u32 s37, 2047, s37
    s_mul_i32 s38, s36, 1280
    s_mul_i32 s39, s37, 1280
    s_mov_b32 m0, 141312
    v_mov_b32 v4, s36
    buffer_load_dwordx4 v13, s[52:55], s38 offen lds
    s_mov_b32 m0, 142848
    v_mov_b32 v5, s37
    buffer_load_dwordx4 v13, s[52:55], s39 offen lds
    s_mov_b64 exec, 0xffff
    buffer_load_dwordx4 v13, s[52:55], s39 offen offset:1024 lds
    s_mov_b32 m0, 141312
    s_mov_b32 vcc_lo, 0xaaaaaaaa
    buffer_load_dwordx4 v13, s[52:55], s38 offen offset:1024 lds
    s_mov_b64 exec, 3
    v_cndmask_b32 v4, v4, v5, vcc
    v_lshlrev_b32 v118, 3, v4
    v_add_u32 v118, 8192000, v118
    v_add_u32 v9, 132872, v12
Lxs_chk:
    s_sub_u32 s35, s35, 1
    s_cbranch_scc1 Lend
    buffer_load_dwordx2 v[116:117], v118, s[28:31], 0 offen sc1
    s_waitcnt vmcnt(0)
    v_cmp_ne_u32 vcc, s34, v117
    s_nop 0
    s_cbranch_vccnz Lxs_chk
    ds_write_b32 v9, v116
    s_mov_b64 exec, -1
    v_mov_b32 v10, 132868
    v_mov_b32 v7, 1
    s_mov_b64 exec, 1
    ds_add_u32 v10, v7
    s_mov_b64 exec, -1
Lnofx:
Lcw_13:
    s_sub_u32 s35, s35, 1
    s_cbranch_scc1 Lend
    s_sleep 2
    ds_read_b32 v7, v11
    s_waitcnt lgkmcnt(0)
    v_readfirstlane_b32 s38, v7
    s_nop 0
    s_cmp_lt_u32 s38, 9
    s_cbranch_scc1 Lcw_13
    s_add_u32 m0, s40, 4096
    s_add_u32 s41, s43, 0
    buffer_load_dwordx4 v22, s[48:51], s41 offen nt lds
    buffer_load_dwordx4 v23, s[48:51], s41 offen offset:1024 nt lds
    buffer_load_dwordx4 v24, s[48:51], s41 offen offset:2048 nt lds
    buffer_load_dwordx4 v25, s[48:51], s41 offen offset:3072 nt lds
    s_add_u32 m0, s40, 8192
    s_add_u32 s41, s43, 40960
    buffer_load_dwordx4 v22, s[48:51], s41 offen nt lds
    buffer_load_dwordx4 v23, s[48:51], s41 offen offset:1024 nt lds
    buffer_load_dwordx4 v24, s[48:51], s41 offen offset:2048 nt lds
    buffer_load_dwordx4 v25, s[48:51], s41 offen offset:3072 nt lds
    s_add_u32 m0, s40, 12288
    s_add_u32 s41, s43, 512
    buffer_load_dwordx4 v22, s[68:71], s41 offen nt lds
    buffer_load_dwordx4 v23, s[68:71], s41 offen offset:1024 nt lds
    buffer_load_dwordx4 v24, s[68:71], s41 offen offset:2048 nt lds
    buffer_load_dwordx4 v25, s[68:71], s41 offen offset:3072 nt lds
    s_add_u32 m0, s40, 0
    s_add_u32 s41, s43, 41472
    buffer_load_dwordx4 v22, s[68:71], s41 offen nt lds
    buffer_load_dwordx4 v23, s[68:71], s41 offen offset:1024 nt lds
    buffer_load_dwordx4 v24, s[68:71], s41 offen offset:2048 nt lds
    buffer_load_dwordx4 v25, s[68:71], s41 offen offset:3072 nt lds
Laux_mm:
    v_mov_b32 v10, 132868
Lcw_14:
    s_sub_u32 s35, s35, 1
    s_cbranch_scc1 Lend
    s_sleep 1
    ds_read_b32 v7, v10
    s_waitcnt lgkmcnt(0)
    v_readfirstlane_b32 s38, v7
    s_nop 0
    s_cmp_lt_u32 s38, 1
    s_cbranch_scc1 Lcw_14
    ds_read_b128 v[92:95], v26 offset:0
    ds_read_b128 v[96:99], v26 offset:256
    ds_read_b128 v[100:103], v26 offset:512
    ds_read_b128 v[104:107], v26 offset:768
    ds_read_b128 v[108:111], v26 offset:1024
    ds_read_b64 v[116:117], v10 offset:4
    s_waitcnt lgkmcnt(0)
    v_readfirstlane_b32 s56, v116
    v_readfirstlane_b32 s57, v117
    v_mfma_f32_16x16x32_bf16 v[112:115], a[0:3], v[92:95], 0
    v_mfma_f32_16x16x32_bf16 v[116:119], a[4:7], v[92:95], 0
    v_mfma_f32_16x16x32_bf16 v[120:123], a[8:11], v[92:95], 0
    v_mfma_f32_16x16x32_bf16 v[124:127], a[12:15], v[92:95], 0
    v_mfma_f32_16x16x32_bf16 v[112:115], a[16:19], v[96:99], v[112:115]
    v_mfma_f32_16x16x32_bf16 v[116:119], a[20:23], v[96:99], v[116:119]
    v_mfma_f32_16x16x32_bf16 v[120:123], a[24:27], v[96:99], v[120:123]
    v_mfma_f32_16x16x32_bf16 v[124:127], a[28:31], v[96:99], v[124:127]
    v_mfma_f32_16x16x32_bf16 v[112:115], a[32:35], v[100:103], v[112:115]
    v_mfma_f32_16x16x32_bf16 v[116:119], a[36:39], v[100:103], v[116:119]
    v_mfma_f32_16x16x32_bf16 v[120:123], a[40:43], v[100:103], v[120:123]
    v_mfma_f32_16x16x32_bf16 v[124:127], a[44:47], v[100:103], v[124:127]
    v_mfma_f32_16x16x32_bf16 v[112:115], a[48:51], v[104:107], v[112:115]
    v_mfma_f32_16x16x32_bf16 v[116:119], a[52:55], v[104:107], v[116:119]
    v_mfma_f32_16x16x32_bf16 v[120:123], a[56:59], v[104:107], v[120:123]
    v_mfma_f32_16x16x32_bf16 v[124:127], a[60:63], v[104:107], v[124:127]
    v_mfma_f32_16x16x32_bf16 v[112:115], a[64:67], v[108:111], v[112:115]
    v_mfma_f32_16x16x32_bf16 v[116:119], a[68:71], v[108:111], v[116:119]
    v_mfma_f32_16x16x32_bf16 v[120:123], a[72:75], v[108:111], v[120:123]
    v_mfma_f32_16x16x32_bf16 v[124:127], a[76:79], v[108:111], v[124:127]
    s_mul_i32 s36, s3, 768
    s_add_u32 s36, s36, 133120
    v_lshlrev_b32 v4, 8, v3
    v_lshl_add_u32 v4, v2, 4, v4
    v_add_u32 v4, s36, v4
    v_add_u32 v5, 133120, v12
    s_lshl_b32 s37, s3, 8
    s_add_u32 s37, s37, 139264
    v_lshl_add_u32 v6, v1, 1, s37
    v_and_b32 v7, 1, v1
    v_lshlrev_b32 v7, 7, v7
    v_lshl_add_u32 v7, v2, 4, v7
    v_add_u32 v7, s37, v7
    s_lshl_b32 s38, s56, 16
    s_lshl_b32 s39, s57, 16
    v_rcp_f32 v8, s38
    v_rcp_f32 v9, s39
    s_and_b32 s56, s56, 0xffff0000
    s_and_b32 s57, s57, 0xffff0000
    s_mov_b32 exec_lo, 0x00070007
    s_mov_b32 exec_hi, 0x00070007
    ds_write_b128 v4, v[112:115] offset:0
    ds_write_b128 v4, v[116:119] offset:64
    ds_write_b128 v4, v[120:123] offset:128
    ds_write_b128 v4, v[124:127] offset:192
    s_mov_b64 exec, -1
    s_waitcnt lgkmcnt(0)
    s_barrier
    ds_read2st64_b32 v[92:93], v5 offset0:0 offset1:1
    ds_read2st64_b32 v[94:95], v5 offset0:2 offset1:3
    ds_read2st64_b32 v[96:97], v5 offset0:4 offset1:5
    ds_read2st64_b32 v[98:99], v5 offset0:6 offset1:7
    ds_read2st64_b32 v[100:101], v5 offset0:8 offset1:9
    ds_read2st64_b32 v[102:103], v5 offset0:10 offset1:11
    ds_read2st64_b32 v[116:117], v5 offset0:12 offset1:13
    ds_read2st64_b32 v[118:119], v5 offset0:14 offset1:15
    ds_read2st64_b32 v[120:121], v5 offset0:16 offset1:17
    ds_read2st64_b32 v[122:123], v5 offset0:18 offset1:19
    ds_read2st64_b32 v[124:125], v5 offset0:20 offset1:21
    ds_read2st64_b32 v[126:127], v5 offset0:22 offset1:23
    v_cmp_eq_u32 s[72:73], 1, v2
    v_cmp_eq_u32 s[74:75], 2, v2
    v_cmp_eq_u32 s[76:77], 3, v2
    s_mul_i32 s37, s32, 10
    s_add_u32 s37, s37, s3
    s_lshl_b32 s37, s37, 10
    s_add_u32 s37, s37, 7405568
    s_waitcnt lgkmcnt(0)
    v_add_f32 v92, v92, v95
    v_add_f32 v98, v98, v101
    v_add_f32 v92, v92, v98
    v_add_f32 v93, v93, v96
    v_add_f32 v99, v99, v102
    v_add_f32 v93, v93, v99
    v_add_f32 v94, v94, v97
    v_add_f32 v100, v100, v103
    v_add_f32 v94, v94, v100
    v_add_f32 v116, v116, v119
    v_add_f32 v122, v122, v125
    v_add_f32 v116, v116, v122
    v_add_f32 v117, v117, v120
    v_add_f32 v123, v123, v126
    v_add_f32 v117, v117, v123
    v_add_f32 v118, v118, v121
    v_add_f32 v124, v124, v127
    v_add_f32 v118, v118, v124
    v_fmac_f32 v92, s56, v94
    v_mul_f32 v112, v92, v8
    v_fmac_f32 v93, s57, v94
    v_mul_f32 v113, v93, v9
    v_fmac_f32 v116, s56, v118
    v_mul_f32 v120, v116, v8
    v_fmac_f32 v117, s57, v118
    v_mul_f32 v121, v117, v9
    v_cvt_pk_bf16_f32 v113, v112, v113
    v_lshlrev_b32 v112, 16, v113
    v_and_b32 v113, 0xffff0000, v113
    v_cvt_pk_bf16_f32 v121, v120, v121
    v_lshlrev_b32 v120, 16, v121
    v_and_b32 v121, 0xffff0000, v121
    v_mul_f32 v114, 0xbfb8aa3b, v112
    v_mul_f32 v115, 0xbfb8aa3b, v113
    v_exp_f32 v114, v114
    v_exp_f32 v115, v115
    v_add_f32 v114, 1.0, v114
    v_add_f32 v115, 1.0, v115
    v_rcp_f32 v114, v114
    v_rcp_f32 v115, v115
    v_mul_f32 v114, v114, v112
    v_mul_f32 v115, v115, v113
    v_cvt_pk_bf16_f32 v115, v114, v115
    v_lshlrev_b32 v114, 16, v115
    v_and_b32 v115, 0xffff0000, v115
    v_mul_f32 v114, v114, v120
    v_mul_f32 v115, v115, v121
    v_cvt_pk_bf16_f32 v114, v114, v115
    ds_write_b16 v6, v114
    ds_write_b16_d16_hi v6, v114 offset:128
    ds_read_b128 v[92:95], v7 offset:0
    ds_read_b128 v[96:99], v7 offset:64
    v_mov_b32 v101, s34
    v_mov_b32 v103, s34
    s_waitcnt vmcnt(0)
    ds_read_b64_tr_b16 v[28:29], v14 offset:4096
    ds_read_b64_tr_b16 v[30:31], v14 offset:4608
    ds_read_b64_tr_b16 v[32:33], v15 offset:4096
    ds_read_b64_tr_b16 v[34:35], v15 offset:4608
    ds_read_b64_tr_b16 v[36:37], v16 offset:4096
    ds_read_b64_tr_b16 v[38:39], v16 offset:4608
    ds_read_b64_tr_b16 v[40:41], v17 offset:4096
    ds_read_b64_tr_b16 v[42:43], v17 offset:4608
    ds_read_b64_tr_b16 v[44:45], v14 offset:8192
    ds_read_b64_tr_b16 v[46:47], v14 offset:8704
    ds_read_b64_tr_b16 v[48:49], v15 offset:8192
    ds_read_b64_tr_b16 v[50:51], v15 offset:8704
    ds_read_b64_tr_b16 v[52:53], v16 offset:8192
    ds_read_b64_tr_b16 v[54:55], v16 offset:8704
    ds_read_b64_tr_b16 v[56:57], v17 offset:8192
    ds_read_b64_tr_b16 v[58:59], v17 offset:8704
    s_waitcnt lgkmcnt(0)
    v_mfma_f32_16x16x32_bf16 v[112:115], v[92:95], v[28:31], 0
    v_mfma_f32_16x16x32_bf16 v[116:119], v[92:95], v[32:35], 0
    v_mfma_f32_16x16x32_bf16 v[120:123], v[92:95], v[36:39], 0
    v_mfma_f32_16x16x32_bf16 v[124:127], v[92:95], v[40:43], 0
    v_mfma_f32_16x16x32_bf16 v[112:115], v[96:99], v[44:47], v[112:115]
    v_mfma_f32_16x16x32_bf16 v[116:119], v[96:99], v[48:51], v[116:119]
    v_mfma_f32_16x16x32_bf16 v[120:123], v[96:99], v[52:55], v[120:123]
    v_mfma_f32_16x16x32_bf16 v[124:127], v[96:99], v[56:59], v[124:127]
    s_nop 5
    v_cndmask_b32 v100, v112, v116, s[72:73]
    v_cndmask_b32 v100, v100, v120, s[74:75]
    v_cndmask_b32 v100, v100, v124, s[76:77]
    v_cndmask_b32 v102, v113, v117, s[72:73]
    v_cndmask_b32 v102, v102, v121, s[74:75]
    v_cndmask_b32 v102, v102, v125, s[76:77]
    buffer_store_dwordx4 v[100:103], v13, s[28:31], s37 offen sc1
    s_sub_u32 s36, s3, 4
    s_cmp_ge_u32 s36, 2
    s_cbranch_scc1 Laux_end
    s_add_u32 s37, s37, 4096
    ds_read_b64_tr_b16 v[60:61], v14 offset:12288
    ds_read_b64_tr_b16 v[62:63], v14 offset:12800
    ds_read_b64_tr_b16 v[64:65], v15 offset:12288
    ds_read_b64_tr_b16 v[66:67], v15 offset:12800
    ds_read_b64_tr_b16 v[68:69], v16 offset:12288
    ds_read_b64_tr_b16 v[70:71], v16 offset:12800
    ds_read_b64_tr_b16 v[72:73], v17 offset:12288
    ds_read_b64_tr_b16 v[74:75], v17 offset:12800
    ds_read_b64_tr_b16 v[76:77], v14 offset:0
    ds_read_b64_tr_b16 v[78:79], v14 offset:512
    ds_read_b64_tr_b16 v[80:81], v15 offset:0
    ds_read_b64_tr_b16 v[82:83], v15 offset:512
    ds_read_b64_tr_b16 v[84:85], v16 offset:0
    ds_read_b64_tr_b16 v[86:87], v16 offset:512
    ds_read_b64_tr_b16 v[88:89], v17 offset:0
    ds_read_b64_tr_b16 v[90:91], v17 offset:512
    s_waitcnt lgkmcnt(0)
    v_mfma_f32_16x16x32_bf16 v[112:115], v[92:95], v[60:63], 0
    v_mfma_f32_16x16x32_bf16 v[116:119], v[92:95], v[64:67], 0
    v_mfma_f32_16x16x32_bf16 v[120:123], v[92:95], v[68:71], 0
    v_mfma_f32_16x16x32_bf16 v[124:127], v[92:95], v[72:75], 0
    v_mfma_f32_16x16x32_bf16 v[112:115], v[96:99], v[76:79], v[112:115]
    v_mfma_f32_16x16x32_bf16 v[116:119], v[96:99], v[80:83], v[116:119]
    v_mfma_f32_16x16x32_bf16 v[120:123], v[96:99], v[84:87], v[120:123]
    v_mfma_f32_16x16x32_bf16 v[124:127], v[96:99], v[88:91], v[124:127]
    s_nop 5
    v_cndmask_b32 v100, v112, v116, s[72:73]
    v_cndmask_b32 v100, v100, v120, s[74:75]
    v_cndmask_b32 v100, v100, v124, s[76:77]
    v_cndmask_b32 v102, v113, v117, s[72:73]
    v_cndmask_b32 v102, v102, v121, s[74:75]
    v_cndmask_b32 v102, v102, v125, s[76:77]
    buffer_store_dwordx4 v[100:103], v13, s[28:31], s37 offen sc1
Laux_end:
    s_endpgm
Lmst:
    s_cmp_lg_u32 s3, 0
    s_cbranch_scc1 Lhelp_i
    s_waitcnt lgkmcnt(0)
    s_mov_b64 s[28:29], s[24:25]
    s_mov_b32 s30, 268435456
    s_mov_b32 s31, 0x20000
    s_load_dword s34, s[28:29], 0
    s_waitcnt lgkmcnt(0)
    s_add_u32 s34, s34, 0x9e3779b8
    s_or_b32 s34, s34, 1
    s_mov_b64 exec, 1
    s_lshl_b32 s36, s2, 2
    s_add_u32 s36, s36, 8323072
    v_mov_b32 v4, s34
    v_mov_b32 v5, s36
    buffer_store_dword v4, v5, s[28:31], 0 offen sc1
    s_mov_b64 exec, -1
    s_cmp_lg_u32 s32, 32
    s_cbranch_scc1 Lend
Lmst_bc:
    v_and_b32 v4, 31, v1
    v_lshlrev_b32 v4, 7, v4
    v_add_u32 v4, 8126464, v4
Lpt_15:
    s_sub_u32 s35, s35, 1
    s_cbranch_scc1 Lend
    s_sleep 8
    buffer_load_dwordx4 v[8:11], v4, s[28:31], 0 offen sc1
    s_waitcnt vmcnt(0)
    v_cmp_ne_u32 vcc, s34, v9
    v_cmp_ne_u32 s[36:37], s34, v11
    s_nop 0
    s_or_b64 s[36:37], s[36:37], vcc
    s_cbranch_scc1 Lpt_15
    v_mov_b32 v4, v8
    s_nop 1
    v_max_u32_dpp v4, v4, v4 row_ror:8 row_mask:0xf bank_mask:0xf
    s_nop 1
    v_max_u32_dpp v4, v4, v4 row_ror:4 row_mask:0xf bank_mask:0xf
    s_nop 1
    v_max_u32_dpp v4, v4, v4 row_ror:2 row_mask:0xf bank_mask:0xf
    s_nop 1
    v_max_u32_dpp v4, v4, v4 row_ror:1 row_mask:0xf bank_mask:0xf
    s_nop 0
    v_readlane_b32 s40, v4, 0
    v_readlane_b32 s36, v4, 16
    v_readlane_b32 s37, v4, 32
    v_readlane_b32 s38, v4, 48
    s_max_u32 s40, s40, s36
    s_max_u32 s37, s37, s38
    s_max_u32 s40, s40, s37
    v_cmp_eq_u32 vcc, s40, v8
    s_nop 1
    v_cndmask_b32 v4, v8, v10, vcc
    s_nop 1
    v_max_u32_dpp v4, v4, v4 row_ror:8 row_mask:0xf bank_mask:0xf
    s_nop 1
    v_max_u32_dpp v4, v4, v4 row_ror:4 row_mask:0xf bank_mask:0xf
    s_nop 1
    v_max_u32_dpp v4, v4, v4 row_ror:2 row_mask:0xf bank_mask:0xf
    s_nop 1
    v_max_u32_dpp v4, v4, v4 row_ror:1 row_mask:0xf bank_mask:0xf
    s_nop 0
    v_readlane_b32 s41, v4, 0
    v_readlane_b32 s36, v4, 16
    v_readlane_b32 s37, v4, 32
    v_readlane_b32 s38, v4, 48
    s_max_u32 s41, s41, s36
    s_max_u32 s37, s37, s38
    s_max_u32 s41, s41, s37
    v_mov_b32 v8, s40
    v_mov_b32 v9, s34
    v_mov_b32 v10, s41
    v_mov_b32 v11, s34
    s_mov_b32 s36, 8257536
    buffer_store_dwordx4 v[8:11], v13, s[28:31], s36 offen offset:0 sc1
    buffer_store_dwordx4 v[8:11], v13, s[28:31], s36 offen offset:1024 sc1
    buffer_store_dwordx4 v[8:11], v13, s[28:31], s36 offen offset:2048 sc1
    s_mov_b32 s36, 8323072
Lmaster:
    s_sub_u32 s35, s35, 1
    s_cbranch_scc1 Lend
    s_sleep 16
    buffer_load_dwordx4 v[4:7], v13, s[28:31], s36 offen sc1
    s_waitcnt vmcnt(0)
    v_xor_b32 v4, s34, v4
    v_xor_b32 v5, s34, v5
    v_xor_b32 v6, s34, v6
    v_xor_b32 v7, s34, v7
    v_or3_b32 v4, v4, v5, v6
    v_or_b32 v4, v4, v7
    v_cmp_ne_u32 vcc, 0, v4
    s_nop 0
    s_cbranch_vccnz Lmaster
    s_mov_b64 exec, 1
    buffer_store_dword v9, v4, s[28:31], 0 offen sc1
    s_endpgm
Lhelp_r:
    s_add_u32 s72, s32, 0
    s_mov_b32 s73, 5
    s_mov_b32 s37, 4
    s_branch Lhelp
Lhelp_i:
    s_cmp_eq_u32 s32, 32
    s_cbranch_scc1 Lend
    s_cmp_eq_u32 s27, 0
    s_cbranch_scc1 Lend
    s_sub_u32 s72, s32, 33
    s_mov_b32 s73, 3
    s_mov_b32 s37, 9
Lhelp:
    s_lshl_b32 s38, s26, 6
    v_add_u32 v4, s38, v1
    v_mul_u32_u24 v4, 1280, v4
    s_waitcnt lgkmcnt(0)
    s_mov_b64 s[68:69], s[18:19]
    s_mov_b32 s70, 2211840
    s_mov_b32 s71, 0x20000
Lhelp2:
    s_mul_i32 s38, s72, 9363
    s_lshr_b32 s38, s38, 16
    s_mul_i32 s39, s38, 7
    s_sub_u32 s39, s72, s39
    s_mul_i32 s39, s39, 327680
    s_lshl_b32 s38, s38, 7
    s_sub_u32 s39, s39, s38
    s_add_u32 s39, s39, 1152
    v_add_u32 v6, s39, v4
    buffer_load_dword v5, v6, s[68:71], 0 offen
    s_add_u32 s72, s72, s73
    s_sub_u32 s37, s37, 1
    s_cmp_lg_u32 s37, 0
    s_cbranch_scc1 Lhelp2
Lend:
    s_endpgm
.section .rodata,"a"
.p2align 6
.amdhsa_kernel recurrent_scan__sliding_local_dilated__moe_arch_mod__prompt_kernel
  .amdhsa_next_free_vgpr 256
  .amdhsa_next_free_sgpr 102
  .amdhsa_accum_offset 128
  .amdhsa_group_segment_fixed_size 0
  .amdhsa_kernarg_size 88
  .amdhsa_user_sgpr_count 2
  .amdhsa_user_sgpr_kernarg_segment_ptr 1
  .amdhsa_system_sgpr_workgroup_id_x 1
  .amdhsa_float_denorm_mode_32 3
.end_amdhsa_kernel
```

```asm
; @launch grid=(256,1,1) block=(512,1,1) lds=163840
.amdgcn_target "amdgcn-amd-amdhsa--gfx950"
.text
.globl recurrent_scan__sliding_local_dilated__moe_arch_mod__prompt_kernel
.p2align 8
.type recurrent_scan__sliding_local_dilated__moe_arch_mod__prompt_kernel,@function
recurrent_scan__sliding_local_dilated__moe_arch_mod__prompt_kernel:
    s_load_dwordx16 s[4:19], s[0:1], 0
    s_load_dwordx4 s[20:23], s[0:1], 64
    s_load_dwordx2 s[24:25], s[0:1], 80
    v_lshrrev_b32 v4, 6, v0
    v_and_b32 v1, 63, v0
    s_cmp_ge_u32 s2, 256
    s_cbranch_scc1 Lend
    v_readfirstlane_b32 s3, v4
    s_getpc_b64 s[36:37]
Lpc:
    s_and_b32 s38, s2, 0xf8
    v_add_u32 v5, s38, v4
    v_and_b32 v6, 1, v0
    v_lshl_add_u32 v5, v5, 1, v6
    v_lshlrev_b32 v5, 7, v5
    v_min_u32 v5, Lend-Lpc, v5
    v_mov_b32 v7, s37
    v_add_co_u32 v6, vcc, s36, v5
    s_nop 1
    v_addc_co_u32 v7, vcc, 0, v7, vcc
    global_load_dword v0, v[6:7], off
    v_lshrrev_b32 v2, 4, v1
    v_and_b32 v3, 15, v1
    v_lshlrev_b32 v12, 2, v1
    v_lshlrev_b32 v13, 4, v1
    s_mov_b32 s35, 2000000
    s_and_b32 s36, s2, 7
    s_lshr_b32 s37, s2, 3
    s_and_b32 s38, s36, 1
    s_lshr_b32 s36, s36, 1
    s_add_u32 s39, s38, 4
    s_and_b32 s26, s3, 3
    s_lshr_b32 s27, s3, 2
    s_cmp_lt_u32 s37, s39
    s_cbranch_scc1 Laux
    s_lshr_b32 s33, s36, 1
    s_and_b32 s36, s36, 1
    s_mul_i32 s36, s36, 55
    s_mul_i32 s38, s38, 28
    s_add_u32 s36, s36, s38
    s_add_u32 s36, s36, s37
    s_sub_u32 s36, s36, s39
    s_mul_i32 s32, s36, 13108
    s_lshr_b32 s32, s32, 16
    s_mul_i32 s37, s32, 5
    s_sub_u32 s36, s36, s37
    s_mul_i32 s33, s33, 5
    s_add_u32 s33, s33, s36
    s_add_u32 s42, s33, s32
    s_mul_i32 s36, s42, 13108
    s_lshr_b32 s36, s36, 16
    s_mul_i32 s36, s36, 5
    s_sub_u32 s42, s42, s36
    s_and_b32 s43, s2, 7
    s_lshl_b32 s43, s43, 2
    s_lshr_b32 s43, 0x30858530, s43
    s_and_b32 s43, s43, 15
    s_cmp_lg_u32 s3, 0
    s_cbranch_scc1 Lcomp
Lloader:
    s_setprio 3
    v_lshrrev_b32 v5, 3, v1
    v_and_b32 v6, 7, v1
    v_and_b32 v8, 1, v2
    v_lshlrev_b32 v8, 1, v8
    v_xor_b32 v8, v8, v6
    s_lshl_b32 s39, s33, 7
    v_lshl_add_u32 v50, v8, 4, s39
    v_mov_b32 v7, 3840
    v_mad_u32_u24 v28, v5, v7, v50
    v_xor_b32 v29, 64, v28
    v_add_u32 v29, 29696, v29
    v_add_u32 v30, 59392, v28
    v_add_u32 v31, 59392, v29
    v_add_u32 v32, 122880, v28
    v_add_u32 v33, 122880, v29
    v_add_u32 v34, 182272, v28
    v_add_u32 v35, 182272, v29
    s_lshl_b32 s79, s42, 2
    s_lshr_b32 s79, 0x21100, s79
    s_and_b32 s79, s79, 15
    s_add_u32 s79, s79, s43
    s_sub_u32 s38, s79, 10
    s_cmp_ge_u32 s79, 10
    s_cselect_b32 s79, s38, s79
    s_mul_i32 s68, s79, 245760
    s_lshl_b32 s78, s79, 7
    s_waitcnt lgkmcnt(0)
    s_mov_b64 s[48:49], s[6:7]
    s_mov_b32 s50, 2457600
    s_mov_b32 s51, 0x20000
    s_add_u32 s52, s6, 1280
    s_addc_u32 s53, s7, 0
    s_mov_b32 s54, 2456320
    s_mov_b32 s55, 0x20000
    s_add_u32 s56, s6, 2560
    s_addc_u32 s57, s7, 0
    s_mov_b32 s58, 2455040
    s_mov_b32 s59, 0x20000
    s_mov_b32 m0, 0
    s_mul_i32 s38, s32, 96
    s_sub_u32 s38, s38, 16
    v_add_u32 v7, s38, v5
    buffer_load_dwordx4 v28, s[48:51], s68 offen lds
    v_xor_b32 v9, v6, v2
    v_lshlrev_b32 v9, 4, v9
    buffer_load_dwordx4 v29, s[48:51], s68 offen offset:1024 lds
    v_xor_b32 v10, 64, v9
    v_mov_b32 v11, 2052
    buffer_load_dwordx4 v30, s[48:51], s68 offen offset:2048 lds
    v_mov_b32 v8, 1280
    v_add_u32 v36, 0, v7
    buffer_load_dwordx4 v31, s[48:51], s68 offen offset:3072 lds
    v_med3_i32 v36, v36, 0, v11
    v_mad_u32_u24 v36, v36, v8, v9
    s_mov_b32 m0, 8192
    v_add_u32 v36, 4096, v36
    v_add_u32 v37, 8, v7
    buffer_load_dwordx4 v28, s[52:55], s68 offen lds
    v_med3_i32 v37, v37, 0, v11
    v_mad_u32_u24 v37, v37, v8, v10
    v_add_u32 v37, 3072, v37
    buffer_load_dwordx4 v29, s[52:55], s68 offen offset:1024 lds
    v_add_u32 v38, 16, v7
    v_med3_i32 v38, v38, 0, v11
    buffer_load_dwordx4 v30, s[52:55], s68 offen offset:2048 lds
    v_mad_u32_u24 v38, v38, v8, v9
    v_add_u32 v38, 2048, v38
    buffer_load_dwordx4 v31, s[52:55], s68 offen offset:3072 lds
    v_add_u32 v39, 24, v7
    v_med3_i32 v39, v39, 0, v11
    s_mov_b32 m0, 16384
    v_mad_u32_u24 v39, v39, v8, v10
    v_add_u32 v39, 1024, v39
    buffer_load_dwordx4 v28, s[56:59], s68 offen lds
    v_add_u32 v40, 32, v7
    v_med3_i32 v40, v40, 0, v11
    buffer_load_dwordx4 v29, s[56:59], s68 offen offset:1024 lds
    v_mad_u32_u24 v40, v40, v8, v9
    v_add_u32 v40, 4096, v40
    v_add_u32 v41, 40, v7
    buffer_load_dwordx4 v30, s[56:59], s68 offen offset:2048 lds
    v_med3_i32 v41, v41, 0, v11
    v_mad_u32_u24 v41, v41, v8, v10
    buffer_load_dwordx4 v31, s[56:59], s68 offen offset:3072 lds
    v_add_u32 v41, 3072, v41
    v_add_u32 v42, 48, v7
    s_mov_b32 m0, 4096
    v_med3_i32 v42, v42, 0, v11
    v_mad_u32_u24 v42, v42, v8, v9
    buffer_load_dwordx4 v32, s[48:51], s68 offen lds
    v_add_u32 v42, 2048, v42
    v_add_u32 v43, 56, v7
    buffer_load_dwordx4 v33, s[48:51], s68 offen offset:1024 lds
    v_med3_i32 v43, v43, 0, v11
    v_mad_u32_u24 v43, v43, v8, v10
    buffer_load_dwordx4 v34, s[48:51], s68 offen offset:2048 lds
    v_add_u32 v43, 1024, v43
    v_add_u32 v44, 64, v7
    v_med3_i32 v44, v44, 0, v11
    buffer_load_dwordx4 v35, s[48:51], s68 offen offset:3072 lds
    v_mad_u32_u24 v44, v44, v8, v9
    v_add_u32 v44, 4096, v44
    s_mov_b32 m0, 12288
    v_add_u32 v45, 72, v7
    v_med3_i32 v45, v45, 0, v11
    buffer_load_dwordx4 v32, s[52:55], s68 offen lds
    v_mad_u32_u24 v45, v45, v8, v10
    v_add_u32 v45, 3072, v45
    buffer_load_dwordx4 v33, s[52:55], s68 offen offset:1024 lds
    v_add_u32 v46, 80, v7
    v_med3_i32 v46, v46, 0, v11
    buffer_load_dwordx4 v34, s[52:55], s68 offen offset:2048 lds
    v_mad_u32_u24 v46, v46, v8, v9
    v_add_u32 v46, 2048, v46
    buffer_load_dwordx4 v35, s[52:55], s68 offen offset:3072 lds
    v_add_u32 v47, 88, v7
    v_med3_i32 v47, v47, 0, v11
    v_mad_u32_u24 v47, v47, v8, v10
    s_mov_b32 m0, 20480
    v_add_u32 v47, 1024, v47
    v_add_u32 v48, 96, v7
    buffer_load_dwordx4 v32, s[56:59], s68 offen lds
    v_med3_i32 v48, v48, 0, v11
    v_mad_u32_u24 v48, v48, v8, v9
    buffer_load_dwordx4 v33, s[56:59], s68 offen offset:1024 lds
    v_add_u32 v48, 4096, v48
    v_add_u32 v49, 104, v7
    buffer_load_dwordx4 v34, s[56:59], s68 offen offset:2048 lds
    v_med3_i32 v49, v49, 0, v11
    v_mad_u32_u24 v49, v49, v8, v10
    buffer_load_dwordx4 v35, s[56:59], s68 offen offset:3072 lds
    v_add_u32 v49, 3072, v49
    s_sub_u32 s44, s4, 4096
    s_subb_u32 s45, s5, 0
    s_mov_b32 s46, 2625536
    s_mov_b32 s47, 0x20000
    s_mov_b32 m0, 24576
    s_nop 0
    buffer_load_dwordx4 v36, s[44:47], s78 offen lds
    buffer_load_dwordx4 v37, s[44:47], s78 offen offset:1024 lds
    buffer_load_dwordx4 v38, s[44:47], s78 offen offset:2048 lds
    buffer_load_dwordx4 v39, s[44:47], s78 offen offset:3072 lds
    s_mov_b32 m0, 28672
    s_nop 0
    buffer_load_dwordx4 v40, s[44:47], s78 offen lds
    buffer_load_dwordx4 v41, s[44:47], s78 offen offset:1024 lds
    buffer_load_dwordx4 v42, s[44:47], s78 offen offset:2048 lds
    buffer_load_dwordx4 v43, s[44:47], s78 offen offset:3072 lds
    s_mov_b32 m0, 32768
    s_nop 0
    buffer_load_dwordx4 v44, s[44:47], s78 offen lds
    buffer_load_dwordx4 v45, s[44:47], s78 offen offset:1024 lds
    buffer_load_dwordx4 v46, s[44:47], s78 offen offset:2048 lds
    buffer_load_dwordx4 v47, s[44:47], s78 offen offset:3072 lds
    s_mov_b32 m0, 36864
    s_nop 0
    buffer_load_dwordx4 v48, s[44:47], s78 offen lds
    buffer_load_dwordx4 v49, s[44:47], s78 offen offset:1024 lds
    s_mov_b32 s80, 0x65482310
    s_mov_b32 s81, 0x97
    s_cmp_eq_u32 s42, 1
    s_cselect_b32 s80, 0x65392410, s80
    s_cselect_b32 s81, 0x87, s81
    s_cmp_eq_u32 s42, 2
    s_cselect_b32 s80, 0x75436021, s80
    s_cselect_b32 s81, 0x98, s81
    s_cmp_eq_u32 s42, 3
    s_cselect_b32 s80, 0x76432501, s80
    s_cselect_b32 s81, 0x98, s81
    s_cmp_eq_u32 s42, 4
    s_cselect_b32 s80, 0x63547102, s80
    s_cselect_b32 s81, 0x98, s81
    s_lshr_b64 s[80:81], s[80:81], 4
    s_and_b32 s79, s80, 15
    s_add_u32 s79, s79, s43
    s_sub_u32 s38, s79, 10
    s_cmp_ge_u32 s79, 10
    s_cselect_b32 s79, s38, s79
    s_mov_b64 s[28:29], s[24:25]
    s_mov_b32 s30, 268435456
    s_mov_b32 s31, 0x20000
    s_load_dword s34, s[28:29], 0
    s_mov_b64 s[60:61], s[8:9]
    s_mov_b32 s62, 819200
    s_mov_b32 s63, 0x20000
    v_mov_b32 v51, 157984
    v_and_b32 v66, 7, v1
    v_max_u32 v66, 1, v66
    v_lshlrev_b32 v66, 2, v66
    v_add_u32 v66, 158016, v66
    s_mul_i32 s69, s79, 245760
    s_lshl_b32 s78, s79, 7
    s_mov_b32 m0, 63616
    s_nop 0
    buffer_load_dwordx4 v36, s[44:47], s78 offen lds
    buffer_load_dwordx4 v37, s[44:47], s78 offen offset:1024 lds
    buffer_load_dwordx4 v38, s[44:47], s78 offen offset:2048 lds
    buffer_load_dwordx4 v39, s[44:47], s78 offen offset:3072 lds
    s_mov_b32 m0, 39040
    s_nop 0
    buffer_load_dwordx4 v28, s[48:51], s69 offen lds
    buffer_load_dwordx4 v29, s[48:51], s69 offen offset:1024 lds
    buffer_load_dwordx4 v30, s[48:51], s69 offen offset:2048 lds
    buffer_load_dwordx4 v31, s[48:51], s69 offen offset:3072 lds
    s_mov_b32 m0, 67712
    s_nop 0
    buffer_load_dwordx4 v40, s[44:47], s78 offen lds
    buffer_load_dwordx4 v41, s[44:47], s78 offen offset:1024 lds
    buffer_load_dwordx4 v42, s[44:47], s78 offen offset:2048 lds
    buffer_load_dwordx4 v43, s[44:47], s78 offen offset:3072 lds
    s_mov_b32 m0, 47232
    s_nop 0
    buffer_load_dwordx4 v28, s[52:55], s69 offen lds
    buffer_load_dwordx4 v29, s[52:55], s69 offen offset:1024 lds
    buffer_load_dwordx4 v30, s[52:55], s69 offen offset:2048 lds
    buffer_load_dwordx4 v31, s[52:55], s69 offen offset:3072 lds
    s_mov_b32 m0, 71808
    s_nop 0
    buffer_load_dwordx4 v44, s[44:47], s78 offen lds
    buffer_load_dwordx4 v45, s[44:47], s78 offen offset:1024 lds
    buffer_load_dwordx4 v46, s[44:47], s78 offen offset:2048 lds
    buffer_load_dwordx4 v47, s[44:47], s78 offen offset:3072 lds
    s_mov_b32 m0, 55424
    s_nop 0
    buffer_load_dwordx4 v28, s[56:59], s69 offen lds
    buffer_load_dwordx4 v29, s[56:59], s69 offen offset:1024 lds
    buffer_load_dwordx4 v30, s[56:59], s69 offen offset:2048 lds
    buffer_load_dwordx4 v31, s[56:59], s69 offen offset:3072 lds
    s_mov_b32 m0, 75904
    s_nop 0
    buffer_load_dwordx4 v48, s[44:47], s78 offen lds
    s_waitcnt vmcnt(55)
    buffer_load_dwordx4 v49, s[44:47], s78 offen offset:1024 lds
    s_mov_b32 m0, 43136
    s_nop 0
    buffer_load_dwordx4 v32, s[48:51], s69 offen lds
    buffer_load_dwordx4 v33, s[48:51], s69 offen offset:1024 lds
    buffer_load_dwordx4 v34, s[48:51], s69 offen offset:2048 lds
    buffer_load_dwordx4 v35, s[48:51], s69 offen offset:3072 lds
    s_mov_b32 m0, 51328
    s_nop 0
    buffer_load_dwordx4 v32, s[52:55], s69 offen lds
    buffer_load_dwordx4 v33, s[52:55], s69 offen offset:1024 lds
    buffer_load_dwordx4 v34, s[52:55], s69 offen offset:2048 lds
    s_waitcnt vmcnt(55)
    buffer_load_dwordx4 v35, s[52:55], s69 offen offset:3072 lds
    s_mov_b32 m0, 59520
    s_nop 0
    buffer_load_dwordx4 v32, s[56:59], s69 offen lds
    buffer_load_dwordx4 v33, s[56:59], s69 offen offset:1024 lds
    buffer_load_dwordx4 v34, s[56:59], s69 offen offset:2048 lds
    buffer_load_dwordx4 v35, s[56:59], s69 offen offset:3072 lds
    s_waitcnt vmcnt(38) lgkmcnt(0)
    s_barrier
    s_add_u32 s34, s34, 0x9e3779b8
    s_or_b32 s34, s34, 1
    s_lshr_b64 s[80:81], s[80:81], 4
    s_and_b32 s79, s80, 15
    s_add_u32 s79, s79, s43
    s_sub_u32 s38, s79, 10
    s_cmp_ge_u32 s79, 10
    s_cselect_b32 s79, s38, s79
    s_mul_i32 s70, s79, 245760
    s_lshl_b32 s78, s79, 7
    s_mov_b32 m0, 102656
    s_nop 0
    buffer_load_dwordx4 v36, s[44:47], s78 offen lds
    buffer_load_dwordx4 v37, s[44:47], s78 offen offset:1024 lds
    buffer_load_dwordx4 v38, s[44:47], s78 offen offset:2048 lds
    buffer_load_dwordx4 v39, s[44:47], s78 offen offset:3072 lds
    s_mov_b32 m0, 78080
    s_nop 0
    buffer_load_dwordx4 v28, s[48:51], s70 offen lds
    buffer_load_dwordx4 v29, s[48:51], s70 offen offset:1024 lds
    buffer_load_dwordx4 v30, s[48:51], s70 offen offset:2048 lds
    buffer_load_dwordx4 v31, s[48:51], s70 offen offset:3072 lds
    s_mov_b32 m0, 106752
    s_nop 0
    buffer_load_dwordx4 v40, s[44:47], s78 offen lds
    buffer_load_dwordx4 v41, s[44:47], s78 offen offset:1024 lds
    buffer_load_dwordx4 v42, s[44:47], s78 offen offset:2048 lds
    buffer_load_dwordx4 v43, s[44:47], s78 offen offset:3072 lds
    s_mov_b32 m0, 86272
    s_nop 0
    buffer_load_dwordx4 v28, s[52:55], s70 offen lds
    buffer_load_dwordx4 v29, s[52:55], s70 offen offset:1024 lds
    buffer_load_dwordx4 v30, s[52:55], s70 offen offset:2048 lds
    buffer_load_dwordx4 v31, s[52:55], s70 offen offset:3072 lds
    s_mov_b32 m0, 110848
    s_nop 0
    buffer_load_dwordx4 v44, s[44:47], s78 offen lds
    buffer_load_dwordx4 v45, s[44:47], s78 offen offset:1024 lds
    buffer_load_dwordx4 v46, s[44:47], s78 offen offset:2048 lds
    buffer_load_dwordx4 v47, s[44:47], s78 offen offset:3072 lds
    s_mov_b32 m0, 94464
    s_nop 0
    buffer_load_dwordx4 v28, s[56:59], s70 offen lds
    buffer_load_dwordx4 v29, s[56:59], s70 offen offset:1024 lds
    buffer_load_dwordx4 v30, s[56:59], s70 offen offset:2048 lds
    buffer_load_dwordx4 v31, s[56:59], s70 offen offset:3072 lds
    s_mov_b32 m0, 114944
    s_nop 0
    buffer_load_dwordx4 v48, s[44:47], s78 offen lds
    s_waitcnt vmcnt(55)
    buffer_load_dwordx4 v49, s[44:47], s78 offen offset:1024 lds
    s_mov_b32 m0, 82176
    s_nop 0
    buffer_load_dwordx4 v32, s[48:51], s70 offen lds
    buffer_load_dwordx4 v33, s[48:51], s70 offen offset:1024 lds
    buffer_load_dwordx4 v34, s[48:51], s70 offen offset:2048 lds
    buffer_load_dwordx4 v35, s[48:51], s70 offen offset:3072 lds
    s_mov_b32 m0, 90368
    s_nop 0
    buffer_load_dwordx4 v32, s[52:55], s70 offen lds
    buffer_load_dwordx4 v33, s[52:55], s70 offen offset:1024 lds
    buffer_load_dwordx4 v34, s[52:55], s70 offen offset:2048 lds
    s_waitcnt vmcnt(55)
    buffer_load_dwordx4 v35, s[52:55], s70 offen offset:3072 lds
    s_mov_b32 m0, 98560
    s_nop 0
    buffer_load_dwordx4 v32, s[56:59], s70 offen lds
    buffer_load_dwordx4 v33, s[56:59], s70 offen offset:1024 lds
    buffer_load_dwordx4 v34, s[56:59], s70 offen offset:2048 lds
    buffer_load_dwordx4 v35, s[56:59], s70 offen offset:3072 lds
    s_waitcnt vmcnt(38) lgkmcnt(0)
    s_barrier
    s_lshr_b64 s[80:81], s[80:81], 4
    s_and_b32 s79, s80, 15
    s_add_u32 s79, s79, s43
    s_sub_u32 s38, s79, 10
    s_cmp_ge_u32 s79, 10
    s_cselect_b32 s79, s38, s79
    s_mul_i32 s71, s79, 245760
    s_lshl_b32 s78, s79, 7
    s_mov_b32 m0, 141696
    s_nop 0
    buffer_load_dwordx4 v36, s[44:47], s78 offen lds
    buffer_load_dwordx4 v37, s[44:47], s78 offen offset:1024 lds
    buffer_load_dwordx4 v38, s[44:47], s78 offen offset:2048 lds
    buffer_load_dwordx4 v39, s[44:47], s78 offen offset:3072 lds
    s_mov_b32 m0, 117120
    s_nop 0
    buffer_load_dwordx4 v28, s[48:51], s71 offen lds
    buffer_load_dwordx4 v29, s[48:51], s71 offen offset:1024 lds
    buffer_load_dwordx4 v30, s[48:51], s71 offen offset:2048 lds
    buffer_load_dwordx4 v31, s[48:51], s71 offen offset:3072 lds
    s_mov_b32 m0, 145792
    s_nop 0
    buffer_load_dwordx4 v40, s[44:47], s78 offen lds
    buffer_load_dwordx4 v41, s[44:47], s78 offen offset:1024 lds
    buffer_load_dwordx4 v42, s[44:47], s78 offen offset:2048 lds
    buffer_load_dwordx4 v43, s[44:47], s78 offen offset:3072 lds
    s_mov_b32 m0, 125312
    s_nop 0
    buffer_load_dwordx4 v28, s[52:55], s71 offen lds
    buffer_load_dwordx4 v29, s[52:55], s71 offen offset:1024 lds
    buffer_load_dwordx4 v30, s[52:55], s71 offen offset:2048 lds
    buffer_load_dwordx4 v31, s[52:55], s71 offen offset:3072 lds
    s_mov_b32 m0, 149888
    s_nop 0
    buffer_load_dwordx4 v44, s[44:47], s78 offen lds
    buffer_load_dwordx4 v45, s[44:47], s78 offen offset:1024 lds
    buffer_load_dwordx4 v46, s[44:47], s78 offen offset:2048 lds
    buffer_load_dwordx4 v47, s[44:47], s78 offen offset:3072 lds
    s_mov_b32 m0, 133504
    s_nop 0
    buffer_load_dwordx4 v28, s[56:59], s71 offen lds
    buffer_load_dwordx4 v29, s[56:59], s71 offen offset:1024 lds
    buffer_load_dwordx4 v30, s[56:59], s71 offen offset:2048 lds
    buffer_load_dwordx4 v31, s[56:59], s71 offen offset:3072 lds
    s_mov_b32 m0, 153984
    s_nop 0
    buffer_load_dwordx4 v48, s[44:47], s78 offen lds
    s_waitcnt vmcnt(55)
    buffer_load_dwordx4 v49, s[44:47], s78 offen offset:1024 lds
    s_mov_b32 m0, 121216
    s_nop 0
    buffer_load_dwordx4 v32, s[48:51], s71 offen lds
    buffer_load_dwordx4 v33, s[48:51], s71 offen offset:1024 lds
    buffer_load_dwordx4 v34, s[48:51], s71 offen offset:2048 lds
    buffer_load_dwordx4 v35, s[48:51], s71 offen offset:3072 lds
    s_mov_b32 m0, 129408
    s_nop 0
    buffer_load_dwordx4 v32, s[52:55], s71 offen lds
    buffer_load_dwordx4 v33, s[52:55], s71 offen offset:1024 lds
    buffer_load_dwordx4 v34, s[52:55], s71 offen offset:2048 lds
    s_waitcnt vmcnt(55)
    buffer_load_dwordx4 v35, s[52:55], s71 offen offset:3072 lds
    s_mov_b32 m0, 137600
    s_nop 0
    buffer_load_dwordx4 v32, s[56:59], s71 offen lds
    buffer_load_dwordx4 v33, s[56:59], s71 offen offset:1024 lds
    buffer_load_dwordx4 v34, s[56:59], s71 offen offset:2048 lds
    buffer_load_dwordx4 v35, s[56:59], s71 offen offset:3072 lds
    s_waitcnt vmcnt(38) lgkmcnt(0)
    s_barrier
    s_lshr_b64 s[80:81], s[80:81], 4
    s_and_b32 s79, s80, 15
    s_add_u32 s79, s79, s43
    s_sub_u32 s38, s79, 10
    s_cmp_ge_u32 s79, 10
    s_cselect_b32 s79, s38, s79
    s_mul_i32 s72, s79, 245760
    s_lshl_b32 s78, s79, 7
    s_mov_b32 m0, 24576
    s_nop 0
    buffer_load_dwordx4 v36, s[44:47], s78 offen lds
    buffer_load_dwordx4 v37, s[44:47], s78 offen offset:1024 lds
    buffer_load_dwordx4 v38, s[44:47], s78 offen offset:2048 lds
    buffer_load_dwordx4 v39, s[44:47], s78 offen offset:3072 lds
    s_mov_b32 m0, 0
    s_nop 0
    buffer_load_dwordx4 v28, s[48:51], s72 offen lds
    buffer_load_dwordx4 v29, s[48:51], s72 offen offset:1024 lds
    buffer_load_dwordx4 v30, s[48:51], s72 offen offset:2048 lds
    buffer_load_dwordx4 v31, s[48:51], s72 offen offset:3072 lds
    s_mov_b32 m0, 28672
    s_nop 0
    buffer_load_dwordx4 v40, s[44:47], s78 offen lds
    buffer_load_dwordx4 v41, s[44:47], s78 offen offset:1024 lds
    buffer_load_dwordx4 v42, s[44:47], s78 offen offset:2048 lds
    buffer_load_dwordx4 v43, s[44:47], s78 offen offset:3072 lds
    s_mov_b32 m0, 8192
    s_nop 0
    buffer_load_dwordx4 v28, s[52:55], s72 offen lds
    buffer_load_dwordx4 v29, s[52:55], s72 offen offset:1024 lds
    buffer_load_dwordx4 v30, s[52:55], s72 offen offset:2048 lds
    buffer_load_dwordx4 v31, s[52:55], s72 offen offset:3072 lds
    s_mov_b32 m0, 32768
    s_nop 0
    buffer_load_dwordx4 v44, s[44:47], s78 offen lds
    buffer_load_dwordx4 v45, s[44:47], s78 offen offset:1024 lds
    buffer_load_dwordx4 v46, s[44:47], s78 offen offset:2048 lds
    buffer_load_dwordx4 v47, s[44:47], s78 offen offset:3072 lds
    s_mov_b32 m0, 16384
    s_nop 0
    buffer_load_dwordx4 v28, s[56:59], s72 offen lds
    buffer_load_dwordx4 v29, s[56:59], s72 offen offset:1024 lds
    buffer_load_dwordx4 v30, s[56:59], s72 offen offset:2048 lds
    buffer_load_dwordx4 v31, s[56:59], s72 offen offset:3072 lds
    s_mov_b32 m0, 36864
    s_nop 0
    buffer_load_dwordx4 v48, s[44:47], s78 offen lds
    s_waitcnt vmcnt(55)
    buffer_load_dwordx4 v49, s[44:47], s78 offen offset:1024 lds
    s_mov_b32 m0, 4096
    s_nop 0
    buffer_load_dwordx4 v32, s[48:51], s72 offen lds
    buffer_load_dwordx4 v33, s[48:51], s72 offen offset:1024 lds
    buffer_load_dwordx4 v34, s[48:51], s72 offen offset:2048 lds
    buffer_load_dwordx4 v35, s[48:51], s72 offen offset:3072 lds
    s_mov_b32 m0, 12288
    s_nop 0
    buffer_load_dwordx4 v32, s[52:55], s72 offen lds
    buffer_load_dwordx4 v33, s[52:55], s72 offen offset:1024 lds
    buffer_load_dwordx4 v34, s[52:55], s72 offen offset:2048 lds
    s_waitcnt vmcnt(55)
    buffer_load_dwordx4 v35, s[52:55], s72 offen offset:3072 lds
    s_mov_b32 m0, 20480
    s_nop 0
    buffer_load_dwordx4 v32, s[56:59], s72 offen lds
    buffer_load_dwordx4 v33, s[56:59], s72 offen offset:1024 lds
    buffer_load_dwordx4 v34, s[56:59], s72 offen offset:2048 lds
    buffer_load_dwordx4 v35, s[56:59], s72 offen offset:3072 lds
    s_waitcnt vmcnt(38) lgkmcnt(0)
    s_barrier
    s_lshr_b64 s[80:81], s[80:81], 4
    s_and_b32 s79, s80, 15
    s_add_u32 s79, s79, s43
    s_sub_u32 s38, s79, 10
    s_cmp_ge_u32 s79, 10
    s_cselect_b32 s79, s38, s79
    s_mul_i32 s73, s79, 245760
    s_lshl_b32 s78, s79, 7
    s_mov_b32 m0, 63616
    s_nop 0
    buffer_load_dwordx4 v36, s[44:47], s78 offen lds
    buffer_load_dwordx4 v37, s[44:47], s78 offen offset:1024 lds
    buffer_load_dwordx4 v38, s[44:47], s78 offen offset:2048 lds
    buffer_load_dwordx4 v39, s[44:47], s78 offen offset:3072 lds
    s_mov_b32 m0, 39040
    s_nop 0
    buffer_load_dwordx4 v28, s[48:51], s73 offen lds
    buffer_load_dwordx4 v29, s[48:51], s73 offen offset:1024 lds
    buffer_load_dwordx4 v30, s[48:51], s73 offen offset:2048 lds
    buffer_load_dwordx4 v31, s[48:51], s73 offen offset:3072 lds
    s_mov_b32 m0, 67712
    s_nop 0
    buffer_load_dwordx4 v40, s[44:47], s78 offen lds
    buffer_load_dwordx4 v41, s[44:47], s78 offen offset:1024 lds
    buffer_load_dwordx4 v42, s[44:47], s78 offen offset:2048 lds
    buffer_load_dwordx4 v43, s[44:47], s78 offen offset:3072 lds
    s_mov_b32 m0, 47232
    s_nop 0
    buffer_load_dwordx4 v28, s[52:55], s73 offen lds
    buffer_load_dwordx4 v29, s[52:55], s73 offen offset:1024 lds
    buffer_load_dwordx4 v30, s[52:55], s73 offen offset:2048 lds
    buffer_load_dwordx4 v31, s[52:55], s73 offen offset:3072 lds
    s_mov_b32 m0, 71808
    s_nop 0
    buffer_load_dwordx4 v44, s[44:47], s78 offen lds
    buffer_load_dwordx4 v45, s[44:47], s78 offen offset:1024 lds
    buffer_load_dwordx4 v46, s[44:47], s78 offen offset:2048 lds
    buffer_load_dwordx4 v47, s[44:47], s78 offen offset:3072 lds
    s_mov_b32 m0, 55424
    s_nop 0
    buffer_load_dwordx4 v28, s[56:59], s73 offen lds
    buffer_load_dwordx4 v29, s[56:59], s73 offen offset:1024 lds
    buffer_load_dwordx4 v30, s[56:59], s73 offen offset:2048 lds
    buffer_load_dwordx4 v31, s[56:59], s73 offen offset:3072 lds
    s_mov_b32 m0, 75904
    s_nop 0
    buffer_load_dwordx4 v48, s[44:47], s78 offen lds
    s_waitcnt vmcnt(55)
    buffer_load_dwordx4 v49, s[44:47], s78 offen offset:1024 lds
    s_mov_b32 m0, 43136
    s_nop 0
    buffer_load_dwordx4 v32, s[48:51], s73 offen lds
    buffer_load_dwordx4 v33, s[48:51], s73 offen offset:1024 lds
    buffer_load_dwordx4 v34, s[48:51], s73 offen offset:2048 lds
    buffer_load_dwordx4 v35, s[48:51], s73 offen offset:3072 lds
    s_mov_b32 m0, 51328
    s_nop 0
    buffer_load_dwordx4 v32, s[52:55], s73 offen lds
    buffer_load_dwordx4 v33, s[52:55], s73 offen offset:1024 lds
    buffer_load_dwordx4 v34, s[52:55], s73 offen offset:2048 lds
    s_waitcnt vmcnt(55)
    buffer_load_dwordx4 v35, s[52:55], s73 offen offset:3072 lds
    s_mov_b32 m0, 59520
    s_nop 0
    buffer_load_dwordx4 v32, s[56:59], s73 offen lds
    buffer_load_dwordx4 v33, s[56:59], s73 offen offset:1024 lds
    buffer_load_dwordx4 v34, s[56:59], s73 offen offset:2048 lds
    buffer_load_dwordx4 v35, s[56:59], s73 offen offset:3072 lds
    s_waitcnt vmcnt(38) lgkmcnt(0)
    s_barrier
    s_lshr_b64 s[80:81], s[80:81], 4
    s_and_b32 s79, s80, 15
    s_add_u32 s79, s79, s43
    s_sub_u32 s38, s79, 10
    s_cmp_ge_u32 s79, 10
    s_cselect_b32 s79, s38, s79
    s_mul_i32 s74, s79, 245760
    s_lshl_b32 s78, s79, 7
    s_mov_b32 m0, 102656
    s_nop 0
    buffer_load_dwordx4 v36, s[44:47], s78 offen lds
    buffer_load_dwordx4 v37, s[44:47], s78 offen offset:1024 lds
    buffer_load_dwordx4 v38, s[44:47], s78 offen offset:2048 lds
    buffer_load_dwordx4 v39, s[44:47], s78 offen offset:3072 lds
    s_mov_b32 m0, 78080
    s_nop 0
    buffer_load_dwordx4 v28, s[48:51], s74 offen lds
    buffer_load_dwordx4 v29, s[48:51], s74 offen offset:1024 lds
    buffer_load_dwordx4 v30, s[48:51], s74 offen offset:2048 lds
    buffer_load_dwordx4 v31, s[48:51], s74 offen offset:3072 lds
    s_mov_b32 m0, 106752
    s_nop 0
    buffer_load_dwordx4 v40, s[44:47], s78 offen lds
    buffer_load_dwordx4 v41, s[44:47], s78 offen offset:1024 lds
    buffer_load_dwordx4 v42, s[44:47], s78 offen offset:2048 lds
    buffer_load_dwordx4 v43, s[44:47], s78 offen offset:3072 lds
    s_mov_b32 m0, 86272
    s_nop 0
    buffer_load_dwordx4 v28, s[52:55], s74 offen lds
    buffer_load_dwordx4 v29, s[52:55], s74 offen offset:1024 lds
    buffer_load_dwordx4 v30, s[52:55], s74 offen offset:2048 lds
    buffer_load_dwordx4 v31, s[52:55], s74 offen offset:3072 lds
    s_mov_b32 m0, 110848
    s_nop 0
    buffer_load_dwordx4 v44, s[44:47], s78 offen lds
    buffer_load_dwordx4 v45, s[44:47], s78 offen offset:1024 lds
    buffer_load_dwordx4 v46, s[44:47], s78 offen offset:2048 lds
    buffer_load_dwordx4 v47, s[44:47], s78 offen offset:3072 lds
    s_mov_b32 m0, 82176
    s_nop 0
    buffer_load_dwordx4 v32, s[48:51], s74 offen lds
    buffer_load_dwordx4 v33, s[48:51], s74 offen offset:1024 lds
    buffer_load_dwordx4 v34, s[48:51], s74 offen offset:2048 lds
    buffer_load_dwordx4 v35, s[48:51], s74 offen offset:3072 lds
    s_mov_b32 m0, 114944
    s_nop 0
    buffer_load_dwordx4 v48, s[44:47], s78 offen lds
    s_waitcnt vmcnt(55)
    buffer_load_dwordx4 v49, s[44:47], s78 offen offset:1024 lds
    s_mov_b32 m0, 90368
    s_nop 0
    buffer_load_dwordx4 v32, s[52:55], s74 offen lds
    buffer_load_dwordx4 v33, s[52:55], s74 offen offset:1024 lds
    buffer_load_dwordx4 v34, s[52:55], s74 offen offset:2048 lds
    buffer_load_dwordx4 v35, s[52:55], s74 offen offset:3072 lds
    s_waitcnt vmcnt(30) lgkmcnt(0)
    s_barrier
    s_lshr_b64 s[80:81], s[80:81], 4
    s_and_b32 s79, s80, 15
    s_add_u32 s79, s79, s43
    s_sub_u32 s38, s79, 10
    s_cmp_ge_u32 s79, 10
    s_cselect_b32 s79, s38, s79
    s_mul_i32 s75, s79, 245760
    s_lshl_b32 s78, s79, 7
    s_mov_b32 m0, 141696
    s_nop 0
    buffer_load_dwordx4 v36, s[44:47], s78 offen lds
    buffer_load_dwordx4 v37, s[44:47], s78 offen offset:1024 lds
    buffer_load_dwordx4 v38, s[44:47], s78 offen offset:2048 lds
    buffer_load_dwordx4 v39, s[44:47], s78 offen offset:3072 lds
    s_mov_b32 m0, 117120
    s_nop 0
    buffer_load_dwordx4 v28, s[48:51], s75 offen lds
    buffer_load_dwordx4 v29, s[48:51], s75 offen offset:1024 lds
    buffer_load_dwordx4 v30, s[48:51], s75 offen offset:2048 lds
    buffer_load_dwordx4 v31, s[48:51], s75 offen offset:3072 lds
    s_mov_b32 m0, 145792
    s_nop 0
    buffer_load_dwordx4 v40, s[44:47], s78 offen lds
    buffer_load_dwordx4 v41, s[44:47], s78 offen offset:1024 lds
    buffer_load_dwordx4 v42, s[44:47], s78 offen offset:2048 lds
    buffer_load_dwordx4 v43, s[44:47], s78 offen offset:3072 lds
    s_mov_b32 m0, 125312
    s_nop 0
    buffer_load_dwordx4 v28, s[52:55], s75 offen lds
    buffer_load_dwordx4 v29, s[52:55], s75 offen offset:1024 lds
    buffer_load_dwordx4 v30, s[52:55], s75 offen offset:2048 lds
    buffer_load_dwordx4 v31, s[52:55], s75 offen offset:3072 lds
    s_mov_b32 m0, 149888
    s_nop 0
    buffer_load_dwordx4 v44, s[44:47], s78 offen lds
    buffer_load_dwordx4 v45, s[44:47], s78 offen offset:1024 lds
    buffer_load_dwordx4 v46, s[44:47], s78 offen offset:2048 lds
    buffer_load_dwordx4 v47, s[44:47], s78 offen offset:3072 lds
    s_mov_b32 m0, 121216
    s_nop 0
    buffer_load_dwordx4 v32, s[48:51], s75 offen lds
    buffer_load_dwordx4 v33, s[48:51], s75 offen offset:1024 lds
    buffer_load_dwordx4 v34, s[48:51], s75 offen offset:2048 lds
    buffer_load_dwordx4 v35, s[48:51], s75 offen offset:3072 lds
    s_mov_b32 m0, 153984
    s_nop 0
    buffer_load_dwordx4 v48, s[44:47], s78 offen lds
    buffer_load_dwordx4 v49, s[44:47], s78 offen offset:1024 lds
    s_mov_b32 m0, 129408
    s_nop 0
    buffer_load_dwordx4 v32, s[52:55], s75 offen lds
    buffer_load_dwordx4 v33, s[52:55], s75 offen offset:1024 lds
    buffer_load_dwordx4 v34, s[52:55], s75 offen offset:2048 lds
    buffer_load_dwordx4 v35, s[52:55], s75 offen offset:3072 lds
    s_waitcnt vmcnt(30) lgkmcnt(0)
    s_barrier
    s_lshr_b64 s[80:81], s[80:81], 4
    s_and_b32 s79, s80, 15
    s_add_u32 s79, s79, s43
    s_sub_u32 s38, s79, 10
    s_cmp_ge_u32 s79, 10
    s_cselect_b32 s79, s38, s79
    s_mul_i32 s76, s79, 245760
    s_lshl_b32 s78, s79, 7
    s_mov_b32 m0, 24576
    s_nop 0
    buffer_load_dwordx4 v36, s[44:47], s78 offen lds
    buffer_load_dwordx4 v37, s[44:47], s78 offen offset:1024 lds
    buffer_load_dwordx4 v38, s[44:47], s78 offen offset:2048 lds
    buffer_load_dwordx4 v39, s[44:47], s78 offen offset:3072 lds
    s_mov_b32 m0, 0
    s_nop 0
    buffer_load_dwordx4 v28, s[48:51], s76 offen lds
    buffer_load_dwordx4 v29, s[48:51], s76 offen offset:1024 lds
    buffer_load_dwordx4 v30, s[48:51], s76 offen offset:2048 lds
    buffer_load_dwordx4 v31, s[48:51], s76 offen offset:3072 lds
    s_mov_b32 m0, 28672
    s_nop 0
    buffer_load_dwordx4 v40, s[44:47], s78 offen lds
    buffer_load_dwordx4 v41, s[44:47], s78 offen offset:1024 lds
    buffer_load_dwordx4 v42, s[44:47], s78 offen offset:2048 lds
    buffer_load_dwordx4 v43, s[44:47], s78 offen offset:3072 lds
    s_mov_b32 m0, 8192
    s_nop 0
    buffer_load_dwordx4 v28, s[52:55], s76 offen lds
    buffer_load_dwordx4 v29, s[52:55], s76 offen offset:1024 lds
    buffer_load_dwordx4 v30, s[52:55], s76 offen offset:2048 lds
    buffer_load_dwordx4 v31, s[52:55], s76 offen offset:3072 lds
    s_mov_b32 m0, 32768
    s_nop 0
    buffer_load_dwordx4 v44, s[44:47], s78 offen lds
    buffer_load_dwordx4 v45, s[44:47], s78 offen offset:1024 lds
    buffer_load_dwordx4 v46, s[44:47], s78 offen offset:2048 lds
    buffer_load_dwordx4 v47, s[44:47], s78 offen offset:3072 lds
    s_mov_b32 m0, 4096
    s_nop 0
    buffer_load_dwordx4 v32, s[48:51], s76 offen lds
    buffer_load_dwordx4 v33, s[48:51], s76 offen offset:1024 lds
    buffer_load_dwordx4 v34, s[48:51], s76 offen offset:2048 lds
    buffer_load_dwordx4 v35, s[48:51], s76 offen offset:3072 lds
    s_mov_b32 m0, 36864
    s_nop 0
    buffer_load_dwordx4 v48, s[44:47], s78 offen lds
    buffer_load_dwordx4 v49, s[44:47], s78 offen offset:1024 lds
    s_mov_b32 m0, 12288
    s_nop 0
    buffer_load_dwordx4 v32, s[52:55], s76 offen lds
    buffer_load_dwordx4 v33, s[52:55], s76 offen offset:1024 lds
    buffer_load_dwordx4 v34, s[52:55], s76 offen offset:2048 lds
    buffer_load_dwordx4 v35, s[52:55], s76 offen offset:3072 lds
    s_waitcnt vmcnt(30) lgkmcnt(0)
    s_barrier
    s_lshr_b64 s[80:81], s[80:81], 4
    s_and_b32 s79, s80, 15
    s_add_u32 s79, s79, s43
    s_sub_u32 s38, s79, 10
    s_cmp_ge_u32 s79, 10
    s_cselect_b32 s79, s38, s79
    s_mul_i32 s77, s79, 245760
    s_lshl_b32 s78, s79, 7
    s_mov_b32 m0, 63616
    s_nop 0
    buffer_load_dwordx4 v36, s[44:47], s78 offen lds
    buffer_load_dwordx4 v37, s[44:47], s78 offen offset:1024 lds
    buffer_load_dwordx4 v38, s[44:47], s78 offen offset:2048 lds
    buffer_load_dwordx4 v39, s[44:47], s78 offen offset:3072 lds
    s_mov_b32 m0, 39040
    s_nop 0
    buffer_load_dwordx4 v28, s[48:51], s77 offen lds
    buffer_load_dwordx4 v29, s[48:51], s77 offen offset:1024 lds
    buffer_load_dwordx4 v30, s[48:51], s77 offen offset:2048 lds
    buffer_load_dwordx4 v31, s[48:51], s77 offen offset:3072 lds
    s_mov_b32 m0, 67712
    s_nop 0
    buffer_load_dwordx4 v40, s[44:47], s78 offen lds
    buffer_load_dwordx4 v41, s[44:47], s78 offen offset:1024 lds
    buffer_load_dwordx4 v42, s[44:47], s78 offen offset:2048 lds
    buffer_load_dwordx4 v43, s[44:47], s78 offen offset:3072 lds
    s_mov_b32 m0, 47232
    s_nop 0
    buffer_load_dwordx4 v28, s[52:55], s77 offen lds
    buffer_load_dwordx4 v29, s[52:55], s77 offen offset:1024 lds
    buffer_load_dwordx4 v30, s[52:55], s77 offen offset:2048 lds
    buffer_load_dwordx4 v31, s[52:55], s77 offen offset:3072 lds
    s_mov_b32 m0, 71808
    s_nop 0
    buffer_load_dwordx4 v44, s[44:47], s78 offen lds
    buffer_load_dwordx4 v45, s[44:47], s78 offen offset:1024 lds
    buffer_load_dwordx4 v46, s[44:47], s78 offen offset:2048 lds
    buffer_load_dwordx4 v47, s[44:47], s78 offen offset:3072 lds
    s_mov_b32 m0, 43136
    s_nop 0
    buffer_load_dwordx4 v32, s[48:51], s77 offen lds
    buffer_load_dwordx4 v33, s[48:51], s77 offen offset:1024 lds
    buffer_load_dwordx4 v34, s[48:51], s77 offen offset:2048 lds
    buffer_load_dwordx4 v35, s[48:51], s77 offen offset:3072 lds
    s_mov_b32 m0, 75904
    s_nop 0
    buffer_load_dwordx4 v48, s[44:47], s78 offen lds
    buffer_load_dwordx4 v49, s[44:47], s78 offen offset:1024 lds
    s_mov_b32 m0, 51328
    s_nop 0
    buffer_load_dwordx4 v32, s[52:55], s77 offen lds
    buffer_load_dwordx4 v33, s[52:55], s77 offen offset:1024 lds
    buffer_load_dwordx4 v34, s[52:55], s77 offen offset:2048 lds
    buffer_load_dwordx4 v35, s[52:55], s77 offen offset:3072 lds
    s_waitcnt vmcnt(30) lgkmcnt(0)
    s_barrier
    s_lshr_b64 s[80:81], s[80:81], 4
    s_and_b32 s79, s80, 15
    s_add_u32 s79, s79, s43
    s_sub_u32 s38, s79, 10
    s_cmp_ge_u32 s79, 10
    s_cselect_b32 s79, s38, s79
    s_mov_b32 m0, 94464
    s_nop 0
    buffer_load_dwordx4 v28, s[56:59], s74 offen lds
    buffer_load_dwordx4 v29, s[56:59], s74 offen offset:1024 lds
    buffer_load_dwordx4 v30, s[56:59], s74 offen offset:2048 lds
    buffer_load_dwordx4 v31, s[56:59], s74 offen offset:3072 lds
    s_mov_b32 m0, 98560
    s_nop 0
    buffer_load_dwordx4 v32, s[56:59], s74 offen lds
    buffer_load_dwordx4 v33, s[56:59], s74 offen offset:1024 lds
    buffer_load_dwordx4 v34, s[56:59], s74 offen offset:2048 lds
    buffer_load_dwordx4 v35, s[56:59], s74 offen offset:3072 lds
    s_mov_b32 m0, 133504
    s_nop 0
    buffer_load_dwordx4 v28, s[56:59], s75 offen lds
    buffer_load_dwordx4 v29, s[56:59], s75 offen offset:1024 lds
    buffer_load_dwordx4 v30, s[56:59], s75 offen offset:2048 lds
    buffer_load_dwordx4 v31, s[56:59], s75 offen offset:3072 lds
    s_waitcnt vmcnt(12) lgkmcnt(0)
    s_barrier
    s_mov_b32 m0, 137600
    s_nop 0
    buffer_load_dwordx4 v32, s[56:59], s75 offen lds
    buffer_load_dwordx4 v33, s[56:59], s75 offen offset:1024 lds
    buffer_load_dwordx4 v34, s[56:59], s75 offen offset:2048 lds
    buffer_load_dwordx4 v35, s[56:59], s75 offen offset:3072 lds
    s_mov_b32 m0, 16384
    s_nop 0
    buffer_load_dwordx4 v28, s[56:59], s76 offen lds
    buffer_load_dwordx4 v29, s[56:59], s76 offen offset:1024 lds
    buffer_load_dwordx4 v30, s[56:59], s76 offen offset:2048 lds
    buffer_load_dwordx4 v31, s[56:59], s76 offen offset:3072 lds
    s_mov_b32 m0, 20480
    s_nop 0
    buffer_load_dwordx4 v32, s[56:59], s76 offen lds
    buffer_load_dwordx4 v33, s[56:59], s76 offen offset:1024 lds
    buffer_load_dwordx4 v34, s[56:59], s76 offen offset:2048 lds
    buffer_load_dwordx4 v35, s[56:59], s76 offen offset:3072 lds
    s_mov_b32 m0, 55424
    s_nop 0
    buffer_load_dwordx4 v28, s[56:59], s77 offen lds
    buffer_load_dwordx4 v29, s[56:59], s77 offen offset:1024 lds
    buffer_load_dwordx4 v30, s[56:59], s77 offen offset:2048 lds
    buffer_load_dwordx4 v31, s[56:59], s77 offen offset:3072 lds
    s_mov_b32 m0, 59520
    s_nop 0
    buffer_load_dwordx4 v32, s[56:59], s77 offen lds
    buffer_load_dwordx4 v33, s[56:59], s77 offen offset:1024 lds
    buffer_load_dwordx4 v34, s[56:59], s77 offen offset:2048 lds
    buffer_load_dwordx4 v35, s[56:59], s77 offen offset:3072 lds
    s_mov_b32 s10, 20480
    v_lshrrev_b32 v52, 5, v1
    v_lshlrev_b32 v52, 3, v52
    v_add_u32 v53, 2, v52
    v_add_u32 v54, 4, v52
    v_add_u32 v55, 6, v52
    v_add_u32 v56, 16, v52
    v_add_u32 v57, 18, v52
    v_add_u32 v58, 20, v52
    v_add_u32 v59, 22, v52
    v_and_b32 v7, 3, v5
    v_mul_u32_u24 v7, 1280, v7
    v_add_u32 v60, v7, v50
    v_xor_b32 v61, 64, v60
    v_add_u32 v61, 4096, v61
    v_add_u32 v62, 8192, v60
    v_add_u32 v63, 8192, v61
    s_mov_b32 s5, 0xbfe10856
    s_mov_b32 s6, 0xaff80255
    s_mov_b32 s7, 0xabfe4015
    s_mov_b32 s8, 0xaa7fd005
    s_mov_b32 s9, 0x6adfb401
    s_cmp_eq_u32 s42, 1
    s_cselect_b32 s5, 0xabfe4015, s5
    s_cselect_b32 s6, 0xaa7fd005, s6
    s_cselect_b32 s7, 0x6adfb401, s7
    s_cselect_b32 s8, 0xbfe10856, s8
    s_cselect_b32 s9, 0xaff80255, s9
    s_cmp_eq_u32 s42, 2
    s_cselect_b32 s5, 0x6adfb401, s5
    s_cselect_b32 s6, 0xbfe10856, s6
    s_cselect_b32 s7, 0xaff80255, s7
    s_cselect_b32 s8, 0xabfe4015, s8
    s_cselect_b32 s9, 0xaa7fd005, s9
    s_cmp_eq_u32 s42, 3
    s_cselect_b32 s5, 0xaff80255, s5
    s_cselect_b32 s6, 0xabfe4015, s6
    s_cselect_b32 s7, 0xaa7fd005, s7
    s_cselect_b32 s8, 0x6adfb401, s8
    s_cselect_b32 s9, 0xbfe10856, s9
    s_cmp_eq_u32 s42, 4
    s_cselect_b32 s5, 0xaa7fd005, s5
    s_cselect_b32 s6, 0x6adfb401, s6
    s_cselect_b32 s7, 0xbfe10856, s7
    s_cselect_b32 s8, 0xaff80255, s8
    s_cselect_b32 s9, 0xabfe4015, s9
    s_mul_i32 s4, s42, 163840
    s_mov_b32 m0, 0
    v_bfe_u32 v64, s5, v52, 2
    v_mad_u32_u24 v64, v64, s10, v60
    buffer_load_dwordx4 v64, s[60:63], s4 offen lds
    v_bfe_u32 v65, s5, v53, 2
    v_mad_u32_u24 v65, v65, s10, v61
    buffer_load_dwordx4 v65, s[60:63], s4 offen offset:1024 lds
    v_bfe_u32 v64, s5, v54, 2
    v_mad_u32_u24 v64, v64, s10, v62
    buffer_load_dwordx4 v64, s[60:63], s4 offen offset:2048 lds
    v_bfe_u32 v65, s5, v55, 2
    v_mad_u32_u24 v65, v65, s10, v63
    buffer_load_dwordx4 v65, s[60:63], s4 offen offset:3072 lds
    s_mov_b32 m0, 4096
    v_bfe_u32 v64, s5, v56, 2
    v_mad_u32_u24 v64, v64, s10, v60
    buffer_load_dwordx4 v64, s[60:63], s4 offen lds
    v_bfe_u32 v65, s5, v57, 2
    v_mad_u32_u24 v65, v65, s10, v61
    buffer_load_dwordx4 v65, s[60:63], s4 offen offset:1024 lds
    v_bfe_u32 v64, s5, v58, 2
    v_mad_u32_u24 v64, v64, s10, v62
    buffer_load_dwordx4 v64, s[60:63], s4 offen offset:2048 lds
    v_bfe_u32 v65, s5, v59, 2
    v_mad_u32_u24 v65, v65, s10, v63
    buffer_load_dwordx4 v65, s[60:63], s4 offen offset:3072 lds
    s_add_u32 s4, s4, 81920
    s_cmp_eq_u32 s4, 819200
    s_cselect_b32 s4, 0, s4
    s_mov_b32 m0, 8192
    v_bfe_u32 v64, s6, v52, 2
    v_mad_u32_u24 v64, v64, s10, v60
    buffer_load_dwordx4 v64, s[60:63], s4 offen lds
    v_bfe_u32 v65, s6, v53, 2
    v_mad_u32_u24 v65, v65, s10, v61
    buffer_load_dwordx4 v65, s[60:63], s4 offen offset:1024 lds
    v_bfe_u32 v64, s6, v54, 2
    v_mad_u32_u24 v64, v64, s10, v62
    buffer_load_dwordx4 v64, s[60:63], s4 offen offset:2048 lds
    v_bfe_u32 v65, s6, v55, 2
    v_mad_u32_u24 v65, v65, s10, v63
    buffer_load_dwordx4 v65, s[60:63], s4 offen offset:3072 lds
    s_mov_b32 m0, 12288
    v_bfe_u32 v64, s6, v56, 2
    v_mad_u32_u24 v64, v64, s10, v60
    buffer_load_dwordx4 v64, s[60:63], s4 offen lds
    v_bfe_u32 v65, s6, v57, 2
    v_mad_u32_u24 v65, v65, s10, v61
    buffer_load_dwordx4 v65, s[60:63], s4 offen offset:1024 lds
    v_bfe_u32 v64, s6, v58, 2
    v_mad_u32_u24 v64, v64, s10, v62
    buffer_load_dwordx4 v64, s[60:63], s4 offen offset:2048 lds
    v_bfe_u32 v65, s6, v59, 2
    v_mad_u32_u24 v65, v65, s10, v63
    buffer_load_dwordx4 v65, s[60:63], s4 offen offset:3072 lds
    s_add_u32 s4, s4, 81920
    s_cmp_eq_u32 s4, 819200
    s_cselect_b32 s4, 0, s4
    s_waitcnt vmcnt(16)
    v_mov_b32 v5, 157980
    v_mov_b32 v6, 1
    s_mov_b64 exec, 1
    ds_add_u32 v5, v6
    s_mov_b64 exec, -1
    v_mov_b32 v5, 157972
    v_mov_b32 v6, 1
    s_mov_b64 exec, 1
    ds_add_u32 v5, v6
    s_mov_b64 exec, -1
    s_mov_b32 m0, 24576
    v_bfe_u32 v64, s7, v52, 2
    v_mad_u32_u24 v64, v64, s10, v60
    buffer_load_dwordx4 v64, s[60:63], s4 offen lds
    v_bfe_u32 v65, s7, v53, 2
    v_mad_u32_u24 v65, v65, s10, v61
    buffer_load_dwordx4 v65, s[60:63], s4 offen offset:1024 lds
    v_bfe_u32 v64, s7, v54, 2
    v_mad_u32_u24 v64, v64, s10, v62
    buffer_load_dwordx4 v64, s[60:63], s4 offen offset:2048 lds
    v_bfe_u32 v65, s7, v55, 2
    v_mad_u32_u24 v65, v65, s10, v63
    buffer_load_dwordx4 v65, s[60:63], s4 offen offset:3072 lds
    s_mov_b32 m0, 28672
    v_bfe_u32 v64, s7, v56, 2
    v_mad_u32_u24 v64, v64, s10, v60
    buffer_load_dwordx4 v64, s[60:63], s4 offen lds
    v_bfe_u32 v65, s7, v57, 2
    v_mad_u32_u24 v65, v65, s10, v61
    buffer_load_dwordx4 v65, s[60:63], s4 offen offset:1024 lds
    v_bfe_u32 v64, s7, v58, 2
    v_mad_u32_u24 v64, v64, s10, v62
    buffer_load_dwordx4 v64, s[60:63], s4 offen offset:2048 lds
    v_bfe_u32 v65, s7, v59, 2
    v_mad_u32_u24 v65, v65, s10, v63
    buffer_load_dwordx4 v65, s[60:63], s4 offen offset:3072 lds
    s_add_u32 s4, s4, 81920
    s_cmp_eq_u32 s4, 819200
    s_cselect_b32 s4, 0, s4
    s_mov_b32 m0, 123136
    v_bfe_u32 v64, s8, v52, 2
    v_mad_u32_u24 v64, v64, s10, v60
    buffer_load_dwordx4 v64, s[60:63], s4 offen lds
    v_bfe_u32 v65, s8, v53, 2
    v_mad_u32_u24 v65, v65, s10, v61
    buffer_load_dwordx4 v65, s[60:63], s4 offen offset:1024 lds
    v_bfe_u32 v64, s8, v54, 2
    v_mad_u32_u24 v64, v64, s10, v62
    buffer_load_dwordx4 v64, s[60:63], s4 offen offset:2048 lds
    v_bfe_u32 v65, s8, v55, 2
    v_mad_u32_u24 v65, v65, s10, v63
    buffer_load_dwordx4 v65, s[60:63], s4 offen offset:3072 lds
    s_mov_b32 m0, 127232
    v_bfe_u32 v64, s8, v56, 2
    v_mad_u32_u24 v64, v64, s10, v60
    buffer_load_dwordx4 v64, s[60:63], s4 offen lds
    v_bfe_u32 v65, s8, v57, 2
    v_mad_u32_u24 v65, v65, s10, v61
    buffer_load_dwordx4 v65, s[60:63], s4 offen offset:1024 lds
    v_bfe_u32 v64, s8, v58, 2
    v_mad_u32_u24 v64, v64, s10, v62
    buffer_load_dwordx4 v64, s[60:63], s4 offen offset:2048 lds
    v_bfe_u32 v65, s8, v59, 2
    v_mad_u32_u24 v65, v65, s10, v63
    buffer_load_dwordx4 v65, s[60:63], s4 offen offset:3072 lds
    s_add_u32 s4, s4, 81920
    s_cmp_eq_u32 s4, 819200
    s_cselect_b32 s4, 0, s4
    s_mov_b32 m0, 80000
    v_bfe_u32 v64, s9, v52, 2
    v_mad_u32_u24 v64, v64, s10, v60
    buffer_load_dwordx4 v64, s[60:63], s4 offen lds
    v_bfe_u32 v65, s9, v53, 2
    v_mad_u32_u24 v65, v65, s10, v61
    buffer_load_dwordx4 v65, s[60:63], s4 offen offset:1024 lds
    v_bfe_u32 v64, s9, v54, 2
    v_mad_u32_u24 v64, v64, s10, v62
    buffer_load_dwordx4 v64, s[60:63], s4 offen offset:2048 lds
    v_bfe_u32 v65, s9, v55, 2
    v_mad_u32_u24 v65, v65, s10, v63
    buffer_load_dwordx4 v65, s[60:63], s4 offen offset:3072 lds
    s_mov_b32 m0, 84096
    v_bfe_u32 v64, s9, v56, 2
    v_mad_u32_u24 v64, v64, s10, v60
    buffer_load_dwordx4 v64, s[60:63], s4 offen lds
    v_bfe_u32 v65, s9, v57, 2
    v_mad_u32_u24 v65, v65, s10, v61
    buffer_load_dwordx4 v65, s[60:63], s4 offen offset:1024 lds
    v_bfe_u32 v64, s9, v58, 2
    v_mad_u32_u24 v64, v64, s10, v62
    buffer_load_dwordx4 v64, s[60:63], s4 offen offset:2048 lds
    v_bfe_u32 v65, s9, v59, 2
    v_mad_u32_u24 v65, v65, s10, v63
    buffer_load_dwordx4 v65, s[60:63], s4 offen offset:3072 lds
    s_add_u32 s4, s4, 81920
    s_cmp_eq_u32 s4, 819200
    s_cselect_b32 s4, 0, s4
    s_waitcnt vmcnt(0)
    v_mov_b32 v7, 157980
    v_mov_b32 v6, 1
    s_mov_b64 exec, 1
    ds_add_u32 v7, v6
    s_mov_b64 exec, -1
Lcw_7:
    s_sub_u32 s35, s35, 1
    s_cbranch_scc1 Lend
    ds_read_b32 v6, v5
    s_waitcnt lgkmcnt(0)
    v_readfirstlane_b32 s38, v6
    s_nop 0
    s_cmp_lt_u32 s38, 8
    s_cbranch_scc1 Lcw_7
    s_lshl_b32 s36, s32, 7
    s_add_u32 s36, s36, 8257536
    v_mov_b32 v69, s36
    buffer_load_dwordx4 v[70:73], v69, s[28:31], 0 offen sc1
    v_mov_b32 v5, 157976
Lcw_8:
    s_sub_u32 s35, s35, 1
    s_cbranch_scc1 Lend
    ds_read_b32 v6, v5
    s_waitcnt lgkmcnt(0)
    v_readfirstlane_b32 s38, v6
    s_nop 0
    s_cmp_lt_u32 s38, 7
    s_cbranch_scc1 Lcw_8
    s_mov_b32 m0, 32768
    v_bfe_u32 v64, s5, v52, 2
    v_mad_u32_u24 v64, v64, s10, v60
    buffer_load_dwordx4 v64, s[60:63], s4 offen lds
    v_bfe_u32 v65, s5, v53, 2
    v_mad_u32_u24 v65, v65, s10, v61
    buffer_load_dwordx4 v65, s[60:63], s4 offen offset:1024 lds
    v_bfe_u32 v64, s5, v54, 2
    v_mad_u32_u24 v64, v64, s10, v62
    buffer_load_dwordx4 v64, s[60:63], s4 offen offset:2048 lds
    v_bfe_u32 v65, s5, v55, 2
    v_mad_u32_u24 v65, v65, s10, v63
    buffer_load_dwordx4 v65, s[60:63], s4 offen offset:3072 lds
    s_mov_b32 m0, 36864
    v_bfe_u32 v64, s5, v56, 2
    v_mad_u32_u24 v64, v64, s10, v60
    buffer_load_dwordx4 v64, s[60:63], s4 offen lds
    v_bfe_u32 v65, s5, v57, 2
    v_mad_u32_u24 v65, v65, s10, v61
    buffer_load_dwordx4 v65, s[60:63], s4 offen offset:1024 lds
    v_bfe_u32 v64, s5, v58, 2
    v_mad_u32_u24 v64, v64, s10, v62
    buffer_load_dwordx4 v64, s[60:63], s4 offen offset:2048 lds
    v_bfe_u32 v65, s5, v59, 2
    v_mad_u32_u24 v65, v65, s10, v63
    buffer_load_dwordx4 v65, s[60:63], s4 offen offset:3072 lds
    s_add_u32 s4, s4, 81920
    s_cmp_eq_u32 s4, 819200
    s_cselect_b32 s4, 0, s4
    s_mov_b32 m0, 40960
    v_bfe_u32 v64, s6, v52, 2
    v_mad_u32_u24 v64, v64, s10, v60
    buffer_load_dwordx4 v64, s[60:63], s4 offen lds
    v_bfe_u32 v65, s6, v53, 2
    v_mad_u32_u24 v65, v65, s10, v61
    buffer_load_dwordx4 v65, s[60:63], s4 offen offset:1024 lds
    v_bfe_u32 v64, s6, v54, 2
    v_mad_u32_u24 v64, v64, s10, v62
    buffer_load_dwordx4 v64, s[60:63], s4 offen offset:2048 lds
    v_bfe_u32 v65, s6, v55, 2
    v_mad_u32_u24 v65, v65, s10, v63
    buffer_load_dwordx4 v65, s[60:63], s4 offen offset:3072 lds
    s_mov_b32 m0, 45056
    v_bfe_u32 v64, s6, v56, 2
    v_mad_u32_u24 v64, v64, s10, v60
    buffer_load_dwordx4 v64, s[60:63], s4 offen lds
    v_bfe_u32 v65, s6, v57, 2
    v_mad_u32_u24 v65, v65, s10, v61
    buffer_load_dwordx4 v65, s[60:63], s4 offen offset:1024 lds
    v_bfe_u32 v64, s6, v58, 2
    v_mad_u32_u24 v64, v64, s10, v62
    buffer_load_dwordx4 v64, s[60:63], s4 offen offset:2048 lds
    v_bfe_u32 v65, s6, v59, 2
    v_mad_u32_u24 v65, v65, s10, v63
    buffer_load_dwordx4 v65, s[60:63], s4 offen offset:3072 lds
    s_add_u32 s4, s4, 81920
    s_cmp_eq_u32 s4, 819200
    s_cselect_b32 s4, 0, s4
    s_mov_b32 m0, 63616
    v_bfe_u32 v64, s7, v52, 2
    v_mad_u32_u24 v64, v64, s10, v60
    buffer_load_dwordx4 v64, s[60:63], s4 offen lds
    v_bfe_u32 v65, s7, v53, 2
    v_mad_u32_u24 v65, v65, s10, v61
    buffer_load_dwordx4 v65, s[60:63], s4 offen offset:1024 lds
    v_bfe_u32 v64, s7, v54, 2
    v_mad_u32_u24 v64, v64, s10, v62
    buffer_load_dwordx4 v64, s[60:63], s4 offen offset:2048 lds
    v_bfe_u32 v65, s7, v55, 2
    v_mad_u32_u24 v65, v65, s10, v63
    buffer_load_dwordx4 v65, s[60:63], s4 offen offset:3072 lds
    s_mov_b32 m0, 67712
    v_bfe_u32 v64, s7, v56, 2
    v_mad_u32_u24 v64, v64, s10, v60
    buffer_load_dwordx4 v64, s[60:63], s4 offen lds
    v_bfe_u32 v65, s7, v57, 2
    v_mad_u32_u24 v65, v65, s10, v61
    buffer_load_dwordx4 v65, s[60:63], s4 offen offset:1024 lds
    v_bfe_u32 v64, s7, v58, 2
    v_mad_u32_u24 v64, v64, s10, v62
    buffer_load_dwordx4 v64, s[60:63], s4 offen offset:2048 lds
    v_bfe_u32 v65, s7, v59, 2
    v_mad_u32_u24 v65, v65, s10, v63
    buffer_load_dwordx4 v65, s[60:63], s4 offen offset:3072 lds
    s_add_u32 s4, s4, 81920
    s_cmp_eq_u32 s4, 819200
    s_cselect_b32 s4, 0, s4
    s_mov_b32 m0, 71808
    v_bfe_u32 v64, s8, v52, 2
    v_mad_u32_u24 v64, v64, s10, v60
    buffer_load_dwordx4 v64, s[60:63], s4 offen lds
    v_bfe_u32 v65, s8, v53, 2
    v_mad_u32_u24 v65, v65, s10, v61
    buffer_load_dwordx4 v65, s[60:63], s4 offen offset:1024 lds
    v_bfe_u32 v64, s8, v54, 2
    v_mad_u32_u24 v64, v64, s10, v62
    buffer_load_dwordx4 v64, s[60:63], s4 offen offset:2048 lds
    v_bfe_u32 v65, s8, v55, 2
    v_mad_u32_u24 v65, v65, s10, v63
    buffer_load_dwordx4 v65, s[60:63], s4 offen offset:3072 lds
    s_mov_b32 m0, 75904
    v_bfe_u32 v64, s8, v56, 2
    v_mad_u32_u24 v64, v64, s10, v60
    buffer_load_dwordx4 v64, s[60:63], s4 offen lds
    v_bfe_u32 v65, s8, v57, 2
    v_mad_u32_u24 v65, v65, s10, v61
    buffer_load_dwordx4 v65, s[60:63], s4 offen offset:1024 lds
    v_bfe_u32 v64, s8, v58, 2
    v_mad_u32_u24 v64, v64, s10, v62
    buffer_load_dwordx4 v64, s[60:63], s4 offen offset:2048 lds
    v_bfe_u32 v65, s8, v59, 2
    v_mad_u32_u24 v65, v65, s10, v63
    buffer_load_dwordx4 v65, s[60:63], s4 offen offset:3072 lds
    s_add_u32 s4, s4, 81920
    s_cmp_eq_u32 s4, 819200
    s_cselect_b32 s4, 0, s4
    s_mov_b32 m0, 49152
    v_bfe_u32 v64, s9, v52, 2
    v_mad_u32_u24 v64, v64, s10, v60
    buffer_load_dwordx4 v64, s[60:63], s4 offen lds
    v_bfe_u32 v65, s9, v53, 2
    v_mad_u32_u24 v65, v65, s10, v61
    buffer_load_dwordx4 v65, s[60:63], s4 offen offset:1024 lds
    v_bfe_u32 v64, s9, v54, 2
    v_mad_u32_u24 v64, v64, s10, v62
    buffer_load_dwordx4 v64, s[60:63], s4 offen offset:2048 lds
    v_bfe_u32 v65, s9, v55, 2
    v_mad_u32_u24 v65, v65, s10, v63
    buffer_load_dwordx4 v65, s[60:63], s4 offen offset:3072 lds
    s_mov_b32 m0, 88192
    v_bfe_u32 v64, s9, v56, 2
    v_mad_u32_u24 v64, v64, s10, v60
    buffer_load_dwordx4 v64, s[60:63], s4 offen lds
    v_bfe_u32 v65, s9, v57, 2
    v_mad_u32_u24 v65, v65, s10, v61
    buffer_load_dwordx4 v65, s[60:63], s4 offen offset:1024 lds
    v_bfe_u32 v64, s9, v58, 2
    v_mad_u32_u24 v64, v64, s10, v62
    buffer_load_dwordx4 v64, s[60:63], s4 offen offset:2048 lds
    v_bfe_u32 v65, s9, v59, 2
    v_mad_u32_u24 v65, v65, s10, v63
    buffer_load_dwordx4 v65, s[60:63], s4 offen offset:3072 lds
    s_add_u32 s4, s4, 81920
    s_cmp_eq_u32 s4, 819200
    s_cselect_b32 s4, 0, s4
    s_waitcnt vmcnt(0)
Lbc:
    v_readfirstlane_b32 s11, v70
    v_readfirstlane_b32 s36, v71
    v_readfirstlane_b32 s12, v72
    v_readfirstlane_b32 s37, v73
    s_cmp_eq_u32 s36, s34
    s_cselect_b32 s37, s37, s36
    s_cmp_eq_u32 s37, s34
    s_cbranch_scc1 Lbc_ok
Lbc_re:
    s_sub_u32 s35, s35, 1
    s_cbranch_scc1 Lend
    buffer_load_dwordx4 v[70:73], v69, s[28:31], 0 offen sc1
    s_waitcnt vmcnt(0)
    s_branch Lbc
Lbc_ok:
    s_mul_i32 s36, s32, 96
    s_and_b32 s13, s11, 0x7ff
    s_sub_u32 s13, 2047, s13
    s_sub_u32 s37, s13, s36
    s_cmp_lt_u32 s37, 96
    s_cselect_b32 s13, s13, -1
    s_and_b32 s14, s12, 0x7ff
    s_sub_u32 s14, 2047, s14
    s_sub_u32 s37, s14, s36
    s_cmp_lt_u32 s37, 96
    s_cselect_b32 s14, s14, -1
    v_mov_b32 v4, s13
    v_mov_b32 v5, s14
    v_mov_b32 v6, 157960
    s_cmp_lg_u32 s3, 0
    s_cbranch_scc1 Lag2
    ds_write_b64 v6, v[4:5]
    s_branch Lw0_done
Lag2:
    s_and_b32 s37, s13, s14
    s_cmp_eq_u32 s37, -1
    s_cbranch_scc1 Lw0_done
    s_max_i32 s36, s13, 0
    s_mul_i32 s36, s36, 1280
    s_lshl_b32 s37, s33, 7
    s_add_u32 s36, s36, s37
    s_add_u32 s36, s36, 4096
    v_lshlrev_b32 v8, 1, v1
    buffer_load_ushort v124, v8, s[44:47], s36 offen
    s_max_i32 s36, s14, 0
    s_mul_i32 s36, s36, 1280
    s_lshl_b32 s37, s33, 7
    s_add_u32 s36, s36, s37
    s_add_u32 s36, s36, 4096
    v_lshlrev_b32 v8, 1, v1
    buffer_load_ushort v125, v8, s[44:47], s36 offen
    v_min_u32 v7, 26, v1
    v_mul_u32_u24 v7, 10240, v7
Ly_poll:
    s_sub_u32 s35, s35, 1
    s_cbranch_scc1 Lend
    s_sleep 4
    s_lshl_b32 s36, s33, 10
    s_add_u32 s36, s36, 7405568
    buffer_load_dword v4, v7, s[28:31], s36 offen offset:1020 sc1
    s_waitcnt vmcnt(0)
    v_cmp_ne_u32 vcc, s34, v4
    s_nop 0
    s_cbranch_vccnz Ly_poll
    buffer_load_dwordx4 v[16:19], v13, s[28:31], s36 offen sc1
    s_add_u32 s36, s36, 10240
    buffer_load_dwordx4 v[20:23], v13, s[28:31], s36 offen sc1
    s_add_u32 s36, s36, 10240
    buffer_load_dwordx4 v[24:27], v13, s[28:31], s36 offen sc1
    s_add_u32 s36, s36, 10240
    buffer_load_dwordx4 v[28:31], v13, s[28:31], s36 offen sc1
    s_add_u32 s36, s36, 10240
    buffer_load_dwordx4 v[32:35], v13, s[28:31], s36 offen sc1
    s_add_u32 s36, s36, 10240
    buffer_load_dwordx4 v[36:39], v13, s[28:31], s36 offen sc1
    s_add_u32 s36, s36, 10240
    buffer_load_dwordx4 v[40:43], v13, s[28:31], s36 offen sc1
    s_add_u32 s36, s36, 10240
    buffer_load_dwordx4 v[44:47], v13, s[28:31], s36 offen sc1
    s_add_u32 s36, s36, 10240
    buffer_load_dwordx4 v[48:51], v13, s[28:31], s36 offen sc1
    s_add_u32 s36, s36, 10240
    buffer_load_dwordx4 v[52:55], v13, s[28:31], s36 offen sc1
    s_add_u32 s36, s36, 10240
    buffer_load_dwordx4 v[56:59], v13, s[28:31], s36 offen sc1
    s_add_u32 s36, s36, 10240
    buffer_load_dwordx4 v[60:63], v13, s[28:31], s36 offen sc1
    s_add_u32 s36, s36, 10240
    buffer_load_dwordx4 v[64:67], v13, s[28:31], s36 offen sc1
    s_add_u32 s36, s36, 10240
    buffer_load_dwordx4 v[68:71], v13, s[28:31], s36 offen sc1
    s_add_u32 s36, s36, 10240
    buffer_load_dwordx4 v[72:75], v13, s[28:31], s36 offen sc1
    s_add_u32 s36, s36, 10240
    buffer_load_dwordx4 v[76:79], v13, s[28:31], s36 offen sc1
    s_add_u32 s36, s36, 10240
    buffer_load_dwordx4 v[80:83], v13, s[28:31], s36 offen sc1
    s_add_u32 s36, s36, 10240
    buffer_load_dwordx4 v[84:87], v13, s[28:31], s36 offen sc1
    s_add_u32 s36, s36, 10240
    buffer_load_dwordx4 v[88:91], v13, s[28:31], s36 offen sc1
    s_add_u32 s36, s36, 10240
    buffer_load_dwordx4 v[92:95], v13, s[28:31], s36 offen sc1
    s_add_u32 s36, s36, 10240
    buffer_load_dwordx4 v[96:99], v13, s[28:31], s36 offen sc1
    s_add_u32 s36, s36, 10240
    buffer_load_dwordx4 v[100:103], v13, s[28:31], s36 offen sc1
    s_add_u32 s36, s36, 10240
    buffer_load_dwordx4 v[104:107], v13, s[28:31], s36 offen sc1
    s_add_u32 s36, s36, 10240
    buffer_load_dwordx4 v[108:111], v13, s[28:31], s36 offen sc1
    s_add_u32 s36, s36, 10240
    buffer_load_dwordx4 v[112:115], v13, s[28:31], s36 offen sc1
    s_add_u32 s36, s36, 10240
    buffer_load_dwordx4 v[116:119], v13, s[28:31], s36 offen sc1
    s_add_u32 s36, s36, 10240
    buffer_load_dwordx4 v[120:123], v13, s[28:31], s36 offen sc1
    s_add_u32 s36, s36, 10240
    s_waitcnt vmcnt(0)
    v_xor_b32 v4, s34, v17
    v_xor_b32 v5, s34, v19
    v_or_b32 v4, v4, v5
    v_xor_b32 v5, s34, v21
    v_or_b32 v4, v4, v5
    v_xor_b32 v5, s34, v23
    v_or_b32 v4, v4, v5
    v_xor_b32 v5, s34, v25
    v_or_b32 v4, v4, v5
    v_xor_b32 v5, s34, v27
    v_or_b32 v4, v4, v5
    v_xor_b32 v5, s34, v29
    v_or_b32 v4, v4, v5
    v_xor_b32 v5, s34, v31
    v_or_b32 v4, v4, v5
    v_xor_b32 v5, s34, v33
    v_or_b32 v4, v4, v5
    v_xor_b32 v5, s34, v35
    v_or_b32 v4, v4, v5
    v_xor_b32 v5, s34, v37
    v_or_b32 v4, v4, v5
    v_xor_b32 v5, s34, v39
    v_or_b32 v4, v4, v5
    v_xor_b32 v5, s34, v41
    v_or_b32 v4, v4, v5
    v_xor_b32 v5, s34, v43
    v_or_b32 v4, v4, v5
    v_xor_b32 v5, s34, v45
    v_or_b32 v4, v4, v5
    v_xor_b32 v5, s34, v47
    v_or_b32 v4, v4, v5
    v_xor_b32 v5, s34, v49
    v_or_b32 v4, v4, v5
    v_xor_b32 v5, s34, v51
    v_or_b32 v4, v4, v5
    v_xor_b32 v5, s34, v53
    v_or_b32 v4, v4, v5
    v_xor_b32 v5, s34, v55
    v_or_b32 v4, v4, v5
    v_xor_b32 v5, s34, v57
    v_or_b32 v4, v4, v5
    v_xor_b32 v5, s34, v59
    v_or_b32 v4, v4, v5
    v_xor_b32 v5, s34, v61
    v_or_b32 v4, v4, v5
    v_xor_b32 v5, s34, v63
    v_or_b32 v4, v4, v5
    v_xor_b32 v5, s34, v65
    v_or_b32 v4, v4, v5
    v_xor_b32 v5, s34, v67
    v_or_b32 v4, v4, v5
    v_xor_b32 v5, s34, v69
    v_or_b32 v4, v4, v5
    v_xor_b32 v5, s34, v71
    v_or_b32 v4, v4, v5
    v_xor_b32 v5, s34, v73
    v_or_b32 v4, v4, v5
    v_xor_b32 v5, s34, v75
    v_or_b32 v4, v4, v5
    v_xor_b32 v5, s34, v77
    v_or_b32 v4, v4, v5
    v_xor_b32 v5, s34, v79
    v_or_b32 v4, v4, v5
    v_xor_b32 v5, s34, v81
    v_or_b32 v4, v4, v5
    v_xor_b32 v5, s34, v83
    v_or_b32 v4, v4, v5
    v_xor_b32 v5, s34, v85
    v_or_b32 v4, v4, v5
    v_xor_b32 v5, s34, v87
    v_or_b32 v4, v4, v5
    v_xor_b32 v5, s34, v89
    v_or_b32 v4, v4, v5
    v_xor_b32 v5, s34, v91
    v_or_b32 v4, v4, v5
    v_xor_b32 v5, s34, v93
    v_or_b32 v4, v4, v5
    v_xor_b32 v5, s34, v95
    v_or_b32 v4, v4, v5
    v_xor_b32 v5, s34, v97
    v_or_b32 v4, v4, v5
    v_xor_b32 v5, s34, v99
    v_or_b32 v4, v4, v5
    v_xor_b32 v5, s34, v101
    v_or_b32 v4, v4, v5
    v_xor_b32 v5, s34, v103
    v_or_b32 v4, v4, v5
    v_xor_b32 v5, s34, v105
    v_or_b32 v4, v4, v5
    v_xor_b32 v5, s34, v107
    v_or_b32 v4, v4, v5
    v_xor_b32 v5, s34, v109
    v_or_b32 v4, v4, v5
    v_xor_b32 v5, s34, v111
    v_or_b32 v4, v4, v5
    v_xor_b32 v5, s34, v113
    v_or_b32 v4, v4, v5
    v_xor_b32 v5, s34, v115
    v_or_b32 v4, v4, v5
    v_xor_b32 v5, s34, v117
    v_or_b32 v4, v4, v5
    v_xor_b32 v5, s34, v119
    v_or_b32 v4, v4, v5
    v_xor_b32 v5, s34, v121
    v_or_b32 v4, v4, v5
    v_xor_b32 v5, s34, v123
    v_or_b32 v4, v4, v5
    v_cmp_ne_u32 vcc, 0, v4
    s_nop 0
    s_cmp_lg_u64 vcc, 0
    s_cbranch_scc1 Ly_poll
    v_add_f32 v16, v16, v20
    v_add_f32 v18, v18, v22
    v_add_f32 v16, v16, v24
    v_add_f32 v18, v18, v26
    v_add_f32 v16, v16, v28
    v_add_f32 v18, v18, v30
    v_add_f32 v16, v16, v32
    v_add_f32 v18, v18, v34
    v_add_f32 v16, v16, v36
    v_add_f32 v18, v18, v38
    v_add_f32 v16, v16, v40
    v_add_f32 v18, v18, v42
    v_add_f32 v16, v16, v44
    v_add_f32 v18, v18, v46
    v_add_f32 v16, v16, v48
    v_add_f32 v18, v18, v50
    v_add_f32 v16, v16, v52
    v_add_f32 v18, v18, v54
    v_add_f32 v16, v16, v56
    v_add_f32 v18, v18, v58
    v_add_f32 v16, v16, v60
    v_add_f32 v18, v18, v62
    v_add_f32 v16, v16, v64
    v_add_f32 v18, v18, v66
    v_add_f32 v16, v16, v68
    v_add_f32 v18, v18, v70
    v_add_f32 v16, v16, v72
    v_add_f32 v18, v18, v74
    v_add_f32 v16, v16, v76
    v_add_f32 v18, v18, v78
    v_add_f32 v16, v16, v80
    v_add_f32 v18, v18, v82
    v_add_f32 v16, v16, v84
    v_add_f32 v18, v18, v86
    v_add_f32 v16, v16, v88
    v_add_f32 v18, v18, v90
    v_add_f32 v16, v16, v92
    v_add_f32 v18, v18, v94
    v_add_f32 v16, v16, v96
    v_add_f32 v18, v18, v98
    v_add_f32 v16, v16, v100
    v_add_f32 v18, v18, v102
    v_add_f32 v16, v16, v104
    v_add_f32 v18, v18, v106
    v_add_f32 v16, v16, v108
    v_add_f32 v18, v18, v110
    v_add_f32 v16, v16, v112
    v_add_f32 v18, v18, v114
    v_add_f32 v16, v16, v116
    v_add_f32 v18, v18, v118
    v_add_f32 v16, v16, v120
    v_add_f32 v18, v18, v122
    s_lshr_b32 s36, s11, 16
    s_cmp_ge_u32 s36, 0x8000
    s_cselect_b32 s37, 0x8000, -1
    s_xor_b32 s36, s36, s37
    s_lshl_b32 s36, s36, 16
    v_mov_b32 v4, s36
    v_mul_f32 v4, 0xbfb8aa3b, v4
    v_exp_f32 v4, v4
    s_nop 0
    v_add_f32 v4, 1.0, v4
    v_rcp_f32 v4, v4
    s_nop 0
    v_cvt_pk_bf16_f32 v4, v4, v4
    v_lshlrev_b32 v4, 16, v4
    v_cvt_pk_bf16_f32 v16, v16, v16
    v_lshlrev_b32 v16, 16, v16
    v_mul_f32 v16, v16, v4
    v_cvt_pk_bf16_f32 v16, v16, v16
    v_lshlrev_b32 v16, 16, v16
    s_lshr_b32 s36, s12, 16
    s_cmp_ge_u32 s36, 0x8000
    s_cselect_b32 s37, 0x8000, -1
    s_xor_b32 s36, s36, s37
    s_lshl_b32 s36, s36, 16
    v_mov_b32 v4, s36
    v_mul_f32 v4, 0xbfb8aa3b, v4
    v_exp_f32 v4, v4
    s_nop 0
    v_add_f32 v4, 1.0, v4
    v_rcp_f32 v4, v4
    s_nop 0
    v_cvt_pk_bf16_f32 v4, v4, v4
    v_lshlrev_b32 v4, 16, v4
    v_cvt_pk_bf16_f32 v18, v18, v18
    v_lshlrev_b32 v18, 16, v18
    v_mul_f32 v18, v18, v4
    v_cvt_pk_bf16_f32 v18, v18, v18
    v_lshlrev_b32 v18, 16, v18
    s_mul_i32 s36, s32, 96
    s_sub_u32 s36, s13, s36
    s_max_i32 s36, s36, 0
    s_lshl_b32 s36, s36, 2
    s_add_u32 s36, s36, 156288
    v_mov_b32 v4, s36
    ds_read2st64_b32 v[4:5], v4 offset0:0 offset1:2
    v_lshlrev_b32 v124, 16, v124
    s_waitcnt lgkmcnt(0)
    v_add_f32 v20, v124, v4
    v_cvt_pk_bf16_f32 v20, v20, v20
    v_lshlrev_b32 v20, 16, v20
    v_mul_f32 v20, v20, v5
    v_cvt_pk_bf16_f32 v20, v20, v20
    v_lshlrev_b32 v20, 16, v20
    v_add_f32 v20, v20, v16
    v_cvt_pk_bf16_f32 v20, v20, v20
    v_lshlrev_b32 v20, 16, v20
    v_mul_f32 v16, 0xbfb8aa3b, v20
    v_exp_f32 v16, v16
    s_nop 0
    v_add_f32 v16, 1.0, v16
    v_rcp_f32 v16, v16
    s_nop 0
    v_mul_f32 v16, v16, v20
    v_cvt_pk_bf16_f32 v16, v16, v16
    v_lshlrev_b32 v16, 16, v16
    s_mul_i32 s36, s32, 96
    s_sub_u32 s36, s14, s36
    s_max_i32 s36, s36, 0
    s_lshl_b32 s36, s36, 2
    s_add_u32 s36, s36, 156288
    v_mov_b32 v4, s36
    ds_read2st64_b32 v[4:5], v4 offset0:0 offset1:2
    v_lshlrev_b32 v125, 16, v125
    s_waitcnt lgkmcnt(0)
    v_add_f32 v22, v125, v4
    v_cvt_pk_bf16_f32 v22, v22, v22
    v_lshlrev_b32 v22, 16, v22
    v_mul_f32 v22, v22, v5
    v_cvt_pk_bf16_f32 v22, v22, v22
    v_lshlrev_b32 v22, 16, v22
    v_add_f32 v22, v22, v18
    v_cvt_pk_bf16_f32 v22, v22, v22
    v_lshlrev_b32 v22, 16, v22
    v_mul_f32 v18, 0xbfb8aa3b, v22
    v_exp_f32 v18, v18
    s_nop 0
    v_add_f32 v18, 1.0, v18
    v_rcp_f32 v18, v18
    s_nop 0
    v_mul_f32 v18, v18, v22
    v_cvt_pk_bf16_f32 v18, v18, v18
    v_lshlrev_b32 v18, 16, v18
    v_add_u32 v5, 158208, v12
    ds_write2st64_b32 v5, v16, v18 offset0:0 offset1:1
    v_mov_b32 v6, 157956
    v_mov_b32 v7, 1
    s_mov_b64 exec, 1
    ds_add_u32 v6, v7
    s_mov_b64 exec, -1
Lw0_done:
    s_endpgm
Lagent:
    s_sub_u32 s44, s4, 4096
    s_subb_u32 s45, s5, 0
    s_mov_b32 s46, 2625536
    s_mov_b32 s47, 0x20000
    s_lshl_b32 s36, s32, 7
    s_add_u32 s36, s36, 8257536
    v_mov_b32 v69, s36
    s_branch Lbc_re
Lcomp:
    s_lshl_b32 s44, s26, 1
    s_add_u32 s44, s44, s27
    s_sub_u32 s36, s33, 5
    s_cmp_ge_u32 s33, 5
    s_cselect_b32 s40, s36, s33
    s_mov_b32 s41, 0xbfe10856
    s_cmp_eq_u32 s40, 1
    s_cselect_b32 s41, 0xaff80255, s41
    s_cmp_eq_u32 s40, 2
    s_cselect_b32 s41, 0xabfe4015, s41
    s_cmp_eq_u32 s40, 3
    s_cselect_b32 s41, 0xaa7fd005, s41
    s_cmp_eq_u32 s40, 4
    s_cselect_b32 s41, 0x6adfb401, s41
    s_lshl_b32 s37, s27, 13
    s_cmp_eq_u32 s44, 1
    s_cselect_b32 s37, 0, s37
    v_bfe_u32 v7, v1, 2, 2
    v_and_b32 v8, 3, v1
    v_lshl_add_u32 v18, v2, 3, v7
    v_lshlrev_b32 v18, 7, v18
    v_lshlrev_b32 v19, 2, v1
    v_and_b32 v19, 0x60, v19
    v_lshlrev_b32 v10, 1, v8
    v_add_u32 v9, s37, v18
    v_add_u32 v11, 0, v10
    v_bfe_u32 v11, s41, v11, 2
    v_lshl_add_u32 v11, v11, 2, v8
    v_lshlrev_b32 v11, 3, v11
    v_xad_u32 v20, v11, v19, v9
    v_add_u32 v11, 8, v10
    v_bfe_u32 v11, s41, v11, 2
    v_lshl_add_u32 v11, v11, 2, v8
    v_lshlrev_b32 v11, 3, v11
    v_xad_u32 v21, v11, v19, v9
    v_add_u32 v11, 16, v10
    v_bfe_u32 v11, s41, v11, 2
    v_lshl_add_u32 v11, v11, 2, v8
    v_lshlrev_b32 v11, 3, v11
    v_xad_u32 v22, v11, v19, v9
    v_add_u32 v11, 24, v10
    v_bfe_u32 v11, s41, v11, 2
    v_lshl_add_u32 v11, v11, 2, v8
    v_lshlrev_b32 v11, 3, v11
    v_xad_u32 v23, v11, v19, v9
    v_add_u32 v24, 78080, v20
    v_add_u32 v25, 78080, v21
    v_add_u32 v26, 78080, v22
    v_add_u32 v27, 78080, v23
    v_lshrrev_b32 v10, 1, v3
    v_xor_b32 v9, v10, v2
    v_lshlrev_b32 v9, 4, v9
    v_lshl_add_u32 v9, v3, 7, v9
    s_lshl_b32 s36, s44, 11
    s_xor_b32 s38, s36, 2048
    s_add_u32 s36, s36, 22528
    s_add_u32 s38, s38, 22528
    v_add_u32 v76, s36, v9
    v_add_u32 v78, s38, v9
    s_mul_i32 s39, s26, 6144
    s_add_u32 s39, s39, 98560
    v_add_u32 v125, s39, v13
    s_lshl_b32 s45, s44, 11
    s_add_u32 s45, s45, 139648
    s_waitcnt lgkmcnt(0)
    s_mov_b64 s[28:29], s[24:25]
    s_mov_b32 s30, 268435456
    s_mov_b32 s31, 0x20000
    s_load_dword s34, s[28:29], 0
    s_cmp_eq_u32 s44, 1
    s_cbranch_scc1 Lhalo
    v_xor_b32 v77, 64, v76
    v_xor_b32 v79, 64, v78
    v_add_u32 v80, 78080, v76
    v_add_u32 v81, 78080, v77
    v_add_u32 v82, 78080, v78
    v_add_u32 v83, 78080, v79
    s_cmp_eq_u32 s27, 0
    s_cselect_b64 vcc, 0, -1
    s_sub_u32 s37, 16384, s37
    v_cndmask_b32 v84, v20, v22, vcc
    v_cndmask_b32 v85, v21, v23, vcc
    v_add_u32 v84, s37, v84
    v_add_u32 v85, s37, v85
    v_add_u32 v86, 78080, v84
    v_add_u32 v87, 78080, v85
    v_lshrrev_b32 v8, 1, v2
    v_xor_b32 v8, v8, v10
    v_lshlrev_b32 v8, 4, v8
    v_lshl_add_u32 v8, v3, 7, v8
    v_and_b32 v7, 1, v2
    v_lshl_add_u32 v124, v7, 3, v8
    s_lshl_b32 s46, s42, 12
    s_mov_b32 s38, 0x87652310
    s_mov_b32 s39, 0x94
    s_cmp_eq_u32 s42, 1
    s_cselect_b32 s38, 0x87625310, s38
    s_cselect_b32 s39, 0x49, s39
    s_cmp_eq_u32 s42, 2
    s_cselect_b32 s38, 0x73654102, s38
    s_cselect_b32 s39, 0x98, s39
    s_cmp_eq_u32 s42, 3
    s_cselect_b32 s38, 0x76254301, s38
    s_cselect_b32 s39, 0x98, s39
    s_cmp_eq_u32 s42, 4
    s_cselect_b32 s38, 0x37546021, s38
    s_cselect_b32 s39, 0x98, s39
    s_sub_u32 s42, s33, s43
    s_cselect_b32 s43, 10, 0
    s_add_u32 s42, s42, s43
    s_lshl_b32 s42, s42, 2
    s_lshr_b64 s[38:39], s[38:39], s42
    s_and_b32 s42, s38, 15
    s_and_b32 s38, s42, 3
    s_mul_i32 s38, s38, 39040
    s_add_u32 s38, s38, s36
    v_add_u32 v4, s38, v124
    v_xor_b32 v5, 32, v4
    v_xor_b32 v6, 64, v4
    v_xor_b32 v7, 0x60, v4
    s_mov_b64 s[48:49], s[20:21]
    s_mov_b32 s50, 2621440
    s_mov_b32 s51, 0x20000
    v_mov_b32 v14, 0x3f803f80
    v_mov_b32 v15, 0x3f803f80
    v_mov_b32 v16, 0x3f803f80
    v_mov_b32 v17, 0x3f803f80
    s_mov_b32 s4, 0xaae00455
    s_cmp_eq_u32 s40, 1
    s_cselect_b32 s4, 0xaaf80155, s4
    s_cmp_eq_u32 s40, 2
    s_cselect_b32 s4, 0xaafe4055, s4
    s_cmp_eq_u32 s40, 3
    s_cselect_b32 s4, 0xaabfd055, s4
    s_cmp_eq_u32 s40, 4
    s_cselect_b32 s4, 0xaaeff455, s4
    v_lshlrev_b32 v10, 1, v2
    v_add_u32 v10, 8, v10
    v_bfe_u32 v10, s4, v10, 2
    v_cmp_eq_u32 s[6:7], 0, v10
    v_cmp_eq_u32 s[8:9], 3, v10
    v_cmp_eq_u32 s[10:11], 1, v10
    v_lshlrev_b32 v10, 1, v2
    v_add_u32 v10, 16, v10
    v_bfe_u32 v10, s4, v10, 2
    v_cmp_eq_u32 s[12:13], 0, v10
    v_cmp_eq_u32 s[14:15], 3, v10
    v_cmp_eq_u32 s[16:17], 2, v10
    s_mov_b32 s4, 0xaaaaaaaa
    s_mov_b32 s5, 0xaaaaaaaa
    s_mov_b32 s18, 0xfff0ffff
    s_mov_b32 s19, 0xf000ff00
    s_mov_b32 s20, 0xffc0fffc
    s_mov_b32 s21, 0xc000fc00
    v_mov_b32 v8, 0xffff
    v_not_b32 v9, v8
    v_cndmask_b32 v8, v8, v9, s[4:5]
    v_cndmask_b32 v118, 0, v8, s[18:19]
    v_cndmask_b32 v119, 0, v8, s[20:21]
    v_xor_b32 v116, v118, v8
    v_xor_b32 v117, v119, v8
    s_cmp_eq_u32 s32, 0
    s_cselect_b32 s36, s44, 0
    s_cmp_eq_u32 s36, 2
    s_cselect_b32 s22, 0xff800000, 0
    s_mul_i32 s36, s32, 6
    s_add_u32 s36, s36, s44
    s_sub_u32 s36, s36, 2
    s_lshl_b32 s24, s36, 7
    s_add_u32 s24, s24, 7340032
    s_mul_i32 s52, s36, 20480
    s_add_u32 s52, s52, 4194304
    s_lshl_b32 s36, s33, 11
    s_add_u32 s23, s36, s52
    s_add_u32 s53, s52, s46
    s_add_u32 s46, s46, 4096
    s_cmp_eq_u32 s46, 20480
    s_cselect_b32 s46, 0, s46
    s_add_u32 s54, s52, s46
    s_add_u32 s46, s46, 4096
    s_cmp_eq_u32 s46, 20480
    s_cselect_b32 s46, 0, s46
    s_add_u32 s55, s52, s46
    s_add_u32 s46, s46, 4096
    s_cmp_eq_u32 s46, 20480
    s_cselect_b32 s46, 0, s46
    s_add_u32 s56, s52, s46
    s_add_u32 s46, s46, 4096
    s_cmp_eq_u32 s46, 20480
    s_cselect_b32 s46, 0, s46
    s_add_u32 s57, s52, s46
    s_add_u32 s46, s46, 4096
    s_cmp_eq_u32 s46, 20480
    s_cselect_b32 s46, 0, s46
    s_mul_i32 s36, s32, 10
    s_add_u32 s36, s36, s33
    s_mul_i32 s58, s36, 6144
    s_lshl_b32 s36, s44, 10
    s_add_u32 s58, s58, s36
    s_add_u32 s58, s58, 1046528
    s_sub_u32 s59, s58, 6144
    s_add_u32 s60, s58, 6144
    s_cmp_eq_u32 s40, 0
    s_cselect_b32 s61, 0, -1
    s_cmp_eq_u32 s40, 4
    s_cselect_b32 s62, 0, -1
    s_lshl_b32 s36, s33, 2
    v_mov_b32 v97, s36
    s_mov_b32 s25, 0x3ea52b5c
    s_lshl_b32 s36, s44, 6
    s_add_u32 s36, s36, 156160
    v_lshl_add_u32 v94, v3, 2, s36
    v_and_b32 v8, 1, v1
    v_lshl_add_u32 v8, v2, 2, v8
    v_lshl_add_u32 v8, v8, 2, s36
    v_subrev_u32 v9, 64, v8
    v_cndmask_b32 v92, v9, v8, s[18:19]
    v_cndmask_b32 v93, v9, v8, s[20:21]
    v_lshlrev_b32 v95, 4, v2
    s_lshl_b32 s36, s27, 8
    s_add_u32 s36, s36, 157184
    v_add_u32 v95, s36, v95
    v_mov_b32 v96, 157968
    v_mov_b32 v100, -1
    v_mov_b32 v101, -1
    v_mov_b32 v102, -1
    v_mov_b32 v103, -1
    v_mov_b32 v127, 157984
    s_lshl_b32 s36, s3, 2
    s_add_u32 s36, s36, 158016
    v_mov_b32 v10, s36
    v_xor_b32 v11, 16, v10
    v_cndmask_b32 v127, v127, v11, s[4:5]
    s_waitcnt vmcnt(0)
    s_waitcnt lgkmcnt(0)
    s_barrier
    ds_read_b128 a[64:67], v76 offset:0
    ds_read_b128 a[68:71], v78 offset:0
    ds_read_b64_tr_b16 a[80:81], v20 offset:0
    ds_read_b64_tr_b16 a[82:83], v20 offset:512
    ds_read_b64_tr_b16 a[84:85], v21 offset:0
    ds_read_b64_tr_b16 a[86:87], v21 offset:512
    ds_read_b64_tr_b16 a[88:89], v22 offset:0
    ds_read_b64_tr_b16 a[90:91], v22 offset:512
    ds_read_b64_tr_b16 a[92:93], v23 offset:0
    ds_read_b64_tr_b16 a[94:95], v23 offset:512
    ds_read_b64_tr_b16 a[96:97], v84 offset:0
    ds_read_b64_tr_b16 a[98:99], v84 offset:512
    ds_read_b64_tr_b16 a[100:101], v85 offset:0
    ds_read_b64_tr_b16 a[102:103], v85 offset:512
    s_add_u32 s34, s34, 0x9e3779b8
    s_or_b32 s34, s34, 1
    s_cmp_eq_u32 s42, 0
    s_cbranch_scc1 Lxe0
Lxe0_b:
    s_setprio 1
    s_waitcnt lgkmcnt(10)
    v_mfma_f32_16x16x32_bf16 v[28:31], a[80:83], a[64:67], 0
    ds_read_b128 a[72:75], v77 offset:0
    ds_read_b128 a[76:79], v79 offset:0
    v_mfma_f32_16x16x32_bf16 v[44:47], a[80:83], a[68:71], 0
    ds_read_b64_tr_b16 a[104:105], v20 offset:4096
    s_waitcnt lgkmcnt(11)
    v_mfma_f32_16x16x32_bf16 v[32:35], a[84:87], a[64:67], 0
    ds_read_b64_tr_b16 a[106:107], v20 offset:4608
    v_mfma_f32_16x16x32_bf16 v[48:51], a[84:87], a[68:71], 0
    ds_read_b64_tr_b16 a[108:109], v21 offset:4096
    s_waitcnt lgkmcnt(11)
    v_mfma_f32_16x16x32_bf16 v[36:39], a[88:91], a[64:67], 0
    ds_read_b64_tr_b16 a[110:111], v21 offset:4608
    ds_read_b64_tr_b16 a[112:113], v22 offset:4096
    v_mfma_f32_16x16x32_bf16 v[52:55], a[88:91], a[68:71], 0
    ds_read_b64_tr_b16 a[114:115], v22 offset:4608
    s_setprio 0
    s_waitcnt lgkmcnt(12)
    v_mfma_f32_16x16x32_bf16 v[40:43], a[92:95], a[64:67], 0
    ds_read_b64_tr_b16 a[116:117], v23 offset:4096
    v_mfma_f32_16x16x32_bf16 v[56:59], a[92:95], a[68:71], 0
    ds_read_b64_tr_b16 a[118:119], v23 offset:4608
    s_waitcnt lgkmcnt(12)
    v_mfma_f32_16x16x32_bf16 v[60:63], a[64:67], a[96:99], 0
    ds_read_b64_tr_b16 a[120:121], v84 offset:4096
    v_mfma_f32_16x16x32_bf16 v[68:71], a[68:71], a[96:99], 0
    ds_read_b64_tr_b16 a[122:123], v84 offset:4608
    s_waitcnt lgkmcnt(12)
    v_mfma_f32_16x16x32_bf16 v[64:67], a[64:67], a[100:103], 0
    ds_read_b64_tr_b16 a[124:125], v85 offset:4096
    v_mfma_f32_16x16x32_bf16 v[72:75], a[68:71], a[100:103], 0
    ds_read_b64_tr_b16 a[126:127], v85 offset:4608
    s_barrier
    s_setprio 3
    s_waitcnt lgkmcnt(10)
    v_mfma_f32_16x16x32_bf16 v[28:31], a[104:107], a[72:75], v[28:31]
    ds_read_b128 a[64:67], v76 offset:39040
    ds_read_b128 a[68:71], v78 offset:39040
    v_mfma_f32_16x16x32_bf16 v[44:47], a[104:107], a[76:79], v[44:47]
    ds_read_b64_tr_b16 a[80:81], v20 offset:39040
    s_waitcnt lgkmcnt(11)
    v_mfma_f32_16x16x32_bf16 v[32:35], a[108:111], a[72:75], v[32:35]
    ds_read_b64_tr_b16 a[82:83], v20 offset:39552
    v_mfma_f32_16x16x32_bf16 v[48:51], a[108:111], a[76:79], v[48:51]
    ds_read_b64_tr_b16 a[84:85], v21 offset:39040
    s_waitcnt lgkmcnt(11)
    v_mfma_f32_16x16x32_bf16 v[36:39], a[112:115], a[72:75], v[36:39]
    ds_read_b64_tr_b16 a[86:87], v21 offset:39552
    v_mfma_f32_16x16x32_bf16 v[52:55], a[112:115], a[76:79], v[52:55]
    ds_read_b64_tr_b16 a[88:89], v22 offset:39040
    s_setprio 2
    s_waitcnt lgkmcnt(11)
    v_mfma_f32_16x16x32_bf16 v[40:43], a[116:119], a[72:75], v[40:43]
    ds_read_b64_tr_b16 a[90:91], v22 offset:39552
    ds_read_b64_tr_b16 a[92:93], v23 offset:39040
    v_mfma_f32_16x16x32_bf16 v[56:59], a[116:119], a[76:79], v[56:59]
    ds_read_b64_tr_b16 a[94:95], v23 offset:39552
    s_waitcnt lgkmcnt(12)
    v_mfma_f32_16x16x32_bf16 v[60:63], a[72:75], a[120:123], v[60:63]
    ds_read_b64_tr_b16 a[96:97], v84 offset:39040
    v_mfma_f32_16x16x32_bf16 v[68:71], a[76:79], a[120:123], v[68:71]
    ds_read_b64_tr_b16 a[98:99], v84 offset:39552
    s_waitcnt lgkmcnt(12)
    v_mfma_f32_16x16x32_bf16 v[64:67], a[72:75], a[124:127], v[64:67]
    ds_read_b64_tr_b16 a[100:101], v85 offset:39040
    v_mfma_f32_16x16x32_bf16 v[72:75], a[76:79], a[124:127], v[72:75]
    ds_read_b64_tr_b16 a[102:103], v85 offset:39552
    s_cmp_eq_u32 s42, 1
    s_cbranch_scc1 Lxe1
Lxe1_b:
    s_setprio 1
    s_waitcnt lgkmcnt(10)
    v_mfma_f32_16x16x32_bf16 v[28:31], a[80:83], a[64:67], v[28:31]
    ds_read_b128 a[72:75], v77 offset:39040
    ds_read_b128 a[76:79], v79 offset:39040
    v_mfma_f32_16x16x32_bf16 v[44:47], a[80:83], a[68:71], v[44:47]
    ds_read_b64_tr_b16 a[104:105], v20 offset:43136
    s_waitcnt lgkmcnt(11)
    v_mfma_f32_16x16x32_bf16 v[32:35], a[84:87], a[64:67], v[32:35]
    ds_read_b64_tr_b16 a[106:107], v20 offset:43648
    v_mfma_f32_16x16x32_bf16 v[48:51], a[84:87], a[68:71], v[48:51]
    ds_read_b64_tr_b16 a[108:109], v21 offset:43136
    s_waitcnt lgkmcnt(11)
    v_mfma_f32_16x16x32_bf16 v[36:39], a[88:91], a[64:67], v[36:39]
    ds_read_b64_tr_b16 a[110:111], v21 offset:43648
    ds_read_b64_tr_b16 a[112:113], v22 offset:43136
    v_mfma_f32_16x16x32_bf16 v[52:55], a[88:91], a[68:71], v[52:55]
    ds_read_b64_tr_b16 a[114:115], v22 offset:43648
    s_setprio 0
    s_waitcnt lgkmcnt(12)
    v_mfma_f32_16x16x32_bf16 v[40:43], a[92:95], a[64:67], v[40:43]
    ds_read_b64_tr_b16 a[116:117], v23 offset:43136
    v_mfma_f32_16x16x32_bf16 v[56:59], a[92:95], a[68:71], v[56:59]
    ds_read_b64_tr_b16 a[118:119], v23 offset:43648
    s_waitcnt lgkmcnt(12)
    v_mfma_f32_16x16x32_bf16 v[60:63], a[64:67], a[96:99], v[60:63]
    ds_read_b64_tr_b16 a[120:121], v84 offset:43136
    v_mfma_f32_16x16x32_bf16 v[68:71], a[68:71], a[96:99], v[68:71]
    ds_read_b64_tr_b16 a[122:123], v84 offset:43648
    s_waitcnt lgkmcnt(12)
    v_mfma_f32_16x16x32_bf16 v[64:67], a[64:67], a[100:103], v[64:67]
    ds_read_b64_tr_b16 a[124:125], v85 offset:43136
    v_mfma_f32_16x16x32_bf16 v[72:75], a[68:71], a[100:103], v[72:75]
    ds_read_b64_tr_b16 a[126:127], v85 offset:43648
    s_barrier
    s_setprio 3
    s_waitcnt lgkmcnt(10)
    v_mfma_f32_16x16x32_bf16 v[28:31], a[104:107], a[72:75], v[28:31]
    ds_read_b128 a[64:67], v80 offset:0
    ds_read_b128 a[68:71], v82 offset:0
    v_mfma_f32_16x16x32_bf16 v[44:47], a[104:107], a[76:79], v[44:47]
    ds_read_b64_tr_b16 a[80:81], v24 offset:0
    s_waitcnt lgkmcnt(11)
    v_mfma_f32_16x16x32_bf16 v[32:35], a[108:111], a[72:75], v[32:35]
    ds_read_b64_tr_b16 a[82:83], v24 offset:512
    v_mfma_f32_16x16x32_bf16 v[48:51], a[108:111], a[76:79], v[48:51]
    ds_read_b64_tr_b16 a[84:85], v25 offset:0
    s_waitcnt lgkmcnt(11)
    v_mfma_f32_16x16x32_bf16 v[36:39], a[112:115], a[72:75], v[36:39]
    ds_read_b64_tr_b16 a[86:87], v25 offset:512
    v_mfma_f32_16x16x32_bf16 v[52:55], a[112:115], a[76:79], v[52:55]
    ds_read_b64_tr_b16 a[88:89], v26 offset:0
    s_setprio 2
    s_waitcnt lgkmcnt(11)
    v_mfma_f32_16x16x32_bf16 v[40:43], a[116:119], a[72:75], v[40:43]
    ds_read_b64_tr_b16 a[90:91], v26 offset:512
    ds_read_b64_tr_b16 a[92:93], v27 offset:0
    v_mfma_f32_16x16x32_bf16 v[56:59], a[116:119], a[76:79], v[56:59]
    ds_read_b64_tr_b16 a[94:95], v27 offset:512
    s_waitcnt lgkmcnt(12)
    v_mfma_f32_16x16x32_bf16 v[60:63], a[72:75], a[120:123], v[60:63]
    ds_read_b64_tr_b16 a[96:97], v86 offset:0
    v_mfma_f32_16x16x32_bf16 v[68:71], a[76:79], a[120:123], v[68:71]
    ds_read_b64_tr_b16 a[98:99], v86 offset:512
    s_waitcnt lgkmcnt(12)
    v_mfma_f32_16x16x32_bf16 v[64:67], a[72:75], a[124:127], v[64:67]
    ds_read_b64_tr_b16 a[100:101], v87 offset:0
    v_mfma_f32_16x16x32_bf16 v[72:75], a[76:79], a[124:127], v[72:75]
    ds_read_b64_tr_b16 a[102:103], v87 offset:512
    buffer_store_dwordx4 v[100:103], v13, s[28:31], s58 offen sc1
    s_cmp_eq_u32 s42, 2
    s_cbranch_scc1 Lxe2
Lxe2_b:
    s_setprio 1
    s_waitcnt lgkmcnt(10)
    v_mfma_f32_16x16x32_bf16 v[28:31], a[80:83], a[64:67], v[28:31]
    ds_read_b128 a[72:75], v81 offset:0
    ds_read_b128 a[76:79], v83 offset:0
    v_mfma_f32_16x16x32_bf16 v[44:47], a[80:83], a[68:71], v[44:47]
    ds_read_b64_tr_b16 a[104:105], v24 offset:4096
    s_waitcnt lgkmcnt(11)
    v_mfma_f32_16x16x32_bf16 v[32:35], a[84:87], a[64:67], v[32:35]
    ds_read_b64_tr_b16 a[106:107], v24 offset:4608
    v_mfma_f32_16x16x32_bf16 v[48:51], a[84:87], a[68:71], v[48:51]
    ds_read_b64_tr_b16 a[108:109], v25 offset:4096
    s_waitcnt lgkmcnt(11)
    v_mfma_f32_16x16x32_bf16 v[36:39], a[88:91], a[64:67], v[36:39]
    ds_read_b64_tr_b16 a[110:111], v25 offset:4608
    ds_read_b64_tr_b16 a[112:113], v26 offset:4096
    v_mfma_f32_16x16x32_bf16 v[52:55], a[88:91], a[68:71], v[52:55]
    ds_read_b64_tr_b16 a[114:115], v26 offset:4608
    s_setprio 0
    s_waitcnt lgkmcnt(12)
    v_mfma_f32_16x16x32_bf16 v[40:43], a[92:95], a[64:67], v[40:43]
    ds_read_b64_tr_b16 a[116:117], v27 offset:4096
    v_mfma_f32_16x16x32_bf16 v[56:59], a[92:95], a[68:71], v[56:59]
    ds_read_b64_tr_b16 a[118:119], v27 offset:4608
    s_waitcnt lgkmcnt(12)
    v_mfma_f32_16x16x32_bf16 v[60:63], a[64:67], a[96:99], v[60:63]
    ds_read_b64_tr_b16 a[120:121], v86 offset:4096
    v_mfma_f32_16x16x32_bf16 v[68:71], a[68:71], a[96:99], v[68:71]
    ds_read_b64_tr_b16 a[122:123], v86 offset:4608
    s_waitcnt lgkmcnt(12)
    v_mfma_f32_16x16x32_bf16 v[64:67], a[64:67], a[100:103], v[64:67]
    ds_read_b64_tr_b16 a[124:125], v87 offset:4096
    v_mfma_f32_16x16x32_bf16 v[72:75], a[68:71], a[100:103], v[72:75]
    ds_read_b64_tr_b16 a[126:127], v87 offset:4608
    s_barrier
    s_setprio 3
    s_waitcnt lgkmcnt(10)
    v_mfma_f32_16x16x32_bf16 v[28:31], a[104:107], a[72:75], v[28:31]
    ds_read_b128 a[64:67], v80 offset:39040
    ds_read_b128 a[68:71], v82 offset:39040
    v_mfma_f32_16x16x32_bf16 v[44:47], a[104:107], a[76:79], v[44:47]
    ds_read_b64_tr_b16 a[80:81], v24 offset:39040
    s_waitcnt lgkmcnt(11)
    v_mfma_f32_16x16x32_bf16 v[32:35], a[108:111], a[72:75], v[32:35]
    ds_read_b64_tr_b16 a[82:83], v24 offset:39552
    v_mfma_f32_16x16x32_bf16 v[48:51], a[108:111], a[76:79], v[48:51]
    ds_read_b64_tr_b16 a[84:85], v25 offset:39040
    s_waitcnt lgkmcnt(11)
    v_mfma_f32_16x16x32_bf16 v[36:39], a[112:115], a[72:75], v[36:39]
    ds_read_b64_tr_b16 a[86:87], v25 offset:39552
    v_mfma_f32_16x16x32_bf16 v[52:55], a[112:115], a[76:79], v[52:55]
    ds_read_b64_tr_b16 a[88:89], v26 offset:39040
    s_setprio 2
    s_waitcnt lgkmcnt(11)
    v_mfma_f32_16x16x32_bf16 v[40:43], a[116:119], a[72:75], v[40:43]
    ds_read_b64_tr_b16 a[90:91], v26 offset:39552
    ds_read_b64_tr_b16 a[92:93], v27 offset:39040
    v_mfma_f32_16x16x32_bf16 v[56:59], a[116:119], a[76:79], v[56:59]
    ds_read_b64_tr_b16 a[94:95], v27 offset:39552
    s_waitcnt lgkmcnt(12)
    v_mfma_f32_16x16x32_bf16 v[60:63], a[72:75], a[120:123], v[60:63]
    ds_read_b64_tr_b16 a[96:97], v86 offset:39040
    v_mfma_f32_16x16x32_bf16 v[68:71], a[76:79], a[120:123], v[68:71]
    ds_read_b64_tr_b16 a[98:99], v86 offset:39552
    s_waitcnt lgkmcnt(12)
    v_mfma_f32_16x16x32_bf16 v[64:67], a[72:75], a[124:127], v[64:67]
    ds_read_b64_tr_b16 a[100:101], v87 offset:39040
    v_mfma_f32_16x16x32_bf16 v[72:75], a[76:79], a[124:127], v[72:75]
    ds_read_b64_tr_b16 a[102:103], v87 offset:39552
    s_cmp_eq_u32 s42, 3
    s_cbranch_scc1 Lxe3
Lxe3_b:
    s_setprio 1
    s_waitcnt lgkmcnt(10)
    v_mfma_f32_16x16x32_bf16 v[28:31], a[80:83], a[64:67], v[28:31]
    ds_read_b128 a[72:75], v81 offset:39040
    ds_read_b128 a[76:79], v83 offset:39040
    v_mfma_f32_16x16x32_bf16 v[44:47], a[80:83], a[68:71], v[44:47]
    ds_read_b64_tr_b16 a[104:105], v24 offset:43136
    s_waitcnt lgkmcnt(11)
    v_mfma_f32_16x16x32_bf16 v[32:35], a[84:87], a[64:67], v[32:35]
    ds_read_b64_tr_b16 a[106:107], v24 offset:43648
    v_mfma_f32_16x16x32_bf16 v[48:51], a[84:87], a[68:71], v[48:51]
    ds_read_b64_tr_b16 a[108:109], v25 offset:43136
    s_waitcnt lgkmcnt(11)
    v_mfma_f32_16x16x32_bf16 v[36:39], a[88:91], a[64:67], v[36:39]
    ds_read_b64_tr_b16 a[110:111], v25 offset:43648
    ds_read_b64_tr_b16 a[112:113], v26 offset:43136
    v_mfma_f32_16x16x32_bf16 v[52:55], a[88:91], a[68:71], v[52:55]
    ds_read_b64_tr_b16 a[114:115], v26 offset:43648
    s_setprio 0
    s_waitcnt lgkmcnt(12)
    v_mfma_f32_16x16x32_bf16 v[40:43], a[92:95], a[64:67], v[40:43]
    ds_read_b64_tr_b16 a[116:117], v27 offset:43136
    v_mfma_f32_16x16x32_bf16 v[56:59], a[92:95], a[68:71], v[56:59]
    ds_read_b64_tr_b16 a[118:119], v27 offset:43648
    s_waitcnt lgkmcnt(12)
    v_mfma_f32_16x16x32_bf16 v[60:63], a[64:67], a[96:99], v[60:63]
    ds_read_b64_tr_b16 a[120:121], v86 offset:43136
    v_mfma_f32_16x16x32_bf16 v[68:71], a[68:71], a[96:99], v[68:71]
    ds_read_b64_tr_b16 a[122:123], v86 offset:43648
    s_waitcnt lgkmcnt(12)
    v_mfma_f32_16x16x32_bf16 v[64:67], a[64:67], a[100:103], v[64:67]
    ds_read_b64_tr_b16 a[124:125], v87 offset:43136
    v_mfma_f32_16x16x32_bf16 v[72:75], a[68:71], a[100:103], v[72:75]
    ds_read_b64_tr_b16 a[126:127], v87 offset:43648
    s_barrier
    s_setprio 3
    s_waitcnt lgkmcnt(10)
    v_mfma_f32_16x16x32_bf16 v[28:31], a[104:107], a[72:75], v[28:31]
    ds_read_b128 a[64:67], v76 offset:0
    ds_read_b128 a[68:71], v78 offset:0
    v_mfma_f32_16x16x32_bf16 v[44:47], a[104:107], a[76:79], v[44:47]
    ds_read_b64_tr_b16 a[80:81], v20 offset:0
    s_waitcnt lgkmcnt(11)
    v_mfma_f32_16x16x32_bf16 v[32:35], a[108:111], a[72:75], v[32:35]
    ds_read_b64_tr_b16 a[82:83], v20 offset:512
    v_mfma_f32_16x16x32_bf16 v[48:51], a[108:111], a[76:79], v[48:51]
    ds_read_b64_tr_b16 a[84:85], v21 offset:0
    s_waitcnt lgkmcnt(11)
    v_mfma_f32_16x16x32_bf16 v[36:39], a[112:115], a[72:75], v[36:39]
    ds_read_b64_tr_b16 a[86:87], v21 offset:512
    v_mfma_f32_16x16x32_bf16 v[52:55], a[112:115], a[76:79], v[52:55]
    ds_read_b64_tr_b16 a[88:89], v22 offset:0
    s_setprio 2
    s_waitcnt lgkmcnt(11)
    v_mfma_f32_16x16x32_bf16 v[40:43], a[116:119], a[72:75], v[40:43]
    ds_read_b64_tr_b16 a[90:91], v22 offset:512
    ds_read_b64_tr_b16 a[92:93], v23 offset:0
    v_mfma_f32_16x16x32_bf16 v[56:59], a[116:119], a[76:79], v[56:59]
    ds_read_b64_tr_b16 a[94:95], v23 offset:512
    s_waitcnt lgkmcnt(12)
    v_mfma_f32_16x16x32_bf16 v[60:63], a[72:75], a[120:123], v[60:63]
    ds_read_b64_tr_b16 a[96:97], v84 offset:0
    v_mfma_f32_16x16x32_bf16 v[68:71], a[76:79], a[120:123], v[68:71]
    ds_read_b64_tr_b16 a[98:99], v84 offset:512
    s_waitcnt lgkmcnt(12)
    v_mfma_f32_16x16x32_bf16 v[64:67], a[72:75], a[124:127], v[64:67]
    ds_read_b64_tr_b16 a[100:101], v85 offset:0
    v_mfma_f32_16x16x32_bf16 v[72:75], a[76:79], a[124:127], v[72:75]
    ds_read_b64_tr_b16 a[102:103], v85 offset:512
    buffer_store_dwordx4 v[100:103], v13, s[28:31], s23 offen offset:0 sc1
    s_cmp_eq_u32 s42, 4
    s_cbranch_scc1 Lxe4
Lxe4_b:
    s_setprio 1
    s_waitcnt lgkmcnt(10)
    v_mfma_f32_16x16x32_bf16 v[28:31], a[80:83], a[64:67], v[28:31]
    ds_read_b128 a[72:75], v77 offset:0
    ds_read_b128 a[76:79], v79 offset:0
    v_mfma_f32_16x16x32_bf16 v[44:47], a[80:83], a[68:71], v[44:47]
    ds_read_b64_tr_b16 a[104:105], v20 offset:4096
    s_waitcnt lgkmcnt(11)
    v_mfma_f32_16x16x32_bf16 v[32:35], a[84:87], a[64:67], v[32:35]
    ds_read_b64_tr_b16 a[106:107], v20 offset:4608
    v_mfma_f32_16x16x32_bf16 v[48:51], a[84:87], a[68:71], v[48:51]
    ds_read_b64_tr_b16 a[108:109], v21 offset:4096
    s_waitcnt lgkmcnt(11)
    v_mfma_f32_16x16x32_bf16 v[36:39], a[88:91], a[64:67], v[36:39]
    ds_read_b64_tr_b16 a[110:111], v21 offset:4608
    ds_read_b64_tr_b16 a[112:113], v22 offset:4096
    v_mfma_f32_16x16x32_bf16 v[52:55], a[88:91], a[68:71], v[52:55]
    ds_read_b64_tr_b16 a[114:115], v22 offset:4608
    s_setprio 0
    s_waitcnt lgkmcnt(12)
    v_mfma_f32_16x16x32_bf16 v[40:43], a[92:95], a[64:67], v[40:43]
    ds_read_b64_tr_b16 a[116:117], v23 offset:4096
    v_mfma_f32_16x16x32_bf16 v[56:59], a[92:95], a[68:71], v[56:59]
    ds_read_b64_tr_b16 a[118:119], v23 offset:4608
    s_waitcnt lgkmcnt(12)
    v_mfma_f32_16x16x32_bf16 v[60:63], a[64:67], a[96:99], v[60:63]
    ds_read_b64_tr_b16 a[120:121], v84 offset:4096
    v_mfma_f32_16x16x32_bf16 v[68:71], a[68:71], a[96:99], v[68:71]
    ds_read_b64_tr_b16 a[122:123], v84 offset:4608
    s_waitcnt lgkmcnt(12)
    v_mfma_f32_16x16x32_bf16 v[64:67], a[64:67], a[100:103], v[64:67]
    ds_read_b64_tr_b16 a[124:125], v85 offset:4096
    v_mfma_f32_16x16x32_bf16 v[72:75], a[68:71], a[100:103], v[72:75]
    ds_read_b64_tr_b16 a[126:127], v85 offset:4608
    s_barrier
    s_setprio 3
    s_waitcnt lgkmcnt(10)
    v_mfma_f32_16x16x32_bf16 v[28:31], a[104:107], a[72:75], v[28:31]
    ds_read_b128 a[64:67], v76 offset:39040
    ds_read_b128 a[68:71], v78 offset:39040
    v_mfma_f32_16x16x32_bf16 v[44:47], a[104:107], a[76:79], v[44:47]
    ds_read_b64_tr_b16 a[80:81], v20 offset:39040
    s_waitcnt lgkmcnt(11)
    v_mfma_f32_16x16x32_bf16 v[32:35], a[108:111], a[72:75], v[32:35]
    ds_read_b64_tr_b16 a[82:83], v20 offset:39552
    v_mfma_f32_16x16x32_bf16 v[48:51], a[108:111], a[76:79], v[48:51]
    ds_read_b64_tr_b16 a[84:85], v21 offset:39040
    s_waitcnt lgkmcnt(11)
    v_mfma_f32_16x16x32_bf16 v[36:39], a[112:115], a[72:75], v[36:39]
    ds_read_b64_tr_b16 a[86:87], v21 offset:39552
    v_mfma_f32_16x16x32_bf16 v[52:55], a[112:115], a[76:79], v[52:55]
    ds_read_b64_tr_b16 a[88:89], v22 offset:39040
    s_setprio 2
    s_waitcnt lgkmcnt(11)
    v_mfma_f32_16x16x32_bf16 v[40:43], a[116:119], a[72:75], v[40:43]
    ds_read_b64_tr_b16 a[90:91], v22 offset:39552
    ds_read_b64_tr_b16 a[92:93], v23 offset:39040
    v_mfma_f32_16x16x32_bf16 v[56:59], a[116:119], a[76:79], v[56:59]
    ds_read_b64_tr_b16 a[94:95], v23 offset:39552
    s_waitcnt lgkmcnt(12)
    v_mfma_f32_16x16x32_bf16 v[60:63], a[72:75], a[120:123], v[60:63]
    ds_read_b64_tr_b16 a[96:97], v84 offset:39040
    v_mfma_f32_16x16x32_bf16 v[68:71], a[76:79], a[120:123], v[68:71]
    ds_read_b64_tr_b16 a[98:99], v84 offset:39552
    s_waitcnt lgkmcnt(12)
    v_mfma_f32_16x16x32_bf16 v[64:67], a[72:75], a[124:127], v[64:67]
    ds_read_b64_tr_b16 a[100:101], v85 offset:39040
    v_mfma_f32_16x16x32_bf16 v[72:75], a[76:79], a[124:127], v[72:75]
    ds_read_b64_tr_b16 a[102:103], v85 offset:39552
    s_cmp_eq_u32 s42, 5
    s_cbranch_scc1 Lxe5
Lxe5_b:
    s_setprio 1
    s_waitcnt lgkmcnt(10)
    v_mfma_f32_16x16x32_bf16 v[28:31], a[80:83], a[64:67], v[28:31]
    ds_read_b128 a[72:75], v77 offset:39040
    ds_read_b128 a[76:79], v79 offset:39040
    v_mfma_f32_16x16x32_bf16 v[44:47], a[80:83], a[68:71], v[44:47]
    ds_read_b64_tr_b16 a[104:105], v20 offset:43136
    s_waitcnt lgkmcnt(11)
    v_mfma_f32_16x16x32_bf16 v[32:35], a[84:87], a[64:67], v[32:35]
    ds_read_b64_tr_b16 a[106:107], v20 offset:43648
    v_mfma_f32_16x16x32_bf16 v[48:51], a[84:87], a[68:71], v[48:51]
    ds_read_b64_tr_b16 a[108:109], v21 offset:43136
    s_waitcnt lgkmcnt(11)
    v_mfma_f32_16x16x32_bf16 v[36:39], a[88:91], a[64:67], v[36:39]
    ds_read_b64_tr_b16 a[110:111], v21 offset:43648
    ds_read_b64_tr_b16 a[112:113], v22 offset:43136
    v_mfma_f32_16x16x32_bf16 v[52:55], a[88:91], a[68:71], v[52:55]
    ds_read_b64_tr_b16 a[114:115], v22 offset:43648
    s_setprio 0
    s_waitcnt lgkmcnt(12)
    v_mfma_f32_16x16x32_bf16 v[40:43], a[92:95], a[64:67], v[40:43]
    ds_read_b64_tr_b16 a[116:117], v23 offset:43136
    v_mfma_f32_16x16x32_bf16 v[56:59], a[92:95], a[68:71], v[56:59]
    ds_read_b64_tr_b16 a[118:119], v23 offset:43648
    s_waitcnt lgkmcnt(12)
    v_mfma_f32_16x16x32_bf16 v[60:63], a[64:67], a[96:99], v[60:63]
    ds_read_b64_tr_b16 a[120:121], v84 offset:43136
    v_mfma_f32_16x16x32_bf16 v[68:71], a[68:71], a[96:99], v[68:71]
    ds_read_b64_tr_b16 a[122:123], v84 offset:43648
    s_waitcnt lgkmcnt(12)
    v_mfma_f32_16x16x32_bf16 v[64:67], a[64:67], a[100:103], v[64:67]
    ds_read_b64_tr_b16 a[124:125], v85 offset:43136
    v_mfma_f32_16x16x32_bf16 v[72:75], a[68:71], a[100:103], v[72:75]
    ds_read_b64_tr_b16 a[126:127], v85 offset:43648
    s_barrier
    s_setprio 3
    s_waitcnt lgkmcnt(10)
    v_mfma_f32_16x16x32_bf16 v[28:31], a[104:107], a[72:75], v[28:31]
    ds_read_b128 a[0:3], v80 offset:0
    v_mfma_f32_16x16x32_bf16 v[44:47], a[104:107], a[76:79], v[44:47]
    ds_read_b128 a[4:7], v82 offset:0
    s_waitcnt lgkmcnt(10)
    v_mfma_f32_16x16x32_bf16 v[32:35], a[108:111], a[72:75], v[32:35]
    ds_read_b64_tr_b16 a[80:81], v24 offset:0
    v_mfma_f32_16x16x32_bf16 v[48:51], a[108:111], a[76:79], v[48:51]
    ds_read_b64_tr_b16 a[82:83], v24 offset:512
    s_waitcnt lgkmcnt(10)
    v_mfma_f32_16x16x32_bf16 v[36:39], a[112:115], a[72:75], v[36:39]
    ds_read_b64_tr_b16 a[84:85], v25 offset:0
    v_mfma_f32_16x16x32_bf16 v[52:55], a[112:115], a[76:79], v[52:55]
    s_setprio 2
    s_waitcnt lgkmcnt(9)
    v_mfma_f32_16x16x32_bf16 v[40:43], a[116:119], a[72:75], v[40:43]
    ds_read_b64_tr_b16 a[86:87], v25 offset:512
    v_mfma_f32_16x16x32_bf16 v[56:59], a[116:119], a[76:79], v[56:59]
    ds_read_b64_tr_b16 a[88:89], v26 offset:0
    s_waitcnt lgkmcnt(9)
    v_mfma_f32_16x16x32_bf16 v[60:63], a[72:75], a[120:123], v[60:63]
    ds_read_b64_tr_b16 a[90:91], v26 offset:512
    v_mfma_f32_16x16x32_bf16 v[68:71], a[76:79], a[120:123], v[68:71]
    ds_read_b64_tr_b16 a[92:93], v27 offset:0
    s_waitcnt lgkmcnt(9)
    v_mfma_f32_16x16x32_bf16 v[64:67], a[72:75], a[124:127], v[64:67]
    ds_read_b64_tr_b16 a[94:95], v27 offset:512
    v_mfma_f32_16x16x32_bf16 v[72:75], a[76:79], a[124:127], v[72:75]
    buffer_store_dwordx4 v[100:103], v13, s[28:31], s23 offen offset:1024 sc1
    s_cmp_eq_u32 s42, 6
    s_cbranch_scc1 Lxe6
Lxe6_b:
    s_setprio 1
    s_waitcnt lgkmcnt(6)
    v_mfma_f32_16x16x32_bf16 v[28:31], a[80:83], a[0:3], v[28:31]
    ds_read_b128 a[8:11], v81 offset:0
    ds_read_b128 a[12:15], v83 offset:0
    v_mfma_f32_16x16x32_bf16 v[44:47], a[80:83], a[4:7], v[44:47]
    ds_read_b64_tr_b16 a[104:105], v24 offset:4096
    s_waitcnt lgkmcnt(7)
    v_mfma_f32_16x16x32_bf16 v[32:35], a[84:87], a[0:3], v[32:35]
    ds_read_b64_tr_b16 a[106:107], v24 offset:4608
    ds_read_b64_tr_b16 a[108:109], v25 offset:4096
    v_mfma_f32_16x16x32_bf16 v[48:51], a[84:87], a[4:7], v[48:51]
    ds_read_b64_tr_b16 a[110:111], v25 offset:4608
    s_setprio 0
    s_waitcnt lgkmcnt(8)
    v_mfma_f32_16x16x32_bf16 v[36:39], a[88:91], a[0:3], v[36:39]
    v_mfma_f32_16x16x32_bf16 v[52:55], a[88:91], a[4:7], v[52:55]
    ds_read_b64_tr_b16 a[112:113], v26 offset:4096
    ds_read_b64_tr_b16 a[114:115], v26 offset:4608
    s_waitcnt lgkmcnt(8)
    v_mfma_f32_16x16x32_bf16 v[40:43], a[92:95], a[0:3], v[40:43]
    ds_read_b64_tr_b16 a[116:117], v27 offset:4096
    v_mfma_f32_16x16x32_bf16 v[56:59], a[92:95], a[4:7], v[56:59]
    ds_read_b64_tr_b16 a[118:119], v27 offset:4608
    s_barrier
    s_setprio 3
    s_waitcnt lgkmcnt(6)
    v_mfma_f32_16x16x32_bf16 v[28:31], a[104:107], a[8:11], v[28:31]
    ds_read_b128 a[16:19], v80 offset:39040
    ds_read_b128 a[20:23], v82 offset:39040
    v_mfma_f32_16x16x32_bf16 v[44:47], a[104:107], a[12:15], v[44:47]
    ds_read_b64_tr_b16 a[80:81], v24 offset:39040
    s_waitcnt lgkmcnt(7)
    v_mfma_f32_16x16x32_bf16 v[32:35], a[108:111], a[8:11], v[32:35]
    ds_read_b64_tr_b16 a[82:83], v24 offset:39552
    v_mfma_f32_16x16x32_bf16 v[48:51], a[108:111], a[12:15], v[48:51]
    ds_read_b64_tr_b16 a[84:85], v25 offset:39040
    s_setprio 2
    s_waitcnt lgkmcnt(7)
    v_mfma_f32_16x16x32_bf16 v[36:39], a[112:115], a[8:11], v[36:39]
    ds_read_b64_tr_b16 a[86:87], v25 offset:39552
    ds_read_b64_tr_b16 a[88:89], v26 offset:39040
    v_mfma_f32_16x16x32_bf16 v[52:55], a[112:115], a[12:15], v[52:55]
    ds_read_b64_tr_b16 a[90:91], v26 offset:39552
    s_waitcnt lgkmcnt(8)
    v_mfma_f32_16x16x32_bf16 v[40:43], a[116:119], a[8:11], v[40:43]
    ds_read_b64_tr_b16 a[92:93], v27 offset:39040
    v_mfma_f32_16x16x32_bf16 v[56:59], a[116:119], a[12:15], v[56:59]
    ds_read_b64_tr_b16 a[94:95], v27 offset:39552
    s_cmp_eq_u32 s42, 7
    s_cbranch_scc1 Lxe7
Lxe7_b:
    s_setprio 1
    s_waitcnt lgkmcnt(6)
    v_mfma_f32_16x16x32_bf16 v[28:31], a[80:83], a[16:19], v[28:31]
    ds_read_b128 a[24:27], v81 offset:39040
    ds_read_b128 a[28:31], v83 offset:39040
    v_mfma_f32_16x16x32_bf16 v[44:47], a[80:83], a[20:23], v[44:47]
    ds_read_b64_tr_b16 a[104:105], v24 offset:43136
    s_waitcnt lgkmcnt(7)
    v_mfma_f32_16x16x32_bf16 v[32:35], a[84:87], a[16:19], v[32:35]
    ds_read_b64_tr_b16 a[106:107], v24 offset:43648
    ds_read_b64_tr_b16 a[108:109], v25 offset:43136
    v_mfma_f32_16x16x32_bf16 v[48:51], a[84:87], a[20:23], v[48:51]
    ds_read_b64_tr_b16 a[110:111], v25 offset:43648
    s_setprio 0
    s_waitcnt lgkmcnt(8)
    v_mfma_f32_16x16x32_bf16 v[36:39], a[88:91], a[16:19], v[36:39]
    v_mfma_f32_16x16x32_bf16 v[52:55], a[88:91], a[20:23], v[52:55]
    ds_read_b64_tr_b16 a[112:113], v26 offset:43136
    ds_read_b64_tr_b16 a[114:115], v26 offset:43648
    s_waitcnt lgkmcnt(8)
    v_mfma_f32_16x16x32_bf16 v[40:43], a[92:95], a[16:19], v[40:43]
    ds_read_b64_tr_b16 a[116:117], v27 offset:43136
    v_mfma_f32_16x16x32_bf16 v[56:59], a[92:95], a[20:23], v[56:59]
    ds_read_b64_tr_b16 a[118:119], v27 offset:43648
    s_barrier
    s_setprio 3
    s_waitcnt lgkmcnt(6)
    v_mfma_f32_16x16x32_bf16 v[28:31], a[104:107], a[24:27], v[28:31]
    ds_read_b128 a[32:35], v76 offset:0
    ds_read_b128 a[36:39], v78 offset:0
    v_mfma_f32_16x16x32_bf16 v[44:47], a[104:107], a[28:31], v[44:47]
    ds_read_b64_tr_b16 a[80:81], v20 offset:0
    s_waitcnt lgkmcnt(7)
    v_mfma_f32_16x16x32_bf16 v[32:35], a[108:111], a[24:27], v[32:35]
    ds_read_b64_tr_b16 a[82:83], v20 offset:512
    v_mfma_f32_16x16x32_bf16 v[48:51], a[108:111], a[28:31], v[48:51]
    ds_read_b64_tr_b16 a[84:85], v21 offset:0
    s_setprio 2
    s_waitcnt lgkmcnt(7)
    v_mfma_f32_16x16x32_bf16 v[36:39], a[112:115], a[24:27], v[36:39]
    ds_read_b64_tr_b16 a[86:87], v21 offset:512
    ds_read_b64_tr_b16 a[88:89], v22 offset:0
    v_mfma_f32_16x16x32_bf16 v[52:55], a[112:115], a[28:31], v[52:55]
    ds_read_b64_tr_b16 a[90:91], v22 offset:512
    s_waitcnt lgkmcnt(8)
    v_mfma_f32_16x16x32_bf16 v[40:43], a[116:119], a[24:27], v[40:43]
    ds_read_b64_tr_b16 a[92:93], v23 offset:0
    v_mfma_f32_16x16x32_bf16 v[56:59], a[116:119], a[28:31], v[56:59]
    ds_read_b64_tr_b16 a[94:95], v23 offset:512
    s_cmp_eq_u32 s42, 8
    s_cbranch_scc1 Lxe8
Lxe8_b:
    s_setprio 1
    s_waitcnt lgkmcnt(6)
    v_mfma_f32_16x16x32_bf16 v[28:31], a[80:83], a[32:35], v[28:31]
    ds_read_b128 a[40:43], v77 offset:0
    ds_read_b128 a[44:47], v79 offset:0
    v_mfma_f32_16x16x32_bf16 v[44:47], a[80:83], a[36:39], v[44:47]
    ds_read_b64_tr_b16 a[104:105], v20 offset:4096
    s_waitcnt lgkmcnt(7)
    v_mfma_f32_16x16x32_bf16 v[32:35], a[84:87], a[32:35], v[32:35]
    ds_read_b64_tr_b16 a[106:107], v20 offset:4608
    v_mfma_f32_16x16x32_bf16 v[48:51], a[84:87], a[36:39], v[48:51]
    ds_read_b64_tr_b16 a[108:109], v21 offset:4096
    s_setprio 0
    s_waitcnt lgkmcnt(7)
    v_mfma_f32_16x16x32_bf16 v[36:39], a[88:91], a[32:35], v[36:39]
    ds_read_b64_tr_b16 a[110:111], v21 offset:4608
    ds_read_b64_tr_b16 a[112:113], v22 offset:4096
    v_mfma_f32_16x16x32_bf16 v[52:55], a[88:91], a[36:39], v[52:55]
    ds_read_b64_tr_b16 a[114:115], v22 offset:4608
    s_waitcnt lgkmcnt(8)
    v_mfma_f32_16x16x32_bf16 v[40:43], a[92:95], a[32:35], v[40:43]
    ds_read_b64_tr_b16 a[116:117], v23 offset:4096
    v_mfma_f32_16x16x32_bf16 v[56:59], a[92:95], a[36:39], v[56:59]
    ds_read_b64_tr_b16 a[118:119], v23 offset:4608
    s_waitcnt lgkmcnt(0)
    s_barrier
    s_setprio 3
    v_mfma_f32_16x16x32_bf16 v[28:31], a[104:107], a[40:43], v[28:31]
    ds_read_b128 a[48:51], v76 offset:39040
    ds_read_b128 a[52:55], v78 offset:39040
    v_mfma_f32_16x16x32_bf16 v[44:47], a[104:107], a[44:47], v[44:47]
    ds_read_b64_tr_b16 a[80:81], v20 offset:39040
    v_mfma_f32_16x16x32_bf16 v[32:35], a[108:111], a[40:43], v[32:35]
    ds_read_b64_tr_b16 a[82:83], v20 offset:39552
    v_mfma_f32_16x16x32_bf16 v[48:51], a[108:111], a[44:47], v[48:51]
    ds_read_b64_tr_b16 a[84:85], v21 offset:39040
    s_setprio 2
    v_mfma_f32_16x16x32_bf16 v[36:39], a[112:115], a[40:43], v[36:39]
    ds_read_b64_tr_b16 a[86:87], v21 offset:39552
    ds_read_b64_tr_b16 a[88:89], v22 offset:39040
    v_mfma_f32_16x16x32_bf16 v[52:55], a[112:115], a[44:47], v[52:55]
    ds_read_b64_tr_b16 a[90:91], v22 offset:39552
    v_mfma_f32_16x16x32_bf16 v[40:43], a[116:119], a[40:43], v[40:43]
    ds_read_b64_tr_b16 a[92:93], v23 offset:39040
    v_mfma_f32_16x16x32_bf16 v[56:59], a[116:119], a[44:47], v[56:59]
    ds_read_b64_tr_b16 a[94:95], v23 offset:39552
    v_mov_b32 v98, s34
    s_waitcnt vmcnt(0)
    s_mov_b64 exec, 1
    buffer_store_dword v98, v97, s[28:31], s24 offen sc1
    s_mov_b64 exec, -1
    s_cmp_eq_u32 s42, 9
    s_cbranch_scc1 Lxe9
Lxe9_b:
    s_setprio 1
    s_waitcnt lgkmcnt(6)
    v_mfma_f32_16x16x32_bf16 v[28:31], a[80:83], a[48:51], v[28:31]
    ds_read_b128 a[56:59], v77 offset:39040
    ds_read_b128 a[60:63], v79 offset:39040
    ds_read_b64_tr_b16 a[104:105], v20 offset:43136
    v_mfma_f32_16x16x32_bf16 v[44:47], a[80:83], a[52:55], v[44:47]
    ds_read_b64_tr_b16 a[106:107], v20 offset:43648
    ds_read_b64_tr_b16 a[108:109], v21 offset:43136
    s_waitcnt lgkmcnt(9)
    v_mfma_f32_16x16x32_bf16 v[32:35], a[84:87], a[48:51], v[32:35]
    ds_read_b64_tr_b16 a[110:111], v21 offset:43648
    ds_read_b64_tr_b16 a[112:113], v22 offset:43136
    ds_read_b64_tr_b16 a[114:115], v22 offset:43648
    v_mfma_f32_16x16x32_bf16 v[48:51], a[84:87], a[52:55], v[48:51]
    ds_read_b64_tr_b16 a[116:117], v23 offset:43136
    ds_read_b64_tr_b16 a[118:119], v23 offset:43648
    s_setprio 0
    s_waitcnt lgkmcnt(12)
    v_mfma_f32_16x16x32_bf16 v[36:39], a[88:91], a[48:51], v[36:39]
    ds_read_b32 v120, v94
    ds_read_b32 v121, v94 offset:512
    v_xor_b32 v94, 64, v94
    v_mfma_f32_16x16x32_bf16 v[52:55], a[88:91], a[52:55], v[52:55]
    ds_read_b32 v122, v94
    ds_read_b32 v123, v92 offset:512
    s_waitcnt lgkmcnt(14)
    v_mfma_f32_16x16x32_bf16 v[40:43], a[92:95], a[48:51], v[40:43]
    ds_read_b32 v126, v93 offset:520
    v_mov_b32 v24, v84
    v_mov_b32 v25, v85
    v_mfma_f32_16x16x32_bf16 v[56:59], a[92:95], a[52:55], v[56:59]
    v_mov_b32 v26, v86
    v_mov_b32 v27, v87
    s_waitcnt lgkmcnt(5)
    v_mfma_f32_16x16x32_bf16 v[44:47], a[104:107], a[60:63], v[44:47]
    v_mfma_f32_16x16x32_bf16 v[48:51], a[108:111], a[60:63], v[48:51]
    v_mfma_f32_16x16x32_bf16 v[52:55], a[112:115], a[60:63], v[52:55]
    v_mfma_f32_16x16x32_bf16 v[56:59], a[116:119], a[60:63], v[56:59]
    v_mfma_f32_16x16x32_bf16 v[28:31], a[104:107], a[56:59], v[28:31]
    v_mfma_f32_16x16x32_bf16 v[32:35], a[108:111], a[56:59], v[32:35]
    ds_read_b32 v7, v96
    ds_read_b128 v[76:79], v95 offset:0
    ds_read_b128 v[80:83], v95 offset:64
    ds_read_b128 v[84:87], v95 offset:128
    ds_read_b128 v[88:91], v95 offset:192
    v_mfma_f32_16x16x32_bf16 v[36:39], a[112:115], a[56:59], v[36:39]
    v_mfma_f32_16x16x32_bf16 v[40:43], a[116:119], a[56:59], v[40:43]
    s_waitcnt lgkmcnt(0)
Lqf:
    v_readfirstlane_b32 s38, v7
    s_nop 0
    s_cmp_eq_u32 s38, 0
    s_cbranch_scc1 Lqf_re
    s_cmp_eq_u32 s27, 0
    v_fmac_f32 v44, v76, v122
    v_fmac_f32 v45, v77, v122
    v_fmac_f32 v46, v78, v122
    v_fmac_f32 v47, v79, v122
    v_cvt_pk_bf16_f32 v44, v44, v45
    v_cvt_pk_bf16_f32 v45, v46, v47
    v_fmac_f32 v48, v80, v122
    v_fmac_f32 v49, v81, v122
    v_fmac_f32 v50, v82, v122
    v_fmac_f32 v51, v83, v122
    v_cvt_pk_bf16_f32 v46, v48, v49
    v_cvt_pk_bf16_f32 v47, v50, v51
    v_fmac_f32 v52, v84, v122
    v_fmac_f32 v53, v85, v122
    v_fmac_f32 v54, v86, v122
    v_fmac_f32 v55, v87, v122
    v_cvt_pk_bf16_f32 v48, v52, v53
    v_cvt_pk_bf16_f32 v49, v54, v55
    v_fmac_f32 v56, v88, v122
    v_fmac_f32 v57, v89, v122
    v_fmac_f32 v58, v90, v122
    v_fmac_f32 v59, v91, v122
    v_cvt_pk_bf16_f32 v50, v56, v57
    v_cvt_pk_bf16_f32 v51, v58, v59
    s_cbranch_scc1 Lh1
    s_setprio 3
    ds_write_b128 v125, v[44:47] offset:2048
    ds_write_b128 v125, v[48:51] offset:3072
    v_fmac_f32 v28, v76, v120
    v_fmac_f32 v29, v77, v120
    v_fmac_f32 v30, v78, v120
    v_fmac_f32 v31, v79, v120
    v_cvt_pk_bf16_f32 v52, v28, v29
    v_cvt_pk_bf16_f32 v53, v30, v31
    v_fmac_f32 v32, v80, v120
    v_fmac_f32 v33, v81, v120
    v_fmac_f32 v34, v82, v120
    v_fmac_f32 v35, v83, v120
    v_cvt_pk_bf16_f32 v54, v32, v33
    v_cvt_pk_bf16_f32 v55, v34, v35
    v_fmac_f32 v36, v84, v120
    v_fmac_f32 v37, v85, v120
    v_fmac_f32 v38, v86, v120
    v_fmac_f32 v39, v87, v120
    v_cvt_pk_bf16_f32 v56, v36, v37
    v_cvt_pk_bf16_f32 v57, v38, v39
    v_fmac_f32 v40, v88, v120
    v_fmac_f32 v41, v89, v120
    v_fmac_f32 v42, v90, v120
    v_fmac_f32 v43, v91, v120
    v_cvt_pk_bf16_f32 v58, v40, v41
    v_cvt_pk_bf16_f32 v59, v42, v43
    ds_write_b128 v125, v[52:55] offset:4096
    ds_write_b128 v125, v[56:59] offset:5120
    v_mov_b32 v5, 157972
    v_mov_b32 v6, 1
    s_mov_b64 exec, 1
    ds_add_u32 v5, v6
    s_mov_b64 exec, -1
    v_mov_b32 v8, s22
    v_mov_b32 v9, s22
    v_mov_b32 v10, s22
    v_mov_b32 v11, s22
Lcw_1:
    s_sub_u32 s35, s35, 1
    s_cbranch_scc1 Lend
    ds_read_b32 v6, v5
    s_waitcnt lgkmcnt(0)
    v_readfirstlane_b32 s38, v6
    s_nop 0
    s_cmp_lt_u32 s38, 8
    s_cbranch_scc1 Lcw_1
    ds_read_b128 v[28:31], v125 offset:0
    ds_read_b128 v[32:35], v125 offset:1024
Lh_join:
    buffer_load_dword v20, v12, s[28:31], s24 offen sc1
    ds_read_b64_tr_b16 a[64:65], v26 offset:0
    ds_read_b64_tr_b16 a[66:67], v26 offset:512
    ds_read_b64_tr_b16 a[68:69], v27 offset:0
    ds_read_b64_tr_b16 a[70:71], v27 offset:512
    ds_read_b64_tr_b16 a[72:73], v26 offset:4096
    ds_read_b64_tr_b16 a[74:75], v26 offset:4608
    ds_read_b64_tr_b16 a[76:77], v27 offset:4096
    ds_read_b64_tr_b16 a[78:79], v27 offset:4608
    s_waitcnt lgkmcnt(8)
    s_setprio 3
    v_cndmask_b32 v92, 0, v30, s[6:7]
    v_cndmask_b32 v93, 0, v31, s[6:7]
    v_cndmask_b32 v94, 0, v32, s[12:13]
    v_cndmask_b32 v95, 0, v33, s[12:13]
    v_cndmask_b32 v104, 0, v30, s[8:9]
    v_cndmask_b32 v105, 0, v31, s[8:9]
    v_mfma_f32_16x16x32_bf16 v[76:79], v[46:49], v[92:95], v[8:11]
    v_mfma_f32_16x16x32_bf16 v[80:83], v[54:57], v[92:95], 0
    v_cndmask_b32 v106, 0, v32, s[14:15]
    v_cndmask_b32 v107, 0, v33, s[14:15]
    v_mov_b32 v96, v28
    v_mov_b32 v97, v29
    v_mfma_f32_16x16x32_bf16 v[84:87], v[46:49], v[104:107], v[8:11]
    v_mfma_f32_16x16x32_bf16 v[88:91], v[54:57], v[104:107], 0
    v_cndmask_b32 v98, 0, v30, s[10:11]
    v_cndmask_b32 v99, 0, v31, s[10:11]
    v_cndmask_b32 v100, 0, v32, s[16:17]
    v_cndmask_b32 v101, 0, v33, s[16:17]
    v_mfma_f32_16x16x32_bf16 v[36:39], v[44:47], v[96:99], v[8:11]
    v_mfma_f32_16x16x32_bf16 v[40:43], v[52:55], v[96:99], 0
    v_cndmask_b32 v76, v76, v77, s[4:5]
    v_cndmask_b32 v80, v80, v81, s[4:5]
    v_cndmask_b32 v78, v78, v79, s[4:5]
    v_cndmask_b32 v82, v82, v83, s[4:5]
    v_cndmask_b32 v92, v76, v80, s[18:19]
    v_cndmask_b32 v94, v78, v82, s[20:21]
    v_min_u32 v4, -2, v92
    v_min_u32 v5, -2, v94
    v_cndmask_b32 v84, v84, v85, s[4:5]
    v_cndmask_b32 v88, v88, v89, s[4:5]
    v_cndmask_b32 v86, v86, v87, s[4:5]
    v_cndmask_b32 v90, v90, v91, s[4:5]
    v_cndmask_b32 v104, v84, v88, s[18:19]
    v_cndmask_b32 v106, v86, v90, s[20:21]
    v_min_u32 v6, -2, v104
    v_min_u32 v7, -2, v106
    buffer_store_dwordx4 v[4:7], v13, s[28:31], s58 offen sc1
    s_setprio 2
    ds_read_b64_tr_b16 a[80:81], v26 offset:39040
    ds_read_b64_tr_b16 a[82:83], v26 offset:39552
    ds_read_b64_tr_b16 a[84:85], v27 offset:39040
    ds_read_b64_tr_b16 a[86:87], v27 offset:39552
    ds_read_b64_tr_b16 a[88:89], v26 offset:43136
    ds_read_b64_tr_b16 a[90:91], v26 offset:43648
    ds_read_b64_tr_b16 a[92:93], v27 offset:43136
    ds_read_b64_tr_b16 a[94:95], v27 offset:43648
    ds_read_b64_tr_b16 a[96:97], v24 offset:0
    ds_read_b64_tr_b16 a[98:99], v24 offset:512
    ds_read_b64_tr_b16 a[100:101], v25 offset:0
    ds_read_b64_tr_b16 a[102:103], v25 offset:512
    ds_read_b64_tr_b16 a[104:105], v24 offset:4096
    ds_read_b64_tr_b16 a[106:107], v24 offset:4608
    ds_read_b64_tr_b16 a[108:109], v25 offset:4096
    ds_read_b64_tr_b16 a[110:111], v25 offset:4608
    ds_read_b64_tr_b16 a[112:113], v24 offset:39040
    ds_read_b64_tr_b16 a[114:115], v24 offset:39552
    ds_read_b64_tr_b16 a[116:117], v25 offset:39040
    ds_read_b64_tr_b16 a[118:119], v25 offset:39552
    ds_read_b64_tr_b16 a[120:121], v24 offset:43136
    ds_read_b64_tr_b16 a[122:123], v24 offset:43648
    ds_read_b64_tr_b16 a[124:125], v25 offset:43136
    ds_read_b64_tr_b16 a[126:127], v25 offset:43648
    s_waitcnt lgkmcnt(15)
    v_mfma_f32_16x16x32_bf16 v[60:63], a[0:3], a[64:67], v[60:63]
    v_mov_b32 v102, v34
    v_mov_b32 v103, v35
    v_mul_f32 v4, s25, v121
    v_mfma_f32_16x16x32_bf16 v[68:71], a[4:7], a[64:67], v[68:71]
    v_mfma_f32_16x16x32_bf16 v[76:79], v[48:51], v[100:103], v[8:11]
    v_mfma_f32_16x16x32_bf16 v[80:83], v[56:59], v[100:103], 0
    v_mul_f32 v123, v123, v4
    v_mfma_f32_16x16x32_bf16 v[64:67], a[0:3], a[68:71], v[64:67]
    v_mul_f32 v126, v126, v4
    v_cndmask_b32 v36, v36, v37, s[4:5]
    v_cndmask_b32 v40, v40, v41, s[4:5]
    v_mfma_f32_16x16x32_bf16 v[72:75], a[4:7], a[68:71], v[72:75]
    v_cndmask_b32 v38, v38, v39, s[4:5]
    v_cndmask_b32 v42, v42, v43, s[4:5]
    v_cndmask_b32 v96, v36, v40, s[18:19]
    v_mfma_f32_16x16x32_bf16 v[60:63], a[8:11], a[72:75], v[60:63]
    v_cndmask_b32 v98, v38, v42, s[20:21]
    v_cndmask_b32 v76, v76, v77, s[4:5]
    v_cndmask_b32 v80, v80, v81, s[4:5]
    v_mfma_f32_16x16x32_bf16 v[68:71], a[12:15], a[72:75], v[68:71]
    v_cndmask_b32 v78, v78, v79, s[4:5]
    v_cndmask_b32 v82, v82, v83, s[4:5]
    v_cndmask_b32 v100, v76, v80, s[18:19]
    v_mfma_f32_16x16x32_bf16 v[64:67], a[8:11], a[76:79], v[64:67]
    v_cndmask_b32 v102, v78, v82, s[20:21]
    v_mul_f32 v96, v96, v123
    v_mul_f32 v98, v98, v126
    v_mfma_f32_16x16x32_bf16 v[72:75], a[12:15], a[76:79], v[72:75]
    v_mul_f32 v100, v100, v123
    v_mul_f32 v102, v102, v126
    v_max_f32 v4, v96, v98
    v_mfma_f32_16x16x32_bf16 v[60:63], a[16:19], a[80:83], v[60:63]
    v_max_f32 v5, v100, v102
    v_mov_b32 v6, v4
    v_mov_b32 v7, v5
    v_mfma_f32_16x16x32_bf16 v[68:71], a[20:23], a[80:83], v[68:71]
    v_permlane32_swap_b32 v4, v6
    v_permlane32_swap_b32 v5, v7
    v_max_f32 v4, v4, v6
    v_mfma_f32_16x16x32_bf16 v[64:67], a[16:19], a[84:87], v[64:67]
    v_max_f32 v5, v5, v7
    v_mov_b32 v6, v4
    v_mov_b32 v7, v5
    v_mfma_f32_16x16x32_bf16 v[72:75], a[20:23], a[84:87], v[72:75]
    v_permlane16_swap_b32 v4, v6
    v_permlane16_swap_b32 v5, v7
    s_setprio 1
    v_mfma_f32_16x16x32_bf16 v[60:63], a[24:27], a[88:91], v[60:63]
    v_max_f32 v4, v4, v6
    v_max_f32 v5, v5, v7
    v_sub_f32 v96, v96, v4
    v_mfma_f32_16x16x32_bf16 v[68:71], a[28:31], a[88:91], v[68:71]
    v_sub_f32 v98, v98, v4
    v_sub_f32 v100, v100, v5
    v_sub_f32 v102, v102, v5
    v_mfma_f32_16x16x32_bf16 v[64:67], a[24:27], a[92:95], v[64:67]
    v_exp_f32 v96, v96
    v_exp_f32 v98, v98
    v_exp_f32 v100, v100
    v_mfma_f32_16x16x32_bf16 v[72:75], a[28:31], a[92:95], v[72:75]
    v_exp_f32 v102, v102
    v_cvt_pk_bf16_f32 v96, v96, v96
    s_waitcnt lgkmcnt(12)
    v_mfma_f32_16x16x32_bf16 v[60:63], a[32:35], a[96:99], v[60:63]
    v_cvt_pk_bf16_f32 v97, v98, v98
    v_cvt_pk_bf16_f32 v100, v100, v100
    v_cvt_pk_bf16_f32 v101, v102, v102
    v_mfma_f32_16x16x32_bf16 v[68:71], a[36:39], a[96:99], v[68:71]
    v_and_b32 v98, v96, v118
    v_and_b32 v99, v97, v119
    v_and_b32 v96, v96, v116
    v_mfma_f32_16x16x32_bf16 v[64:67], a[32:35], a[100:103], v[64:67]
    v_and_b32 v97, v97, v117
    v_and_b32 v102, v100, v118
    v_and_b32 v103, v101, v119
    v_mfma_f32_16x16x32_bf16 v[72:75], a[36:39], a[100:103], v[72:75]
    v_and_b32 v100, v100, v116
    v_and_b32 v101, v101, v117
    s_waitcnt lgkmcnt(8)
    v_mfma_f32_16x16x32_bf16 v[60:63], a[40:43], a[104:107], v[60:63]
    s_lshl_b32 s36, s44, 6
    s_add_u32 s36, s36, 156160
    v_lshl_add_u32 v48, v2, 4, s36
    v_xor_b32 v49, 64, v48
    ds_read_b128 v[28:31], v48 offset:0
    v_mfma_f32_16x16x32_bf16 v[68:71], a[44:47], a[104:107], v[68:71]
    ds_read_b128 v[32:35], v48 offset:512
    ds_read_b128 v[36:39], v49 offset:0
    ds_read_b128 v[40:43], v49 offset:512
    s_lshl_b32 s36, s27, 3
    s_add_u32 s36, s36, 157696
    v_mfma_f32_16x16x32_bf16 v[64:67], a[40:43], a[108:111], v[64:67]
    v_lshl_add_u32 v48, v3, 4, s36
    v_mov_b32 v49, 157952
    v_lshl_add_u32 v125, v1, 3, s45
    s_lshl_b32 s36, s27, 10
    v_add_u32 v50, s36, v125
    v_mfma_f32_16x16x32_bf16 v[72:75], a[44:47], a[108:111], v[72:75]
    s_lshl_b32 s37, s27, 12
    s_sub_u32 s37, 2048, s37
    v_add_u32 v51, s37, v50
    v_subrev_u32 v125, 2048, v125
    s_setprio 0
    s_waitcnt lgkmcnt(8)
    v_mfma_f32_16x16x32_bf16 v[60:63], a[48:51], a[112:115], v[60:63]
    v_mfma_f32_16x16x32_bf16 v[68:71], a[52:55], a[112:115], v[68:71]
    v_mfma_f32_16x16x32_bf16 v[64:67], a[48:51], a[116:119], v[64:67]
    v_mfma_f32_16x16x32_bf16 v[72:75], a[52:55], a[116:119], v[72:75]
    s_waitcnt vmcnt(1)
Lfl_chk:
    v_cmp_eq_u32 vcc, s34, v20
    s_nop 0
    s_and_b32 s36, vcc_lo, 0x3ff
    s_cmp_lg_u32 s36, 0x3ff
    s_cbranch_scc1 Lfl_re
    buffer_load_dwordx2 v[52:53], v13, s[28:31], s59 offen offset:8 sc1
    buffer_load_dwordx2 v[54:55], v13, s[28:31], s60 offen offset:0 sc1
    s_waitcnt lgkmcnt(4)
    v_mfma_f32_16x16x32_bf16 v[60:63], a[56:59], a[120:123], v[60:63]
    v_mfma_f32_16x16x32_bf16 v[68:71], a[60:63], a[120:123], v[68:71]
    v_mfma_f32_16x16x32_bf16 v[64:67], a[56:59], a[124:127], v[64:67]
    v_mfma_f32_16x16x32_bf16 v[72:75], a[60:63], a[124:127], v[72:75]
    ds_read_b32 v46, v49
    ds_read_b64 v[44:45], v48
    s_waitcnt lgkmcnt(0)
Lcsv:
    v_readfirstlane_b32 s38, v46
    s_nop 0
    s_cmp_eq_u32 s38, 0
    s_cbranch_scc1 Lcsv_re
    v_fmac_f32 v60, v28, v44
    v_fmac_f32 v61, v29, v44
    v_fmac_f32 v62, v30, v44
    v_fmac_f32 v63, v31, v44
    v_mul_f32 v60, v60, v32
    v_mul_f32 v61, v61, v33
    v_mul_f32 v62, v62, v34
    v_mul_f32 v63, v63, v35
    v_cvt_pk_bf16_f32 v60, v60, v61
    v_cvt_pk_bf16_f32 v61, v62, v63
    ds_write_b64 v50, v[60:61] offset:0
    v_fmac_f32 v64, v28, v45
    v_fmac_f32 v65, v29, v45
    v_fmac_f32 v66, v30, v45
    v_fmac_f32 v67, v31, v45
    v_mul_f32 v64, v64, v32
    v_mul_f32 v65, v65, v33
    v_mul_f32 v66, v66, v34
    v_mul_f32 v67, v67, v35
    v_cvt_pk_bf16_f32 v64, v64, v65
    v_cvt_pk_bf16_f32 v65, v66, v67
    ds_write_b64 v50, v[64:65] offset:512
    v_fmac_f32 v68, v36, v44
    v_fmac_f32 v69, v37, v44
    v_fmac_f32 v70, v38, v44
    v_fmac_f32 v71, v39, v44
    v_mul_f32 v68, v68, v40
    v_mul_f32 v69, v69, v41
    v_mul_f32 v70, v70, v42
    v_mul_f32 v71, v71, v43
    v_cvt_pk_bf16_f32 v68, v68, v69
    v_cvt_pk_bf16_f32 v69, v70, v71
    ds_write_b64 v51, v[68:69] offset:0
    v_fmac_f32 v72, v36, v45
    v_fmac_f32 v73, v37, v45
    v_fmac_f32 v74, v38, v45
    v_fmac_f32 v75, v39, v45
    v_mul_f32 v72, v72, v40
    v_mul_f32 v73, v73, v41
    v_mul_f32 v74, v74, v42
    v_mul_f32 v75, v75, v43
    v_cvt_pk_bf16_f32 v72, v72, v73
    v_cvt_pk_bf16_f32 v73, v74, v75
    ds_write_b64 v51, v[72:73] offset:512
    v_mov_b32 v8, 157976
    v_mov_b32 v9, 1
    s_mov_b64 exec, 1
    ds_add_u32 v8, v9
    s_mov_b64 exec, -1
    s_waitcnt vmcnt(0)
Lrx_chk:
    v_and_b32 v52, s61, v52
    v_and_b32 v53, s61, v53
    v_and_b32 v54, s62, v54
    v_and_b32 v55, s62, v55
    v_max3_u32 v4, v52, v53, v54
    v_max_u32 v4, v4, v55
    v_cmp_eq_u32 vcc, -1, v4
    s_nop 0
    s_cbranch_vccnz Lrx_re
    v_add_f32 v92, v92, v52
    v_add_f32 v94, v94, v53
    v_add_f32 v104, v104, v54
    v_add_f32 v106, v106, v55
Lcw_4:
    s_sub_u32 s35, s35, 1
    s_cbranch_scc1 Lend
    ds_read_b32 v9, v8
    s_waitcnt lgkmcnt(0)
    v_readfirstlane_b32 s38, v9
    s_nop 0
    s_cmp_lt_u32 s38, 7
    s_cbranch_scc1 Lcw_4
    s_setprio 2
    ds_read2st64_b64 v[60:63], v125 offset0:0 offset1:4
    ds_read2st64_b64 v[64:67], v125 offset0:1 offset1:5
    ds_read2st64_b64 v[68:71], v125 offset0:2 offset1:6
    ds_read2st64_b64 v[72:75], v125 offset0:3 offset1:7
    v_mul_f32 v92, v92, v123
    v_mul_f32 v94, v94, v126
    v_mul_f32 v104, v104, v123
    v_mul_f32 v106, v106, v126
    v_max_f32 v4, v92, v94
    v_max_f32 v5, v104, v106
    v_mov_b32 v6, v4
    v_mov_b32 v7, v5
    s_nop 0
    v_permlane32_swap_b32 v4, v6
    v_permlane32_swap_b32 v5, v7
    v_max_f32 v4, v4, v6
    v_max_f32 v5, v5, v7
    s_waitcnt lgkmcnt(0)
    v_mov_b32 v6, v4
    v_mfma_f32_16x16x32_bf16 v[80:83], v[14:17], v[96:99], 0
    v_mov_b32 v7, v5
    v_permlane16_swap_b32 v4, v6
    s_nop 0
    v_permlane16_swap_b32 v5, v7
    v_max_f32 v4, v4, v6
    v_mfma_f32_16x16x32_bf16 v[84:87], v[14:17], v[100:103], 0
    v_max_f32 v5, v5, v7
    v_sub_f32 v92, v92, v4
    v_sub_f32 v94, v94, v4
    v_sub_f32 v104, v104, v5
    v_mfma_f32_16x16x32_bf16 v[28:31], v[60:63], v[96:99], 0
    v_sub_f32 v106, v106, v5
    v_exp_f32 v92, v92
    v_exp_f32 v94, v94
    v_exp_f32 v104, v104
    v_exp_f32 v106, v106
    v_mfma_f32_16x16x32_bf16 v[32:35], v[64:67], v[96:99], 0
    v_cvt_pk_bf16_f32 v92, v92, v92
    v_cvt_pk_bf16_f32 v93, v94, v94
    v_cvt_pk_bf16_f32 v104, v104, v104
    v_cvt_pk_bf16_f32 v105, v106, v106
    v_mfma_f32_16x16x32_bf16 v[36:39], v[68:71], v[100:103], 0
    v_and_b32 v94, v92, v118
    v_and_b32 v95, v93, v119
    v_and_b32 v92, v92, v116
    v_and_b32 v93, v93, v117
    v_mfma_f32_16x16x32_bf16 v[40:43], v[72:75], v[100:103], 0
    v_and_b32 v106, v104, v118
    v_and_b32 v107, v105, v119
    v_and_b32 v104, v104, v116
    v_and_b32 v105, v105, v117
    v_mfma_f32_16x16x32_bf16 v[76:79], v[14:17], v[92:95], 0
    v_rcp_f32 v80, v80
    v_rcp_f32 v84, v84
    v_mfma_f32_16x16x32_bf16 v[88:91], v[14:17], v[104:107], 0
    v_mul_f32 v28, v28, v80
    v_mul_f32 v29, v29, v80
    v_mfma_f32_16x16x32_bf16 v[44:47], v[64:67], v[92:95], 0
    v_mul_f32 v30, v30, v80
    v_mfma_f32_16x16x32_bf16 v[48:51], v[68:71], v[92:95], 0
    v_mul_f32 v31, v31, v80
    v_cvt_pk_bf16_f32 v4, v28, v29
    v_mfma_f32_16x16x32_bf16 v[52:55], v[64:67], v[104:107], 0
    v_cvt_pk_bf16_f32 v5, v30, v31
    v_min_u32 v4, -2, v4
    v_mfma_f32_16x16x32_bf16 v[56:59], v[68:71], v[104:107], 0
    v_min_u32 v5, -2, v5
    v_mul_f32 v40, v40, v84
    v_mul_f32 v41, v41, v84
    v_mul_f32 v42, v42, v84
    v_mul_f32 v43, v43, v84
    v_cvt_pk_bf16_f32 v10, v40, v41
    v_cvt_pk_bf16_f32 v11, v42, v43
    v_min_u32 v10, -2, v10
    v_min_u32 v11, -2, v11
    v_rcp_f32 v76, v76
    v_rcp_f32 v88, v88
    v_cndmask_b32 v82, v80, v76, s[6:7]
    v_cndmask_b32 v82, v82, v88, s[8:9]
    v_cndmask_b32 v32, v32, v44, s[6:7]
    v_cndmask_b32 v33, v33, v45, s[6:7]
    v_cndmask_b32 v34, v34, v46, s[6:7]
    v_cndmask_b32 v35, v35, v47, s[6:7]
    v_cndmask_b32 v32, v32, v52, s[8:9]
    v_cndmask_b32 v33, v33, v53, s[8:9]
    v_cndmask_b32 v34, v34, v54, s[8:9]
    v_cndmask_b32 v35, v35, v55, s[8:9]
    v_mul_f32 v32, v32, v82
    v_mul_f32 v33, v33, v82
    v_mul_f32 v34, v34, v82
    v_mul_f32 v35, v35, v82
    v_cvt_pk_bf16_f32 v6, v32, v33
    v_cvt_pk_bf16_f32 v7, v34, v35
    v_min_u32 v6, -2, v6
    v_min_u32 v7, -2, v7
    buffer_store_dwordx4 v[4:7], v13, s[28:31], s23 offen offset:0 sc1
    v_cndmask_b32 v86, v84, v76, s[12:13]
    v_cndmask_b32 v86, v86, v88, s[14:15]
    v_cndmask_b32 v36, v36, v48, s[12:13]
    v_cndmask_b32 v37, v37, v49, s[12:13]
    v_cndmask_b32 v38, v38, v50, s[12:13]
    v_cndmask_b32 v39, v39, v51, s[12:13]
    v_cndmask_b32 v36, v36, v56, s[14:15]
    v_cndmask_b32 v37, v37, v57, s[14:15]
    v_cndmask_b32 v38, v38, v58, s[14:15]
    v_cndmask_b32 v39, v39, v59, s[14:15]
    v_mul_f32 v36, v36, v86
    v_mul_f32 v37, v37, v86
    v_mul_f32 v38, v38, v86
    v_mul_f32 v39, v39, v86
    v_cvt_pk_bf16_f32 v8, v36, v37
    v_cvt_pk_bf16_f32 v9, v38, v39
    v_min_u32 v8, -2, v8
    v_min_u32 v9, -2, v9
    buffer_store_dwordx4 v[8:11], v13, s[28:31], s23 offen offset:1024 sc1
    s_setprio 1
    s_nop 0
    v_mov_b32 v10, 157980
    v_and_b32 v6, 3, v1
    v_lshl_add_u32 v6, v6, 3, v19
    v_add_u32 v20, v6, v18
    v_xor_b32 v21, 32, v20
    v_xor_b32 v22, 64, v20
    v_xor_b32 v23, 96, v20
    v_add_u32 v24, 63616, v20
    v_add_u32 v25, 63616, v21
    v_add_u32 v26, 63616, v22
    v_add_u32 v27, 63616, v23
Lcw_3:
    s_sub_u32 s35, s35, 1
    s_cbranch_scc1 Lend
    ds_read_b32 v11, v10
    s_waitcnt lgkmcnt(0)
    v_readfirstlane_b32 s38, v11
    s_nop 0
    s_cmp_lt_u32 s38, 2
    s_cbranch_scc1 Lcw_3
    s_mul_i32 s36, s32, 96
    s_lshl_b32 s37, s44, 4
    s_add_u32 s36, s36, s37
    s_sub_u32 s36, s36, 32
    v_add_u32 v126, s36, v3
    v_lshrrev_b32 v6, 3, v1
    v_add_u32 v6, s36, v6
    v_mul_u32_u24 v6, 1280, v6
    v_and_b32 v7, 7, v1
    v_xor_b32 v7, v7, v2
    v_lshl_add_u32 v122, v7, 4, v6
    v_xor_b32 v123, 64, v122
    v_add_u32 v123, 10240, v123
    s_lshl_b32 s36, s44, 11
    s_add_u32 s36, s36, 102656
    v_add_u32 v124, s36, v124
    v_add_u32 v125, s36, v13
    s_lshl_b32 s24, s33, 7
    v_mov_b32 v10, 157960
    s_mov_b32 s41, 0
    s_mov_b32 s47, 3
    v_lshlrev_b32 v28, 16, v108
    ds_read_b64_tr_b16 a[0:1], v20 offset:0
    ds_read_b64_tr_b16 a[2:3], v20 offset:512
    ds_read_b64_tr_b16 a[4:5], v21 offset:0
    ds_read_b64_tr_b16 a[6:7], v21 offset:512
    ds_read_b64_tr_b16 a[8:9], v22 offset:0
    ds_read_b64_tr_b16 a[10:11], v22 offset:512
    ds_read_b64_tr_b16 a[12:13], v23 offset:0
    ds_read_b64_tr_b16 a[14:15], v23 offset:512
    v_and_b32 v29, 0xffff0000, v108
    v_lshlrev_b32 v30, 16, v109
    v_and_b32 v31, 0xffff0000, v109
    v_lshlrev_b32 v32, 16, v110
    v_and_b32 v33, 0xffff0000, v110
    v_lshlrev_b32 v34, 16, v111
    v_and_b32 v35, 0xffff0000, v111
    v_lshlrev_b32 v36, 16, v112
    v_and_b32 v37, 0xffff0000, v112
    v_lshlrev_b32 v38, 16, v113
    v_and_b32 v39, 0xffff0000, v113
    v_lshlrev_b32 v40, 16, v114
    v_and_b32 v41, 0xffff0000, v114
    v_lshlrev_b32 v42, 16, v115
    ds_read_b64_tr_b16 a[16:17], v20 offset:4096
    ds_read_b64_tr_b16 a[18:19], v20 offset:4608
    ds_read_b64_tr_b16 a[20:21], v21 offset:4096
    ds_read_b64_tr_b16 a[22:23], v21 offset:4608
    ds_read_b64_tr_b16 a[24:25], v22 offset:4096
    ds_read_b64_tr_b16 a[26:27], v22 offset:4608
    ds_read_b64_tr_b16 a[28:29], v23 offset:4096
    ds_read_b64_tr_b16 a[30:31], v23 offset:4608
    v_and_b32 v43, 0xffff0000, v115
    v_mul_f32 v4, v120, v121
    v_mul_f32 v5, 0xbfb8aa3b, v121
    v_mul_f32 v6, 0xbfb8aa3b, v4
    v_fma_f32 v44, v28, v5, v6
    v_fma_f32 v45, v29, v5, v6
    v_fma_f32 v46, v30, v5, v6
    v_fma_f32 v47, v31, v5, v6
    v_fma_f32 v48, v32, v5, v6
    v_fma_f32 v49, v33, v5, v6
    v_fma_f32 v50, v34, v5, v6
    v_fma_f32 v51, v35, v5, v6
    v_fma_f32 v52, v36, v5, v6
    v_fma_f32 v53, v37, v5, v6
    ds_read_b64_tr_b16 a[32:33], v20 offset:8192
    ds_read_b64_tr_b16 a[34:35], v20 offset:8704
    ds_read_b64_tr_b16 a[36:37], v21 offset:8192
    ds_read_b64_tr_b16 a[38:39], v21 offset:8704
    ds_read_b64_tr_b16 a[40:41], v22 offset:8192
    ds_read_b64_tr_b16 a[42:43], v22 offset:8704
    ds_read_b64_tr_b16 a[44:45], v23 offset:8192
    ds_read_b64_tr_b16 a[46:47], v23 offset:8704
    v_fma_f32 v54, v38, v5, v6
    v_fma_f32 v55, v39, v5, v6
    v_fma_f32 v56, v40, v5, v6
    v_fma_f32 v57, v41, v5, v6
    v_fma_f32 v58, v42, v5, v6
    v_fma_f32 v59, v43, v5, v6
    v_exp_f32 v44, v44
    v_exp_f32 v45, v45
    v_exp_f32 v46, v46
    v_exp_f32 v47, v47
    v_exp_f32 v48, v48
    v_exp_f32 v49, v49
    v_exp_f32 v50, v50
    v_exp_f32 v51, v51
    v_exp_f32 v52, v52
    ds_read_b64_tr_b16 a[48:49], v20 offset:12288
    ds_read_b64_tr_b16 a[50:51], v20 offset:12800
    ds_read_b64_tr_b16 a[52:53], v21 offset:12288
    ds_read_b64_tr_b16 a[54:55], v21 offset:12800
    ds_read_b64_tr_b16 a[56:57], v22 offset:12288
    ds_read_b64_tr_b16 a[58:59], v22 offset:12800
    ds_read_b64_tr_b16 a[60:61], v23 offset:12288
    ds_read_b64_tr_b16 a[62:63], v23 offset:12800
    v_exp_f32 v53, v53
    v_exp_f32 v54, v54
    v_exp_f32 v55, v55
    v_exp_f32 v56, v56
    v_exp_f32 v57, v57
    v_exp_f32 v58, v58
    v_exp_f32 v59, v59
    v_fma_f32 v92, v28, v121, v4
    v_fma_f32 v93, v29, v121, v4
    v_fma_f32 v94, v30, v121, v4
    v_fma_f32 v95, v31, v121, v4
    v_fma_f32 v96, v32, v121, v4
    v_fma_f32 v97, v33, v121, v4
    v_fma_f32 v98, v34, v121, v4
    ds_read_b64_tr_b16 a[64:65], v20 offset:24576
    ds_read_b64_tr_b16 a[66:67], v20 offset:25088
    ds_read_b64_tr_b16 a[68:69], v21 offset:24576
    ds_read_b64_tr_b16 a[70:71], v21 offset:25088
    ds_read_b64_tr_b16 a[72:73], v22 offset:24576
    ds_read_b64_tr_b16 a[74:75], v22 offset:25088
    ds_read_b64_tr_b16 a[76:77], v23 offset:24576
    ds_read_b64_tr_b16 a[78:79], v23 offset:25088
    v_fma_f32 v99, v35, v121, v4
    v_fma_f32 v100, v36, v121, v4
    v_fma_f32 v101, v37, v121, v4
    v_fma_f32 v102, v38, v121, v4
    v_fma_f32 v103, v39, v121, v4
    v_fma_f32 v104, v40, v121, v4
    v_fma_f32 v105, v41, v121, v4
    v_fma_f32 v106, v42, v121, v4
    v_fma_f32 v107, v43, v121, v4
    v_add_f32 v44, 1.0, v44
    v_add_f32 v45, 1.0, v45
    v_add_f32 v46, 1.0, v46
    v_add_f32 v47, 1.0, v47
    v_add_f32 v48, 1.0, v48
    ds_read_b64_tr_b16 a[80:81], v20 offset:28672
    ds_read_b64_tr_b16 a[82:83], v20 offset:29184
    ds_read_b64_tr_b16 a[84:85], v21 offset:28672
    ds_read_b64_tr_b16 a[86:87], v21 offset:29184
    ds_read_b64_tr_b16 a[88:89], v22 offset:28672
    ds_read_b64_tr_b16 a[90:91], v22 offset:29184
    ds_read_b64_tr_b16 a[92:93], v23 offset:28672
    ds_read_b64_tr_b16 a[94:95], v23 offset:29184
    v_add_f32 v49, 1.0, v49
    v_add_f32 v50, 1.0, v50
    v_add_f32 v51, 1.0, v51
    v_add_f32 v52, 1.0, v52
    v_add_f32 v53, 1.0, v53
    v_add_f32 v54, 1.0, v54
    v_add_f32 v55, 1.0, v55
    v_add_f32 v56, 1.0, v56
    v_add_f32 v57, 1.0, v57
    v_add_f32 v58, 1.0, v58
    v_add_f32 v59, 1.0, v59
    v_rcp_f32 v44, v44
    v_rcp_f32 v45, v45
    v_rcp_f32 v46, v46
    v_rcp_f32 v47, v47
    ds_read_b64_tr_b16 a[96:97], v24 offset:59520
    ds_read_b64_tr_b16 a[98:99], v24 offset:60032
    ds_read_b64_tr_b16 a[100:101], v25 offset:59520
    ds_read_b64_tr_b16 a[102:103], v25 offset:60032
    ds_read_b64_tr_b16 a[104:105], v26 offset:59520
    ds_read_b64_tr_b16 a[106:107], v26 offset:60032
    ds_read_b64_tr_b16 a[108:109], v27 offset:59520
    ds_read_b64_tr_b16 a[110:111], v27 offset:60032
    v_rcp_f32 v48, v48
    v_rcp_f32 v49, v49
    v_rcp_f32 v50, v50
    v_rcp_f32 v51, v51
    v_rcp_f32 v52, v52
    v_rcp_f32 v53, v53
    v_rcp_f32 v54, v54
    v_rcp_f32 v55, v55
    v_rcp_f32 v56, v56
    v_rcp_f32 v57, v57
    v_rcp_f32 v58, v58
    v_rcp_f32 v59, v59
    v_mul_f32 v44, v44, v92
    v_mul_f32 v45, v45, v93
    ds_read_b64_tr_b16 a[112:113], v24 offset:63616
    ds_read_b64_tr_b16 a[114:115], v24 offset:64128
    ds_read_b64_tr_b16 a[116:117], v25 offset:63616
    ds_read_b64_tr_b16 a[118:119], v25 offset:64128
    ds_read_b64_tr_b16 a[120:121], v26 offset:63616
    ds_read_b64_tr_b16 a[122:123], v26 offset:64128
    ds_read_b64_tr_b16 a[124:125], v27 offset:63616
    ds_read_b64_tr_b16 a[126:127], v27 offset:64128
    v_mul_f32 v46, v46, v94
    v_mul_f32 v47, v47, v95
    v_mul_f32 v48, v48, v96
    v_mul_f32 v49, v49, v97
    v_mul_f32 v50, v50, v98
    v_mul_f32 v51, v51, v99
    v_mul_f32 v52, v52, v100
    v_mul_f32 v53, v53, v101
    v_mul_f32 v54, v54, v102
    v_mul_f32 v55, v55, v103
    v_mul_f32 v56, v56, v104
    v_mul_f32 v57, v57, v105
    v_mul_f32 v58, v58, v106
    v_mul_f32 v59, v59, v107
    buffer_load_dwordx4 v[60:63], v13, s[28:31], s53 offen offset:0 sc1
    buffer_load_dwordx4 v[64:67], v13, s[28:31], s53 offen offset:1024 sc1
    buffer_load_dwordx4 v[68:71], v13, s[28:31], s53 offen offset:2048 sc1
    buffer_load_dwordx4 v[72:75], v13, s[28:31], s53 offen offset:3072 sc1
    buffer_load_dwordx4 v[76:79], v13, s[28:31], s54 offen offset:0 sc1
    buffer_load_dwordx4 v[80:83], v13, s[28:31], s54 offen offset:1024 sc1
    buffer_load_dwordx4 v[84:87], v13, s[28:31], s54 offen offset:2048 sc1
    buffer_load_dwordx4 v[88:91], v13, s[28:31], s54 offen offset:3072 sc1
    s_setprio 0
Lwo_go:
    s_setprio 3
    ds_read_b64 v[8:9], v10
    s_waitcnt vmcnt(6)
    v_max3_u32 v4, v60, v61, v62
    v_max3_u32 v5, v64, v65, v66
    v_max3_u32 v4, v4, v63, v67
    v_max_u32 v4, v4, v5
    v_cmp_eq_u32 vcc, -1, v4
    s_nop 0
    s_cbranch_vccnz Lre_0
Lck_0:
    s_waitcnt lgkmcnt(15)
    v_mfma_f32_16x16x32_bf16 v[108:111], a[0:3], v[60:63], 0
    ds_read_b64_tr_b16 a[0:1], v24 offset:16384
    ds_read_b64_tr_b16 a[2:3], v24 offset:16896
    buffer_load_dwordx4 v[92:95], v13, s[28:31], s55 offen offset:0 sc1
    v_mfma_f32_16x16x32_bf16 v[112:115], a[4:7], v[60:63], 0
    ds_read_b64_tr_b16 a[4:5], v25 offset:16384
    ds_read_b64_tr_b16 a[6:7], v25 offset:16896
    v_mfma_f32_16x16x32_bf16 v[116:119], a[8:11], v[60:63], 0
    ds_read_b64_tr_b16 a[8:9], v26 offset:16384
    ds_read_b64_tr_b16 a[10:11], v26 offset:16896
    buffer_load_dwordx4 v[96:99], v13, s[28:31], s55 offen offset:1024 sc1
    v_mfma_f32_16x16x32_bf16 v[14:17], a[12:15], v[60:63], 0
    ds_read_b64_tr_b16 a[12:13], v27 offset:16384
    ds_read_b64_tr_b16 a[14:15], v27 offset:16896
    v_mfma_f32_16x16x32_bf16 v[108:111], a[16:19], v[64:67], v[108:111]
    ds_read_b64_tr_b16 a[16:17], v24 offset:20480
    ds_read_b64_tr_b16 a[18:19], v24 offset:20992
    s_waitcnt vmcnt(6)
    v_max3_u32 v4, v68, v69, v70
    v_mfma_f32_16x16x32_bf16 v[112:115], a[20:23], v[64:67], v[112:115]
    ds_read_b64_tr_b16 a[20:21], v25 offset:20480
    ds_read_b64_tr_b16 a[22:23], v25 offset:20992
    v_max3_u32 v5, v72, v73, v74
    v_max3_u32 v4, v4, v71, v75
    v_mfma_f32_16x16x32_bf16 v[116:119], a[24:27], v[64:67], v[116:119]
    ds_read_b64_tr_b16 a[24:25], v26 offset:20480
    ds_read_b64_tr_b16 a[26:27], v26 offset:20992
    v_max_u32 v4, v4, v5
    v_cmp_eq_u32 vcc, -1, v4
    v_mfma_f32_16x16x32_bf16 v[14:17], a[28:31], v[64:67], v[14:17]
    ds_read_b64_tr_b16 a[28:29], v27 offset:20480
    ds_read_b64_tr_b16 a[30:31], v27 offset:20992
    s_cbranch_vccnz Lre_1
Lck_1:
    s_waitcnt lgkmcnt(15)
Linfo:
    v_readfirstlane_b32 s39, v8
    s_nop 0
    s_cmp_eq_u32 s39, -2
    s_cbranch_scc1 Linfo_re
    v_mfma_f32_16x16x32_bf16 v[108:111], a[32:35], v[68:71], v[108:111]
    ds_read_b64_tr_b16 a[32:33], v20 offset:32768
    ds_read_b64_tr_b16 a[34:35], v20 offset:33280
    buffer_load_dwordx4 v[100:103], v13, s[28:31], s55 offen offset:2048 sc1
    v_mfma_f32_16x16x32_bf16 v[112:115], a[36:39], v[68:71], v[112:115]
    ds_read_b64_tr_b16 a[36:37], v21 offset:32768
    ds_read_b64_tr_b16 a[38:39], v21 offset:33280
    v_mfma_f32_16x16x32_bf16 v[116:119], a[40:43], v[68:71], v[116:119]
    ds_read_b64_tr_b16 a[40:41], v22 offset:32768
    ds_read_b64_tr_b16 a[42:43], v22 offset:33280
    buffer_load_dwordx4 v[104:107], v13, s[28:31], s55 offen offset:3072 sc1
    v_mfma_f32_16x16x32_bf16 v[14:17], a[44:47], v[68:71], v[14:17]
    ds_read_b64_tr_b16 a[44:45], v23 offset:32768
    ds_read_b64_tr_b16 a[46:47], v23 offset:33280
    v_mfma_f32_16x16x32_bf16 v[108:111], a[48:51], v[72:75], v[108:111]
    ds_read_b64_tr_b16 a[48:49], v20 offset:36864
    ds_read_b64_tr_b16 a[50:51], v20 offset:37376
    s_waitcnt vmcnt(6)
    v_max3_u32 v4, v76, v77, v78
    v_mfma_f32_16x16x32_bf16 v[112:115], a[52:55], v[72:75], v[112:115]
    ds_read_b64_tr_b16 a[52:53], v21 offset:36864
    ds_read_b64_tr_b16 a[54:55], v21 offset:37376
    v_max3_u32 v5, v80, v81, v82
    v_max3_u32 v4, v4, v79, v83
    v_mfma_f32_16x16x32_bf16 v[116:119], a[56:59], v[72:75], v[116:119]
    ds_read_b64_tr_b16 a[56:57], v22 offset:36864
    ds_read_b64_tr_b16 a[58:59], v22 offset:37376
    v_max_u32 v4, v4, v5
    v_cmp_eq_u32 vcc, -1, v4
    v_mfma_f32_16x16x32_bf16 v[14:17], a[60:63], v[72:75], v[14:17]
    ds_read_b64_tr_b16 a[60:61], v23 offset:36864
    ds_read_b64_tr_b16 a[62:63], v23 offset:37376
    s_cbranch_vccnz Lre_2
Lck_2:
    v_mfma_f32_16x16x32_bf16 v[108:111], a[64:67], v[76:79], v[108:111]
    ds_read_b64_tr_b16 a[64:65], v20 offset:40960
    ds_read_b64_tr_b16 a[66:67], v20 offset:41472
    buffer_load_dwordx4 v[60:63], v13, s[28:31], s56 offen offset:0 sc1
    v_mfma_f32_16x16x32_bf16 v[112:115], a[68:71], v[76:79], v[112:115]
    ds_read_b64_tr_b16 a[68:69], v21 offset:40960
    ds_read_b64_tr_b16 a[70:71], v21 offset:41472
    v_mfma_f32_16x16x32_bf16 v[116:119], a[72:75], v[76:79], v[116:119]
    ds_read_b64_tr_b16 a[72:73], v22 offset:40960
    ds_read_b64_tr_b16 a[74:75], v22 offset:41472
    buffer_load_dwordx4 v[64:67], v13, s[28:31], s56 offen offset:1024 sc1
    v_mfma_f32_16x16x32_bf16 v[14:17], a[76:79], v[76:79], v[14:17]
    ds_read_b64_tr_b16 a[76:77], v23 offset:40960
    ds_read_b64_tr_b16 a[78:79], v23 offset:41472
    v_mfma_f32_16x16x32_bf16 v[108:111], a[80:83], v[80:83], v[108:111]
    ds_read_b64_tr_b16 a[80:81], v20 offset:45056
    ds_read_b64_tr_b16 a[82:83], v20 offset:45568
    s_waitcnt vmcnt(6)
    v_max3_u32 v4, v84, v85, v86
    v_mfma_f32_16x16x32_bf16 v[112:115], a[84:87], v[80:83], v[112:115]
    ds_read_b64_tr_b16 a[84:85], v21 offset:45056
    ds_read_b64_tr_b16 a[86:87], v21 offset:45568
    v_max3_u32 v5, v88, v89, v90
    v_max3_u32 v4, v4, v87, v91
    v_mfma_f32_16x16x32_bf16 v[116:119], a[88:91], v[80:83], v[116:119]
    ds_read_b64_tr_b16 a[88:89], v22 offset:45056
    ds_read_b64_tr_b16 a[90:91], v22 offset:45568
    v_max_u32 v4, v4, v5
    v_cmp_eq_u32 vcc, -1, v4
    v_mfma_f32_16x16x32_bf16 v[14:17], a[92:95], v[80:83], v[14:17]
    ds_read_b64_tr_b16 a[92:93], v23 offset:45056
    ds_read_b64_tr_b16 a[94:95], v23 offset:45568
    s_cbranch_vccnz Lre_3
Lck_3:
    s_setprio 2
    v_mfma_f32_16x16x32_bf16 v[108:111], a[96:99], v[84:87], v[108:111]
    ds_read_b64_tr_b16 a[96:97], v24 offset:0
    ds_read_b64_tr_b16 a[98:99], v24 offset:512
    buffer_load_dwordx4 v[68:71], v13, s[28:31], s56 offen offset:2048 sc1
    v_mfma_f32_16x16x32_bf16 v[112:115], a[100:103], v[84:87], v[112:115]
    ds_read_b64_tr_b16 a[100:101], v25 offset:0
    ds_read_b64_tr_b16 a[102:103], v25 offset:512
    v_mfma_f32_16x16x32_bf16 v[116:119], a[104:107], v[84:87], v[116:119]
    ds_read_b64_tr_b16 a[104:105], v26 offset:0
    ds_read_b64_tr_b16 a[106:107], v26 offset:512
    buffer_load_dwordx4 v[72:75], v13, s[28:31], s56 offen offset:3072 sc1
    v_mfma_f32_16x16x32_bf16 v[14:17], a[108:111], v[84:87], v[14:17]
    ds_read_b64_tr_b16 a[108:109], v27 offset:0
    ds_read_b64_tr_b16 a[110:111], v27 offset:512
    v_mfma_f32_16x16x32_bf16 v[108:111], a[112:115], v[88:91], v[108:111]
    ds_read_b64_tr_b16 a[112:113], v24 offset:4096
    ds_read_b64_tr_b16 a[114:115], v24 offset:4608
    s_waitcnt vmcnt(6)
    v_max3_u32 v4, v92, v93, v94
    v_mfma_f32_16x16x32_bf16 v[112:115], a[116:119], v[88:91], v[112:115]
    ds_read_b64_tr_b16 a[116:117], v25 offset:4096
    ds_read_b64_tr_b16 a[118:119], v25 offset:4608
    v_max3_u32 v5, v96, v97, v98
    v_max3_u32 v4, v4, v95, v99
    v_mfma_f32_16x16x32_bf16 v[116:119], a[120:123], v[88:91], v[116:119]
    ds_read_b64_tr_b16 a[120:121], v26 offset:4096
    ds_read_b64_tr_b16 a[122:123], v26 offset:4608
    v_max_u32 v4, v4, v5
    v_cmp_eq_u32 vcc, -1, v4
    v_mfma_f32_16x16x32_bf16 v[14:17], a[124:127], v[88:91], v[14:17]
    ds_read_b64_tr_b16 a[124:125], v27 offset:4096
    ds_read_b64_tr_b16 a[126:127], v27 offset:4608
    s_cbranch_vccnz Lre_4
Lck_4:
    s_waitcnt lgkmcnt(15)
    v_mfma_f32_16x16x32_bf16 v[108:111], a[0:3], v[92:95], v[108:111]
    ds_read_b64_tr_b16 a[0:1], v24 offset:8192
    ds_read_b64_tr_b16 a[2:3], v24 offset:8704
    buffer_load_dwordx4 v[76:79], v13, s[28:31], s57 offen offset:0 sc1
    v_mfma_f32_16x16x32_bf16 v[112:115], a[4:7], v[92:95], v[112:115]
    ds_read_b64_tr_b16 a[4:5], v25 offset:8192
    ds_read_b64_tr_b16 a[6:7], v25 offset:8704
    v_mfma_f32_16x16x32_bf16 v[116:119], a[8:11], v[92:95], v[116:119]
    ds_read_b64_tr_b16 a[8:9], v26 offset:8192
    ds_read_b64_tr_b16 a[10:11], v26 offset:8704
    buffer_load_dwordx4 v[80:83], v13, s[28:31], s57 offen offset:1024 sc1
    v_mfma_f32_16x16x32_bf16 v[14:17], a[12:15], v[92:95], v[14:17]
    ds_read_b64_tr_b16 a[12:13], v27 offset:8192
    ds_read_b64_tr_b16 a[14:15], v27 offset:8704
    v_mfma_f32_16x16x32_bf16 v[108:111], a[16:19], v[96:99], v[108:111]
    ds_read_b64_tr_b16 a[16:17], v24 offset:12288
    ds_read_b64_tr_b16 a[18:19], v24 offset:12800
    s_waitcnt vmcnt(6)
    v_max3_u32 v4, v100, v101, v102
    v_mfma_f32_16x16x32_bf16 v[112:115], a[20:23], v[96:99], v[112:115]
    ds_read_b64_tr_b16 a[20:21], v25 offset:12288
    ds_read_b64_tr_b16 a[22:23], v25 offset:12800
    v_max3_u32 v5, v104, v105, v106
    v_max3_u32 v4, v4, v103, v107
    v_mfma_f32_16x16x32_bf16 v[116:119], a[24:27], v[96:99], v[116:119]
    ds_read_b64_tr_b16 a[24:25], v26 offset:12288
    ds_read_b64_tr_b16 a[26:27], v26 offset:12800
    v_max_u32 v4, v4, v5
    v_cmp_eq_u32 vcc, -1, v4
    v_mfma_f32_16x16x32_bf16 v[14:17], a[28:31], v[96:99], v[14:17]
    ds_read_b64_tr_b16 a[28:29], v27 offset:12288
    ds_read_b64_tr_b16 a[30:31], v27 offset:12800
    s_cbranch_vccnz Lre_5
Lck_5:
    v_mfma_f32_16x16x32_bf16 v[108:111], a[32:35], v[100:103], v[108:111]
    ds_read_b64_tr_b16 a[32:33], v20 offset:49152
    ds_read_b64_tr_b16 a[34:35], v20 offset:49664
    buffer_load_dwordx4 v[84:87], v13, s[28:31], s57 offen offset:2048 sc1
    v_mfma_f32_16x16x32_bf16 v[112:115], a[36:39], v[100:103], v[112:115]
    ds_read_b64_tr_b16 a[36:37], v21 offset:49152
    ds_read_b64_tr_b16 a[38:39], v21 offset:49664
    v_mfma_f32_16x16x32_bf16 v[116:119], a[40:43], v[100:103], v[116:119]
    ds_read_b64_tr_b16 a[40:41], v22 offset:49152
    ds_read_b64_tr_b16 a[42:43], v22 offset:49664
    buffer_load_dwordx4 v[88:91], v13, s[28:31], s57 offen offset:3072 sc1
    v_mfma_f32_16x16x32_bf16 v[14:17], a[44:47], v[100:103], v[14:17]
    ds_read_b64_tr_b16 a[44:45], v23 offset:49152
    ds_read_b64_tr_b16 a[46:47], v23 offset:49664
    v_mfma_f32_16x16x32_bf16 v[108:111], a[48:51], v[104:107], v[108:111]
    ds_read_b64_tr_b16 a[48:49], v24 offset:24576
    ds_read_b64_tr_b16 a[50:51], v24 offset:25088
    s_waitcnt vmcnt(6)
    v_max3_u32 v4, v60, v61, v62
    v_mfma_f32_16x16x32_bf16 v[112:115], a[52:55], v[104:107], v[112:115]
    ds_read_b64_tr_b16 a[52:53], v25 offset:24576
    ds_read_b64_tr_b16 a[54:55], v25 offset:25088
    v_max3_u32 v5, v64, v65, v66
    v_max3_u32 v4, v4, v63, v67
    v_mfma_f32_16x16x32_bf16 v[116:119], a[56:59], v[104:107], v[116:119]
    ds_read_b64_tr_b16 a[56:57], v26 offset:24576
    ds_read_b64_tr_b16 a[58:59], v26 offset:25088
    v_max_u32 v4, v4, v5
    v_cmp_eq_u32 vcc, -1, v4
    v_mfma_f32_16x16x32_bf16 v[14:17], a[60:63], v[104:107], v[14:17]
    ds_read_b64_tr_b16 a[60:61], v27 offset:24576
    ds_read_b64_tr_b16 a[62:63], v27 offset:25088
    s_cbranch_vccnz Lre_6
Lck_6:
    s_setprio 1
    v_mfma_f32_16x16x32_bf16 v[108:111], a[64:67], v[60:63], v[108:111]
    v_mfma_f32_16x16x32_bf16 v[112:115], a[68:71], v[60:63], v[112:115]
    v_mfma_f32_16x16x32_bf16 v[116:119], a[72:75], v[60:63], v[116:119]
    v_mfma_f32_16x16x32_bf16 v[14:17], a[76:79], v[60:63], v[14:17]
    v_mfma_f32_16x16x32_bf16 v[108:111], a[80:83], v[64:67], v[108:111]
    s_waitcnt vmcnt(4)
    v_max3_u32 v4, v68, v69, v70
    v_mfma_f32_16x16x32_bf16 v[112:115], a[84:87], v[64:67], v[112:115]
    v_max3_u32 v5, v72, v73, v74
    v_max3_u32 v4, v4, v71, v75
    v_mfma_f32_16x16x32_bf16 v[116:119], a[88:91], v[64:67], v[116:119]
    v_max_u32 v4, v4, v5
    v_cmp_eq_u32 vcc, -1, v4
    v_mfma_f32_16x16x32_bf16 v[14:17], a[92:95], v[64:67], v[14:17]
    s_cbranch_vccnz Lre_7
Lck_7:
    s_waitcnt lgkmcnt(15)
    v_mfma_f32_16x16x32_bf16 v[108:111], a[96:99], v[68:71], v[108:111]
    v_mfma_f32_16x16x32_bf16 v[112:115], a[100:103], v[68:71], v[112:115]
    v_mfma_f32_16x16x32_bf16 v[116:119], a[104:107], v[68:71], v[116:119]
    v_mfma_f32_16x16x32_bf16 v[14:17], a[108:111], v[68:71], v[14:17]
    v_mfma_f32_16x16x32_bf16 v[108:111], a[112:115], v[72:75], v[108:111]
    s_waitcnt vmcnt(2)
    v_max3_u32 v4, v76, v77, v78
    v_mfma_f32_16x16x32_bf16 v[112:115], a[116:119], v[72:75], v[112:115]
    v_max3_u32 v5, v80, v81, v82
    v_max3_u32 v4, v4, v79, v83
    v_mfma_f32_16x16x32_bf16 v[116:119], a[120:123], v[72:75], v[116:119]
    v_max_u32 v4, v4, v5
    v_cmp_eq_u32 vcc, -1, v4
    v_mfma_f32_16x16x32_bf16 v[14:17], a[124:127], v[72:75], v[14:17]
    s_cbranch_vccnz Lre_8
Lck_8:
    s_setprio 0
    v_mfma_f32_16x16x32_bf16 v[108:111], a[0:3], v[76:79], v[108:111]
    v_mfma_f32_16x16x32_bf16 v[112:115], a[4:7], v[76:79], v[112:115]
    v_mfma_f32_16x16x32_bf16 v[116:119], a[8:11], v[76:79], v[116:119]
    v_mfma_f32_16x16x32_bf16 v[14:17], a[12:15], v[76:79], v[14:17]
    v_mfma_f32_16x16x32_bf16 v[108:111], a[16:19], v[80:83], v[108:111]
    s_waitcnt vmcnt(0)
    v_max3_u32 v4, v84, v85, v86
    v_mfma_f32_16x16x32_bf16 v[112:115], a[20:23], v[80:83], v[112:115]
    v_max3_u32 v5, v88, v89, v90
    v_max3_u32 v4, v4, v87, v91
    v_mfma_f32_16x16x32_bf16 v[116:119], a[24:27], v[80:83], v[116:119]
    v_max_u32 v4, v4, v5
    v_cmp_eq_u32 vcc, -1, v4
    v_mfma_f32_16x16x32_bf16 v[14:17], a[28:31], v[80:83], v[14:17]
    s_cbranch_vccnz Lre_9
Lck_9:
    s_waitcnt lgkmcnt(8)
    v_mfma_f32_16x16x32_bf16 v[108:111], a[32:35], v[84:87], v[108:111]
    v_mfma_f32_16x16x32_bf16 v[112:115], a[36:39], v[84:87], v[112:115]
    v_mfma_f32_16x16x32_bf16 v[116:119], a[40:43], v[84:87], v[116:119]
    v_mfma_f32_16x16x32_bf16 v[14:17], a[44:47], v[84:87], v[14:17]
    s_waitcnt lgkmcnt(0)
    v_mfma_f32_16x16x32_bf16 v[108:111], a[48:51], v[88:91], v[108:111]
    v_mfma_f32_16x16x32_bf16 v[112:115], a[52:55], v[88:91], v[112:115]
    v_mfma_f32_16x16x32_bf16 v[116:119], a[56:59], v[88:91], v[116:119]
    v_mfma_f32_16x16x32_bf16 v[14:17], a[60:63], v[88:91], v[14:17]
    v_xor_b32 v60, 32, v124
    v_xor_b32 v61, 64, v124
    v_xor_b32 v62, 96, v124
    v_cmp_eq_u32 s[36:37], v8, v126
    v_cmp_eq_u32 s[38:39], v9, v126
    s_nop 0
    s_or_b64 vcc, s[36:37], s[38:39]
    s_cbranch_scc1 Lfix
Lnofix:
    v_fma_f32 v108, v108, v44, v28
    v_fma_f32 v109, v109, v45, v29
    v_fma_f32 v110, v110, v46, v30
    v_fma_f32 v111, v111, v47, v31
    v_cvt_pk_bf16_f32 v68, v108, v109
    v_cvt_pk_bf16_f32 v69, v110, v111
    ds_write_b64 v124, v[68:69]
    v_fma_f32 v112, v112, v48, v32
    v_fma_f32 v113, v113, v49, v33
    v_fma_f32 v114, v114, v50, v34
    v_fma_f32 v115, v115, v51, v35
    v_cvt_pk_bf16_f32 v70, v112, v113
    v_cvt_pk_bf16_f32 v71, v114, v115
    ds_write_b64 v60, v[70:71]
    v_fma_f32 v116, v116, v52, v36
    v_fma_f32 v117, v117, v53, v37
    v_fma_f32 v118, v118, v54, v38
    v_fma_f32 v119, v119, v55, v39
    v_cvt_pk_bf16_f32 v72, v116, v117
    v_cvt_pk_bf16_f32 v73, v118, v119
    ds_write_b64 v61, v[72:73]
    v_fma_f32 v14, v14, v56, v40
    v_fma_f32 v15, v15, v57, v41
    v_fma_f32 v16, v16, v58, v42
    v_fma_f32 v17, v17, v59, v43
    v_cvt_pk_bf16_f32 v74, v14, v15
    v_cvt_pk_bf16_f32 v75, v16, v17
    ds_write_b64 v62, v[74:75]
    ds_read_b128 v[76:79], v125 offset:0
    ds_read_b128 v[80:83], v125 offset:1024
    s_waitcnt lgkmcnt(1)
    buffer_store_dwordx4 v[76:79], v122, s[48:51], s24 offen
    s_waitcnt lgkmcnt(0)
    buffer_store_dwordx4 v[80:83], v123, s[48:51], s24 offen
    s_endpgm
Lh1:
    ds_write_b128 v125, v[44:47] offset:0
    ds_write_b128 v125, v[48:51] offset:1024
    v_mov_b32 v5, 157972
    v_mov_b32 v6, 1
    s_mov_b64 exec, 1
    ds_add_u32 v5, v6
    s_mov_b64 exec, -1
    v_fmac_f32 v28, v76, v120
    v_fmac_f32 v29, v77, v120
    v_fmac_f32 v30, v78, v120
    v_fmac_f32 v31, v79, v120
    v_cvt_pk_bf16_f32 v28, v28, v29
    v_cvt_pk_bf16_f32 v29, v30, v31
    v_fmac_f32 v32, v80, v120
    v_fmac_f32 v33, v81, v120
    v_fmac_f32 v34, v82, v120
    v_fmac_f32 v35, v83, v120
    v_cvt_pk_bf16_f32 v30, v32, v33
    v_cvt_pk_bf16_f32 v31, v34, v35
    v_fmac_f32 v36, v84, v120
    v_fmac_f32 v37, v85, v120
    v_fmac_f32 v38, v86, v120
    v_fmac_f32 v39, v87, v120
    v_cvt_pk_bf16_f32 v32, v36, v37
    v_cvt_pk_bf16_f32 v33, v38, v39
    v_fmac_f32 v40, v88, v120
    v_fmac_f32 v41, v89, v120
    v_fmac_f32 v42, v90, v120
    v_fmac_f32 v43, v91, v120
    v_cvt_pk_bf16_f32 v34, v40, v41
    v_cvt_pk_bf16_f32 v35, v42, v43
    v_subrev_u32 v4, 6144, v125
    v_mov_b32 v8, s22
    v_mov_b32 v9, s22
    v_mov_b32 v10, s22
    v_mov_b32 v11, s22
Lcw_2:
    s_sub_u32 s35, s35, 1
    s_cbranch_scc1 Lend
    ds_read_b32 v6, v5
    s_waitcnt lgkmcnt(0)
    v_readfirstlane_b32 s38, v6
    s_nop 0
    s_cmp_lt_u32 s38, 8
    s_cbranch_scc1 Lcw_2
    ds_read_b128 v[52:55], v125 offset:2048
    ds_read_b128 v[56:59], v125 offset:3072
    ds_read_b128 v[44:47], v4 offset:4096
    ds_read_b128 v[48:51], v4 offset:5120
    s_branch Lh_join
Lqf_re:
    s_sub_u32 s35, s35, 1
    s_cbranch_scc1 Lend
    ds_read_b32 v7, v96
    ds_read_b128 v[76:79], v95 offset:0
    ds_read_b128 v[80:83], v95 offset:64
    ds_read_b128 v[84:87], v95 offset:128
    ds_read_b128 v[88:91], v95 offset:192
    s_waitcnt lgkmcnt(0)
    s_branch Lqf
Lcsv_re:
    s_sub_u32 s35, s35, 1
    s_cbranch_scc1 Lend
    ds_read_b32 v46, v49
    ds_read_b64 v[44:45], v48
    s_waitcnt lgkmcnt(0)
    s_branch Lcsv
Lrx_re:
    s_sub_u32 s35, s35, 1
    s_cbranch_scc1 Lend
    buffer_load_dwordx2 v[52:53], v13, s[28:31], s59 offen offset:8 sc1
    buffer_load_dwordx2 v[54:55], v13, s[28:31], s60 offen offset:0 sc1
    s_waitcnt vmcnt(0)
    s_branch Lrx_chk
Linfo_re:
    s_sub_u32 s35, s35, 1
    s_cbranch_scc1 Lend
    ds_read_b64 v[8:9], v10
    s_waitcnt lgkmcnt(0)
    s_branch Linfo
Lfl_re:
    s_sub_u32 s35, s35, 1
    s_cbranch_scc1 Lend
    buffer_load_dword v20, v12, s[28:31], s24 offen sc1
    s_waitcnt vmcnt(0)
    s_branch Lfl_chk
Lxe0:
    ds_read_b64 v[108:109], v4
    ds_read_b64 v[110:111], v5
    ds_read_b64 v[112:113], v6
    ds_read_b64 v[114:115], v7
    s_branch Lxe0_b
Lxe1:
    ds_read_b64 v[108:109], v4
    ds_read_b64 v[110:111], v5
    ds_read_b64 v[112:113], v6
    ds_read_b64 v[114:115], v7
    s_branch Lxe1_b
Lxe2:
    ds_read_b64 v[108:109], v4
    ds_read_b64 v[110:111], v5
    ds_read_b64 v[112:113], v6
    ds_read_b64 v[114:115], v7
    s_branch Lxe2_b
Lxe3:
    ds_read_b64 v[108:109], v4
    ds_read_b64 v[110:111], v5
    ds_read_b64 v[112:113], v6
    ds_read_b64 v[114:115], v7
    s_branch Lxe3_b
Lxe4:
    ds_read_b64 v[108:109], v4
    ds_read_b64 v[110:111], v5
    ds_read_b64 v[112:113], v6
    ds_read_b64 v[114:115], v7
    s_branch Lxe4_b
Lxe5:
    ds_read_b64 v[108:109], v4
    ds_read_b64 v[110:111], v5
    ds_read_b64 v[112:113], v6
    ds_read_b64 v[114:115], v7
    s_branch Lxe5_b
Lxe6:
    ds_read_b64 v[108:109], v4
    ds_read_b64 v[110:111], v5
    ds_read_b64 v[112:113], v6
    ds_read_b64 v[114:115], v7
    s_branch Lxe6_b
Lxe7:
    ds_read_b64 v[108:109], v4
    ds_read_b64 v[110:111], v5
    ds_read_b64 v[112:113], v6
    ds_read_b64 v[114:115], v7
    s_branch Lxe7_b
Lxe8:
    ds_read_b64 v[108:109], v4
    ds_read_b64 v[110:111], v5
    ds_read_b64 v[112:113], v6
    ds_read_b64 v[114:115], v7
    s_branch Lxe8_b
Lxe9:
    ds_read_b64 v[108:109], v4
    ds_read_b64 v[110:111], v5
    ds_read_b64 v[112:113], v6
    ds_read_b64 v[114:115], v7
    s_branch Lxe9_b
Lre_0:
    s_mov_b32 s41, 1
    s_sub_u32 s35, s35, 1
    s_cbranch_scc1 Lend
    s_sleep 2
    buffer_load_dwordx4 v[60:63], v13, s[28:31], s53 offen offset:0 sc1
    buffer_load_dwordx4 v[64:67], v13, s[28:31], s53 offen offset:1024 sc1
    s_waitcnt vmcnt(0)
    v_max3_u32 v4, v60, v61, v62
    v_max3_u32 v5, v64, v65, v66
    v_max3_u32 v4, v4, v63, v67
    v_max_u32 v4, v4, v5
    v_cmp_eq_u32 vcc, -1, v4
    s_nop 0
    s_cbranch_vccnz Lre_0
    buffer_load_dwordx4 v[68:71], v13, s[28:31], s53 offen offset:2048 sc1
    buffer_load_dwordx4 v[72:75], v13, s[28:31], s53 offen offset:3072 sc1
    buffer_load_dwordx4 v[76:79], v13, s[28:31], s54 offen offset:0 sc1
    buffer_load_dwordx4 v[80:83], v13, s[28:31], s54 offen offset:1024 sc1
    buffer_load_dwordx4 v[84:87], v13, s[28:31], s54 offen offset:2048 sc1
    buffer_load_dwordx4 v[88:91], v13, s[28:31], s54 offen offset:3072 sc1
    s_branch Lck_0
Lre_1:
    s_mov_b32 s41, 1
    s_sub_u32 s35, s35, 1
    s_cbranch_scc1 Lend
    s_sleep 2
    buffer_load_dwordx4 v[68:71], v13, s[28:31], s53 offen offset:2048 sc1
    buffer_load_dwordx4 v[72:75], v13, s[28:31], s53 offen offset:3072 sc1
    s_waitcnt vmcnt(0)
    v_max3_u32 v4, v68, v69, v70
    v_max3_u32 v5, v72, v73, v74
    v_max3_u32 v4, v4, v71, v75
    v_max_u32 v4, v4, v5
    v_cmp_eq_u32 vcc, -1, v4
    s_nop 0
    s_cbranch_vccnz Lre_1
    buffer_load_dwordx4 v[76:79], v13, s[28:31], s54 offen offset:0 sc1
    buffer_load_dwordx4 v[80:83], v13, s[28:31], s54 offen offset:1024 sc1
    buffer_load_dwordx4 v[84:87], v13, s[28:31], s54 offen offset:2048 sc1
    buffer_load_dwordx4 v[88:91], v13, s[28:31], s54 offen offset:3072 sc1
    buffer_load_dwordx4 v[92:95], v13, s[28:31], s55 offen offset:0 sc1
    buffer_load_dwordx4 v[96:99], v13, s[28:31], s55 offen offset:1024 sc1
    s_branch Lck_1
Lre_2:
    s_mov_b32 s41, 1
    s_sub_u32 s35, s35, 1
    s_cbranch_scc1 Lend
    s_sleep 2
    buffer_load_dwordx4 v[76:79], v13, s[28:31], s54 offen offset:0 sc1
    buffer_load_dwordx4 v[80:83], v13, s[28:31], s54 offen offset:1024 sc1
    s_waitcnt vmcnt(0)
    v_max3_u32 v4, v76, v77, v78
    v_max3_u32 v5, v80, v81, v82
    v_max3_u32 v4, v4, v79, v83
    v_max_u32 v4, v4, v5
    v_cmp_eq_u32 vcc, -1, v4
    s_nop 0
    s_cbranch_vccnz Lre_2
    buffer_load_dwordx4 v[84:87], v13, s[28:31], s54 offen offset:2048 sc1
    buffer_load_dwordx4 v[88:91], v13, s[28:31], s54 offen offset:3072 sc1
    buffer_load_dwordx4 v[92:95], v13, s[28:31], s55 offen offset:0 sc1
    buffer_load_dwordx4 v[96:99], v13, s[28:31], s55 offen offset:1024 sc1
    buffer_load_dwordx4 v[100:103], v13, s[28:31], s55 offen offset:2048 sc1
    buffer_load_dwordx4 v[104:107], v13, s[28:31], s55 offen offset:3072 sc1
    s_branch Lck_2
Lre_3:
    s_mov_b32 s41, 1
    s_sub_u32 s35, s35, 1
    s_cbranch_scc1 Lend
    s_sleep 2
    buffer_load_dwordx4 v[84:87], v13, s[28:31], s54 offen offset:2048 sc1
    buffer_load_dwordx4 v[88:91], v13, s[28:31], s54 offen offset:3072 sc1
    s_waitcnt vmcnt(0)
    v_max3_u32 v4, v84, v85, v86
    v_max3_u32 v5, v88, v89, v90
    v_max3_u32 v4, v4, v87, v91
    v_max_u32 v4, v4, v5
    v_cmp_eq_u32 vcc, -1, v4
    s_nop 0
    s_cbranch_vccnz Lre_3
    buffer_load_dwordx4 v[92:95], v13, s[28:31], s55 offen offset:0 sc1
    buffer_load_dwordx4 v[96:99], v13, s[28:31], s55 offen offset:1024 sc1
    buffer_load_dwordx4 v[100:103], v13, s[28:31], s55 offen offset:2048 sc1
    buffer_load_dwordx4 v[104:107], v13, s[28:31], s55 offen offset:3072 sc1
    buffer_load_dwordx4 v[60:63], v13, s[28:31], s56 offen offset:0 sc1
    buffer_load_dwordx4 v[64:67], v13, s[28:31], s56 offen offset:1024 sc1
    s_branch Lck_3
Lre_4:
    s_mov_b32 s41, 1
    s_sub_u32 s35, s35, 1
    s_cbranch_scc1 Lend
    s_sleep 2
    buffer_load_dwordx4 v[92:95], v13, s[28:31], s55 offen offset:0 sc1
    buffer_load_dwordx4 v[96:99], v13, s[28:31], s55 offen offset:1024 sc1
    s_waitcnt vmcnt(0)
    v_max3_u32 v4, v92, v93, v94
    v_max3_u32 v5, v96, v97, v98
    v_max3_u32 v4, v4, v95, v99
    v_max_u32 v4, v4, v5
    v_cmp_eq_u32 vcc, -1, v4
    s_nop 0
    s_cbranch_vccnz Lre_4
    buffer_load_dwordx4 v[100:103], v13, s[28:31], s55 offen offset:2048 sc1
    buffer_load_dwordx4 v[104:107], v13, s[28:31], s55 offen offset:3072 sc1
    buffer_load_dwordx4 v[60:63], v13, s[28:31], s56 offen offset:0 sc1
    buffer_load_dwordx4 v[64:67], v13, s[28:31], s56 offen offset:1024 sc1
    buffer_load_dwordx4 v[68:71], v13, s[28:31], s56 offen offset:2048 sc1
    buffer_load_dwordx4 v[72:75], v13, s[28:31], s56 offen offset:3072 sc1
    s_branch Lck_4
Lre_5:
    s_mov_b32 s41, 1
    s_sub_u32 s35, s35, 1
    s_cbranch_scc1 Lend
    s_sleep 2
    buffer_load_dwordx4 v[100:103], v13, s[28:31], s55 offen offset:2048 sc1
    buffer_load_dwordx4 v[104:107], v13, s[28:31], s55 offen offset:3072 sc1
    s_waitcnt vmcnt(0)
    v_max3_u32 v4, v100, v101, v102
    v_max3_u32 v5, v104, v105, v106
    v_max3_u32 v4, v4, v103, v107
    v_max_u32 v4, v4, v5
    v_cmp_eq_u32 vcc, -1, v4
    s_nop 0
    s_cbranch_vccnz Lre_5
    buffer_load_dwordx4 v[60:63], v13, s[28:31], s56 offen offset:0 sc1
    buffer_load_dwordx4 v[64:67], v13, s[28:31], s56 offen offset:1024 sc1
    buffer_load_dwordx4 v[68:71], v13, s[28:31], s56 offen offset:2048 sc1
    buffer_load_dwordx4 v[72:75], v13, s[28:31], s56 offen offset:3072 sc1
    buffer_load_dwordx4 v[76:79], v13, s[28:31], s57 offen offset:0 sc1
    buffer_load_dwordx4 v[80:83], v13, s[28:31], s57 offen offset:1024 sc1
    s_branch Lck_5
Lre_6:
    s_mov_b32 s41, 1
    s_sub_u32 s35, s35, 1
    s_cbranch_scc1 Lend
    s_sleep 2
    buffer_load_dwordx4 v[60:63], v13, s[28:31], s56 offen offset:0 sc1
    buffer_load_dwordx4 v[64:67], v13, s[28:31], s56 offen offset:1024 sc1
    s_waitcnt vmcnt(0)
    v_max3_u32 v4, v60, v61, v62
    v_max3_u32 v5, v64, v65, v66
    v_max3_u32 v4, v4, v63, v67
    v_max_u32 v4, v4, v5
    v_cmp_eq_u32 vcc, -1, v4
    s_nop 0
    s_cbranch_vccnz Lre_6
    buffer_load_dwordx4 v[68:71], v13, s[28:31], s56 offen offset:2048 sc1
    buffer_load_dwordx4 v[72:75], v13, s[28:31], s56 offen offset:3072 sc1
    buffer_load_dwordx4 v[76:79], v13, s[28:31], s57 offen offset:0 sc1
    buffer_load_dwordx4 v[80:83], v13, s[28:31], s57 offen offset:1024 sc1
    buffer_load_dwordx4 v[84:87], v13, s[28:31], s57 offen offset:2048 sc1
    buffer_load_dwordx4 v[88:91], v13, s[28:31], s57 offen offset:3072 sc1
    s_branch Lck_6
Lre_7:
    s_mov_b32 s41, 1
    s_sub_u32 s35, s35, 1
    s_cbranch_scc1 Lend
    s_sleep 2
    buffer_load_dwordx4 v[68:71], v13, s[28:31], s56 offen offset:2048 sc1
    buffer_load_dwordx4 v[72:75], v13, s[28:31], s56 offen offset:3072 sc1
    s_waitcnt vmcnt(0)
    v_max3_u32 v4, v68, v69, v70
    v_max3_u32 v5, v72, v73, v74
    v_max3_u32 v4, v4, v71, v75
    v_max_u32 v4, v4, v5
    v_cmp_eq_u32 vcc, -1, v4
    s_nop 0
    s_cbranch_vccnz Lre_7
    buffer_load_dwordx4 v[76:79], v13, s[28:31], s57 offen offset:0 sc1
    buffer_load_dwordx4 v[80:83], v13, s[28:31], s57 offen offset:1024 sc1
    buffer_load_dwordx4 v[84:87], v13, s[28:31], s57 offen offset:2048 sc1
    buffer_load_dwordx4 v[88:91], v13, s[28:31], s57 offen offset:3072 sc1
    s_branch Lck_7
Lre_8:
    s_mov_b32 s41, 1
    s_sub_u32 s35, s35, 1
    s_cbranch_scc1 Lend
    s_sleep 2
    buffer_load_dwordx4 v[76:79], v13, s[28:31], s57 offen offset:0 sc1
    buffer_load_dwordx4 v[80:83], v13, s[28:31], s57 offen offset:1024 sc1
    s_waitcnt vmcnt(0)
    v_max3_u32 v4, v76, v77, v78
    v_max3_u32 v5, v80, v81, v82
    v_max3_u32 v4, v4, v79, v83
    v_max_u32 v4, v4, v5
    v_cmp_eq_u32 vcc, -1, v4
    s_nop 0
    s_cbranch_vccnz Lre_8
    buffer_load_dwordx4 v[84:87], v13, s[28:31], s57 offen offset:2048 sc1
    buffer_load_dwordx4 v[88:91], v13, s[28:31], s57 offen offset:3072 sc1
    s_branch Lck_8
Lre_9:
    s_mov_b32 s41, 1
    s_sub_u32 s35, s35, 1
    s_cbranch_scc1 Lend
    s_sleep 2
    buffer_load_dwordx4 v[84:87], v13, s[28:31], s57 offen offset:2048 sc1
    buffer_load_dwordx4 v[88:91], v13, s[28:31], s57 offen offset:3072 sc1
    s_waitcnt vmcnt(0)
    v_max3_u32 v4, v84, v85, v86
    v_max3_u32 v5, v88, v89, v90
    v_max3_u32 v4, v4, v87, v91
    v_max_u32 v4, v4, v5
    v_cmp_eq_u32 vcc, -1, v4
    s_nop 0
    s_cbranch_vccnz Lre_9
    s_branch Lck_9
Lfix:
    s_mov_b64 vcc, s[38:39]
    v_lshlrev_b32 v6, 4, v2
    v_add_u32 v6, 158208, v6
    v_mov_b32 v10, 157956
Lcw_5:
    s_sub_u32 s35, s35, 1
    s_cbranch_scc1 Lend
    ds_read_b32 v11, v10
    s_waitcnt lgkmcnt(0)
    v_readfirstlane_b32 s38, v11
    s_nop 0
    s_cmp_lt_u32 s38, 1
    s_cbranch_scc1 Lcw_5
    s_mov_b64 exec, s[36:37]
    ds_read_b128 v[44:47], v6 offset:0
    ds_read_b128 v[48:51], v6 offset:64
    ds_read_b128 v[52:55], v6 offset:128
    ds_read_b128 v[56:59], v6 offset:192
    s_mov_b64 exec, vcc
    ds_read_b128 v[44:47], v6 offset:256
    ds_read_b128 v[48:51], v6 offset:320
    ds_read_b128 v[52:55], v6 offset:384
    ds_read_b128 v[56:59], v6 offset:448
    s_mov_b64 exec, -1
    s_waitcnt lgkmcnt(0)
    s_branch Lnofix
Lhalo:
    s_mov_b32 vcc_lo, 0x00010001
    s_mov_b32 vcc_hi, 0x00010001
    v_mov_b32 v11, 38912
    v_cndmask_b32 v76, v76, v11, vcc
    v_xor_b32 v77, 64, v76
    v_add_u32 v80, 78080, v76
    v_add_u32 v81, 78080, v77
    v_mov_b32 v14, 0x3f803f80
    v_mov_b32 v15, 0x3f803f80
    v_mov_b32 v16, 0x3f803f80
    v_mov_b32 v17, 0x3f803f80
    v_and_b32 v4, 7, v1
    v_lshlrev_b32 v4, 4, v4
    v_mul_u32_u24 v5, 39040, v2
    v_add_u32 v4, v4, v5
    ds_write_b128 v4, v[14:17] offset:38912
    v_mov_b32 v4, 157952
    v_mov_b32 v8, 0
    v_mov_b32 v9, 0
    v_mov_b32 v10, -2
    v_mov_b32 v11, -2
    ds_write_b128 v4, v[8:11]
    v_min_u32 v5, 23, v1
    v_lshl_add_u32 v5, v5, 2, v4
    ds_write_b32 v5, v8 offset:16
    s_mul_i32 s36, s32, 96
    s_sub_u32 s36, s36, 16
    v_add_u32 v96, s36, v1
    v_min_u32 v5, 47, v1
    v_add3_u32 v97, s36, v5, 64
    v_mov_b32 v6, 2047
    v_med3_i32 v96, v96, 0, v6
    v_med3_i32 v97, v97, 0, v6
    v_lshlrev_b32 v96, 3, v96
    v_lshlrev_b32 v97, 3, v97
    s_mov_b32 s46, 8192000
    v_mov_b32 v127, 157984
    s_lshl_b32 s36, s3, 2
    s_add_u32 s36, s36, 158016
    v_mov_b32 v10, s36
    s_mov_b32 vcc_lo, 0x00010001
    s_mov_b32 vcc_hi, 0x00010001
    v_cndmask_b32 v116, 0, v14, vcc
    v_cndmask_b32 v117, 0, v15, vcc
    v_cndmask_b32 v118, 0, v16, vcc
    v_cndmask_b32 v119, 0, v17, vcc
    s_waitcnt vmcnt(0)
    s_waitcnt lgkmcnt(0)
    s_barrier
    s_add_u32 s34, s34, 0x9e3779b8
    s_or_b32 s34, s34, 1
    ds_read_b128 v[108:111], v76 offset:0
    ds_read_b128 v[112:115], v77 offset:0
    ds_read_b64_tr_b16 a[0:1], v20 offset:0
    ds_read_b64_tr_b16 a[2:3], v20 offset:512
    ds_read_b64_tr_b16 a[4:5], v21 offset:0
    ds_read_b64_tr_b16 a[6:7], v21 offset:512
    ds_read_b64_tr_b16 a[8:9], v22 offset:0
    ds_read_b64_tr_b16 a[10:11], v22 offset:512
    ds_read_b64_tr_b16 a[12:13], v23 offset:0
    ds_read_b64_tr_b16 a[14:15], v23 offset:512
    ds_read_b64_tr_b16 a[16:17], v20 offset:8192
    ds_read_b64_tr_b16 a[18:19], v20 offset:8704
    ds_read_b64_tr_b16 a[20:21], v21 offset:8192
    ds_read_b64_tr_b16 a[22:23], v21 offset:8704
    ds_read_b64_tr_b16 a[24:25], v22 offset:8192
    ds_read_b64_tr_b16 a[26:27], v22 offset:8704
    s_waitcnt lgkmcnt(12)
    v_mfma_f32_16x16x32_bf16 v[28:31], a[0:3], v[116:119], 0
    ds_read_b64_tr_b16 a[28:29], v23 offset:8192
    ds_read_b64_tr_b16 a[30:31], v23 offset:8704
    s_waitcnt lgkmcnt(12)
    v_mfma_f32_16x16x32_bf16 v[32:35], a[4:7], v[116:119], 0
    ds_read_b64_tr_b16 a[32:33], v20 offset:16384
    ds_read_b64_tr_b16 a[34:35], v20 offset:16896
    s_waitcnt lgkmcnt(12)
    v_mfma_f32_16x16x32_bf16 v[36:39], a[8:11], v[116:119], 0
    ds_read_b64_tr_b16 a[36:37], v21 offset:16384
    ds_read_b64_tr_b16 a[38:39], v21 offset:16896
    s_waitcnt lgkmcnt(12)
    v_mfma_f32_16x16x32_bf16 v[40:43], a[12:15], v[116:119], 0
    ds_read_b64_tr_b16 a[40:41], v22 offset:16384
    ds_read_b64_tr_b16 a[42:43], v22 offset:16896
    s_waitcnt lgkmcnt(12)
    v_mfma_f32_16x16x32_bf16 v[44:47], a[16:19], v[108:111], 0
    ds_read_b64_tr_b16 a[44:45], v23 offset:16384
    ds_read_b64_tr_b16 a[46:47], v23 offset:16896
    s_waitcnt lgkmcnt(12)
    v_mfma_f32_16x16x32_bf16 v[48:51], a[20:23], v[108:111], 0
    ds_read_b64_tr_b16 a[48:49], v20 offset:4096
    ds_read_b64_tr_b16 a[50:51], v20 offset:4608
    s_waitcnt lgkmcnt(12)
    v_mfma_f32_16x16x32_bf16 v[52:55], a[24:27], v[108:111], 0
    ds_read_b64_tr_b16 a[52:53], v21 offset:4096
    ds_read_b64_tr_b16 a[54:55], v21 offset:4608
    s_waitcnt lgkmcnt(12)
    v_mfma_f32_16x16x32_bf16 v[56:59], a[28:31], v[108:111], 0
    ds_read_b64_tr_b16 a[56:57], v22 offset:4096
    ds_read_b64_tr_b16 a[58:59], v22 offset:4608
    s_waitcnt lgkmcnt(12)
    v_mfma_f32_16x16x32_bf16 v[60:63], v[108:111], a[32:35], 0
    ds_read_b64_tr_b16 a[60:61], v23 offset:4096
    ds_read_b64_tr_b16 a[62:63], v23 offset:4608
    s_waitcnt lgkmcnt(12)
    v_mfma_f32_16x16x32_bf16 v[64:67], v[108:111], a[36:39], 0
    ds_read_b64_tr_b16 a[64:65], v20 offset:12288
    ds_read_b64_tr_b16 a[66:67], v20 offset:12800
    s_waitcnt lgkmcnt(12)
    v_mfma_f32_16x16x32_bf16 v[68:71], v[108:111], a[40:43], 0
    ds_read_b64_tr_b16 a[68:69], v21 offset:12288
    ds_read_b64_tr_b16 a[70:71], v21 offset:12800
    s_waitcnt lgkmcnt(12)
    v_mfma_f32_16x16x32_bf16 v[72:75], v[108:111], a[44:47], 0
    ds_read_b64_tr_b16 a[72:73], v22 offset:12288
    ds_read_b64_tr_b16 a[74:75], v22 offset:12800
    s_waitcnt lgkmcnt(12)
    v_mfma_f32_16x16x32_bf16 v[28:31], a[48:51], v[116:119], v[28:31]
    ds_read_b64_tr_b16 a[76:77], v23 offset:12288
    ds_read_b64_tr_b16 a[78:79], v23 offset:12800
    s_waitcnt lgkmcnt(12)
    v_mfma_f32_16x16x32_bf16 v[32:35], a[52:55], v[116:119], v[32:35]
    ds_read_b64_tr_b16 a[80:81], v20 offset:20480
    ds_read_b64_tr_b16 a[82:83], v20 offset:20992
    s_waitcnt lgkmcnt(12)
    v_mfma_f32_16x16x32_bf16 v[36:39], a[56:59], v[116:119], v[36:39]
    ds_read_b64_tr_b16 a[84:85], v21 offset:20480
    ds_read_b64_tr_b16 a[86:87], v21 offset:20992
    s_waitcnt lgkmcnt(12)
    v_mfma_f32_16x16x32_bf16 v[40:43], a[60:63], v[116:119], v[40:43]
    ds_read_b64_tr_b16 a[88:89], v22 offset:20480
    ds_read_b64_tr_b16 a[90:91], v22 offset:20992
    s_waitcnt lgkmcnt(12)
    v_mfma_f32_16x16x32_bf16 v[44:47], a[64:67], v[112:115], v[44:47]
    ds_read_b64_tr_b16 a[92:93], v23 offset:20480
    ds_read_b64_tr_b16 a[94:95], v23 offset:20992
    s_waitcnt lgkmcnt(12)
    v_mfma_f32_16x16x32_bf16 v[48:51], a[68:71], v[112:115], v[48:51]
    s_waitcnt lgkmcnt(10)
    v_mfma_f32_16x16x32_bf16 v[52:55], a[72:75], v[112:115], v[52:55]
    s_waitcnt lgkmcnt(8)
    v_mfma_f32_16x16x32_bf16 v[56:59], a[76:79], v[112:115], v[56:59]
    s_waitcnt lgkmcnt(6)
    v_mfma_f32_16x16x32_bf16 v[60:63], v[112:115], a[80:83], v[60:63]
    s_waitcnt lgkmcnt(4)
    v_mfma_f32_16x16x32_bf16 v[64:67], v[112:115], a[84:87], v[64:67]
    s_waitcnt lgkmcnt(2)
    v_mfma_f32_16x16x32_bf16 v[68:71], v[112:115], a[88:91], v[68:71]
    s_waitcnt lgkmcnt(0)
    v_mfma_f32_16x16x32_bf16 v[72:75], v[112:115], a[92:95], v[72:75]
    s_barrier
    ds_read_b128 v[108:111], v76 offset:39040
    ds_read_b128 v[112:115], v77 offset:39040
    ds_read_b64_tr_b16 a[0:1], v20 offset:39040
    ds_read_b64_tr_b16 a[2:3], v20 offset:39552
    ds_read_b64_tr_b16 a[4:5], v21 offset:39040
    ds_read_b64_tr_b16 a[6:7], v21 offset:39552
    ds_read_b64_tr_b16 a[8:9], v22 offset:39040
    ds_read_b64_tr_b16 a[10:11], v22 offset:39552
    ds_read_b64_tr_b16 a[12:13], v23 offset:39040
    ds_read_b64_tr_b16 a[14:15], v23 offset:39552
    ds_read_b64_tr_b16 a[16:17], v20 offset:47232
    ds_read_b64_tr_b16 a[18:19], v20 offset:47744
    ds_read_b64_tr_b16 a[20:21], v21 offset:47232
    ds_read_b64_tr_b16 a[22:23], v21 offset:47744
    ds_read_b64_tr_b16 a[24:25], v22 offset:47232
    ds_read_b64_tr_b16 a[26:27], v22 offset:47744
    s_waitcnt lgkmcnt(12)
    v_mfma_f32_16x16x32_bf16 v[28:31], a[0:3], v[116:119], v[28:31]
    ds_read_b64_tr_b16 a[28:29], v23 offset:47232
    ds_read_b64_tr_b16 a[30:31], v23 offset:47744
    s_waitcnt lgkmcnt(12)
    v_mfma_f32_16x16x32_bf16 v[32:35], a[4:7], v[116:119], v[32:35]
    ds_read_b64_tr_b16 a[32:33], v20 offset:55424
    ds_read_b64_tr_b16 a[34:35], v20 offset:55936
    s_waitcnt lgkmcnt(12)
    v_mfma_f32_16x16x32_bf16 v[36:39], a[8:11], v[116:119], v[36:39]
    ds_read_b64_tr_b16 a[36:37], v21 offset:55424
    ds_read_b64_tr_b16 a[38:39], v21 offset:55936
    s_waitcnt lgkmcnt(12)
    v_mfma_f32_16x16x32_bf16 v[40:43], a[12:15], v[116:119], v[40:43]
    ds_read_b64_tr_b16 a[40:41], v22 offset:55424
    ds_read_b64_tr_b16 a[42:43], v22 offset:55936
    s_waitcnt lgkmcnt(12)
    v_mfma_f32_16x16x32_bf16 v[44:47], a[16:19], v[108:111], v[44:47]
    ds_read_b64_tr_b16 a[44:45], v23 offset:55424
    ds_read_b64_tr_b16 a[46:47], v23 offset:55936
    s_waitcnt lgkmcnt(12)
    v_mfma_f32_16x16x32_bf16 v[48:51], a[20:23], v[108:111], v[48:51]
    ds_read_b64_tr_b16 a[48:49], v20 offset:43136
    ds_read_b64_tr_b16 a[50:51], v20 offset:43648
    s_waitcnt lgkmcnt(12)
    v_mfma_f32_16x16x32_bf16 v[52:55], a[24:27], v[108:111], v[52:55]
    ds_read_b64_tr_b16 a[52:53], v21 offset:43136
    ds_read_b64_tr_b16 a[54:55], v21 offset:43648
    s_waitcnt lgkmcnt(12)
    v_mfma_f32_16x16x32_bf16 v[56:59], a[28:31], v[108:111], v[56:59]
    ds_read_b64_tr_b16 a[56:57], v22 offset:43136
    ds_read_b64_tr_b16 a[58:59], v22 offset:43648
    s_waitcnt lgkmcnt(12)
    v_mfma_f32_16x16x32_bf16 v[60:63], v[108:111], a[32:35], v[60:63]
    ds_read_b64_tr_b16 a[60:61], v23 offset:43136
    ds_read_b64_tr_b16 a[62:63], v23 offset:43648
    s_waitcnt lgkmcnt(12)
    v_mfma_f32_16x16x32_bf16 v[64:67], v[108:111], a[36:39], v[64:67]
    ds_read_b64_tr_b16 a[64:65], v20 offset:51328
    ds_read_b64_tr_b16 a[66:67], v20 offset:51840
    s_waitcnt lgkmcnt(12)
    v_mfma_f32_16x16x32_bf16 v[68:71], v[108:111], a[40:43], v[68:71]
    ds_read_b64_tr_b16 a[68:69], v21 offset:51328
    ds_read_b64_tr_b16 a[70:71], v21 offset:51840
    s_waitcnt lgkmcnt(12)
    v_mfma_f32_16x16x32_bf16 v[72:75], v[108:111], a[44:47], v[72:75]
    ds_read_b64_tr_b16 a[72:73], v22 offset:51328
    ds_read_b64_tr_b16 a[74:75], v22 offset:51840
    s_waitcnt lgkmcnt(12)
    v_mfma_f32_16x16x32_bf16 v[28:31], a[48:51], v[116:119], v[28:31]
    ds_read_b64_tr_b16 a[76:77], v23 offset:51328
    ds_read_b64_tr_b16 a[78:79], v23 offset:51840
    s_waitcnt lgkmcnt(12)
    v_mfma_f32_16x16x32_bf16 v[32:35], a[52:55], v[116:119], v[32:35]
    ds_read_b64_tr_b16 a[80:81], v20 offset:59520
    ds_read_b64_tr_b16 a[82:83], v20 offset:60032
    s_waitcnt lgkmcnt(12)
    v_mfma_f32_16x16x32_bf16 v[36:39], a[56:59], v[116:119], v[36:39]
    ds_read_b64_tr_b16 a[84:85], v21 offset:59520
    ds_read_b64_tr_b16 a[86:87], v21 offset:60032
    s_waitcnt lgkmcnt(12)
    v_mfma_f32_16x16x32_bf16 v[40:43], a[60:63], v[116:119], v[40:43]
    ds_read_b64_tr_b16 a[88:89], v22 offset:59520
    ds_read_b64_tr_b16 a[90:91], v22 offset:60032
    s_waitcnt lgkmcnt(12)
    v_mfma_f32_16x16x32_bf16 v[44:47], a[64:67], v[112:115], v[44:47]
    ds_read_b64_tr_b16 a[92:93], v23 offset:59520
    ds_read_b64_tr_b16 a[94:95], v23 offset:60032
    s_waitcnt lgkmcnt(12)
    v_mfma_f32_16x16x32_bf16 v[48:51], a[68:71], v[112:115], v[48:51]
    s_waitcnt lgkmcnt(10)
    v_mfma_f32_16x16x32_bf16 v[52:55], a[72:75], v[112:115], v[52:55]
    s_waitcnt lgkmcnt(8)
    v_mfma_f32_16x16x32_bf16 v[56:59], a[76:79], v[112:115], v[56:59]
    s_waitcnt lgkmcnt(6)
    v_mfma_f32_16x16x32_bf16 v[60:63], v[112:115], a[80:83], v[60:63]
    s_waitcnt lgkmcnt(4)
    v_mfma_f32_16x16x32_bf16 v[64:67], v[112:115], a[84:87], v[64:67]
    s_waitcnt lgkmcnt(2)
    v_mfma_f32_16x16x32_bf16 v[68:71], v[112:115], a[88:91], v[68:71]
    s_waitcnt lgkmcnt(0)
    v_mfma_f32_16x16x32_bf16 v[72:75], v[112:115], a[92:95], v[72:75]
    s_mov_b64 exec, 1
    s_lshl_b32 s36, s2, 2
    s_add_u32 s36, s36, 8323072
    v_mov_b32 v4, s34
    v_mov_b32 v5, s36
    buffer_store_dword v4, v5, s[28:31], 0 offen sc1
    s_mov_b64 exec, -1
    s_barrier
    ds_read_b128 v[108:111], v80 offset:0
    ds_read_b128 v[112:115], v81 offset:0
    ds_read_b64_tr_b16 a[0:1], v24 offset:0
    ds_read_b64_tr_b16 a[2:3], v24 offset:512
    ds_read_b64_tr_b16 a[4:5], v25 offset:0
    ds_read_b64_tr_b16 a[6:7], v25 offset:512
    ds_read_b64_tr_b16 a[8:9], v26 offset:0
    ds_read_b64_tr_b16 a[10:11], v26 offset:512
    ds_read_b64_tr_b16 a[12:13], v27 offset:0
    ds_read_b64_tr_b16 a[14:15], v27 offset:512
    ds_read_b64_tr_b16 a[16:17], v24 offset:8192
    ds_read_b64_tr_b16 a[18:19], v24 offset:8704
    ds_read_b64_tr_b16 a[20:21], v25 offset:8192
    ds_read_b64_tr_b16 a[22:23], v25 offset:8704
    ds_read_b64_tr_b16 a[24:25], v26 offset:8192
    ds_read_b64_tr_b16 a[26:27], v26 offset:8704
    s_waitcnt lgkmcnt(12)
    v_mfma_f32_16x16x32_bf16 v[28:31], a[0:3], v[116:119], v[28:31]
    ds_read_b64_tr_b16 a[28:29], v27 offset:8192
    ds_read_b64_tr_b16 a[30:31], v27 offset:8704
    s_waitcnt lgkmcnt(12)
    v_mfma_f32_16x16x32_bf16 v[32:35], a[4:7], v[116:119], v[32:35]
    ds_read_b64_tr_b16 a[32:33], v24 offset:16384
    ds_read_b64_tr_b16 a[34:35], v24 offset:16896
    s_waitcnt lgkmcnt(12)
    v_mfma_f32_16x16x32_bf16 v[36:39], a[8:11], v[116:119], v[36:39]
    ds_read_b64_tr_b16 a[36:37], v25 offset:16384
    ds_read_b64_tr_b16 a[38:39], v25 offset:16896
    s_waitcnt lgkmcnt(12)
    v_mfma_f32_16x16x32_bf16 v[40:43], a[12:15], v[116:119], v[40:43]
    ds_read_b64_tr_b16 a[40:41], v26 offset:16384
    ds_read_b64_tr_b16 a[42:43], v26 offset:16896
    s_waitcnt lgkmcnt(12)
    v_mfma_f32_16x16x32_bf16 v[44:47], a[16:19], v[108:111], v[44:47]
    ds_read_b64_tr_b16 a[44:45], v27 offset:16384
    ds_read_b64_tr_b16 a[46:47], v27 offset:16896
    s_waitcnt lgkmcnt(12)
    v_mfma_f32_16x16x32_bf16 v[48:51], a[20:23], v[108:111], v[48:51]
    ds_read_b64_tr_b16 a[48:49], v24 offset:4096
    ds_read_b64_tr_b16 a[50:51], v24 offset:4608
    s_waitcnt lgkmcnt(12)
    v_mfma_f32_16x16x32_bf16 v[52:55], a[24:27], v[108:111], v[52:55]
    ds_read_b64_tr_b16 a[52:53], v25 offset:4096
    ds_read_b64_tr_b16 a[54:55], v25 offset:4608
    s_waitcnt lgkmcnt(12)
    v_mfma_f32_16x16x32_bf16 v[56:59], a[28:31], v[108:111], v[56:59]
    ds_read_b64_tr_b16 a[56:57], v26 offset:4096
    ds_read_b64_tr_b16 a[58:59], v26 offset:4608
    s_waitcnt lgkmcnt(12)
    v_mfma_f32_16x16x32_bf16 v[60:63], v[108:111], a[32:35], v[60:63]
    ds_read_b64_tr_b16 a[60:61], v27 offset:4096
    ds_read_b64_tr_b16 a[62:63], v27 offset:4608
    s_waitcnt lgkmcnt(12)
    v_mfma_f32_16x16x32_bf16 v[64:67], v[108:111], a[36:39], v[64:67]
    ds_read_b64_tr_b16 a[64:65], v24 offset:12288
    ds_read_b64_tr_b16 a[66:67], v24 offset:12800
    s_waitcnt lgkmcnt(12)
    v_mfma_f32_16x16x32_bf16 v[68:71], v[108:111], a[40:43], v[68:71]
    ds_read_b64_tr_b16 a[68:69], v25 offset:12288
    ds_read_b64_tr_b16 a[70:71], v25 offset:12800
    s_waitcnt lgkmcnt(12)
    v_mfma_f32_16x16x32_bf16 v[72:75], v[108:111], a[44:47], v[72:75]
    ds_read_b64_tr_b16 a[72:73], v26 offset:12288
    ds_read_b64_tr_b16 a[74:75], v26 offset:12800
    s_waitcnt lgkmcnt(12)
    v_mfma_f32_16x16x32_bf16 v[28:31], a[48:51], v[116:119], v[28:31]
    ds_read_b64_tr_b16 a[76:77], v27 offset:12288
    ds_read_b64_tr_b16 a[78:79], v27 offset:12800
    s_waitcnt lgkmcnt(12)
    v_mfma_f32_16x16x32_bf16 v[32:35], a[52:55], v[116:119], v[32:35]
    ds_read_b64_tr_b16 a[80:81], v24 offset:20480
    ds_read_b64_tr_b16 a[82:83], v24 offset:20992
    s_waitcnt lgkmcnt(12)
    v_mfma_f32_16x16x32_bf16 v[36:39], a[56:59], v[116:119], v[36:39]
    ds_read_b64_tr_b16 a[84:85], v25 offset:20480
    ds_read_b64_tr_b16 a[86:87], v25 offset:20992
    s_waitcnt lgkmcnt(12)
    v_mfma_f32_16x16x32_bf16 v[40:43], a[60:63], v[116:119], v[40:43]
    ds_read_b64_tr_b16 a[88:89], v26 offset:20480
    ds_read_b64_tr_b16 a[90:91], v26 offset:20992
    s_waitcnt lgkmcnt(12)
    v_mfma_f32_16x16x32_bf16 v[44:47], a[64:67], v[112:115], v[44:47]
    ds_read_b64_tr_b16 a[92:93], v27 offset:20480
    ds_read_b64_tr_b16 a[94:95], v27 offset:20992
    s_waitcnt lgkmcnt(12)
    v_mfma_f32_16x16x32_bf16 v[48:51], a[68:71], v[112:115], v[48:51]
    s_waitcnt lgkmcnt(10)
    v_mfma_f32_16x16x32_bf16 v[52:55], a[72:75], v[112:115], v[52:55]
    s_waitcnt lgkmcnt(8)
    v_mfma_f32_16x16x32_bf16 v[56:59], a[76:79], v[112:115], v[56:59]
    s_waitcnt lgkmcnt(6)
    v_mfma_f32_16x16x32_bf16 v[60:63], v[112:115], a[80:83], v[60:63]
    s_waitcnt lgkmcnt(4)
    v_mfma_f32_16x16x32_bf16 v[64:67], v[112:115], a[84:87], v[64:67]
    s_waitcnt lgkmcnt(2)
    v_mfma_f32_16x16x32_bf16 v[68:71], v[112:115], a[88:91], v[68:71]
    s_waitcnt lgkmcnt(0)
    v_mfma_f32_16x16x32_bf16 v[72:75], v[112:115], a[92:95], v[72:75]
    s_barrier
    ds_read_b128 v[108:111], v80 offset:39040
    ds_read_b128 v[112:115], v81 offset:39040
    ds_read_b64_tr_b16 a[0:1], v24 offset:39040
    ds_read_b64_tr_b16 a[2:3], v24 offset:39552
    ds_read_b64_tr_b16 a[4:5], v25 offset:39040
    ds_read_b64_tr_b16 a[6:7], v25 offset:39552
    ds_read_b64_tr_b16 a[8:9], v26 offset:39040
    ds_read_b64_tr_b16 a[10:11], v26 offset:39552
    ds_read_b64_tr_b16 a[12:13], v27 offset:39040
    ds_read_b64_tr_b16 a[14:15], v27 offset:39552
    ds_read_b64_tr_b16 a[16:17], v24 offset:47232
    ds_read_b64_tr_b16 a[18:19], v24 offset:47744
    ds_read_b64_tr_b16 a[20:21], v25 offset:47232
    ds_read_b64_tr_b16 a[22:23], v25 offset:47744
    ds_read_b64_tr_b16 a[24:25], v26 offset:47232
    ds_read_b64_tr_b16 a[26:27], v26 offset:47744
    s_waitcnt lgkmcnt(12)
    v_mfma_f32_16x16x32_bf16 v[28:31], a[0:3], v[116:119], v[28:31]
    ds_read_b64_tr_b16 a[28:29], v27 offset:47232
    ds_read_b64_tr_b16 a[30:31], v27 offset:47744
    s_waitcnt lgkmcnt(12)
    v_mfma_f32_16x16x32_bf16 v[32:35], a[4:7], v[116:119], v[32:35]
    ds_read_b64_tr_b16 a[32:33], v24 offset:55424
    ds_read_b64_tr_b16 a[34:35], v24 offset:55936
    s_waitcnt lgkmcnt(12)
    v_mfma_f32_16x16x32_bf16 v[36:39], a[8:11], v[116:119], v[36:39]
    ds_read_b64_tr_b16 a[36:37], v25 offset:55424
    ds_read_b64_tr_b16 a[38:39], v25 offset:55936
    s_waitcnt lgkmcnt(12)
    v_mfma_f32_16x16x32_bf16 v[40:43], a[12:15], v[116:119], v[40:43]
    ds_read_b64_tr_b16 a[40:41], v26 offset:55424
    ds_read_b64_tr_b16 a[42:43], v26 offset:55936
    s_waitcnt lgkmcnt(12)
    v_mfma_f32_16x16x32_bf16 v[44:47], a[16:19], v[108:111], v[44:47]
    ds_read_b64_tr_b16 a[44:45], v27 offset:55424
    ds_read_b64_tr_b16 a[46:47], v27 offset:55936
    s_waitcnt lgkmcnt(12)
    v_mfma_f32_16x16x32_bf16 v[48:51], a[20:23], v[108:111], v[48:51]
    ds_read_b64_tr_b16 a[48:49], v24 offset:43136
    ds_read_b64_tr_b16 a[50:51], v24 offset:43648
    s_waitcnt lgkmcnt(12)
    v_mfma_f32_16x16x32_bf16 v[52:55], a[24:27], v[108:111], v[52:55]
    ds_read_b64_tr_b16 a[52:53], v25 offset:43136
    ds_read_b64_tr_b16 a[54:55], v25 offset:43648
    s_waitcnt lgkmcnt(12)
    v_mfma_f32_16x16x32_bf16 v[56:59], a[28:31], v[108:111], v[56:59]
    ds_read_b64_tr_b16 a[56:57], v26 offset:43136
    ds_read_b64_tr_b16 a[58:59], v26 offset:43648
    s_waitcnt lgkmcnt(12)
    v_mfma_f32_16x16x32_bf16 v[60:63], v[108:111], a[32:35], v[60:63]
    ds_read_b64_tr_b16 a[60:61], v27 offset:43136
    ds_read_b64_tr_b16 a[62:63], v27 offset:43648
    s_waitcnt lgkmcnt(12)
    v_mfma_f32_16x16x32_bf16 v[64:67], v[108:111], a[36:39], v[64:67]
    ds_read_b64_tr_b16 a[64:65], v24 offset:51328
    ds_read_b64_tr_b16 a[66:67], v24 offset:51840
    s_waitcnt lgkmcnt(12)
    v_mfma_f32_16x16x32_bf16 v[68:71], v[108:111], a[40:43], v[68:71]
    ds_read_b64_tr_b16 a[68:69], v25 offset:51328
    ds_read_b64_tr_b16 a[70:71], v25 offset:51840
    s_waitcnt lgkmcnt(12)
    v_mfma_f32_16x16x32_bf16 v[72:75], v[108:111], a[44:47], v[72:75]
    ds_read_b64_tr_b16 a[72:73], v26 offset:51328
    ds_read_b64_tr_b16 a[74:75], v26 offset:51840
    s_waitcnt lgkmcnt(12)
    v_mfma_f32_16x16x32_bf16 v[28:31], a[48:51], v[116:119], v[28:31]
    ds_read_b64_tr_b16 a[76:77], v27 offset:51328
    ds_read_b64_tr_b16 a[78:79], v27 offset:51840
    s_waitcnt lgkmcnt(12)
    v_mfma_f32_16x16x32_bf16 v[32:35], a[52:55], v[116:119], v[32:35]
    ds_read_b64_tr_b16 a[80:81], v24 offset:59520
    ds_read_b64_tr_b16 a[82:83], v24 offset:60032
    s_waitcnt lgkmcnt(12)
    v_mfma_f32_16x16x32_bf16 v[36:39], a[56:59], v[116:119], v[36:39]
    ds_read_b64_tr_b16 a[84:85], v25 offset:59520
    ds_read_b64_tr_b16 a[86:87], v25 offset:60032
    s_waitcnt lgkmcnt(12)
    v_mfma_f32_16x16x32_bf16 v[40:43], a[60:63], v[116:119], v[40:43]
    ds_read_b64_tr_b16 a[88:89], v26 offset:59520
    ds_read_b64_tr_b16 a[90:91], v26 offset:60032
    s_waitcnt lgkmcnt(12)
    v_mfma_f32_16x16x32_bf16 v[44:47], a[64:67], v[112:115], v[44:47]
    ds_read_b64_tr_b16 a[92:93], v27 offset:59520
    ds_read_b64_tr_b16 a[94:95], v27 offset:60032
    s_waitcnt lgkmcnt(12)
    v_mfma_f32_16x16x32_bf16 v[48:51], a[68:71], v[112:115], v[48:51]
    s_waitcnt lgkmcnt(10)
    v_mfma_f32_16x16x32_bf16 v[52:55], a[72:75], v[112:115], v[52:55]
    s_waitcnt lgkmcnt(8)
    v_mfma_f32_16x16x32_bf16 v[56:59], a[76:79], v[112:115], v[56:59]
    s_waitcnt lgkmcnt(6)
    v_mfma_f32_16x16x32_bf16 v[60:63], v[112:115], a[80:83], v[60:63]
    s_waitcnt lgkmcnt(4)
    v_mfma_f32_16x16x32_bf16 v[64:67], v[112:115], a[84:87], v[64:67]
    s_waitcnt lgkmcnt(2)
    v_mfma_f32_16x16x32_bf16 v[68:71], v[112:115], a[88:91], v[68:71]
    s_waitcnt lgkmcnt(0)
    v_mfma_f32_16x16x32_bf16 v[72:75], v[112:115], a[92:95], v[72:75]
    v_add_u32 v4, 156224, v12
    v_min_u32 v5, 47, v1
    v_lshlrev_b32 v5, 2, v5
    v_add_u32 v5, 156480, v5
    v_lshlrev_b32 v6, 4, v2
    v_add_u32 v6, 157184, v6
    v_mov_b32 v7, 157968
    v_lshlrev_b32 v11, 2, v3
    v_add_u32 v11, 156224, v11
    s_barrier
    ds_read_b128 v[108:111], v76 offset:0
    ds_read_b128 v[112:115], v77 offset:0
    ds_read_b64_tr_b16 a[0:1], v20 offset:0
    ds_read_b64_tr_b16 a[2:3], v20 offset:512
    ds_read_b64_tr_b16 a[4:5], v21 offset:0
    ds_read_b64_tr_b16 a[6:7], v21 offset:512
    ds_read_b64_tr_b16 a[8:9], v22 offset:0
    ds_read_b64_tr_b16 a[10:11], v22 offset:512
    ds_read_b64_tr_b16 a[12:13], v23 offset:0
    ds_read_b64_tr_b16 a[14:15], v23 offset:512
    ds_read_b64_tr_b16 a[16:17], v20 offset:8192
    ds_read_b64_tr_b16 a[18:19], v20 offset:8704
    ds_read_b64_tr_b16 a[20:21], v21 offset:8192
    ds_read_b64_tr_b16 a[22:23], v21 offset:8704
    ds_read_b64_tr_b16 a[24:25], v22 offset:8192
    ds_read_b64_tr_b16 a[26:27], v22 offset:8704
    s_waitcnt lgkmcnt(12)
    v_mfma_f32_16x16x32_bf16 v[28:31], a[0:3], v[116:119], v[28:31]
    ds_read_b64_tr_b16 a[28:29], v23 offset:8192
    ds_read_b64_tr_b16 a[30:31], v23 offset:8704
    s_waitcnt lgkmcnt(12)
    v_mfma_f32_16x16x32_bf16 v[32:35], a[4:7], v[116:119], v[32:35]
    ds_read_b64_tr_b16 a[32:33], v20 offset:16384
    ds_read_b64_tr_b16 a[34:35], v20 offset:16896
    s_waitcnt lgkmcnt(12)
    v_mfma_f32_16x16x32_bf16 v[36:39], a[8:11], v[116:119], v[36:39]
    ds_read_b64_tr_b16 a[36:37], v21 offset:16384
    ds_read_b64_tr_b16 a[38:39], v21 offset:16896
    s_waitcnt lgkmcnt(12)
    v_mfma_f32_16x16x32_bf16 v[40:43], a[12:15], v[116:119], v[40:43]
    ds_read_b64_tr_b16 a[40:41], v22 offset:16384
    ds_read_b64_tr_b16 a[42:43], v22 offset:16896
    s_waitcnt lgkmcnt(12)
    v_mfma_f32_16x16x32_bf16 v[44:47], a[16:19], v[108:111], v[44:47]
    ds_read_b64_tr_b16 a[44:45], v23 offset:16384
    ds_read_b64_tr_b16 a[46:47], v23 offset:16896
    s_waitcnt lgkmcnt(12)
    v_mfma_f32_16x16x32_bf16 v[48:51], a[20:23], v[108:111], v[48:51]
    ds_read_b64_tr_b16 a[48:49], v20 offset:4096
    ds_read_b64_tr_b16 a[50:51], v20 offset:4608
    s_waitcnt lgkmcnt(12)
    v_mfma_f32_16x16x32_bf16 v[52:55], a[24:27], v[108:111], v[52:55]
    ds_read_b64_tr_b16 a[52:53], v21 offset:4096
    ds_read_b64_tr_b16 a[54:55], v21 offset:4608
    s_waitcnt lgkmcnt(12)
    v_mfma_f32_16x16x32_bf16 v[56:59], a[28:31], v[108:111], v[56:59]
    ds_read_b64_tr_b16 a[56:57], v22 offset:4096
    ds_read_b64_tr_b16 a[58:59], v22 offset:4608
    s_waitcnt lgkmcnt(12)
    v_mfma_f32_16x16x32_bf16 v[60:63], v[108:111], a[32:35], v[60:63]
    ds_read_b64_tr_b16 a[60:61], v23 offset:4096
    ds_read_b64_tr_b16 a[62:63], v23 offset:4608
    s_waitcnt lgkmcnt(12)
    v_mfma_f32_16x16x32_bf16 v[64:67], v[108:111], a[36:39], v[64:67]
    ds_read_b64_tr_b16 a[64:65], v20 offset:12288
    ds_read_b64_tr_b16 a[66:67], v20 offset:12800
    s_waitcnt lgkmcnt(12)
    v_mfma_f32_16x16x32_bf16 v[68:71], v[108:111], a[40:43], v[68:71]
    ds_read_b64_tr_b16 a[68:69], v21 offset:12288
    ds_read_b64_tr_b16 a[70:71], v21 offset:12800
    s_waitcnt lgkmcnt(12)
    v_mfma_f32_16x16x32_bf16 v[72:75], v[108:111], a[44:47], v[72:75]
    ds_read_b64_tr_b16 a[72:73], v22 offset:12288
    ds_read_b64_tr_b16 a[74:75], v22 offset:12800
    s_waitcnt lgkmcnt(12)
    v_mfma_f32_16x16x32_bf16 v[28:31], a[48:51], v[116:119], v[28:31]
    ds_read_b64_tr_b16 a[76:77], v23 offset:12288
    ds_read_b64_tr_b16 a[78:79], v23 offset:12800
    s_waitcnt lgkmcnt(12)
    v_mfma_f32_16x16x32_bf16 v[32:35], a[52:55], v[116:119], v[32:35]
    ds_read_b64_tr_b16 a[80:81], v20 offset:20480
    ds_read_b64_tr_b16 a[82:83], v20 offset:20992
    s_waitcnt lgkmcnt(12)
    v_mfma_f32_16x16x32_bf16 v[36:39], a[56:59], v[116:119], v[36:39]
    ds_read_b64_tr_b16 a[84:85], v21 offset:20480
    ds_read_b64_tr_b16 a[86:87], v21 offset:20992
    s_waitcnt lgkmcnt(12)
    v_mfma_f32_16x16x32_bf16 v[40:43], a[60:63], v[116:119], v[40:43]
    ds_read_b64_tr_b16 a[88:89], v22 offset:20480
    ds_read_b64_tr_b16 a[90:91], v22 offset:20992
    s_waitcnt lgkmcnt(12)
    v_mfma_f32_16x16x32_bf16 v[44:47], a[64:67], v[112:115], v[44:47]
    ds_read_b64_tr_b16 a[92:93], v23 offset:20480
    ds_read_b64_tr_b16 a[94:95], v23 offset:20992
    s_waitcnt lgkmcnt(12)
    v_mfma_f32_16x16x32_bf16 v[48:51], a[68:71], v[112:115], v[48:51]
    s_waitcnt lgkmcnt(10)
    v_mfma_f32_16x16x32_bf16 v[52:55], a[72:75], v[112:115], v[52:55]
    s_waitcnt lgkmcnt(8)
    v_mfma_f32_16x16x32_bf16 v[56:59], a[76:79], v[112:115], v[56:59]
    s_waitcnt lgkmcnt(6)
    v_mfma_f32_16x16x32_bf16 v[60:63], v[112:115], a[80:83], v[60:63]
    s_waitcnt lgkmcnt(4)
    v_mfma_f32_16x16x32_bf16 v[64:67], v[112:115], a[84:87], v[64:67]
    s_waitcnt lgkmcnt(2)
    v_mfma_f32_16x16x32_bf16 v[68:71], v[112:115], a[88:91], v[68:71]
    s_waitcnt lgkmcnt(0)
    v_mfma_f32_16x16x32_bf16 v[72:75], v[112:115], a[92:95], v[72:75]
    s_barrier
    ds_read_b128 v[108:111], v76 offset:39040
    ds_read_b128 v[112:115], v77 offset:39040
    ds_read_b64_tr_b16 a[0:1], v20 offset:39040
    ds_read_b64_tr_b16 a[2:3], v20 offset:39552
    ds_read_b64_tr_b16 a[4:5], v21 offset:39040
    ds_read_b64_tr_b16 a[6:7], v21 offset:39552
    ds_read_b64_tr_b16 a[8:9], v22 offset:39040
    ds_read_b64_tr_b16 a[10:11], v22 offset:39552
    ds_read_b64_tr_b16 a[12:13], v23 offset:39040
    ds_read_b64_tr_b16 a[14:15], v23 offset:39552
    ds_read_b64_tr_b16 a[16:17], v20 offset:47232
    ds_read_b64_tr_b16 a[18:19], v20 offset:47744
    ds_read_b64_tr_b16 a[20:21], v21 offset:47232
    ds_read_b64_tr_b16 a[22:23], v21 offset:47744
    ds_read_b64_tr_b16 a[24:25], v22 offset:47232
    ds_read_b64_tr_b16 a[26:27], v22 offset:47744
    s_waitcnt lgkmcnt(12)
    v_mfma_f32_16x16x32_bf16 v[28:31], a[0:3], v[116:119], v[28:31]
    ds_read_b64_tr_b16 a[28:29], v23 offset:47232
    ds_read_b64_tr_b16 a[30:31], v23 offset:47744
    s_waitcnt lgkmcnt(12)
    v_mfma_f32_16x16x32_bf16 v[32:35], a[4:7], v[116:119], v[32:35]
    ds_read_b64_tr_b16 a[32:33], v20 offset:55424
    ds_read_b64_tr_b16 a[34:35], v20 offset:55936
    s_waitcnt lgkmcnt(12)
    v_mfma_f32_16x16x32_bf16 v[36:39], a[8:11], v[116:119], v[36:39]
    ds_read_b64_tr_b16 a[36:37], v21 offset:55424
    ds_read_b64_tr_b16 a[38:39], v21 offset:55936
    s_waitcnt lgkmcnt(12)
    v_mfma_f32_16x16x32_bf16 v[40:43], a[12:15], v[116:119], v[40:43]
    ds_read_b64_tr_b16 a[40:41], v22 offset:55424
    ds_read_b64_tr_b16 a[42:43], v22 offset:55936
    s_waitcnt lgkmcnt(12)
    v_mfma_f32_16x16x32_bf16 v[44:47], a[16:19], v[108:111], v[44:47]
    ds_read_b64_tr_b16 a[44:45], v23 offset:55424
    ds_read_b64_tr_b16 a[46:47], v23 offset:55936
    s_waitcnt lgkmcnt(12)
    v_mfma_f32_16x16x32_bf16 v[48:51], a[20:23], v[108:111], v[48:51]
    ds_read_b64_tr_b16 a[48:49], v20 offset:43136
    ds_read_b64_tr_b16 a[50:51], v20 offset:43648
    s_waitcnt lgkmcnt(12)
    v_mfma_f32_16x16x32_bf16 v[52:55], a[24:27], v[108:111], v[52:55]
    ds_read_b64_tr_b16 a[52:53], v21 offset:43136
    ds_read_b64_tr_b16 a[54:55], v21 offset:43648
    s_waitcnt lgkmcnt(12)
    v_mfma_f32_16x16x32_bf16 v[56:59], a[28:31], v[108:111], v[56:59]
    ds_read_b64_tr_b16 a[56:57], v22 offset:43136
    ds_read_b64_tr_b16 a[58:59], v22 offset:43648
    s_waitcnt lgkmcnt(12)
    v_mfma_f32_16x16x32_bf16 v[60:63], v[108:111], a[32:35], v[60:63]
    ds_read_b64_tr_b16 a[60:61], v23 offset:43136
    ds_read_b64_tr_b16 a[62:63], v23 offset:43648
    s_waitcnt lgkmcnt(12)
    v_mfma_f32_16x16x32_bf16 v[64:67], v[108:111], a[36:39], v[64:67]
    ds_read_b64_tr_b16 a[64:65], v20 offset:51328
    ds_read_b64_tr_b16 a[66:67], v20 offset:51840
    s_waitcnt lgkmcnt(12)
    v_mfma_f32_16x16x32_bf16 v[68:71], v[108:111], a[40:43], v[68:71]
    ds_read_b64_tr_b16 a[68:69], v21 offset:51328
    ds_read_b64_tr_b16 a[70:71], v21 offset:51840
    s_waitcnt lgkmcnt(12)
    v_mfma_f32_16x16x32_bf16 v[72:75], v[108:111], a[44:47], v[72:75]
    ds_read_b64_tr_b16 a[72:73], v22 offset:51328
    ds_read_b64_tr_b16 a[74:75], v22 offset:51840
    s_waitcnt lgkmcnt(12)
    v_mfma_f32_16x16x32_bf16 v[28:31], a[48:51], v[116:119], v[28:31]
    ds_read_b64_tr_b16 a[76:77], v23 offset:51328
    ds_read_b64_tr_b16 a[78:79], v23 offset:51840
    s_waitcnt lgkmcnt(12)
    v_mfma_f32_16x16x32_bf16 v[32:35], a[52:55], v[116:119], v[32:35]
    ds_read_b64_tr_b16 a[80:81], v20 offset:59520
    ds_read_b64_tr_b16 a[82:83], v20 offset:60032
    s_waitcnt lgkmcnt(12)
    v_mfma_f32_16x16x32_bf16 v[36:39], a[56:59], v[116:119], v[36:39]
    ds_read_b64_tr_b16 a[84:85], v21 offset:59520
    ds_read_b64_tr_b16 a[86:87], v21 offset:60032
    s_waitcnt lgkmcnt(12)
    v_mfma_f32_16x16x32_bf16 v[40:43], a[60:63], v[116:119], v[40:43]
    ds_read_b64_tr_b16 a[88:89], v22 offset:59520
    ds_read_b64_tr_b16 a[90:91], v22 offset:60032
    s_waitcnt lgkmcnt(12)
    v_mfma_f32_16x16x32_bf16 v[44:47], a[64:67], v[112:115], v[44:47]
    ds_read_b64_tr_b16 a[92:93], v23 offset:59520
    ds_read_b64_tr_b16 a[94:95], v23 offset:60032
    s_waitcnt lgkmcnt(12)
    v_mfma_f32_16x16x32_bf16 v[48:51], a[68:71], v[112:115], v[48:51]
    s_waitcnt lgkmcnt(10)
    v_mfma_f32_16x16x32_bf16 v[52:55], a[72:75], v[112:115], v[52:55]
    s_waitcnt lgkmcnt(8)
    v_mfma_f32_16x16x32_bf16 v[56:59], a[76:79], v[112:115], v[56:59]
    s_waitcnt lgkmcnt(6)
    v_mfma_f32_16x16x32_bf16 v[60:63], v[112:115], a[80:83], v[60:63]
    s_waitcnt lgkmcnt(4)
    v_mfma_f32_16x16x32_bf16 v[64:67], v[112:115], a[84:87], v[64:67]
    s_waitcnt lgkmcnt(2)
    v_mfma_f32_16x16x32_bf16 v[68:71], v[112:115], a[88:91], v[68:71]
    s_waitcnt lgkmcnt(0)
    v_mfma_f32_16x16x32_bf16 v[72:75], v[112:115], a[92:95], v[72:75]
    s_barrier
    ds_read_b128 a[96:99], v80 offset:0
    ds_read_b128 a[100:103], v81 offset:0
    ds_read_b64_tr_b16 a[0:1], v24 offset:0
    ds_read_b64_tr_b16 a[2:3], v24 offset:512
    ds_read_b64_tr_b16 a[4:5], v25 offset:0
    ds_read_b64_tr_b16 a[6:7], v25 offset:512
    ds_read_b64_tr_b16 a[8:9], v26 offset:0
    ds_read_b64_tr_b16 a[10:11], v26 offset:512
    ds_read_b64_tr_b16 a[12:13], v27 offset:0
    ds_read_b64_tr_b16 a[14:15], v27 offset:512
    ds_read_b64_tr_b16 a[16:17], v24 offset:8192
    ds_read_b64_tr_b16 a[18:19], v24 offset:8704
    ds_read_b64_tr_b16 a[20:21], v25 offset:8192
    ds_read_b64_tr_b16 a[22:23], v25 offset:8704
    ds_read_b64_tr_b16 a[24:25], v26 offset:8192
    ds_read_b64_tr_b16 a[26:27], v26 offset:8704
    s_waitcnt lgkmcnt(12)
    v_mfma_f32_16x16x32_bf16 v[28:31], a[0:3], v[116:119], v[28:31]
    ds_read_b64_tr_b16 a[28:29], v27 offset:8192
    ds_read_b64_tr_b16 a[30:31], v27 offset:8704
    s_waitcnt lgkmcnt(12)
    v_mfma_f32_16x16x32_bf16 v[32:35], a[4:7], v[116:119], v[32:35]
    ds_read_b64_tr_b16 a[48:49], v24 offset:4096
    ds_read_b64_tr_b16 a[50:51], v24 offset:4608
    s_waitcnt lgkmcnt(12)
    v_mfma_f32_16x16x32_bf16 v[36:39], a[8:11], v[116:119], v[36:39]
    ds_read_b64_tr_b16 a[52:53], v25 offset:4096
    ds_read_b64_tr_b16 a[54:55], v25 offset:4608
    s_waitcnt lgkmcnt(12)
    v_mfma_f32_16x16x32_bf16 v[40:43], a[12:15], v[116:119], v[40:43]
    ds_read_b64_tr_b16 a[56:57], v26 offset:4096
    ds_read_b64_tr_b16 a[58:59], v26 offset:4608
    s_waitcnt lgkmcnt(12)
    v_mfma_f32_16x16x32_bf16 v[44:47], a[16:19], a[96:99], v[44:47]
    ds_read_b64_tr_b16 a[60:61], v27 offset:4096
    ds_read_b64_tr_b16 a[62:63], v27 offset:4608
    s_waitcnt lgkmcnt(12)
    v_mfma_f32_16x16x32_bf16 v[48:51], a[20:23], a[96:99], v[48:51]
    ds_read_b64_tr_b16 a[64:65], v24 offset:12288
    ds_read_b64_tr_b16 a[66:67], v24 offset:12800
    s_waitcnt lgkmcnt(12)
    v_mfma_f32_16x16x32_bf16 v[52:55], a[24:27], a[96:99], v[52:55]
    ds_read_b64_tr_b16 a[68:69], v25 offset:12288
    ds_read_b64_tr_b16 a[70:71], v25 offset:12800
    s_waitcnt lgkmcnt(12)
    v_mfma_f32_16x16x32_bf16 v[56:59], a[28:31], a[96:99], v[56:59]
    ds_read_b64_tr_b16 a[72:73], v26 offset:12288
    ds_read_b64_tr_b16 a[74:75], v26 offset:12800
    s_waitcnt lgkmcnt(12)
    v_mfma_f32_16x16x32_bf16 v[28:31], a[48:51], v[116:119], v[28:31]
    ds_read_b64_tr_b16 a[76:77], v27 offset:12288
    ds_read_b64_tr_b16 a[78:79], v27 offset:12800
    s_waitcnt lgkmcnt(12)
    v_mfma_f32_16x16x32_bf16 v[32:35], a[52:55], v[116:119], v[32:35]
    s_waitcnt lgkmcnt(10)
    v_mfma_f32_16x16x32_bf16 v[36:39], a[56:59], v[116:119], v[36:39]
    s_waitcnt lgkmcnt(8)
    v_mfma_f32_16x16x32_bf16 v[40:43], a[60:63], v[116:119], v[40:43]
    s_waitcnt lgkmcnt(6)
    v_mfma_f32_16x16x32_bf16 v[44:47], a[64:67], a[100:103], v[44:47]
    s_waitcnt lgkmcnt(4)
    v_mfma_f32_16x16x32_bf16 v[48:51], a[68:71], a[100:103], v[48:51]
    s_waitcnt lgkmcnt(2)
    v_mfma_f32_16x16x32_bf16 v[52:55], a[72:75], a[100:103], v[52:55]
    s_waitcnt lgkmcnt(0)
    v_mfma_f32_16x16x32_bf16 v[56:59], a[76:79], a[100:103], v[56:59]
    s_barrier
    ds_read_b128 a[104:107], v80 offset:39040
    ds_read_b128 a[108:111], v81 offset:39040
    ds_read_b64_tr_b16 a[0:1], v24 offset:39040
    ds_read_b64_tr_b16 a[2:3], v24 offset:39552
    ds_read_b64_tr_b16 a[4:5], v25 offset:39040
    ds_read_b64_tr_b16 a[6:7], v25 offset:39552
    ds_read_b64_tr_b16 a[8:9], v26 offset:39040
    ds_read_b64_tr_b16 a[10:11], v26 offset:39552
    ds_read_b64_tr_b16 a[12:13], v27 offset:39040
    ds_read_b64_tr_b16 a[14:15], v27 offset:39552
    ds_read_b64_tr_b16 a[16:17], v24 offset:47232
    ds_read_b64_tr_b16 a[18:19], v24 offset:47744
    ds_read_b64_tr_b16 a[20:21], v25 offset:47232
    ds_read_b64_tr_b16 a[22:23], v25 offset:47744
    ds_read_b64_tr_b16 a[24:25], v26 offset:47232
    ds_read_b64_tr_b16 a[26:27], v26 offset:47744
    s_waitcnt lgkmcnt(12)
    v_mfma_f32_16x16x32_bf16 v[28:31], a[0:3], v[116:119], v[28:31]
    ds_read_b64_tr_b16 a[28:29], v27 offset:47232
    ds_read_b64_tr_b16 a[30:31], v27 offset:47744
    s_waitcnt lgkmcnt(12)
    v_mfma_f32_16x16x32_bf16 v[32:35], a[4:7], v[116:119], v[32:35]
    ds_read_b64_tr_b16 a[48:49], v24 offset:43136
    ds_read_b64_tr_b16 a[50:51], v24 offset:43648
    s_waitcnt lgkmcnt(12)
    v_mfma_f32_16x16x32_bf16 v[36:39], a[8:11], v[116:119], v[36:39]
    ds_read_b64_tr_b16 a[52:53], v25 offset:43136
    ds_read_b64_tr_b16 a[54:55], v25 offset:43648
    s_waitcnt lgkmcnt(12)
    v_mfma_f32_16x16x32_bf16 v[40:43], a[12:15], v[116:119], v[40:43]
    ds_read_b64_tr_b16 a[56:57], v26 offset:43136
    ds_read_b64_tr_b16 a[58:59], v26 offset:43648
    s_waitcnt lgkmcnt(12)
    v_mfma_f32_16x16x32_bf16 v[44:47], a[16:19], a[104:107], v[44:47]
    ds_read_b64_tr_b16 a[60:61], v27 offset:43136
    ds_read_b64_tr_b16 a[62:63], v27 offset:43648
    s_waitcnt lgkmcnt(12)
    v_mfma_f32_16x16x32_bf16 v[48:51], a[20:23], a[104:107], v[48:51]
    ds_read_b64_tr_b16 a[64:65], v24 offset:51328
    ds_read_b64_tr_b16 a[66:67], v24 offset:51840
    s_waitcnt lgkmcnt(12)
    v_mfma_f32_16x16x32_bf16 v[52:55], a[24:27], a[104:107], v[52:55]
    ds_read_b64_tr_b16 a[68:69], v25 offset:51328
    ds_read_b64_tr_b16 a[70:71], v25 offset:51840
    s_waitcnt lgkmcnt(12)
    v_mfma_f32_16x16x32_bf16 v[56:59], a[28:31], a[104:107], v[56:59]
    ds_read_b64_tr_b16 a[72:73], v26 offset:51328
    ds_read_b64_tr_b16 a[74:75], v26 offset:51840
    s_waitcnt lgkmcnt(12)
    v_mfma_f32_16x16x32_bf16 v[28:31], a[48:51], v[116:119], v[28:31]
    ds_read_b64_tr_b16 a[76:77], v27 offset:51328
    ds_read_b64_tr_b16 a[78:79], v27 offset:51840
    s_waitcnt lgkmcnt(12)
    v_mfma_f32_16x16x32_bf16 v[32:35], a[52:55], v[116:119], v[32:35]
    s_waitcnt lgkmcnt(10)
    v_mfma_f32_16x16x32_bf16 v[36:39], a[56:59], v[116:119], v[36:39]
    s_waitcnt lgkmcnt(8)
    v_mfma_f32_16x16x32_bf16 v[40:43], a[60:63], v[116:119], v[40:43]
    s_waitcnt lgkmcnt(6)
    v_mfma_f32_16x16x32_bf16 v[44:47], a[64:67], a[108:111], v[44:47]
    s_waitcnt lgkmcnt(4)
    v_mfma_f32_16x16x32_bf16 v[48:51], a[68:71], a[108:111], v[48:51]
    s_waitcnt lgkmcnt(2)
    v_mfma_f32_16x16x32_bf16 v[52:55], a[72:75], a[108:111], v[52:55]
    s_waitcnt lgkmcnt(0)
    v_mfma_f32_16x16x32_bf16 v[56:59], a[76:79], a[108:111], v[56:59]
    buffer_load_dwordx2 v[92:93], v96, s[28:31], s46 offen sc1
    buffer_load_dwordx2 v[94:95], v97, s[28:31], s46 offen sc1
    s_barrier
    ds_read_b128 a[112:115], v76 offset:0
    ds_read_b128 a[116:119], v77 offset:0
    ds_read_b64_tr_b16 a[0:1], v20 offset:0
    ds_read_b64_tr_b16 a[2:3], v20 offset:512
    ds_read_b64_tr_b16 a[4:5], v21 offset:0
    ds_read_b64_tr_b16 a[6:7], v21 offset:512
    ds_read_b64_tr_b16 a[8:9], v22 offset:0
    ds_read_b64_tr_b16 a[10:11], v22 offset:512
    ds_read_b64_tr_b16 a[12:13], v23 offset:0
    ds_read_b64_tr_b16 a[14:15], v23 offset:512
    ds_read_b64_tr_b16 a[16:17], v20 offset:8192
    ds_read_b64_tr_b16 a[18:19], v20 offset:8704
    ds_read_b64_tr_b16 a[20:21], v21 offset:8192
    ds_read_b64_tr_b16 a[22:23], v21 offset:8704
    ds_read_b64_tr_b16 a[24:25], v22 offset:8192
    ds_read_b64_tr_b16 a[26:27], v22 offset:8704
    s_waitcnt lgkmcnt(12)
    v_mfma_f32_16x16x32_bf16 v[28:31], a[0:3], v[116:119], v[28:31]
    ds_read_b64_tr_b16 a[28:29], v23 offset:8192
    ds_read_b64_tr_b16 a[30:31], v23 offset:8704
    s_waitcnt lgkmcnt(12)
    v_mfma_f32_16x16x32_bf16 v[32:35], a[4:7], v[116:119], v[32:35]
    ds_read_b64_tr_b16 a[48:49], v20 offset:4096
    ds_read_b64_tr_b16 a[50:51], v20 offset:4608
    s_waitcnt lgkmcnt(12)
    v_mfma_f32_16x16x32_bf16 v[36:39], a[8:11], v[116:119], v[36:39]
    ds_read_b64_tr_b16 a[52:53], v21 offset:4096
    ds_read_b64_tr_b16 a[54:55], v21 offset:4608
    s_waitcnt lgkmcnt(12)
    v_mfma_f32_16x16x32_bf16 v[40:43], a[12:15], v[116:119], v[40:43]
    ds_read_b64_tr_b16 a[56:57], v22 offset:4096
    ds_read_b64_tr_b16 a[58:59], v22 offset:4608
    s_waitcnt lgkmcnt(12)
    v_mfma_f32_16x16x32_bf16 v[44:47], a[16:19], a[112:115], v[44:47]
    ds_read_b64_tr_b16 a[60:61], v23 offset:4096
    ds_read_b64_tr_b16 a[62:63], v23 offset:4608
    s_waitcnt lgkmcnt(12)
    v_mfma_f32_16x16x32_bf16 v[48:51], a[20:23], a[112:115], v[48:51]
    ds_read_b64_tr_b16 a[64:65], v20 offset:12288
    ds_read_b64_tr_b16 a[66:67], v20 offset:12800
    s_waitcnt lgkmcnt(12)
    v_mfma_f32_16x16x32_bf16 v[52:55], a[24:27], a[112:115], v[52:55]
    ds_read_b64_tr_b16 a[68:69], v21 offset:12288
    ds_read_b64_tr_b16 a[70:71], v21 offset:12800
    s_waitcnt lgkmcnt(12)
    v_mfma_f32_16x16x32_bf16 v[56:59], a[28:31], a[112:115], v[56:59]
    ds_read_b64_tr_b16 a[72:73], v22 offset:12288
    ds_read_b64_tr_b16 a[74:75], v22 offset:12800
    s_waitcnt lgkmcnt(12)
    v_mfma_f32_16x16x32_bf16 v[28:31], a[48:51], v[116:119], v[28:31]
    ds_read_b64_tr_b16 a[76:77], v23 offset:12288
    ds_read_b64_tr_b16 a[78:79], v23 offset:12800
    s_waitcnt lgkmcnt(12)
    v_mfma_f32_16x16x32_bf16 v[32:35], a[52:55], v[116:119], v[32:35]
    s_waitcnt lgkmcnt(10)
    v_mfma_f32_16x16x32_bf16 v[36:39], a[56:59], v[116:119], v[36:39]
    s_waitcnt vmcnt(0)
Lst_chk:
    v_cmp_ne_u32 vcc, s34, v93
    v_cmp_ne_u32 s[36:37], s34, v95
    s_nop 0
    s_or_b64 s[36:37], s[36:37], vcc
    s_cbranch_scc1 Lst_re
    v_lshlrev_b32 v93, 16, v92
    s_waitcnt lgkmcnt(8)
    v_mfma_f32_16x16x32_bf16 v[40:43], a[60:63], v[116:119], v[40:43]
    v_and_b32 v92, 0xffff0000, v92
    v_rcp_f32 v93, v93
    s_waitcnt lgkmcnt(6)
    v_mfma_f32_16x16x32_bf16 v[44:47], a[64:67], a[116:119], v[44:47]
    v_lshlrev_b32 v95, 16, v94
    v_and_b32 v94, 0xffff0000, v94
    s_waitcnt lgkmcnt(4)
    v_mfma_f32_16x16x32_bf16 v[48:51], a[68:71], a[116:119], v[48:51]
    v_rcp_f32 v95, v95
    ds_write2st64_b32 v4, v92, v93 offset0:0 offset1:2
    s_waitcnt lgkmcnt(3)
    v_mfma_f32_16x16x32_bf16 v[52:55], a[72:75], a[116:119], v[52:55]
    ds_write2st64_b32 v5, v94, v95 offset0:0 offset1:2
    ds_read_b32 v120, v11
    s_waitcnt lgkmcnt(3)
    v_mfma_f32_16x16x32_bf16 v[56:59], a[76:79], a[116:119], v[56:59]
    s_waitcnt lgkmcnt(0)
    s_barrier
    ds_read_b128 a[120:123], v76 offset:39040
    ds_read_b128 a[124:127], v77 offset:39040
    ds_read_b64_tr_b16 a[0:1], v20 offset:39040
    ds_read_b64_tr_b16 a[2:3], v20 offset:39552
    ds_read_b64_tr_b16 a[4:5], v21 offset:39040
    ds_read_b64_tr_b16 a[6:7], v21 offset:39552
    ds_read_b64_tr_b16 a[8:9], v22 offset:39040
    ds_read_b64_tr_b16 a[10:11], v22 offset:39552
    ds_read_b64_tr_b16 a[12:13], v23 offset:39040
    ds_read_b64_tr_b16 a[14:15], v23 offset:39552
    ds_read_b64_tr_b16 a[16:17], v20 offset:47232
    ds_read_b64_tr_b16 a[18:19], v20 offset:47744
    ds_read_b64_tr_b16 a[20:21], v21 offset:47232
    ds_read_b64_tr_b16 a[22:23], v21 offset:47744
    ds_read_b64_tr_b16 a[24:25], v22 offset:47232
    ds_read_b64_tr_b16 a[26:27], v22 offset:47744
    s_waitcnt lgkmcnt(12)
    v_mfma_f32_16x16x32_bf16 v[28:31], a[0:3], v[116:119], v[28:31]
    ds_read_b64_tr_b16 a[28:29], v23 offset:47232
    ds_read_b64_tr_b16 a[30:31], v23 offset:47744
    s_waitcnt lgkmcnt(12)
    v_mfma_f32_16x16x32_bf16 v[32:35], a[4:7], v[116:119], v[32:35]
    ds_read_b64_tr_b16 a[48:49], v20 offset:43136
    ds_read_b64_tr_b16 a[50:51], v20 offset:43648
    s_waitcnt lgkmcnt(12)
    v_mfma_f32_16x16x32_bf16 v[36:39], a[8:11], v[116:119], v[36:39]
    ds_read_b64_tr_b16 a[52:53], v21 offset:43136
    ds_read_b64_tr_b16 a[54:55], v21 offset:43648
    s_waitcnt lgkmcnt(12)
    v_mfma_f32_16x16x32_bf16 v[40:43], a[12:15], v[116:119], v[40:43]
    ds_read_b64_tr_b16 a[56:57], v22 offset:43136
    ds_read_b64_tr_b16 a[58:59], v22 offset:43648
    s_waitcnt lgkmcnt(12)
    v_mfma_f32_16x16x32_bf16 v[44:47], a[16:19], a[120:123], v[44:47]
    ds_read_b64_tr_b16 a[60:61], v23 offset:43136
    ds_read_b64_tr_b16 a[62:63], v23 offset:43648
    s_waitcnt lgkmcnt(12)
    v_mfma_f32_16x16x32_bf16 v[48:51], a[20:23], a[120:123], v[48:51]
    ds_read_b64_tr_b16 a[64:65], v20 offset:51328
    ds_read_b64_tr_b16 a[66:67], v20 offset:51840
    s_waitcnt lgkmcnt(12)
    v_mfma_f32_16x16x32_bf16 v[52:55], a[24:27], a[120:123], v[52:55]
    ds_read_b64_tr_b16 a[68:69], v21 offset:51328
    ds_read_b64_tr_b16 a[70:71], v21 offset:51840
    s_waitcnt lgkmcnt(12)
    v_mfma_f32_16x16x32_bf16 v[56:59], a[28:31], a[120:123], v[56:59]
    ds_read_b64_tr_b16 a[72:73], v22 offset:51328
    ds_read_b64_tr_b16 a[74:75], v22 offset:51840
    s_waitcnt lgkmcnt(12)
    v_mfma_f32_16x16x32_bf16 v[28:31], a[48:51], v[116:119], v[28:31]
    ds_read_b64_tr_b16 a[76:77], v23 offset:51328
    ds_read_b64_tr_b16 a[78:79], v23 offset:51840
    s_waitcnt lgkmcnt(12)
    v_mfma_f32_16x16x32_bf16 v[32:35], a[52:55], v[116:119], v[32:35]
    s_waitcnt lgkmcnt(10)
    v_mfma_f32_16x16x32_bf16 v[36:39], a[56:59], v[116:119], v[36:39]
    s_waitcnt lgkmcnt(8)
    v_mfma_f32_16x16x32_bf16 v[40:43], a[60:63], v[116:119], v[40:43]
    s_waitcnt lgkmcnt(6)
    v_mfma_f32_16x16x32_bf16 v[44:47], a[64:67], a[124:127], v[44:47]
    s_waitcnt lgkmcnt(4)
    v_mfma_f32_16x16x32_bf16 v[48:51], a[68:71], a[124:127], v[48:51]
    s_waitcnt lgkmcnt(2)
    v_mfma_f32_16x16x32_bf16 v[52:55], a[72:75], a[124:127], v[52:55]
    s_waitcnt lgkmcnt(0)
    v_mfma_f32_16x16x32_bf16 v[56:59], a[76:79], a[124:127], v[56:59]
    s_mov_b32 exec_lo, 0x00010001
    s_mov_b32 exec_hi, 0x00010001
    ds_write_b128 v6, v[28:31] offset:0
    ds_write_b128 v6, v[32:35] offset:64
    ds_write_b128 v6, v[36:39] offset:128
    ds_write_b128 v6, v[40:43] offset:192
    ds_write_b128 v6, v[44:47] offset:256
    ds_write_b128 v6, v[48:51] offset:320
    ds_write_b128 v6, v[52:55] offset:384
    ds_write_b128 v6, v[56:59] offset:448
    ds_write_b32 v7, v7
    s_mov_b64 exec, -1
    ds_read_b128 v[76:79], v6 offset:256
    ds_read_b128 v[80:83], v6 offset:320
    ds_read_b128 v[84:87], v6 offset:384
    ds_read_b128 v[88:91], v6 offset:448
    s_waitcnt lgkmcnt(0)
    v_fmac_f32 v44, v76, v120
    v_fmac_f32 v45, v77, v120
    v_fmac_f32 v46, v78, v120
    v_fmac_f32 v47, v79, v120
    v_cvt_pk_bf16_f32 v44, v44, v45
    v_cvt_pk_bf16_f32 v45, v46, v47
    v_fmac_f32 v48, v80, v120
    v_fmac_f32 v49, v81, v120
    v_fmac_f32 v50, v82, v120
    v_fmac_f32 v51, v83, v120
    v_cvt_pk_bf16_f32 v46, v48, v49
    v_cvt_pk_bf16_f32 v47, v50, v51
    v_fmac_f32 v52, v84, v120
    v_fmac_f32 v53, v85, v120
    v_fmac_f32 v54, v86, v120
    v_fmac_f32 v55, v87, v120
    v_cvt_pk_bf16_f32 v48, v52, v53
    v_cvt_pk_bf16_f32 v49, v54, v55
    v_fmac_f32 v56, v88, v120
    v_fmac_f32 v57, v89, v120
    v_fmac_f32 v58, v90, v120
    v_fmac_f32 v59, v91, v120
    v_cvt_pk_bf16_f32 v50, v56, v57
    v_cvt_pk_bf16_f32 v51, v58, v59
    ds_write_b128 v125, v[44:47] offset:4096
    ds_write_b128 v125, v[48:51] offset:5120
    v_mov_b32 v5, 157972
    v_mov_b32 v6, 1
    s_mov_b64 exec, 1
    ds_add_u32 v5, v6
    s_mov_b64 exec, -1
    v_mov_b32 v5, 157980
Lcw_6:
    s_sub_u32 s35, s35, 1
    s_cbranch_scc1 Lend
    ds_read_b32 v6, v5
    s_waitcnt lgkmcnt(0)
    v_readfirstlane_b32 s38, v6
    s_nop 0
    s_cmp_lt_u32 s38, 1
    s_cbranch_scc1 Lcw_6
    ds_read_b64_tr_b16 a[0:1], v24 offset:16384
    ds_read_b64_tr_b16 a[2:3], v24 offset:16896
    ds_read_b64_tr_b16 a[4:5], v25 offset:16384
    ds_read_b64_tr_b16 a[6:7], v25 offset:16896
    ds_read_b64_tr_b16 a[8:9], v26 offset:16384
    ds_read_b64_tr_b16 a[10:11], v26 offset:16896
    ds_read_b64_tr_b16 a[12:13], v27 offset:16384
    ds_read_b64_tr_b16 a[14:15], v27 offset:16896
    ds_read_b64_tr_b16 a[16:17], v24 offset:20480
    ds_read_b64_tr_b16 a[18:19], v24 offset:20992
    ds_read_b64_tr_b16 a[20:21], v25 offset:20480
    ds_read_b64_tr_b16 a[22:23], v25 offset:20992
    ds_read_b64_tr_b16 a[24:25], v26 offset:20480
    ds_read_b64_tr_b16 a[26:27], v26 offset:20992
    ds_read_b64_tr_b16 a[28:29], v27 offset:20480
    ds_read_b64_tr_b16 a[30:31], v27 offset:20992
    ds_read_b64_tr_b16 a[32:33], v24 offset:55424
    ds_read_b64_tr_b16 a[34:35], v24 offset:55936
    ds_read_b64_tr_b16 a[36:37], v25 offset:55424
    ds_read_b64_tr_b16 a[38:39], v25 offset:55936
    ds_read_b64_tr_b16 a[40:41], v26 offset:55424
    ds_read_b64_tr_b16 a[42:43], v26 offset:55936
    ds_read_b64_tr_b16 a[44:45], v27 offset:55424
    ds_read_b64_tr_b16 a[46:47], v27 offset:55936
    ds_read_b64_tr_b16 a[48:49], v24 offset:59520
    ds_read_b64_tr_b16 a[50:51], v24 offset:60032
    ds_read_b64_tr_b16 a[52:53], v25 offset:59520
    ds_read_b64_tr_b16 a[54:55], v25 offset:60032
    ds_read_b64_tr_b16 a[56:57], v26 offset:59520
    ds_read_b64_tr_b16 a[58:59], v26 offset:60032
    ds_read_b64_tr_b16 a[60:61], v27 offset:59520
    ds_read_b64_tr_b16 a[62:63], v27 offset:60032
    ds_read_b64_tr_b16 a[64:65], v20 offset:16384
    ds_read_b64_tr_b16 a[66:67], v20 offset:16896
    ds_read_b64_tr_b16 a[68:69], v21 offset:16384
    ds_read_b64_tr_b16 a[70:71], v21 offset:16896
    ds_read_b64_tr_b16 a[72:73], v22 offset:16384
    ds_read_b64_tr_b16 a[74:75], v22 offset:16896
    ds_read_b64_tr_b16 a[76:77], v23 offset:16384
    ds_read_b64_tr_b16 a[78:79], v23 offset:16896
    ds_read_b64_tr_b16 a[80:81], v20 offset:20480
    ds_read_b64_tr_b16 a[82:83], v20 offset:20992
    ds_read_b64_tr_b16 a[84:85], v21 offset:20480
    ds_read_b64_tr_b16 a[86:87], v21 offset:20992
    ds_read_b64_tr_b16 a[88:89], v22 offset:20480
    ds_read_b64_tr_b16 a[90:91], v22 offset:20992
    ds_read_b64_tr_b16 a[92:93], v23 offset:20480
    ds_read_b64_tr_b16 a[94:95], v23 offset:20992
    s_waitcnt lgkmcnt(15)
    v_mfma_f32_16x16x32_bf16 v[60:63], a[96:99], a[0:3], v[60:63]
    v_mfma_f32_16x16x32_bf16 v[64:67], a[96:99], a[4:7], v[64:67]
    v_mfma_f32_16x16x32_bf16 v[68:71], a[96:99], a[8:11], v[68:71]
    v_mfma_f32_16x16x32_bf16 v[72:75], a[96:99], a[12:15], v[72:75]
    ds_read_b64_tr_b16 a[0:1], v20 offset:55424
    ds_read_b64_tr_b16 a[2:3], v20 offset:55936
    ds_read_b64_tr_b16 a[4:5], v21 offset:55424
    ds_read_b64_tr_b16 a[6:7], v21 offset:55936
    ds_read_b64_tr_b16 a[8:9], v22 offset:55424
    ds_read_b64_tr_b16 a[10:11], v22 offset:55936
    ds_read_b64_tr_b16 a[12:13], v23 offset:55424
    ds_read_b64_tr_b16 a[14:15], v23 offset:55936
    v_mfma_f32_16x16x32_bf16 v[60:63], a[100:103], a[16:19], v[60:63]
    v_mfma_f32_16x16x32_bf16 v[64:67], a[100:103], a[20:23], v[64:67]
    v_mfma_f32_16x16x32_bf16 v[68:71], a[100:103], a[24:27], v[68:71]
    v_mfma_f32_16x16x32_bf16 v[72:75], a[100:103], a[28:31], v[72:75]
    ds_read_b64_tr_b16 a[16:17], v20 offset:59520
    ds_read_b64_tr_b16 a[18:19], v20 offset:60032
    ds_read_b64_tr_b16 a[20:21], v21 offset:59520
    ds_read_b64_tr_b16 a[22:23], v21 offset:60032
    ds_read_b64_tr_b16 a[24:25], v22 offset:59520
    ds_read_b64_tr_b16 a[26:27], v22 offset:60032
    ds_read_b64_tr_b16 a[28:29], v23 offset:59520
    ds_read_b64_tr_b16 a[30:31], v23 offset:60032
    v_mfma_f32_16x16x32_bf16 v[60:63], a[104:107], a[32:35], v[60:63]
    v_mfma_f32_16x16x32_bf16 v[64:67], a[104:107], a[36:39], v[64:67]
    v_mfma_f32_16x16x32_bf16 v[68:71], a[104:107], a[40:43], v[68:71]
    v_mfma_f32_16x16x32_bf16 v[72:75], a[104:107], a[44:47], v[72:75]
    v_mfma_f32_16x16x32_bf16 v[60:63], a[108:111], a[48:51], v[60:63]
    v_mfma_f32_16x16x32_bf16 v[64:67], a[108:111], a[52:55], v[64:67]
    v_mfma_f32_16x16x32_bf16 v[68:71], a[108:111], a[56:59], v[68:71]
    v_mfma_f32_16x16x32_bf16 v[72:75], a[108:111], a[60:63], v[72:75]
    s_waitcnt lgkmcnt(15)
    v_mfma_f32_16x16x32_bf16 v[60:63], a[112:115], a[64:67], v[60:63]
    v_mfma_f32_16x16x32_bf16 v[64:67], a[112:115], a[68:71], v[64:67]
    v_mfma_f32_16x16x32_bf16 v[68:71], a[112:115], a[72:75], v[68:71]
    v_mfma_f32_16x16x32_bf16 v[72:75], a[112:115], a[76:79], v[72:75]
    v_mfma_f32_16x16x32_bf16 v[60:63], a[116:119], a[80:83], v[60:63]
    v_mfma_f32_16x16x32_bf16 v[64:67], a[116:119], a[84:87], v[64:67]
    v_mfma_f32_16x16x32_bf16 v[68:71], a[116:119], a[88:91], v[68:71]
    v_mfma_f32_16x16x32_bf16 v[72:75], a[116:119], a[92:95], v[72:75]
    s_waitcnt lgkmcnt(8)
    v_mfma_f32_16x16x32_bf16 v[60:63], a[120:123], a[0:3], v[60:63]
    v_mfma_f32_16x16x32_bf16 v[64:67], a[120:123], a[4:7], v[64:67]
    v_mfma_f32_16x16x32_bf16 v[68:71], a[120:123], a[8:11], v[68:71]
    v_mfma_f32_16x16x32_bf16 v[72:75], a[120:123], a[12:15], v[72:75]
    s_waitcnt lgkmcnt(0)
    v_mfma_f32_16x16x32_bf16 v[60:63], a[124:127], a[16:19], v[60:63]
    v_mfma_f32_16x16x32_bf16 v[64:67], a[124:127], a[20:23], v[64:67]
    v_mfma_f32_16x16x32_bf16 v[68:71], a[124:127], a[24:27], v[68:71]
    v_mfma_f32_16x16x32_bf16 v[72:75], a[124:127], a[28:31], v[72:75]
    v_lshlrev_b32 v5, 4, v3
    v_add_u32 v5, 157696, v5
    v_mov_b32 v6, 157952
    v_lshlrev_b32 v4, 4, v2
    v_add_u32 v4, 156224, v4
    v_lshl_add_u32 v125, v1, 3, s45
    s_mov_b64 exec, 0xffff
    ds_write_b32 v5, v60 offset:0
    ds_write_b32 v5, v64 offset:4
    ds_write_b32 v5, v68 offset:8
    ds_write_b32 v5, v72 offset:12
    ds_write_b32 v6, v6
    s_mov_b64 exec, -1
    ds_read_b128 v[36:39], v5
    ds_read_b128 v[28:31], v4
    ds_read_b128 v[32:35], v4 offset:512
    s_waitcnt lgkmcnt(0)
    v_fmac_f32 v60, v28, v36
    v_fmac_f32 v61, v29, v36
    v_fmac_f32 v62, v30, v36
    v_fmac_f32 v63, v31, v36
    v_mul_f32 v60, v60, v32
    v_mul_f32 v61, v61, v33
    v_mul_f32 v62, v62, v34
    v_mul_f32 v63, v63, v35
    v_cvt_pk_bf16_f32 v60, v60, v61
    v_cvt_pk_bf16_f32 v61, v62, v63
    ds_write_b64 v125, v[60:61] offset:0
    v_fmac_f32 v64, v28, v37
    v_fmac_f32 v65, v29, v37
    v_fmac_f32 v66, v30, v37
    v_fmac_f32 v67, v31, v37
    v_mul_f32 v64, v64, v32
    v_mul_f32 v65, v65, v33
    v_mul_f32 v66, v66, v34
    v_mul_f32 v67, v67, v35
    v_cvt_pk_bf16_f32 v64, v64, v65
    v_cvt_pk_bf16_f32 v65, v66, v67
    ds_write_b64 v125, v[64:65] offset:512
    v_fmac_f32 v68, v28, v38
    v_fmac_f32 v69, v29, v38
    v_fmac_f32 v70, v30, v38
    v_fmac_f32 v71, v31, v38
    v_mul_f32 v68, v68, v32
    v_mul_f32 v69, v69, v33
    v_mul_f32 v70, v70, v34
    v_mul_f32 v71, v71, v35
    v_cvt_pk_bf16_f32 v68, v68, v69
    v_cvt_pk_bf16_f32 v69, v70, v71
    ds_write_b64 v125, v[68:69] offset:1024
    v_fmac_f32 v72, v28, v39
    v_fmac_f32 v73, v29, v39
    v_fmac_f32 v74, v30, v39
    v_fmac_f32 v75, v31, v39
    v_mul_f32 v72, v72, v32
    v_mul_f32 v73, v73, v33
    v_mul_f32 v74, v74, v34
    v_mul_f32 v75, v75, v35
    v_cvt_pk_bf16_f32 v72, v72, v73
    v_cvt_pk_bf16_f32 v73, v74, v75
    ds_write_b64 v125, v[72:73] offset:1536
    v_mov_b32 v8, 157976
    v_mov_b32 v9, 1
    s_mov_b64 exec, 1
    ds_add_u32 v8, v9
    s_mov_b64 exec, -1
    s_branch Lagent
Lst_re:
    s_sub_u32 s35, s35, 1
    s_cbranch_scc1 Lend
    buffer_load_dwordx2 v[92:93], v96, s[28:31], s46 offen sc1
    buffer_load_dwordx2 v[94:95], v97, s[28:31], s46 offen sc1
    s_waitcnt vmcnt(0)
    s_branch Lst_chk
Laux:
    s_lshl_b32 s32, s37, 3
    s_lshl_b32 s39, s38, 2
    s_add_u32 s32, s32, s36
    s_cmp_lt_u32 s37, 4
    s_cselect_b32 s39, s39, 0
    s_add_u32 s32, s32, s39
    s_and_b32 s33, s2, 3
    s_lshl_b32 s33, s33, 3
    s_and_b32 s39, s2, 4
    s_add_u32 s33, s33, s39
    s_add_u32 s33, s33, s37
    s_cmp_ge_u32 s32, 32
    s_cbranch_scc1 Lmst
    v_lshrrev_b32 v5, 3, v1
    v_and_b32 v6, 7, v1
    s_lshl_b32 s40, s3, 14
    s_cmp_eq_u32 s27, 0
    s_cbranch_scc0 Laux_u
    s_lshl_b32 s36, s33, 6
    s_lshl_b32 s37, s26, 4
    s_add_u32 s36, s36, s37
    v_add_u32 v7, s36, v5
    v_mul_u32_u24 v7, 1280, v7
    v_xor_b32 v8, v6, v2
    v_lshl_add_u32 v92, v8, 4, v7
    v_add_u32 v92, 4096, v92
    v_xor_b32 v93, 64, v92
    v_add_u32 v93, 9216, v93
    v_subrev_u32 v94, 1920, v92
    v_subrev_u32 v95, 1920, v93
    s_waitcnt lgkmcnt(0)
    s_sub_u32 s52, s4, 4096
    s_subb_u32 s53, s5, 0
    s_mov_b32 s54, 2625536
    s_mov_b32 s55, 0x20000
    s_mov_b64 s[60:61], s[12:13]
    s_mov_b32 s62, 1280
    s_mov_b32 s63, 0x20000
    s_mov_b32 m0, 131072
    s_nop 0
    buffer_load_dwordx4 v13, s[60:63], 0 offen lds
    s_mov_b64 exec, 0xffff
    buffer_load_dwordx4 v13, s[60:63], 0 offen offset:1024 lds
    s_mov_b64 exec, -1
    s_add_u32 m0, s40, 0
    s_mov_b32 s41, 0
    buffer_load_dwordx4 v92, s[52:55], s41 offen lds
    buffer_load_dwordx4 v93, s[52:55], s41 offen offset:1024 lds
    buffer_load_dwordx4 v94, s[52:55], s41 offen offset:2048 lds
    buffer_load_dwordx4 v95, s[52:55], s41 offen offset:3072 lds
    s_add_u32 m0, s40, 4096
    s_mov_b32 s41, 256
    buffer_load_dwordx4 v92, s[52:55], s41 offen lds
    buffer_load_dwordx4 v93, s[52:55], s41 offen offset:1024 lds
    buffer_load_dwordx4 v94, s[52:55], s41 offen offset:2048 lds
    buffer_load_dwordx4 v95, s[52:55], s41 offen offset:3072 lds
    s_add_u32 m0, s40, 8192
    s_mov_b32 s41, 512
    buffer_load_dwordx4 v92, s[52:55], s41 offen lds
    buffer_load_dwordx4 v93, s[52:55], s41 offen offset:1024 lds
    buffer_load_dwordx4 v94, s[52:55], s41 offen offset:2048 lds
    buffer_load_dwordx4 v95, s[52:55], s41 offen offset:3072 lds
    s_add_u32 m0, s40, 12288
    s_mov_b32 s41, 768
    buffer_load_dwordx4 v92, s[52:55], s41 offen lds
    buffer_load_dwordx4 v93, s[52:55], s41 offen offset:1024 lds
    buffer_load_dwordx4 v94, s[52:55], s41 offen offset:2048 lds
    buffer_load_dwordx4 v95, s[52:55], s41 offen offset:3072 lds
    s_mov_b64 s[28:29], s[24:25]
    s_mov_b32 s30, 268435456
    s_mov_b32 s31, 0x20000
    s_load_dword s34, s[28:29], 0
    s_mov_b64 s[44:45], s[14:15]
    s_mov_b32 s46, 2211840
    s_mov_b32 s47, 0x20000
    s_mov_b64 s[48:49], s[18:19]
    s_mov_b32 s50, 2211840
    s_mov_b32 s51, 0x20000
    v_and_b32 v8, 1, v2
    v_lshlrev_b32 v8, 1, v8
    v_xor_b32 v8, v8, v6
    v_lshlrev_b32 v8, 4, v8
    v_mul_u32_u24 v9, 3456, v5
    s_lshl_b32 s38, s32, 7
    v_add3_u32 v18, v9, v8, s38
    v_xor_b32 v19, 64, v18
    v_add_u32 v19, 26624, v19
    v_add_u32 v20, 53248, v18
    v_add_u32 v21, 53248, v19
    s_mul_i32 s42, s26, 110592
    v_mul_u32_u24 v9, 1280, v5
    v_add_u32 v22, v9, v8
    v_xor_b32 v23, 64, v22
    v_add_u32 v23, 9216, v23
    v_add_u32 v24, 18432, v22
    v_add_u32 v25, 18432, v23
    s_mul_i32 s43, s32, 81920
    s_lshl_b32 s38, s3, 7
    s_add_u32 s43, s43, s38
    v_mov_b32 v96, 0x3f803f80
    v_mov_b32 v97, 0x3f803f80
    v_mov_b32 v98, 0x3f803f80
    v_mov_b32 v99, 0x3f803f80
    v_lshlrev_b32 v100, 4, v2
    v_add_u32 v100, 131072, v100
    v_lshrrev_b32 v10, 1, v3
    v_xor_b32 v10, v10, v2
    v_lshlrev_b32 v10, 4, v10
    v_lshl_add_u32 v10, v3, 7, v10
    v_add_u32 v102, s40, v10
    v_xor_b32 v103, 64, v102
    s_mov_b32 s58, 0xaaaaaaaa
    s_mov_b32 s59, 0xaaaaaaaa
    s_mov_b32 s64, 0xcccccccc
    s_mov_b32 s65, 0xcccccccc
    v_lshrrev_b32 v101, 2, v3
    v_lshl_add_u32 v101, v101, 4, v3
    v_lshlrev_b32 v101, 2, v101
    s_lshl_b32 s36, s26, 4
    v_add_u32 v10, s36, v3
    s_lshl_b32 s37, s33, 6
    s_sub_u32 s37, 2047, s37
    v_sub_u32 v106, s37, v10
    v_lshlrev_b32 v107, 2, v10
    v_add_u32 v107, 132608, v107
    s_lshl_b32 s36, s33, 9
    s_add_u32 s36, s36, 8192000
    v_lshl_add_u32 v108, v10, 3, s36
    v_bfe_u32 v10, v1, 2, 2
    v_and_b32 v8, 3, v1
    v_lshl_add_u32 v14, v2, 3, v10
    v_lshlrev_b32 v14, 7, v14
    v_lshlrev_b32 v9, 2, v1
    v_and_b32 v9, 0x60, v9
    v_add3_u32 v14, v14, v9, s40
    v_lshl_add_u32 v14, v8, 3, v14
    v_xor_b32 v15, 32, v14
    v_xor_b32 v16, 64, v14
    v_xor_b32 v17, 96, v14
    s_lshl_b32 s36, s26, 6
    s_add_u32 s36, s36, 141312
    v_lshl_add_u32 v26, v2, 4, s36
    v_min_u32 v8, 2, v3
    v_mul_u32_u24 v8, 1536, v8
    v_add_u32 v26, v26, v8
    v_add_u32 v4, 132864, v12
    v_mov_b32 v5, 0
    ds_write_b32 v4, v5
    s_waitcnt lgkmcnt(0)
    s_add_u32 s34, s34, 0x9e3779b8
    s_or_b32 s34, s34, 1
    s_waitcnt vmcnt(12)
    ds_read_b128 a[80:83], v102 offset:0
    ds_read_b128 a[84:87], v100 offset:0
    ds_read_b128 a[88:91], v103 offset:0
    ds_read_b128 a[92:95], v100 offset:64
    ds_read_b128 a[96:99], v102 offset:2048
    ds_read_b128 a[100:103], v100 offset:128
    ds_read_b128 a[104:107], v103 offset:2048
    ds_read_b128 a[108:111], v100 offset:192
    s_waitcnt lgkmcnt(0)
    s_add_u32 m0, s40, 0
    s_mov_b32 s41, 1024
    buffer_load_dwordx4 v92, s[52:55], s41 offen lds
    buffer_load_dwordx4 v93, s[52:55], s41 offen offset:1024 lds
    buffer_load_dwordx4 v94, s[52:55], s41 offen offset:2048 lds
    buffer_load_dwordx4 v95, s[52:55], s41 offen offset:3072 lds
    s_barrier
    v_mfma_f32_16x16x32_bf16 v[116:119], a[80:83], a[80:83], 0
    v_mfma_f32_16x16x32_bf16 v[112:115], v[96:99], a[80:83], 0
    v_mfma_f32_16x16x32_bf16 v[120:123], a[84:87], a[80:83], 0
    v_mfma_f32_16x16x32_bf16 v[124:127], a[84:87], v[96:99], 0
    v_mfma_f32_16x16x32_bf16 v[116:119], a[88:91], a[88:91], v[116:119]
    v_mfma_f32_16x16x32_bf16 v[112:115], v[96:99], a[88:91], v[112:115]
    v_mfma_f32_16x16x32_bf16 v[120:123], a[92:95], a[88:91], v[120:123]
    v_mfma_f32_16x16x32_bf16 v[124:127], a[92:95], v[96:99], v[124:127]
    v_mfma_f32_16x16x32_bf16 v[116:119], a[96:99], a[96:99], v[116:119]
    v_mfma_f32_16x16x32_bf16 v[112:115], v[96:99], a[96:99], v[112:115]
    v_mfma_f32_16x16x32_bf16 v[120:123], a[100:103], a[96:99], v[120:123]
    v_mfma_f32_16x16x32_bf16 v[124:127], a[100:103], v[96:99], v[124:127]
    v_mfma_f32_16x16x32_bf16 v[116:119], a[104:107], a[104:107], v[116:119]
    v_mfma_f32_16x16x32_bf16 v[112:115], v[96:99], a[104:107], v[112:115]
    v_mfma_f32_16x16x32_bf16 v[120:123], a[108:111], a[104:107], v[120:123]
    v_mfma_f32_16x16x32_bf16 v[124:127], a[108:111], v[96:99], v[124:127]
    s_waitcnt vmcnt(12)
    ds_read_b128 a[80:83], v102 offset:4096
    ds_read_b128 a[84:87], v100 offset:256
    ds_read_b128 a[88:91], v103 offset:4096
    ds_read_b128 a[92:95], v100 offset:320
    ds_read_b128 a[96:99], v102 offset:6144
    ds_read_b128 a[100:103], v100 offset:384
    ds_read_b128 a[104:107], v103 offset:6144
    ds_read_b128 a[108:111], v100 offset:448
    s_waitcnt lgkmcnt(0)
    v_mfma_f32_16x16x32_bf16 v[116:119], a[80:83], a[80:83], v[116:119]
    v_mfma_f32_16x16x32_bf16 v[112:115], v[96:99], a[80:83], v[112:115]
    v_mfma_f32_16x16x32_bf16 v[120:123], a[84:87], a[80:83], v[120:123]
    v_mfma_f32_16x16x32_bf16 v[124:127], a[84:87], v[96:99], v[124:127]
    v_mfma_f32_16x16x32_bf16 v[116:119], a[88:91], a[88:91], v[116:119]
    v_mfma_f32_16x16x32_bf16 v[112:115], v[96:99], a[88:91], v[112:115]
    v_mfma_f32_16x16x32_bf16 v[120:123], a[92:95], a[88:91], v[120:123]
    v_mfma_f32_16x16x32_bf16 v[124:127], a[92:95], v[96:99], v[124:127]
    v_mfma_f32_16x16x32_bf16 v[116:119], a[96:99], a[96:99], v[116:119]
    v_mfma_f32_16x16x32_bf16 v[112:115], v[96:99], a[96:99], v[112:115]
    v_mfma_f32_16x16x32_bf16 v[120:123], a[100:103], a[96:99], v[120:123]
    v_mfma_f32_16x16x32_bf16 v[124:127], a[100:103], v[96:99], v[124:127]
    v_mfma_f32_16x16x32_bf16 v[116:119], a[104:107], a[104:107], v[116:119]
    v_mfma_f32_16x16x32_bf16 v[112:115], v[96:99], a[104:107], v[112:115]
    v_mfma_f32_16x16x32_bf16 v[120:123], a[108:111], a[104:107], v[120:123]
    v_mfma_f32_16x16x32_bf16 v[124:127], a[108:111], v[96:99], v[124:127]
    s_waitcnt vmcnt(8)
    ds_read_b128 a[80:83], v102 offset:8192
    ds_read_b128 a[84:87], v100 offset:512
    ds_read_b128 a[88:91], v103 offset:8192
    ds_read_b128 a[92:95], v100 offset:576
    ds_read_b128 a[96:99], v102 offset:10240
    ds_read_b128 a[100:103], v100 offset:640
    ds_read_b128 a[104:107], v103 offset:10240
    ds_read_b128 a[108:111], v100 offset:704
    s_waitcnt lgkmcnt(0)
    v_mfma_f32_16x16x32_bf16 v[116:119], a[80:83], a[80:83], v[116:119]
    v_mfma_f32_16x16x32_bf16 v[112:115], v[96:99], a[80:83], v[112:115]
    v_mfma_f32_16x16x32_bf16 v[120:123], a[84:87], a[80:83], v[120:123]
    v_mfma_f32_16x16x32_bf16 v[124:127], a[84:87], v[96:99], v[124:127]
    v_mfma_f32_16x16x32_bf16 v[116:119], a[88:91], a[88:91], v[116:119]
    v_mfma_f32_16x16x32_bf16 v[112:115], v[96:99], a[88:91], v[112:115]
    v_mfma_f32_16x16x32_bf16 v[120:123], a[92:95], a[88:91], v[120:123]
    v_mfma_f32_16x16x32_bf16 v[124:127], a[92:95], v[96:99], v[124:127]
    v_mfma_f32_16x16x32_bf16 v[116:119], a[96:99], a[96:99], v[116:119]
    v_mfma_f32_16x16x32_bf16 v[112:115], v[96:99], a[96:99], v[112:115]
    v_mfma_f32_16x16x32_bf16 v[120:123], a[100:103], a[96:99], v[120:123]
    v_mfma_f32_16x16x32_bf16 v[124:127], a[100:103], v[96:99], v[124:127]
    v_mfma_f32_16x16x32_bf16 v[116:119], a[104:107], a[104:107], v[116:119]
    v_mfma_f32_16x16x32_bf16 v[112:115], v[96:99], a[104:107], v[112:115]
    v_mfma_f32_16x16x32_bf16 v[120:123], a[108:111], a[104:107], v[120:123]
    v_mfma_f32_16x16x32_bf16 v[124:127], a[108:111], v[96:99], v[124:127]
    s_waitcnt vmcnt(4)
    ds_read_b128 a[80:83], v102 offset:12288
    ds_read_b128 a[84:87], v100 offset:768
    ds_read_b128 a[88:91], v103 offset:12288
    ds_read_b128 a[92:95], v100 offset:832
    ds_read_b128 a[96:99], v102 offset:14336
    ds_read_b128 a[100:103], v100 offset:896
    ds_read_b128 a[104:107], v103 offset:14336
    ds_read_b128 a[108:111], v100 offset:960
    s_waitcnt lgkmcnt(0)
    v_mfma_f32_16x16x32_bf16 v[116:119], a[80:83], a[80:83], v[116:119]
    v_mfma_f32_16x16x32_bf16 v[112:115], v[96:99], a[80:83], v[112:115]
    v_mfma_f32_16x16x32_bf16 v[120:123], a[84:87], a[80:83], v[120:123]
    v_mfma_f32_16x16x32_bf16 v[124:127], a[84:87], v[96:99], v[124:127]
    v_mfma_f32_16x16x32_bf16 v[116:119], a[88:91], a[88:91], v[116:119]
    v_mfma_f32_16x16x32_bf16 v[112:115], v[96:99], a[88:91], v[112:115]
    v_mfma_f32_16x16x32_bf16 v[120:123], a[92:95], a[88:91], v[120:123]
    v_mfma_f32_16x16x32_bf16 v[124:127], a[92:95], v[96:99], v[124:127]
    v_mfma_f32_16x16x32_bf16 v[116:119], a[96:99], a[96:99], v[116:119]
    v_mfma_f32_16x16x32_bf16 v[112:115], v[96:99], a[96:99], v[112:115]
    v_mfma_f32_16x16x32_bf16 v[120:123], a[100:103], a[96:99], v[120:123]
    v_mfma_f32_16x16x32_bf16 v[124:127], a[100:103], v[96:99], v[124:127]
    v_mfma_f32_16x16x32_bf16 v[116:119], a[104:107], a[104:107], v[116:119]
    v_mfma_f32_16x16x32_bf16 v[112:115], v[96:99], a[104:107], v[112:115]
    v_mfma_f32_16x16x32_bf16 v[120:123], a[108:111], a[104:107], v[120:123]
    v_mfma_f32_16x16x32_bf16 v[124:127], a[108:111], v[96:99], v[124:127]
    s_waitcnt vmcnt(0)
    ds_read_b128 a[80:83], v102 offset:0
    ds_read_b128 a[84:87], v100 offset:1024
    ds_read_b128 a[88:91], v103 offset:0
    ds_read_b128 a[92:95], v100 offset:1088
    ds_read_b128 a[96:99], v102 offset:2048
    ds_read_b128 a[100:103], v100 offset:1152
    ds_read_b128 a[104:107], v103 offset:2048
    ds_read_b128 a[108:111], v100 offset:1216
    s_waitcnt lgkmcnt(0)
    v_mfma_f32_16x16x32_bf16 v[116:119], a[80:83], a[80:83], v[116:119]
    v_mfma_f32_16x16x32_bf16 v[112:115], v[96:99], a[80:83], v[112:115]
    v_mfma_f32_16x16x32_bf16 v[120:123], a[84:87], a[80:83], v[120:123]
    v_mfma_f32_16x16x32_bf16 v[124:127], a[84:87], v[96:99], v[124:127]
    v_mfma_f32_16x16x32_bf16 v[116:119], a[88:91], a[88:91], v[116:119]
    v_mfma_f32_16x16x32_bf16 v[112:115], v[96:99], a[88:91], v[112:115]
    v_mfma_f32_16x16x32_bf16 v[120:123], a[92:95], a[88:91], v[120:123]
    v_mfma_f32_16x16x32_bf16 v[124:127], a[92:95], v[96:99], v[124:127]
    v_mfma_f32_16x16x32_bf16 v[116:119], a[96:99], a[96:99], v[116:119]
    v_mfma_f32_16x16x32_bf16 v[112:115], v[96:99], a[96:99], v[112:115]
    v_mfma_f32_16x16x32_bf16 v[120:123], a[100:103], a[96:99], v[120:123]
    v_mfma_f32_16x16x32_bf16 v[124:127], a[100:103], v[96:99], v[124:127]
    v_mfma_f32_16x16x32_bf16 v[116:119], a[104:107], a[104:107], v[116:119]
    v_mfma_f32_16x16x32_bf16 v[112:115], v[96:99], a[104:107], v[112:115]
    v_mfma_f32_16x16x32_bf16 v[120:123], a[108:111], a[104:107], v[120:123]
    v_mfma_f32_16x16x32_bf16 v[124:127], a[108:111], v[96:99], v[124:127]
    s_nop 4
    v_cndmask_b32 v4, v116, v117, s[58:59]
    v_cndmask_b32 v5, v118, v119, s[58:59]
    v_cndmask_b32 v4, v4, v5, s[64:65]
    ds_bpermute_b32 v4, v101, v4
    v_mul_f32 v5, 0xbacccccd, v112
    v_cvt_pk_bf16_f32 v104, v5, v5
    v_lshlrev_b32 v104, 16, v104
    v_mul_f32 v5, v5, v5
    v_mov_b32 v6, 0x3acccccd
    s_waitcnt lgkmcnt(0)
    v_fma_f32 v4, v4, v6, -v5
    v_max_f32 v4, 0, v4
    v_cvt_pk_bf16_f32 v4, v4, v4
    v_lshlrev_b32 v4, 16, v4
    v_add_f32 v4, 0x3727c5ac, v4
    v_cvt_pk_bf16_f32 v4, v4, v4
    v_lshlrev_b32 v4, 16, v4
    v_sqrt_f32 v4, v4
    s_nop 0
    v_cvt_pk_bf16_f32 v4, v4, v4
    v_lshlrev_b32 v4, 16, v4
    v_rcp_f32 v105, v4
    v_lshrrev_b32 v8, 16, v4
    v_fma_f32 v4, v104, v124, v120
    v_mul_f32 v4, v4, v105
    v_cvt_pk_bf16_f32 v4, v4, v4
    v_ashrrev_i32 v5, 31, v4
    v_or_b32 v5, 0x80000000, v5
    v_xor_b32 v4, v4, v5
    v_and_b32 v4, 0xffff0000, v4
    v_or_b32 v4, v4, v106
    ds_write_b32 v107, v4
    v_mov_b32 v11, 132864
    v_mov_b32 v7, 1
    s_mov_b64 exec, 1
    ds_add_u32 v11, v7
    s_mov_b64 exec, -1
    v_or_b32 v8, v8, v104
    v_mov_b32 v9, s34
    s_mov_b64 exec, 0xffff
    buffer_store_dwordx2 v[8:9], v108, s[28:31], 0 offen sc1
    s_mov_b64 exec, -1
    s_cmp_lg_u32 s26, 0
    s_cbranch_scc1 Lpub_done
    s_setprio 3
Lcw_9:
    s_sub_u32 s35, s35, 1
    s_cbranch_scc1 Lend
    ds_read_b32 v7, v11
    s_waitcnt lgkmcnt(0)
    v_readfirstlane_b32 s38, v7
    s_nop 0
    s_cmp_lt_u32 s38, 4
    s_cbranch_scc1 Lcw_9
    v_add_u32 v5, 132608, v12
    ds_read_b32 v6, v5
    s_waitcnt lgkmcnt(0)
    v_mov_b32 v4, v6
    s_nop 1
    v_max_u32_dpp v4, v4, v4 row_ror:8 row_mask:0xf bank_mask:0xf
    s_nop 1
    v_max_u32_dpp v4, v4, v4 row_ror:4 row_mask:0xf bank_mask:0xf
    s_nop 1
    v_max_u32_dpp v4, v4, v4 row_ror:2 row_mask:0xf bank_mask:0xf
    s_nop 1
    v_max_u32_dpp v4, v4, v4 row_ror:1 row_mask:0xf bank_mask:0xf
    s_nop 0
    v_readlane_b32 s66, v4, 0
    v_readlane_b32 s36, v4, 16
    v_readlane_b32 s37, v4, 32
    v_readlane_b32 s38, v4, 48
    s_max_u32 s66, s66, s36
    s_max_u32 s37, s37, s38
    s_max_u32 s66, s66, s37
    v_cmp_eq_u32 vcc, s66, v6
    s_nop 1
    v_cndmask_b32 v4, v6, 0, vcc
    s_nop 1
    v_max_u32_dpp v4, v4, v4 row_ror:8 row_mask:0xf bank_mask:0xf
    s_nop 1
    v_max_u32_dpp v4, v4, v4 row_ror:4 row_mask:0xf bank_mask:0xf
    s_nop 1
    v_max_u32_dpp v4, v4, v4 row_ror:2 row_mask:0xf bank_mask:0xf
    s_nop 1
    v_max_u32_dpp v4, v4, v4 row_ror:1 row_mask:0xf bank_mask:0xf
    s_nop 0
    v_readlane_b32 s67, v4, 0
    v_readlane_b32 s36, v4, 16
    v_readlane_b32 s37, v4, 32
    v_readlane_b32 s38, v4, 48
    s_max_u32 s67, s67, s36
    s_max_u32 s37, s37, s38
    s_max_u32 s67, s67, s37
    v_mov_b32 v112, s66
    v_mov_b32 v113, s34
    v_mov_b32 v114, s67
    v_mov_b32 v115, s34
    s_lshl_b32 s36, s32, 7
    s_add_u32 s36, s36, 8126464
    s_mov_b64 exec, 0xff
    buffer_store_dwordx4 v[112:115], v13, s[28:31], s36 offen sc1
    s_mov_b64 exec, -1
    v_mov_b32 v11, 132864
    v_mov_b32 v7, 1
    s_mov_b64 exec, 1
    ds_add_u32 v11, v7
    s_mov_b64 exec, -1
    s_mov_b64 exec, 1
    s_lshl_b32 s36, s2, 2
    s_add_u32 s36, s36, 8323072
    v_mov_b32 v4, s34
    v_mov_b32 v5, s36
    buffer_store_dword v4, v5, s[28:31], 0 offen sc1
    s_mov_b64 exec, -1
    s_setprio 0
Lpub_done:
Lcw_10:
    s_sub_u32 s35, s35, 1
    s_cbranch_scc1 Lend
    ds_read_b32 v7, v11
    s_waitcnt lgkmcnt(0)
    v_readfirstlane_b32 s38, v7
    s_nop 0
    s_cmp_lt_u32 s38, 5
    s_cbranch_scc1 Lcw_10
    s_cmp_ge_u32 s32, 27
    s_cbranch_scc1 Lhelp_r
    s_add_u32 m0, s40, 0
    s_add_u32 s41, s42, 0
    buffer_load_dwordx4 v18, s[44:47], s41 offen nt lds
    buffer_load_dwordx4 v19, s[44:47], s41 offen offset:1024 nt lds
    buffer_load_dwordx4 v20, s[44:47], s41 offen offset:2048 nt lds
    buffer_load_dwordx4 v21, s[44:47], s41 offen offset:3072 nt lds
    s_add_u32 m0, s40, 4096
    s_add_u32 s41, s42, 442368
    buffer_load_dwordx4 v18, s[44:47], s41 offen nt lds
    buffer_load_dwordx4 v19, s[44:47], s41 offen offset:1024 nt lds
    buffer_load_dwordx4 v20, s[44:47], s41 offen offset:2048 nt lds
    buffer_load_dwordx4 v21, s[44:47], s41 offen offset:3072 nt lds
    s_add_u32 m0, s40, 8192
    s_add_u32 s41, s42, 884736
    buffer_load_dwordx4 v18, s[44:47], s41 offen nt lds
    buffer_load_dwordx4 v19, s[44:47], s41 offen offset:1024 nt lds
    buffer_load_dwordx4 v20, s[44:47], s41 offen offset:2048 nt lds
    buffer_load_dwordx4 v21, s[44:47], s41 offen offset:3072 nt lds
    s_add_u32 m0, s40, 12288
    s_add_u32 s41, s42, 1327104
    buffer_load_dwordx4 v18, s[44:47], s41 offen nt lds
    buffer_load_dwordx4 v19, s[44:47], s41 offen offset:1024 nt lds
    buffer_load_dwordx4 v20, s[44:47], s41 offen offset:2048 nt lds
    buffer_load_dwordx4 v21, s[44:47], s41 offen offset:3072 nt lds
    s_waitcnt vmcnt(12)
    ds_read_b64_tr_b16 a[0:1], v14 offset:0
    ds_read_b64_tr_b16 a[2:3], v14 offset:512
    ds_read_b64_tr_b16 a[4:5], v15 offset:0
    ds_read_b64_tr_b16 a[6:7], v15 offset:512
    ds_read_b64_tr_b16 a[8:9], v16 offset:0
    ds_read_b64_tr_b16 a[10:11], v16 offset:512
    ds_read_b64_tr_b16 a[12:13], v17 offset:0
    ds_read_b64_tr_b16 a[14:15], v17 offset:512
    s_waitcnt lgkmcnt(0)
    s_add_u32 m0, s40, 0
    s_add_u32 s41, s42, 1769472
    buffer_load_dwordx4 v18, s[44:47], s41 offen nt lds
    buffer_load_dwordx4 v19, s[44:47], s41 offen offset:1024 nt lds
    buffer_load_dwordx4 v20, s[44:47], s41 offen offset:2048 nt lds
    buffer_load_dwordx4 v21, s[44:47], s41 offen offset:3072 nt lds
    v_mov_b32 v11, 132864
    v_mov_b32 v7, 1
    s_mov_b64 exec, 1
    ds_add_u32 v11, v7
    s_mov_b64 exec, -1
    s_waitcnt vmcnt(12)
    ds_read_b64_tr_b16 a[16:17], v14 offset:4096
    ds_read_b64_tr_b16 a[18:19], v14 offset:4608
    ds_read_b64_tr_b16 a[20:21], v15 offset:4096
    ds_read_b64_tr_b16 a[22:23], v15 offset:4608
    ds_read_b64_tr_b16 a[24:25], v16 offset:4096
    ds_read_b64_tr_b16 a[26:27], v16 offset:4608
    ds_read_b64_tr_b16 a[28:29], v17 offset:4096
    ds_read_b64_tr_b16 a[30:31], v17 offset:4608
    s_waitcnt lgkmcnt(0)
    s_add_u32 m0, s40, 4096
    s_add_u32 s41, s43, 0
    buffer_load_dwordx4 v22, s[48:51], s41 offen nt lds
    buffer_load_dwordx4 v23, s[48:51], s41 offen offset:1024 nt lds
    buffer_load_dwordx4 v24, s[48:51], s41 offen offset:2048 nt lds
    buffer_load_dwordx4 v25, s[48:51], s41 offen offset:3072 nt lds
    s_waitcnt vmcnt(12)
    ds_read_b64_tr_b16 a[32:33], v14 offset:8192
    ds_read_b64_tr_b16 a[34:35], v14 offset:8704
    ds_read_b64_tr_b16 a[36:37], v15 offset:8192
    ds_read_b64_tr_b16 a[38:39], v15 offset:8704
    ds_read_b64_tr_b16 a[40:41], v16 offset:8192
    ds_read_b64_tr_b16 a[42:43], v16 offset:8704
    ds_read_b64_tr_b16 a[44:45], v17 offset:8192
    ds_read_b64_tr_b16 a[46:47], v17 offset:8704
    s_waitcnt lgkmcnt(0)
    s_add_u32 m0, s40, 8192
    s_add_u32 s41, s43, 40960
    buffer_load_dwordx4 v22, s[48:51], s41 offen nt lds
    buffer_load_dwordx4 v23, s[48:51], s41 offen offset:1024 nt lds
    buffer_load_dwordx4 v24, s[48:51], s41 offen offset:2048 nt lds
    buffer_load_dwordx4 v25, s[48:51], s41 offen offset:3072 nt lds
    s_waitcnt vmcnt(12)
    ds_read_b64_tr_b16 a[48:49], v14 offset:12288
    ds_read_b64_tr_b16 a[50:51], v14 offset:12800
    ds_read_b64_tr_b16 a[52:53], v15 offset:12288
    ds_read_b64_tr_b16 a[54:55], v15 offset:12800
    ds_read_b64_tr_b16 a[56:57], v16 offset:12288
    ds_read_b64_tr_b16 a[58:59], v16 offset:12800
    ds_read_b64_tr_b16 a[60:61], v17 offset:12288
    ds_read_b64_tr_b16 a[62:63], v17 offset:12800
    s_waitcnt vmcnt(8)
    ds_read_b64_tr_b16 a[64:65], v14 offset:0
    ds_read_b64_tr_b16 a[66:67], v14 offset:512
    ds_read_b64_tr_b16 a[68:69], v15 offset:0
    ds_read_b64_tr_b16 a[70:71], v15 offset:512
    ds_read_b64_tr_b16 a[72:73], v16 offset:0
    ds_read_b64_tr_b16 a[74:75], v16 offset:512
    ds_read_b64_tr_b16 a[76:77], v17 offset:0
    ds_read_b64_tr_b16 a[78:79], v17 offset:512
    s_branch Laux_mm
Laux_u:
    s_cmp_ge_u32 s32, 27
    s_cbranch_scc1 Lend
    v_and_b32 v8, 1, v2
    v_lshlrev_b32 v8, 1, v8
    v_xor_b32 v8, v8, v6
    v_lshlrev_b32 v8, 4, v8
    v_mul_u32_u24 v9, 3456, v5
    s_lshl_b32 s38, s32, 7
    v_add3_u32 v18, v9, v8, s38
    v_xor_b32 v19, 64, v18
    v_add_u32 v19, 26624, v19
    v_add_u32 v20, 53248, v18
    v_add_u32 v21, 53248, v19
    s_mul_i32 s42, s26, 110592
    v_mul_u32_u24 v9, 1280, v5
    v_add_u32 v22, v9, v8
    v_xor_b32 v23, 64, v22
    v_add_u32 v23, 9216, v23
    v_add_u32 v24, 18432, v22
    v_add_u32 v25, 18432, v23
    s_mul_i32 s43, s32, 81920
    s_lshl_b32 s38, s3, 7
    s_add_u32 s43, s43, s38
    s_waitcnt lgkmcnt(0)
    s_mov_b64 s[44:45], s[16:17]
    s_mov_b32 s46, 2211840
    s_mov_b32 s47, 0x20000
    s_mov_b64 s[28:29], s[24:25]
    s_mov_b32 s30, 268435456
    s_mov_b32 s31, 0x20000
    s_load_dword s34, s[28:29], 0
    s_mov_b64 s[52:53], s[4:5]
    s_mov_b32 s54, 2621440
    s_mov_b32 s55, 0x20000
    s_mov_b64 s[48:49], s[18:19]
    s_mov_b32 s50, 2211840
    s_mov_b32 s51, 0x20000
    s_mov_b64 s[68:69], s[18:19]
    s_mov_b32 s70, 2211840
    s_mov_b32 s71, 0x20000
    s_cmp_ge_u32 s26, 2
    s_cselect_b32 s70, 0, s70
    v_bfe_u32 v10, v1, 2, 2
    v_and_b32 v8, 3, v1
    v_lshl_add_u32 v14, v2, 3, v10
    v_lshlrev_b32 v14, 7, v14
    v_lshlrev_b32 v9, 2, v1
    v_and_b32 v9, 0x60, v9
    v_add3_u32 v14, v14, v9, s40
    v_lshl_add_u32 v14, v8, 3, v14
    v_xor_b32 v15, 32, v14
    v_xor_b32 v16, 64, v14
    v_xor_b32 v17, 96, v14
    s_lshl_b32 s36, s26, 6
    s_add_u32 s36, s36, 141312
    v_lshl_add_u32 v26, v2, 4, s36
    v_min_u32 v8, 2, v3
    v_mul_u32_u24 v8, 1536, v8
    v_add_u32 v26, v26, v8
    s_waitcnt lgkmcnt(0)
    s_add_u32 s34, s34, 0x9e3779b8
    s_or_b32 s34, s34, 1
    s_cmp_lg_u32 s3, 7
    s_cbranch_scc1 Lnop7
    s_setprio 3
Lnop7:
    s_barrier
    s_add_u32 m0, s40, 0
    s_add_u32 s41, s42, 0
    buffer_load_dwordx4 v18, s[44:47], s41 offen nt lds
    buffer_load_dwordx4 v19, s[44:47], s41 offen offset:1024 nt lds
    buffer_load_dwordx4 v20, s[44:47], s41 offen offset:2048 nt lds
    buffer_load_dwordx4 v21, s[44:47], s41 offen offset:3072 nt lds
    s_add_u32 m0, s40, 4096
    s_add_u32 s41, s42, 442368
    buffer_load_dwordx4 v18, s[44:47], s41 offen nt lds
    buffer_load_dwordx4 v19, s[44:47], s41 offen offset:1024 nt lds
    buffer_load_dwordx4 v20, s[44:47], s41 offen offset:2048 nt lds
    buffer_load_dwordx4 v21, s[44:47], s41 offen offset:3072 nt lds
    s_add_u32 m0, s40, 8192
    s_add_u32 s41, s42, 884736
    buffer_load_dwordx4 v18, s[44:47], s41 offen nt lds
    buffer_load_dwordx4 v19, s[44:47], s41 offen offset:1024 nt lds
    buffer_load_dwordx4 v20, s[44:47], s41 offen offset:2048 nt lds
    buffer_load_dwordx4 v21, s[44:47], s41 offen offset:3072 nt lds
    s_add_u32 m0, s40, 12288
    s_add_u32 s41, s42, 1327104
    buffer_load_dwordx4 v18, s[44:47], s41 offen nt lds
    buffer_load_dwordx4 v19, s[44:47], s41 offen offset:1024 nt lds
    buffer_load_dwordx4 v20, s[44:47], s41 offen offset:2048 nt lds
    buffer_load_dwordx4 v21, s[44:47], s41 offen offset:3072 nt lds
    v_mov_b32 v11, 132864
Lcw_11:
    s_sub_u32 s35, s35, 1
    s_cbranch_scc1 Lend
    s_sleep 4
    ds_read_b32 v7, v11
    s_waitcnt lgkmcnt(0)
    v_readfirstlane_b32 s38, v7
    s_nop 0
    s_cmp_lt_u32 s38, 5
    s_cbranch_scc1 Lcw_11
    s_waitcnt vmcnt(12)
    ds_read_b64_tr_b16 a[0:1], v14 offset:0
    ds_read_b64_tr_b16 a[2:3], v14 offset:512
    ds_read_b64_tr_b16 a[4:5], v15 offset:0
    ds_read_b64_tr_b16 a[6:7], v15 offset:512
    ds_read_b64_tr_b16 a[8:9], v16 offset:0
    ds_read_b64_tr_b16 a[10:11], v16 offset:512
    ds_read_b64_tr_b16 a[12:13], v17 offset:0
    ds_read_b64_tr_b16 a[14:15], v17 offset:512
    s_waitcnt lgkmcnt(0)
    s_add_u32 m0, s40, 0
    s_add_u32 s41, s42, 1769472
    buffer_load_dwordx4 v18, s[44:47], s41 offen nt lds
    buffer_load_dwordx4 v19, s[44:47], s41 offen offset:1024 nt lds
    buffer_load_dwordx4 v20, s[44:47], s41 offen offset:2048 nt lds
    buffer_load_dwordx4 v21, s[44:47], s41 offen offset:3072 nt lds
    s_waitcnt vmcnt(12)
    ds_read_b64_tr_b16 a[16:17], v14 offset:4096
    ds_read_b64_tr_b16 a[18:19], v14 offset:4608
    ds_read_b64_tr_b16 a[20:21], v15 offset:4096
    ds_read_b64_tr_b16 a[22:23], v15 offset:4608
    ds_read_b64_tr_b16 a[24:25], v16 offset:4096
    ds_read_b64_tr_b16 a[26:27], v16 offset:4608
    ds_read_b64_tr_b16 a[28:29], v17 offset:4096
    ds_read_b64_tr_b16 a[30:31], v17 offset:4608
    s_waitcnt vmcnt(8)
    ds_read_b64_tr_b16 a[32:33], v14 offset:8192
    ds_read_b64_tr_b16 a[34:35], v14 offset:8704
    ds_read_b64_tr_b16 a[36:37], v15 offset:8192
    ds_read_b64_tr_b16 a[38:39], v15 offset:8704
    ds_read_b64_tr_b16 a[40:41], v16 offset:8192
    ds_read_b64_tr_b16 a[42:43], v16 offset:8704
    ds_read_b64_tr_b16 a[44:45], v17 offset:8192
    ds_read_b64_tr_b16 a[46:47], v17 offset:8704
    s_waitcnt vmcnt(4)
    ds_read_b64_tr_b16 a[48:49], v14 offset:12288
    ds_read_b64_tr_b16 a[50:51], v14 offset:12800
    ds_read_b64_tr_b16 a[52:53], v15 offset:12288
    ds_read_b64_tr_b16 a[54:55], v15 offset:12800
    ds_read_b64_tr_b16 a[56:57], v16 offset:12288
    ds_read_b64_tr_b16 a[58:59], v16 offset:12800
    ds_read_b64_tr_b16 a[60:61], v17 offset:12288
    ds_read_b64_tr_b16 a[62:63], v17 offset:12800
    s_waitcnt vmcnt(0)
    ds_read_b64_tr_b16 a[64:65], v14 offset:0
    ds_read_b64_tr_b16 a[66:67], v14 offset:512
    ds_read_b64_tr_b16 a[68:69], v15 offset:0
    ds_read_b64_tr_b16 a[70:71], v15 offset:512
    ds_read_b64_tr_b16 a[72:73], v16 offset:0
    ds_read_b64_tr_b16 a[74:75], v16 offset:512
    ds_read_b64_tr_b16 a[76:77], v17 offset:0
    ds_read_b64_tr_b16 a[78:79], v17 offset:512
    s_cmp_lg_u32 s3, 7
    s_cbranch_scc1 Lnofx
    v_mov_b32 v92, 0x3f803f80
    v_mov_b32 v93, 0x3f803f80
    v_mov_b32 v94, 0x3f803f80
    v_mov_b32 v95, 0x3f803f80
    v_add_u32 v4, 144384, v13
    ds_write_b128 v4, v[92:95]
    ds_write_b128 v4, v[92:95] offset:1024
    v_and_b32 v120, 31, v1
    v_lshlrev_b32 v120, 7, v120
    v_add_u32 v120, 8126464, v120
Lpt_12:
    s_sub_u32 s35, s35, 1
    s_cbranch_scc1 Lend
    s_sleep 2
    buffer_load_dwordx4 v[124:127], v120, s[28:31], 0 offen sc1
    s_waitcnt vmcnt(0)
    v_cmp_ne_u32 vcc, s34, v125
    v_cmp_ne_u32 s[36:37], s34, v127
    s_nop 0
    s_or_b64 s[36:37], s[36:37], vcc
    s_cbranch_scc1 Lpt_12
    v_mov_b32 v120, v124
    s_nop 1
    v_max_u32_dpp v120, v120, v120 row_ror:8 row_mask:0xf bank_mask:0xf
    s_nop 1
    v_max_u32_dpp v120, v120, v120 row_ror:4 row_mask:0xf bank_mask:0xf
    s_nop 1
    v_max_u32_dpp v120, v120, v120 row_ror:2 row_mask:0xf bank_mask:0xf
    s_nop 1
    v_max_u32_dpp v120, v120, v120 row_ror:1 row_mask:0xf bank_mask:0xf
    s_nop 0
    v_readlane_b32 s56, v120, 0
    v_readlane_b32 s36, v120, 16
    v_readlane_b32 s37, v120, 32
    v_readlane_b32 s38, v120, 48
    s_max_u32 s56, s56, s36
    s_max_u32 s37, s37, s38
    s_max_u32 s56, s56, s37
    v_cmp_eq_u32 vcc, s56, v124
    s_nop 1
    v_cndmask_b32 v120, v124, v126, vcc
    s_nop 1
    v_max_u32_dpp v120, v120, v120 row_ror:8 row_mask:0xf bank_mask:0xf
    s_nop 1
    v_max_u32_dpp v120, v120, v120 row_ror:4 row_mask:0xf bank_mask:0xf
    s_nop 1
    v_max_u32_dpp v120, v120, v120 row_ror:2 row_mask:0xf bank_mask:0xf
    s_nop 1
    v_max_u32_dpp v120, v120, v120 row_ror:1 row_mask:0xf bank_mask:0xf
    s_nop 0
    v_readlane_b32 s57, v120, 0
    v_readlane_b32 s36, v120, 16
    v_readlane_b32 s37, v120, 32
    v_readlane_b32 s38, v120, 48
    s_max_u32 s57, s57, s36
    s_max_u32 s37, s37, s38
    s_max_u32 s57, s57, s37
    s_and_b32 s36, s56, 0x7ff
    s_sub_u32 s36, 2047, s36
    s_and_b32 s37, s57, 0x7ff
    s_sub_u32 s37, 2047, s37
    s_mul_i32 s38, s36, 1280
    s_mul_i32 s39, s37, 1280
    s_mov_b32 m0, 141312
    v_mov_b32 v4, s36
    buffer_load_dwordx4 v13, s[52:55], s38 offen lds
    s_mov_b32 m0, 142848
    v_mov_b32 v5, s37
    buffer_load_dwordx4 v13, s[52:55], s39 offen lds
    s_mov_b64 exec, 0xffff
    buffer_load_dwordx4 v13, s[52:55], s39 offen offset:1024 lds
    s_mov_b32 m0, 141312
    s_mov_b32 vcc_lo, 0xaaaaaaaa
    buffer_load_dwordx4 v13, s[52:55], s38 offen offset:1024 lds
    s_mov_b64 exec, 3
    v_cndmask_b32 v4, v4, v5, vcc
    v_lshlrev_b32 v118, 3, v4
    v_add_u32 v118, 8192000, v118
    v_add_u32 v9, 132872, v12
Lxs_chk:
    s_sub_u32 s35, s35, 1
    s_cbranch_scc1 Lend
    buffer_load_dwordx2 v[116:117], v118, s[28:31], 0 offen sc1
    s_waitcnt vmcnt(0)
    v_cmp_ne_u32 vcc, s34, v117
    s_nop 0
    s_cbranch_vccnz Lxs_chk
    ds_write_b32 v9, v116
    s_mov_b64 exec, -1
    v_mov_b32 v10, 132868
    v_mov_b32 v7, 1
    s_mov_b64 exec, 1
    ds_add_u32 v10, v7
    s_mov_b64 exec, -1
Lnofx:
Lcw_13:
    s_sub_u32 s35, s35, 1
    s_cbranch_scc1 Lend
    s_sleep 2
    ds_read_b32 v7, v11
    s_waitcnt lgkmcnt(0)
    v_readfirstlane_b32 s38, v7
    s_nop 0
    s_cmp_lt_u32 s38, 9
    s_cbranch_scc1 Lcw_13
    s_add_u32 m0, s40, 4096
    s_add_u32 s41, s43, 0
    buffer_load_dwordx4 v22, s[48:51], s41 offen nt lds
    buffer_load_dwordx4 v23, s[48:51], s41 offen offset:1024 nt lds
    buffer_load_dwordx4 v24, s[48:51], s41 offen offset:2048 nt lds
    buffer_load_dwordx4 v25, s[48:51], s41 offen offset:3072 nt lds
    s_add_u32 m0, s40, 8192
    s_add_u32 s41, s43, 40960
    buffer_load_dwordx4 v22, s[48:51], s41 offen nt lds
    buffer_load_dwordx4 v23, s[48:51], s41 offen offset:1024 nt lds
    buffer_load_dwordx4 v24, s[48:51], s41 offen offset:2048 nt lds
    buffer_load_dwordx4 v25, s[48:51], s41 offen offset:3072 nt lds
    s_add_u32 m0, s40, 12288
    s_add_u32 s41, s43, 512
    buffer_load_dwordx4 v22, s[68:71], s41 offen nt lds
    buffer_load_dwordx4 v23, s[68:71], s41 offen offset:1024 nt lds
    buffer_load_dwordx4 v24, s[68:71], s41 offen offset:2048 nt lds
    buffer_load_dwordx4 v25, s[68:71], s41 offen offset:3072 nt lds
    s_add_u32 m0, s40, 0
    s_add_u32 s41, s43, 41472
    buffer_load_dwordx4 v22, s[68:71], s41 offen nt lds
    buffer_load_dwordx4 v23, s[68:71], s41 offen offset:1024 nt lds
    buffer_load_dwordx4 v24, s[68:71], s41 offen offset:2048 nt lds
    buffer_load_dwordx4 v25, s[68:71], s41 offen offset:3072 nt lds
Laux_mm:
    v_mov_b32 v10, 132868
Lcw_14:
    s_sub_u32 s35, s35, 1
    s_cbranch_scc1 Lend
    s_sleep 1
    ds_read_b32 v7, v10
    s_waitcnt lgkmcnt(0)
    v_readfirstlane_b32 s38, v7
    s_nop 0
    s_cmp_lt_u32 s38, 1
    s_cbranch_scc1 Lcw_14
    ds_read_b128 v[92:95], v26 offset:0
    ds_read_b128 v[96:99], v26 offset:256
    ds_read_b128 v[100:103], v26 offset:512
    ds_read_b128 v[104:107], v26 offset:768
    ds_read_b128 v[108:111], v26 offset:1024
    ds_read_b64 v[116:117], v10 offset:4
    s_waitcnt lgkmcnt(0)
    v_readfirstlane_b32 s56, v116
    v_readfirstlane_b32 s57, v117
    v_mfma_f32_16x16x32_bf16 v[112:115], a[0:3], v[92:95], 0
    v_mfma_f32_16x16x32_bf16 v[116:119], a[4:7], v[92:95], 0
    v_mfma_f32_16x16x32_bf16 v[120:123], a[8:11], v[92:95], 0
    v_mfma_f32_16x16x32_bf16 v[124:127], a[12:15], v[92:95], 0
    v_mfma_f32_16x16x32_bf16 v[112:115], a[16:19], v[96:99], v[112:115]
    v_mfma_f32_16x16x32_bf16 v[116:119], a[20:23], v[96:99], v[116:119]
    v_mfma_f32_16x16x32_bf16 v[120:123], a[24:27], v[96:99], v[120:123]
    v_mfma_f32_16x16x32_bf16 v[124:127], a[28:31], v[96:99], v[124:127]
    v_mfma_f32_16x16x32_bf16 v[112:115], a[32:35], v[100:103], v[112:115]
    v_mfma_f32_16x16x32_bf16 v[116:119], a[36:39], v[100:103], v[116:119]
    v_mfma_f32_16x16x32_bf16 v[120:123], a[40:43], v[100:103], v[120:123]
    v_mfma_f32_16x16x32_bf16 v[124:127], a[44:47], v[100:103], v[124:127]
    v_mfma_f32_16x16x32_bf16 v[112:115], a[48:51], v[104:107], v[112:115]
    v_mfma_f32_16x16x32_bf16 v[116:119], a[52:55], v[104:107], v[116:119]
    v_mfma_f32_16x16x32_bf16 v[120:123], a[56:59], v[104:107], v[120:123]
    v_mfma_f32_16x16x32_bf16 v[124:127], a[60:63], v[104:107], v[124:127]
    v_mfma_f32_16x16x32_bf16 v[112:115], a[64:67], v[108:111], v[112:115]
    v_mfma_f32_16x16x32_bf16 v[116:119], a[68:71], v[108:111], v[116:119]
    v_mfma_f32_16x16x32_bf16 v[120:123], a[72:75], v[108:111], v[120:123]
    v_mfma_f32_16x16x32_bf16 v[124:127], a[76:79], v[108:111], v[124:127]
    s_mul_i32 s36, s3, 768
    s_add_u32 s36, s36, 133120
    v_lshlrev_b32 v4, 8, v3
    v_lshl_add_u32 v4, v2, 4, v4
    v_add_u32 v4, s36, v4
    v_add_u32 v5, 133120, v12
    s_lshl_b32 s37, s3, 8
    s_add_u32 s37, s37, 139264
    v_lshl_add_u32 v6, v1, 1, s37
    v_and_b32 v7, 1, v1
    v_lshlrev_b32 v7, 7, v7
    v_lshl_add_u32 v7, v2, 4, v7
    v_add_u32 v7, s37, v7
    s_lshl_b32 s38, s56, 16
    s_lshl_b32 s39, s57, 16
    v_rcp_f32 v8, s38
    v_rcp_f32 v9, s39
    s_and_b32 s56, s56, 0xffff0000
    s_and_b32 s57, s57, 0xffff0000
    s_mov_b32 exec_lo, 0x00070007
    s_mov_b32 exec_hi, 0x00070007
    ds_write_b128 v4, v[112:115] offset:0
    ds_write_b128 v4, v[116:119] offset:64
    ds_write_b128 v4, v[120:123] offset:128
    ds_write_b128 v4, v[124:127] offset:192
    s_mov_b64 exec, -1
    s_waitcnt lgkmcnt(0)
    s_barrier
    ds_read2st64_b32 v[92:93], v5 offset0:0 offset1:1
    ds_read2st64_b32 v[94:95], v5 offset0:2 offset1:3
    ds_read2st64_b32 v[96:97], v5 offset0:4 offset1:5
    ds_read2st64_b32 v[98:99], v5 offset0:6 offset1:7
    ds_read2st64_b32 v[100:101], v5 offset0:8 offset1:9
    ds_read2st64_b32 v[102:103], v5 offset0:10 offset1:11
    ds_read2st64_b32 v[116:117], v5 offset0:12 offset1:13
    ds_read2st64_b32 v[118:119], v5 offset0:14 offset1:15
    ds_read2st64_b32 v[120:121], v5 offset0:16 offset1:17
    ds_read2st64_b32 v[122:123], v5 offset0:18 offset1:19
    ds_read2st64_b32 v[124:125], v5 offset0:20 offset1:21
    ds_read2st64_b32 v[126:127], v5 offset0:22 offset1:23
    v_cmp_eq_u32 s[72:73], 1, v2
    v_cmp_eq_u32 s[74:75], 2, v2
    v_cmp_eq_u32 s[76:77], 3, v2
    s_mul_i32 s37, s32, 10
    s_add_u32 s37, s37, s3
    s_lshl_b32 s37, s37, 10
    s_add_u32 s37, s37, 7405568
    s_waitcnt lgkmcnt(0)
    v_add_f32 v92, v92, v95
    v_add_f32 v98, v98, v101
    v_add_f32 v92, v92, v98
    v_add_f32 v93, v93, v96
    v_add_f32 v99, v99, v102
    v_add_f32 v93, v93, v99
    v_add_f32 v94, v94, v97
    v_add_f32 v100, v100, v103
    v_add_f32 v94, v94, v100
    v_add_f32 v116, v116, v119
    v_add_f32 v122, v122, v125
    v_add_f32 v116, v116, v122
    v_add_f32 v117, v117, v120
    v_add_f32 v123, v123, v126
    v_add_f32 v117, v117, v123
    v_add_f32 v118, v118, v121
    v_add_f32 v124, v124, v127
    v_add_f32 v118, v118, v124
    v_fmac_f32 v92, s56, v94
    v_mul_f32 v112, v92, v8
    v_fmac_f32 v93, s57, v94
    v_mul_f32 v113, v93, v9
    v_fmac_f32 v116, s56, v118
    v_mul_f32 v120, v116, v8
    v_fmac_f32 v117, s57, v118
    v_mul_f32 v121, v117, v9
    v_cvt_pk_bf16_f32 v113, v112, v113
    v_lshlrev_b32 v112, 16, v113
    v_and_b32 v113, 0xffff0000, v113
    v_cvt_pk_bf16_f32 v121, v120, v121
    v_lshlrev_b32 v120, 16, v121
    v_and_b32 v121, 0xffff0000, v121
    v_mul_f32 v114, 0xbfb8aa3b, v112
    v_mul_f32 v115, 0xbfb8aa3b, v113
    v_exp_f32 v114, v114
    v_exp_f32 v115, v115
    v_add_f32 v114, 1.0, v114
    v_add_f32 v115, 1.0, v115
    v_rcp_f32 v114, v114
    v_rcp_f32 v115, v115
    v_mul_f32 v114, v114, v112
    v_mul_f32 v115, v115, v113
    v_cvt_pk_bf16_f32 v115, v114, v115
    v_lshlrev_b32 v114, 16, v115
    v_and_b32 v115, 0xffff0000, v115
    v_mul_f32 v114, v114, v120
    v_mul_f32 v115, v115, v121
    v_cvt_pk_bf16_f32 v114, v114, v115
    ds_write_b16 v6, v114
    ds_write_b16_d16_hi v6, v114 offset:128
    ds_read_b128 v[92:95], v7 offset:0
    ds_read_b128 v[96:99], v7 offset:64
    v_mov_b32 v101, s34
    v_mov_b32 v103, s34
    s_waitcnt vmcnt(0)
    ds_read_b64_tr_b16 v[28:29], v14 offset:4096
    ds_read_b64_tr_b16 v[30:31], v14 offset:4608
    ds_read_b64_tr_b16 v[32:33], v15 offset:4096
    ds_read_b64_tr_b16 v[34:35], v15 offset:4608
    ds_read_b64_tr_b16 v[36:37], v16 offset:4096
    ds_read_b64_tr_b16 v[38:39], v16 offset:4608
    ds_read_b64_tr_b16 v[40:41], v17 offset:4096
    ds_read_b64_tr_b16 v[42:43], v17 offset:4608
    ds_read_b64_tr_b16 v[44:45], v14 offset:8192
    ds_read_b64_tr_b16 v[46:47], v14 offset:8704
    ds_read_b64_tr_b16 v[48:49], v15 offset:8192
    ds_read_b64_tr_b16 v[50:51], v15 offset:8704
    ds_read_b64_tr_b16 v[52:53], v16 offset:8192
    ds_read_b64_tr_b16 v[54:55], v16 offset:8704
    ds_read_b64_tr_b16 v[56:57], v17 offset:8192
    ds_read_b64_tr_b16 v[58:59], v17 offset:8704
    s_waitcnt lgkmcnt(0)
    v_mfma_f32_16x16x32_bf16 v[112:115], v[92:95], v[28:31], 0
    v_mfma_f32_16x16x32_bf16 v[116:119], v[92:95], v[32:35], 0
    v_mfma_f32_16x16x32_bf16 v[120:123], v[92:95], v[36:39], 0
    v_mfma_f32_16x16x32_bf16 v[124:127], v[92:95], v[40:43], 0
    v_mfma_f32_16x16x32_bf16 v[112:115], v[96:99], v[44:47], v[112:115]
    v_mfma_f32_16x16x32_bf16 v[116:119], v[96:99], v[48:51], v[116:119]
    v_mfma_f32_16x16x32_bf16 v[120:123], v[96:99], v[52:55], v[120:123]
    v_mfma_f32_16x16x32_bf16 v[124:127], v[96:99], v[56:59], v[124:127]
    s_nop 5
    v_cndmask_b32 v100, v112, v116, s[72:73]
    v_cndmask_b32 v100, v100, v120, s[74:75]
    v_cndmask_b32 v100, v100, v124, s[76:77]
    v_cndmask_b32 v102, v113, v117, s[72:73]
    v_cndmask_b32 v102, v102, v121, s[74:75]
    v_cndmask_b32 v102, v102, v125, s[76:77]
    buffer_store_dwordx4 v[100:103], v13, s[28:31], s37 offen sc1
    s_sub_u32 s36, s3, 4
    s_cmp_ge_u32 s36, 2
    s_cbranch_scc1 Laux_end
    s_add_u32 s37, s37, 4096
    ds_read_b64_tr_b16 v[60:61], v14 offset:12288
    ds_read_b64_tr_b16 v[62:63], v14 offset:12800
    ds_read_b64_tr_b16 v[64:65], v15 offset:12288
    ds_read_b64_tr_b16 v[66:67], v15 offset:12800
    ds_read_b64_tr_b16 v[68:69], v16 offset:12288
    ds_read_b64_tr_b16 v[70:71], v16 offset:12800
    ds_read_b64_tr_b16 v[72:73], v17 offset:12288
    ds_read_b64_tr_b16 v[74:75], v17 offset:12800
    ds_read_b64_tr_b16 v[76:77], v14 offset:0
    ds_read_b64_tr_b16 v[78:79], v14 offset:512
    ds_read_b64_tr_b16 v[80:81], v15 offset:0
    ds_read_b64_tr_b16 v[82:83], v15 offset:512
    ds_read_b64_tr_b16 v[84:85], v16 offset:0
    ds_read_b64_tr_b16 v[86:87], v16 offset:512
    ds_read_b64_tr_b16 v[88:89], v17 offset:0
    ds_read_b64_tr_b16 v[90:91], v17 offset:512
    s_waitcnt lgkmcnt(0)
    v_mfma_f32_16x16x32_bf16 v[112:115], v[92:95], v[60:63], 0
    v_mfma_f32_16x16x32_bf16 v[116:119], v[92:95], v[64:67], 0
    v_mfma_f32_16x16x32_bf16 v[120:123], v[92:95], v[68:71], 0
    v_mfma_f32_16x16x32_bf16 v[124:127], v[92:95], v[72:75], 0
    v_mfma_f32_16x16x32_bf16 v[112:115], v[96:99], v[76:79], v[112:115]
    v_mfma_f32_16x16x32_bf16 v[116:119], v[96:99], v[80:83], v[116:119]
    v_mfma_f32_16x16x32_bf16 v[120:123], v[96:99], v[84:87], v[120:123]
    v_mfma_f32_16x16x32_bf16 v[124:127], v[96:99], v[88:91], v[124:127]
    s_nop 5
    v_cndmask_b32 v100, v112, v116, s[72:73]
    v_cndmask_b32 v100, v100, v120, s[74:75]
    v_cndmask_b32 v100, v100, v124, s[76:77]
    v_cndmask_b32 v102, v113, v117, s[72:73]
    v_cndmask_b32 v102, v102, v121, s[74:75]
    v_cndmask_b32 v102, v102, v125, s[76:77]
    buffer_store_dwordx4 v[100:103], v13, s[28:31], s37 offen sc1
Laux_end:
    s_endpgm
Lmst:
    s_cmp_lg_u32 s3, 0
    s_cbranch_scc1 Lhelp_i
    s_waitcnt lgkmcnt(0)
    s_mov_b64 s[28:29], s[24:25]
    s_mov_b32 s30, 268435456
    s_mov_b32 s31, 0x20000
    s_load_dword s34, s[28:29], 0
    s_waitcnt lgkmcnt(0)
    s_add_u32 s34, s34, 0x9e3779b8
    s_or_b32 s34, s34, 1
    s_mov_b64 exec, 1
    s_lshl_b32 s36, s2, 2
    s_add_u32 s36, s36, 8323072
    v_mov_b32 v4, s34
    v_mov_b32 v5, s36
    buffer_store_dword v4, v5, s[28:31], 0 offen sc1
    s_mov_b64 exec, -1
    s_cmp_lg_u32 s32, 32
    s_cbranch_scc1 Lend
Lmst_bc:
    v_and_b32 v4, 31, v1
    v_lshlrev_b32 v4, 7, v4
    v_add_u32 v4, 8126464, v4
Lpt_15:
    s_sub_u32 s35, s35, 1
    s_cbranch_scc1 Lend
    s_sleep 8
    buffer_load_dwordx4 v[8:11], v4, s[28:31], 0 offen sc1
    s_waitcnt vmcnt(0)
    v_cmp_ne_u32 vcc, s34, v9
    v_cmp_ne_u32 s[36:37], s34, v11
    s_nop 0
    s_or_b64 s[36:37], s[36:37], vcc
    s_cbranch_scc1 Lpt_15
    v_mov_b32 v4, v8
    s_nop 1
    v_max_u32_dpp v4, v4, v4 row_ror:8 row_mask:0xf bank_mask:0xf
    s_nop 1
    v_max_u32_dpp v4, v4, v4 row_ror:4 row_mask:0xf bank_mask:0xf
    s_nop 1
    v_max_u32_dpp v4, v4, v4 row_ror:2 row_mask:0xf bank_mask:0xf
    s_nop 1
    v_max_u32_dpp v4, v4, v4 row_ror:1 row_mask:0xf bank_mask:0xf
    s_nop 0
    v_readlane_b32 s40, v4, 0
    v_readlane_b32 s36, v4, 16
    v_readlane_b32 s37, v4, 32
    v_readlane_b32 s38, v4, 48
    s_max_u32 s40, s40, s36
    s_max_u32 s37, s37, s38
    s_max_u32 s40, s40, s37
    v_cmp_eq_u32 vcc, s40, v8
    s_nop 1
    v_cndmask_b32 v4, v8, v10, vcc
    s_nop 1
    v_max_u32_dpp v4, v4, v4 row_ror:8 row_mask:0xf bank_mask:0xf
    s_nop 1
    v_max_u32_dpp v4, v4, v4 row_ror:4 row_mask:0xf bank_mask:0xf
    s_nop 1
    v_max_u32_dpp v4, v4, v4 row_ror:2 row_mask:0xf bank_mask:0xf
    s_nop 1
    v_max_u32_dpp v4, v4, v4 row_ror:1 row_mask:0xf bank_mask:0xf
    s_nop 0
    v_readlane_b32 s41, v4, 0
    v_readlane_b32 s36, v4, 16
    v_readlane_b32 s37, v4, 32
    v_readlane_b32 s38, v4, 48
    s_max_u32 s41, s41, s36
    s_max_u32 s37, s37, s38
    s_max_u32 s41, s41, s37
    v_mov_b32 v8, s40
    v_mov_b32 v9, s34
    v_mov_b32 v10, s41
    v_mov_b32 v11, s34
    s_mov_b32 s36, 8257536
    buffer_store_dwordx4 v[8:11], v13, s[28:31], s36 offen offset:0 sc1
    buffer_store_dwordx4 v[8:11], v13, s[28:31], s36 offen offset:1024 sc1
    buffer_store_dwordx4 v[8:11], v13, s[28:31], s36 offen offset:2048 sc1
    s_mov_b32 s36, 8323072
Lmaster:
    s_sub_u32 s35, s35, 1
    s_cbranch_scc1 Lend
    s_sleep 16
    buffer_load_dwordx4 v[4:7], v13, s[28:31], s36 offen sc1
    s_waitcnt vmcnt(0)
    v_xor_b32 v4, s34, v4
    v_xor_b32 v5, s34, v5
    v_xor_b32 v6, s34, v6
    v_xor_b32 v7, s34, v7
    v_or3_b32 v4, v4, v5, v6
    v_or_b32 v4, v4, v7
    v_cmp_ne_u32 vcc, 0, v4
    s_nop 0
    s_cbranch_vccnz Lmaster
    s_mov_b64 exec, 1
    buffer_store_dword v9, v4, s[28:31], 0 offen sc1
    s_endpgm
Lhelp_r:
    s_add_u32 s72, s32, 0
    s_mov_b32 s73, 5
    s_mov_b32 s37, 4
    s_branch Lhelp
Lhelp_i:
    s_cmp_eq_u32 s32, 32
    s_cbranch_scc1 Lend
    s_cmp_eq_u32 s27, 0
    s_cbranch_scc1 Lend
    s_sub_u32 s72, s32, 33
    s_mov_b32 s73, 3
    s_mov_b32 s37, 9
Lhelp:
    s_lshl_b32 s38, s26, 6
    v_add_u32 v4, s38, v1
    v_mul_u32_u24 v4, 1280, v4
    s_waitcnt lgkmcnt(0)
    s_mov_b64 s[68:69], s[18:19]
    s_mov_b32 s70, 2211840
    s_mov_b32 s71, 0x20000
Lhelp2:
    s_mul_i32 s38, s72, 9363
    s_lshr_b32 s38, s38, 16
    s_mul_i32 s39, s38, 7
    s_sub_u32 s39, s72, s39
    s_mul_i32 s39, s39, 327680
    s_lshl_b32 s38, s38, 7
    s_sub_u32 s39, s39, s38
    s_add_u32 s39, s39, 1152
    v_add_u32 v6, s39, v4
    buffer_load_dword v5, v6, s[68:71], 0 offen
    s_add_u32 s72, s72, s73
    s_sub_u32 s37, s37, 1
    s_cmp_lg_u32 s37, 0
    s_cbranch_scc1 Lhelp2
Lend:
    s_endpgm
.section .rodata,"a"
.p2align 6
.amdhsa_kernel recurrent_scan__sliding_local_dilated__moe_arch_mod__prompt_kernel
  .amdhsa_next_free_vgpr 256
  .amdhsa_next_free_sgpr 102
  .amdhsa_accum_offset 128
  .amdhsa_group_segment_fixed_size 0
  .amdhsa_kernarg_size 88
  .amdhsa_user_sgpr_count 2
  .amdhsa_user_sgpr_kernarg_segment_ptr 1
  .amdhsa_system_sgpr_workgroup_id_x 1
  .amdhsa_float_denorm_mode_32 3
.end_amdhsa_kernel
```

```asm
; @launch grid=(256,1,1) block=(512,1,1) lds=163840
.amdgcn_target "amdgcn-amd-amdhsa--gfx950"
.text
.globl recurrent_scan__sliding_local_dilated__moe_arch_mod__prompt_kernel
.p2align 8
.type recurrent_scan__sliding_local_dilated__moe_arch_mod__prompt_kernel,@function
recurrent_scan__sliding_local_dilated__moe_arch_mod__prompt_kernel:
    s_load_dwordx16 s[4:19], s[0:1], 0
    s_load_dwordx4 s[20:23], s[0:1], 64
    s_load_dwordx2 s[24:25], s[0:1], 80
    v_lshrrev_b32 v4, 6, v0
    v_and_b32 v1, 63, v0
    s_cmp_ge_u32 s2, 256
    s_cbranch_scc1 Lend
    v_readfirstlane_b32 s3, v4
    s_getpc_b64 s[36:37]
Lpc:
    s_and_b32 s38, s2, 0xf8
    v_add_u32 v5, s38, v4
    v_and_b32 v6, 1, v0
    v_lshl_add_u32 v5, v5, 1, v6
    v_lshlrev_b32 v5, 7, v5
    v_min_u32 v5, Lend-Lpc, v5
    v_mov_b32 v7, s37
    v_add_co_u32 v6, vcc, s36, v5
    s_nop 1
    v_addc_co_u32 v7, vcc, 0, v7, vcc
    global_load_dword v0, v[6:7], off
    v_lshrrev_b32 v2, 4, v1
    v_and_b32 v3, 15, v1
    v_lshlrev_b32 v12, 2, v1
    v_lshlrev_b32 v13, 4, v1
    s_mov_b32 s35, 2000000
    s_and_b32 s36, s2, 7
    s_lshr_b32 s37, s2, 3
    s_and_b32 s38, s36, 1
    s_lshr_b32 s36, s36, 1
    s_add_u32 s39, s38, 4
    s_and_b32 s26, s3, 3
    s_lshr_b32 s27, s3, 2
    s_cmp_lt_u32 s37, s39
    s_cbranch_scc1 Laux
    s_lshr_b32 s33, s36, 1
    s_and_b32 s36, s36, 1
    s_mul_i32 s36, s36, 55
    s_mul_i32 s38, s38, 28
    s_add_u32 s36, s36, s38
    s_add_u32 s36, s36, s37
    s_sub_u32 s36, s36, s39
    s_mul_i32 s32, s36, 13108
    s_lshr_b32 s32, s32, 16
    s_mul_i32 s37, s32, 5
    s_sub_u32 s36, s36, s37
    s_mul_i32 s33, s33, 5
    s_add_u32 s33, s33, s36
    s_add_u32 s42, s33, s32
    s_mul_i32 s36, s42, 13108
    s_lshr_b32 s36, s36, 16
    s_mul_i32 s36, s36, 5
    s_sub_u32 s42, s42, s36
    s_and_b32 s43, s2, 7
    s_lshl_b32 s43, s43, 2
    s_lshr_b32 s43, 0x30858530, s43
    s_and_b32 s43, s43, 15
    s_cmp_lg_u32 s3, 0
    s_cbranch_scc1 Lcomp
Lloader:
    s_setprio 3
    v_lshrrev_b32 v5, 3, v1
    v_and_b32 v6, 7, v1
    v_and_b32 v8, 1, v2
    v_lshlrev_b32 v8, 1, v8
    v_xor_b32 v8, v8, v6
    s_lshl_b32 s39, s33, 7
    v_lshl_add_u32 v50, v8, 4, s39
    v_mov_b32 v7, 3840
    v_mad_u32_u24 v28, v5, v7, v50
    v_xor_b32 v29, 64, v28
    v_add_u32 v29, 29696, v29
    v_add_u32 v30, 59392, v28
    v_add_u32 v31, 59392, v29
    v_add_u32 v32, 122880, v28
    v_add_u32 v33, 122880, v29
    v_add_u32 v34, 182272, v28
    v_add_u32 v35, 182272, v29
    s_lshl_b32 s79, s42, 2
    s_lshr_b32 s79, 0x21100, s79
    s_and_b32 s79, s79, 15
    s_add_u32 s79, s79, s43
    s_sub_u32 s38, s79, 10
    s_cmp_ge_u32 s79, 10
    s_cselect_b32 s79, s38, s79
    s_mul_i32 s68, s79, 245760
    s_lshl_b32 s78, s79, 7
    s_waitcnt lgkmcnt(0)
    s_mov_b64 s[48:49], s[6:7]
    s_mov_b32 s50, 2457600
    s_mov_b32 s51, 0x20000
    s_add_u32 s52, s6, 1280
    s_addc_u32 s53, s7, 0
    s_mov_b32 s54, 2456320
    s_mov_b32 s55, 0x20000
    s_add_u32 s56, s6, 2560
    s_addc_u32 s57, s7, 0
    s_mov_b32 s58, 2455040
    s_mov_b32 s59, 0x20000
    s_mov_b32 m0, 0
    s_mul_i32 s38, s32, 96
    s_sub_u32 s38, s38, 16
    v_add_u32 v7, s38, v5
    buffer_load_dwordx4 v28, s[48:51], s68 offen lds
    v_xor_b32 v9, v6, v2
    v_lshlrev_b32 v9, 4, v9
    buffer_load_dwordx4 v29, s[48:51], s68 offen offset:1024 lds
    v_xor_b32 v10, 64, v9
    v_mov_b32 v11, 2052
    buffer_load_dwordx4 v30, s[48:51], s68 offen offset:2048 lds
    v_mov_b32 v8, 1280
    v_add_u32 v36, 0, v7
    buffer_load_dwordx4 v31, s[48:51], s68 offen offset:3072 lds
    v_med3_i32 v36, v36, 0, v11
    v_mad_u32_u24 v36, v36, v8, v9
    s_mov_b32 m0, 8192
    v_add_u32 v36, 4096, v36
    v_add_u32 v37, 8, v7
    buffer_load_dwordx4 v28, s[52:55], s68 offen lds
    v_med3_i32 v37, v37, 0, v11
    v_mad_u32_u24 v37, v37, v8, v10
    v_add_u32 v37, 3072, v37
    buffer_load_dwordx4 v29, s[52:55], s68 offen offset:1024 lds
    v_add_u32 v38, 16, v7
    v_med3_i32 v38, v38, 0, v11
    buffer_load_dwordx4 v30, s[52:55], s68 offen offset:2048 lds
    v_mad_u32_u24 v38, v38, v8, v9
    v_add_u32 v38, 2048, v38
    buffer_load_dwordx4 v31, s[52:55], s68 offen offset:3072 lds
    v_add_u32 v39, 24, v7
    v_med3_i32 v39, v39, 0, v11
    s_mov_b32 m0, 16384
    v_mad_u32_u24 v39, v39, v8, v10
    v_add_u32 v39, 1024, v39
    buffer_load_dwordx4 v28, s[56:59], s68 offen lds
    v_add_u32 v40, 32, v7
    v_med3_i32 v40, v40, 0, v11
    buffer_load_dwordx4 v29, s[56:59], s68 offen offset:1024 lds
    v_mad_u32_u24 v40, v40, v8, v9
    v_add_u32 v40, 4096, v40
    v_add_u32 v41, 40, v7
    buffer_load_dwordx4 v30, s[56:59], s68 offen offset:2048 lds
    v_med3_i32 v41, v41, 0, v11
    v_mad_u32_u24 v41, v41, v8, v10
    buffer_load_dwordx4 v31, s[56:59], s68 offen offset:3072 lds
    v_add_u32 v41, 3072, v41
    v_add_u32 v42, 48, v7
    s_mov_b32 m0, 4096
    v_med3_i32 v42, v42, 0, v11
    v_mad_u32_u24 v42, v42, v8, v9
    buffer_load_dwordx4 v32, s[48:51], s68 offen lds
    v_add_u32 v42, 2048, v42
    v_add_u32 v43, 56, v7
    buffer_load_dwordx4 v33, s[48:51], s68 offen offset:1024 lds
    v_med3_i32 v43, v43, 0, v11
    v_mad_u32_u24 v43, v43, v8, v10
    buffer_load_dwordx4 v34, s[48:51], s68 offen offset:2048 lds
    v_add_u32 v43, 1024, v43
    v_add_u32 v44, 64, v7
    v_med3_i32 v44, v44, 0, v11
    buffer_load_dwordx4 v35, s[48:51], s68 offen offset:3072 lds
    v_mad_u32_u24 v44, v44, v8, v9
    v_add_u32 v44, 4096, v44
    s_mov_b32 m0, 12288
    v_add_u32 v45, 72, v7
    v_med3_i32 v45, v45, 0, v11
    buffer_load_dwordx4 v32, s[52:55], s68 offen lds
    v_mad_u32_u24 v45, v45, v8, v10
    v_add_u32 v45, 3072, v45
    buffer_load_dwordx4 v33, s[52:55], s68 offen offset:1024 lds
    v_add_u32 v46, 80, v7
    v_med3_i32 v46, v46, 0, v11
    buffer_load_dwordx4 v34, s[52:55], s68 offen offset:2048 lds
    v_mad_u32_u24 v46, v46, v8, v9
    v_add_u32 v46, 2048, v46
    buffer_load_dwordx4 v35, s[52:55], s68 offen offset:3072 lds
    v_add_u32 v47, 88, v7
    v_med3_i32 v47, v47, 0, v11
    v_mad_u32_u24 v47, v47, v8, v10
    s_mov_b32 m0, 20480
    v_add_u32 v47, 1024, v47
    v_add_u32 v48, 96, v7
    buffer_load_dwordx4 v32, s[56:59], s68 offen lds
    v_med3_i32 v48, v48, 0, v11
    v_mad_u32_u24 v48, v48, v8, v9
    buffer_load_dwordx4 v33, s[56:59], s68 offen offset:1024 lds
    v_add_u32 v48, 4096, v48
    v_add_u32 v49, 104, v7
    buffer_load_dwordx4 v34, s[56:59], s68 offen offset:2048 lds
    v_med3_i32 v49, v49, 0, v11
    v_mad_u32_u24 v49, v49, v8, v10
    buffer_load_dwordx4 v35, s[56:59], s68 offen offset:3072 lds
    v_add_u32 v49, 3072, v49
    s_sub_u32 s44, s4, 4096
    s_subb_u32 s45, s5, 0
    s_mov_b32 s46, 2625536
    s_mov_b32 s47, 0x20000
    s_mov_b32 m0, 24576
    s_nop 0
    buffer_load_dwordx4 v36, s[44:47], s78 offen lds
    buffer_load_dwordx4 v37, s[44:47], s78 offen offset:1024 lds
    buffer_load_dwordx4 v38, s[44:47], s78 offen offset:2048 lds
    buffer_load_dwordx4 v39, s[44:47], s78 offen offset:3072 lds
    s_mov_b32 m0, 28672
    s_nop 0
    buffer_load_dwordx4 v40, s[44:47], s78 offen lds
    buffer_load_dwordx4 v41, s[44:47], s78 offen offset:1024 lds
    buffer_load_dwordx4 v42, s[44:47], s78 offen offset:2048 lds
    buffer_load_dwordx4 v43, s[44:47], s78 offen offset:3072 lds
    s_mov_b32 m0, 32768
    s_nop 0
    buffer_load_dwordx4 v44, s[44:47], s78 offen lds
    buffer_load_dwordx4 v45, s[44:47], s78 offen offset:1024 lds
    buffer_load_dwordx4 v46, s[44:47], s78 offen offset:2048 lds
    buffer_load_dwordx4 v47, s[44:47], s78 offen offset:3072 lds
    s_mov_b32 m0, 36864
    s_nop 0
    buffer_load_dwordx4 v48, s[44:47], s78 offen lds
    buffer_load_dwordx4 v49, s[44:47], s78 offen offset:1024 lds
    s_mov_b32 s80, 0x65482310
    s_mov_b32 s81, 0x97
    s_cmp_eq_u32 s42, 1
    s_cselect_b32 s80, 0x65392410, s80
    s_cselect_b32 s81, 0x87, s81
    s_cmp_eq_u32 s42, 2
    s_cselect_b32 s80, 0x75436021, s80
    s_cselect_b32 s81, 0x98, s81
    s_cmp_eq_u32 s42, 3
    s_cselect_b32 s80, 0x76432501, s80
    s_cselect_b32 s81, 0x98, s81
    s_cmp_eq_u32 s42, 4
    s_cselect_b32 s80, 0x63547102, s80
    s_cselect_b32 s81, 0x98, s81
    s_lshr_b64 s[80:81], s[80:81], 4
    s_and_b32 s79, s80, 15
    s_add_u32 s79, s79, s43
    s_sub_u32 s38, s79, 10
    s_cmp_ge_u32 s79, 10
    s_cselect_b32 s79, s38, s79
    s_mov_b64 s[28:29], s[24:25]
    s_mov_b32 s30, 268435456
    s_mov_b32 s31, 0x20000
    s_load_dword s34, s[28:29], 0
    s_mov_b64 s[60:61], s[8:9]
    s_mov_b32 s62, 819200
    s_mov_b32 s63, 0x20000
    v_mov_b32 v51, 157984
    v_and_b32 v66, 7, v1
    v_max_u32 v66, 1, v66
    v_lshlrev_b32 v66, 2, v66
    v_add_u32 v66, 158016, v66
    s_mul_i32 s69, s79, 245760
    s_lshl_b32 s78, s79, 7
    s_mov_b32 m0, 63616
    s_nop 0
    buffer_load_dwordx4 v36, s[44:47], s78 offen lds
    buffer_load_dwordx4 v37, s[44:47], s78 offen offset:1024 lds
    buffer_load_dwordx4 v38, s[44:47], s78 offen offset:2048 lds
    buffer_load_dwordx4 v39, s[44:47], s78 offen offset:3072 lds
    s_mov_b32 m0, 39040
    s_nop 0
    buffer_load_dwordx4 v28, s[48:51], s69 offen lds
    buffer_load_dwordx4 v29, s[48:51], s69 offen offset:1024 lds
    buffer_load_dwordx4 v30, s[48:51], s69 offen offset:2048 lds
    buffer_load_dwordx4 v31, s[48:51], s69 offen offset:3072 lds
    s_mov_b32 m0, 67712
    s_nop 0
    buffer_load_dwordx4 v40, s[44:47], s78 offen lds
    buffer_load_dwordx4 v41, s[44:47], s78 offen offset:1024 lds
    buffer_load_dwordx4 v42, s[44:47], s78 offen offset:2048 lds
    buffer_load_dwordx4 v43, s[44:47], s78 offen offset:3072 lds
    s_mov_b32 m0, 47232
    s_nop 0
    buffer_load_dwordx4 v28, s[52:55], s69 offen lds
    buffer_load_dwordx4 v29, s[52:55], s69 offen offset:1024 lds
    buffer_load_dwordx4 v30, s[52:55], s69 offen offset:2048 lds
    buffer_load_dwordx4 v31, s[52:55], s69 offen offset:3072 lds
    s_mov_b32 m0, 71808
    s_nop 0
    buffer_load_dwordx4 v44, s[44:47], s78 offen lds
    buffer_load_dwordx4 v45, s[44:47], s78 offen offset:1024 lds
    buffer_load_dwordx4 v46, s[44:47], s78 offen offset:2048 lds
    buffer_load_dwordx4 v47, s[44:47], s78 offen offset:3072 lds
    s_mov_b32 m0, 55424
    s_nop 0
    buffer_load_dwordx4 v28, s[56:59], s69 offen lds
    buffer_load_dwordx4 v29, s[56:59], s69 offen offset:1024 lds
    buffer_load_dwordx4 v30, s[56:59], s69 offen offset:2048 lds
    buffer_load_dwordx4 v31, s[56:59], s69 offen offset:3072 lds
    s_mov_b32 m0, 75904
    s_nop 0
    buffer_load_dwordx4 v48, s[44:47], s78 offen lds
    s_waitcnt vmcnt(55)
    buffer_load_dwordx4 v49, s[44:47], s78 offen offset:1024 lds
    s_mov_b32 m0, 43136
    s_nop 0
    buffer_load_dwordx4 v32, s[48:51], s69 offen lds
    buffer_load_dwordx4 v33, s[48:51], s69 offen offset:1024 lds
    buffer_load_dwordx4 v34, s[48:51], s69 offen offset:2048 lds
    buffer_load_dwordx4 v35, s[48:51], s69 offen offset:3072 lds
    s_mov_b32 m0, 51328
    s_nop 0
    buffer_load_dwordx4 v32, s[52:55], s69 offen lds
    buffer_load_dwordx4 v33, s[52:55], s69 offen offset:1024 lds
    buffer_load_dwordx4 v34, s[52:55], s69 offen offset:2048 lds
    s_waitcnt vmcnt(55)
    buffer_load_dwordx4 v35, s[52:55], s69 offen offset:3072 lds
    s_mov_b32 m0, 59520
    s_nop 0
    buffer_load_dwordx4 v32, s[56:59], s69 offen lds
    buffer_load_dwordx4 v33, s[56:59], s69 offen offset:1024 lds
    buffer_load_dwordx4 v34, s[56:59], s69 offen offset:2048 lds
    buffer_load_dwordx4 v35, s[56:59], s69 offen offset:3072 lds
    s_waitcnt vmcnt(38) lgkmcnt(0)
    s_barrier
    s_add_u32 s34, s34, 0x9e3779b8
    s_or_b32 s34, s34, 1
    s_lshr_b64 s[80:81], s[80:81], 4
    s_and_b32 s79, s80, 15
    s_add_u32 s79, s79, s43
    s_sub_u32 s38, s79, 10
    s_cmp_ge_u32 s79, 10
    s_cselect_b32 s79, s38, s79
    s_mul_i32 s70, s79, 245760
    s_lshl_b32 s78, s79, 7
    s_mov_b32 m0, 102656
    s_nop 0
    buffer_load_dwordx4 v36, s[44:47], s78 offen lds
    buffer_load_dwordx4 v37, s[44:47], s78 offen offset:1024 lds
    buffer_load_dwordx4 v38, s[44:47], s78 offen offset:2048 lds
    buffer_load_dwordx4 v39, s[44:47], s78 offen offset:3072 lds
    s_mov_b32 m0, 78080
    s_nop 0
    buffer_load_dwordx4 v28, s[48:51], s70 offen lds
    buffer_load_dwordx4 v29, s[48:51], s70 offen offset:1024 lds
    buffer_load_dwordx4 v30, s[48:51], s70 offen offset:2048 lds
    buffer_load_dwordx4 v31, s[48:51], s70 offen offset:3072 lds
    s_mov_b32 m0, 106752
    s_nop 0
    buffer_load_dwordx4 v40, s[44:47], s78 offen lds
    buffer_load_dwordx4 v41, s[44:47], s78 offen offset:1024 lds
    buffer_load_dwordx4 v42, s[44:47], s78 offen offset:2048 lds
    buffer_load_dwordx4 v43, s[44:47], s78 offen offset:3072 lds
    s_mov_b32 m0, 86272
    s_nop 0
    buffer_load_dwordx4 v28, s[52:55], s70 offen lds
    buffer_load_dwordx4 v29, s[52:55], s70 offen offset:1024 lds
    buffer_load_dwordx4 v30, s[52:55], s70 offen offset:2048 lds
    buffer_load_dwordx4 v31, s[52:55], s70 offen offset:3072 lds
    s_mov_b32 m0, 110848
    s_nop 0
    buffer_load_dwordx4 v44, s[44:47], s78 offen lds
    buffer_load_dwordx4 v45, s[44:47], s78 offen offset:1024 lds
    buffer_load_dwordx4 v46, s[44:47], s78 offen offset:2048 lds
    buffer_load_dwordx4 v47, s[44:47], s78 offen offset:3072 lds
    s_mov_b32 m0, 94464
    s_nop 0
    buffer_load_dwordx4 v28, s[56:59], s70 offen lds
    buffer_load_dwordx4 v29, s[56:59], s70 offen offset:1024 lds
    buffer_load_dwordx4 v30, s[56:59], s70 offen offset:2048 lds
    buffer_load_dwordx4 v31, s[56:59], s70 offen offset:3072 lds
    s_mov_b32 m0, 114944
    s_nop 0
    buffer_load_dwordx4 v48, s[44:47], s78 offen lds
    s_waitcnt vmcnt(55)
    buffer_load_dwordx4 v49, s[44:47], s78 offen offset:1024 lds
    s_mov_b32 m0, 82176
    s_nop 0
    buffer_load_dwordx4 v32, s[48:51], s70 offen lds
    buffer_load_dwordx4 v33, s[48:51], s70 offen offset:1024 lds
    buffer_load_dwordx4 v34, s[48:51], s70 offen offset:2048 lds
    buffer_load_dwordx4 v35, s[48:51], s70 offen offset:3072 lds
    s_mov_b32 m0, 90368
    s_nop 0
    buffer_load_dwordx4 v32, s[52:55], s70 offen lds
    buffer_load_dwordx4 v33, s[52:55], s70 offen offset:1024 lds
    buffer_load_dwordx4 v34, s[52:55], s70 offen offset:2048 lds
    s_waitcnt vmcnt(55)
    buffer_load_dwordx4 v35, s[52:55], s70 offen offset:3072 lds
    s_mov_b32 m0, 98560
    s_nop 0
    buffer_load_dwordx4 v32, s[56:59], s70 offen lds
    buffer_load_dwordx4 v33, s[56:59], s70 offen offset:1024 lds
    buffer_load_dwordx4 v34, s[56:59], s70 offen offset:2048 lds
    buffer_load_dwordx4 v35, s[56:59], s70 offen offset:3072 lds
    s_waitcnt vmcnt(38) lgkmcnt(0)
    s_barrier
    s_lshr_b64 s[80:81], s[80:81], 4
    s_and_b32 s79, s80, 15
    s_add_u32 s79, s79, s43
    s_sub_u32 s38, s79, 10
    s_cmp_ge_u32 s79, 10
    s_cselect_b32 s79, s38, s79
    s_mul_i32 s71, s79, 245760
    s_lshl_b32 s78, s79, 7
    s_mov_b32 m0, 141696
    s_nop 0
    buffer_load_dwordx4 v36, s[44:47], s78 offen lds
    buffer_load_dwordx4 v37, s[44:47], s78 offen offset:1024 lds
    buffer_load_dwordx4 v38, s[44:47], s78 offen offset:2048 lds
    buffer_load_dwordx4 v39, s[44:47], s78 offen offset:3072 lds
    s_mov_b32 m0, 117120
    s_nop 0
    buffer_load_dwordx4 v28, s[48:51], s71 offen lds
    buffer_load_dwordx4 v29, s[48:51], s71 offen offset:1024 lds
    buffer_load_dwordx4 v30, s[48:51], s71 offen offset:2048 lds
    buffer_load_dwordx4 v31, s[48:51], s71 offen offset:3072 lds
    s_mov_b32 m0, 145792
    s_nop 0
    buffer_load_dwordx4 v40, s[44:47], s78 offen lds
    buffer_load_dwordx4 v41, s[44:47], s78 offen offset:1024 lds
    buffer_load_dwordx4 v42, s[44:47], s78 offen offset:2048 lds
    buffer_load_dwordx4 v43, s[44:47], s78 offen offset:3072 lds
    s_mov_b32 m0, 125312
    s_nop 0
    buffer_load_dwordx4 v28, s[52:55], s71 offen lds
    buffer_load_dwordx4 v29, s[52:55], s71 offen offset:1024 lds
    buffer_load_dwordx4 v30, s[52:55], s71 offen offset:2048 lds
    buffer_load_dwordx4 v31, s[52:55], s71 offen offset:3072 lds
    s_mov_b32 m0, 149888
    s_nop 0
    buffer_load_dwordx4 v44, s[44:47], s78 offen lds
    buffer_load_dwordx4 v45, s[44:47], s78 offen offset:1024 lds
    buffer_load_dwordx4 v46, s[44:47], s78 offen offset:2048 lds
    buffer_load_dwordx4 v47, s[44:47], s78 offen offset:3072 lds
    s_mov_b32 m0, 133504
    s_nop 0
    buffer_load_dwordx4 v28, s[56:59], s71 offen lds
    buffer_load_dwordx4 v29, s[56:59], s71 offen offset:1024 lds
    buffer_load_dwordx4 v30, s[56:59], s71 offen offset:2048 lds
    buffer_load_dwordx4 v31, s[56:59], s71 offen offset:3072 lds
    s_mov_b32 m0, 153984
    s_nop 0
    buffer_load_dwordx4 v48, s[44:47], s78 offen lds
    s_waitcnt vmcnt(55)
    buffer_load_dwordx4 v49, s[44:47], s78 offen offset:1024 lds
    s_mov_b32 m0, 121216
    s_nop 0
    buffer_load_dwordx4 v32, s[48:51], s71 offen lds
    buffer_load_dwordx4 v33, s[48:51], s71 offen offset:1024 lds
    buffer_load_dwordx4 v34, s[48:51], s71 offen offset:2048 lds
    buffer_load_dwordx4 v35, s[48:51], s71 offen offset:3072 lds
    s_mov_b32 m0, 129408
    s_nop 0
    buffer_load_dwordx4 v32, s[52:55], s71 offen lds
    buffer_load_dwordx4 v33, s[52:55], s71 offen offset:1024 lds
    buffer_load_dwordx4 v34, s[52:55], s71 offen offset:2048 lds
    s_waitcnt vmcnt(55)
    buffer_load_dwordx4 v35, s[52:55], s71 offen offset:3072 lds
    s_mov_b32 m0, 137600
    s_nop 0
    buffer_load_dwordx4 v32, s[56:59], s71 offen lds
    buffer_load_dwordx4 v33, s[56:59], s71 offen offset:1024 lds
    buffer_load_dwordx4 v34, s[56:59], s71 offen offset:2048 lds
    buffer_load_dwordx4 v35, s[56:59], s71 offen offset:3072 lds
    s_waitcnt vmcnt(38) lgkmcnt(0)
    s_barrier
    s_lshr_b64 s[80:81], s[80:81], 4
    s_and_b32 s79, s80, 15
    s_add_u32 s79, s79, s43
    s_sub_u32 s38, s79, 10
    s_cmp_ge_u32 s79, 10
    s_cselect_b32 s79, s38, s79
    s_mul_i32 s72, s79, 245760
    s_lshl_b32 s78, s79, 7
    s_mov_b32 m0, 24576
    s_nop 0
    buffer_load_dwordx4 v36, s[44:47], s78 offen lds
    buffer_load_dwordx4 v37, s[44:47], s78 offen offset:1024 lds
    buffer_load_dwordx4 v38, s[44:47], s78 offen offset:2048 lds
    buffer_load_dwordx4 v39, s[44:47], s78 offen offset:3072 lds
    s_mov_b32 m0, 0
    s_nop 0
    buffer_load_dwordx4 v28, s[48:51], s72 offen lds
    buffer_load_dwordx4 v29, s[48:51], s72 offen offset:1024 lds
    buffer_load_dwordx4 v30, s[48:51], s72 offen offset:2048 lds
    buffer_load_dwordx4 v31, s[48:51], s72 offen offset:3072 lds
    s_mov_b32 m0, 28672
    s_nop 0
    buffer_load_dwordx4 v40, s[44:47], s78 offen lds
    buffer_load_dwordx4 v41, s[44:47], s78 offen offset:1024 lds
    buffer_load_dwordx4 v42, s[44:47], s78 offen offset:2048 lds
    buffer_load_dwordx4 v43, s[44:47], s78 offen offset:3072 lds
    s_mov_b32 m0, 8192
    s_nop 0
    buffer_load_dwordx4 v28, s[52:55], s72 offen lds
    buffer_load_dwordx4 v29, s[52:55], s72 offen offset:1024 lds
    buffer_load_dwordx4 v30, s[52:55], s72 offen offset:2048 lds
    buffer_load_dwordx4 v31, s[52:55], s72 offen offset:3072 lds
    s_mov_b32 m0, 32768
    s_nop 0
    buffer_load_dwordx4 v44, s[44:47], s78 offen lds
    buffer_load_dwordx4 v45, s[44:47], s78 offen offset:1024 lds
    buffer_load_dwordx4 v46, s[44:47], s78 offen offset:2048 lds
    buffer_load_dwordx4 v47, s[44:47], s78 offen offset:3072 lds
    s_mov_b32 m0, 16384
    s_nop 0
    buffer_load_dwordx4 v28, s[56:59], s72 offen lds
    buffer_load_dwordx4 v29, s[56:59], s72 offen offset:1024 lds
    buffer_load_dwordx4 v30, s[56:59], s72 offen offset:2048 lds
    buffer_load_dwordx4 v31, s[56:59], s72 offen offset:3072 lds
    s_mov_b32 m0, 36864
    s_nop 0
    buffer_load_dwordx4 v48, s[44:47], s78 offen lds
    s_waitcnt vmcnt(55)
    buffer_load_dwordx4 v49, s[44:47], s78 offen offset:1024 lds
    s_mov_b32 m0, 4096
    s_nop 0
    buffer_load_dwordx4 v32, s[48:51], s72 offen lds
    buffer_load_dwordx4 v33, s[48:51], s72 offen offset:1024 lds
    buffer_load_dwordx4 v34, s[48:51], s72 offen offset:2048 lds
    buffer_load_dwordx4 v35, s[48:51], s72 offen offset:3072 lds
    s_mov_b32 m0, 12288
    s_nop 0
    buffer_load_dwordx4 v32, s[52:55], s72 offen lds
    buffer_load_dwordx4 v33, s[52:55], s72 offen offset:1024 lds
    buffer_load_dwordx4 v34, s[52:55], s72 offen offset:2048 lds
    s_waitcnt vmcnt(55)
    buffer_load_dwordx4 v35, s[52:55], s72 offen offset:3072 lds
    s_mov_b32 m0, 20480
    s_nop 0
    buffer_load_dwordx4 v32, s[56:59], s72 offen lds
    buffer_load_dwordx4 v33, s[56:59], s72 offen offset:1024 lds
    buffer_load_dwordx4 v34, s[56:59], s72 offen offset:2048 lds
    buffer_load_dwordx4 v35, s[56:59], s72 offen offset:3072 lds
    s_waitcnt vmcnt(38) lgkmcnt(0)
    s_barrier
    s_lshr_b64 s[80:81], s[80:81], 4
    s_and_b32 s79, s80, 15
    s_add_u32 s79, s79, s43
    s_sub_u32 s38, s79, 10
    s_cmp_ge_u32 s79, 10
    s_cselect_b32 s79, s38, s79
    s_mul_i32 s73, s79, 245760
    s_lshl_b32 s78, s79, 7
    s_mov_b32 m0, 63616
    s_nop 0
    buffer_load_dwordx4 v36, s[44:47], s78 offen lds
    buffer_load_dwordx4 v37, s[44:47], s78 offen offset:1024 lds
    buffer_load_dwordx4 v38, s[44:47], s78 offen offset:2048 lds
    buffer_load_dwordx4 v39, s[44:47], s78 offen offset:3072 lds
    s_mov_b32 m0, 39040
    s_nop 0
    buffer_load_dwordx4 v28, s[48:51], s73 offen lds
    buffer_load_dwordx4 v29, s[48:51], s73 offen offset:1024 lds
    buffer_load_dwordx4 v30, s[48:51], s73 offen offset:2048 lds
    buffer_load_dwordx4 v31, s[48:51], s73 offen offset:3072 lds
    s_mov_b32 m0, 67712
    s_nop 0
    buffer_load_dwordx4 v40, s[44:47], s78 offen lds
    buffer_load_dwordx4 v41, s[44:47], s78 offen offset:1024 lds
    buffer_load_dwordx4 v42, s[44:47], s78 offen offset:2048 lds
    buffer_load_dwordx4 v43, s[44:47], s78 offen offset:3072 lds
    s_mov_b32 m0, 47232
    s_nop 0
    buffer_load_dwordx4 v28, s[52:55], s73 offen lds
    buffer_load_dwordx4 v29, s[52:55], s73 offen offset:1024 lds
    buffer_load_dwordx4 v30, s[52:55], s73 offen offset:2048 lds
    buffer_load_dwordx4 v31, s[52:55], s73 offen offset:3072 lds
    s_mov_b32 m0, 71808
    s_nop 0
    buffer_load_dwordx4 v44, s[44:47], s78 offen lds
    buffer_load_dwordx4 v45, s[44:47], s78 offen offset:1024 lds
    buffer_load_dwordx4 v46, s[44:47], s78 offen offset:2048 lds
    buffer_load_dwordx4 v47, s[44:47], s78 offen offset:3072 lds
    s_mov_b32 m0, 55424
    s_nop 0
    buffer_load_dwordx4 v28, s[56:59], s73 offen lds
    buffer_load_dwordx4 v29, s[56:59], s73 offen offset:1024 lds
    buffer_load_dwordx4 v30, s[56:59], s73 offen offset:2048 lds
    buffer_load_dwordx4 v31, s[56:59], s73 offen offset:3072 lds
    s_mov_b32 m0, 75904
    s_nop 0
    buffer_load_dwordx4 v48, s[44:47], s78 offen lds
    s_waitcnt vmcnt(55)
    buffer_load_dwordx4 v49, s[44:47], s78 offen offset:1024 lds
    s_mov_b32 m0, 43136
    s_nop 0
    buffer_load_dwordx4 v32, s[48:51], s73 offen lds
    buffer_load_dwordx4 v33, s[48:51], s73 offen offset:1024 lds
    buffer_load_dwordx4 v34, s[48:51], s73 offen offset:2048 lds
    buffer_load_dwordx4 v35, s[48:51], s73 offen offset:3072 lds
    s_mov_b32 m0, 51328
    s_nop 0
    buffer_load_dwordx4 v32, s[52:55], s73 offen lds
    buffer_load_dwordx4 v33, s[52:55], s73 offen offset:1024 lds
    buffer_load_dwordx4 v34, s[52:55], s73 offen offset:2048 lds
    s_waitcnt vmcnt(55)
    buffer_load_dwordx4 v35, s[52:55], s73 offen offset:3072 lds
    s_mov_b32 m0, 59520
    s_nop 0
    buffer_load_dwordx4 v32, s[56:59], s73 offen lds
    buffer_load_dwordx4 v33, s[56:59], s73 offen offset:1024 lds
    buffer_load_dwordx4 v34, s[56:59], s73 offen offset:2048 lds
    buffer_load_dwordx4 v35, s[56:59], s73 offen offset:3072 lds
    s_waitcnt vmcnt(38) lgkmcnt(0)
    s_barrier
    s_lshr_b64 s[80:81], s[80:81], 4
    s_and_b32 s79, s80, 15
    s_add_u32 s79, s79, s43
    s_sub_u32 s38, s79, 10
    s_cmp_ge_u32 s79, 10
    s_cselect_b32 s79, s38, s79
    s_mul_i32 s74, s79, 245760
    s_lshl_b32 s78, s79, 7
    s_mov_b32 m0, 102656
    s_nop 0
    buffer_load_dwordx4 v36, s[44:47], s78 offen lds
    buffer_load_dwordx4 v37, s[44:47], s78 offen offset:1024 lds
    buffer_load_dwordx4 v38, s[44:47], s78 offen offset:2048 lds
    buffer_load_dwordx4 v39, s[44:47], s78 offen offset:3072 lds
    s_mov_b32 m0, 78080
    s_nop 0
    buffer_load_dwordx4 v28, s[48:51], s74 offen lds
    buffer_load_dwordx4 v29, s[48:51], s74 offen offset:1024 lds
    buffer_load_dwordx4 v30, s[48:51], s74 offen offset:2048 lds
    buffer_load_dwordx4 v31, s[48:51], s74 offen offset:3072 lds
    s_mov_b32 m0, 106752
    s_nop 0
    buffer_load_dwordx4 v40, s[44:47], s78 offen lds
    buffer_load_dwordx4 v41, s[44:47], s78 offen offset:1024 lds
    buffer_load_dwordx4 v42, s[44:47], s78 offen offset:2048 lds
    buffer_load_dwordx4 v43, s[44:47], s78 offen offset:3072 lds
    s_mov_b32 m0, 86272
    s_nop 0
    buffer_load_dwordx4 v28, s[52:55], s74 offen lds
    buffer_load_dwordx4 v29, s[52:55], s74 offen offset:1024 lds
    buffer_load_dwordx4 v30, s[52:55], s74 offen offset:2048 lds
    buffer_load_dwordx4 v31, s[52:55], s74 offen offset:3072 lds
    s_mov_b32 m0, 110848
    s_nop 0
    buffer_load_dwordx4 v44, s[44:47], s78 offen lds
    buffer_load_dwordx4 v45, s[44:47], s78 offen offset:1024 lds
    buffer_load_dwordx4 v46, s[44:47], s78 offen offset:2048 lds
    buffer_load_dwordx4 v47, s[44:47], s78 offen offset:3072 lds
    s_mov_b32 m0, 82176
    s_nop 0
    buffer_load_dwordx4 v32, s[48:51], s74 offen lds
    buffer_load_dwordx4 v33, s[48:51], s74 offen offset:1024 lds
    buffer_load_dwordx4 v34, s[48:51], s74 offen offset:2048 lds
    buffer_load_dwordx4 v35, s[48:51], s74 offen offset:3072 lds
    s_mov_b32 m0, 114944
    s_nop 0
    buffer_load_dwordx4 v48, s[44:47], s78 offen lds
    s_waitcnt vmcnt(55)
    buffer_load_dwordx4 v49, s[44:47], s78 offen offset:1024 lds
    s_mov_b32 m0, 90368
    s_nop 0
    buffer_load_dwordx4 v32, s[52:55], s74 offen lds
    buffer_load_dwordx4 v33, s[52:55], s74 offen offset:1024 lds
    buffer_load_dwordx4 v34, s[52:55], s74 offen offset:2048 lds
    buffer_load_dwordx4 v35, s[52:55], s74 offen offset:3072 lds
    s_waitcnt vmcnt(30) lgkmcnt(0)
    s_barrier
    s_lshr_b64 s[80:81], s[80:81], 4
    s_and_b32 s79, s80, 15
    s_add_u32 s79, s79, s43
    s_sub_u32 s38, s79, 10
    s_cmp_ge_u32 s79, 10
    s_cselect_b32 s79, s38, s79
    s_mul_i32 s75, s79, 245760
    s_lshl_b32 s78, s79, 7
    s_mov_b32 m0, 141696
    s_nop 0
    buffer_load_dwordx4 v36, s[44:47], s78 offen lds
    buffer_load_dwordx4 v37, s[44:47], s78 offen offset:1024 lds
    buffer_load_dwordx4 v38, s[44:47], s78 offen offset:2048 lds
    buffer_load_dwordx4 v39, s[44:47], s78 offen offset:3072 lds
    s_mov_b32 m0, 117120
    s_nop 0
    buffer_load_dwordx4 v28, s[48:51], s75 offen lds
    buffer_load_dwordx4 v29, s[48:51], s75 offen offset:1024 lds
    buffer_load_dwordx4 v30, s[48:51], s75 offen offset:2048 lds
    buffer_load_dwordx4 v31, s[48:51], s75 offen offset:3072 lds
    s_mov_b32 m0, 145792
    s_nop 0
    buffer_load_dwordx4 v40, s[44:47], s78 offen lds
    buffer_load_dwordx4 v41, s[44:47], s78 offen offset:1024 lds
    buffer_load_dwordx4 v42, s[44:47], s78 offen offset:2048 lds
    buffer_load_dwordx4 v43, s[44:47], s78 offen offset:3072 lds
    s_mov_b32 m0, 125312
    s_nop 0
    buffer_load_dwordx4 v28, s[52:55], s75 offen lds
    buffer_load_dwordx4 v29, s[52:55], s75 offen offset:1024 lds
    buffer_load_dwordx4 v30, s[52:55], s75 offen offset:2048 lds
    buffer_load_dwordx4 v31, s[52:55], s75 offen offset:3072 lds
    s_mov_b32 m0, 149888
    s_nop 0
    buffer_load_dwordx4 v44, s[44:47], s78 offen lds
    buffer_load_dwordx4 v45, s[44:47], s78 offen offset:1024 lds
    buffer_load_dwordx4 v46, s[44:47], s78 offen offset:2048 lds
    buffer_load_dwordx4 v47, s[44:47], s78 offen offset:3072 lds
    s_mov_b32 m0, 121216
    s_nop 0
    buffer_load_dwordx4 v32, s[48:51], s75 offen lds
    buffer_load_dwordx4 v33, s[48:51], s75 offen offset:1024 lds
    buffer_load_dwordx4 v34, s[48:51], s75 offen offset:2048 lds
    buffer_load_dwordx4 v35, s[48:51], s75 offen offset:3072 lds
    s_mov_b32 m0, 153984
    s_nop 0
    buffer_load_dwordx4 v48, s[44:47], s78 offen lds
    buffer_load_dwordx4 v49, s[44:47], s78 offen offset:1024 lds
    s_mov_b32 m0, 129408
    s_nop 0
    buffer_load_dwordx4 v32, s[52:55], s75 offen lds
    buffer_load_dwordx4 v33, s[52:55], s75 offen offset:1024 lds
    buffer_load_dwordx4 v34, s[52:55], s75 offen offset:2048 lds
    buffer_load_dwordx4 v35, s[52:55], s75 offen offset:3072 lds
    s_waitcnt vmcnt(30) lgkmcnt(0)
    s_barrier
    s_lshr_b64 s[80:81], s[80:81], 4
    s_and_b32 s79, s80, 15
    s_add_u32 s79, s79, s43
    s_sub_u32 s38, s79, 10
    s_cmp_ge_u32 s79, 10
    s_cselect_b32 s79, s38, s79
    s_mul_i32 s76, s79, 245760
    s_lshl_b32 s78, s79, 7
    s_mov_b32 m0, 24576
    s_nop 0
    buffer_load_dwordx4 v36, s[44:47], s78 offen lds
    buffer_load_dwordx4 v37, s[44:47], s78 offen offset:1024 lds
    buffer_load_dwordx4 v38, s[44:47], s78 offen offset:2048 lds
    buffer_load_dwordx4 v39, s[44:47], s78 offen offset:3072 lds
    s_mov_b32 m0, 0
    s_nop 0
    buffer_load_dwordx4 v28, s[48:51], s76 offen lds
    buffer_load_dwordx4 v29, s[48:51], s76 offen offset:1024 lds
    buffer_load_dwordx4 v30, s[48:51], s76 offen offset:2048 lds
    buffer_load_dwordx4 v31, s[48:51], s76 offen offset:3072 lds
    s_mov_b32 m0, 28672
    s_nop 0
    buffer_load_dwordx4 v40, s[44:47], s78 offen lds
    buffer_load_dwordx4 v41, s[44:47], s78 offen offset:1024 lds
    buffer_load_dwordx4 v42, s[44:47], s78 offen offset:2048 lds
    buffer_load_dwordx4 v43, s[44:47], s78 offen offset:3072 lds
    s_mov_b32 m0, 8192
    s_nop 0
    buffer_load_dwordx4 v28, s[52:55], s76 offen lds
    buffer_load_dwordx4 v29, s[52:55], s76 offen offset:1024 lds
    buffer_load_dwordx4 v30, s[52:55], s76 offen offset:2048 lds
    buffer_load_dwordx4 v31, s[52:55], s76 offen offset:3072 lds
    s_mov_b32 m0, 32768
    s_nop 0
    buffer_load_dwordx4 v44, s[44:47], s78 offen lds
    buffer_load_dwordx4 v45, s[44:47], s78 offen offset:1024 lds
    buffer_load_dwordx4 v46, s[44:47], s78 offen offset:2048 lds
    buffer_load_dwordx4 v47, s[44:47], s78 offen offset:3072 lds
    s_mov_b32 m0, 4096
    s_nop 0
    buffer_load_dwordx4 v32, s[48:51], s76 offen lds
    buffer_load_dwordx4 v33, s[48:51], s76 offen offset:1024 lds
    buffer_load_dwordx4 v34, s[48:51], s76 offen offset:2048 lds
    buffer_load_dwordx4 v35, s[48:51], s76 offen offset:3072 lds
    s_mov_b32 m0, 36864
    s_nop 0
    buffer_load_dwordx4 v48, s[44:47], s78 offen lds
    buffer_load_dwordx4 v49, s[44:47], s78 offen offset:1024 lds
    s_mov_b32 m0, 12288
    s_nop 0
    buffer_load_dwordx4 v32, s[52:55], s76 offen lds
    buffer_load_dwordx4 v33, s[52:55], s76 offen offset:1024 lds
    buffer_load_dwordx4 v34, s[52:55], s76 offen offset:2048 lds
    buffer_load_dwordx4 v35, s[52:55], s76 offen offset:3072 lds
    s_waitcnt vmcnt(30) lgkmcnt(0)
    s_barrier
    s_lshr_b64 s[80:81], s[80:81], 4
    s_and_b32 s79, s80, 15
    s_add_u32 s79, s79, s43
    s_sub_u32 s38, s79, 10
    s_cmp_ge_u32 s79, 10
    s_cselect_b32 s79, s38, s79
    s_mul_i32 s77, s79, 245760
    s_lshl_b32 s78, s79, 7
    s_mov_b32 m0, 63616
    s_nop 0
    buffer_load_dwordx4 v36, s[44:47], s78 offen lds
    buffer_load_dwordx4 v37, s[44:47], s78 offen offset:1024 lds
    buffer_load_dwordx4 v38, s[44:47], s78 offen offset:2048 lds
    buffer_load_dwordx4 v39, s[44:47], s78 offen offset:3072 lds
    s_mov_b32 m0, 39040
    s_nop 0
    buffer_load_dwordx4 v28, s[48:51], s77 offen lds
    buffer_load_dwordx4 v29, s[48:51], s77 offen offset:1024 lds
    buffer_load_dwordx4 v30, s[48:51], s77 offen offset:2048 lds
    buffer_load_dwordx4 v31, s[48:51], s77 offen offset:3072 lds
    s_mov_b32 m0, 67712
    s_nop 0
    buffer_load_dwordx4 v40, s[44:47], s78 offen lds
    buffer_load_dwordx4 v41, s[44:47], s78 offen offset:1024 lds
    buffer_load_dwordx4 v42, s[44:47], s78 offen offset:2048 lds
    buffer_load_dwordx4 v43, s[44:47], s78 offen offset:3072 lds
    s_mov_b32 m0, 47232
    s_nop 0
    buffer_load_dwordx4 v28, s[52:55], s77 offen lds
    buffer_load_dwordx4 v29, s[52:55], s77 offen offset:1024 lds
    buffer_load_dwordx4 v30, s[52:55], s77 offen offset:2048 lds
    buffer_load_dwordx4 v31, s[52:55], s77 offen offset:3072 lds
    s_mov_b32 m0, 71808
    s_nop 0
    buffer_load_dwordx4 v44, s[44:47], s78 offen lds
    buffer_load_dwordx4 v45, s[44:47], s78 offen offset:1024 lds
    buffer_load_dwordx4 v46, s[44:47], s78 offen offset:2048 lds
    buffer_load_dwordx4 v47, s[44:47], s78 offen offset:3072 lds
    s_mov_b32 m0, 43136
    s_nop 0
    buffer_load_dwordx4 v32, s[48:51], s77 offen lds
    buffer_load_dwordx4 v33, s[48:51], s77 offen offset:1024 lds
    buffer_load_dwordx4 v34, s[48:51], s77 offen offset:2048 lds
    buffer_load_dwordx4 v35, s[48:51], s77 offen offset:3072 lds
    s_mov_b32 m0, 75904
    s_nop 0
    buffer_load_dwordx4 v48, s[44:47], s78 offen lds
    buffer_load_dwordx4 v49, s[44:47], s78 offen offset:1024 lds
    s_mov_b32 m0, 51328
    s_nop 0
    buffer_load_dwordx4 v32, s[52:55], s77 offen lds
    buffer_load_dwordx4 v33, s[52:55], s77 offen offset:1024 lds
    buffer_load_dwordx4 v34, s[52:55], s77 offen offset:2048 lds
    buffer_load_dwordx4 v35, s[52:55], s77 offen offset:3072 lds
    s_waitcnt vmcnt(30) lgkmcnt(0)
    s_barrier
    s_lshr_b64 s[80:81], s[80:81], 4
    s_and_b32 s79, s80, 15
    s_add_u32 s79, s79, s43
    s_sub_u32 s38, s79, 10
    s_cmp_ge_u32 s79, 10
    s_cselect_b32 s79, s38, s79
    s_mov_b32 m0, 94464
    s_nop 0
    buffer_load_dwordx4 v28, s[56:59], s74 offen lds
    buffer_load_dwordx4 v29, s[56:59], s74 offen offset:1024 lds
    buffer_load_dwordx4 v30, s[56:59], s74 offen offset:2048 lds
    buffer_load_dwordx4 v31, s[56:59], s74 offen offset:3072 lds
    s_mov_b32 m0, 98560
    s_nop 0
    buffer_load_dwordx4 v32, s[56:59], s74 offen lds
    buffer_load_dwordx4 v33, s[56:59], s74 offen offset:1024 lds
    buffer_load_dwordx4 v34, s[56:59], s74 offen offset:2048 lds
    buffer_load_dwordx4 v35, s[56:59], s74 offen offset:3072 lds
    s_mov_b32 m0, 133504
    s_nop 0
    buffer_load_dwordx4 v28, s[56:59], s75 offen lds
    buffer_load_dwordx4 v29, s[56:59], s75 offen offset:1024 lds
    buffer_load_dwordx4 v30, s[56:59], s75 offen offset:2048 lds
    buffer_load_dwordx4 v31, s[56:59], s75 offen offset:3072 lds
    s_waitcnt vmcnt(12) lgkmcnt(0)
    s_barrier
    s_mov_b32 m0, 137600
    s_nop 0
    buffer_load_dwordx4 v32, s[56:59], s75 offen lds
    buffer_load_dwordx4 v33, s[56:59], s75 offen offset:1024 lds
    buffer_load_dwordx4 v34, s[56:59], s75 offen offset:2048 lds
    buffer_load_dwordx4 v35, s[56:59], s75 offen offset:3072 lds
    s_mov_b32 m0, 16384
    s_nop 0
    buffer_load_dwordx4 v28, s[56:59], s76 offen lds
    buffer_load_dwordx4 v29, s[56:59], s76 offen offset:1024 lds
    buffer_load_dwordx4 v30, s[56:59], s76 offen offset:2048 lds
    buffer_load_dwordx4 v31, s[56:59], s76 offen offset:3072 lds
    s_mov_b32 m0, 20480
    s_nop 0
    buffer_load_dwordx4 v32, s[56:59], s76 offen lds
    buffer_load_dwordx4 v33, s[56:59], s76 offen offset:1024 lds
    buffer_load_dwordx4 v34, s[56:59], s76 offen offset:2048 lds
    buffer_load_dwordx4 v35, s[56:59], s76 offen offset:3072 lds
    s_mov_b32 m0, 55424
    s_nop 0
    buffer_load_dwordx4 v28, s[56:59], s77 offen lds
    buffer_load_dwordx4 v29, s[56:59], s77 offen offset:1024 lds
    buffer_load_dwordx4 v30, s[56:59], s77 offen offset:2048 lds
    buffer_load_dwordx4 v31, s[56:59], s77 offen offset:3072 lds
    s_mov_b32 m0, 59520
    s_nop 0
    buffer_load_dwordx4 v32, s[56:59], s77 offen lds
    buffer_load_dwordx4 v33, s[56:59], s77 offen offset:1024 lds
    buffer_load_dwordx4 v34, s[56:59], s77 offen offset:2048 lds
    buffer_load_dwordx4 v35, s[56:59], s77 offen offset:3072 lds
    s_mov_b32 s10, 20480
    v_lshrrev_b32 v52, 5, v1
    v_lshlrev_b32 v52, 3, v52
    v_add_u32 v53, 2, v52
    v_add_u32 v54, 4, v52
    v_add_u32 v55, 6, v52
    v_add_u32 v56, 16, v52
    v_add_u32 v57, 18, v52
    v_add_u32 v58, 20, v52
    v_add_u32 v59, 22, v52
    v_and_b32 v7, 3, v5
    v_mul_u32_u24 v7, 1280, v7
    v_add_u32 v60, v7, v50
    v_xor_b32 v61, 64, v60
    v_add_u32 v61, 4096, v61
    v_add_u32 v62, 8192, v60
    v_add_u32 v63, 8192, v61
    s_mov_b32 s5, 0xbfe10856
    s_mov_b32 s6, 0xaff80255
    s_mov_b32 s7, 0xabfe4015
    s_mov_b32 s8, 0xaa7fd005
    s_mov_b32 s9, 0x6adfb401
    s_cmp_eq_u32 s42, 1
    s_cselect_b32 s5, 0xabfe4015, s5
    s_cselect_b32 s6, 0xaa7fd005, s6
    s_cselect_b32 s7, 0x6adfb401, s7
    s_cselect_b32 s8, 0xbfe10856, s8
    s_cselect_b32 s9, 0xaff80255, s9
    s_cmp_eq_u32 s42, 2
    s_cselect_b32 s5, 0x6adfb401, s5
    s_cselect_b32 s6, 0xbfe10856, s6
    s_cselect_b32 s7, 0xaff80255, s7
    s_cselect_b32 s8, 0xabfe4015, s8
    s_cselect_b32 s9, 0xaa7fd005, s9
    s_cmp_eq_u32 s42, 3
    s_cselect_b32 s5, 0xaff80255, s5
    s_cselect_b32 s6, 0xabfe4015, s6
    s_cselect_b32 s7, 0xaa7fd005, s7
    s_cselect_b32 s8, 0x6adfb401, s8
    s_cselect_b32 s9, 0xbfe10856, s9
    s_cmp_eq_u32 s42, 4
    s_cselect_b32 s5, 0xaa7fd005, s5
    s_cselect_b32 s6, 0x6adfb401, s6
    s_cselect_b32 s7, 0xbfe10856, s7
    s_cselect_b32 s8, 0xaff80255, s8
    s_cselect_b32 s9, 0xabfe4015, s9
    s_mul_i32 s4, s42, 163840
    s_mov_b32 m0, 0
    v_bfe_u32 v64, s5, v52, 2
    v_mad_u32_u24 v64, v64, s10, v60
    buffer_load_dwordx4 v64, s[60:63], s4 offen lds
    v_bfe_u32 v65, s5, v53, 2
    v_mad_u32_u24 v65, v65, s10, v61
    buffer_load_dwordx4 v65, s[60:63], s4 offen offset:1024 lds
    v_bfe_u32 v64, s5, v54, 2
    v_mad_u32_u24 v64, v64, s10, v62
    buffer_load_dwordx4 v64, s[60:63], s4 offen offset:2048 lds
    v_bfe_u32 v65, s5, v55, 2
    v_mad_u32_u24 v65, v65, s10, v63
    buffer_load_dwordx4 v65, s[60:63], s4 offen offset:3072 lds
    s_mov_b32 m0, 4096
    v_bfe_u32 v64, s5, v56, 2
    v_mad_u32_u24 v64, v64, s10, v60
    buffer_load_dwordx4 v64, s[60:63], s4 offen lds
    v_bfe_u32 v65, s5, v57, 2
    v_mad_u32_u24 v65, v65, s10, v61
    buffer_load_dwordx4 v65, s[60:63], s4 offen offset:1024 lds
    v_bfe_u32 v64, s5, v58, 2
    v_mad_u32_u24 v64, v64, s10, v62
    buffer_load_dwordx4 v64, s[60:63], s4 offen offset:2048 lds
    v_bfe_u32 v65, s5, v59, 2
    v_mad_u32_u24 v65, v65, s10, v63
    buffer_load_dwordx4 v65, s[60:63], s4 offen offset:3072 lds
    s_add_u32 s4, s4, 81920
    s_cmp_eq_u32 s4, 819200
    s_cselect_b32 s4, 0, s4
    s_mov_b32 m0, 8192
    v_bfe_u32 v64, s6, v52, 2
    v_mad_u32_u24 v64, v64, s10, v60
    buffer_load_dwordx4 v64, s[60:63], s4 offen lds
    v_bfe_u32 v65, s6, v53, 2
    v_mad_u32_u24 v65, v65, s10, v61
    buffer_load_dwordx4 v65, s[60:63], s4 offen offset:1024 lds
    v_bfe_u32 v64, s6, v54, 2
    v_mad_u32_u24 v64, v64, s10, v62
    buffer_load_dwordx4 v64, s[60:63], s4 offen offset:2048 lds
    v_bfe_u32 v65, s6, v55, 2
    v_mad_u32_u24 v65, v65, s10, v63
    buffer_load_dwordx4 v65, s[60:63], s4 offen offset:3072 lds
    s_mov_b32 m0, 12288
    v_bfe_u32 v64, s6, v56, 2
    v_mad_u32_u24 v64, v64, s10, v60
    buffer_load_dwordx4 v64, s[60:63], s4 offen lds
    v_bfe_u32 v65, s6, v57, 2
    v_mad_u32_u24 v65, v65, s10, v61
    buffer_load_dwordx4 v65, s[60:63], s4 offen offset:1024 lds
    v_bfe_u32 v64, s6, v58, 2
    v_mad_u32_u24 v64, v64, s10, v62
    buffer_load_dwordx4 v64, s[60:63], s4 offen offset:2048 lds
    v_bfe_u32 v65, s6, v59, 2
    v_mad_u32_u24 v65, v65, s10, v63
    buffer_load_dwordx4 v65, s[60:63], s4 offen offset:3072 lds
    s_add_u32 s4, s4, 81920
    s_cmp_eq_u32 s4, 819200
    s_cselect_b32 s4, 0, s4
    s_waitcnt vmcnt(16)
    v_mov_b32 v5, 157980
    v_mov_b32 v6, 1
    s_mov_b64 exec, 1
    ds_add_u32 v5, v6
    s_mov_b64 exec, -1
    v_mov_b32 v5, 157972
    v_mov_b32 v6, 1
    s_mov_b64 exec, 1
    ds_add_u32 v5, v6
    s_mov_b64 exec, -1
    s_mov_b32 m0, 24576
    v_bfe_u32 v64, s7, v52, 2
    v_mad_u32_u24 v64, v64, s10, v60
    buffer_load_dwordx4 v64, s[60:63], s4 offen lds
    v_bfe_u32 v65, s7, v53, 2
    v_mad_u32_u24 v65, v65, s10, v61
    buffer_load_dwordx4 v65, s[60:63], s4 offen offset:1024 lds
    v_bfe_u32 v64, s7, v54, 2
    v_mad_u32_u24 v64, v64, s10, v62
    buffer_load_dwordx4 v64, s[60:63], s4 offen offset:2048 lds
    v_bfe_u32 v65, s7, v55, 2
    v_mad_u32_u24 v65, v65, s10, v63
    buffer_load_dwordx4 v65, s[60:63], s4 offen offset:3072 lds
    s_mov_b32 m0, 28672
    v_bfe_u32 v64, s7, v56, 2
    v_mad_u32_u24 v64, v64, s10, v60
    buffer_load_dwordx4 v64, s[60:63], s4 offen lds
    v_bfe_u32 v65, s7, v57, 2
    v_mad_u32_u24 v65, v65, s10, v61
    buffer_load_dwordx4 v65, s[60:63], s4 offen offset:1024 lds
    v_bfe_u32 v64, s7, v58, 2
    v_mad_u32_u24 v64, v64, s10, v62
    buffer_load_dwordx4 v64, s[60:63], s4 offen offset:2048 lds
    v_bfe_u32 v65, s7, v59, 2
    v_mad_u32_u24 v65, v65, s10, v63
    buffer_load_dwordx4 v65, s[60:63], s4 offen offset:3072 lds
    s_add_u32 s4, s4, 81920
    s_cmp_eq_u32 s4, 819200
    s_cselect_b32 s4, 0, s4
    s_mov_b32 m0, 123136
    v_bfe_u32 v64, s8, v52, 2
    v_mad_u32_u24 v64, v64, s10, v60
    buffer_load_dwordx4 v64, s[60:63], s4 offen lds
    v_bfe_u32 v65, s8, v53, 2
    v_mad_u32_u24 v65, v65, s10, v61
    buffer_load_dwordx4 v65, s[60:63], s4 offen offset:1024 lds
    v_bfe_u32 v64, s8, v54, 2
    v_mad_u32_u24 v64, v64, s10, v62
    buffer_load_dwordx4 v64, s[60:63], s4 offen offset:2048 lds
    v_bfe_u32 v65, s8, v55, 2
    v_mad_u32_u24 v65, v65, s10, v63
    buffer_load_dwordx4 v65, s[60:63], s4 offen offset:3072 lds
    s_mov_b32 m0, 127232
    v_bfe_u32 v64, s8, v56, 2
    v_mad_u32_u24 v64, v64, s10, v60
    buffer_load_dwordx4 v64, s[60:63], s4 offen lds
    v_bfe_u32 v65, s8, v57, 2
    v_mad_u32_u24 v65, v65, s10, v61
    buffer_load_dwordx4 v65, s[60:63], s4 offen offset:1024 lds
    v_bfe_u32 v64, s8, v58, 2
    v_mad_u32_u24 v64, v64, s10, v62
    buffer_load_dwordx4 v64, s[60:63], s4 offen offset:2048 lds
    v_bfe_u32 v65, s8, v59, 2
    v_mad_u32_u24 v65, v65, s10, v63
    buffer_load_dwordx4 v65, s[60:63], s4 offen offset:3072 lds
    s_add_u32 s4, s4, 81920
    s_cmp_eq_u32 s4, 819200
    s_cselect_b32 s4, 0, s4
    s_mov_b32 m0, 80000
    v_bfe_u32 v64, s9, v52, 2
    v_mad_u32_u24 v64, v64, s10, v60
    buffer_load_dwordx4 v64, s[60:63], s4 offen lds
    v_bfe_u32 v65, s9, v53, 2
    v_mad_u32_u24 v65, v65, s10, v61
    buffer_load_dwordx4 v65, s[60:63], s4 offen offset:1024 lds
    v_bfe_u32 v64, s9, v54, 2
    v_mad_u32_u24 v64, v64, s10, v62
    buffer_load_dwordx4 v64, s[60:63], s4 offen offset:2048 lds
    v_bfe_u32 v65, s9, v55, 2
    v_mad_u32_u24 v65, v65, s10, v63
    buffer_load_dwordx4 v65, s[60:63], s4 offen offset:3072 lds
    s_mov_b32 m0, 84096
    v_bfe_u32 v64, s9, v56, 2
    v_mad_u32_u24 v64, v64, s10, v60
    buffer_load_dwordx4 v64, s[60:63], s4 offen lds
    v_bfe_u32 v65, s9, v57, 2
    v_mad_u32_u24 v65, v65, s10, v61
    buffer_load_dwordx4 v65, s[60:63], s4 offen offset:1024 lds
    v_bfe_u32 v64, s9, v58, 2
    v_mad_u32_u24 v64, v64, s10, v62
    buffer_load_dwordx4 v64, s[60:63], s4 offen offset:2048 lds
    v_bfe_u32 v65, s9, v59, 2
    v_mad_u32_u24 v65, v65, s10, v63
    buffer_load_dwordx4 v65, s[60:63], s4 offen offset:3072 lds
    s_add_u32 s4, s4, 81920
    s_cmp_eq_u32 s4, 819200
    s_cselect_b32 s4, 0, s4
    s_waitcnt vmcnt(0)
    v_mov_b32 v7, 157980
    v_mov_b32 v6, 1
    s_mov_b64 exec, 1
    ds_add_u32 v7, v6
    s_mov_b64 exec, -1
Lcw_7:
    s_sub_u32 s35, s35, 1
    s_cbranch_scc1 Lend
    s_sleep 2
    ds_read_b32 v6, v5
    s_waitcnt lgkmcnt(0)
    v_readfirstlane_b32 s38, v6
    s_nop 0
    s_cmp_lt_u32 s38, 8
    s_cbranch_scc1 Lcw_7
    s_lshl_b32 s36, s32, 7
    s_add_u32 s36, s36, 8257536
    v_mov_b32 v69, s36
    buffer_load_dwordx4 v[70:73], v69, s[28:31], 0 offen sc1
    v_mov_b32 v5, 157976
Lcw_8:
    s_sub_u32 s35, s35, 1
    s_cbranch_scc1 Lend
    s_sleep 2
    ds_read_b32 v6, v5
    s_waitcnt lgkmcnt(0)
    v_readfirstlane_b32 s38, v6
    s_nop 0
    s_cmp_lt_u32 s38, 7
    s_cbranch_scc1 Lcw_8
    s_mov_b32 m0, 32768
    v_bfe_u32 v64, s5, v52, 2
    v_mad_u32_u24 v64, v64, s10, v60
    buffer_load_dwordx4 v64, s[60:63], s4 offen lds
    v_bfe_u32 v65, s5, v53, 2
    v_mad_u32_u24 v65, v65, s10, v61
    buffer_load_dwordx4 v65, s[60:63], s4 offen offset:1024 lds
    v_bfe_u32 v64, s5, v54, 2
    v_mad_u32_u24 v64, v64, s10, v62
    buffer_load_dwordx4 v64, s[60:63], s4 offen offset:2048 lds
    v_bfe_u32 v65, s5, v55, 2
    v_mad_u32_u24 v65, v65, s10, v63
    buffer_load_dwordx4 v65, s[60:63], s4 offen offset:3072 lds
    s_mov_b32 m0, 36864
    v_bfe_u32 v64, s5, v56, 2
    v_mad_u32_u24 v64, v64, s10, v60
    buffer_load_dwordx4 v64, s[60:63], s4 offen lds
    v_bfe_u32 v65, s5, v57, 2
    v_mad_u32_u24 v65, v65, s10, v61
    buffer_load_dwordx4 v65, s[60:63], s4 offen offset:1024 lds
    v_bfe_u32 v64, s5, v58, 2
    v_mad_u32_u24 v64, v64, s10, v62
    buffer_load_dwordx4 v64, s[60:63], s4 offen offset:2048 lds
    v_bfe_u32 v65, s5, v59, 2
    v_mad_u32_u24 v65, v65, s10, v63
    buffer_load_dwordx4 v65, s[60:63], s4 offen offset:3072 lds
    s_add_u32 s4, s4, 81920
    s_cmp_eq_u32 s4, 819200
    s_cselect_b32 s4, 0, s4
    s_mov_b32 m0, 40960
    v_bfe_u32 v64, s6, v52, 2
    v_mad_u32_u24 v64, v64, s10, v60
    buffer_load_dwordx4 v64, s[60:63], s4 offen lds
    v_bfe_u32 v65, s6, v53, 2
    v_mad_u32_u24 v65, v65, s10, v61
    buffer_load_dwordx4 v65, s[60:63], s4 offen offset:1024 lds
    v_bfe_u32 v64, s6, v54, 2
    v_mad_u32_u24 v64, v64, s10, v62
    buffer_load_dwordx4 v64, s[60:63], s4 offen offset:2048 lds
    v_bfe_u32 v65, s6, v55, 2
    v_mad_u32_u24 v65, v65, s10, v63
    buffer_load_dwordx4 v65, s[60:63], s4 offen offset:3072 lds
    s_mov_b32 m0, 45056
    v_bfe_u32 v64, s6, v56, 2
    v_mad_u32_u24 v64, v64, s10, v60
    buffer_load_dwordx4 v64, s[60:63], s4 offen lds
    v_bfe_u32 v65, s6, v57, 2
    v_mad_u32_u24 v65, v65, s10, v61
    buffer_load_dwordx4 v65, s[60:63], s4 offen offset:1024 lds
    v_bfe_u32 v64, s6, v58, 2
    v_mad_u32_u24 v64, v64, s10, v62
    buffer_load_dwordx4 v64, s[60:63], s4 offen offset:2048 lds
    v_bfe_u32 v65, s6, v59, 2
    v_mad_u32_u24 v65, v65, s10, v63
    buffer_load_dwordx4 v65, s[60:63], s4 offen offset:3072 lds
    s_add_u32 s4, s4, 81920
    s_cmp_eq_u32 s4, 819200
    s_cselect_b32 s4, 0, s4
    s_mov_b32 m0, 63616
    v_bfe_u32 v64, s7, v52, 2
    v_mad_u32_u24 v64, v64, s10, v60
    buffer_load_dwordx4 v64, s[60:63], s4 offen lds
    v_bfe_u32 v65, s7, v53, 2
    v_mad_u32_u24 v65, v65, s10, v61
    buffer_load_dwordx4 v65, s[60:63], s4 offen offset:1024 lds
    v_bfe_u32 v64, s7, v54, 2
    v_mad_u32_u24 v64, v64, s10, v62
    buffer_load_dwordx4 v64, s[60:63], s4 offen offset:2048 lds
    v_bfe_u32 v65, s7, v55, 2
    v_mad_u32_u24 v65, v65, s10, v63
    buffer_load_dwordx4 v65, s[60:63], s4 offen offset:3072 lds
    s_mov_b32 m0, 67712
    v_bfe_u32 v64, s7, v56, 2
    v_mad_u32_u24 v64, v64, s10, v60
    buffer_load_dwordx4 v64, s[60:63], s4 offen lds
    v_bfe_u32 v65, s7, v57, 2
    v_mad_u32_u24 v65, v65, s10, v61
    buffer_load_dwordx4 v65, s[60:63], s4 offen offset:1024 lds
    v_bfe_u32 v64, s7, v58, 2
    v_mad_u32_u24 v64, v64, s10, v62
    buffer_load_dwordx4 v64, s[60:63], s4 offen offset:2048 lds
    v_bfe_u32 v65, s7, v59, 2
    v_mad_u32_u24 v65, v65, s10, v63
    buffer_load_dwordx4 v65, s[60:63], s4 offen offset:3072 lds
    s_add_u32 s4, s4, 81920
    s_cmp_eq_u32 s4, 819200
    s_cselect_b32 s4, 0, s4
    s_mov_b32 m0, 71808
    v_bfe_u32 v64, s8, v52, 2
    v_mad_u32_u24 v64, v64, s10, v60
    buffer_load_dwordx4 v64, s[60:63], s4 offen lds
    v_bfe_u32 v65, s8, v53, 2
    v_mad_u32_u24 v65, v65, s10, v61
    buffer_load_dwordx4 v65, s[60:63], s4 offen offset:1024 lds
    v_bfe_u32 v64, s8, v54, 2
    v_mad_u32_u24 v64, v64, s10, v62
    buffer_load_dwordx4 v64, s[60:63], s4 offen offset:2048 lds
    v_bfe_u32 v65, s8, v55, 2
    v_mad_u32_u24 v65, v65, s10, v63
    buffer_load_dwordx4 v65, s[60:63], s4 offen offset:3072 lds
    s_mov_b32 m0, 75904
    v_bfe_u32 v64, s8, v56, 2
    v_mad_u32_u24 v64, v64, s10, v60
    buffer_load_dwordx4 v64, s[60:63], s4 offen lds
    v_bfe_u32 v65, s8, v57, 2
    v_mad_u32_u24 v65, v65, s10, v61
    buffer_load_dwordx4 v65, s[60:63], s4 offen offset:1024 lds
    v_bfe_u32 v64, s8, v58, 2
    v_mad_u32_u24 v64, v64, s10, v62
    buffer_load_dwordx4 v64, s[60:63], s4 offen offset:2048 lds
    v_bfe_u32 v65, s8, v59, 2
    v_mad_u32_u24 v65, v65, s10, v63
    buffer_load_dwordx4 v65, s[60:63], s4 offen offset:3072 lds
    s_add_u32 s4, s4, 81920
    s_cmp_eq_u32 s4, 819200
    s_cselect_b32 s4, 0, s4
    s_mov_b32 m0, 49152
    v_bfe_u32 v64, s9, v52, 2
    v_mad_u32_u24 v64, v64, s10, v60
    buffer_load_dwordx4 v64, s[60:63], s4 offen lds
    v_bfe_u32 v65, s9, v53, 2
    v_mad_u32_u24 v65, v65, s10, v61
    buffer_load_dwordx4 v65, s[60:63], s4 offen offset:1024 lds
    v_bfe_u32 v64, s9, v54, 2
    v_mad_u32_u24 v64, v64, s10, v62
    buffer_load_dwordx4 v64, s[60:63], s4 offen offset:2048 lds
    v_bfe_u32 v65, s9, v55, 2
    v_mad_u32_u24 v65, v65, s10, v63
    buffer_load_dwordx4 v65, s[60:63], s4 offen offset:3072 lds
    s_mov_b32 m0, 88192
    v_bfe_u32 v64, s9, v56, 2
    v_mad_u32_u24 v64, v64, s10, v60
    buffer_load_dwordx4 v64, s[60:63], s4 offen lds
    v_bfe_u32 v65, s9, v57, 2
    v_mad_u32_u24 v65, v65, s10, v61
    buffer_load_dwordx4 v65, s[60:63], s4 offen offset:1024 lds
    v_bfe_u32 v64, s9, v58, 2
    v_mad_u32_u24 v64, v64, s10, v62
    buffer_load_dwordx4 v64, s[60:63], s4 offen offset:2048 lds
    v_bfe_u32 v65, s9, v59, 2
    v_mad_u32_u24 v65, v65, s10, v63
    buffer_load_dwordx4 v65, s[60:63], s4 offen offset:3072 lds
    s_add_u32 s4, s4, 81920
    s_cmp_eq_u32 s4, 819200
    s_cselect_b32 s4, 0, s4
    s_waitcnt vmcnt(0)
Lbc:
    v_readfirstlane_b32 s11, v70
    v_readfirstlane_b32 s36, v71
    v_readfirstlane_b32 s12, v72
    v_readfirstlane_b32 s37, v73
    s_cmp_eq_u32 s36, s34
    s_cselect_b32 s37, s37, s36
    s_cmp_eq_u32 s37, s34
    s_cbranch_scc1 Lbc_ok
Lbc_re:
    s_sub_u32 s35, s35, 1
    s_cbranch_scc1 Lend
    buffer_load_dwordx4 v[70:73], v69, s[28:31], 0 offen sc1
    s_waitcnt vmcnt(0)
    s_branch Lbc
Lbc_ok:
    s_mul_i32 s36, s32, 96
    s_and_b32 s13, s11, 0x7ff
    s_sub_u32 s13, 2047, s13
    s_sub_u32 s37, s13, s36
    s_cmp_lt_u32 s37, 96
    s_cselect_b32 s13, s13, -1
    s_and_b32 s14, s12, 0x7ff
    s_sub_u32 s14, 2047, s14
    s_sub_u32 s37, s14, s36
    s_cmp_lt_u32 s37, 96
    s_cselect_b32 s14, s14, -1
    v_mov_b32 v4, s13
    v_mov_b32 v5, s14
    v_mov_b32 v6, 157960
    s_cmp_lg_u32 s3, 0
    s_cbranch_scc1 Lag2
    ds_write_b64 v6, v[4:5]
    s_branch Lw0_done
Lag2:
    s_and_b32 s37, s13, s14
    s_cmp_eq_u32 s37, -1
    s_cbranch_scc1 Lw0_done
    s_max_i32 s36, s13, 0
    s_mul_i32 s36, s36, 1280
    s_lshl_b32 s37, s33, 7
    s_add_u32 s36, s36, s37
    s_add_u32 s36, s36, 4096
    v_lshlrev_b32 v8, 1, v1
    buffer_load_ushort v124, v8, s[44:47], s36 offen
    s_max_i32 s36, s14, 0
    s_mul_i32 s36, s36, 1280
    s_lshl_b32 s37, s33, 7
    s_add_u32 s36, s36, s37
    s_add_u32 s36, s36, 4096
    v_lshlrev_b32 v8, 1, v1
    buffer_load_ushort v125, v8, s[44:47], s36 offen
    v_min_u32 v7, 26, v1
    v_mul_u32_u24 v7, 10240, v7
Ly_poll:
    s_sub_u32 s35, s35, 1
    s_cbranch_scc1 Lend
    s_sleep 4
    s_lshl_b32 s36, s33, 10
    s_add_u32 s36, s36, 7405568
    buffer_load_dword v4, v7, s[28:31], s36 offen offset:1020 sc1
    s_waitcnt vmcnt(0)
    v_cmp_ne_u32 vcc, s34, v4
    s_nop 0
    s_cbranch_vccnz Ly_poll
    buffer_load_dwordx4 v[16:19], v13, s[28:31], s36 offen sc1
    s_add_u32 s36, s36, 10240
    buffer_load_dwordx4 v[20:23], v13, s[28:31], s36 offen sc1
    s_add_u32 s36, s36, 10240
    buffer_load_dwordx4 v[24:27], v13, s[28:31], s36 offen sc1
    s_add_u32 s36, s36, 10240
    buffer_load_dwordx4 v[28:31], v13, s[28:31], s36 offen sc1
    s_add_u32 s36, s36, 10240
    buffer_load_dwordx4 v[32:35], v13, s[28:31], s36 offen sc1
    s_add_u32 s36, s36, 10240
    buffer_load_dwordx4 v[36:39], v13, s[28:31], s36 offen sc1
    s_add_u32 s36, s36, 10240
    buffer_load_dwordx4 v[40:43], v13, s[28:31], s36 offen sc1
    s_add_u32 s36, s36, 10240
    buffer_load_dwordx4 v[44:47], v13, s[28:31], s36 offen sc1
    s_add_u32 s36, s36, 10240
    buffer_load_dwordx4 v[48:51], v13, s[28:31], s36 offen sc1
    s_add_u32 s36, s36, 10240
    buffer_load_dwordx4 v[52:55], v13, s[28:31], s36 offen sc1
    s_add_u32 s36, s36, 10240
    buffer_load_dwordx4 v[56:59], v13, s[28:31], s36 offen sc1
    s_add_u32 s36, s36, 10240
    buffer_load_dwordx4 v[60:63], v13, s[28:31], s36 offen sc1
    s_add_u32 s36, s36, 10240
    buffer_load_dwordx4 v[64:67], v13, s[28:31], s36 offen sc1
    s_add_u32 s36, s36, 10240
    buffer_load_dwordx4 v[68:71], v13, s[28:31], s36 offen sc1
    s_add_u32 s36, s36, 10240
    buffer_load_dwordx4 v[72:75], v13, s[28:31], s36 offen sc1
    s_add_u32 s36, s36, 10240
    buffer_load_dwordx4 v[76:79], v13, s[28:31], s36 offen sc1
    s_add_u32 s36, s36, 10240
    buffer_load_dwordx4 v[80:83], v13, s[28:31], s36 offen sc1
    s_add_u32 s36, s36, 10240
    buffer_load_dwordx4 v[84:87], v13, s[28:31], s36 offen sc1
    s_add_u32 s36, s36, 10240
    buffer_load_dwordx4 v[88:91], v13, s[28:31], s36 offen sc1
    s_add_u32 s36, s36, 10240
    buffer_load_dwordx4 v[92:95], v13, s[28:31], s36 offen sc1
    s_add_u32 s36, s36, 10240
    buffer_load_dwordx4 v[96:99], v13, s[28:31], s36 offen sc1
    s_add_u32 s36, s36, 10240
    buffer_load_dwordx4 v[100:103], v13, s[28:31], s36 offen sc1
    s_add_u32 s36, s36, 10240
    buffer_load_dwordx4 v[104:107], v13, s[28:31], s36 offen sc1
    s_add_u32 s36, s36, 10240
    buffer_load_dwordx4 v[108:111], v13, s[28:31], s36 offen sc1
    s_add_u32 s36, s36, 10240
    buffer_load_dwordx4 v[112:115], v13, s[28:31], s36 offen sc1
    s_add_u32 s36, s36, 10240
    buffer_load_dwordx4 v[116:119], v13, s[28:31], s36 offen sc1
    s_add_u32 s36, s36, 10240
    buffer_load_dwordx4 v[120:123], v13, s[28:31], s36 offen sc1
    s_add_u32 s36, s36, 10240
    s_waitcnt vmcnt(0)
    v_xor_b32 v4, s34, v17
    v_xor_b32 v5, s34, v19
    v_or_b32 v4, v4, v5
    v_xor_b32 v5, s34, v21
    v_or_b32 v4, v4, v5
    v_xor_b32 v5, s34, v23
    v_or_b32 v4, v4, v5
    v_xor_b32 v5, s34, v25
    v_or_b32 v4, v4, v5
    v_xor_b32 v5, s34, v27
    v_or_b32 v4, v4, v5
    v_xor_b32 v5, s34, v29
    v_or_b32 v4, v4, v5
    v_xor_b32 v5, s34, v31
    v_or_b32 v4, v4, v5
    v_xor_b32 v5, s34, v33
    v_or_b32 v4, v4, v5
    v_xor_b32 v5, s34, v35
    v_or_b32 v4, v4, v5
    v_xor_b32 v5, s34, v37
    v_or_b32 v4, v4, v5
    v_xor_b32 v5, s34, v39
    v_or_b32 v4, v4, v5
    v_xor_b32 v5, s34, v41
    v_or_b32 v4, v4, v5
    v_xor_b32 v5, s34, v43
    v_or_b32 v4, v4, v5
    v_xor_b32 v5, s34, v45
    v_or_b32 v4, v4, v5
    v_xor_b32 v5, s34, v47
    v_or_b32 v4, v4, v5
    v_xor_b32 v5, s34, v49
    v_or_b32 v4, v4, v5
    v_xor_b32 v5, s34, v51
    v_or_b32 v4, v4, v5
    v_xor_b32 v5, s34, v53
    v_or_b32 v4, v4, v5
    v_xor_b32 v5, s34, v55
    v_or_b32 v4, v4, v5
    v_xor_b32 v5, s34, v57
    v_or_b32 v4, v4, v5
    v_xor_b32 v5, s34, v59
    v_or_b32 v4, v4, v5
    v_xor_b32 v5, s34, v61
    v_or_b32 v4, v4, v5
    v_xor_b32 v5, s34, v63
    v_or_b32 v4, v4, v5
    v_xor_b32 v5, s34, v65
    v_or_b32 v4, v4, v5
    v_xor_b32 v5, s34, v67
    v_or_b32 v4, v4, v5
    v_xor_b32 v5, s34, v69
    v_or_b32 v4, v4, v5
    v_xor_b32 v5, s34, v71
    v_or_b32 v4, v4, v5
    v_xor_b32 v5, s34, v73
    v_or_b32 v4, v4, v5
    v_xor_b32 v5, s34, v75
    v_or_b32 v4, v4, v5
    v_xor_b32 v5, s34, v77
    v_or_b32 v4, v4, v5
    v_xor_b32 v5, s34, v79
    v_or_b32 v4, v4, v5
    v_xor_b32 v5, s34, v81
    v_or_b32 v4, v4, v5
    v_xor_b32 v5, s34, v83
    v_or_b32 v4, v4, v5
    v_xor_b32 v5, s34, v85
    v_or_b32 v4, v4, v5
    v_xor_b32 v5, s34, v87
    v_or_b32 v4, v4, v5
    v_xor_b32 v5, s34, v89
    v_or_b32 v4, v4, v5
    v_xor_b32 v5, s34, v91
    v_or_b32 v4, v4, v5
    v_xor_b32 v5, s34, v93
    v_or_b32 v4, v4, v5
    v_xor_b32 v5, s34, v95
    v_or_b32 v4, v4, v5
    v_xor_b32 v5, s34, v97
    v_or_b32 v4, v4, v5
    v_xor_b32 v5, s34, v99
    v_or_b32 v4, v4, v5
    v_xor_b32 v5, s34, v101
    v_or_b32 v4, v4, v5
    v_xor_b32 v5, s34, v103
    v_or_b32 v4, v4, v5
    v_xor_b32 v5, s34, v105
    v_or_b32 v4, v4, v5
    v_xor_b32 v5, s34, v107
    v_or_b32 v4, v4, v5
    v_xor_b32 v5, s34, v109
    v_or_b32 v4, v4, v5
    v_xor_b32 v5, s34, v111
    v_or_b32 v4, v4, v5
    v_xor_b32 v5, s34, v113
    v_or_b32 v4, v4, v5
    v_xor_b32 v5, s34, v115
    v_or_b32 v4, v4, v5
    v_xor_b32 v5, s34, v117
    v_or_b32 v4, v4, v5
    v_xor_b32 v5, s34, v119
    v_or_b32 v4, v4, v5
    v_xor_b32 v5, s34, v121
    v_or_b32 v4, v4, v5
    v_xor_b32 v5, s34, v123
    v_or_b32 v4, v4, v5
    v_cmp_ne_u32 vcc, 0, v4
    s_nop 0
    s_cmp_lg_u64 vcc, 0
    s_cbranch_scc1 Ly_poll
    v_add_f32 v16, v16, v20
    v_add_f32 v18, v18, v22
    v_add_f32 v16, v16, v24
    v_add_f32 v18, v18, v26
    v_add_f32 v16, v16, v28
    v_add_f32 v18, v18, v30
    v_add_f32 v16, v16, v32
    v_add_f32 v18, v18, v34
    v_add_f32 v16, v16, v36
    v_add_f32 v18, v18, v38
    v_add_f32 v16, v16, v40
    v_add_f32 v18, v18, v42
    v_add_f32 v16, v16, v44
    v_add_f32 v18, v18, v46
    v_add_f32 v16, v16, v48
    v_add_f32 v18, v18, v50
    v_add_f32 v16, v16, v52
    v_add_f32 v18, v18, v54
    v_add_f32 v16, v16, v56
    v_add_f32 v18, v18, v58
    v_add_f32 v16, v16, v60
    v_add_f32 v18, v18, v62
    v_add_f32 v16, v16, v64
    v_add_f32 v18, v18, v66
    v_add_f32 v16, v16, v68
    v_add_f32 v18, v18, v70
    v_add_f32 v16, v16, v72
    v_add_f32 v18, v18, v74
    v_add_f32 v16, v16, v76
    v_add_f32 v18, v18, v78
    v_add_f32 v16, v16, v80
    v_add_f32 v18, v18, v82
    v_add_f32 v16, v16, v84
    v_add_f32 v18, v18, v86
    v_add_f32 v16, v16, v88
    v_add_f32 v18, v18, v90
    v_add_f32 v16, v16, v92
    v_add_f32 v18, v18, v94
    v_add_f32 v16, v16, v96
    v_add_f32 v18, v18, v98
    v_add_f32 v16, v16, v100
    v_add_f32 v18, v18, v102
    v_add_f32 v16, v16, v104
    v_add_f32 v18, v18, v106
    v_add_f32 v16, v16, v108
    v_add_f32 v18, v18, v110
    v_add_f32 v16, v16, v112
    v_add_f32 v18, v18, v114
    v_add_f32 v16, v16, v116
    v_add_f32 v18, v18, v118
    v_add_f32 v16, v16, v120
    v_add_f32 v18, v18, v122
    s_lshr_b32 s36, s11, 16
    s_cmp_ge_u32 s36, 0x8000
    s_cselect_b32 s37, 0x8000, -1
    s_xor_b32 s36, s36, s37
    s_lshl_b32 s36, s36, 16
    v_mov_b32 v4, s36
    v_mul_f32 v4, 0xbfb8aa3b, v4
    v_exp_f32 v4, v4
    s_nop 0
    v_add_f32 v4, 1.0, v4
    v_rcp_f32 v4, v4
    s_nop 0
    v_cvt_pk_bf16_f32 v4, v4, v4
    v_lshlrev_b32 v4, 16, v4
    v_cvt_pk_bf16_f32 v16, v16, v16
    v_lshlrev_b32 v16, 16, v16
    v_mul_f32 v16, v16, v4
    v_cvt_pk_bf16_f32 v16, v16, v16
    v_lshlrev_b32 v16, 16, v16
    s_lshr_b32 s36, s12, 16
    s_cmp_ge_u32 s36, 0x8000
    s_cselect_b32 s37, 0x8000, -1
    s_xor_b32 s36, s36, s37
    s_lshl_b32 s36, s36, 16
    v_mov_b32 v4, s36
    v_mul_f32 v4, 0xbfb8aa3b, v4
    v_exp_f32 v4, v4
    s_nop 0
    v_add_f32 v4, 1.0, v4
    v_rcp_f32 v4, v4
    s_nop 0
    v_cvt_pk_bf16_f32 v4, v4, v4
    v_lshlrev_b32 v4, 16, v4
    v_cvt_pk_bf16_f32 v18, v18, v18
    v_lshlrev_b32 v18, 16, v18
    v_mul_f32 v18, v18, v4
    v_cvt_pk_bf16_f32 v18, v18, v18
    v_lshlrev_b32 v18, 16, v18
    s_mul_i32 s36, s32, 96
    s_sub_u32 s36, s13, s36
    s_max_i32 s36, s36, 0
    s_lshl_b32 s36, s36, 2
    s_add_u32 s36, s36, 156288
    v_mov_b32 v4, s36
    ds_read2st64_b32 v[4:5], v4 offset0:0 offset1:2
    v_lshlrev_b32 v124, 16, v124
    s_waitcnt lgkmcnt(0)
    v_add_f32 v20, v124, v4
    v_cvt_pk_bf16_f32 v20, v20, v20
    v_lshlrev_b32 v20, 16, v20
    v_mul_f32 v20, v20, v5
    v_cvt_pk_bf16_f32 v20, v20, v20
    v_lshlrev_b32 v20, 16, v20
    v_add_f32 v20, v20, v16
    v_cvt_pk_bf16_f32 v20, v20, v20
    v_lshlrev_b32 v20, 16, v20
    v_mul_f32 v16, 0xbfb8aa3b, v20
    v_exp_f32 v16, v16
    s_nop 0
    v_add_f32 v16, 1.0, v16
    v_rcp_f32 v16, v16
    s_nop 0
    v_mul_f32 v16, v16, v20
    v_cvt_pk_bf16_f32 v16, v16, v16
    v_lshlrev_b32 v16, 16, v16
    s_mul_i32 s36, s32, 96
    s_sub_u32 s36, s14, s36
    s_max_i32 s36, s36, 0
    s_lshl_b32 s36, s36, 2
    s_add_u32 s36, s36, 156288
    v_mov_b32 v4, s36
    ds_read2st64_b32 v[4:5], v4 offset0:0 offset1:2
    v_lshlrev_b32 v125, 16, v125
    s_waitcnt lgkmcnt(0)
    v_add_f32 v22, v125, v4
    v_cvt_pk_bf16_f32 v22, v22, v22
    v_lshlrev_b32 v22, 16, v22
    v_mul_f32 v22, v22, v5
    v_cvt_pk_bf16_f32 v22, v22, v22
    v_lshlrev_b32 v22, 16, v22
    v_add_f32 v22, v22, v18
    v_cvt_pk_bf16_f32 v22, v22, v22
    v_lshlrev_b32 v22, 16, v22
    v_mul_f32 v18, 0xbfb8aa3b, v22
    v_exp_f32 v18, v18
    s_nop 0
    v_add_f32 v18, 1.0, v18
    v_rcp_f32 v18, v18
    s_nop 0
    v_mul_f32 v18, v18, v22
    v_cvt_pk_bf16_f32 v18, v18, v18
    v_lshlrev_b32 v18, 16, v18
    v_add_u32 v5, 158208, v12
    ds_write2st64_b32 v5, v16, v18 offset0:0 offset1:1
    v_mov_b32 v6, 157956
    v_mov_b32 v7, 1
    s_mov_b64 exec, 1
    ds_add_u32 v6, v7
    s_mov_b64 exec, -1
Lw0_done:
    s_endpgm
Lagent:
    s_sub_u32 s44, s4, 4096
    s_subb_u32 s45, s5, 0
    s_mov_b32 s46, 2625536
    s_mov_b32 s47, 0x20000
    s_lshl_b32 s36, s32, 7
    s_add_u32 s36, s36, 8257536
    v_mov_b32 v69, s36
    s_branch Lbc_re
Lcomp:
    s_lshl_b32 s44, s26, 1
    s_add_u32 s44, s44, s27
    s_sub_u32 s36, s33, 5
    s_cmp_ge_u32 s33, 5
    s_cselect_b32 s40, s36, s33
    s_mov_b32 s41, 0xbfe10856
    s_cmp_eq_u32 s40, 1
    s_cselect_b32 s41, 0xaff80255, s41
    s_cmp_eq_u32 s40, 2
    s_cselect_b32 s41, 0xabfe4015, s41
    s_cmp_eq_u32 s40, 3
    s_cselect_b32 s41, 0xaa7fd005, s41
    s_cmp_eq_u32 s40, 4
    s_cselect_b32 s41, 0x6adfb401, s41
    s_lshl_b32 s37, s27, 13
    s_cmp_eq_u32 s44, 1
    s_cselect_b32 s37, 0, s37
    v_bfe_u32 v7, v1, 2, 2
    v_and_b32 v8, 3, v1
    v_lshl_add_u32 v18, v2, 3, v7
    v_lshlrev_b32 v18, 7, v18
    v_lshlrev_b32 v19, 2, v1
    v_and_b32 v19, 0x60, v19
    v_lshlrev_b32 v10, 1, v8
    v_add_u32 v9, s37, v18
    v_add_u32 v11, 0, v10
    v_bfe_u32 v11, s41, v11, 2
    v_lshl_add_u32 v11, v11, 2, v8
    v_lshlrev_b32 v11, 3, v11
    v_xad_u32 v20, v11, v19, v9
    v_add_u32 v11, 8, v10
    v_bfe_u32 v11, s41, v11, 2
    v_lshl_add_u32 v11, v11, 2, v8
    v_lshlrev_b32 v11, 3, v11
    v_xad_u32 v21, v11, v19, v9
    v_add_u32 v11, 16, v10
    v_bfe_u32 v11, s41, v11, 2
    v_lshl_add_u32 v11, v11, 2, v8
    v_lshlrev_b32 v11, 3, v11
    v_xad_u32 v22, v11, v19, v9
    v_add_u32 v11, 24, v10
    v_bfe_u32 v11, s41, v11, 2
    v_lshl_add_u32 v11, v11, 2, v8
    v_lshlrev_b32 v11, 3, v11
    v_xad_u32 v23, v11, v19, v9
    v_add_u32 v24, 78080, v20
    v_add_u32 v25, 78080, v21
    v_add_u32 v26, 78080, v22
    v_add_u32 v27, 78080, v23
    v_lshrrev_b32 v10, 1, v3
    v_xor_b32 v9, v10, v2
    v_lshlrev_b32 v9, 4, v9
    v_lshl_add_u32 v9, v3, 7, v9
    s_lshl_b32 s36, s44, 11
    s_xor_b32 s38, s36, 2048
    s_add_u32 s36, s36, 22528
    s_add_u32 s38, s38, 22528
    v_add_u32 v76, s36, v9
    v_add_u32 v78, s38, v9
    s_mul_i32 s39, s26, 6144
    s_add_u32 s39, s39, 98560
    v_add_u32 v125, s39, v13
    s_lshl_b32 s45, s44, 11
    s_add_u32 s45, s45, 139648
    s_waitcnt lgkmcnt(0)
    s_mov_b64 s[28:29], s[24:25]
    s_mov_b32 s30, 268435456
    s_mov_b32 s31, 0x20000
    s_load_dword s34, s[28:29], 0
    s_cmp_eq_u32 s44, 1
    s_cbranch_scc1 Lhalo
    v_xor_b32 v77, 64, v76
    v_xor_b32 v79, 64, v78
    v_add_u32 v80, 78080, v76
    v_add_u32 v81, 78080, v77
    v_add_u32 v82, 78080, v78
    v_add_u32 v83, 78080, v79
    s_cmp_eq_u32 s27, 0
    s_cselect_b64 vcc, 0, -1
    s_sub_u32 s37, 16384, s37
    v_cndmask_b32 v84, v20, v22, vcc
    v_cndmask_b32 v85, v21, v23, vcc
    v_add_u32 v84, s37, v84
    v_add_u32 v85, s37, v85
    v_add_u32 v86, 78080, v84
    v_add_u32 v87, 78080, v85
    v_lshrrev_b32 v8, 1, v2
    v_xor_b32 v8, v8, v10
    v_lshlrev_b32 v8, 4, v8
    v_lshl_add_u32 v8, v3, 7, v8
    v_and_b32 v7, 1, v2
    v_lshl_add_u32 v124, v7, 3, v8
    s_lshl_b32 s46, s42, 12
    s_mov_b32 s38, 0x87652310
    s_mov_b32 s39, 0x94
    s_cmp_eq_u32 s42, 1
    s_cselect_b32 s38, 0x87625310, s38
    s_cselect_b32 s39, 0x49, s39
    s_cmp_eq_u32 s42, 2
    s_cselect_b32 s38, 0x73654102, s38
    s_cselect_b32 s39, 0x98, s39
    s_cmp_eq_u32 s42, 3
    s_cselect_b32 s38, 0x76254301, s38
    s_cselect_b32 s39, 0x98, s39
    s_cmp_eq_u32 s42, 4
    s_cselect_b32 s38, 0x37546021, s38
    s_cselect_b32 s39, 0x98, s39
    s_sub_u32 s42, s33, s43
    s_cselect_b32 s43, 10, 0
    s_add_u32 s42, s42, s43
    s_lshl_b32 s42, s42, 2
    s_lshr_b64 s[38:39], s[38:39], s42
    s_and_b32 s42, s38, 15
    s_and_b32 s38, s42, 3
    s_mul_i32 s38, s38, 39040
    s_add_u32 s38, s38, s36
    v_add_u32 v4, s38, v124
    v_xor_b32 v5, 32, v4
    v_xor_b32 v6, 64, v4
    v_xor_b32 v7, 0x60, v4
    s_mov_b64 s[48:49], s[20:21]
    s_mov_b32 s50, 2621440
    s_mov_b32 s51, 0x20000
    v_mov_b32 v14, 0x3f803f80
    v_mov_b32 v15, 0x3f803f80
    v_mov_b32 v16, 0x3f803f80
    v_mov_b32 v17, 0x3f803f80
    s_mov_b32 s4, 0xaae00455
    s_cmp_eq_u32 s40, 1
    s_cselect_b32 s4, 0xaaf80155, s4
    s_cmp_eq_u32 s40, 2
    s_cselect_b32 s4, 0xaafe4055, s4
    s_cmp_eq_u32 s40, 3
    s_cselect_b32 s4, 0xaabfd055, s4
    s_cmp_eq_u32 s40, 4
    s_cselect_b32 s4, 0xaaeff455, s4
    v_lshlrev_b32 v10, 1, v2
    v_add_u32 v10, 8, v10
    v_bfe_u32 v10, s4, v10, 2
    v_cmp_eq_u32 s[6:7], 0, v10
    v_cmp_eq_u32 s[8:9], 3, v10
    v_cmp_eq_u32 s[10:11], 1, v10
    v_lshlrev_b32 v10, 1, v2
    v_add_u32 v10, 16, v10
    v_bfe_u32 v10, s4, v10, 2
    v_cmp_eq_u32 s[12:13], 0, v10
    v_cmp_eq_u32 s[14:15], 3, v10
    v_cmp_eq_u32 s[16:17], 2, v10
    s_mov_b32 s4, 0xaaaaaaaa
    s_mov_b32 s5, 0xaaaaaaaa
    s_mov_b32 s18, 0xfff0ffff
    s_mov_b32 s19, 0xf000ff00
    s_mov_b32 s20, 0xffc0fffc
    s_mov_b32 s21, 0xc000fc00
    v_mov_b32 v8, 0xffff
    v_not_b32 v9, v8
    v_cndmask_b32 v8, v8, v9, s[4:5]
    v_cndmask_b32 v118, 0, v8, s[18:19]
    v_cndmask_b32 v119, 0, v8, s[20:21]
    v_xor_b32 v116, v118, v8
    v_xor_b32 v117, v119, v8
    s_cmp_eq_u32 s32, 0
    s_cselect_b32 s36, s44, 0
    s_cmp_eq_u32 s36, 2
    s_cselect_b32 s22, 0xff800000, 0
    s_mul_i32 s36, s32, 6
    s_add_u32 s36, s36, s44
    s_sub_u32 s36, s36, 2
    s_lshl_b32 s24, s36, 7
    s_add_u32 s24, s24, 7340032
    s_mul_i32 s52, s36, 20480
    s_add_u32 s52, s52, 4194304
    s_lshl_b32 s36, s33, 11
    s_add_u32 s23, s36, s52
    s_add_u32 s53, s52, s46
    s_add_u32 s46, s46, 4096
    s_cmp_eq_u32 s46, 20480
    s_cselect_b32 s46, 0, s46
    s_add_u32 s54, s52, s46
    s_add_u32 s46, s46, 4096
    s_cmp_eq_u32 s46, 20480
    s_cselect_b32 s46, 0, s46
    s_add_u32 s55, s52, s46
    s_add_u32 s46, s46, 4096
    s_cmp_eq_u32 s46, 20480
    s_cselect_b32 s46, 0, s46
    s_add_u32 s56, s52, s46
    s_add_u32 s46, s46, 4096
    s_cmp_eq_u32 s46, 20480
    s_cselect_b32 s46, 0, s46
    s_add_u32 s57, s52, s46
    s_add_u32 s46, s46, 4096
    s_cmp_eq_u32 s46, 20480
    s_cselect_b32 s46, 0, s46
    s_mul_i32 s36, s32, 10
    s_add_u32 s36, s36, s33
    s_mul_i32 s58, s36, 6144
    s_lshl_b32 s36, s44, 10
    s_add_u32 s58, s58, s36
    s_add_u32 s58, s58, 1046528
    s_sub_u32 s59, s58, 6144
    s_add_u32 s60, s58, 6144
    s_cmp_eq_u32 s40, 0
    s_cselect_b32 s61, 0, -1
    s_cmp_eq_u32 s40, 4
    s_cselect_b32 s62, 0, -1
    s_lshl_b32 s36, s33, 2
    v_mov_b32 v97, s36
    s_mov_b32 s25, 0x3ea52b5c
    s_lshl_b32 s36, s44, 6
    s_add_u32 s36, s36, 156160
    v_lshl_add_u32 v94, v3, 2, s36
    v_and_b32 v8, 1, v1
    v_lshl_add_u32 v8, v2, 2, v8
    v_lshl_add_u32 v8, v8, 2, s36
    v_subrev_u32 v9, 64, v8
    v_cndmask_b32 v92, v9, v8, s[18:19]
    v_cndmask_b32 v93, v9, v8, s[20:21]
    v_lshlrev_b32 v95, 4, v2
    s_lshl_b32 s36, s27, 8
    s_add_u32 s36, s36, 157184
    v_add_u32 v95, s36, v95
    v_mov_b32 v96, 157968
    v_mov_b32 v100, -1
    v_mov_b32 v101, -1
    v_mov_b32 v102, -1
    v_mov_b32 v103, -1
    v_mov_b32 v127, 157984
    s_lshl_b32 s36, s3, 2
    s_add_u32 s36, s36, 158016
    v_mov_b32 v10, s36
    v_xor_b32 v11, 16, v10
    v_cndmask_b32 v127, v127, v11, s[4:5]
    s_waitcnt vmcnt(0)
    s_waitcnt lgkmcnt(0)
    s_barrier
    ds_read_b128 a[64:67], v76 offset:0
    ds_read_b128 a[68:71], v78 offset:0
    ds_read_b64_tr_b16 a[80:81], v20 offset:0
    ds_read_b64_tr_b16 a[82:83], v20 offset:512
    ds_read_b64_tr_b16 a[84:85], v21 offset:0
    ds_read_b64_tr_b16 a[86:87], v21 offset:512
    ds_read_b64_tr_b16 a[88:89], v22 offset:0
    ds_read_b64_tr_b16 a[90:91], v22 offset:512
    ds_read_b64_tr_b16 a[92:93], v23 offset:0
    ds_read_b64_tr_b16 a[94:95], v23 offset:512
    ds_read_b64_tr_b16 a[96:97], v84 offset:0
    ds_read_b64_tr_b16 a[98:99], v84 offset:512
    ds_read_b64_tr_b16 a[100:101], v85 offset:0
    ds_read_b64_tr_b16 a[102:103], v85 offset:512
    s_add_u32 s34, s34, 0x9e3779b8
    s_or_b32 s34, s34, 1
    s_cmp_eq_u32 s42, 0
    s_cbranch_scc1 Lxe0
Lxe0_b:
    s_setprio 1
    s_waitcnt lgkmcnt(10)
    v_mfma_f32_16x16x32_bf16 v[28:31], a[80:83], a[64:67], 0
    ds_read_b128 a[72:75], v77 offset:0
    ds_read_b128 a[76:79], v79 offset:0
    v_mfma_f32_16x16x32_bf16 v[44:47], a[80:83], a[68:71], 0
    ds_read_b64_tr_b16 a[104:105], v20 offset:4096
    s_waitcnt lgkmcnt(11)
    v_mfma_f32_16x16x32_bf16 v[48:51], a[84:87], a[68:71], 0
    ds_read_b64_tr_b16 a[106:107], v20 offset:4608
    v_mfma_f32_16x16x32_bf16 v[32:35], a[84:87], a[64:67], 0
    ds_read_b64_tr_b16 a[108:109], v21 offset:4096
    s_waitcnt lgkmcnt(11)
    v_mfma_f32_16x16x32_bf16 v[36:39], a[88:91], a[64:67], 0
    ds_read_b64_tr_b16 a[110:111], v21 offset:4608
    ds_read_b64_tr_b16 a[112:113], v22 offset:4096
    v_mfma_f32_16x16x32_bf16 v[52:55], a[88:91], a[68:71], 0
    ds_read_b64_tr_b16 a[114:115], v22 offset:4608
    s_setprio 0
    s_waitcnt lgkmcnt(12)
    v_mfma_f32_16x16x32_bf16 v[56:59], a[92:95], a[68:71], 0
    ds_read_b64_tr_b16 a[116:117], v23 offset:4096
    v_mfma_f32_16x16x32_bf16 v[40:43], a[92:95], a[64:67], 0
    ds_read_b64_tr_b16 a[118:119], v23 offset:4608
    s_waitcnt lgkmcnt(12)
    v_mfma_f32_16x16x32_bf16 v[60:63], a[64:67], a[96:99], 0
    ds_read_b64_tr_b16 a[120:121], v84 offset:4096
    v_mfma_f32_16x16x32_bf16 v[68:71], a[68:71], a[96:99], 0
    ds_read_b64_tr_b16 a[122:123], v84 offset:4608
    s_waitcnt lgkmcnt(12)
    v_mfma_f32_16x16x32_bf16 v[72:75], a[68:71], a[100:103], 0
    ds_read_b64_tr_b16 a[124:125], v85 offset:4096
    v_mfma_f32_16x16x32_bf16 v[64:67], a[64:67], a[100:103], 0
    ds_read_b64_tr_b16 a[126:127], v85 offset:4608
    s_barrier
    s_setprio 3
    s_waitcnt lgkmcnt(10)
    v_mfma_f32_16x16x32_bf16 v[28:31], a[104:107], a[72:75], v[28:31]
    ds_read_b128 a[64:67], v76 offset:39040
    ds_read_b128 a[68:71], v78 offset:39040
    v_mfma_f32_16x16x32_bf16 v[44:47], a[104:107], a[76:79], v[44:47]
    ds_read_b64_tr_b16 a[80:81], v20 offset:39040
    s_waitcnt lgkmcnt(11)
    v_mfma_f32_16x16x32_bf16 v[48:51], a[108:111], a[76:79], v[48:51]
    ds_read_b64_tr_b16 a[82:83], v20 offset:39552
    v_mfma_f32_16x16x32_bf16 v[32:35], a[108:111], a[72:75], v[32:35]
    ds_read_b64_tr_b16 a[84:85], v21 offset:39040
    s_waitcnt lgkmcnt(11)
    v_mfma_f32_16x16x32_bf16 v[36:39], a[112:115], a[72:75], v[36:39]
    ds_read_b64_tr_b16 a[86:87], v21 offset:39552
    v_mfma_f32_16x16x32_bf16 v[52:55], a[112:115], a[76:79], v[52:55]
    ds_read_b64_tr_b16 a[88:89], v22 offset:39040
    s_setprio 2
    s_waitcnt lgkmcnt(11)
    v_mfma_f32_16x16x32_bf16 v[56:59], a[116:119], a[76:79], v[56:59]
    ds_read_b64_tr_b16 a[90:91], v22 offset:39552
    ds_read_b64_tr_b16 a[92:93], v23 offset:39040
    v_mfma_f32_16x16x32_bf16 v[40:43], a[116:119], a[72:75], v[40:43]
    ds_read_b64_tr_b16 a[94:95], v23 offset:39552
    s_waitcnt lgkmcnt(12)
    v_mfma_f32_16x16x32_bf16 v[60:63], a[72:75], a[120:123], v[60:63]
    ds_read_b64_tr_b16 a[96:97], v84 offset:39040
    v_mfma_f32_16x16x32_bf16 v[68:71], a[76:79], a[120:123], v[68:71]
    ds_read_b64_tr_b16 a[98:99], v84 offset:39552
    s_waitcnt lgkmcnt(12)
    v_mfma_f32_16x16x32_bf16 v[72:75], a[76:79], a[124:127], v[72:75]
    ds_read_b64_tr_b16 a[100:101], v85 offset:39040
    v_mfma_f32_16x16x32_bf16 v[64:67], a[72:75], a[124:127], v[64:67]
    ds_read_b64_tr_b16 a[102:103], v85 offset:39552
    s_cmp_eq_u32 s42, 1
    s_cbranch_scc1 Lxe1
Lxe1_b:
    s_setprio 1
    s_waitcnt lgkmcnt(10)
    v_mfma_f32_16x16x32_bf16 v[28:31], a[80:83], a[64:67], v[28:31]
    ds_read_b128 a[72:75], v77 offset:39040
    ds_read_b128 a[76:79], v79 offset:39040
    v_mfma_f32_16x16x32_bf16 v[44:47], a[80:83], a[68:71], v[44:47]
    ds_read_b64_tr_b16 a[104:105], v20 offset:43136
    s_waitcnt lgkmcnt(11)
    v_mfma_f32_16x16x32_bf16 v[48:51], a[84:87], a[68:71], v[48:51]
    ds_read_b64_tr_b16 a[106:107], v20 offset:43648
    v_mfma_f32_16x16x32_bf16 v[32:35], a[84:87], a[64:67], v[32:35]
    ds_read_b64_tr_b16 a[108:109], v21 offset:43136
    s_waitcnt lgkmcnt(11)
    v_mfma_f32_16x16x32_bf16 v[36:39], a[88:91], a[64:67], v[36:39]
    ds_read_b64_tr_b16 a[110:111], v21 offset:43648
    ds_read_b64_tr_b16 a[112:113], v22 offset:43136
    v_mfma_f32_16x16x32_bf16 v[52:55], a[88:91], a[68:71], v[52:55]
    ds_read_b64_tr_b16 a[114:115], v22 offset:43648
    s_setprio 0
    s_waitcnt lgkmcnt(12)
    v_mfma_f32_16x16x32_bf16 v[56:59], a[92:95], a[68:71], v[56:59]
    ds_read_b64_tr_b16 a[116:117], v23 offset:43136
    v_mfma_f32_16x16x32_bf16 v[40:43], a[92:95], a[64:67], v[40:43]
    ds_read_b64_tr_b16 a[118:119], v23 offset:43648
    s_waitcnt lgkmcnt(12)
    v_mfma_f32_16x16x32_bf16 v[60:63], a[64:67], a[96:99], v[60:63]
    ds_read_b64_tr_b16 a[120:121], v84 offset:43136
    v_mfma_f32_16x16x32_bf16 v[68:71], a[68:71], a[96:99], v[68:71]
    ds_read_b64_tr_b16 a[122:123], v84 offset:43648
    s_waitcnt lgkmcnt(12)
    v_mfma_f32_16x16x32_bf16 v[72:75], a[68:71], a[100:103], v[72:75]
    ds_read_b64_tr_b16 a[124:125], v85 offset:43136
    v_mfma_f32_16x16x32_bf16 v[64:67], a[64:67], a[100:103], v[64:67]
    ds_read_b64_tr_b16 a[126:127], v85 offset:43648
    s_barrier
    s_setprio 3
    s_waitcnt lgkmcnt(10)
    v_mfma_f32_16x16x32_bf16 v[28:31], a[104:107], a[72:75], v[28:31]
    ds_read_b128 a[64:67], v80 offset:0
    ds_read_b128 a[68:71], v82 offset:0
    v_mfma_f32_16x16x32_bf16 v[44:47], a[104:107], a[76:79], v[44:47]
    ds_read_b64_tr_b16 a[80:81], v24 offset:0
    s_waitcnt lgkmcnt(11)
    v_mfma_f32_16x16x32_bf16 v[48:51], a[108:111], a[76:79], v[48:51]
    ds_read_b64_tr_b16 a[82:83], v24 offset:512
    v_mfma_f32_16x16x32_bf16 v[32:35], a[108:111], a[72:75], v[32:35]
    ds_read_b64_tr_b16 a[84:85], v25 offset:0
    s_waitcnt lgkmcnt(11)
    v_mfma_f32_16x16x32_bf16 v[36:39], a[112:115], a[72:75], v[36:39]
    ds_read_b64_tr_b16 a[86:87], v25 offset:512
    v_mfma_f32_16x16x32_bf16 v[52:55], a[112:115], a[76:79], v[52:55]
    ds_read_b64_tr_b16 a[88:89], v26 offset:0
    s_setprio 2
    s_waitcnt lgkmcnt(11)
    v_mfma_f32_16x16x32_bf16 v[56:59], a[116:119], a[76:79], v[56:59]
    ds_read_b64_tr_b16 a[90:91], v26 offset:512
    ds_read_b64_tr_b16 a[92:93], v27 offset:0
    v_mfma_f32_16x16x32_bf16 v[40:43], a[116:119], a[72:75], v[40:43]
    ds_read_b64_tr_b16 a[94:95], v27 offset:512
    s_waitcnt lgkmcnt(12)
    v_mfma_f32_16x16x32_bf16 v[60:63], a[72:75], a[120:123], v[60:63]
    ds_read_b64_tr_b16 a[96:97], v86 offset:0
    v_mfma_f32_16x16x32_bf16 v[68:71], a[76:79], a[120:123], v[68:71]
    ds_read_b64_tr_b16 a[98:99], v86 offset:512
    s_waitcnt lgkmcnt(12)
    v_mfma_f32_16x16x32_bf16 v[72:75], a[76:79], a[124:127], v[72:75]
    ds_read_b64_tr_b16 a[100:101], v87 offset:0
    v_mfma_f32_16x16x32_bf16 v[64:67], a[72:75], a[124:127], v[64:67]
    ds_read_b64_tr_b16 a[102:103], v87 offset:512
    buffer_store_dwordx4 v[100:103], v13, s[28:31], s58 offen sc1
    s_cmp_eq_u32 s42, 2
    s_cbranch_scc1 Lxe2
Lxe2_b:
    s_setprio 1
    s_waitcnt lgkmcnt(10)
    v_mfma_f32_16x16x32_bf16 v[28:31], a[80:83], a[64:67], v[28:31]
    ds_read_b128 a[72:75], v81 offset:0
    ds_read_b128 a[76:79], v83 offset:0
    v_mfma_f32_16x16x32_bf16 v[44:47], a[80:83], a[68:71], v[44:47]
    ds_read_b64_tr_b16 a[104:105], v24 offset:4096
    s_waitcnt lgkmcnt(11)
    v_mfma_f32_16x16x32_bf16 v[48:51], a[84:87], a[68:71], v[48:51]
    ds_read_b64_tr_b16 a[106:107], v24 offset:4608
    v_mfma_f32_16x16x32_bf16 v[32:35], a[84:87], a[64:67], v[32:35]
    ds_read_b64_tr_b16 a[108:109], v25 offset:4096
    s_waitcnt lgkmcnt(11)
    v_mfma_f32_16x16x32_bf16 v[36:39], a[88:91], a[64:67], v[36:39]
    ds_read_b64_tr_b16 a[110:111], v25 offset:4608
    ds_read_b64_tr_b16 a[112:113], v26 offset:4096
    v_mfma_f32_16x16x32_bf16 v[52:55], a[88:91], a[68:71], v[52:55]
    ds_read_b64_tr_b16 a[114:115], v26 offset:4608
    s_setprio 0
    s_waitcnt lgkmcnt(12)
    v_mfma_f32_16x16x32_bf16 v[56:59], a[92:95], a[68:71], v[56:59]
    ds_read_b64_tr_b16 a[116:117], v27 offset:4096
    v_mfma_f32_16x16x32_bf16 v[40:43], a[92:95], a[64:67], v[40:43]
    ds_read_b64_tr_b16 a[118:119], v27 offset:4608
    s_waitcnt lgkmcnt(12)
    v_mfma_f32_16x16x32_bf16 v[60:63], a[64:67], a[96:99], v[60:63]
    ds_read_b64_tr_b16 a[120:121], v86 offset:4096
    v_mfma_f32_16x16x32_bf16 v[68:71], a[68:71], a[96:99], v[68:71]
    ds_read_b64_tr_b16 a[122:123], v86 offset:4608
    s_waitcnt lgkmcnt(12)
    v_mfma_f32_16x16x32_bf16 v[72:75], a[68:71], a[100:103], v[72:75]
    ds_read_b64_tr_b16 a[124:125], v87 offset:4096
    v_mfma_f32_16x16x32_bf16 v[64:67], a[64:67], a[100:103], v[64:67]
    ds_read_b64_tr_b16 a[126:127], v87 offset:4608
    s_barrier
    s_setprio 3
    s_waitcnt lgkmcnt(10)
    v_mfma_f32_16x16x32_bf16 v[28:31], a[104:107], a[72:75], v[28:31]
    ds_read_b128 a[64:67], v80 offset:39040
    ds_read_b128 a[68:71], v82 offset:39040
    v_mfma_f32_16x16x32_bf16 v[44:47], a[104:107], a[76:79], v[44:47]
    ds_read_b64_tr_b16 a[80:81], v24 offset:39040
    s_waitcnt lgkmcnt(11)
    v_mfma_f32_16x16x32_bf16 v[48:51], a[108:111], a[76:79], v[48:51]
    ds_read_b64_tr_b16 a[82:83], v24 offset:39552
    v_mfma_f32_16x16x32_bf16 v[32:35], a[108:111], a[72:75], v[32:35]
    ds_read_b64_tr_b16 a[84:85], v25 offset:39040
    s_waitcnt lgkmcnt(11)
    v_mfma_f32_16x16x32_bf16 v[36:39], a[112:115], a[72:75], v[36:39]
    ds_read_b64_tr_b16 a[86:87], v25 offset:39552
    v_mfma_f32_16x16x32_bf16 v[52:55], a[112:115], a[76:79], v[52:55]
    ds_read_b64_tr_b16 a[88:89], v26 offset:39040
    s_setprio 2
    s_waitcnt lgkmcnt(11)
    v_mfma_f32_16x16x32_bf16 v[56:59], a[116:119], a[76:79], v[56:59]
    ds_read_b64_tr_b16 a[90:91], v26 offset:39552
    ds_read_b64_tr_b16 a[92:93], v27 offset:39040
    v_mfma_f32_16x16x32_bf16 v[40:43], a[116:119], a[72:75], v[40:43]
    ds_read_b64_tr_b16 a[94:95], v27 offset:39552
    s_waitcnt lgkmcnt(12)
    v_mfma_f32_16x16x32_bf16 v[60:63], a[72:75], a[120:123], v[60:63]
    ds_read_b64_tr_b16 a[96:97], v86 offset:39040
    v_mfma_f32_16x16x32_bf16 v[68:71], a[76:79], a[120:123], v[68:71]
    ds_read_b64_tr_b16 a[98:99], v86 offset:39552
    s_waitcnt lgkmcnt(12)
    v_mfma_f32_16x16x32_bf16 v[72:75], a[76:79], a[124:127], v[72:75]
    ds_read_b64_tr_b16 a[100:101], v87 offset:39040
    v_mfma_f32_16x16x32_bf16 v[64:67], a[72:75], a[124:127], v[64:67]
    ds_read_b64_tr_b16 a[102:103], v87 offset:39552
    s_cmp_eq_u32 s42, 3
    s_cbranch_scc1 Lxe3
Lxe3_b:
    s_setprio 1
    s_waitcnt lgkmcnt(10)
    v_mfma_f32_16x16x32_bf16 v[28:31], a[80:83], a[64:67], v[28:31]
    ds_read_b128 a[72:75], v81 offset:39040
    ds_read_b128 a[76:79], v83 offset:39040
    v_mfma_f32_16x16x32_bf16 v[44:47], a[80:83], a[68:71], v[44:47]
    ds_read_b64_tr_b16 a[104:105], v24 offset:43136
    s_waitcnt lgkmcnt(11)
    v_mfma_f32_16x16x32_bf16 v[48:51], a[84:87], a[68:71], v[48:51]
    ds_read_b64_tr_b16 a[106:107], v24 offset:43648
    v_mfma_f32_16x16x32_bf16 v[32:35], a[84:87], a[64:67], v[32:35]
    ds_read_b64_tr_b16 a[108:109], v25 offset:43136
    s_waitcnt lgkmcnt(11)
    v_mfma_f32_16x16x32_bf16 v[36:39], a[88:91], a[64:67], v[36:39]
    ds_read_b64_tr_b16 a[110:111], v25 offset:43648
    ds_read_b64_tr_b16 a[112:113], v26 offset:43136
    v_mfma_f32_16x16x32_bf16 v[52:55], a[88:91], a[68:71], v[52:55]
    ds_read_b64_tr_b16 a[114:115], v26 offset:43648
    s_setprio 0
    s_waitcnt lgkmcnt(12)
    v_mfma_f32_16x16x32_bf16 v[56:59], a[92:95], a[68:71], v[56:59]
    ds_read_b64_tr_b16 a[116:117], v27 offset:43136
    v_mfma_f32_16x16x32_bf16 v[40:43], a[92:95], a[64:67], v[40:43]
    ds_read_b64_tr_b16 a[118:119], v27 offset:43648
    s_waitcnt lgkmcnt(12)
    v_mfma_f32_16x16x32_bf16 v[60:63], a[64:67], a[96:99], v[60:63]
    ds_read_b64_tr_b16 a[120:121], v86 offset:43136
    v_mfma_f32_16x16x32_bf16 v[68:71], a[68:71], a[96:99], v[68:71]
    ds_read_b64_tr_b16 a[122:123], v86 offset:43648
    s_waitcnt lgkmcnt(12)
    v_mfma_f32_16x16x32_bf16 v[72:75], a[68:71], a[100:103], v[72:75]
    ds_read_b64_tr_b16 a[124:125], v87 offset:43136
    v_mfma_f32_16x16x32_bf16 v[64:67], a[64:67], a[100:103], v[64:67]
    ds_read_b64_tr_b16 a[126:127], v87 offset:43648
    s_barrier
    s_setprio 3
    s_waitcnt lgkmcnt(10)
    v_mfma_f32_16x16x32_bf16 v[28:31], a[104:107], a[72:75], v[28:31]
    ds_read_b128 a[64:67], v76 offset:0
    ds_read_b128 a[68:71], v78 offset:0
    v_mfma_f32_16x16x32_bf16 v[44:47], a[104:107], a[76:79], v[44:47]
    ds_read_b64_tr_b16 a[80:81], v20 offset:0
    s_waitcnt lgkmcnt(11)
    v_mfma_f32_16x16x32_bf16 v[48:51], a[108:111], a[76:79], v[48:51]
    ds_read_b64_tr_b16 a[82:83], v20 offset:512
    v_mfma_f32_16x16x32_bf16 v[32:35], a[108:111], a[72:75], v[32:35]
    ds_read_b64_tr_b16 a[84:85], v21 offset:0
    s_waitcnt lgkmcnt(11)
    v_mfma_f32_16x16x32_bf16 v[36:39], a[112:115], a[72:75], v[36:39]
    ds_read_b64_tr_b16 a[86:87], v21 offset:512
    v_mfma_f32_16x16x32_bf16 v[52:55], a[112:115], a[76:79], v[52:55]
    ds_read_b64_tr_b16 a[88:89], v22 offset:0
    s_setprio 2
    s_waitcnt lgkmcnt(11)
    v_mfma_f32_16x16x32_bf16 v[56:59], a[116:119], a[76:79], v[56:59]
    ds_read_b64_tr_b16 a[90:91], v22 offset:512
    ds_read_b64_tr_b16 a[92:93], v23 offset:0
    v_mfma_f32_16x16x32_bf16 v[40:43], a[116:119], a[72:75], v[40:43]
    ds_read_b64_tr_b16 a[94:95], v23 offset:512
    s_waitcnt lgkmcnt(12)
    v_mfma_f32_16x16x32_bf16 v[60:63], a[72:75], a[120:123], v[60:63]
    ds_read_b64_tr_b16 a[96:97], v84 offset:0
    v_mfma_f32_16x16x32_bf16 v[68:71], a[76:79], a[120:123], v[68:71]
    ds_read_b64_tr_b16 a[98:99], v84 offset:512
    s_waitcnt lgkmcnt(12)
    v_mfma_f32_16x16x32_bf16 v[72:75], a[76:79], a[124:127], v[72:75]
    ds_read_b64_tr_b16 a[100:101], v85 offset:0
    v_mfma_f32_16x16x32_bf16 v[64:67], a[72:75], a[124:127], v[64:67]
    ds_read_b64_tr_b16 a[102:103], v85 offset:512
    buffer_store_dwordx4 v[100:103], v13, s[28:31], s23 offen offset:0 sc1
    s_cmp_eq_u32 s42, 4
    s_cbranch_scc1 Lxe4
Lxe4_b:
    s_setprio 1
    s_waitcnt lgkmcnt(10)
    v_mfma_f32_16x16x32_bf16 v[28:31], a[80:83], a[64:67], v[28:31]
    ds_read_b128 a[72:75], v77 offset:0
    ds_read_b128 a[76:79], v79 offset:0
    v_mfma_f32_16x16x32_bf16 v[44:47], a[80:83], a[68:71], v[44:47]
    ds_read_b64_tr_b16 a[104:105], v20 offset:4096
    s_waitcnt lgkmcnt(11)
    v_mfma_f32_16x16x32_bf16 v[48:51], a[84:87], a[68:71], v[48:51]
    ds_read_b64_tr_b16 a[106:107], v20 offset:4608
    v_mfma_f32_16x16x32_bf16 v[32:35], a[84:87], a[64:67], v[32:35]
    ds_read_b64_tr_b16 a[108:109], v21 offset:4096
    s_waitcnt lgkmcnt(11)
    v_mfma_f32_16x16x32_bf16 v[36:39], a[88:91], a[64:67], v[36:39]
    ds_read_b64_tr_b16 a[110:111], v21 offset:4608
    ds_read_b64_tr_b16 a[112:113], v22 offset:4096
    v_mfma_f32_16x16x32_bf16 v[52:55], a[88:91], a[68:71], v[52:55]
    ds_read_b64_tr_b16 a[114:115], v22 offset:4608
    s_setprio 0
    s_waitcnt lgkmcnt(12)
    v_mfma_f32_16x16x32_bf16 v[56:59], a[92:95], a[68:71], v[56:59]
    ds_read_b64_tr_b16 a[116:117], v23 offset:4096
    v_mfma_f32_16x16x32_bf16 v[40:43], a[92:95], a[64:67], v[40:43]
    ds_read_b64_tr_b16 a[118:119], v23 offset:4608
    s_waitcnt lgkmcnt(12)
    v_mfma_f32_16x16x32_bf16 v[60:63], a[64:67], a[96:99], v[60:63]
    ds_read_b64_tr_b16 a[120:121], v84 offset:4096
    v_mfma_f32_16x16x32_bf16 v[68:71], a[68:71], a[96:99], v[68:71]
    ds_read_b64_tr_b16 a[122:123], v84 offset:4608
    s_waitcnt lgkmcnt(12)
    v_mfma_f32_16x16x32_bf16 v[72:75], a[68:71], a[100:103], v[72:75]
    ds_read_b64_tr_b16 a[124:125], v85 offset:4096
    v_mfma_f32_16x16x32_bf16 v[64:67], a[64:67], a[100:103], v[64:67]
    ds_read_b64_tr_b16 a[126:127], v85 offset:4608
    s_barrier
    s_setprio 3
    s_waitcnt lgkmcnt(10)
    v_mfma_f32_16x16x32_bf16 v[28:31], a[104:107], a[72:75], v[28:31]
    ds_read_b128 a[64:67], v76 offset:39040
    ds_read_b128 a[68:71], v78 offset:39040
    v_mfma_f32_16x16x32_bf16 v[44:47], a[104:107], a[76:79], v[44:47]
    ds_read_b64_tr_b16 a[80:81], v20 offset:39040
    s_waitcnt lgkmcnt(11)
    v_mfma_f32_16x16x32_bf16 v[48:51], a[108:111], a[76:79], v[48:51]
    ds_read_b64_tr_b16 a[82:83], v20 offset:39552
    v_mfma_f32_16x16x32_bf16 v[32:35], a[108:111], a[72:75], v[32:35]
    ds_read_b64_tr_b16 a[84:85], v21 offset:39040
    s_waitcnt lgkmcnt(11)
    v_mfma_f32_16x16x32_bf16 v[36:39], a[112:115], a[72:75], v[36:39]
    ds_read_b64_tr_b16 a[86:87], v21 offset:39552
    v_mfma_f32_16x16x32_bf16 v[52:55], a[112:115], a[76:79], v[52:55]
    ds_read_b64_tr_b16 a[88:89], v22 offset:39040
    s_setprio 2
    s_waitcnt lgkmcnt(11)
    v_mfma_f32_16x16x32_bf16 v[56:59], a[116:119], a[76:79], v[56:59]
    ds_read_b64_tr_b16 a[90:91], v22 offset:39552
    ds_read_b64_tr_b16 a[92:93], v23 offset:39040
    v_mfma_f32_16x16x32_bf16 v[40:43], a[116:119], a[72:75], v[40:43]
    ds_read_b64_tr_b16 a[94:95], v23 offset:39552
    s_waitcnt lgkmcnt(12)
    v_mfma_f32_16x16x32_bf16 v[60:63], a[72:75], a[120:123], v[60:63]
    ds_read_b64_tr_b16 a[96:97], v84 offset:39040
    v_mfma_f32_16x16x32_bf16 v[68:71], a[76:79], a[120:123], v[68:71]
    ds_read_b64_tr_b16 a[98:99], v84 offset:39552
    s_waitcnt lgkmcnt(12)
    v_mfma_f32_16x16x32_bf16 v[72:75], a[76:79], a[124:127], v[72:75]
    ds_read_b64_tr_b16 a[100:101], v85 offset:39040
    v_mfma_f32_16x16x32_bf16 v[64:67], a[72:75], a[124:127], v[64:67]
    ds_read_b64_tr_b16 a[102:103], v85 offset:39552
    s_cmp_eq_u32 s42, 5
    s_cbranch_scc1 Lxe5
Lxe5_b:
    s_setprio 1
    s_waitcnt lgkmcnt(10)
    v_mfma_f32_16x16x32_bf16 v[28:31], a[80:83], a[64:67], v[28:31]
    ds_read_b128 a[72:75], v77 offset:39040
    ds_read_b128 a[76:79], v79 offset:39040
    v_mfma_f32_16x16x32_bf16 v[44:47], a[80:83], a[68:71], v[44:47]
    ds_read_b64_tr_b16 a[104:105], v20 offset:43136
    s_waitcnt lgkmcnt(11)
    v_mfma_f32_16x16x32_bf16 v[48:51], a[84:87], a[68:71], v[48:51]
    ds_read_b64_tr_b16 a[106:107], v20 offset:43648
    v_mfma_f32_16x16x32_bf16 v[32:35], a[84:87], a[64:67], v[32:35]
    ds_read_b64_tr_b16 a[108:109], v21 offset:43136
    s_waitcnt lgkmcnt(11)
    v_mfma_f32_16x16x32_bf16 v[36:39], a[88:91], a[64:67], v[36:39]
    ds_read_b64_tr_b16 a[110:111], v21 offset:43648
    ds_read_b64_tr_b16 a[112:113], v22 offset:43136
    v_mfma_f32_16x16x32_bf16 v[52:55], a[88:91], a[68:71], v[52:55]
    ds_read_b64_tr_b16 a[114:115], v22 offset:43648
    s_setprio 0
    s_waitcnt lgkmcnt(12)
    v_mfma_f32_16x16x32_bf16 v[56:59], a[92:95], a[68:71], v[56:59]
    ds_read_b64_tr_b16 a[116:117], v23 offset:43136
    v_mfma_f32_16x16x32_bf16 v[40:43], a[92:95], a[64:67], v[40:43]
    ds_read_b64_tr_b16 a[118:119], v23 offset:43648
    s_waitcnt lgkmcnt(12)
    v_mfma_f32_16x16x32_bf16 v[60:63], a[64:67], a[96:99], v[60:63]
    ds_read_b64_tr_b16 a[120:121], v84 offset:43136
    v_mfma_f32_16x16x32_bf16 v[68:71], a[68:71], a[96:99], v[68:71]
    ds_read_b64_tr_b16 a[122:123], v84 offset:43648
    s_waitcnt lgkmcnt(12)
    v_mfma_f32_16x16x32_bf16 v[72:75], a[68:71], a[100:103], v[72:75]
    ds_read_b64_tr_b16 a[124:125], v85 offset:43136
    v_mfma_f32_16x16x32_bf16 v[64:67], a[64:67], a[100:103], v[64:67]
    ds_read_b64_tr_b16 a[126:127], v85 offset:43648
    s_barrier
    s_setprio 3
    s_waitcnt lgkmcnt(10)
    v_mfma_f32_16x16x32_bf16 v[28:31], a[104:107], a[72:75], v[28:31]
    ds_read_b128 a[0:3], v80 offset:0
    v_mfma_f32_16x16x32_bf16 v[44:47], a[104:107], a[76:79], v[44:47]
    ds_read_b128 a[4:7], v82 offset:0
    s_waitcnt lgkmcnt(10)
    v_mfma_f32_16x16x32_bf16 v[48:51], a[108:111], a[76:79], v[48:51]
    ds_read_b64_tr_b16 a[80:81], v24 offset:0
    v_mfma_f32_16x16x32_bf16 v[32:35], a[108:111], a[72:75], v[32:35]
    ds_read_b64_tr_b16 a[82:83], v24 offset:512
    s_waitcnt lgkmcnt(10)
    v_mfma_f32_16x16x32_bf16 v[36:39], a[112:115], a[72:75], v[36:39]
    ds_read_b64_tr_b16 a[84:85], v25 offset:0
    v_mfma_f32_16x16x32_bf16 v[52:55], a[112:115], a[76:79], v[52:55]
    s_setprio 2
    s_waitcnt lgkmcnt(9)
    v_mfma_f32_16x16x32_bf16 v[56:59], a[116:119], a[76:79], v[56:59]
    ds_read_b64_tr_b16 a[86:87], v25 offset:512
    v_mfma_f32_16x16x32_bf16 v[40:43], a[116:119], a[72:75], v[40:43]
    ds_read_b64_tr_b16 a[88:89], v26 offset:0
    s_waitcnt lgkmcnt(9)
    v_mfma_f32_16x16x32_bf16 v[60:63], a[72:75], a[120:123], v[60:63]
    ds_read_b64_tr_b16 a[90:91], v26 offset:512
    v_mfma_f32_16x16x32_bf16 v[68:71], a[76:79], a[120:123], v[68:71]
    ds_read_b64_tr_b16 a[92:93], v27 offset:0
    s_waitcnt lgkmcnt(9)
    v_mfma_f32_16x16x32_bf16 v[72:75], a[76:79], a[124:127], v[72:75]
    ds_read_b64_tr_b16 a[94:95], v27 offset:512
    v_mfma_f32_16x16x32_bf16 v[64:67], a[72:75], a[124:127], v[64:67]
    buffer_store_dwordx4 v[100:103], v13, s[28:31], s23 offen offset:1024 sc1
    s_cmp_eq_u32 s42, 6
    s_cbranch_scc1 Lxe6
Lxe6_b:
    s_setprio 1
    s_waitcnt lgkmcnt(6)
    v_mfma_f32_16x16x32_bf16 v[28:31], a[80:83], a[0:3], v[28:31]
    ds_read_b128 a[8:11], v81 offset:0
    ds_read_b128 a[12:15], v83 offset:0
    v_mfma_f32_16x16x32_bf16 v[44:47], a[80:83], a[4:7], v[44:47]
    ds_read_b64_tr_b16 a[104:105], v24 offset:4096
    s_waitcnt lgkmcnt(7)
    v_mfma_f32_16x16x32_bf16 v[48:51], a[84:87], a[4:7], v[48:51]
    ds_read_b64_tr_b16 a[106:107], v24 offset:4608
    ds_read_b64_tr_b16 a[108:109], v25 offset:4096
    v_mfma_f32_16x16x32_bf16 v[32:35], a[84:87], a[0:3], v[32:35]
    ds_read_b64_tr_b16 a[110:111], v25 offset:4608
    s_setprio 0
    s_waitcnt lgkmcnt(8)
    v_mfma_f32_16x16x32_bf16 v[36:39], a[88:91], a[0:3], v[36:39]
    v_mfma_f32_16x16x32_bf16 v[52:55], a[88:91], a[4:7], v[52:55]
    ds_read_b64_tr_b16 a[112:113], v26 offset:4096
    ds_read_b64_tr_b16 a[114:115], v26 offset:4608
    s_waitcnt lgkmcnt(8)
    v_mfma_f32_16x16x32_bf16 v[56:59], a[92:95], a[4:7], v[56:59]
    ds_read_b64_tr_b16 a[116:117], v27 offset:4096
    v_mfma_f32_16x16x32_bf16 v[40:43], a[92:95], a[0:3], v[40:43]
    ds_read_b64_tr_b16 a[118:119], v27 offset:4608
    s_barrier
    s_setprio 3
    s_waitcnt lgkmcnt(6)
    v_mfma_f32_16x16x32_bf16 v[28:31], a[104:107], a[8:11], v[28:31]
    ds_read_b128 a[16:19], v80 offset:39040
    ds_read_b128 a[20:23], v82 offset:39040
    v_mfma_f32_16x16x32_bf16 v[44:47], a[104:107], a[12:15], v[44:47]
    ds_read_b64_tr_b16 a[80:81], v24 offset:39040
    s_waitcnt lgkmcnt(7)
    v_mfma_f32_16x16x32_bf16 v[48:51], a[108:111], a[12:15], v[48:51]
    ds_read_b64_tr_b16 a[82:83], v24 offset:39552
    v_mfma_f32_16x16x32_bf16 v[32:35], a[108:111], a[8:11], v[32:35]
    ds_read_b64_tr_b16 a[84:85], v25 offset:39040
    s_setprio 2
    s_waitcnt lgkmcnt(7)
    v_mfma_f32_16x16x32_bf16 v[36:39], a[112:115], a[8:11], v[36:39]
    ds_read_b64_tr_b16 a[86:87], v25 offset:39552
    ds_read_b64_tr_b16 a[88:89], v26 offset:39040
    v_mfma_f32_16x16x32_bf16 v[52:55], a[112:115], a[12:15], v[52:55]
    ds_read_b64_tr_b16 a[90:91], v26 offset:39552
    s_waitcnt lgkmcnt(8)
    v_mfma_f32_16x16x32_bf16 v[56:59], a[116:119], a[12:15], v[56:59]
    ds_read_b64_tr_b16 a[92:93], v27 offset:39040
    v_mfma_f32_16x16x32_bf16 v[40:43], a[116:119], a[8:11], v[40:43]
    ds_read_b64_tr_b16 a[94:95], v27 offset:39552
    s_cmp_eq_u32 s42, 7
    s_cbranch_scc1 Lxe7
Lxe7_b:
    s_setprio 1
    s_waitcnt lgkmcnt(6)
    v_mfma_f32_16x16x32_bf16 v[28:31], a[80:83], a[16:19], v[28:31]
    ds_read_b128 a[24:27], v81 offset:39040
    ds_read_b128 a[28:31], v83 offset:39040
    v_mfma_f32_16x16x32_bf16 v[44:47], a[80:83], a[20:23], v[44:47]
    ds_read_b64_tr_b16 a[104:105], v24 offset:43136
    s_waitcnt lgkmcnt(7)
    v_mfma_f32_16x16x32_bf16 v[48:51], a[84:87], a[20:23], v[48:51]
    ds_read_b64_tr_b16 a[106:107], v24 offset:43648
    ds_read_b64_tr_b16 a[108:109], v25 offset:43136
    v_mfma_f32_16x16x32_bf16 v[32:35], a[84:87], a[16:19], v[32:35]
    ds_read_b64_tr_b16 a[110:111], v25 offset:43648
    s_setprio 0
    s_waitcnt lgkmcnt(8)
    v_mfma_f32_16x16x32_bf16 v[36:39], a[88:91], a[16:19], v[36:39]
    v_mfma_f32_16x16x32_bf16 v[52:55], a[88:91], a[20:23], v[52:55]
    ds_read_b64_tr_b16 a[112:113], v26 offset:43136
    ds_read_b64_tr_b16 a[114:115], v26 offset:43648
    s_waitcnt lgkmcnt(8)
    v_mfma_f32_16x16x32_bf16 v[56:59], a[92:95], a[20:23], v[56:59]
    ds_read_b64_tr_b16 a[116:117], v27 offset:43136
    v_mfma_f32_16x16x32_bf16 v[40:43], a[92:95], a[16:19], v[40:43]
    ds_read_b64_tr_b16 a[118:119], v27 offset:43648
    s_barrier
    s_setprio 3
    s_waitcnt lgkmcnt(6)
    v_mfma_f32_16x16x32_bf16 v[28:31], a[104:107], a[24:27], v[28:31]
    ds_read_b128 a[32:35], v76 offset:0
    ds_read_b128 a[36:39], v78 offset:0
    v_mfma_f32_16x16x32_bf16 v[44:47], a[104:107], a[28:31], v[44:47]
    ds_read_b64_tr_b16 a[80:81], v20 offset:0
    s_waitcnt lgkmcnt(7)
    v_mfma_f32_16x16x32_bf16 v[48:51], a[108:111], a[28:31], v[48:51]
    ds_read_b64_tr_b16 a[82:83], v20 offset:512
    v_mfma_f32_16x16x32_bf16 v[32:35], a[108:111], a[24:27], v[32:35]
    ds_read_b64_tr_b16 a[84:85], v21 offset:0
    s_setprio 2
    s_waitcnt lgkmcnt(7)
    v_mfma_f32_16x16x32_bf16 v[36:39], a[112:115], a[24:27], v[36:39]
    ds_read_b64_tr_b16 a[86:87], v21 offset:512
    ds_read_b64_tr_b16 a[88:89], v22 offset:0
    v_mfma_f32_16x16x32_bf16 v[52:55], a[112:115], a[28:31], v[52:55]
    ds_read_b64_tr_b16 a[90:91], v22 offset:512
    s_waitcnt lgkmcnt(8)
    v_mfma_f32_16x16x32_bf16 v[56:59], a[116:119], a[28:31], v[56:59]
    ds_read_b64_tr_b16 a[92:93], v23 offset:0
    v_mfma_f32_16x16x32_bf16 v[40:43], a[116:119], a[24:27], v[40:43]
    ds_read_b64_tr_b16 a[94:95], v23 offset:512
    s_cmp_eq_u32 s42, 8
    s_cbranch_scc1 Lxe8
Lxe8_b:
    s_setprio 1
    s_waitcnt lgkmcnt(6)
    v_mfma_f32_16x16x32_bf16 v[28:31], a[80:83], a[32:35], v[28:31]
    ds_read_b128 a[40:43], v77 offset:0
    ds_read_b128 a[44:47], v79 offset:0
    v_mfma_f32_16x16x32_bf16 v[44:47], a[80:83], a[36:39], v[44:47]
    ds_read_b64_tr_b16 a[104:105], v20 offset:4096
    s_waitcnt lgkmcnt(7)
    v_mfma_f32_16x16x32_bf16 v[48:51], a[84:87], a[36:39], v[48:51]
    ds_read_b64_tr_b16 a[106:107], v20 offset:4608
    v_mfma_f32_16x16x32_bf16 v[32:35], a[84:87], a[32:35], v[32:35]
    ds_read_b64_tr_b16 a[108:109], v21 offset:4096
    s_setprio 0
    s_waitcnt lgkmcnt(7)
    v_mfma_f32_16x16x32_bf16 v[36:39], a[88:91], a[32:35], v[36:39]
    ds_read_b64_tr_b16 a[110:111], v21 offset:4608
    ds_read_b64_tr_b16 a[112:113], v22 offset:4096
    v_mfma_f32_16x16x32_bf16 v[52:55], a[88:91], a[36:39], v[52:55]
    ds_read_b64_tr_b16 a[114:115], v22 offset:4608
    s_waitcnt lgkmcnt(8)
    v_mfma_f32_16x16x32_bf16 v[56:59], a[92:95], a[36:39], v[56:59]
    ds_read_b64_tr_b16 a[116:117], v23 offset:4096
    v_mfma_f32_16x16x32_bf16 v[40:43], a[92:95], a[32:35], v[40:43]
    ds_read_b64_tr_b16 a[118:119], v23 offset:4608
    s_waitcnt lgkmcnt(0)
    s_barrier
    s_setprio 3
    v_mfma_f32_16x16x32_bf16 v[28:31], a[104:107], a[40:43], v[28:31]
    ds_read_b128 a[48:51], v76 offset:39040
    ds_read_b128 a[52:55], v78 offset:39040
    v_mfma_f32_16x16x32_bf16 v[44:47], a[104:107], a[44:47], v[44:47]
    ds_read_b64_tr_b16 a[80:81], v20 offset:39040
    v_mfma_f32_16x16x32_bf16 v[48:51], a[108:111], a[44:47], v[48:51]
    ds_read_b64_tr_b16 a[82:83], v20 offset:39552
    v_mfma_f32_16x16x32_bf16 v[32:35], a[108:111], a[40:43], v[32:35]
    ds_read_b64_tr_b16 a[84:85], v21 offset:39040
    s_setprio 2
    v_mfma_f32_16x16x32_bf16 v[36:39], a[112:115], a[40:43], v[36:39]
    ds_read_b64_tr_b16 a[86:87], v21 offset:39552
    ds_read_b64_tr_b16 a[88:89], v22 offset:39040
    v_mfma_f32_16x16x32_bf16 v[52:55], a[112:115], a[44:47], v[52:55]
    ds_read_b64_tr_b16 a[90:91], v22 offset:39552
    v_mfma_f32_16x16x32_bf16 v[56:59], a[116:119], a[44:47], v[56:59]
    ds_read_b64_tr_b16 a[92:93], v23 offset:39040
    v_mfma_f32_16x16x32_bf16 v[40:43], a[116:119], a[40:43], v[40:43]
    ds_read_b64_tr_b16 a[94:95], v23 offset:39552
    v_mov_b32 v98, s34
    s_waitcnt vmcnt(0)
    s_mov_b64 exec, 1
    buffer_store_dword v98, v97, s[28:31], s24 offen sc1
    s_mov_b64 exec, -1
    s_cmp_eq_u32 s42, 9
    s_cbranch_scc1 Lxe9
Lxe9_b:
    s_setprio 1
    s_waitcnt lgkmcnt(6)
    v_mfma_f32_16x16x32_bf16 v[28:31], a[80:83], a[48:51], v[28:31]
    ds_read_b128 a[56:59], v77 offset:39040
    ds_read_b128 a[60:63], v79 offset:39040
    ds_read_b64_tr_b16 a[104:105], v20 offset:43136
    v_mfma_f32_16x16x32_bf16 v[44:47], a[80:83], a[52:55], v[44:47]
    ds_read_b64_tr_b16 a[106:107], v20 offset:43648
    ds_read_b64_tr_b16 a[108:109], v21 offset:43136
    s_waitcnt lgkmcnt(9)
    v_mfma_f32_16x16x32_bf16 v[48:51], a[84:87], a[52:55], v[48:51]
    ds_read_b64_tr_b16 a[110:111], v21 offset:43648
    ds_read_b64_tr_b16 a[112:113], v22 offset:43136
    ds_read_b64_tr_b16 a[114:115], v22 offset:43648
    v_mfma_f32_16x16x32_bf16 v[32:35], a[84:87], a[48:51], v[32:35]
    ds_read_b64_tr_b16 a[116:117], v23 offset:43136
    ds_read_b64_tr_b16 a[118:119], v23 offset:43648
    s_setprio 0
    s_waitcnt lgkmcnt(12)
    v_mfma_f32_16x16x32_bf16 v[36:39], a[88:91], a[48:51], v[36:39]
    ds_read_b32 v120, v94
    ds_read_b32 v121, v94 offset:512
    v_xor_b32 v94, 64, v94
    v_mfma_f32_16x16x32_bf16 v[52:55], a[88:91], a[52:55], v[52:55]
    ds_read_b32 v122, v94
    ds_read_b32 v123, v92 offset:512
    s_waitcnt lgkmcnt(14)
    v_mfma_f32_16x16x32_bf16 v[56:59], a[92:95], a[52:55], v[56:59]
    ds_read_b32 v126, v93 offset:520
    v_mov_b32 v24, v84
    v_mov_b32 v25, v85
    v_mfma_f32_16x16x32_bf16 v[40:43], a[92:95], a[48:51], v[40:43]
    v_mov_b32 v26, v86
    v_mov_b32 v27, v87
    s_waitcnt lgkmcnt(5)
    v_mfma_f32_16x16x32_bf16 v[44:47], a[104:107], a[60:63], v[44:47]
    v_mfma_f32_16x16x32_bf16 v[48:51], a[108:111], a[60:63], v[48:51]
    v_mfma_f32_16x16x32_bf16 v[52:55], a[112:115], a[60:63], v[52:55]
    v_mfma_f32_16x16x32_bf16 v[56:59], a[116:119], a[60:63], v[56:59]
    v_mfma_f32_16x16x32_bf16 v[28:31], a[104:107], a[56:59], v[28:31]
    v_mfma_f32_16x16x32_bf16 v[32:35], a[108:111], a[56:59], v[32:35]
    ds_read_b32 v7, v96
    ds_read_b128 v[76:79], v95 offset:0
    ds_read_b128 v[80:83], v95 offset:64
    ds_read_b128 v[84:87], v95 offset:128
    ds_read_b128 v[88:91], v95 offset:192
    v_mfma_f32_16x16x32_bf16 v[36:39], a[112:115], a[56:59], v[36:39]
    v_mfma_f32_16x16x32_bf16 v[40:43], a[116:119], a[56:59], v[40:43]
    s_waitcnt lgkmcnt(0)
Lqf:
    v_readfirstlane_b32 s38, v7
    s_nop 0
    s_cmp_eq_u32 s38, 0
    s_cbranch_scc1 Lqf_re
    s_cmp_eq_u32 s27, 0
    v_fmac_f32 v44, v76, v122
    v_fmac_f32 v45, v77, v122
    v_fmac_f32 v46, v78, v122
    v_fmac_f32 v47, v79, v122
    v_cvt_pk_bf16_f32 v44, v44, v45
    v_cvt_pk_bf16_f32 v45, v46, v47
    v_fmac_f32 v48, v80, v122
    v_fmac_f32 v49, v81, v122
    v_fmac_f32 v50, v82, v122
    v_fmac_f32 v51, v83, v122
    v_cvt_pk_bf16_f32 v46, v48, v49
    v_cvt_pk_bf16_f32 v47, v50, v51
    v_fmac_f32 v52, v84, v122
    v_fmac_f32 v53, v85, v122
    v_fmac_f32 v54, v86, v122
    v_fmac_f32 v55, v87, v122
    v_cvt_pk_bf16_f32 v48, v52, v53
    v_cvt_pk_bf16_f32 v49, v54, v55
    v_fmac_f32 v56, v88, v122
    v_fmac_f32 v57, v89, v122
    v_fmac_f32 v58, v90, v122
    v_fmac_f32 v59, v91, v122
    v_cvt_pk_bf16_f32 v50, v56, v57
    v_cvt_pk_bf16_f32 v51, v58, v59
    s_cbranch_scc1 Lh1
    s_setprio 3
    ds_write_b128 v125, v[44:47] offset:2048
    ds_write_b128 v125, v[48:51] offset:3072
    v_fmac_f32 v28, v76, v120
    v_fmac_f32 v29, v77, v120
    v_fmac_f32 v30, v78, v120
    v_fmac_f32 v31, v79, v120
    v_cvt_pk_bf16_f32 v52, v28, v29
    v_cvt_pk_bf16_f32 v53, v30, v31
    v_fmac_f32 v32, v80, v120
    v_fmac_f32 v33, v81, v120
    v_fmac_f32 v34, v82, v120
    v_fmac_f32 v35, v83, v120
    v_cvt_pk_bf16_f32 v54, v32, v33
    v_cvt_pk_bf16_f32 v55, v34, v35
    v_fmac_f32 v36, v84, v120
    v_fmac_f32 v37, v85, v120
    v_fmac_f32 v38, v86, v120
    v_fmac_f32 v39, v87, v120
    v_cvt_pk_bf16_f32 v56, v36, v37
    v_cvt_pk_bf16_f32 v57, v38, v39
    v_fmac_f32 v40, v88, v120
    v_fmac_f32 v41, v89, v120
    v_fmac_f32 v42, v90, v120
    v_fmac_f32 v43, v91, v120
    v_cvt_pk_bf16_f32 v58, v40, v41
    v_cvt_pk_bf16_f32 v59, v42, v43
    ds_write_b128 v125, v[52:55] offset:4096
    ds_write_b128 v125, v[56:59] offset:5120
    v_mov_b32 v5, 157972
    v_mov_b32 v6, 1
    s_mov_b64 exec, 1
    ds_add_u32 v5, v6
    s_mov_b64 exec, -1
    v_mov_b32 v8, s22
    v_mov_b32 v9, s22
    v_mov_b32 v10, s22
    v_mov_b32 v11, s22
Lcw_1:
    s_sub_u32 s35, s35, 1
    s_cbranch_scc1 Lend
    ds_read_b32 v6, v5
    s_waitcnt lgkmcnt(0)
    v_readfirstlane_b32 s38, v6
    s_nop 0
    s_cmp_lt_u32 s38, 8
    s_cbranch_scc1 Lcw_1
    ds_read_b128 v[28:31], v125 offset:0
    ds_read_b128 v[32:35], v125 offset:1024
Lh_join:
    buffer_load_dword v20, v12, s[28:31], s24 offen sc1
    ds_read_b64_tr_b16 a[64:65], v26 offset:0
    ds_read_b64_tr_b16 a[66:67], v26 offset:512
    ds_read_b64_tr_b16 a[68:69], v27 offset:0
    ds_read_b64_tr_b16 a[70:71], v27 offset:512
    ds_read_b64_tr_b16 a[72:73], v26 offset:4096
    ds_read_b64_tr_b16 a[74:75], v26 offset:4608
    ds_read_b64_tr_b16 a[76:77], v27 offset:4096
    ds_read_b64_tr_b16 a[78:79], v27 offset:4608
    s_waitcnt lgkmcnt(8)
    s_setprio 3
    v_cndmask_b32 v92, 0, v30, s[6:7]
    v_cndmask_b32 v93, 0, v31, s[6:7]
    v_cndmask_b32 v94, 0, v32, s[12:13]
    v_cndmask_b32 v95, 0, v33, s[12:13]
    v_cndmask_b32 v104, 0, v30, s[8:9]
    v_cndmask_b32 v105, 0, v31, s[8:9]
    v_mfma_f32_16x16x32_bf16 v[76:79], v[46:49], v[92:95], v[8:11]
    v_mfma_f32_16x16x32_bf16 v[80:83], v[54:57], v[92:95], 0
    v_cndmask_b32 v106, 0, v32, s[14:15]
    v_cndmask_b32 v107, 0, v33, s[14:15]
    v_mov_b32 v96, v28
    v_mov_b32 v97, v29
    v_mfma_f32_16x16x32_bf16 v[84:87], v[46:49], v[104:107], v[8:11]
    v_mfma_f32_16x16x32_bf16 v[88:91], v[54:57], v[104:107], 0
    v_cndmask_b32 v98, 0, v30, s[10:11]
    v_cndmask_b32 v99, 0, v31, s[10:11]
    v_cndmask_b32 v100, 0, v32, s[16:17]
    v_cndmask_b32 v101, 0, v33, s[16:17]
    v_mfma_f32_16x16x32_bf16 v[36:39], v[44:47], v[96:99], v[8:11]
    v_mfma_f32_16x16x32_bf16 v[40:43], v[52:55], v[96:99], 0
    v_cndmask_b32 v76, v76, v77, s[4:5]
    v_cndmask_b32 v80, v80, v81, s[4:5]
    v_cndmask_b32 v78, v78, v79, s[4:5]
    v_cndmask_b32 v82, v82, v83, s[4:5]
    v_cndmask_b32 v92, v76, v80, s[18:19]
    v_cndmask_b32 v94, v78, v82, s[20:21]
    v_min_u32 v4, -2, v92
    v_min_u32 v5, -2, v94
    v_cndmask_b32 v84, v84, v85, s[4:5]
    v_cndmask_b32 v88, v88, v89, s[4:5]
    v_cndmask_b32 v86, v86, v87, s[4:5]
    v_cndmask_b32 v90, v90, v91, s[4:5]
    v_cndmask_b32 v104, v84, v88, s[18:19]
    v_cndmask_b32 v106, v86, v90, s[20:21]
    v_min_u32 v6, -2, v104
    v_min_u32 v7, -2, v106
    buffer_store_dwordx4 v[4:7], v13, s[28:31], s58 offen sc0 sc1
    s_setprio 2
    ds_read_b64_tr_b16 a[80:81], v26 offset:39040
    ds_read_b64_tr_b16 a[82:83], v26 offset:39552
    ds_read_b64_tr_b16 a[84:85], v27 offset:39040
    ds_read_b64_tr_b16 a[86:87], v27 offset:39552
    ds_read_b64_tr_b16 a[88:89], v26 offset:43136
    ds_read_b64_tr_b16 a[90:91], v26 offset:43648
    ds_read_b64_tr_b16 a[92:93], v27 offset:43136
    ds_read_b64_tr_b16 a[94:95], v27 offset:43648
    ds_read_b64_tr_b16 a[96:97], v24 offset:0
    ds_read_b64_tr_b16 a[98:99], v24 offset:512
    ds_read_b64_tr_b16 a[100:101], v25 offset:0
    ds_read_b64_tr_b16 a[102:103], v25 offset:512
    ds_read_b64_tr_b16 a[104:105], v24 offset:4096
    ds_read_b64_tr_b16 a[106:107], v24 offset:4608
    ds_read_b64_tr_b16 a[108:109], v25 offset:4096
    ds_read_b64_tr_b16 a[110:111], v25 offset:4608
    ds_read_b64_tr_b16 a[112:113], v24 offset:39040
    ds_read_b64_tr_b16 a[114:115], v24 offset:39552
    ds_read_b64_tr_b16 a[116:117], v25 offset:39040
    ds_read_b64_tr_b16 a[118:119], v25 offset:39552
    ds_read_b64_tr_b16 a[120:121], v24 offset:43136
    ds_read_b64_tr_b16 a[122:123], v24 offset:43648
    ds_read_b64_tr_b16 a[124:125], v25 offset:43136
    ds_read_b64_tr_b16 a[126:127], v25 offset:43648
    s_waitcnt lgkmcnt(15)
    v_mfma_f32_16x16x32_bf16 v[60:63], a[0:3], a[64:67], v[60:63]
    v_mov_b32 v102, v34
    v_mov_b32 v103, v35
    v_mul_f32 v4, s25, v121
    v_mfma_f32_16x16x32_bf16 v[68:71], a[4:7], a[64:67], v[68:71]
    v_mfma_f32_16x16x32_bf16 v[76:79], v[48:51], v[100:103], v[8:11]
    v_mfma_f32_16x16x32_bf16 v[80:83], v[56:59], v[100:103], 0
    v_mul_f32 v123, v123, v4
    v_mfma_f32_16x16x32_bf16 v[64:67], a[0:3], a[68:71], v[64:67]
    v_mul_f32 v126, v126, v4
    v_cndmask_b32 v36, v36, v37, s[4:5]
    v_cndmask_b32 v40, v40, v41, s[4:5]
    v_mfma_f32_16x16x32_bf16 v[72:75], a[4:7], a[68:71], v[72:75]
    v_cndmask_b32 v38, v38, v39, s[4:5]
    v_cndmask_b32 v42, v42, v43, s[4:5]
    v_cndmask_b32 v96, v36, v40, s[18:19]
    v_mfma_f32_16x16x32_bf16 v[60:63], a[8:11], a[72:75], v[60:63]
    v_cndmask_b32 v98, v38, v42, s[20:21]
    v_cndmask_b32 v76, v76, v77, s[4:5]
    v_cndmask_b32 v80, v80, v81, s[4:5]
    v_mfma_f32_16x16x32_bf16 v[68:71], a[12:15], a[72:75], v[68:71]
    v_cndmask_b32 v78, v78, v79, s[4:5]
    v_cndmask_b32 v82, v82, v83, s[4:5]
    v_cndmask_b32 v100, v76, v80, s[18:19]
    v_mfma_f32_16x16x32_bf16 v[64:67], a[8:11], a[76:79], v[64:67]
    v_cndmask_b32 v102, v78, v82, s[20:21]
    v_mul_f32 v96, v96, v123
    v_mul_f32 v98, v98, v126
    v_mfma_f32_16x16x32_bf16 v[72:75], a[12:15], a[76:79], v[72:75]
    v_mul_f32 v100, v100, v123
    v_mul_f32 v102, v102, v126
    v_max_f32 v4, v96, v98
    v_mfma_f32_16x16x32_bf16 v[60:63], a[16:19], a[80:83], v[60:63]
    v_max_f32 v5, v100, v102
    v_mov_b32 v6, v4
    v_mov_b32 v7, v5
    v_mfma_f32_16x16x32_bf16 v[68:71], a[20:23], a[80:83], v[68:71]
    v_permlane32_swap_b32 v4, v6
    v_permlane32_swap_b32 v5, v7
    v_max_f32 v4, v4, v6
    v_mfma_f32_16x16x32_bf16 v[64:67], a[16:19], a[84:87], v[64:67]
    v_max_f32 v5, v5, v7
    v_mov_b32 v6, v4
    v_mov_b32 v7, v5
    v_mfma_f32_16x16x32_bf16 v[72:75], a[20:23], a[84:87], v[72:75]
    v_permlane16_swap_b32 v4, v6
    v_permlane16_swap_b32 v5, v7
    s_setprio 1
    v_mfma_f32_16x16x32_bf16 v[60:63], a[24:27], a[88:91], v[60:63]
    v_max_f32 v4, v4, v6
    v_max_f32 v5, v5, v7
    v_sub_f32 v96, v96, v4
    v_mfma_f32_16x16x32_bf16 v[68:71], a[28:31], a[88:91], v[68:71]
    v_sub_f32 v98, v98, v4
    v_sub_f32 v100, v100, v5
    v_sub_f32 v102, v102, v5
    v_mfma_f32_16x16x32_bf16 v[64:67], a[24:27], a[92:95], v[64:67]
    v_exp_f32 v96, v96
    v_exp_f32 v98, v98
    v_exp_f32 v100, v100
    v_mfma_f32_16x16x32_bf16 v[72:75], a[28:31], a[92:95], v[72:75]
    v_exp_f32 v102, v102
    v_cvt_pk_bf16_f32 v96, v96, v96
    s_waitcnt lgkmcnt(12)
    v_mfma_f32_16x16x32_bf16 v[60:63], a[32:35], a[96:99], v[60:63]
    v_cvt_pk_bf16_f32 v97, v98, v98
    v_cvt_pk_bf16_f32 v100, v100, v100
    v_cvt_pk_bf16_f32 v101, v102, v102
    v_mfma_f32_16x16x32_bf16 v[68:71], a[36:39], a[96:99], v[68:71]
    v_and_b32 v98, v96, v118
    v_and_b32 v99, v97, v119
    v_and_b32 v96, v96, v116
    v_mfma_f32_16x16x32_bf16 v[64:67], a[32:35], a[100:103], v[64:67]
    v_and_b32 v97, v97, v117
    v_and_b32 v102, v100, v118
    v_and_b32 v103, v101, v119
    v_mfma_f32_16x16x32_bf16 v[72:75], a[36:39], a[100:103], v[72:75]
    v_and_b32 v100, v100, v116
    v_and_b32 v101, v101, v117
    s_waitcnt lgkmcnt(8)
    v_mfma_f32_16x16x32_bf16 v[60:63], a[40:43], a[104:107], v[60:63]
    s_lshl_b32 s36, s44, 6
    s_add_u32 s36, s36, 156160
    v_lshl_add_u32 v48, v2, 4, s36
    v_xor_b32 v49, 64, v48
    ds_read_b128 v[28:31], v48 offset:0
    v_mfma_f32_16x16x32_bf16 v[68:71], a[44:47], a[104:107], v[68:71]
    ds_read_b128 v[32:35], v48 offset:512
    ds_read_b128 v[36:39], v49 offset:0
    ds_read_b128 v[40:43], v49 offset:512
    s_lshl_b32 s36, s27, 3
    s_add_u32 s36, s36, 157696
    v_mfma_f32_16x16x32_bf16 v[64:67], a[40:43], a[108:111], v[64:67]
    v_lshl_add_u32 v48, v3, 4, s36
    v_mov_b32 v49, 157952
    v_lshl_add_u32 v125, v1, 3, s45
    s_lshl_b32 s36, s27, 10
    v_add_u32 v50, s36, v125
    v_mfma_f32_16x16x32_bf16 v[72:75], a[44:47], a[108:111], v[72:75]
    s_lshl_b32 s37, s27, 12
    s_sub_u32 s37, 2048, s37
    v_add_u32 v51, s37, v50
    v_subrev_u32 v125, 2048, v125
    s_setprio 0
    s_waitcnt lgkmcnt(8)
    v_mfma_f32_16x16x32_bf16 v[60:63], a[48:51], a[112:115], v[60:63]
    v_mfma_f32_16x16x32_bf16 v[68:71], a[52:55], a[112:115], v[68:71]
    v_mfma_f32_16x16x32_bf16 v[64:67], a[48:51], a[116:119], v[64:67]
    v_mfma_f32_16x16x32_bf16 v[72:75], a[52:55], a[116:119], v[72:75]
    s_waitcnt vmcnt(1)
Lfl_chk:
    v_cmp_eq_u32 vcc, s34, v20
    s_nop 0
    s_and_b32 s36, vcc_lo, 0x3ff
    s_cmp_lg_u32 s36, 0x3ff
    s_cbranch_scc1 Lfl_re
    buffer_load_dwordx2 v[52:53], v13, s[28:31], s59 offen offset:8 sc1
    buffer_load_dwordx2 v[54:55], v13, s[28:31], s60 offen offset:0 sc1
    s_waitcnt lgkmcnt(4)
    v_mfma_f32_16x16x32_bf16 v[60:63], a[56:59], a[120:123], v[60:63]
    v_mfma_f32_16x16x32_bf16 v[68:71], a[60:63], a[120:123], v[68:71]
    v_mfma_f32_16x16x32_bf16 v[64:67], a[56:59], a[124:127], v[64:67]
    v_mfma_f32_16x16x32_bf16 v[72:75], a[60:63], a[124:127], v[72:75]
    ds_read_b32 v46, v49
    ds_read_b64 v[44:45], v48
    s_waitcnt lgkmcnt(0)
Lcsv:
    v_readfirstlane_b32 s38, v46
    s_nop 0
    s_cmp_eq_u32 s38, 0
    s_cbranch_scc1 Lcsv_re
    v_fmac_f32 v60, v28, v44
    v_fmac_f32 v61, v29, v44
    v_fmac_f32 v62, v30, v44
    v_fmac_f32 v63, v31, v44
    v_mul_f32 v60, v60, v32
    v_mul_f32 v61, v61, v33
    v_mul_f32 v62, v62, v34
    v_mul_f32 v63, v63, v35
    v_cvt_pk_bf16_f32 v60, v60, v61
    v_cvt_pk_bf16_f32 v61, v62, v63
    ds_write_b64 v50, v[60:61] offset:0
    v_fmac_f32 v64, v28, v45
    v_fmac_f32 v65, v29, v45
    v_fmac_f32 v66, v30, v45
    v_fmac_f32 v67, v31, v45
    v_mul_f32 v64, v64, v32
    v_mul_f32 v65, v65, v33
    v_mul_f32 v66, v66, v34
    v_mul_f32 v67, v67, v35
    v_cvt_pk_bf16_f32 v64, v64, v65
    v_cvt_pk_bf16_f32 v65, v66, v67
    ds_write_b64 v50, v[64:65] offset:512
    v_fmac_f32 v68, v36, v44
    v_fmac_f32 v69, v37, v44
    v_fmac_f32 v70, v38, v44
    v_fmac_f32 v71, v39, v44
    v_mul_f32 v68, v68, v40
    v_mul_f32 v69, v69, v41
    v_mul_f32 v70, v70, v42
    v_mul_f32 v71, v71, v43
    v_cvt_pk_bf16_f32 v68, v68, v69
    v_cvt_pk_bf16_f32 v69, v70, v71
    ds_write_b64 v51, v[68:69] offset:0
    v_fmac_f32 v72, v36, v45
    v_fmac_f32 v73, v37, v45
    v_fmac_f32 v74, v38, v45
    v_fmac_f32 v75, v39, v45
    v_mul_f32 v72, v72, v40
    v_mul_f32 v73, v73, v41
    v_mul_f32 v74, v74, v42
    v_mul_f32 v75, v75, v43
    v_cvt_pk_bf16_f32 v72, v72, v73
    v_cvt_pk_bf16_f32 v73, v74, v75
    ds_write_b64 v51, v[72:73] offset:512
    v_mov_b32 v8, 157976
    v_mov_b32 v9, 1
    s_mov_b64 exec, 1
    ds_add_u32 v8, v9
    s_mov_b64 exec, -1
    s_waitcnt vmcnt(0)
Lrx_chk:
    v_and_b32 v52, s61, v52
    v_and_b32 v53, s61, v53
    v_and_b32 v54, s62, v54
    v_and_b32 v55, s62, v55
    v_max3_u32 v4, v52, v53, v54
    v_max_u32 v4, v4, v55
    v_cmp_eq_u32 vcc, -1, v4
    s_nop 0
    s_cbranch_vccnz Lrx_re
    v_add_f32 v92, v92, v52
    v_add_f32 v94, v94, v53
    v_add_f32 v104, v104, v54
    v_add_f32 v106, v106, v55
Lcw_4:
    s_sub_u32 s35, s35, 1
    s_cbranch_scc1 Lend
    ds_read_b32 v9, v8
    s_waitcnt lgkmcnt(0)
    v_readfirstlane_b32 s38, v9
    s_nop 0
    s_cmp_lt_u32 s38, 7
    s_cbranch_scc1 Lcw_4
    s_setprio 2
    ds_read2st64_b64 v[60:63], v125 offset0:0 offset1:4
    ds_read2st64_b64 v[64:67], v125 offset0:1 offset1:5
    ds_read2st64_b64 v[68:71], v125 offset0:2 offset1:6
    ds_read2st64_b64 v[72:75], v125 offset0:3 offset1:7
    v_mul_f32 v92, v92, v123
    v_mul_f32 v94, v94, v126
    v_mul_f32 v104, v104, v123
    v_mul_f32 v106, v106, v126
    v_max_f32 v4, v92, v94
    v_max_f32 v5, v104, v106
    v_mov_b32 v6, v4
    v_mov_b32 v7, v5
    s_nop 0
    v_permlane32_swap_b32 v4, v6
    v_permlane32_swap_b32 v5, v7
    v_max_f32 v4, v4, v6
    v_max_f32 v5, v5, v7
    s_waitcnt lgkmcnt(0)
    v_mov_b32 v6, v4
    v_mfma_f32_16x16x32_bf16 v[80:83], v[14:17], v[96:99], 0
    v_mov_b32 v7, v5
    v_permlane16_swap_b32 v4, v6
    s_nop 0
    v_permlane16_swap_b32 v5, v7
    v_max_f32 v4, v4, v6
    v_mfma_f32_16x16x32_bf16 v[84:87], v[14:17], v[100:103], 0
    v_max_f32 v5, v5, v7
    v_sub_f32 v92, v92, v4
    v_sub_f32 v94, v94, v4
    v_sub_f32 v104, v104, v5
    v_mfma_f32_16x16x32_bf16 v[28:31], v[60:63], v[96:99], 0
    v_sub_f32 v106, v106, v5
    v_exp_f32 v92, v92
    v_exp_f32 v94, v94
    v_exp_f32 v104, v104
    v_exp_f32 v106, v106
    v_mfma_f32_16x16x32_bf16 v[32:35], v[64:67], v[96:99], 0
    v_cvt_pk_bf16_f32 v92, v92, v92
    v_cvt_pk_bf16_f32 v93, v94, v94
    v_cvt_pk_bf16_f32 v104, v104, v104
    v_cvt_pk_bf16_f32 v105, v106, v106
    v_mfma_f32_16x16x32_bf16 v[36:39], v[68:71], v[100:103], 0
    v_and_b32 v94, v92, v118
    v_and_b32 v95, v93, v119
    v_and_b32 v92, v92, v116
    v_and_b32 v93, v93, v117
    v_mfma_f32_16x16x32_bf16 v[40:43], v[72:75], v[100:103], 0
    v_and_b32 v106, v104, v118
    v_and_b32 v107, v105, v119
    v_and_b32 v104, v104, v116
    v_and_b32 v105, v105, v117
    v_mfma_f32_16x16x32_bf16 v[76:79], v[14:17], v[92:95], 0
    v_rcp_f32 v80, v80
    v_rcp_f32 v84, v84
    v_mfma_f32_16x16x32_bf16 v[88:91], v[14:17], v[104:107], 0
    v_mul_f32 v28, v28, v80
    v_mul_f32 v29, v29, v80
    v_mfma_f32_16x16x32_bf16 v[44:47], v[64:67], v[92:95], 0
    v_mul_f32 v30, v30, v80
    v_mfma_f32_16x16x32_bf16 v[48:51], v[68:71], v[92:95], 0
    v_mul_f32 v31, v31, v80
    v_cvt_pk_bf16_f32 v4, v28, v29
    v_mfma_f32_16x16x32_bf16 v[52:55], v[64:67], v[104:107], 0
    v_cvt_pk_bf16_f32 v5, v30, v31
    v_min_u32 v4, -2, v4
    v_mfma_f32_16x16x32_bf16 v[56:59], v[68:71], v[104:107], 0
    v_min_u32 v5, -2, v5
    v_mul_f32 v40, v40, v84
    v_mul_f32 v41, v41, v84
    v_mul_f32 v42, v42, v84
    v_mul_f32 v43, v43, v84
    v_cvt_pk_bf16_f32 v10, v40, v41
    v_cvt_pk_bf16_f32 v11, v42, v43
    v_min_u32 v10, -2, v10
    v_min_u32 v11, -2, v11
    v_rcp_f32 v76, v76
    v_rcp_f32 v88, v88
    v_cndmask_b32 v82, v80, v76, s[6:7]
    v_cndmask_b32 v82, v82, v88, s[8:9]
    v_cndmask_b32 v32, v32, v44, s[6:7]
    v_cndmask_b32 v33, v33, v45, s[6:7]
    v_cndmask_b32 v34, v34, v46, s[6:7]
    v_cndmask_b32 v35, v35, v47, s[6:7]
    v_cndmask_b32 v32, v32, v52, s[8:9]
    v_cndmask_b32 v33, v33, v53, s[8:9]
    v_cndmask_b32 v34, v34, v54, s[8:9]
    v_cndmask_b32 v35, v35, v55, s[8:9]
    v_mul_f32 v32, v32, v82
    v_mul_f32 v33, v33, v82
    v_mul_f32 v34, v34, v82
    v_mul_f32 v35, v35, v82
    v_cvt_pk_bf16_f32 v6, v32, v33
    v_cvt_pk_bf16_f32 v7, v34, v35
    v_min_u32 v6, -2, v6
    v_min_u32 v7, -2, v7
    buffer_store_dwordx4 v[4:7], v13, s[28:31], s23 offen offset:0 sc0 sc1
    v_cndmask_b32 v86, v84, v76, s[12:13]
    v_cndmask_b32 v86, v86, v88, s[14:15]
    v_cndmask_b32 v36, v36, v48, s[12:13]
    v_cndmask_b32 v37, v37, v49, s[12:13]
    v_cndmask_b32 v38, v38, v50, s[12:13]
    v_cndmask_b32 v39, v39, v51, s[12:13]
    v_cndmask_b32 v36, v36, v56, s[14:15]
    v_cndmask_b32 v37, v37, v57, s[14:15]
    v_cndmask_b32 v38, v38, v58, s[14:15]
    v_cndmask_b32 v39, v39, v59, s[14:15]
    v_mul_f32 v36, v36, v86
    v_mul_f32 v37, v37, v86
    v_mul_f32 v38, v38, v86
    v_mul_f32 v39, v39, v86
    v_cvt_pk_bf16_f32 v8, v36, v37
    v_cvt_pk_bf16_f32 v9, v38, v39
    v_min_u32 v8, -2, v8
    v_min_u32 v9, -2, v9
    buffer_store_dwordx4 v[8:11], v13, s[28:31], s23 offen offset:1024 sc0 sc1
    s_setprio 1
    s_nop 0
    v_mov_b32 v10, 157980
    v_and_b32 v6, 3, v1
    v_lshl_add_u32 v6, v6, 3, v19
    v_add_u32 v20, v6, v18
    v_xor_b32 v21, 32, v20
    v_xor_b32 v22, 64, v20
    v_xor_b32 v23, 96, v20
    v_add_u32 v24, 63616, v20
    v_add_u32 v25, 63616, v21
    v_add_u32 v26, 63616, v22
    v_add_u32 v27, 63616, v23
Lcw_3:
    s_sub_u32 s35, s35, 1
    s_cbranch_scc1 Lend
    ds_read_b32 v11, v10
    s_waitcnt lgkmcnt(0)
    v_readfirstlane_b32 s38, v11
    s_nop 0
    s_cmp_lt_u32 s38, 2
    s_cbranch_scc1 Lcw_3
    s_mul_i32 s36, s32, 96
    s_lshl_b32 s37, s44, 4
    s_add_u32 s36, s36, s37
    s_sub_u32 s36, s36, 32
    v_add_u32 v126, s36, v3
    v_lshrrev_b32 v6, 3, v1
    v_add_u32 v6, s36, v6
    v_mul_u32_u24 v6, 1280, v6
    v_and_b32 v7, 7, v1
    v_xor_b32 v7, v7, v2
    v_lshl_add_u32 v122, v7, 4, v6
    v_xor_b32 v123, 64, v122
    v_add_u32 v123, 10240, v123
    s_lshl_b32 s36, s44, 11
    s_add_u32 s36, s36, 102656
    v_add_u32 v124, s36, v124
    v_add_u32 v125, s36, v13
    s_lshl_b32 s24, s33, 7
    v_mov_b32 v10, 157960
    s_mov_b32 s41, 0
    s_mov_b32 s47, 3
    v_lshlrev_b32 v28, 16, v108
    ds_read_b64_tr_b16 a[0:1], v20 offset:0
    ds_read_b64_tr_b16 a[2:3], v20 offset:512
    ds_read_b64_tr_b16 a[4:5], v21 offset:0
    ds_read_b64_tr_b16 a[6:7], v21 offset:512
    ds_read_b64_tr_b16 a[8:9], v22 offset:0
    ds_read_b64_tr_b16 a[10:11], v22 offset:512
    ds_read_b64_tr_b16 a[12:13], v23 offset:0
    ds_read_b64_tr_b16 a[14:15], v23 offset:512
    v_and_b32 v29, 0xffff0000, v108
    v_lshlrev_b32 v30, 16, v109
    v_and_b32 v31, 0xffff0000, v109
    v_lshlrev_b32 v32, 16, v110
    v_and_b32 v33, 0xffff0000, v110
    v_lshlrev_b32 v34, 16, v111
    v_and_b32 v35, 0xffff0000, v111
    v_lshlrev_b32 v36, 16, v112
    v_and_b32 v37, 0xffff0000, v112
    v_lshlrev_b32 v38, 16, v113
    v_and_b32 v39, 0xffff0000, v113
    v_lshlrev_b32 v40, 16, v114
    v_and_b32 v41, 0xffff0000, v114
    v_lshlrev_b32 v42, 16, v115
    ds_read_b64_tr_b16 a[16:17], v20 offset:4096
    ds_read_b64_tr_b16 a[18:19], v20 offset:4608
    ds_read_b64_tr_b16 a[20:21], v21 offset:4096
    ds_read_b64_tr_b16 a[22:23], v21 offset:4608
    ds_read_b64_tr_b16 a[24:25], v22 offset:4096
    ds_read_b64_tr_b16 a[26:27], v22 offset:4608
    ds_read_b64_tr_b16 a[28:29], v23 offset:4096
    ds_read_b64_tr_b16 a[30:31], v23 offset:4608
    v_and_b32 v43, 0xffff0000, v115
    v_mul_f32 v4, v120, v121
    v_mul_f32 v5, 0xbfb8aa3b, v121
    v_mul_f32 v6, 0xbfb8aa3b, v4
    v_fma_f32 v44, v28, v5, v6
    v_fma_f32 v45, v29, v5, v6
    v_fma_f32 v46, v30, v5, v6
    v_fma_f32 v47, v31, v5, v6
    v_fma_f32 v48, v32, v5, v6
    v_fma_f32 v49, v33, v5, v6
    v_fma_f32 v50, v34, v5, v6
    v_fma_f32 v51, v35, v5, v6
    v_fma_f32 v52, v36, v5, v6
    v_fma_f32 v53, v37, v5, v6
    ds_read_b64_tr_b16 a[32:33], v20 offset:8192
    ds_read_b64_tr_b16 a[34:35], v20 offset:8704
    ds_read_b64_tr_b16 a[36:37], v21 offset:8192
    ds_read_b64_tr_b16 a[38:39], v21 offset:8704
    ds_read_b64_tr_b16 a[40:41], v22 offset:8192
    ds_read_b64_tr_b16 a[42:43], v22 offset:8704
    ds_read_b64_tr_b16 a[44:45], v23 offset:8192
    ds_read_b64_tr_b16 a[46:47], v23 offset:8704
    v_fma_f32 v54, v38, v5, v6
    v_fma_f32 v55, v39, v5, v6
    v_fma_f32 v56, v40, v5, v6
    v_fma_f32 v57, v41, v5, v6
    v_fma_f32 v58, v42, v5, v6
    v_fma_f32 v59, v43, v5, v6
    v_exp_f32 v44, v44
    v_exp_f32 v45, v45
    v_exp_f32 v46, v46
    v_exp_f32 v47, v47
    v_exp_f32 v48, v48
    v_exp_f32 v49, v49
    v_exp_f32 v50, v50
    v_exp_f32 v51, v51
    v_exp_f32 v52, v52
    ds_read_b64_tr_b16 a[48:49], v20 offset:12288
    ds_read_b64_tr_b16 a[50:51], v20 offset:12800
    ds_read_b64_tr_b16 a[52:53], v21 offset:12288
    ds_read_b64_tr_b16 a[54:55], v21 offset:12800
    ds_read_b64_tr_b16 a[56:57], v22 offset:12288
    ds_read_b64_tr_b16 a[58:59], v22 offset:12800
    ds_read_b64_tr_b16 a[60:61], v23 offset:12288
    ds_read_b64_tr_b16 a[62:63], v23 offset:12800
    v_exp_f32 v53, v53
    v_exp_f32 v54, v54
    v_exp_f32 v55, v55
    v_exp_f32 v56, v56
    v_exp_f32 v57, v57
    v_exp_f32 v58, v58
    v_exp_f32 v59, v59
    v_fma_f32 v92, v28, v121, v4
    v_fma_f32 v93, v29, v121, v4
    v_fma_f32 v94, v30, v121, v4
    v_fma_f32 v95, v31, v121, v4
    v_fma_f32 v96, v32, v121, v4
    v_fma_f32 v97, v33, v121, v4
    v_fma_f32 v98, v34, v121, v4
    ds_read_b64_tr_b16 a[64:65], v20 offset:24576
    ds_read_b64_tr_b16 a[66:67], v20 offset:25088
    ds_read_b64_tr_b16 a[68:69], v21 offset:24576
    ds_read_b64_tr_b16 a[70:71], v21 offset:25088
    ds_read_b64_tr_b16 a[72:73], v22 offset:24576
    ds_read_b64_tr_b16 a[74:75], v22 offset:25088
    ds_read_b64_tr_b16 a[76:77], v23 offset:24576
    ds_read_b64_tr_b16 a[78:79], v23 offset:25088
    v_fma_f32 v99, v35, v121, v4
    v_fma_f32 v100, v36, v121, v4
    v_fma_f32 v101, v37, v121, v4
    v_fma_f32 v102, v38, v121, v4
    v_fma_f32 v103, v39, v121, v4
    v_fma_f32 v104, v40, v121, v4
    v_fma_f32 v105, v41, v121, v4
    v_fma_f32 v106, v42, v121, v4
    v_fma_f32 v107, v43, v121, v4
    v_add_f32 v44, 1.0, v44
    v_add_f32 v45, 1.0, v45
    v_add_f32 v46, 1.0, v46
    v_add_f32 v47, 1.0, v47
    v_add_f32 v48, 1.0, v48
    ds_read_b64_tr_b16 a[80:81], v20 offset:28672
    ds_read_b64_tr_b16 a[82:83], v20 offset:29184
    ds_read_b64_tr_b16 a[84:85], v21 offset:28672
    ds_read_b64_tr_b16 a[86:87], v21 offset:29184
    ds_read_b64_tr_b16 a[88:89], v22 offset:28672
    ds_read_b64_tr_b16 a[90:91], v22 offset:29184
    ds_read_b64_tr_b16 a[92:93], v23 offset:28672
    ds_read_b64_tr_b16 a[94:95], v23 offset:29184
    v_add_f32 v49, 1.0, v49
    v_add_f32 v50, 1.0, v50
    v_add_f32 v51, 1.0, v51
    v_add_f32 v52, 1.0, v52
    v_add_f32 v53, 1.0, v53
    v_add_f32 v54, 1.0, v54
    v_add_f32 v55, 1.0, v55
    v_add_f32 v56, 1.0, v56
    v_add_f32 v57, 1.0, v57
    v_add_f32 v58, 1.0, v58
    v_add_f32 v59, 1.0, v59
    v_rcp_f32 v44, v44
    v_rcp_f32 v45, v45
    v_rcp_f32 v46, v46
    v_rcp_f32 v47, v47
    ds_read_b64_tr_b16 a[96:97], v24 offset:59520
    ds_read_b64_tr_b16 a[98:99], v24 offset:60032
    ds_read_b64_tr_b16 a[100:101], v25 offset:59520
    ds_read_b64_tr_b16 a[102:103], v25 offset:60032
    ds_read_b64_tr_b16 a[104:105], v26 offset:59520
    ds_read_b64_tr_b16 a[106:107], v26 offset:60032
    ds_read_b64_tr_b16 a[108:109], v27 offset:59520
    ds_read_b64_tr_b16 a[110:111], v27 offset:60032
    v_rcp_f32 v48, v48
    v_rcp_f32 v49, v49
    v_rcp_f32 v50, v50
    v_rcp_f32 v51, v51
    v_rcp_f32 v52, v52
    v_rcp_f32 v53, v53
    v_rcp_f32 v54, v54
    v_rcp_f32 v55, v55
    v_rcp_f32 v56, v56
    v_rcp_f32 v57, v57
    v_rcp_f32 v58, v58
    v_rcp_f32 v59, v59
    v_mul_f32 v44, v44, v92
    v_mul_f32 v45, v45, v93
    ds_read_b64_tr_b16 a[112:113], v24 offset:63616
    ds_read_b64_tr_b16 a[114:115], v24 offset:64128
    ds_read_b64_tr_b16 a[116:117], v25 offset:63616
    ds_read_b64_tr_b16 a[118:119], v25 offset:64128
    ds_read_b64_tr_b16 a[120:121], v26 offset:63616
    ds_read_b64_tr_b16 a[122:123], v26 offset:64128
    ds_read_b64_tr_b16 a[124:125], v27 offset:63616
    ds_read_b64_tr_b16 a[126:127], v27 offset:64128
    v_mul_f32 v46, v46, v94
    v_mul_f32 v47, v47, v95
    v_mul_f32 v48, v48, v96
    v_mul_f32 v49, v49, v97
    v_mul_f32 v50, v50, v98
    v_mul_f32 v51, v51, v99
    v_mul_f32 v52, v52, v100
    v_mul_f32 v53, v53, v101
    v_mul_f32 v54, v54, v102
    v_mul_f32 v55, v55, v103
    v_mul_f32 v56, v56, v104
    v_mul_f32 v57, v57, v105
    v_mul_f32 v58, v58, v106
    v_mul_f32 v59, v59, v107
    buffer_load_dwordx4 v[60:63], v13, s[28:31], s53 offen offset:0 sc1
    buffer_load_dwordx4 v[64:67], v13, s[28:31], s53 offen offset:1024 sc1
    buffer_load_dwordx4 v[68:71], v13, s[28:31], s53 offen offset:2048 sc1
    buffer_load_dwordx4 v[72:75], v13, s[28:31], s53 offen offset:3072 sc1
    buffer_load_dwordx4 v[76:79], v13, s[28:31], s54 offen offset:0 sc1
    buffer_load_dwordx4 v[80:83], v13, s[28:31], s54 offen offset:1024 sc1
    buffer_load_dwordx4 v[84:87], v13, s[28:31], s54 offen offset:2048 sc1
    buffer_load_dwordx4 v[88:91], v13, s[28:31], s54 offen offset:3072 sc1
    s_setprio 0
Lwo_go:
    s_setprio 3
    ds_read_b64 v[8:9], v10
    s_waitcnt vmcnt(6)
    v_max3_u32 v4, v60, v61, v62
    v_max3_u32 v5, v64, v65, v66
    v_max3_u32 v4, v4, v63, v67
    v_max_u32 v4, v4, v5
    v_cmp_eq_u32 vcc, -1, v4
    s_nop 0
    s_cbranch_vccnz Lre_0
Lck_0:
    s_waitcnt lgkmcnt(15)
    v_mfma_f32_16x16x32_bf16 v[108:111], a[0:3], v[60:63], 0
    ds_read_b64_tr_b16 a[0:1], v24 offset:16384
    ds_read_b64_tr_b16 a[2:3], v24 offset:16896
    buffer_load_dwordx4 v[92:95], v13, s[28:31], s55 offen offset:0 sc1
    v_mfma_f32_16x16x32_bf16 v[112:115], a[4:7], v[60:63], 0
    ds_read_b64_tr_b16 a[4:5], v25 offset:16384
    ds_read_b64_tr_b16 a[6:7], v25 offset:16896
    v_mfma_f32_16x16x32_bf16 v[116:119], a[8:11], v[60:63], 0
    ds_read_b64_tr_b16 a[8:9], v26 offset:16384
    ds_read_b64_tr_b16 a[10:11], v26 offset:16896
    buffer_load_dwordx4 v[96:99], v13, s[28:31], s55 offen offset:1024 sc1
    v_mfma_f32_16x16x32_bf16 v[14:17], a[12:15], v[60:63], 0
    ds_read_b64_tr_b16 a[12:13], v27 offset:16384
    ds_read_b64_tr_b16 a[14:15], v27 offset:16896
    v_mfma_f32_16x16x32_bf16 v[108:111], a[16:19], v[64:67], v[108:111]
    ds_read_b64_tr_b16 a[16:17], v24 offset:20480
    ds_read_b64_tr_b16 a[18:19], v24 offset:20992
    s_waitcnt vmcnt(6)
    v_max3_u32 v4, v68, v69, v70
    v_mfma_f32_16x16x32_bf16 v[112:115], a[20:23], v[64:67], v[112:115]
    ds_read_b64_tr_b16 a[20:21], v25 offset:20480
    ds_read_b64_tr_b16 a[22:23], v25 offset:20992
    v_max3_u32 v5, v72, v73, v74
    v_max3_u32 v4, v4, v71, v75
    v_mfma_f32_16x16x32_bf16 v[116:119], a[24:27], v[64:67], v[116:119]
    ds_read_b64_tr_b16 a[24:25], v26 offset:20480
    ds_read_b64_tr_b16 a[26:27], v26 offset:20992
    v_max_u32 v4, v4, v5
    v_cmp_eq_u32 vcc, -1, v4
    v_mfma_f32_16x16x32_bf16 v[14:17], a[28:31], v[64:67], v[14:17]
    ds_read_b64_tr_b16 a[28:29], v27 offset:20480
    ds_read_b64_tr_b16 a[30:31], v27 offset:20992
    s_cbranch_vccnz Lre_1
Lck_1:
    s_waitcnt lgkmcnt(15)
Linfo:
    v_readfirstlane_b32 s39, v8
    s_nop 0
    s_cmp_eq_u32 s39, -2
    s_cbranch_scc1 Linfo_re
    v_mfma_f32_16x16x32_bf16 v[108:111], a[32:35], v[68:71], v[108:111]
    ds_read_b64_tr_b16 a[32:33], v20 offset:32768
    ds_read_b64_tr_b16 a[34:35], v20 offset:33280
    buffer_load_dwordx4 v[100:103], v13, s[28:31], s55 offen offset:2048 sc1
    v_mfma_f32_16x16x32_bf16 v[112:115], a[36:39], v[68:71], v[112:115]
    ds_read_b64_tr_b16 a[36:37], v21 offset:32768
    ds_read_b64_tr_b16 a[38:39], v21 offset:33280
    v_mfma_f32_16x16x32_bf16 v[116:119], a[40:43], v[68:71], v[116:119]
    ds_read_b64_tr_b16 a[40:41], v22 offset:32768
    ds_read_b64_tr_b16 a[42:43], v22 offset:33280
    buffer_load_dwordx4 v[104:107], v13, s[28:31], s55 offen offset:3072 sc1
    v_mfma_f32_16x16x32_bf16 v[14:17], a[44:47], v[68:71], v[14:17]
    ds_read_b64_tr_b16 a[44:45], v23 offset:32768
    ds_read_b64_tr_b16 a[46:47], v23 offset:33280
    v_mfma_f32_16x16x32_bf16 v[108:111], a[48:51], v[72:75], v[108:111]
    ds_read_b64_tr_b16 a[48:49], v20 offset:36864
    ds_read_b64_tr_b16 a[50:51], v20 offset:37376
    s_waitcnt vmcnt(6)
    v_max3_u32 v4, v76, v77, v78
    v_mfma_f32_16x16x32_bf16 v[112:115], a[52:55], v[72:75], v[112:115]
    ds_read_b64_tr_b16 a[52:53], v21 offset:36864
    ds_read_b64_tr_b16 a[54:55], v21 offset:37376
    v_max3_u32 v5, v80, v81, v82
    v_max3_u32 v4, v4, v79, v83
    v_mfma_f32_16x16x32_bf16 v[116:119], a[56:59], v[72:75], v[116:119]
    ds_read_b64_tr_b16 a[56:57], v22 offset:36864
    ds_read_b64_tr_b16 a[58:59], v22 offset:37376
    v_max_u32 v4, v4, v5
    v_cmp_eq_u32 vcc, -1, v4
    v_mfma_f32_16x16x32_bf16 v[14:17], a[60:63], v[72:75], v[14:17]
    ds_read_b64_tr_b16 a[60:61], v23 offset:36864
    ds_read_b64_tr_b16 a[62:63], v23 offset:37376
    s_cbranch_vccnz Lre_2
Lck_2:
    v_mfma_f32_16x16x32_bf16 v[108:111], a[64:67], v[76:79], v[108:111]
    ds_read_b64_tr_b16 a[64:65], v20 offset:40960
    ds_read_b64_tr_b16 a[66:67], v20 offset:41472
    buffer_load_dwordx4 v[60:63], v13, s[28:31], s56 offen offset:0 sc1
    v_mfma_f32_16x16x32_bf16 v[112:115], a[68:71], v[76:79], v[112:115]
    ds_read_b64_tr_b16 a[68:69], v21 offset:40960
    ds_read_b64_tr_b16 a[70:71], v21 offset:41472
    v_mfma_f32_16x16x32_bf16 v[116:119], a[72:75], v[76:79], v[116:119]
    ds_read_b64_tr_b16 a[72:73], v22 offset:40960
    ds_read_b64_tr_b16 a[74:75], v22 offset:41472
    buffer_load_dwordx4 v[64:67], v13, s[28:31], s56 offen offset:1024 sc1
    v_mfma_f32_16x16x32_bf16 v[14:17], a[76:79], v[76:79], v[14:17]
    ds_read_b64_tr_b16 a[76:77], v23 offset:40960
    ds_read_b64_tr_b16 a[78:79], v23 offset:41472
    v_mfma_f32_16x16x32_bf16 v[108:111], a[80:83], v[80:83], v[108:111]
    ds_read_b64_tr_b16 a[80:81], v20 offset:45056
    ds_read_b64_tr_b16 a[82:83], v20 offset:45568
    s_waitcnt vmcnt(6)
    v_max3_u32 v4, v84, v85, v86
    v_mfma_f32_16x16x32_bf16 v[112:115], a[84:87], v[80:83], v[112:115]
    ds_read_b64_tr_b16 a[84:85], v21 offset:45056
    ds_read_b64_tr_b16 a[86:87], v21 offset:45568
    v_max3_u32 v5, v88, v89, v90
    v_max3_u32 v4, v4, v87, v91
    v_mfma_f32_16x16x32_bf16 v[116:119], a[88:91], v[80:83], v[116:119]
    ds_read_b64_tr_b16 a[88:89], v22 offset:45056
    ds_read_b64_tr_b16 a[90:91], v22 offset:45568
    v_max_u32 v4, v4, v5
    v_cmp_eq_u32 vcc, -1, v4
    v_mfma_f32_16x16x32_bf16 v[14:17], a[92:95], v[80:83], v[14:17]
    ds_read_b64_tr_b16 a[92:93], v23 offset:45056
    ds_read_b64_tr_b16 a[94:95], v23 offset:45568
    s_cbranch_vccnz Lre_3
Lck_3:
    s_setprio 2
    v_mfma_f32_16x16x32_bf16 v[108:111], a[96:99], v[84:87], v[108:111]
    ds_read_b64_tr_b16 a[96:97], v24 offset:0
    ds_read_b64_tr_b16 a[98:99], v24 offset:512
    buffer_load_dwordx4 v[68:71], v13, s[28:31], s56 offen offset:2048 sc1
    v_mfma_f32_16x16x32_bf16 v[112:115], a[100:103], v[84:87], v[112:115]
    ds_read_b64_tr_b16 a[100:101], v25 offset:0
    ds_read_b64_tr_b16 a[102:103], v25 offset:512
    v_mfma_f32_16x16x32_bf16 v[116:119], a[104:107], v[84:87], v[116:119]
    ds_read_b64_tr_b16 a[104:105], v26 offset:0
    ds_read_b64_tr_b16 a[106:107], v26 offset:512
    buffer_load_dwordx4 v[72:75], v13, s[28:31], s56 offen offset:3072 sc1
    v_mfma_f32_16x16x32_bf16 v[14:17], a[108:111], v[84:87], v[14:17]
    ds_read_b64_tr_b16 a[108:109], v27 offset:0
    ds_read_b64_tr_b16 a[110:111], v27 offset:512
    v_mfma_f32_16x16x32_bf16 v[108:111], a[112:115], v[88:91], v[108:111]
    ds_read_b64_tr_b16 a[112:113], v24 offset:4096
    ds_read_b64_tr_b16 a[114:115], v24 offset:4608
    s_waitcnt vmcnt(6)
    v_max3_u32 v4, v92, v93, v94
    v_mfma_f32_16x16x32_bf16 v[112:115], a[116:119], v[88:91], v[112:115]
    ds_read_b64_tr_b16 a[116:117], v25 offset:4096
    ds_read_b64_tr_b16 a[118:119], v25 offset:4608
    v_max3_u32 v5, v96, v97, v98
    v_max3_u32 v4, v4, v95, v99
    v_mfma_f32_16x16x32_bf16 v[116:119], a[120:123], v[88:91], v[116:119]
    ds_read_b64_tr_b16 a[120:121], v26 offset:4096
    ds_read_b64_tr_b16 a[122:123], v26 offset:4608
    v_max_u32 v4, v4, v5
    v_cmp_eq_u32 vcc, -1, v4
    v_mfma_f32_16x16x32_bf16 v[14:17], a[124:127], v[88:91], v[14:17]
    ds_read_b64_tr_b16 a[124:125], v27 offset:4096
    ds_read_b64_tr_b16 a[126:127], v27 offset:4608
    s_cbranch_vccnz Lre_4
Lck_4:
    s_waitcnt lgkmcnt(15)
    v_mfma_f32_16x16x32_bf16 v[108:111], a[0:3], v[92:95], v[108:111]
    ds_read_b64_tr_b16 a[0:1], v24 offset:8192
    ds_read_b64_tr_b16 a[2:3], v24 offset:8704
    buffer_load_dwordx4 v[76:79], v13, s[28:31], s57 offen offset:0 sc1
    v_mfma_f32_16x16x32_bf16 v[112:115], a[4:7], v[92:95], v[112:115]
    ds_read_b64_tr_b16 a[4:5], v25 offset:8192
    ds_read_b64_tr_b16 a[6:7], v25 offset:8704
    v_mfma_f32_16x16x32_bf16 v[116:119], a[8:11], v[92:95], v[116:119]
    ds_read_b64_tr_b16 a[8:9], v26 offset:8192
    ds_read_b64_tr_b16 a[10:11], v26 offset:8704
    buffer_load_dwordx4 v[80:83], v13, s[28:31], s57 offen offset:1024 sc1
    v_mfma_f32_16x16x32_bf16 v[14:17], a[12:15], v[92:95], v[14:17]
    ds_read_b64_tr_b16 a[12:13], v27 offset:8192
    ds_read_b64_tr_b16 a[14:15], v27 offset:8704
    v_mfma_f32_16x16x32_bf16 v[108:111], a[16:19], v[96:99], v[108:111]
    ds_read_b64_tr_b16 a[16:17], v24 offset:12288
    ds_read_b64_tr_b16 a[18:19], v24 offset:12800
    s_waitcnt vmcnt(6)
    v_max3_u32 v4, v100, v101, v102
    v_mfma_f32_16x16x32_bf16 v[112:115], a[20:23], v[96:99], v[112:115]
    ds_read_b64_tr_b16 a[20:21], v25 offset:12288
    ds_read_b64_tr_b16 a[22:23], v25 offset:12800
    v_max3_u32 v5, v104, v105, v106
    v_max3_u32 v4, v4, v103, v107
    v_mfma_f32_16x16x32_bf16 v[116:119], a[24:27], v[96:99], v[116:119]
    ds_read_b64_tr_b16 a[24:25], v26 offset:12288
    ds_read_b64_tr_b16 a[26:27], v26 offset:12800
    v_max_u32 v4, v4, v5
    v_cmp_eq_u32 vcc, -1, v4
    v_mfma_f32_16x16x32_bf16 v[14:17], a[28:31], v[96:99], v[14:17]
    ds_read_b64_tr_b16 a[28:29], v27 offset:12288
    ds_read_b64_tr_b16 a[30:31], v27 offset:12800
    s_cbranch_vccnz Lre_5
Lck_5:
    v_mfma_f32_16x16x32_bf16 v[108:111], a[32:35], v[100:103], v[108:111]
    ds_read_b64_tr_b16 a[32:33], v20 offset:49152
    ds_read_b64_tr_b16 a[34:35], v20 offset:49664
    buffer_load_dwordx4 v[84:87], v13, s[28:31], s57 offen offset:2048 sc1
    v_mfma_f32_16x16x32_bf16 v[112:115], a[36:39], v[100:103], v[112:115]
    ds_read_b64_tr_b16 a[36:37], v21 offset:49152
    ds_read_b64_tr_b16 a[38:39], v21 offset:49664
    v_mfma_f32_16x16x32_bf16 v[116:119], a[40:43], v[100:103], v[116:119]
    ds_read_b64_tr_b16 a[40:41], v22 offset:49152
    ds_read_b64_tr_b16 a[42:43], v22 offset:49664
    buffer_load_dwordx4 v[88:91], v13, s[28:31], s57 offen offset:3072 sc1
    v_mfma_f32_16x16x32_bf16 v[14:17], a[44:47], v[100:103], v[14:17]
    ds_read_b64_tr_b16 a[44:45], v23 offset:49152
    ds_read_b64_tr_b16 a[46:47], v23 offset:49664
    v_mfma_f32_16x16x32_bf16 v[108:111], a[48:51], v[104:107], v[108:111]
    ds_read_b64_tr_b16 a[48:49], v24 offset:24576
    ds_read_b64_tr_b16 a[50:51], v24 offset:25088
    s_waitcnt vmcnt(6)
    v_max3_u32 v4, v60, v61, v62
    v_mfma_f32_16x16x32_bf16 v[112:115], a[52:55], v[104:107], v[112:115]
    ds_read_b64_tr_b16 a[52:53], v25 offset:24576
    ds_read_b64_tr_b16 a[54:55], v25 offset:25088
    v_max3_u32 v5, v64, v65, v66
    v_max3_u32 v4, v4, v63, v67
    v_mfma_f32_16x16x32_bf16 v[116:119], a[56:59], v[104:107], v[116:119]
    ds_read_b64_tr_b16 a[56:57], v26 offset:24576
    ds_read_b64_tr_b16 a[58:59], v26 offset:25088
    v_max_u32 v4, v4, v5
    v_cmp_eq_u32 vcc, -1, v4
    v_mfma_f32_16x16x32_bf16 v[14:17], a[60:63], v[104:107], v[14:17]
    ds_read_b64_tr_b16 a[60:61], v27 offset:24576
    ds_read_b64_tr_b16 a[62:63], v27 offset:25088
    s_cbranch_vccnz Lre_6
Lck_6:
    s_setprio 1
    v_mfma_f32_16x16x32_bf16 v[108:111], a[64:67], v[60:63], v[108:111]
    v_mfma_f32_16x16x32_bf16 v[112:115], a[68:71], v[60:63], v[112:115]
    v_mfma_f32_16x16x32_bf16 v[116:119], a[72:75], v[60:63], v[116:119]
    v_mfma_f32_16x16x32_bf16 v[14:17], a[76:79], v[60:63], v[14:17]
    v_mfma_f32_16x16x32_bf16 v[108:111], a[80:83], v[64:67], v[108:111]
    s_waitcnt vmcnt(4)
    v_max3_u32 v4, v68, v69, v70
    v_mfma_f32_16x16x32_bf16 v[112:115], a[84:87], v[64:67], v[112:115]
    v_max3_u32 v5, v72, v73, v74
    v_max3_u32 v4, v4, v71, v75
    v_mfma_f32_16x16x32_bf16 v[116:119], a[88:91], v[64:67], v[116:119]
    v_max_u32 v4, v4, v5
    v_cmp_eq_u32 vcc, -1, v4
    v_mfma_f32_16x16x32_bf16 v[14:17], a[92:95], v[64:67], v[14:17]
    s_cbranch_vccnz Lre_7
Lck_7:
    s_waitcnt lgkmcnt(15)
    v_mfma_f32_16x16x32_bf16 v[108:111], a[96:99], v[68:71], v[108:111]
    v_mfma_f32_16x16x32_bf16 v[112:115], a[100:103], v[68:71], v[112:115]
    v_mfma_f32_16x16x32_bf16 v[116:119], a[104:107], v[68:71], v[116:119]
    v_mfma_f32_16x16x32_bf16 v[14:17], a[108:111], v[68:71], v[14:17]
    v_mfma_f32_16x16x32_bf16 v[108:111], a[112:115], v[72:75], v[108:111]
    s_waitcnt vmcnt(2)
    v_max3_u32 v4, v76, v77, v78
    v_mfma_f32_16x16x32_bf16 v[112:115], a[116:119], v[72:75], v[112:115]
    v_max3_u32 v5, v80, v81, v82
    v_max3_u32 v4, v4, v79, v83
    v_mfma_f32_16x16x32_bf16 v[116:119], a[120:123], v[72:75], v[116:119]
    v_max_u32 v4, v4, v5
    v_cmp_eq_u32 vcc, -1, v4
    v_mfma_f32_16x16x32_bf16 v[14:17], a[124:127], v[72:75], v[14:17]
    s_cbranch_vccnz Lre_8
Lck_8:
    s_setprio 0
    v_mfma_f32_16x16x32_bf16 v[108:111], a[0:3], v[76:79], v[108:111]
    v_mfma_f32_16x16x32_bf16 v[112:115], a[4:7], v[76:79], v[112:115]
    v_mfma_f32_16x16x32_bf16 v[116:119], a[8:11], v[76:79], v[116:119]
    v_mfma_f32_16x16x32_bf16 v[14:17], a[12:15], v[76:79], v[14:17]
    v_mfma_f32_16x16x32_bf16 v[108:111], a[16:19], v[80:83], v[108:111]
    s_waitcnt vmcnt(0)
    v_max3_u32 v4, v84, v85, v86
    v_mfma_f32_16x16x32_bf16 v[112:115], a[20:23], v[80:83], v[112:115]
    v_max3_u32 v5, v88, v89, v90
    v_max3_u32 v4, v4, v87, v91
    v_mfma_f32_16x16x32_bf16 v[116:119], a[24:27], v[80:83], v[116:119]
    v_max_u32 v4, v4, v5
    v_cmp_eq_u32 vcc, -1, v4
    v_mfma_f32_16x16x32_bf16 v[14:17], a[28:31], v[80:83], v[14:17]
    s_cbranch_vccnz Lre_9
Lck_9:
    s_waitcnt lgkmcnt(8)
    v_mfma_f32_16x16x32_bf16 v[108:111], a[32:35], v[84:87], v[108:111]
    v_mfma_f32_16x16x32_bf16 v[112:115], a[36:39], v[84:87], v[112:115]
    v_mfma_f32_16x16x32_bf16 v[116:119], a[40:43], v[84:87], v[116:119]
    v_mfma_f32_16x16x32_bf16 v[14:17], a[44:47], v[84:87], v[14:17]
    s_waitcnt lgkmcnt(0)
    v_mfma_f32_16x16x32_bf16 v[108:111], a[48:51], v[88:91], v[108:111]
    v_mfma_f32_16x16x32_bf16 v[112:115], a[52:55], v[88:91], v[112:115]
    v_mfma_f32_16x16x32_bf16 v[116:119], a[56:59], v[88:91], v[116:119]
    v_mfma_f32_16x16x32_bf16 v[14:17], a[60:63], v[88:91], v[14:17]
    v_xor_b32 v60, 32, v124
    v_xor_b32 v61, 64, v124
    v_xor_b32 v62, 96, v124
    v_cmp_eq_u32 s[36:37], v8, v126
    v_cmp_eq_u32 s[38:39], v9, v126
    s_nop 0
    s_or_b64 vcc, s[36:37], s[38:39]
    s_cbranch_scc1 Lfix
Lnofix:
    v_fma_f32 v108, v108, v44, v28
    v_fma_f32 v109, v109, v45, v29
    v_fma_f32 v110, v110, v46, v30
    v_fma_f32 v111, v111, v47, v31
    v_cvt_pk_bf16_f32 v68, v108, v109
    v_cvt_pk_bf16_f32 v69, v110, v111
    ds_write_b64 v124, v[68:69]
    v_fma_f32 v112, v112, v48, v32
    v_fma_f32 v113, v113, v49, v33
    v_fma_f32 v114, v114, v50, v34
    v_fma_f32 v115, v115, v51, v35
    v_cvt_pk_bf16_f32 v70, v112, v113
    v_cvt_pk_bf16_f32 v71, v114, v115
    ds_write_b64 v60, v[70:71]
    v_fma_f32 v116, v116, v52, v36
    v_fma_f32 v117, v117, v53, v37
    v_fma_f32 v118, v118, v54, v38
    v_fma_f32 v119, v119, v55, v39
    v_cvt_pk_bf16_f32 v72, v116, v117
    v_cvt_pk_bf16_f32 v73, v118, v119
    ds_write_b64 v61, v[72:73]
    v_fma_f32 v14, v14, v56, v40
    v_fma_f32 v15, v15, v57, v41
    v_fma_f32 v16, v16, v58, v42
    v_fma_f32 v17, v17, v59, v43
    v_cvt_pk_bf16_f32 v74, v14, v15
    v_cvt_pk_bf16_f32 v75, v16, v17
    ds_write_b64 v62, v[74:75]
    ds_read_b128 v[76:79], v125 offset:0
    ds_read_b128 v[80:83], v125 offset:1024
    s_waitcnt lgkmcnt(1)
    buffer_store_dwordx4 v[76:79], v122, s[48:51], s24 offen sc0 sc1
    s_waitcnt lgkmcnt(0)
    buffer_store_dwordx4 v[80:83], v123, s[48:51], s24 offen sc0 sc1
    s_endpgm
Lh1:
    ds_write_b128 v125, v[44:47] offset:0
    ds_write_b128 v125, v[48:51] offset:1024
    v_mov_b32 v5, 157972
    v_mov_b32 v6, 1
    s_mov_b64 exec, 1
    ds_add_u32 v5, v6
    s_mov_b64 exec, -1
    v_fmac_f32 v28, v76, v120
    v_fmac_f32 v29, v77, v120
    v_fmac_f32 v30, v78, v120
    v_fmac_f32 v31, v79, v120
    v_cvt_pk_bf16_f32 v28, v28, v29
    v_cvt_pk_bf16_f32 v29, v30, v31
    v_fmac_f32 v32, v80, v120
    v_fmac_f32 v33, v81, v120
    v_fmac_f32 v34, v82, v120
    v_fmac_f32 v35, v83, v120
    v_cvt_pk_bf16_f32 v30, v32, v33
    v_cvt_pk_bf16_f32 v31, v34, v35
    v_fmac_f32 v36, v84, v120
    v_fmac_f32 v37, v85, v120
    v_fmac_f32 v38, v86, v120
    v_fmac_f32 v39, v87, v120
    v_cvt_pk_bf16_f32 v32, v36, v37
    v_cvt_pk_bf16_f32 v33, v38, v39
    v_fmac_f32 v40, v88, v120
    v_fmac_f32 v41, v89, v120
    v_fmac_f32 v42, v90, v120
    v_fmac_f32 v43, v91, v120
    v_cvt_pk_bf16_f32 v34, v40, v41
    v_cvt_pk_bf16_f32 v35, v42, v43
    v_subrev_u32 v4, 6144, v125
    v_mov_b32 v8, s22
    v_mov_b32 v9, s22
    v_mov_b32 v10, s22
    v_mov_b32 v11, s22
Lcw_2:
    s_sub_u32 s35, s35, 1
    s_cbranch_scc1 Lend
    ds_read_b32 v6, v5
    s_waitcnt lgkmcnt(0)
    v_readfirstlane_b32 s38, v6
    s_nop 0
    s_cmp_lt_u32 s38, 8
    s_cbranch_scc1 Lcw_2
    ds_read_b128 v[52:55], v125 offset:2048
    ds_read_b128 v[56:59], v125 offset:3072
    ds_read_b128 v[44:47], v4 offset:4096
    ds_read_b128 v[48:51], v4 offset:5120
    s_branch Lh_join
Lqf_re:
    s_sub_u32 s35, s35, 1
    s_cbranch_scc1 Lend
    ds_read_b32 v7, v96
    ds_read_b128 v[76:79], v95 offset:0
    ds_read_b128 v[80:83], v95 offset:64
    ds_read_b128 v[84:87], v95 offset:128
    ds_read_b128 v[88:91], v95 offset:192
    s_waitcnt lgkmcnt(0)
    s_branch Lqf
Lcsv_re:
    s_sub_u32 s35, s35, 1
    s_cbranch_scc1 Lend
    ds_read_b32 v46, v49
    ds_read_b64 v[44:45], v48
    s_waitcnt lgkmcnt(0)
    s_branch Lcsv
Lrx_re:
    s_sub_u32 s35, s35, 1
    s_cbranch_scc1 Lend
    buffer_load_dwordx2 v[52:53], v13, s[28:31], s59 offen offset:8 sc1
    buffer_load_dwordx2 v[54:55], v13, s[28:31], s60 offen offset:0 sc1
    s_waitcnt vmcnt(0)
    s_branch Lrx_chk
Linfo_re:
    s_sub_u32 s35, s35, 1
    s_cbranch_scc1 Lend
    ds_read_b64 v[8:9], v10
    s_waitcnt lgkmcnt(0)
    s_branch Linfo
Lfl_re:
    s_sub_u32 s35, s35, 1
    s_cbranch_scc1 Lend
    buffer_load_dword v20, v12, s[28:31], s24 offen sc1
    s_waitcnt vmcnt(0)
    s_branch Lfl_chk
Lxe0:
    ds_read_b64 v[108:109], v4
    ds_read_b64 v[110:111], v5
    ds_read_b64 v[112:113], v6
    ds_read_b64 v[114:115], v7
    s_branch Lxe0_b
Lxe1:
    ds_read_b64 v[108:109], v4
    ds_read_b64 v[110:111], v5
    ds_read_b64 v[112:113], v6
    ds_read_b64 v[114:115], v7
    s_branch Lxe1_b
Lxe2:
    ds_read_b64 v[108:109], v4
    ds_read_b64 v[110:111], v5
    ds_read_b64 v[112:113], v6
    ds_read_b64 v[114:115], v7
    s_branch Lxe2_b
Lxe3:
    ds_read_b64 v[108:109], v4
    ds_read_b64 v[110:111], v5
    ds_read_b64 v[112:113], v6
    ds_read_b64 v[114:115], v7
    s_branch Lxe3_b
Lxe4:
    ds_read_b64 v[108:109], v4
    ds_read_b64 v[110:111], v5
    ds_read_b64 v[112:113], v6
    ds_read_b64 v[114:115], v7
    s_branch Lxe4_b
Lxe5:
    ds_read_b64 v[108:109], v4
    ds_read_b64 v[110:111], v5
    ds_read_b64 v[112:113], v6
    ds_read_b64 v[114:115], v7
    s_branch Lxe5_b
Lxe6:
    ds_read_b64 v[108:109], v4
    ds_read_b64 v[110:111], v5
    ds_read_b64 v[112:113], v6
    ds_read_b64 v[114:115], v7
    s_branch Lxe6_b
Lxe7:
    ds_read_b64 v[108:109], v4
    ds_read_b64 v[110:111], v5
    ds_read_b64 v[112:113], v6
    ds_read_b64 v[114:115], v7
    s_branch Lxe7_b
Lxe8:
    ds_read_b64 v[108:109], v4
    ds_read_b64 v[110:111], v5
    ds_read_b64 v[112:113], v6
    ds_read_b64 v[114:115], v7
    s_branch Lxe8_b
Lxe9:
    ds_read_b64 v[108:109], v4
    ds_read_b64 v[110:111], v5
    ds_read_b64 v[112:113], v6
    ds_read_b64 v[114:115], v7
    s_branch Lxe9_b
Lre_0:
    s_mov_b32 s41, 1
    s_sub_u32 s35, s35, 1
    s_cbranch_scc1 Lend
    s_sleep 2
    buffer_load_dwordx4 v[60:63], v13, s[28:31], s53 offen offset:0 sc1
    buffer_load_dwordx4 v[64:67], v13, s[28:31], s53 offen offset:1024 sc1
    s_waitcnt vmcnt(0)
    v_max3_u32 v4, v60, v61, v62
    v_max3_u32 v5, v64, v65, v66
    v_max3_u32 v4, v4, v63, v67
    v_max_u32 v4, v4, v5
    v_cmp_eq_u32 vcc, -1, v4
    s_nop 0
    s_cbranch_vccnz Lre_0
    buffer_load_dwordx4 v[68:71], v13, s[28:31], s53 offen offset:2048 sc1
    buffer_load_dwordx4 v[72:75], v13, s[28:31], s53 offen offset:3072 sc1
    buffer_load_dwordx4 v[76:79], v13, s[28:31], s54 offen offset:0 sc1
    buffer_load_dwordx4 v[80:83], v13, s[28:31], s54 offen offset:1024 sc1
    buffer_load_dwordx4 v[84:87], v13, s[28:31], s54 offen offset:2048 sc1
    buffer_load_dwordx4 v[88:91], v13, s[28:31], s54 offen offset:3072 sc1
    s_branch Lck_0
Lre_1:
    s_mov_b32 s41, 1
    s_sub_u32 s35, s35, 1
    s_cbranch_scc1 Lend
    s_sleep 2
    buffer_load_dwordx4 v[68:71], v13, s[28:31], s53 offen offset:2048 sc1
    buffer_load_dwordx4 v[72:75], v13, s[28:31], s53 offen offset:3072 sc1
    s_waitcnt vmcnt(0)
    v_max3_u32 v4, v68, v69, v70
    v_max3_u32 v5, v72, v73, v74
    v_max3_u32 v4, v4, v71, v75
    v_max_u32 v4, v4, v5
    v_cmp_eq_u32 vcc, -1, v4
    s_nop 0
    s_cbranch_vccnz Lre_1
    buffer_load_dwordx4 v[76:79], v13, s[28:31], s54 offen offset:0 sc1
    buffer_load_dwordx4 v[80:83], v13, s[28:31], s54 offen offset:1024 sc1
    buffer_load_dwordx4 v[84:87], v13, s[28:31], s54 offen offset:2048 sc1
    buffer_load_dwordx4 v[88:91], v13, s[28:31], s54 offen offset:3072 sc1
    buffer_load_dwordx4 v[92:95], v13, s[28:31], s55 offen offset:0 sc1
    buffer_load_dwordx4 v[96:99], v13, s[28:31], s55 offen offset:1024 sc1
    s_branch Lck_1
Lre_2:
    s_mov_b32 s41, 1
    s_sub_u32 s35, s35, 1
    s_cbranch_scc1 Lend
    s_sleep 2
    buffer_load_dwordx4 v[76:79], v13, s[28:31], s54 offen offset:0 sc1
    buffer_load_dwordx4 v[80:83], v13, s[28:31], s54 offen offset:1024 sc1
    s_waitcnt vmcnt(0)
    v_max3_u32 v4, v76, v77, v78
    v_max3_u32 v5, v80, v81, v82
    v_max3_u32 v4, v4, v79, v83
    v_max_u32 v4, v4, v5
    v_cmp_eq_u32 vcc, -1, v4
    s_nop 0
    s_cbranch_vccnz Lre_2
    buffer_load_dwordx4 v[84:87], v13, s[28:31], s54 offen offset:2048 sc1
    buffer_load_dwordx4 v[88:91], v13, s[28:31], s54 offen offset:3072 sc1
    buffer_load_dwordx4 v[92:95], v13, s[28:31], s55 offen offset:0 sc1
    buffer_load_dwordx4 v[96:99], v13, s[28:31], s55 offen offset:1024 sc1
    buffer_load_dwordx4 v[100:103], v13, s[28:31], s55 offen offset:2048 sc1
    buffer_load_dwordx4 v[104:107], v13, s[28:31], s55 offen offset:3072 sc1
    s_branch Lck_2
Lre_3:
    s_mov_b32 s41, 1
    s_sub_u32 s35, s35, 1
    s_cbranch_scc1 Lend
    s_sleep 2
    buffer_load_dwordx4 v[84:87], v13, s[28:31], s54 offen offset:2048 sc1
    buffer_load_dwordx4 v[88:91], v13, s[28:31], s54 offen offset:3072 sc1
    s_waitcnt vmcnt(0)
    v_max3_u32 v4, v84, v85, v86
    v_max3_u32 v5, v88, v89, v90
    v_max3_u32 v4, v4, v87, v91
    v_max_u32 v4, v4, v5
    v_cmp_eq_u32 vcc, -1, v4
    s_nop 0
    s_cbranch_vccnz Lre_3
    buffer_load_dwordx4 v[92:95], v13, s[28:31], s55 offen offset:0 sc1
    buffer_load_dwordx4 v[96:99], v13, s[28:31], s55 offen offset:1024 sc1
    buffer_load_dwordx4 v[100:103], v13, s[28:31], s55 offen offset:2048 sc1
    buffer_load_dwordx4 v[104:107], v13, s[28:31], s55 offen offset:3072 sc1
    buffer_load_dwordx4 v[60:63], v13, s[28:31], s56 offen offset:0 sc1
    buffer_load_dwordx4 v[64:67], v13, s[28:31], s56 offen offset:1024 sc1
    s_branch Lck_3
Lre_4:
    s_mov_b32 s41, 1
    s_sub_u32 s35, s35, 1
    s_cbranch_scc1 Lend
    s_sleep 2
    buffer_load_dwordx4 v[92:95], v13, s[28:31], s55 offen offset:0 sc1
    buffer_load_dwordx4 v[96:99], v13, s[28:31], s55 offen offset:1024 sc1
    s_waitcnt vmcnt(0)
    v_max3_u32 v4, v92, v93, v94
    v_max3_u32 v5, v96, v97, v98
    v_max3_u32 v4, v4, v95, v99
    v_max_u32 v4, v4, v5
    v_cmp_eq_u32 vcc, -1, v4
    s_nop 0
    s_cbranch_vccnz Lre_4
    buffer_load_dwordx4 v[100:103], v13, s[28:31], s55 offen offset:2048 sc1
    buffer_load_dwordx4 v[104:107], v13, s[28:31], s55 offen offset:3072 sc1
    buffer_load_dwordx4 v[60:63], v13, s[28:31], s56 offen offset:0 sc1
    buffer_load_dwordx4 v[64:67], v13, s[28:31], s56 offen offset:1024 sc1
    buffer_load_dwordx4 v[68:71], v13, s[28:31], s56 offen offset:2048 sc1
    buffer_load_dwordx4 v[72:75], v13, s[28:31], s56 offen offset:3072 sc1
    s_branch Lck_4
Lre_5:
    s_mov_b32 s41, 1
    s_sub_u32 s35, s35, 1
    s_cbranch_scc1 Lend
    s_sleep 2
    buffer_load_dwordx4 v[100:103], v13, s[28:31], s55 offen offset:2048 sc1
    buffer_load_dwordx4 v[104:107], v13, s[28:31], s55 offen offset:3072 sc1
    s_waitcnt vmcnt(0)
    v_max3_u32 v4, v100, v101, v102
    v_max3_u32 v5, v104, v105, v106
    v_max3_u32 v4, v4, v103, v107
    v_max_u32 v4, v4, v5
    v_cmp_eq_u32 vcc, -1, v4
    s_nop 0
    s_cbranch_vccnz Lre_5
    buffer_load_dwordx4 v[60:63], v13, s[28:31], s56 offen offset:0 sc1
    buffer_load_dwordx4 v[64:67], v13, s[28:31], s56 offen offset:1024 sc1
    buffer_load_dwordx4 v[68:71], v13, s[28:31], s56 offen offset:2048 sc1
    buffer_load_dwordx4 v[72:75], v13, s[28:31], s56 offen offset:3072 sc1
    buffer_load_dwordx4 v[76:79], v13, s[28:31], s57 offen offset:0 sc1
    buffer_load_dwordx4 v[80:83], v13, s[28:31], s57 offen offset:1024 sc1
    s_branch Lck_5
Lre_6:
    s_mov_b32 s41, 1
    s_sub_u32 s35, s35, 1
    s_cbranch_scc1 Lend
    s_sleep 2
    buffer_load_dwordx4 v[60:63], v13, s[28:31], s56 offen offset:0 sc1
    buffer_load_dwordx4 v[64:67], v13, s[28:31], s56 offen offset:1024 sc1
    s_waitcnt vmcnt(0)
    v_max3_u32 v4, v60, v61, v62
    v_max3_u32 v5, v64, v65, v66
    v_max3_u32 v4, v4, v63, v67
    v_max_u32 v4, v4, v5
    v_cmp_eq_u32 vcc, -1, v4
    s_nop 0
    s_cbranch_vccnz Lre_6
    buffer_load_dwordx4 v[68:71], v13, s[28:31], s56 offen offset:2048 sc1
    buffer_load_dwordx4 v[72:75], v13, s[28:31], s56 offen offset:3072 sc1
    buffer_load_dwordx4 v[76:79], v13, s[28:31], s57 offen offset:0 sc1
    buffer_load_dwordx4 v[80:83], v13, s[28:31], s57 offen offset:1024 sc1
    buffer_load_dwordx4 v[84:87], v13, s[28:31], s57 offen offset:2048 sc1
    buffer_load_dwordx4 v[88:91], v13, s[28:31], s57 offen offset:3072 sc1
    s_branch Lck_6
Lre_7:
    s_mov_b32 s41, 1
    s_sub_u32 s35, s35, 1
    s_cbranch_scc1 Lend
    s_sleep 2
    buffer_load_dwordx4 v[68:71], v13, s[28:31], s56 offen offset:2048 sc1
    buffer_load_dwordx4 v[72:75], v13, s[28:31], s56 offen offset:3072 sc1
    s_waitcnt vmcnt(0)
    v_max3_u32 v4, v68, v69, v70
    v_max3_u32 v5, v72, v73, v74
    v_max3_u32 v4, v4, v71, v75
    v_max_u32 v4, v4, v5
    v_cmp_eq_u32 vcc, -1, v4
    s_nop 0
    s_cbranch_vccnz Lre_7
    buffer_load_dwordx4 v[76:79], v13, s[28:31], s57 offen offset:0 sc1
    buffer_load_dwordx4 v[80:83], v13, s[28:31], s57 offen offset:1024 sc1
    buffer_load_dwordx4 v[84:87], v13, s[28:31], s57 offen offset:2048 sc1
    buffer_load_dwordx4 v[88:91], v13, s[28:31], s57 offen offset:3072 sc1
    s_branch Lck_7
Lre_8:
    s_mov_b32 s41, 1
    s_sub_u32 s35, s35, 1
    s_cbranch_scc1 Lend
    s_sleep 2
    buffer_load_dwordx4 v[76:79], v13, s[28:31], s57 offen offset:0 sc1
    buffer_load_dwordx4 v[80:83], v13, s[28:31], s57 offen offset:1024 sc1
    s_waitcnt vmcnt(0)
    v_max3_u32 v4, v76, v77, v78
    v_max3_u32 v5, v80, v81, v82
    v_max3_u32 v4, v4, v79, v83
    v_max_u32 v4, v4, v5
    v_cmp_eq_u32 vcc, -1, v4
    s_nop 0
    s_cbranch_vccnz Lre_8
    buffer_load_dwordx4 v[84:87], v13, s[28:31], s57 offen offset:2048 sc1
    buffer_load_dwordx4 v[88:91], v13, s[28:31], s57 offen offset:3072 sc1
    s_branch Lck_8
Lre_9:
    s_mov_b32 s41, 1
    s_sub_u32 s35, s35, 1
    s_cbranch_scc1 Lend
    s_sleep 2
    buffer_load_dwordx4 v[84:87], v13, s[28:31], s57 offen offset:2048 sc1
    buffer_load_dwordx4 v[88:91], v13, s[28:31], s57 offen offset:3072 sc1
    s_waitcnt vmcnt(0)
    v_max3_u32 v4, v84, v85, v86
    v_max3_u32 v5, v88, v89, v90
    v_max3_u32 v4, v4, v87, v91
    v_max_u32 v4, v4, v5
    v_cmp_eq_u32 vcc, -1, v4
    s_nop 0
    s_cbranch_vccnz Lre_9
    s_branch Lck_9
Lfix:
    s_mov_b64 vcc, s[38:39]
    v_lshlrev_b32 v6, 4, v2
    v_add_u32 v6, 158208, v6
    v_mov_b32 v10, 157956
Lcw_5:
    s_sub_u32 s35, s35, 1
    s_cbranch_scc1 Lend
    ds_read_b32 v11, v10
    s_waitcnt lgkmcnt(0)
    v_readfirstlane_b32 s38, v11
    s_nop 0
    s_cmp_lt_u32 s38, 1
    s_cbranch_scc1 Lcw_5
    s_mov_b64 exec, s[36:37]
    ds_read_b128 v[44:47], v6 offset:0
    ds_read_b128 v[48:51], v6 offset:64
    ds_read_b128 v[52:55], v6 offset:128
    ds_read_b128 v[56:59], v6 offset:192
    s_mov_b64 exec, vcc
    ds_read_b128 v[44:47], v6 offset:256
    ds_read_b128 v[48:51], v6 offset:320
    ds_read_b128 v[52:55], v6 offset:384
    ds_read_b128 v[56:59], v6 offset:448
    s_mov_b64 exec, -1
    s_waitcnt lgkmcnt(0)
    s_branch Lnofix
Lhalo:
    s_mov_b32 vcc_lo, 0x00010001
    s_mov_b32 vcc_hi, 0x00010001
    v_mov_b32 v11, 38912
    v_cndmask_b32 v76, v76, v11, vcc
    v_xor_b32 v77, 64, v76
    v_add_u32 v80, 78080, v76
    v_add_u32 v81, 78080, v77
    v_mov_b32 v14, 0x3f803f80
    v_mov_b32 v15, 0x3f803f80
    v_mov_b32 v16, 0x3f803f80
    v_mov_b32 v17, 0x3f803f80
    v_and_b32 v4, 7, v1
    v_lshlrev_b32 v4, 4, v4
    v_mul_u32_u24 v5, 39040, v2
    v_add_u32 v4, v4, v5
    ds_write_b128 v4, v[14:17] offset:38912
    v_mov_b32 v4, 157952
    v_mov_b32 v8, 0
    v_mov_b32 v9, 0
    v_mov_b32 v10, -2
    v_mov_b32 v11, -2
    ds_write_b128 v4, v[8:11]
    v_min_u32 v5, 23, v1
    v_lshl_add_u32 v5, v5, 2, v4
    ds_write_b32 v5, v8 offset:16
    s_mul_i32 s36, s32, 96
    s_sub_u32 s36, s36, 16
    v_add_u32 v96, s36, v1
    v_min_u32 v5, 47, v1
    v_add3_u32 v97, s36, v5, 64
    v_mov_b32 v6, 2047
    v_med3_i32 v96, v96, 0, v6
    v_med3_i32 v97, v97, 0, v6
    v_lshlrev_b32 v96, 3, v96
    v_lshlrev_b32 v97, 3, v97
    s_mov_b32 s46, 8192000
    v_mov_b32 v127, 157984
    s_lshl_b32 s36, s3, 2
    s_add_u32 s36, s36, 158016
    v_mov_b32 v10, s36
    s_mov_b32 vcc_lo, 0x00010001
    s_mov_b32 vcc_hi, 0x00010001
    v_cndmask_b32 v116, 0, v14, vcc
    v_cndmask_b32 v117, 0, v15, vcc
    v_cndmask_b32 v118, 0, v16, vcc
    v_cndmask_b32 v119, 0, v17, vcc
    s_waitcnt vmcnt(0)
    s_waitcnt lgkmcnt(0)
    s_barrier
    s_add_u32 s34, s34, 0x9e3779b8
    s_or_b32 s34, s34, 1
    ds_read_b128 v[108:111], v76 offset:0
    ds_read_b128 v[112:115], v77 offset:0
    ds_read_b64_tr_b16 a[0:1], v20 offset:0
    ds_read_b64_tr_b16 a[2:3], v20 offset:512
    ds_read_b64_tr_b16 a[4:5], v21 offset:0
    ds_read_b64_tr_b16 a[6:7], v21 offset:512
    ds_read_b64_tr_b16 a[8:9], v22 offset:0
    ds_read_b64_tr_b16 a[10:11], v22 offset:512
    ds_read_b64_tr_b16 a[12:13], v23 offset:0
    ds_read_b64_tr_b16 a[14:15], v23 offset:512
    ds_read_b64_tr_b16 a[16:17], v20 offset:8192
    ds_read_b64_tr_b16 a[18:19], v20 offset:8704
    ds_read_b64_tr_b16 a[20:21], v21 offset:8192
    ds_read_b64_tr_b16 a[22:23], v21 offset:8704
    ds_read_b64_tr_b16 a[24:25], v22 offset:8192
    ds_read_b64_tr_b16 a[26:27], v22 offset:8704
    s_waitcnt lgkmcnt(12)
    v_mfma_f32_16x16x32_bf16 v[28:31], a[0:3], v[116:119], 0
    ds_read_b64_tr_b16 a[28:29], v23 offset:8192
    ds_read_b64_tr_b16 a[30:31], v23 offset:8704
    s_waitcnt lgkmcnt(12)
    v_mfma_f32_16x16x32_bf16 v[32:35], a[4:7], v[116:119], 0
    ds_read_b64_tr_b16 a[32:33], v20 offset:16384
    ds_read_b64_tr_b16 a[34:35], v20 offset:16896
    s_waitcnt lgkmcnt(12)
    v_mfma_f32_16x16x32_bf16 v[36:39], a[8:11], v[116:119], 0
    ds_read_b64_tr_b16 a[36:37], v21 offset:16384
    ds_read_b64_tr_b16 a[38:39], v21 offset:16896
    s_waitcnt lgkmcnt(12)
    v_mfma_f32_16x16x32_bf16 v[40:43], a[12:15], v[116:119], 0
    ds_read_b64_tr_b16 a[40:41], v22 offset:16384
    ds_read_b64_tr_b16 a[42:43], v22 offset:16896
    s_waitcnt lgkmcnt(12)
    v_mfma_f32_16x16x32_bf16 v[44:47], a[16:19], v[108:111], 0
    ds_read_b64_tr_b16 a[44:45], v23 offset:16384
    ds_read_b64_tr_b16 a[46:47], v23 offset:16896
    s_waitcnt lgkmcnt(12)
    v_mfma_f32_16x16x32_bf16 v[48:51], a[20:23], v[108:111], 0
    ds_read_b64_tr_b16 a[48:49], v20 offset:4096
    ds_read_b64_tr_b16 a[50:51], v20 offset:4608
    s_waitcnt lgkmcnt(12)
    v_mfma_f32_16x16x32_bf16 v[52:55], a[24:27], v[108:111], 0
    ds_read_b64_tr_b16 a[52:53], v21 offset:4096
    ds_read_b64_tr_b16 a[54:55], v21 offset:4608
    s_waitcnt lgkmcnt(12)
    v_mfma_f32_16x16x32_bf16 v[56:59], a[28:31], v[108:111], 0
    ds_read_b64_tr_b16 a[56:57], v22 offset:4096
    ds_read_b64_tr_b16 a[58:59], v22 offset:4608
    s_waitcnt lgkmcnt(12)
    v_mfma_f32_16x16x32_bf16 v[60:63], v[108:111], a[32:35], 0
    ds_read_b64_tr_b16 a[60:61], v23 offset:4096
    ds_read_b64_tr_b16 a[62:63], v23 offset:4608
    s_waitcnt lgkmcnt(12)
    v_mfma_f32_16x16x32_bf16 v[64:67], v[108:111], a[36:39], 0
    ds_read_b64_tr_b16 a[64:65], v20 offset:12288
    ds_read_b64_tr_b16 a[66:67], v20 offset:12800
    s_waitcnt lgkmcnt(12)
    v_mfma_f32_16x16x32_bf16 v[68:71], v[108:111], a[40:43], 0
    ds_read_b64_tr_b16 a[68:69], v21 offset:12288
    ds_read_b64_tr_b16 a[70:71], v21 offset:12800
    s_waitcnt lgkmcnt(12)
    v_mfma_f32_16x16x32_bf16 v[72:75], v[108:111], a[44:47], 0
    ds_read_b64_tr_b16 a[72:73], v22 offset:12288
    ds_read_b64_tr_b16 a[74:75], v22 offset:12800
    s_waitcnt lgkmcnt(12)
    v_mfma_f32_16x16x32_bf16 v[28:31], a[48:51], v[116:119], v[28:31]
    ds_read_b64_tr_b16 a[76:77], v23 offset:12288
    ds_read_b64_tr_b16 a[78:79], v23 offset:12800
    s_waitcnt lgkmcnt(12)
    v_mfma_f32_16x16x32_bf16 v[32:35], a[52:55], v[116:119], v[32:35]
    ds_read_b64_tr_b16 a[80:81], v20 offset:20480
    ds_read_b64_tr_b16 a[82:83], v20 offset:20992
    s_waitcnt lgkmcnt(12)
    v_mfma_f32_16x16x32_bf16 v[36:39], a[56:59], v[116:119], v[36:39]
    ds_read_b64_tr_b16 a[84:85], v21 offset:20480
    ds_read_b64_tr_b16 a[86:87], v21 offset:20992
    s_waitcnt lgkmcnt(12)
    v_mfma_f32_16x16x32_bf16 v[40:43], a[60:63], v[116:119], v[40:43]
    ds_read_b64_tr_b16 a[88:89], v22 offset:20480
    ds_read_b64_tr_b16 a[90:91], v22 offset:20992
    s_waitcnt lgkmcnt(12)
    v_mfma_f32_16x16x32_bf16 v[44:47], a[64:67], v[112:115], v[44:47]
    ds_read_b64_tr_b16 a[92:93], v23 offset:20480
    ds_read_b64_tr_b16 a[94:95], v23 offset:20992
    s_waitcnt lgkmcnt(12)
    v_mfma_f32_16x16x32_bf16 v[48:51], a[68:71], v[112:115], v[48:51]
    s_waitcnt lgkmcnt(10)
    v_mfma_f32_16x16x32_bf16 v[52:55], a[72:75], v[112:115], v[52:55]
    s_waitcnt lgkmcnt(8)
    v_mfma_f32_16x16x32_bf16 v[56:59], a[76:79], v[112:115], v[56:59]
    s_waitcnt lgkmcnt(6)
    v_mfma_f32_16x16x32_bf16 v[60:63], v[112:115], a[80:83], v[60:63]
    s_waitcnt lgkmcnt(4)
    v_mfma_f32_16x16x32_bf16 v[64:67], v[112:115], a[84:87], v[64:67]
    s_waitcnt lgkmcnt(2)
    v_mfma_f32_16x16x32_bf16 v[68:71], v[112:115], a[88:91], v[68:71]
    s_waitcnt lgkmcnt(0)
    v_mfma_f32_16x16x32_bf16 v[72:75], v[112:115], a[92:95], v[72:75]
    s_barrier
    ds_read_b128 v[108:111], v76 offset:39040
    ds_read_b128 v[112:115], v77 offset:39040
    ds_read_b64_tr_b16 a[0:1], v20 offset:39040
    ds_read_b64_tr_b16 a[2:3], v20 offset:39552
    ds_read_b64_tr_b16 a[4:5], v21 offset:39040
    ds_read_b64_tr_b16 a[6:7], v21 offset:39552
    ds_read_b64_tr_b16 a[8:9], v22 offset:39040
    ds_read_b64_tr_b16 a[10:11], v22 offset:39552
    ds_read_b64_tr_b16 a[12:13], v23 offset:39040
    ds_read_b64_tr_b16 a[14:15], v23 offset:39552
    ds_read_b64_tr_b16 a[16:17], v20 offset:47232
    ds_read_b64_tr_b16 a[18:19], v20 offset:47744
    ds_read_b64_tr_b16 a[20:21], v21 offset:47232
    ds_read_b64_tr_b16 a[22:23], v21 offset:47744
    ds_read_b64_tr_b16 a[24:25], v22 offset:47232
    ds_read_b64_tr_b16 a[26:27], v22 offset:47744
    s_waitcnt lgkmcnt(12)
    v_mfma_f32_16x16x32_bf16 v[28:31], a[0:3], v[116:119], v[28:31]
    ds_read_b64_tr_b16 a[28:29], v23 offset:47232
    ds_read_b64_tr_b16 a[30:31], v23 offset:47744
    s_waitcnt lgkmcnt(12)
    v_mfma_f32_16x16x32_bf16 v[32:35], a[4:7], v[116:119], v[32:35]
    ds_read_b64_tr_b16 a[32:33], v20 offset:55424
    ds_read_b64_tr_b16 a[34:35], v20 offset:55936
    s_waitcnt lgkmcnt(12)
    v_mfma_f32_16x16x32_bf16 v[36:39], a[8:11], v[116:119], v[36:39]
    ds_read_b64_tr_b16 a[36:37], v21 offset:55424
    ds_read_b64_tr_b16 a[38:39], v21 offset:55936
    s_waitcnt lgkmcnt(12)
    v_mfma_f32_16x16x32_bf16 v[40:43], a[12:15], v[116:119], v[40:43]
    ds_read_b64_tr_b16 a[40:41], v22 offset:55424
    ds_read_b64_tr_b16 a[42:43], v22 offset:55936
    s_waitcnt lgkmcnt(12)
    v_mfma_f32_16x16x32_bf16 v[44:47], a[16:19], v[108:111], v[44:47]
    ds_read_b64_tr_b16 a[44:45], v23 offset:55424
    ds_read_b64_tr_b16 a[46:47], v23 offset:55936
    s_waitcnt lgkmcnt(12)
    v_mfma_f32_16x16x32_bf16 v[48:51], a[20:23], v[108:111], v[48:51]
    ds_read_b64_tr_b16 a[48:49], v20 offset:43136
    ds_read_b64_tr_b16 a[50:51], v20 offset:43648
    s_waitcnt lgkmcnt(12)
    v_mfma_f32_16x16x32_bf16 v[52:55], a[24:27], v[108:111], v[52:55]
    ds_read_b64_tr_b16 a[52:53], v21 offset:43136
    ds_read_b64_tr_b16 a[54:55], v21 offset:43648
    s_waitcnt lgkmcnt(12)
    v_mfma_f32_16x16x32_bf16 v[56:59], a[28:31], v[108:111], v[56:59]
    ds_read_b64_tr_b16 a[56:57], v22 offset:43136
    ds_read_b64_tr_b16 a[58:59], v22 offset:43648
    s_waitcnt lgkmcnt(12)
    v_mfma_f32_16x16x32_bf16 v[60:63], v[108:111], a[32:35], v[60:63]
    ds_read_b64_tr_b16 a[60:61], v23 offset:43136
    ds_read_b64_tr_b16 a[62:63], v23 offset:43648
    s_waitcnt lgkmcnt(12)
    v_mfma_f32_16x16x32_bf16 v[64:67], v[108:111], a[36:39], v[64:67]
    ds_read_b64_tr_b16 a[64:65], v20 offset:51328
    ds_read_b64_tr_b16 a[66:67], v20 offset:51840
    s_waitcnt lgkmcnt(12)
    v_mfma_f32_16x16x32_bf16 v[68:71], v[108:111], a[40:43], v[68:71]
    ds_read_b64_tr_b16 a[68:69], v21 offset:51328
    ds_read_b64_tr_b16 a[70:71], v21 offset:51840
    s_waitcnt lgkmcnt(12)
    v_mfma_f32_16x16x32_bf16 v[72:75], v[108:111], a[44:47], v[72:75]
    ds_read_b64_tr_b16 a[72:73], v22 offset:51328
    ds_read_b64_tr_b16 a[74:75], v22 offset:51840
    s_waitcnt lgkmcnt(12)
    v_mfma_f32_16x16x32_bf16 v[28:31], a[48:51], v[116:119], v[28:31]
    ds_read_b64_tr_b16 a[76:77], v23 offset:51328
    ds_read_b64_tr_b16 a[78:79], v23 offset:51840
    s_waitcnt lgkmcnt(12)
    v_mfma_f32_16x16x32_bf16 v[32:35], a[52:55], v[116:119], v[32:35]
    ds_read_b64_tr_b16 a[80:81], v20 offset:59520
    ds_read_b64_tr_b16 a[82:83], v20 offset:60032
    s_waitcnt lgkmcnt(12)
    v_mfma_f32_16x16x32_bf16 v[36:39], a[56:59], v[116:119], v[36:39]
    ds_read_b64_tr_b16 a[84:85], v21 offset:59520
    ds_read_b64_tr_b16 a[86:87], v21 offset:60032
    s_waitcnt lgkmcnt(12)
    v_mfma_f32_16x16x32_bf16 v[40:43], a[60:63], v[116:119], v[40:43]
    ds_read_b64_tr_b16 a[88:89], v22 offset:59520
    ds_read_b64_tr_b16 a[90:91], v22 offset:60032
    s_waitcnt lgkmcnt(12)
    v_mfma_f32_16x16x32_bf16 v[44:47], a[64:67], v[112:115], v[44:47]
    ds_read_b64_tr_b16 a[92:93], v23 offset:59520
    ds_read_b64_tr_b16 a[94:95], v23 offset:60032
    s_waitcnt lgkmcnt(12)
    v_mfma_f32_16x16x32_bf16 v[48:51], a[68:71], v[112:115], v[48:51]
    s_waitcnt lgkmcnt(10)
    v_mfma_f32_16x16x32_bf16 v[52:55], a[72:75], v[112:115], v[52:55]
    s_waitcnt lgkmcnt(8)
    v_mfma_f32_16x16x32_bf16 v[56:59], a[76:79], v[112:115], v[56:59]
    s_waitcnt lgkmcnt(6)
    v_mfma_f32_16x16x32_bf16 v[60:63], v[112:115], a[80:83], v[60:63]
    s_waitcnt lgkmcnt(4)
    v_mfma_f32_16x16x32_bf16 v[64:67], v[112:115], a[84:87], v[64:67]
    s_waitcnt lgkmcnt(2)
    v_mfma_f32_16x16x32_bf16 v[68:71], v[112:115], a[88:91], v[68:71]
    s_waitcnt lgkmcnt(0)
    v_mfma_f32_16x16x32_bf16 v[72:75], v[112:115], a[92:95], v[72:75]
    s_mov_b64 exec, 1
    s_lshl_b32 s36, s2, 2
    s_add_u32 s36, s36, 8323072
    v_mov_b32 v4, s34
    v_mov_b32 v5, s36
    buffer_store_dword v4, v5, s[28:31], 0 offen sc1
    s_mov_b64 exec, -1
    s_barrier
    ds_read_b128 v[108:111], v80 offset:0
    ds_read_b128 v[112:115], v81 offset:0
    ds_read_b64_tr_b16 a[0:1], v24 offset:0
    ds_read_b64_tr_b16 a[2:3], v24 offset:512
    ds_read_b64_tr_b16 a[4:5], v25 offset:0
    ds_read_b64_tr_b16 a[6:7], v25 offset:512
    ds_read_b64_tr_b16 a[8:9], v26 offset:0
    ds_read_b64_tr_b16 a[10:11], v26 offset:512
    ds_read_b64_tr_b16 a[12:13], v27 offset:0
    ds_read_b64_tr_b16 a[14:15], v27 offset:512
    ds_read_b64_tr_b16 a[16:17], v24 offset:8192
    ds_read_b64_tr_b16 a[18:19], v24 offset:8704
    ds_read_b64_tr_b16 a[20:21], v25 offset:8192
    ds_read_b64_tr_b16 a[22:23], v25 offset:8704
    ds_read_b64_tr_b16 a[24:25], v26 offset:8192
    ds_read_b64_tr_b16 a[26:27], v26 offset:8704
    s_waitcnt lgkmcnt(12)
    v_mfma_f32_16x16x32_bf16 v[28:31], a[0:3], v[116:119], v[28:31]
    ds_read_b64_tr_b16 a[28:29], v27 offset:8192
    ds_read_b64_tr_b16 a[30:31], v27 offset:8704
    s_waitcnt lgkmcnt(12)
    v_mfma_f32_16x16x32_bf16 v[32:35], a[4:7], v[116:119], v[32:35]
    ds_read_b64_tr_b16 a[32:33], v24 offset:16384
    ds_read_b64_tr_b16 a[34:35], v24 offset:16896
    s_waitcnt lgkmcnt(12)
    v_mfma_f32_16x16x32_bf16 v[36:39], a[8:11], v[116:119], v[36:39]
    ds_read_b64_tr_b16 a[36:37], v25 offset:16384
    ds_read_b64_tr_b16 a[38:39], v25 offset:16896
    s_waitcnt lgkmcnt(12)
    v_mfma_f32_16x16x32_bf16 v[40:43], a[12:15], v[116:119], v[40:43]
    ds_read_b64_tr_b16 a[40:41], v26 offset:16384
    ds_read_b64_tr_b16 a[42:43], v26 offset:16896
    s_waitcnt lgkmcnt(12)
    v_mfma_f32_16x16x32_bf16 v[44:47], a[16:19], v[108:111], v[44:47]
    ds_read_b64_tr_b16 a[44:45], v27 offset:16384
    ds_read_b64_tr_b16 a[46:47], v27 offset:16896
    s_waitcnt lgkmcnt(12)
    v_mfma_f32_16x16x32_bf16 v[48:51], a[20:23], v[108:111], v[48:51]
    ds_read_b64_tr_b16 a[48:49], v24 offset:4096
    ds_read_b64_tr_b16 a[50:51], v24 offset:4608
    s_waitcnt lgkmcnt(12)
    v_mfma_f32_16x16x32_bf16 v[52:55], a[24:27], v[108:111], v[52:55]
    ds_read_b64_tr_b16 a[52:53], v25 offset:4096
    ds_read_b64_tr_b16 a[54:55], v25 offset:4608
    s_waitcnt lgkmcnt(12)
    v_mfma_f32_16x16x32_bf16 v[56:59], a[28:31], v[108:111], v[56:59]
    ds_read_b64_tr_b16 a[56:57], v26 offset:4096
    ds_read_b64_tr_b16 a[58:59], v26 offset:4608
    s_waitcnt lgkmcnt(12)
    v_mfma_f32_16x16x32_bf16 v[60:63], v[108:111], a[32:35], v[60:63]
    ds_read_b64_tr_b16 a[60:61], v27 offset:4096
    ds_read_b64_tr_b16 a[62:63], v27 offset:4608
    s_waitcnt lgkmcnt(12)
    v_mfma_f32_16x16x32_bf16 v[64:67], v[108:111], a[36:39], v[64:67]
    ds_read_b64_tr_b16 a[64:65], v24 offset:12288
    ds_read_b64_tr_b16 a[66:67], v24 offset:12800
    s_waitcnt lgkmcnt(12)
    v_mfma_f32_16x16x32_bf16 v[68:71], v[108:111], a[40:43], v[68:71]
    ds_read_b64_tr_b16 a[68:69], v25 offset:12288
    ds_read_b64_tr_b16 a[70:71], v25 offset:12800
    s_waitcnt lgkmcnt(12)
    v_mfma_f32_16x16x32_bf16 v[72:75], v[108:111], a[44:47], v[72:75]
    ds_read_b64_tr_b16 a[72:73], v26 offset:12288
    ds_read_b64_tr_b16 a[74:75], v26 offset:12800
    s_waitcnt lgkmcnt(12)
    v_mfma_f32_16x16x32_bf16 v[28:31], a[48:51], v[116:119], v[28:31]
    ds_read_b64_tr_b16 a[76:77], v27 offset:12288
    ds_read_b64_tr_b16 a[78:79], v27 offset:12800
    s_waitcnt lgkmcnt(12)
    v_mfma_f32_16x16x32_bf16 v[32:35], a[52:55], v[116:119], v[32:35]
    ds_read_b64_tr_b16 a[80:81], v24 offset:20480
    ds_read_b64_tr_b16 a[82:83], v24 offset:20992
    s_waitcnt lgkmcnt(12)
    v_mfma_f32_16x16x32_bf16 v[36:39], a[56:59], v[116:119], v[36:39]
    ds_read_b64_tr_b16 a[84:85], v25 offset:20480
    ds_read_b64_tr_b16 a[86:87], v25 offset:20992
    s_waitcnt lgkmcnt(12)
    v_mfma_f32_16x16x32_bf16 v[40:43], a[60:63], v[116:119], v[40:43]
    ds_read_b64_tr_b16 a[88:89], v26 offset:20480
    ds_read_b64_tr_b16 a[90:91], v26 offset:20992
    s_waitcnt lgkmcnt(12)
    v_mfma_f32_16x16x32_bf16 v[44:47], a[64:67], v[112:115], v[44:47]
    ds_read_b64_tr_b16 a[92:93], v27 offset:20480
    ds_read_b64_tr_b16 a[94:95], v27 offset:20992
    s_waitcnt lgkmcnt(12)
    v_mfma_f32_16x16x32_bf16 v[48:51], a[68:71], v[112:115], v[48:51]
    s_waitcnt lgkmcnt(10)
    v_mfma_f32_16x16x32_bf16 v[52:55], a[72:75], v[112:115], v[52:55]
    s_waitcnt lgkmcnt(8)
    v_mfma_f32_16x16x32_bf16 v[56:59], a[76:79], v[112:115], v[56:59]
    s_waitcnt lgkmcnt(6)
    v_mfma_f32_16x16x32_bf16 v[60:63], v[112:115], a[80:83], v[60:63]
    s_waitcnt lgkmcnt(4)
    v_mfma_f32_16x16x32_bf16 v[64:67], v[112:115], a[84:87], v[64:67]
    s_waitcnt lgkmcnt(2)
    v_mfma_f32_16x16x32_bf16 v[68:71], v[112:115], a[88:91], v[68:71]
    s_waitcnt lgkmcnt(0)
    v_mfma_f32_16x16x32_bf16 v[72:75], v[112:115], a[92:95], v[72:75]
    s_barrier
    ds_read_b128 v[108:111], v80 offset:39040
    ds_read_b128 v[112:115], v81 offset:39040
    ds_read_b64_tr_b16 a[0:1], v24 offset:39040
    ds_read_b64_tr_b16 a[2:3], v24 offset:39552
    ds_read_b64_tr_b16 a[4:5], v25 offset:39040
    ds_read_b64_tr_b16 a[6:7], v25 offset:39552
    ds_read_b64_tr_b16 a[8:9], v26 offset:39040
    ds_read_b64_tr_b16 a[10:11], v26 offset:39552
    ds_read_b64_tr_b16 a[12:13], v27 offset:39040
    ds_read_b64_tr_b16 a[14:15], v27 offset:39552
    ds_read_b64_tr_b16 a[16:17], v24 offset:47232
    ds_read_b64_tr_b16 a[18:19], v24 offset:47744
    ds_read_b64_tr_b16 a[20:21], v25 offset:47232
    ds_read_b64_tr_b16 a[22:23], v25 offset:47744
    ds_read_b64_tr_b16 a[24:25], v26 offset:47232
    ds_read_b64_tr_b16 a[26:27], v26 offset:47744
    s_waitcnt lgkmcnt(12)
    v_mfma_f32_16x16x32_bf16 v[28:31], a[0:3], v[116:119], v[28:31]
    ds_read_b64_tr_b16 a[28:29], v27 offset:47232
    ds_read_b64_tr_b16 a[30:31], v27 offset:47744
    s_waitcnt lgkmcnt(12)
    v_mfma_f32_16x16x32_bf16 v[32:35], a[4:7], v[116:119], v[32:35]
    ds_read_b64_tr_b16 a[32:33], v24 offset:55424
    ds_read_b64_tr_b16 a[34:35], v24 offset:55936
    s_waitcnt lgkmcnt(12)
    v_mfma_f32_16x16x32_bf16 v[36:39], a[8:11], v[116:119], v[36:39]
    ds_read_b64_tr_b16 a[36:37], v25 offset:55424
    ds_read_b64_tr_b16 a[38:39], v25 offset:55936
    s_waitcnt lgkmcnt(12)
    v_mfma_f32_16x16x32_bf16 v[40:43], a[12:15], v[116:119], v[40:43]
    ds_read_b64_tr_b16 a[40:41], v26 offset:55424
    ds_read_b64_tr_b16 a[42:43], v26 offset:55936
    s_waitcnt lgkmcnt(12)
    v_mfma_f32_16x16x32_bf16 v[44:47], a[16:19], v[108:111], v[44:47]
    ds_read_b64_tr_b16 a[44:45], v27 offset:55424
    ds_read_b64_tr_b16 a[46:47], v27 offset:55936
    s_waitcnt lgkmcnt(12)
    v_mfma_f32_16x16x32_bf16 v[48:51], a[20:23], v[108:111], v[48:51]
    ds_read_b64_tr_b16 a[48:49], v24 offset:43136
    ds_read_b64_tr_b16 a[50:51], v24 offset:43648
    s_waitcnt lgkmcnt(12)
    v_mfma_f32_16x16x32_bf16 v[52:55], a[24:27], v[108:111], v[52:55]
    ds_read_b64_tr_b16 a[52:53], v25 offset:43136
    ds_read_b64_tr_b16 a[54:55], v25 offset:43648
    s_waitcnt lgkmcnt(12)
    v_mfma_f32_16x16x32_bf16 v[56:59], a[28:31], v[108:111], v[56:59]
    ds_read_b64_tr_b16 a[56:57], v26 offset:43136
    ds_read_b64_tr_b16 a[58:59], v26 offset:43648
    s_waitcnt lgkmcnt(12)
    v_mfma_f32_16x16x32_bf16 v[60:63], v[108:111], a[32:35], v[60:63]
    ds_read_b64_tr_b16 a[60:61], v27 offset:43136
    ds_read_b64_tr_b16 a[62:63], v27 offset:43648
    s_waitcnt lgkmcnt(12)
    v_mfma_f32_16x16x32_bf16 v[64:67], v[108:111], a[36:39], v[64:67]
    ds_read_b64_tr_b16 a[64:65], v24 offset:51328
    ds_read_b64_tr_b16 a[66:67], v24 offset:51840
    s_waitcnt lgkmcnt(12)
    v_mfma_f32_16x16x32_bf16 v[68:71], v[108:111], a[40:43], v[68:71]
    ds_read_b64_tr_b16 a[68:69], v25 offset:51328
    ds_read_b64_tr_b16 a[70:71], v25 offset:51840
    s_waitcnt lgkmcnt(12)
    v_mfma_f32_16x16x32_bf16 v[72:75], v[108:111], a[44:47], v[72:75]
    ds_read_b64_tr_b16 a[72:73], v26 offset:51328
    ds_read_b64_tr_b16 a[74:75], v26 offset:51840
    s_waitcnt lgkmcnt(12)
    v_mfma_f32_16x16x32_bf16 v[28:31], a[48:51], v[116:119], v[28:31]
    ds_read_b64_tr_b16 a[76:77], v27 offset:51328
    ds_read_b64_tr_b16 a[78:79], v27 offset:51840
    s_waitcnt lgkmcnt(12)
    v_mfma_f32_16x16x32_bf16 v[32:35], a[52:55], v[116:119], v[32:35]
    ds_read_b64_tr_b16 a[80:81], v24 offset:59520
    ds_read_b64_tr_b16 a[82:83], v24 offset:60032
    s_waitcnt lgkmcnt(12)
    v_mfma_f32_16x16x32_bf16 v[36:39], a[56:59], v[116:119], v[36:39]
    ds_read_b64_tr_b16 a[84:85], v25 offset:59520
    ds_read_b64_tr_b16 a[86:87], v25 offset:60032
    s_waitcnt lgkmcnt(12)
    v_mfma_f32_16x16x32_bf16 v[40:43], a[60:63], v[116:119], v[40:43]
    ds_read_b64_tr_b16 a[88:89], v26 offset:59520
    ds_read_b64_tr_b16 a[90:91], v26 offset:60032
    s_waitcnt lgkmcnt(12)
    v_mfma_f32_16x16x32_bf16 v[44:47], a[64:67], v[112:115], v[44:47]
    ds_read_b64_tr_b16 a[92:93], v27 offset:59520
    ds_read_b64_tr_b16 a[94:95], v27 offset:60032
    s_waitcnt lgkmcnt(12)
    v_mfma_f32_16x16x32_bf16 v[48:51], a[68:71], v[112:115], v[48:51]
    s_waitcnt lgkmcnt(10)
    v_mfma_f32_16x16x32_bf16 v[52:55], a[72:75], v[112:115], v[52:55]
    s_waitcnt lgkmcnt(8)
    v_mfma_f32_16x16x32_bf16 v[56:59], a[76:79], v[112:115], v[56:59]
    s_waitcnt lgkmcnt(6)
    v_mfma_f32_16x16x32_bf16 v[60:63], v[112:115], a[80:83], v[60:63]
    s_waitcnt lgkmcnt(4)
    v_mfma_f32_16x16x32_bf16 v[64:67], v[112:115], a[84:87], v[64:67]
    s_waitcnt lgkmcnt(2)
    v_mfma_f32_16x16x32_bf16 v[68:71], v[112:115], a[88:91], v[68:71]
    s_waitcnt lgkmcnt(0)
    v_mfma_f32_16x16x32_bf16 v[72:75], v[112:115], a[92:95], v[72:75]
    v_add_u32 v4, 156224, v12
    v_min_u32 v5, 47, v1
    v_lshlrev_b32 v5, 2, v5
    v_add_u32 v5, 156480, v5
    v_lshlrev_b32 v6, 4, v2
    v_add_u32 v6, 157184, v6
    v_mov_b32 v7, 157968
    v_lshlrev_b32 v11, 2, v3
    v_add_u32 v11, 156224, v11
    s_barrier
    ds_read_b128 v[108:111], v76 offset:0
    ds_read_b128 v[112:115], v77 offset:0
    ds_read_b64_tr_b16 a[0:1], v20 offset:0
    ds_read_b64_tr_b16 a[2:3], v20 offset:512
    ds_read_b64_tr_b16 a[4:5], v21 offset:0
    ds_read_b64_tr_b16 a[6:7], v21 offset:512
    ds_read_b64_tr_b16 a[8:9], v22 offset:0
    ds_read_b64_tr_b16 a[10:11], v22 offset:512
    ds_read_b64_tr_b16 a[12:13], v23 offset:0
    ds_read_b64_tr_b16 a[14:15], v23 offset:512
    ds_read_b64_tr_b16 a[16:17], v20 offset:8192
    ds_read_b64_tr_b16 a[18:19], v20 offset:8704
    ds_read_b64_tr_b16 a[20:21], v21 offset:8192
    ds_read_b64_tr_b16 a[22:23], v21 offset:8704
    ds_read_b64_tr_b16 a[24:25], v22 offset:8192
    ds_read_b64_tr_b16 a[26:27], v22 offset:8704
    s_waitcnt lgkmcnt(12)
    v_mfma_f32_16x16x32_bf16 v[28:31], a[0:3], v[116:119], v[28:31]
    ds_read_b64_tr_b16 a[28:29], v23 offset:8192
    ds_read_b64_tr_b16 a[30:31], v23 offset:8704
    s_waitcnt lgkmcnt(12)
    v_mfma_f32_16x16x32_bf16 v[32:35], a[4:7], v[116:119], v[32:35]
    ds_read_b64_tr_b16 a[32:33], v20 offset:16384
    ds_read_b64_tr_b16 a[34:35], v20 offset:16896
    s_waitcnt lgkmcnt(12)
    v_mfma_f32_16x16x32_bf16 v[36:39], a[8:11], v[116:119], v[36:39]
    ds_read_b64_tr_b16 a[36:37], v21 offset:16384
    ds_read_b64_tr_b16 a[38:39], v21 offset:16896
    s_waitcnt lgkmcnt(12)
    v_mfma_f32_16x16x32_bf16 v[40:43], a[12:15], v[116:119], v[40:43]
    ds_read_b64_tr_b16 a[40:41], v22 offset:16384
    ds_read_b64_tr_b16 a[42:43], v22 offset:16896
    s_waitcnt lgkmcnt(12)
    v_mfma_f32_16x16x32_bf16 v[44:47], a[16:19], v[108:111], v[44:47]
    ds_read_b64_tr_b16 a[44:45], v23 offset:16384
    ds_read_b64_tr_b16 a[46:47], v23 offset:16896
    s_waitcnt lgkmcnt(12)
    v_mfma_f32_16x16x32_bf16 v[48:51], a[20:23], v[108:111], v[48:51]
    ds_read_b64_tr_b16 a[48:49], v20 offset:4096
    ds_read_b64_tr_b16 a[50:51], v20 offset:4608
    s_waitcnt lgkmcnt(12)
    v_mfma_f32_16x16x32_bf16 v[52:55], a[24:27], v[108:111], v[52:55]
    ds_read_b64_tr_b16 a[52:53], v21 offset:4096
    ds_read_b64_tr_b16 a[54:55], v21 offset:4608
    s_waitcnt lgkmcnt(12)
    v_mfma_f32_16x16x32_bf16 v[56:59], a[28:31], v[108:111], v[56:59]
    ds_read_b64_tr_b16 a[56:57], v22 offset:4096
    ds_read_b64_tr_b16 a[58:59], v22 offset:4608
    s_waitcnt lgkmcnt(12)
    v_mfma_f32_16x16x32_bf16 v[60:63], v[108:111], a[32:35], v[60:63]
    ds_read_b64_tr_b16 a[60:61], v23 offset:4096
    ds_read_b64_tr_b16 a[62:63], v23 offset:4608
    s_waitcnt lgkmcnt(12)
    v_mfma_f32_16x16x32_bf16 v[64:67], v[108:111], a[36:39], v[64:67]
    ds_read_b64_tr_b16 a[64:65], v20 offset:12288
    ds_read_b64_tr_b16 a[66:67], v20 offset:12800
    s_waitcnt lgkmcnt(12)
    v_mfma_f32_16x16x32_bf16 v[68:71], v[108:111], a[40:43], v[68:71]
    ds_read_b64_tr_b16 a[68:69], v21 offset:12288
    ds_read_b64_tr_b16 a[70:71], v21 offset:12800
    s_waitcnt lgkmcnt(12)
    v_mfma_f32_16x16x32_bf16 v[72:75], v[108:111], a[44:47], v[72:75]
    ds_read_b64_tr_b16 a[72:73], v22 offset:12288
    ds_read_b64_tr_b16 a[74:75], v22 offset:12800
    s_waitcnt lgkmcnt(12)
    v_mfma_f32_16x16x32_bf16 v[28:31], a[48:51], v[116:119], v[28:31]
    ds_read_b64_tr_b16 a[76:77], v23 offset:12288
    ds_read_b64_tr_b16 a[78:79], v23 offset:12800
    s_waitcnt lgkmcnt(12)
    v_mfma_f32_16x16x32_bf16 v[32:35], a[52:55], v[116:119], v[32:35]
    ds_read_b64_tr_b16 a[80:81], v20 offset:20480
    ds_read_b64_tr_b16 a[82:83], v20 offset:20992
    s_waitcnt lgkmcnt(12)
    v_mfma_f32_16x16x32_bf16 v[36:39], a[56:59], v[116:119], v[36:39]
    ds_read_b64_tr_b16 a[84:85], v21 offset:20480
    ds_read_b64_tr_b16 a[86:87], v21 offset:20992
    s_waitcnt lgkmcnt(12)
    v_mfma_f32_16x16x32_bf16 v[40:43], a[60:63], v[116:119], v[40:43]
    ds_read_b64_tr_b16 a[88:89], v22 offset:20480
    ds_read_b64_tr_b16 a[90:91], v22 offset:20992
    s_waitcnt lgkmcnt(12)
    v_mfma_f32_16x16x32_bf16 v[44:47], a[64:67], v[112:115], v[44:47]
    ds_read_b64_tr_b16 a[92:93], v23 offset:20480
    ds_read_b64_tr_b16 a[94:95], v23 offset:20992
    s_waitcnt lgkmcnt(12)
    v_mfma_f32_16x16x32_bf16 v[48:51], a[68:71], v[112:115], v[48:51]
    s_waitcnt lgkmcnt(10)
    v_mfma_f32_16x16x32_bf16 v[52:55], a[72:75], v[112:115], v[52:55]
    s_waitcnt lgkmcnt(8)
    v_mfma_f32_16x16x32_bf16 v[56:59], a[76:79], v[112:115], v[56:59]
    s_waitcnt lgkmcnt(6)
    v_mfma_f32_16x16x32_bf16 v[60:63], v[112:115], a[80:83], v[60:63]
    s_waitcnt lgkmcnt(4)
    v_mfma_f32_16x16x32_bf16 v[64:67], v[112:115], a[84:87], v[64:67]
    s_waitcnt lgkmcnt(2)
    v_mfma_f32_16x16x32_bf16 v[68:71], v[112:115], a[88:91], v[68:71]
    s_waitcnt lgkmcnt(0)
    v_mfma_f32_16x16x32_bf16 v[72:75], v[112:115], a[92:95], v[72:75]
    s_barrier
    ds_read_b128 v[108:111], v76 offset:39040
    ds_read_b128 v[112:115], v77 offset:39040
    ds_read_b64_tr_b16 a[0:1], v20 offset:39040
    ds_read_b64_tr_b16 a[2:3], v20 offset:39552
    ds_read_b64_tr_b16 a[4:5], v21 offset:39040
    ds_read_b64_tr_b16 a[6:7], v21 offset:39552
    ds_read_b64_tr_b16 a[8:9], v22 offset:39040
    ds_read_b64_tr_b16 a[10:11], v22 offset:39552
    ds_read_b64_tr_b16 a[12:13], v23 offset:39040
    ds_read_b64_tr_b16 a[14:15], v23 offset:39552
    ds_read_b64_tr_b16 a[16:17], v20 offset:47232
    ds_read_b64_tr_b16 a[18:19], v20 offset:47744
    ds_read_b64_tr_b16 a[20:21], v21 offset:47232
    ds_read_b64_tr_b16 a[22:23], v21 offset:47744
    ds_read_b64_tr_b16 a[24:25], v22 offset:47232
    ds_read_b64_tr_b16 a[26:27], v22 offset:47744
    s_waitcnt lgkmcnt(12)
    v_mfma_f32_16x16x32_bf16 v[28:31], a[0:3], v[116:119], v[28:31]
    ds_read_b64_tr_b16 a[28:29], v23 offset:47232
    ds_read_b64_tr_b16 a[30:31], v23 offset:47744
    s_waitcnt lgkmcnt(12)
    v_mfma_f32_16x16x32_bf16 v[32:35], a[4:7], v[116:119], v[32:35]
    ds_read_b64_tr_b16 a[32:33], v20 offset:55424
    ds_read_b64_tr_b16 a[34:35], v20 offset:55936
    s_waitcnt lgkmcnt(12)
    v_mfma_f32_16x16x32_bf16 v[36:39], a[8:11], v[116:119], v[36:39]
    ds_read_b64_tr_b16 a[36:37], v21 offset:55424
    ds_read_b64_tr_b16 a[38:39], v21 offset:55936
    s_waitcnt lgkmcnt(12)
    v_mfma_f32_16x16x32_bf16 v[40:43], a[12:15], v[116:119], v[40:43]
    ds_read_b64_tr_b16 a[40:41], v22 offset:55424
    ds_read_b64_tr_b16 a[42:43], v22 offset:55936
    s_waitcnt lgkmcnt(12)
    v_mfma_f32_16x16x32_bf16 v[44:47], a[16:19], v[108:111], v[44:47]
    ds_read_b64_tr_b16 a[44:45], v23 offset:55424
    ds_read_b64_tr_b16 a[46:47], v23 offset:55936
    s_waitcnt lgkmcnt(12)
    v_mfma_f32_16x16x32_bf16 v[48:51], a[20:23], v[108:111], v[48:51]
    ds_read_b64_tr_b16 a[48:49], v20 offset:43136
    ds_read_b64_tr_b16 a[50:51], v20 offset:43648
    s_waitcnt lgkmcnt(12)
    v_mfma_f32_16x16x32_bf16 v[52:55], a[24:27], v[108:111], v[52:55]
    ds_read_b64_tr_b16 a[52:53], v21 offset:43136
    ds_read_b64_tr_b16 a[54:55], v21 offset:43648
    s_waitcnt lgkmcnt(12)
    v_mfma_f32_16x16x32_bf16 v[56:59], a[28:31], v[108:111], v[56:59]
    ds_read_b64_tr_b16 a[56:57], v22 offset:43136
    ds_read_b64_tr_b16 a[58:59], v22 offset:43648
    s_waitcnt lgkmcnt(12)
    v_mfma_f32_16x16x32_bf16 v[60:63], v[108:111], a[32:35], v[60:63]
    ds_read_b64_tr_b16 a[60:61], v23 offset:43136
    ds_read_b64_tr_b16 a[62:63], v23 offset:43648
    s_waitcnt lgkmcnt(12)
    v_mfma_f32_16x16x32_bf16 v[64:67], v[108:111], a[36:39], v[64:67]
    ds_read_b64_tr_b16 a[64:65], v20 offset:51328
    ds_read_b64_tr_b16 a[66:67], v20 offset:51840
    s_waitcnt lgkmcnt(12)
    v_mfma_f32_16x16x32_bf16 v[68:71], v[108:111], a[40:43], v[68:71]
    ds_read_b64_tr_b16 a[68:69], v21 offset:51328
    ds_read_b64_tr_b16 a[70:71], v21 offset:51840
    s_waitcnt lgkmcnt(12)
    v_mfma_f32_16x16x32_bf16 v[72:75], v[108:111], a[44:47], v[72:75]
    ds_read_b64_tr_b16 a[72:73], v22 offset:51328
    ds_read_b64_tr_b16 a[74:75], v22 offset:51840
    s_waitcnt lgkmcnt(12)
    v_mfma_f32_16x16x32_bf16 v[28:31], a[48:51], v[116:119], v[28:31]
    ds_read_b64_tr_b16 a[76:77], v23 offset:51328
    ds_read_b64_tr_b16 a[78:79], v23 offset:51840
    s_waitcnt lgkmcnt(12)
    v_mfma_f32_16x16x32_bf16 v[32:35], a[52:55], v[116:119], v[32:35]
    ds_read_b64_tr_b16 a[80:81], v20 offset:59520
    ds_read_b64_tr_b16 a[82:83], v20 offset:60032
    s_waitcnt lgkmcnt(12)
    v_mfma_f32_16x16x32_bf16 v[36:39], a[56:59], v[116:119], v[36:39]
    ds_read_b64_tr_b16 a[84:85], v21 offset:59520
    ds_read_b64_tr_b16 a[86:87], v21 offset:60032
    s_waitcnt lgkmcnt(12)
    v_mfma_f32_16x16x32_bf16 v[40:43], a[60:63], v[116:119], v[40:43]
    ds_read_b64_tr_b16 a[88:89], v22 offset:59520
    ds_read_b64_tr_b16 a[90:91], v22 offset:60032
    s_waitcnt lgkmcnt(12)
    v_mfma_f32_16x16x32_bf16 v[44:47], a[64:67], v[112:115], v[44:47]
    ds_read_b64_tr_b16 a[92:93], v23 offset:59520
    ds_read_b64_tr_b16 a[94:95], v23 offset:60032
    s_waitcnt lgkmcnt(12)
    v_mfma_f32_16x16x32_bf16 v[48:51], a[68:71], v[112:115], v[48:51]
    s_waitcnt lgkmcnt(10)
    v_mfma_f32_16x16x32_bf16 v[52:55], a[72:75], v[112:115], v[52:55]
    s_waitcnt lgkmcnt(8)
    v_mfma_f32_16x16x32_bf16 v[56:59], a[76:79], v[112:115], v[56:59]
    s_waitcnt lgkmcnt(6)
    v_mfma_f32_16x16x32_bf16 v[60:63], v[112:115], a[80:83], v[60:63]
    s_waitcnt lgkmcnt(4)
    v_mfma_f32_16x16x32_bf16 v[64:67], v[112:115], a[84:87], v[64:67]
    s_waitcnt lgkmcnt(2)
    v_mfma_f32_16x16x32_bf16 v[68:71], v[112:115], a[88:91], v[68:71]
    s_waitcnt lgkmcnt(0)
    v_mfma_f32_16x16x32_bf16 v[72:75], v[112:115], a[92:95], v[72:75]
    s_barrier
    ds_read_b128 a[96:99], v80 offset:0
    ds_read_b128 a[100:103], v81 offset:0
    ds_read_b64_tr_b16 a[0:1], v24 offset:0
    ds_read_b64_tr_b16 a[2:3], v24 offset:512
    ds_read_b64_tr_b16 a[4:5], v25 offset:0
    ds_read_b64_tr_b16 a[6:7], v25 offset:512
    ds_read_b64_tr_b16 a[8:9], v26 offset:0
    ds_read_b64_tr_b16 a[10:11], v26 offset:512
    ds_read_b64_tr_b16 a[12:13], v27 offset:0
    ds_read_b64_tr_b16 a[14:15], v27 offset:512
    ds_read_b64_tr_b16 a[16:17], v24 offset:8192
    ds_read_b64_tr_b16 a[18:19], v24 offset:8704
    ds_read_b64_tr_b16 a[20:21], v25 offset:8192
    ds_read_b64_tr_b16 a[22:23], v25 offset:8704
    ds_read_b64_tr_b16 a[24:25], v26 offset:8192
    ds_read_b64_tr_b16 a[26:27], v26 offset:8704
    s_waitcnt lgkmcnt(12)
    v_mfma_f32_16x16x32_bf16 v[28:31], a[0:3], v[116:119], v[28:31]
    ds_read_b64_tr_b16 a[28:29], v27 offset:8192
    ds_read_b64_tr_b16 a[30:31], v27 offset:8704
    s_waitcnt lgkmcnt(12)
    v_mfma_f32_16x16x32_bf16 v[32:35], a[4:7], v[116:119], v[32:35]
    ds_read_b64_tr_b16 a[48:49], v24 offset:4096
    ds_read_b64_tr_b16 a[50:51], v24 offset:4608
    s_waitcnt lgkmcnt(12)
    v_mfma_f32_16x16x32_bf16 v[36:39], a[8:11], v[116:119], v[36:39]
    ds_read_b64_tr_b16 a[52:53], v25 offset:4096
    ds_read_b64_tr_b16 a[54:55], v25 offset:4608
    s_waitcnt lgkmcnt(12)
    v_mfma_f32_16x16x32_bf16 v[40:43], a[12:15], v[116:119], v[40:43]
    ds_read_b64_tr_b16 a[56:57], v26 offset:4096
    ds_read_b64_tr_b16 a[58:59], v26 offset:4608
    s_waitcnt lgkmcnt(12)
    v_mfma_f32_16x16x32_bf16 v[44:47], a[16:19], a[96:99], v[44:47]
    ds_read_b64_tr_b16 a[60:61], v27 offset:4096
    ds_read_b64_tr_b16 a[62:63], v27 offset:4608
    s_waitcnt lgkmcnt(12)
    v_mfma_f32_16x16x32_bf16 v[48:51], a[20:23], a[96:99], v[48:51]
    ds_read_b64_tr_b16 a[64:65], v24 offset:12288
    ds_read_b64_tr_b16 a[66:67], v24 offset:12800
    s_waitcnt lgkmcnt(12)
    v_mfma_f32_16x16x32_bf16 v[52:55], a[24:27], a[96:99], v[52:55]
    ds_read_b64_tr_b16 a[68:69], v25 offset:12288
    ds_read_b64_tr_b16 a[70:71], v25 offset:12800
    s_waitcnt lgkmcnt(12)
    v_mfma_f32_16x16x32_bf16 v[56:59], a[28:31], a[96:99], v[56:59]
    ds_read_b64_tr_b16 a[72:73], v26 offset:12288
    ds_read_b64_tr_b16 a[74:75], v26 offset:12800
    s_waitcnt lgkmcnt(12)
    v_mfma_f32_16x16x32_bf16 v[28:31], a[48:51], v[116:119], v[28:31]
    ds_read_b64_tr_b16 a[76:77], v27 offset:12288
    ds_read_b64_tr_b16 a[78:79], v27 offset:12800
    s_waitcnt lgkmcnt(12)
    v_mfma_f32_16x16x32_bf16 v[32:35], a[52:55], v[116:119], v[32:35]
    s_waitcnt lgkmcnt(10)
    v_mfma_f32_16x16x32_bf16 v[36:39], a[56:59], v[116:119], v[36:39]
    s_waitcnt lgkmcnt(8)
    v_mfma_f32_16x16x32_bf16 v[40:43], a[60:63], v[116:119], v[40:43]
    s_waitcnt lgkmcnt(6)
    v_mfma_f32_16x16x32_bf16 v[44:47], a[64:67], a[100:103], v[44:47]
    s_waitcnt lgkmcnt(4)
    v_mfma_f32_16x16x32_bf16 v[48:51], a[68:71], a[100:103], v[48:51]
    s_waitcnt lgkmcnt(2)
    v_mfma_f32_16x16x32_bf16 v[52:55], a[72:75], a[100:103], v[52:55]
    s_waitcnt lgkmcnt(0)
    v_mfma_f32_16x16x32_bf16 v[56:59], a[76:79], a[100:103], v[56:59]
    s_barrier
    ds_read_b128 a[104:107], v80 offset:39040
    ds_read_b128 a[108:111], v81 offset:39040
    ds_read_b64_tr_b16 a[0:1], v24 offset:39040
    ds_read_b64_tr_b16 a[2:3], v24 offset:39552
    ds_read_b64_tr_b16 a[4:5], v25 offset:39040
    ds_read_b64_tr_b16 a[6:7], v25 offset:39552
    ds_read_b64_tr_b16 a[8:9], v26 offset:39040
    ds_read_b64_tr_b16 a[10:11], v26 offset:39552
    ds_read_b64_tr_b16 a[12:13], v27 offset:39040
    ds_read_b64_tr_b16 a[14:15], v27 offset:39552
    ds_read_b64_tr_b16 a[16:17], v24 offset:47232
    ds_read_b64_tr_b16 a[18:19], v24 offset:47744
    ds_read_b64_tr_b16 a[20:21], v25 offset:47232
    ds_read_b64_tr_b16 a[22:23], v25 offset:47744
    ds_read_b64_tr_b16 a[24:25], v26 offset:47232
    ds_read_b64_tr_b16 a[26:27], v26 offset:47744
    s_waitcnt lgkmcnt(12)
    v_mfma_f32_16x16x32_bf16 v[28:31], a[0:3], v[116:119], v[28:31]
    ds_read_b64_tr_b16 a[28:29], v27 offset:47232
    ds_read_b64_tr_b16 a[30:31], v27 offset:47744
    s_waitcnt lgkmcnt(12)
    v_mfma_f32_16x16x32_bf16 v[32:35], a[4:7], v[116:119], v[32:35]
    ds_read_b64_tr_b16 a[48:49], v24 offset:43136
    ds_read_b64_tr_b16 a[50:51], v24 offset:43648
    s_waitcnt lgkmcnt(12)
    v_mfma_f32_16x16x32_bf16 v[36:39], a[8:11], v[116:119], v[36:39]
    ds_read_b64_tr_b16 a[52:53], v25 offset:43136
    ds_read_b64_tr_b16 a[54:55], v25 offset:43648
    s_waitcnt lgkmcnt(12)
    v_mfma_f32_16x16x32_bf16 v[40:43], a[12:15], v[116:119], v[40:43]
    ds_read_b64_tr_b16 a[56:57], v26 offset:43136
    ds_read_b64_tr_b16 a[58:59], v26 offset:43648
    s_waitcnt lgkmcnt(12)
    v_mfma_f32_16x16x32_bf16 v[44:47], a[16:19], a[104:107], v[44:47]
    ds_read_b64_tr_b16 a[60:61], v27 offset:43136
    ds_read_b64_tr_b16 a[62:63], v27 offset:43648
    s_waitcnt lgkmcnt(12)
    v_mfma_f32_16x16x32_bf16 v[48:51], a[20:23], a[104:107], v[48:51]
    ds_read_b64_tr_b16 a[64:65], v24 offset:51328
    ds_read_b64_tr_b16 a[66:67], v24 offset:51840
    s_waitcnt lgkmcnt(12)
    v_mfma_f32_16x16x32_bf16 v[52:55], a[24:27], a[104:107], v[52:55]
    ds_read_b64_tr_b16 a[68:69], v25 offset:51328
    ds_read_b64_tr_b16 a[70:71], v25 offset:51840
    s_waitcnt lgkmcnt(12)
    v_mfma_f32_16x16x32_bf16 v[56:59], a[28:31], a[104:107], v[56:59]
    ds_read_b64_tr_b16 a[72:73], v26 offset:51328
    ds_read_b64_tr_b16 a[74:75], v26 offset:51840
    s_waitcnt lgkmcnt(12)
    v_mfma_f32_16x16x32_bf16 v[28:31], a[48:51], v[116:119], v[28:31]
    ds_read_b64_tr_b16 a[76:77], v27 offset:51328
    ds_read_b64_tr_b16 a[78:79], v27 offset:51840
    s_waitcnt lgkmcnt(12)
    v_mfma_f32_16x16x32_bf16 v[32:35], a[52:55], v[116:119], v[32:35]
    s_waitcnt lgkmcnt(10)
    v_mfma_f32_16x16x32_bf16 v[36:39], a[56:59], v[116:119], v[36:39]
    s_waitcnt lgkmcnt(8)
    v_mfma_f32_16x16x32_bf16 v[40:43], a[60:63], v[116:119], v[40:43]
    s_waitcnt lgkmcnt(6)
    v_mfma_f32_16x16x32_bf16 v[44:47], a[64:67], a[108:111], v[44:47]
    s_waitcnt lgkmcnt(4)
    v_mfma_f32_16x16x32_bf16 v[48:51], a[68:71], a[108:111], v[48:51]
    s_waitcnt lgkmcnt(2)
    v_mfma_f32_16x16x32_bf16 v[52:55], a[72:75], a[108:111], v[52:55]
    s_waitcnt lgkmcnt(0)
    v_mfma_f32_16x16x32_bf16 v[56:59], a[76:79], a[108:111], v[56:59]
    buffer_load_dwordx2 v[92:93], v96, s[28:31], s46 offen sc1
    buffer_load_dwordx2 v[94:95], v97, s[28:31], s46 offen sc1
    s_barrier
    ds_read_b128 a[112:115], v76 offset:0
    ds_read_b128 a[116:119], v77 offset:0
    ds_read_b64_tr_b16 a[0:1], v20 offset:0
    ds_read_b64_tr_b16 a[2:3], v20 offset:512
    ds_read_b64_tr_b16 a[4:5], v21 offset:0
    ds_read_b64_tr_b16 a[6:7], v21 offset:512
    ds_read_b64_tr_b16 a[8:9], v22 offset:0
    ds_read_b64_tr_b16 a[10:11], v22 offset:512
    ds_read_b64_tr_b16 a[12:13], v23 offset:0
    ds_read_b64_tr_b16 a[14:15], v23 offset:512
    ds_read_b64_tr_b16 a[16:17], v20 offset:8192
    ds_read_b64_tr_b16 a[18:19], v20 offset:8704
    ds_read_b64_tr_b16 a[20:21], v21 offset:8192
    ds_read_b64_tr_b16 a[22:23], v21 offset:8704
    ds_read_b64_tr_b16 a[24:25], v22 offset:8192
    ds_read_b64_tr_b16 a[26:27], v22 offset:8704
    s_waitcnt lgkmcnt(12)
    v_mfma_f32_16x16x32_bf16 v[28:31], a[0:3], v[116:119], v[28:31]
    ds_read_b64_tr_b16 a[28:29], v23 offset:8192
    ds_read_b64_tr_b16 a[30:31], v23 offset:8704
    s_waitcnt lgkmcnt(12)
    v_mfma_f32_16x16x32_bf16 v[32:35], a[4:7], v[116:119], v[32:35]
    ds_read_b64_tr_b16 a[48:49], v20 offset:4096
    ds_read_b64_tr_b16 a[50:51], v20 offset:4608
    s_waitcnt lgkmcnt(12)
    v_mfma_f32_16x16x32_bf16 v[36:39], a[8:11], v[116:119], v[36:39]
    ds_read_b64_tr_b16 a[52:53], v21 offset:4096
    ds_read_b64_tr_b16 a[54:55], v21 offset:4608
    s_waitcnt lgkmcnt(12)
    v_mfma_f32_16x16x32_bf16 v[40:43], a[12:15], v[116:119], v[40:43]
    ds_read_b64_tr_b16 a[56:57], v22 offset:4096
    ds_read_b64_tr_b16 a[58:59], v22 offset:4608
    s_waitcnt lgkmcnt(12)
    v_mfma_f32_16x16x32_bf16 v[44:47], a[16:19], a[112:115], v[44:47]
    ds_read_b64_tr_b16 a[60:61], v23 offset:4096
    ds_read_b64_tr_b16 a[62:63], v23 offset:4608
    s_waitcnt lgkmcnt(12)
    v_mfma_f32_16x16x32_bf16 v[48:51], a[20:23], a[112:115], v[48:51]
    ds_read_b64_tr_b16 a[64:65], v20 offset:12288
    ds_read_b64_tr_b16 a[66:67], v20 offset:12800
    s_waitcnt lgkmcnt(12)
    v_mfma_f32_16x16x32_bf16 v[52:55], a[24:27], a[112:115], v[52:55]
    ds_read_b64_tr_b16 a[68:69], v21 offset:12288
    ds_read_b64_tr_b16 a[70:71], v21 offset:12800
    s_waitcnt lgkmcnt(12)
    v_mfma_f32_16x16x32_bf16 v[56:59], a[28:31], a[112:115], v[56:59]
    ds_read_b64_tr_b16 a[72:73], v22 offset:12288
    ds_read_b64_tr_b16 a[74:75], v22 offset:12800
    s_waitcnt lgkmcnt(12)
    v_mfma_f32_16x16x32_bf16 v[28:31], a[48:51], v[116:119], v[28:31]
    ds_read_b64_tr_b16 a[76:77], v23 offset:12288
    ds_read_b64_tr_b16 a[78:79], v23 offset:12800
    s_waitcnt lgkmcnt(12)
    v_mfma_f32_16x16x32_bf16 v[32:35], a[52:55], v[116:119], v[32:35]
    s_waitcnt lgkmcnt(10)
    v_mfma_f32_16x16x32_bf16 v[36:39], a[56:59], v[116:119], v[36:39]
    s_waitcnt vmcnt(0)
Lst_chk:
    v_cmp_ne_u32 vcc, s34, v93
    v_cmp_ne_u32 s[36:37], s34, v95
    s_nop 0
    s_or_b64 s[36:37], s[36:37], vcc
    s_cbranch_scc1 Lst_re
    v_lshlrev_b32 v93, 16, v92
    s_waitcnt lgkmcnt(8)
    v_mfma_f32_16x16x32_bf16 v[40:43], a[60:63], v[116:119], v[40:43]
    v_and_b32 v92, 0xffff0000, v92
    v_rcp_f32 v93, v93
    s_waitcnt lgkmcnt(6)
    v_mfma_f32_16x16x32_bf16 v[44:47], a[64:67], a[116:119], v[44:47]
    v_lshlrev_b32 v95, 16, v94
    v_and_b32 v94, 0xffff0000, v94
    s_waitcnt lgkmcnt(4)
    v_mfma_f32_16x16x32_bf16 v[48:51], a[68:71], a[116:119], v[48:51]
    v_rcp_f32 v95, v95
    ds_write2st64_b32 v4, v92, v93 offset0:0 offset1:2
    s_waitcnt lgkmcnt(3)
    v_mfma_f32_16x16x32_bf16 v[52:55], a[72:75], a[116:119], v[52:55]
    ds_write2st64_b32 v5, v94, v95 offset0:0 offset1:2
    ds_read_b32 v120, v11
    s_waitcnt lgkmcnt(3)
    v_mfma_f32_16x16x32_bf16 v[56:59], a[76:79], a[116:119], v[56:59]
    s_waitcnt lgkmcnt(0)
    s_barrier
    ds_read_b128 a[120:123], v76 offset:39040
    ds_read_b128 a[124:127], v77 offset:39040
    ds_read_b64_tr_b16 a[0:1], v20 offset:39040
    ds_read_b64_tr_b16 a[2:3], v20 offset:39552
    ds_read_b64_tr_b16 a[4:5], v21 offset:39040
    ds_read_b64_tr_b16 a[6:7], v21 offset:39552
    ds_read_b64_tr_b16 a[8:9], v22 offset:39040
    ds_read_b64_tr_b16 a[10:11], v22 offset:39552
    ds_read_b64_tr_b16 a[12:13], v23 offset:39040
    ds_read_b64_tr_b16 a[14:15], v23 offset:39552
    ds_read_b64_tr_b16 a[16:17], v20 offset:47232
    ds_read_b64_tr_b16 a[18:19], v20 offset:47744
    ds_read_b64_tr_b16 a[20:21], v21 offset:47232
    ds_read_b64_tr_b16 a[22:23], v21 offset:47744
    ds_read_b64_tr_b16 a[24:25], v22 offset:47232
    ds_read_b64_tr_b16 a[26:27], v22 offset:47744
    s_waitcnt lgkmcnt(12)
    v_mfma_f32_16x16x32_bf16 v[28:31], a[0:3], v[116:119], v[28:31]
    ds_read_b64_tr_b16 a[28:29], v23 offset:47232
    ds_read_b64_tr_b16 a[30:31], v23 offset:47744
    s_waitcnt lgkmcnt(12)
    v_mfma_f32_16x16x32_bf16 v[32:35], a[4:7], v[116:119], v[32:35]
    ds_read_b64_tr_b16 a[48:49], v20 offset:43136
    ds_read_b64_tr_b16 a[50:51], v20 offset:43648
    s_waitcnt lgkmcnt(12)
    v_mfma_f32_16x16x32_bf16 v[36:39], a[8:11], v[116:119], v[36:39]
    ds_read_b64_tr_b16 a[52:53], v21 offset:43136
    ds_read_b64_tr_b16 a[54:55], v21 offset:43648
    s_waitcnt lgkmcnt(12)
    v_mfma_f32_16x16x32_bf16 v[40:43], a[12:15], v[116:119], v[40:43]
    ds_read_b64_tr_b16 a[56:57], v22 offset:43136
    ds_read_b64_tr_b16 a[58:59], v22 offset:43648
    s_waitcnt lgkmcnt(12)
    v_mfma_f32_16x16x32_bf16 v[44:47], a[16:19], a[120:123], v[44:47]
    ds_read_b64_tr_b16 a[60:61], v23 offset:43136
    ds_read_b64_tr_b16 a[62:63], v23 offset:43648
    s_waitcnt lgkmcnt(12)
    v_mfma_f32_16x16x32_bf16 v[48:51], a[20:23], a[120:123], v[48:51]
    ds_read_b64_tr_b16 a[64:65], v20 offset:51328
    ds_read_b64_tr_b16 a[66:67], v20 offset:51840
    s_waitcnt lgkmcnt(12)
    v_mfma_f32_16x16x32_bf16 v[52:55], a[24:27], a[120:123], v[52:55]
    ds_read_b64_tr_b16 a[68:69], v21 offset:51328
    ds_read_b64_tr_b16 a[70:71], v21 offset:51840
    s_waitcnt lgkmcnt(12)
    v_mfma_f32_16x16x32_bf16 v[56:59], a[28:31], a[120:123], v[56:59]
    ds_read_b64_tr_b16 a[72:73], v22 offset:51328
    ds_read_b64_tr_b16 a[74:75], v22 offset:51840
    s_waitcnt lgkmcnt(12)
    v_mfma_f32_16x16x32_bf16 v[28:31], a[48:51], v[116:119], v[28:31]
    ds_read_b64_tr_b16 a[76:77], v23 offset:51328
    ds_read_b64_tr_b16 a[78:79], v23 offset:51840
    s_waitcnt lgkmcnt(12)
    v_mfma_f32_16x16x32_bf16 v[32:35], a[52:55], v[116:119], v[32:35]
    s_waitcnt lgkmcnt(10)
    v_mfma_f32_16x16x32_bf16 v[36:39], a[56:59], v[116:119], v[36:39]
    s_waitcnt lgkmcnt(8)
    v_mfma_f32_16x16x32_bf16 v[40:43], a[60:63], v[116:119], v[40:43]
    s_waitcnt lgkmcnt(6)
    v_mfma_f32_16x16x32_bf16 v[44:47], a[64:67], a[124:127], v[44:47]
    s_waitcnt lgkmcnt(4)
    v_mfma_f32_16x16x32_bf16 v[48:51], a[68:71], a[124:127], v[48:51]
    s_waitcnt lgkmcnt(2)
    v_mfma_f32_16x16x32_bf16 v[52:55], a[72:75], a[124:127], v[52:55]
    s_waitcnt lgkmcnt(0)
    v_mfma_f32_16x16x32_bf16 v[56:59], a[76:79], a[124:127], v[56:59]
    s_mov_b32 exec_lo, 0x00010001
    s_mov_b32 exec_hi, 0x00010001
    ds_write_b128 v6, v[28:31] offset:0
    ds_write_b128 v6, v[32:35] offset:64
    ds_write_b128 v6, v[36:39] offset:128
    ds_write_b128 v6, v[40:43] offset:192
    ds_write_b128 v6, v[44:47] offset:256
    ds_write_b128 v6, v[48:51] offset:320
    ds_write_b128 v6, v[52:55] offset:384
    ds_write_b128 v6, v[56:59] offset:448
    ds_write_b32 v7, v7
    s_mov_b64 exec, -1
    ds_read_b128 v[76:79], v6 offset:256
    ds_read_b128 v[80:83], v6 offset:320
    ds_read_b128 v[84:87], v6 offset:384
    ds_read_b128 v[88:91], v6 offset:448
    s_waitcnt lgkmcnt(0)
    v_fmac_f32 v44, v76, v120
    v_fmac_f32 v45, v77, v120
    v_fmac_f32 v46, v78, v120
    v_fmac_f32 v47, v79, v120
    v_cvt_pk_bf16_f32 v44, v44, v45
    v_cvt_pk_bf16_f32 v45, v46, v47
    v_fmac_f32 v48, v80, v120
    v_fmac_f32 v49, v81, v120
    v_fmac_f32 v50, v82, v120
    v_fmac_f32 v51, v83, v120
    v_cvt_pk_bf16_f32 v46, v48, v49
    v_cvt_pk_bf16_f32 v47, v50, v51
    v_fmac_f32 v52, v84, v120
    v_fmac_f32 v53, v85, v120
    v_fmac_f32 v54, v86, v120
    v_fmac_f32 v55, v87, v120
    v_cvt_pk_bf16_f32 v48, v52, v53
    v_cvt_pk_bf16_f32 v49, v54, v55
    v_fmac_f32 v56, v88, v120
    v_fmac_f32 v57, v89, v120
    v_fmac_f32 v58, v90, v120
    v_fmac_f32 v59, v91, v120
    v_cvt_pk_bf16_f32 v50, v56, v57
    v_cvt_pk_bf16_f32 v51, v58, v59
    ds_write_b128 v125, v[44:47] offset:4096
    ds_write_b128 v125, v[48:51] offset:5120
    v_mov_b32 v5, 157972
    v_mov_b32 v6, 1
    s_mov_b64 exec, 1
    ds_add_u32 v5, v6
    s_mov_b64 exec, -1
    v_mov_b32 v5, 157980
Lcw_6:
    s_sub_u32 s35, s35, 1
    s_cbranch_scc1 Lend
    ds_read_b32 v6, v5
    s_waitcnt lgkmcnt(0)
    v_readfirstlane_b32 s38, v6
    s_nop 0
    s_cmp_lt_u32 s38, 1
    s_cbranch_scc1 Lcw_6
    ds_read_b64_tr_b16 a[0:1], v24 offset:16384
    ds_read_b64_tr_b16 a[2:3], v24 offset:16896
    ds_read_b64_tr_b16 a[4:5], v25 offset:16384
    ds_read_b64_tr_b16 a[6:7], v25 offset:16896
    ds_read_b64_tr_b16 a[8:9], v26 offset:16384
    ds_read_b64_tr_b16 a[10:11], v26 offset:16896
    ds_read_b64_tr_b16 a[12:13], v27 offset:16384
    ds_read_b64_tr_b16 a[14:15], v27 offset:16896
    ds_read_b64_tr_b16 a[16:17], v24 offset:20480
    ds_read_b64_tr_b16 a[18:19], v24 offset:20992
    ds_read_b64_tr_b16 a[20:21], v25 offset:20480
    ds_read_b64_tr_b16 a[22:23], v25 offset:20992
    ds_read_b64_tr_b16 a[24:25], v26 offset:20480
    ds_read_b64_tr_b16 a[26:27], v26 offset:20992
    ds_read_b64_tr_b16 a[28:29], v27 offset:20480
    ds_read_b64_tr_b16 a[30:31], v27 offset:20992
    ds_read_b64_tr_b16 a[32:33], v24 offset:55424
    ds_read_b64_tr_b16 a[34:35], v24 offset:55936
    ds_read_b64_tr_b16 a[36:37], v25 offset:55424
    ds_read_b64_tr_b16 a[38:39], v25 offset:55936
    ds_read_b64_tr_b16 a[40:41], v26 offset:55424
    ds_read_b64_tr_b16 a[42:43], v26 offset:55936
    ds_read_b64_tr_b16 a[44:45], v27 offset:55424
    ds_read_b64_tr_b16 a[46:47], v27 offset:55936
    ds_read_b64_tr_b16 a[48:49], v24 offset:59520
    ds_read_b64_tr_b16 a[50:51], v24 offset:60032
    ds_read_b64_tr_b16 a[52:53], v25 offset:59520
    ds_read_b64_tr_b16 a[54:55], v25 offset:60032
    ds_read_b64_tr_b16 a[56:57], v26 offset:59520
    ds_read_b64_tr_b16 a[58:59], v26 offset:60032
    ds_read_b64_tr_b16 a[60:61], v27 offset:59520
    ds_read_b64_tr_b16 a[62:63], v27 offset:60032
    ds_read_b64_tr_b16 a[64:65], v20 offset:16384
    ds_read_b64_tr_b16 a[66:67], v20 offset:16896
    ds_read_b64_tr_b16 a[68:69], v21 offset:16384
    ds_read_b64_tr_b16 a[70:71], v21 offset:16896
    ds_read_b64_tr_b16 a[72:73], v22 offset:16384
    ds_read_b64_tr_b16 a[74:75], v22 offset:16896
    ds_read_b64_tr_b16 a[76:77], v23 offset:16384
    ds_read_b64_tr_b16 a[78:79], v23 offset:16896
    ds_read_b64_tr_b16 a[80:81], v20 offset:20480
    ds_read_b64_tr_b16 a[82:83], v20 offset:20992
    ds_read_b64_tr_b16 a[84:85], v21 offset:20480
    ds_read_b64_tr_b16 a[86:87], v21 offset:20992
    ds_read_b64_tr_b16 a[88:89], v22 offset:20480
    ds_read_b64_tr_b16 a[90:91], v22 offset:20992
    ds_read_b64_tr_b16 a[92:93], v23 offset:20480
    ds_read_b64_tr_b16 a[94:95], v23 offset:20992
    s_waitcnt lgkmcnt(15)
    v_mfma_f32_16x16x32_bf16 v[60:63], a[96:99], a[0:3], v[60:63]
    v_mfma_f32_16x16x32_bf16 v[64:67], a[96:99], a[4:7], v[64:67]
    v_mfma_f32_16x16x32_bf16 v[68:71], a[96:99], a[8:11], v[68:71]
    v_mfma_f32_16x16x32_bf16 v[72:75], a[96:99], a[12:15], v[72:75]
    ds_read_b64_tr_b16 a[0:1], v20 offset:55424
    ds_read_b64_tr_b16 a[2:3], v20 offset:55936
    ds_read_b64_tr_b16 a[4:5], v21 offset:55424
    ds_read_b64_tr_b16 a[6:7], v21 offset:55936
    ds_read_b64_tr_b16 a[8:9], v22 offset:55424
    ds_read_b64_tr_b16 a[10:11], v22 offset:55936
    ds_read_b64_tr_b16 a[12:13], v23 offset:55424
    ds_read_b64_tr_b16 a[14:15], v23 offset:55936
    v_mfma_f32_16x16x32_bf16 v[60:63], a[100:103], a[16:19], v[60:63]
    v_mfma_f32_16x16x32_bf16 v[64:67], a[100:103], a[20:23], v[64:67]
    v_mfma_f32_16x16x32_bf16 v[68:71], a[100:103], a[24:27], v[68:71]
    v_mfma_f32_16x16x32_bf16 v[72:75], a[100:103], a[28:31], v[72:75]
    ds_read_b64_tr_b16 a[16:17], v20 offset:59520
    ds_read_b64_tr_b16 a[18:19], v20 offset:60032
    ds_read_b64_tr_b16 a[20:21], v21 offset:59520
    ds_read_b64_tr_b16 a[22:23], v21 offset:60032
    ds_read_b64_tr_b16 a[24:25], v22 offset:59520
    ds_read_b64_tr_b16 a[26:27], v22 offset:60032
    ds_read_b64_tr_b16 a[28:29], v23 offset:59520
    ds_read_b64_tr_b16 a[30:31], v23 offset:60032
    v_mfma_f32_16x16x32_bf16 v[60:63], a[104:107], a[32:35], v[60:63]
    v_mfma_f32_16x16x32_bf16 v[64:67], a[104:107], a[36:39], v[64:67]
    v_mfma_f32_16x16x32_bf16 v[68:71], a[104:107], a[40:43], v[68:71]
    v_mfma_f32_16x16x32_bf16 v[72:75], a[104:107], a[44:47], v[72:75]
    v_mfma_f32_16x16x32_bf16 v[60:63], a[108:111], a[48:51], v[60:63]
    v_mfma_f32_16x16x32_bf16 v[64:67], a[108:111], a[52:55], v[64:67]
    v_mfma_f32_16x16x32_bf16 v[68:71], a[108:111], a[56:59], v[68:71]
    v_mfma_f32_16x16x32_bf16 v[72:75], a[108:111], a[60:63], v[72:75]
    s_waitcnt lgkmcnt(15)
    v_mfma_f32_16x16x32_bf16 v[60:63], a[112:115], a[64:67], v[60:63]
    v_mfma_f32_16x16x32_bf16 v[64:67], a[112:115], a[68:71], v[64:67]
    v_mfma_f32_16x16x32_bf16 v[68:71], a[112:115], a[72:75], v[68:71]
    v_mfma_f32_16x16x32_bf16 v[72:75], a[112:115], a[76:79], v[72:75]
    v_mfma_f32_16x16x32_bf16 v[60:63], a[116:119], a[80:83], v[60:63]
    v_mfma_f32_16x16x32_bf16 v[64:67], a[116:119], a[84:87], v[64:67]
    v_mfma_f32_16x16x32_bf16 v[68:71], a[116:119], a[88:91], v[68:71]
    v_mfma_f32_16x16x32_bf16 v[72:75], a[116:119], a[92:95], v[72:75]
    s_waitcnt lgkmcnt(8)
    v_mfma_f32_16x16x32_bf16 v[60:63], a[120:123], a[0:3], v[60:63]
    v_mfma_f32_16x16x32_bf16 v[64:67], a[120:123], a[4:7], v[64:67]
    v_mfma_f32_16x16x32_bf16 v[68:71], a[120:123], a[8:11], v[68:71]
    v_mfma_f32_16x16x32_bf16 v[72:75], a[120:123], a[12:15], v[72:75]
    s_waitcnt lgkmcnt(0)
    v_mfma_f32_16x16x32_bf16 v[60:63], a[124:127], a[16:19], v[60:63]
    v_mfma_f32_16x16x32_bf16 v[64:67], a[124:127], a[20:23], v[64:67]
    v_mfma_f32_16x16x32_bf16 v[68:71], a[124:127], a[24:27], v[68:71]
    v_mfma_f32_16x16x32_bf16 v[72:75], a[124:127], a[28:31], v[72:75]
    v_lshlrev_b32 v5, 4, v3
    v_add_u32 v5, 157696, v5
    v_mov_b32 v6, 157952
    v_lshlrev_b32 v4, 4, v2
    v_add_u32 v4, 156224, v4
    v_lshl_add_u32 v125, v1, 3, s45
    s_mov_b64 exec, 0xffff
    ds_write_b32 v5, v60 offset:0
    ds_write_b32 v5, v64 offset:4
    ds_write_b32 v5, v68 offset:8
    ds_write_b32 v5, v72 offset:12
    ds_write_b32 v6, v6
    s_mov_b64 exec, -1
    ds_read_b128 v[36:39], v5
    ds_read_b128 v[28:31], v4
    ds_read_b128 v[32:35], v4 offset:512
    s_waitcnt lgkmcnt(0)
    v_fmac_f32 v60, v28, v36
    v_fmac_f32 v61, v29, v36
    v_fmac_f32 v62, v30, v36
    v_fmac_f32 v63, v31, v36
    v_mul_f32 v60, v60, v32
    v_mul_f32 v61, v61, v33
    v_mul_f32 v62, v62, v34
    v_mul_f32 v63, v63, v35
    v_cvt_pk_bf16_f32 v60, v60, v61
    v_cvt_pk_bf16_f32 v61, v62, v63
    ds_write_b64 v125, v[60:61] offset:0
    v_fmac_f32 v64, v28, v37
    v_fmac_f32 v65, v29, v37
    v_fmac_f32 v66, v30, v37
    v_fmac_f32 v67, v31, v37
    v_mul_f32 v64, v64, v32
    v_mul_f32 v65, v65, v33
    v_mul_f32 v66, v66, v34
    v_mul_f32 v67, v67, v35
    v_cvt_pk_bf16_f32 v64, v64, v65
    v_cvt_pk_bf16_f32 v65, v66, v67
    ds_write_b64 v125, v[64:65] offset:512
    v_fmac_f32 v68, v28, v38
    v_fmac_f32 v69, v29, v38
    v_fmac_f32 v70, v30, v38
    v_fmac_f32 v71, v31, v38
    v_mul_f32 v68, v68, v32
    v_mul_f32 v69, v69, v33
    v_mul_f32 v70, v70, v34
    v_mul_f32 v71, v71, v35
    v_cvt_pk_bf16_f32 v68, v68, v69
    v_cvt_pk_bf16_f32 v69, v70, v71
    ds_write_b64 v125, v[68:69] offset:1024
    v_fmac_f32 v72, v28, v39
    v_fmac_f32 v73, v29, v39
    v_fmac_f32 v74, v30, v39
    v_fmac_f32 v75, v31, v39
    v_mul_f32 v72, v72, v32
    v_mul_f32 v73, v73, v33
    v_mul_f32 v74, v74, v34
    v_mul_f32 v75, v75, v35
    v_cvt_pk_bf16_f32 v72, v72, v73
    v_cvt_pk_bf16_f32 v73, v74, v75
    ds_write_b64 v125, v[72:73] offset:1536
    v_mov_b32 v8, 157976
    v_mov_b32 v9, 1
    s_mov_b64 exec, 1
    ds_add_u32 v8, v9
    s_mov_b64 exec, -1
    s_branch Lagent
Lst_re:
    s_sub_u32 s35, s35, 1
    s_cbranch_scc1 Lend
    buffer_load_dwordx2 v[92:93], v96, s[28:31], s46 offen sc1
    buffer_load_dwordx2 v[94:95], v97, s[28:31], s46 offen sc1
    s_waitcnt vmcnt(0)
    s_branch Lst_chk
Laux:
    s_lshl_b32 s32, s37, 3
    s_lshl_b32 s39, s38, 2
    s_add_u32 s32, s32, s36
    s_cmp_lt_u32 s37, 4
    s_cselect_b32 s39, s39, 0
    s_add_u32 s32, s32, s39
    s_and_b32 s33, s2, 3
    s_lshl_b32 s33, s33, 3
    s_and_b32 s39, s2, 4
    s_add_u32 s33, s33, s39
    s_add_u32 s33, s33, s37
    s_cmp_ge_u32 s32, 32
    s_cbranch_scc1 Lmst
    v_lshrrev_b32 v5, 3, v1
    v_and_b32 v6, 7, v1
    s_lshl_b32 s40, s3, 14
    s_cmp_eq_u32 s27, 0
    s_cbranch_scc0 Laux_u
    s_lshl_b32 s36, s33, 6
    s_lshl_b32 s37, s26, 4
    s_add_u32 s36, s36, s37
    v_add_u32 v7, s36, v5
    v_mul_u32_u24 v7, 1280, v7
    v_xor_b32 v8, v6, v2
    v_lshl_add_u32 v92, v8, 4, v7
    v_add_u32 v92, 4096, v92
    v_xor_b32 v93, 64, v92
    v_add_u32 v93, 9216, v93
    v_subrev_u32 v94, 1920, v92
    v_subrev_u32 v95, 1920, v93
    s_waitcnt lgkmcnt(0)
    s_sub_u32 s52, s4, 4096
    s_subb_u32 s53, s5, 0
    s_mov_b32 s54, 2625536
    s_mov_b32 s55, 0x20000
    s_mov_b64 s[60:61], s[12:13]
    s_mov_b32 s62, 1280
    s_mov_b32 s63, 0x20000
    s_mov_b32 m0, 131072
    s_nop 0
    buffer_load_dwordx4 v13, s[60:63], 0 offen lds
    s_mov_b64 exec, 0xffff
    buffer_load_dwordx4 v13, s[60:63], 0 offen offset:1024 lds
    s_mov_b64 exec, -1
    s_add_u32 m0, s40, 0
    s_mov_b32 s41, 0
    buffer_load_dwordx4 v92, s[52:55], s41 offen lds
    buffer_load_dwordx4 v93, s[52:55], s41 offen offset:1024 lds
    buffer_load_dwordx4 v94, s[52:55], s41 offen offset:2048 lds
    buffer_load_dwordx4 v95, s[52:55], s41 offen offset:3072 lds
    s_add_u32 m0, s40, 4096
    s_mov_b32 s41, 256
    buffer_load_dwordx4 v92, s[52:55], s41 offen lds
    buffer_load_dwordx4 v93, s[52:55], s41 offen offset:1024 lds
    buffer_load_dwordx4 v94, s[52:55], s41 offen offset:2048 lds
    buffer_load_dwordx4 v95, s[52:55], s41 offen offset:3072 lds
    s_add_u32 m0, s40, 8192
    s_mov_b32 s41, 512
    buffer_load_dwordx4 v92, s[52:55], s41 offen lds
    buffer_load_dwordx4 v93, s[52:55], s41 offen offset:1024 lds
    buffer_load_dwordx4 v94, s[52:55], s41 offen offset:2048 lds
    buffer_load_dwordx4 v95, s[52:55], s41 offen offset:3072 lds
    s_add_u32 m0, s40, 12288
    s_mov_b32 s41, 768
    buffer_load_dwordx4 v92, s[52:55], s41 offen lds
    buffer_load_dwordx4 v93, s[52:55], s41 offen offset:1024 lds
    buffer_load_dwordx4 v94, s[52:55], s41 offen offset:2048 lds
    buffer_load_dwordx4 v95, s[52:55], s41 offen offset:3072 lds
    s_mov_b64 s[28:29], s[24:25]
    s_mov_b32 s30, 268435456
    s_mov_b32 s31, 0x20000
    s_load_dword s34, s[28:29], 0
    s_mov_b64 s[44:45], s[14:15]
    s_mov_b32 s46, 2211840
    s_mov_b32 s47, 0x20000
    s_mov_b64 s[48:49], s[18:19]
    s_mov_b32 s50, 2211840
    s_mov_b32 s51, 0x20000
    v_and_b32 v8, 1, v2
    v_lshlrev_b32 v8, 1, v8
    v_xor_b32 v8, v8, v6
    v_lshlrev_b32 v8, 4, v8
    v_mul_u32_u24 v9, 3456, v5
    s_lshl_b32 s38, s32, 7
    v_add3_u32 v18, v9, v8, s38
    v_xor_b32 v19, 64, v18
    v_add_u32 v19, 26624, v19
    v_add_u32 v20, 53248, v18
    v_add_u32 v21, 53248, v19
    s_mul_i32 s42, s26, 110592
    v_mul_u32_u24 v9, 1280, v5
    v_add_u32 v22, v9, v8
    v_xor_b32 v23, 64, v22
    v_add_u32 v23, 9216, v23
    v_add_u32 v24, 18432, v22
    v_add_u32 v25, 18432, v23
    s_mul_i32 s43, s32, 81920
    s_lshl_b32 s38, s3, 7
    s_add_u32 s43, s43, s38
    v_mov_b32 v96, 0x3f803f80
    v_mov_b32 v97, 0x3f803f80
    v_mov_b32 v98, 0x3f803f80
    v_mov_b32 v99, 0x3f803f80
    v_lshlrev_b32 v100, 4, v2
    v_add_u32 v100, 131072, v100
    v_lshrrev_b32 v10, 1, v3
    v_xor_b32 v10, v10, v2
    v_lshlrev_b32 v10, 4, v10
    v_lshl_add_u32 v10, v3, 7, v10
    v_add_u32 v102, s40, v10
    v_xor_b32 v103, 64, v102
    s_mov_b32 s58, 0xaaaaaaaa
    s_mov_b32 s59, 0xaaaaaaaa
    s_mov_b32 s64, 0xcccccccc
    s_mov_b32 s65, 0xcccccccc
    v_lshrrev_b32 v101, 2, v3
    v_lshl_add_u32 v101, v101, 4, v3
    v_lshlrev_b32 v101, 2, v101
    s_lshl_b32 s36, s26, 4
    v_add_u32 v10, s36, v3
    s_lshl_b32 s37, s33, 6
    s_sub_u32 s37, 2047, s37
    v_sub_u32 v106, s37, v10
    v_lshlrev_b32 v107, 2, v10
    v_add_u32 v107, 132608, v107
    s_lshl_b32 s36, s33, 9
    s_add_u32 s36, s36, 8192000
    v_lshl_add_u32 v108, v10, 3, s36
    v_bfe_u32 v10, v1, 2, 2
    v_and_b32 v8, 3, v1
    v_lshl_add_u32 v14, v2, 3, v10
    v_lshlrev_b32 v14, 7, v14
    v_lshlrev_b32 v9, 2, v1
    v_and_b32 v9, 0x60, v9
    v_add3_u32 v14, v14, v9, s40
    v_lshl_add_u32 v14, v8, 3, v14
    v_xor_b32 v15, 32, v14
    v_xor_b32 v16, 64, v14
    v_xor_b32 v17, 96, v14
    s_lshl_b32 s36, s26, 6
    s_add_u32 s36, s36, 141312
    v_lshl_add_u32 v26, v2, 4, s36
    v_min_u32 v8, 2, v3
    v_mul_u32_u24 v8, 1536, v8
    v_add_u32 v26, v26, v8
    v_add_u32 v4, 132864, v12
    v_mov_b32 v5, 0
    ds_write_b32 v4, v5
    s_waitcnt lgkmcnt(0)
    s_add_u32 s34, s34, 0x9e3779b8
    s_or_b32 s34, s34, 1
    s_waitcnt vmcnt(12)
    ds_read_b128 a[80:83], v102 offset:0
    ds_read_b128 a[84:87], v100 offset:0
    ds_read_b128 a[88:91], v103 offset:0
    ds_read_b128 a[92:95], v100 offset:64
    ds_read_b128 a[96:99], v102 offset:2048
    ds_read_b128 a[100:103], v100 offset:128
    ds_read_b128 a[104:107], v103 offset:2048
    ds_read_b128 a[108:111], v100 offset:192
    s_waitcnt lgkmcnt(0)
    s_add_u32 m0, s40, 0
    s_mov_b32 s41, 1024
    buffer_load_dwordx4 v92, s[52:55], s41 offen lds
    buffer_load_dwordx4 v93, s[52:55], s41 offen offset:1024 lds
    buffer_load_dwordx4 v94, s[52:55], s41 offen offset:2048 lds
    buffer_load_dwordx4 v95, s[52:55], s41 offen offset:3072 lds
    s_barrier
    v_mfma_f32_16x16x32_bf16 v[116:119], a[80:83], a[80:83], 0
    v_mfma_f32_16x16x32_bf16 v[112:115], v[96:99], a[80:83], 0
    v_mfma_f32_16x16x32_bf16 v[120:123], a[84:87], a[80:83], 0
    v_mfma_f32_16x16x32_bf16 v[124:127], a[84:87], v[96:99], 0
    v_mfma_f32_16x16x32_bf16 v[116:119], a[88:91], a[88:91], v[116:119]
    v_mfma_f32_16x16x32_bf16 v[112:115], v[96:99], a[88:91], v[112:115]
    v_mfma_f32_16x16x32_bf16 v[120:123], a[92:95], a[88:91], v[120:123]
    v_mfma_f32_16x16x32_bf16 v[124:127], a[92:95], v[96:99], v[124:127]
    v_mfma_f32_16x16x32_bf16 v[116:119], a[96:99], a[96:99], v[116:119]
    v_mfma_f32_16x16x32_bf16 v[112:115], v[96:99], a[96:99], v[112:115]
    v_mfma_f32_16x16x32_bf16 v[120:123], a[100:103], a[96:99], v[120:123]
    v_mfma_f32_16x16x32_bf16 v[124:127], a[100:103], v[96:99], v[124:127]
    v_mfma_f32_16x16x32_bf16 v[116:119], a[104:107], a[104:107], v[116:119]
    v_mfma_f32_16x16x32_bf16 v[112:115], v[96:99], a[104:107], v[112:115]
    v_mfma_f32_16x16x32_bf16 v[120:123], a[108:111], a[104:107], v[120:123]
    v_mfma_f32_16x16x32_bf16 v[124:127], a[108:111], v[96:99], v[124:127]
    s_waitcnt vmcnt(12)
    ds_read_b128 a[80:83], v102 offset:4096
    ds_read_b128 a[84:87], v100 offset:256
    ds_read_b128 a[88:91], v103 offset:4096
    ds_read_b128 a[92:95], v100 offset:320
    ds_read_b128 a[96:99], v102 offset:6144
    ds_read_b128 a[100:103], v100 offset:384
    ds_read_b128 a[104:107], v103 offset:6144
    ds_read_b128 a[108:111], v100 offset:448
    s_waitcnt lgkmcnt(0)
    v_mfma_f32_16x16x32_bf16 v[116:119], a[80:83], a[80:83], v[116:119]
    v_mfma_f32_16x16x32_bf16 v[112:115], v[96:99], a[80:83], v[112:115]
    v_mfma_f32_16x16x32_bf16 v[120:123], a[84:87], a[80:83], v[120:123]
    v_mfma_f32_16x16x32_bf16 v[124:127], a[84:87], v[96:99], v[124:127]
    v_mfma_f32_16x16x32_bf16 v[116:119], a[88:91], a[88:91], v[116:119]
    v_mfma_f32_16x16x32_bf16 v[112:115], v[96:99], a[88:91], v[112:115]
    v_mfma_f32_16x16x32_bf16 v[120:123], a[92:95], a[88:91], v[120:123]
    v_mfma_f32_16x16x32_bf16 v[124:127], a[92:95], v[96:99], v[124:127]
    v_mfma_f32_16x16x32_bf16 v[116:119], a[96:99], a[96:99], v[116:119]
    v_mfma_f32_16x16x32_bf16 v[112:115], v[96:99], a[96:99], v[112:115]
    v_mfma_f32_16x16x32_bf16 v[120:123], a[100:103], a[96:99], v[120:123]
    v_mfma_f32_16x16x32_bf16 v[124:127], a[100:103], v[96:99], v[124:127]
    v_mfma_f32_16x16x32_bf16 v[116:119], a[104:107], a[104:107], v[116:119]
    v_mfma_f32_16x16x32_bf16 v[112:115], v[96:99], a[104:107], v[112:115]
    v_mfma_f32_16x16x32_bf16 v[120:123], a[108:111], a[104:107], v[120:123]
    v_mfma_f32_16x16x32_bf16 v[124:127], a[108:111], v[96:99], v[124:127]
    s_waitcnt vmcnt(8)
    ds_read_b128 a[80:83], v102 offset:8192
    ds_read_b128 a[84:87], v100 offset:512
    ds_read_b128 a[88:91], v103 offset:8192
    ds_read_b128 a[92:95], v100 offset:576
    ds_read_b128 a[96:99], v102 offset:10240
    ds_read_b128 a[100:103], v100 offset:640
    ds_read_b128 a[104:107], v103 offset:10240
    ds_read_b128 a[108:111], v100 offset:704
    s_waitcnt lgkmcnt(0)
    v_mfma_f32_16x16x32_bf16 v[116:119], a[80:83], a[80:83], v[116:119]
    v_mfma_f32_16x16x32_bf16 v[112:115], v[96:99], a[80:83], v[112:115]
    v_mfma_f32_16x16x32_bf16 v[120:123], a[84:87], a[80:83], v[120:123]
    v_mfma_f32_16x16x32_bf16 v[124:127], a[84:87], v[96:99], v[124:127]
    v_mfma_f32_16x16x32_bf16 v[116:119], a[88:91], a[88:91], v[116:119]
    v_mfma_f32_16x16x32_bf16 v[112:115], v[96:99], a[88:91], v[112:115]
    v_mfma_f32_16x16x32_bf16 v[120:123], a[92:95], a[88:91], v[120:123]
    v_mfma_f32_16x16x32_bf16 v[124:127], a[92:95], v[96:99], v[124:127]
    v_mfma_f32_16x16x32_bf16 v[116:119], a[96:99], a[96:99], v[116:119]
    v_mfma_f32_16x16x32_bf16 v[112:115], v[96:99], a[96:99], v[112:115]
    v_mfma_f32_16x16x32_bf16 v[120:123], a[100:103], a[96:99], v[120:123]
    v_mfma_f32_16x16x32_bf16 v[124:127], a[100:103], v[96:99], v[124:127]
    v_mfma_f32_16x16x32_bf16 v[116:119], a[104:107], a[104:107], v[116:119]
    v_mfma_f32_16x16x32_bf16 v[112:115], v[96:99], a[104:107], v[112:115]
    v_mfma_f32_16x16x32_bf16 v[120:123], a[108:111], a[104:107], v[120:123]
    v_mfma_f32_16x16x32_bf16 v[124:127], a[108:111], v[96:99], v[124:127]
    s_waitcnt vmcnt(4)
    ds_read_b128 a[80:83], v102 offset:12288
    ds_read_b128 a[84:87], v100 offset:768
    ds_read_b128 a[88:91], v103 offset:12288
    ds_read_b128 a[92:95], v100 offset:832
    ds_read_b128 a[96:99], v102 offset:14336
    ds_read_b128 a[100:103], v100 offset:896
    ds_read_b128 a[104:107], v103 offset:14336
    ds_read_b128 a[108:111], v100 offset:960
    s_waitcnt lgkmcnt(0)
    v_mfma_f32_16x16x32_bf16 v[116:119], a[80:83], a[80:83], v[116:119]
    v_mfma_f32_16x16x32_bf16 v[112:115], v[96:99], a[80:83], v[112:115]
    v_mfma_f32_16x16x32_bf16 v[120:123], a[84:87], a[80:83], v[120:123]
    v_mfma_f32_16x16x32_bf16 v[124:127], a[84:87], v[96:99], v[124:127]
    v_mfma_f32_16x16x32_bf16 v[116:119], a[88:91], a[88:91], v[116:119]
    v_mfma_f32_16x16x32_bf16 v[112:115], v[96:99], a[88:91], v[112:115]
    v_mfma_f32_16x16x32_bf16 v[120:123], a[92:95], a[88:91], v[120:123]
    v_mfma_f32_16x16x32_bf16 v[124:127], a[92:95], v[96:99], v[124:127]
    v_mfma_f32_16x16x32_bf16 v[116:119], a[96:99], a[96:99], v[116:119]
    v_mfma_f32_16x16x32_bf16 v[112:115], v[96:99], a[96:99], v[112:115]
    v_mfma_f32_16x16x32_bf16 v[120:123], a[100:103], a[96:99], v[120:123]
    v_mfma_f32_16x16x32_bf16 v[124:127], a[100:103], v[96:99], v[124:127]
    v_mfma_f32_16x16x32_bf16 v[116:119], a[104:107], a[104:107], v[116:119]
    v_mfma_f32_16x16x32_bf16 v[112:115], v[96:99], a[104:107], v[112:115]
    v_mfma_f32_16x16x32_bf16 v[120:123], a[108:111], a[104:107], v[120:123]
    v_mfma_f32_16x16x32_bf16 v[124:127], a[108:111], v[96:99], v[124:127]
    s_waitcnt vmcnt(0)
    ds_read_b128 a[80:83], v102 offset:0
    ds_read_b128 a[84:87], v100 offset:1024
    ds_read_b128 a[88:91], v103 offset:0
    ds_read_b128 a[92:95], v100 offset:1088
    ds_read_b128 a[96:99], v102 offset:2048
    ds_read_b128 a[100:103], v100 offset:1152
    ds_read_b128 a[104:107], v103 offset:2048
    ds_read_b128 a[108:111], v100 offset:1216
    s_waitcnt lgkmcnt(0)
    v_mfma_f32_16x16x32_bf16 v[116:119], a[80:83], a[80:83], v[116:119]
    v_mfma_f32_16x16x32_bf16 v[112:115], v[96:99], a[80:83], v[112:115]
    v_mfma_f32_16x16x32_bf16 v[120:123], a[84:87], a[80:83], v[120:123]
    v_mfma_f32_16x16x32_bf16 v[124:127], a[84:87], v[96:99], v[124:127]
    v_mfma_f32_16x16x32_bf16 v[116:119], a[88:91], a[88:91], v[116:119]
    v_mfma_f32_16x16x32_bf16 v[112:115], v[96:99], a[88:91], v[112:115]
    v_mfma_f32_16x16x32_bf16 v[120:123], a[92:95], a[88:91], v[120:123]
    v_mfma_f32_16x16x32_bf16 v[124:127], a[92:95], v[96:99], v[124:127]
    v_mfma_f32_16x16x32_bf16 v[116:119], a[96:99], a[96:99], v[116:119]
    v_mfma_f32_16x16x32_bf16 v[112:115], v[96:99], a[96:99], v[112:115]
    v_mfma_f32_16x16x32_bf16 v[120:123], a[100:103], a[96:99], v[120:123]
    v_mfma_f32_16x16x32_bf16 v[124:127], a[100:103], v[96:99], v[124:127]
    v_mfma_f32_16x16x32_bf16 v[116:119], a[104:107], a[104:107], v[116:119]
    v_mfma_f32_16x16x32_bf16 v[112:115], v[96:99], a[104:107], v[112:115]
    v_mfma_f32_16x16x32_bf16 v[120:123], a[108:111], a[104:107], v[120:123]
    v_mfma_f32_16x16x32_bf16 v[124:127], a[108:111], v[96:99], v[124:127]
    s_nop 4
    v_cndmask_b32 v4, v116, v117, s[58:59]
    v_cndmask_b32 v5, v118, v119, s[58:59]
    v_cndmask_b32 v4, v4, v5, s[64:65]
    ds_bpermute_b32 v4, v101, v4
    v_mul_f32 v5, 0xbacccccd, v112
    v_cvt_pk_bf16_f32 v104, v5, v5
    v_lshlrev_b32 v104, 16, v104
    v_mul_f32 v5, v5, v5
    v_mov_b32 v6, 0x3acccccd
    s_waitcnt lgkmcnt(0)
    v_fma_f32 v4, v4, v6, -v5
    v_max_f32 v4, 0, v4
    v_cvt_pk_bf16_f32 v4, v4, v4
    v_lshlrev_b32 v4, 16, v4
    v_add_f32 v4, 0x3727c5ac, v4
    v_cvt_pk_bf16_f32 v4, v4, v4
    v_lshlrev_b32 v4, 16, v4
    v_sqrt_f32 v4, v4
    s_nop 0
    v_cvt_pk_bf16_f32 v4, v4, v4
    v_lshlrev_b32 v4, 16, v4
    v_rcp_f32 v105, v4
    v_lshrrev_b32 v8, 16, v4
    v_fma_f32 v4, v104, v124, v120
    v_mul_f32 v4, v4, v105
    v_cvt_pk_bf16_f32 v4, v4, v4
    v_ashrrev_i32 v5, 31, v4
    v_or_b32 v5, 0x80000000, v5
    v_xor_b32 v4, v4, v5
    v_and_b32 v4, 0xffff0000, v4
    v_or_b32 v4, v4, v106
    ds_write_b32 v107, v4
    v_mov_b32 v11, 132864
    v_mov_b32 v7, 1
    s_mov_b64 exec, 1
    ds_add_u32 v11, v7
    s_mov_b64 exec, -1
    v_or_b32 v8, v8, v104
    v_mov_b32 v9, s34
    s_mov_b64 exec, 0xffff
    buffer_store_dwordx2 v[8:9], v108, s[28:31], 0 offen sc1
    s_mov_b64 exec, -1
    s_cmp_lg_u32 s26, 0
    s_cbranch_scc1 Lpub_done
    s_setprio 3
Lcw_9:
    s_sub_u32 s35, s35, 1
    s_cbranch_scc1 Lend
    ds_read_b32 v7, v11
    s_waitcnt lgkmcnt(0)
    v_readfirstlane_b32 s38, v7
    s_nop 0
    s_cmp_lt_u32 s38, 4
    s_cbranch_scc1 Lcw_9
    v_add_u32 v5, 132608, v12
    ds_read_b32 v6, v5
    s_waitcnt lgkmcnt(0)
    v_mov_b32 v4, v6
    s_nop 1
    v_max_u32_dpp v4, v4, v4 row_ror:8 row_mask:0xf bank_mask:0xf
    s_nop 1
    v_max_u32_dpp v4, v4, v4 row_ror:4 row_mask:0xf bank_mask:0xf
    s_nop 1
    v_max_u32_dpp v4, v4, v4 row_ror:2 row_mask:0xf bank_mask:0xf
    s_nop 1
    v_max_u32_dpp v4, v4, v4 row_ror:1 row_mask:0xf bank_mask:0xf
    s_nop 0
    v_readlane_b32 s66, v4, 0
    v_readlane_b32 s36, v4, 16
    v_readlane_b32 s37, v4, 32
    v_readlane_b32 s38, v4, 48
    s_max_u32 s66, s66, s36
    s_max_u32 s37, s37, s38
    s_max_u32 s66, s66, s37
    v_cmp_eq_u32 vcc, s66, v6
    s_nop 1
    v_cndmask_b32 v4, v6, 0, vcc
    s_nop 1
    v_max_u32_dpp v4, v4, v4 row_ror:8 row_mask:0xf bank_mask:0xf
    s_nop 1
    v_max_u32_dpp v4, v4, v4 row_ror:4 row_mask:0xf bank_mask:0xf
    s_nop 1
    v_max_u32_dpp v4, v4, v4 row_ror:2 row_mask:0xf bank_mask:0xf
    s_nop 1
    v_max_u32_dpp v4, v4, v4 row_ror:1 row_mask:0xf bank_mask:0xf
    s_nop 0
    v_readlane_b32 s67, v4, 0
    v_readlane_b32 s36, v4, 16
    v_readlane_b32 s37, v4, 32
    v_readlane_b32 s38, v4, 48
    s_max_u32 s67, s67, s36
    s_max_u32 s37, s37, s38
    s_max_u32 s67, s67, s37
    v_mov_b32 v112, s66
    v_mov_b32 v113, s34
    v_mov_b32 v114, s67
    v_mov_b32 v115, s34
    s_lshl_b32 s36, s32, 7
    s_add_u32 s36, s36, 8126464
    s_mov_b64 exec, 0xff
    buffer_store_dwordx4 v[112:115], v13, s[28:31], s36 offen sc1
    s_mov_b64 exec, -1
    v_mov_b32 v11, 132864
    v_mov_b32 v7, 1
    s_mov_b64 exec, 1
    ds_add_u32 v11, v7
    s_mov_b64 exec, -1
    s_mov_b64 exec, 1
    s_lshl_b32 s36, s2, 2
    s_add_u32 s36, s36, 8323072
    v_mov_b32 v4, s34
    v_mov_b32 v5, s36
    buffer_store_dword v4, v5, s[28:31], 0 offen sc1
    s_mov_b64 exec, -1
    s_setprio 0
Lpub_done:
Lcw_10:
    s_sub_u32 s35, s35, 1
    s_cbranch_scc1 Lend
    ds_read_b32 v7, v11
    s_waitcnt lgkmcnt(0)
    v_readfirstlane_b32 s38, v7
    s_nop 0
    s_cmp_lt_u32 s38, 5
    s_cbranch_scc1 Lcw_10
    s_cmp_ge_u32 s32, 27
    s_cbranch_scc1 Lhelp_r
    s_add_u32 m0, s40, 0
    s_add_u32 s41, s42, 0
    buffer_load_dwordx4 v18, s[44:47], s41 offen nt lds
    buffer_load_dwordx4 v19, s[44:47], s41 offen offset:1024 nt lds
    buffer_load_dwordx4 v20, s[44:47], s41 offen offset:2048 nt lds
    buffer_load_dwordx4 v21, s[44:47], s41 offen offset:3072 nt lds
    s_add_u32 m0, s40, 4096
    s_add_u32 s41, s42, 442368
    buffer_load_dwordx4 v18, s[44:47], s41 offen nt lds
    buffer_load_dwordx4 v19, s[44:47], s41 offen offset:1024 nt lds
    buffer_load_dwordx4 v20, s[44:47], s41 offen offset:2048 nt lds
    buffer_load_dwordx4 v21, s[44:47], s41 offen offset:3072 nt lds
    s_add_u32 m0, s40, 8192
    s_add_u32 s41, s42, 884736
    buffer_load_dwordx4 v18, s[44:47], s41 offen nt lds
    buffer_load_dwordx4 v19, s[44:47], s41 offen offset:1024 nt lds
    buffer_load_dwordx4 v20, s[44:47], s41 offen offset:2048 nt lds
    buffer_load_dwordx4 v21, s[44:47], s41 offen offset:3072 nt lds
    s_add_u32 m0, s40, 12288
    s_add_u32 s41, s42, 1327104
    buffer_load_dwordx4 v18, s[44:47], s41 offen nt lds
    buffer_load_dwordx4 v19, s[44:47], s41 offen offset:1024 nt lds
    buffer_load_dwordx4 v20, s[44:47], s41 offen offset:2048 nt lds
    buffer_load_dwordx4 v21, s[44:47], s41 offen offset:3072 nt lds
    s_waitcnt vmcnt(12)
    ds_read_b64_tr_b16 a[0:1], v14 offset:0
    ds_read_b64_tr_b16 a[2:3], v14 offset:512
    ds_read_b64_tr_b16 a[4:5], v15 offset:0
    ds_read_b64_tr_b16 a[6:7], v15 offset:512
    ds_read_b64_tr_b16 a[8:9], v16 offset:0
    ds_read_b64_tr_b16 a[10:11], v16 offset:512
    ds_read_b64_tr_b16 a[12:13], v17 offset:0
    ds_read_b64_tr_b16 a[14:15], v17 offset:512
    s_waitcnt lgkmcnt(0)
    s_add_u32 m0, s40, 0
    s_add_u32 s41, s42, 1769472
    buffer_load_dwordx4 v18, s[44:47], s41 offen nt lds
    buffer_load_dwordx4 v19, s[44:47], s41 offen offset:1024 nt lds
    buffer_load_dwordx4 v20, s[44:47], s41 offen offset:2048 nt lds
    buffer_load_dwordx4 v21, s[44:47], s41 offen offset:3072 nt lds
    v_mov_b32 v11, 132864
    v_mov_b32 v7, 1
    s_mov_b64 exec, 1
    ds_add_u32 v11, v7
    s_mov_b64 exec, -1
    s_waitcnt vmcnt(12)
    ds_read_b64_tr_b16 a[16:17], v14 offset:4096
    ds_read_b64_tr_b16 a[18:19], v14 offset:4608
    ds_read_b64_tr_b16 a[20:21], v15 offset:4096
    ds_read_b64_tr_b16 a[22:23], v15 offset:4608
    ds_read_b64_tr_b16 a[24:25], v16 offset:4096
    ds_read_b64_tr_b16 a[26:27], v16 offset:4608
    ds_read_b64_tr_b16 a[28:29], v17 offset:4096
    ds_read_b64_tr_b16 a[30:31], v17 offset:4608
    s_waitcnt lgkmcnt(0)
    s_add_u32 m0, s40, 4096
    s_add_u32 s41, s43, 0
    buffer_load_dwordx4 v22, s[48:51], s41 offen nt lds
    buffer_load_dwordx4 v23, s[48:51], s41 offen offset:1024 nt lds
    buffer_load_dwordx4 v24, s[48:51], s41 offen offset:2048 nt lds
    buffer_load_dwordx4 v25, s[48:51], s41 offen offset:3072 nt lds
    s_waitcnt vmcnt(12)
    ds_read_b64_tr_b16 a[32:33], v14 offset:8192
    ds_read_b64_tr_b16 a[34:35], v14 offset:8704
    ds_read_b64_tr_b16 a[36:37], v15 offset:8192
    ds_read_b64_tr_b16 a[38:39], v15 offset:8704
    ds_read_b64_tr_b16 a[40:41], v16 offset:8192
    ds_read_b64_tr_b16 a[42:43], v16 offset:8704
    ds_read_b64_tr_b16 a[44:45], v17 offset:8192
    ds_read_b64_tr_b16 a[46:47], v17 offset:8704
    s_waitcnt lgkmcnt(0)
    s_add_u32 m0, s40, 8192
    s_add_u32 s41, s43, 40960
    buffer_load_dwordx4 v22, s[48:51], s41 offen nt lds
    buffer_load_dwordx4 v23, s[48:51], s41 offen offset:1024 nt lds
    buffer_load_dwordx4 v24, s[48:51], s41 offen offset:2048 nt lds
    buffer_load_dwordx4 v25, s[48:51], s41 offen offset:3072 nt lds
    s_waitcnt vmcnt(12)
    ds_read_b64_tr_b16 a[48:49], v14 offset:12288
    ds_read_b64_tr_b16 a[50:51], v14 offset:12800
    ds_read_b64_tr_b16 a[52:53], v15 offset:12288
    ds_read_b64_tr_b16 a[54:55], v15 offset:12800
    ds_read_b64_tr_b16 a[56:57], v16 offset:12288
    ds_read_b64_tr_b16 a[58:59], v16 offset:12800
    ds_read_b64_tr_b16 a[60:61], v17 offset:12288
    ds_read_b64_tr_b16 a[62:63], v17 offset:12800
    s_waitcnt vmcnt(8)
    ds_read_b64_tr_b16 a[64:65], v14 offset:0
    ds_read_b64_tr_b16 a[66:67], v14 offset:512
    ds_read_b64_tr_b16 a[68:69], v15 offset:0
    ds_read_b64_tr_b16 a[70:71], v15 offset:512
    ds_read_b64_tr_b16 a[72:73], v16 offset:0
    ds_read_b64_tr_b16 a[74:75], v16 offset:512
    ds_read_b64_tr_b16 a[76:77], v17 offset:0
    ds_read_b64_tr_b16 a[78:79], v17 offset:512
    s_branch Laux_mm
Laux_u:
    s_cmp_ge_u32 s32, 27
    s_cbranch_scc1 Lend
    v_and_b32 v8, 1, v2
    v_lshlrev_b32 v8, 1, v8
    v_xor_b32 v8, v8, v6
    v_lshlrev_b32 v8, 4, v8
    v_mul_u32_u24 v9, 3456, v5
    s_lshl_b32 s38, s32, 7
    v_add3_u32 v18, v9, v8, s38
    v_xor_b32 v19, 64, v18
    v_add_u32 v19, 26624, v19
    v_add_u32 v20, 53248, v18
    v_add_u32 v21, 53248, v19
    s_mul_i32 s42, s26, 110592
    v_mul_u32_u24 v9, 1280, v5
    v_add_u32 v22, v9, v8
    v_xor_b32 v23, 64, v22
    v_add_u32 v23, 9216, v23
    v_add_u32 v24, 18432, v22
    v_add_u32 v25, 18432, v23
    s_mul_i32 s43, s32, 81920
    s_lshl_b32 s38, s3, 7
    s_add_u32 s43, s43, s38
    s_waitcnt lgkmcnt(0)
    s_mov_b64 s[44:45], s[16:17]
    s_mov_b32 s46, 2211840
    s_mov_b32 s47, 0x20000
    s_mov_b64 s[28:29], s[24:25]
    s_mov_b32 s30, 268435456
    s_mov_b32 s31, 0x20000
    s_load_dword s34, s[28:29], 0
    s_mov_b64 s[52:53], s[4:5]
    s_mov_b32 s54, 2621440
    s_mov_b32 s55, 0x20000
    s_mov_b64 s[48:49], s[18:19]
    s_mov_b32 s50, 2211840
    s_mov_b32 s51, 0x20000
    s_mov_b64 s[68:69], s[18:19]
    s_mov_b32 s70, 2211840
    s_mov_b32 s71, 0x20000
    s_cmp_ge_u32 s26, 2
    s_cselect_b32 s70, 0, s70
    v_bfe_u32 v10, v1, 2, 2
    v_and_b32 v8, 3, v1
    v_lshl_add_u32 v14, v2, 3, v10
    v_lshlrev_b32 v14, 7, v14
    v_lshlrev_b32 v9, 2, v1
    v_and_b32 v9, 0x60, v9
    v_add3_u32 v14, v14, v9, s40
    v_lshl_add_u32 v14, v8, 3, v14
    v_xor_b32 v15, 32, v14
    v_xor_b32 v16, 64, v14
    v_xor_b32 v17, 96, v14
    s_lshl_b32 s36, s26, 6
    s_add_u32 s36, s36, 141312
    v_lshl_add_u32 v26, v2, 4, s36
    v_min_u32 v8, 2, v3
    v_mul_u32_u24 v8, 1536, v8
    v_add_u32 v26, v26, v8
    s_waitcnt lgkmcnt(0)
    s_add_u32 s34, s34, 0x9e3779b8
    s_or_b32 s34, s34, 1
    s_cmp_lg_u32 s3, 7
    s_cbranch_scc1 Lnop7
    s_setprio 3
Lnop7:
    s_barrier
    s_add_u32 m0, s40, 0
    s_add_u32 s41, s42, 0
    buffer_load_dwordx4 v18, s[44:47], s41 offen nt lds
    buffer_load_dwordx4 v19, s[44:47], s41 offen offset:1024 nt lds
    buffer_load_dwordx4 v20, s[44:47], s41 offen offset:2048 nt lds
    buffer_load_dwordx4 v21, s[44:47], s41 offen offset:3072 nt lds
    s_add_u32 m0, s40, 4096
    s_add_u32 s41, s42, 442368
    buffer_load_dwordx4 v18, s[44:47], s41 offen nt lds
    buffer_load_dwordx4 v19, s[44:47], s41 offen offset:1024 nt lds
    buffer_load_dwordx4 v20, s[44:47], s41 offen offset:2048 nt lds
    buffer_load_dwordx4 v21, s[44:47], s41 offen offset:3072 nt lds
    s_add_u32 m0, s40, 8192
    s_add_u32 s41, s42, 884736
    buffer_load_dwordx4 v18, s[44:47], s41 offen nt lds
    buffer_load_dwordx4 v19, s[44:47], s41 offen offset:1024 nt lds
    buffer_load_dwordx4 v20, s[44:47], s41 offen offset:2048 nt lds
    buffer_load_dwordx4 v21, s[44:47], s41 offen offset:3072 nt lds
    s_add_u32 m0, s40, 12288
    s_add_u32 s41, s42, 1327104
    buffer_load_dwordx4 v18, s[44:47], s41 offen nt lds
    buffer_load_dwordx4 v19, s[44:47], s41 offen offset:1024 nt lds
    buffer_load_dwordx4 v20, s[44:47], s41 offen offset:2048 nt lds
    buffer_load_dwordx4 v21, s[44:47], s41 offen offset:3072 nt lds
    v_mov_b32 v11, 132864
Lcw_11:
    s_sub_u32 s35, s35, 1
    s_cbranch_scc1 Lend
    s_sleep 4
    ds_read_b32 v7, v11
    s_waitcnt lgkmcnt(0)
    v_readfirstlane_b32 s38, v7
    s_nop 0
    s_cmp_lt_u32 s38, 5
    s_cbranch_scc1 Lcw_11
    s_waitcnt vmcnt(12)
    ds_read_b64_tr_b16 a[0:1], v14 offset:0
    ds_read_b64_tr_b16 a[2:3], v14 offset:512
    ds_read_b64_tr_b16 a[4:5], v15 offset:0
    ds_read_b64_tr_b16 a[6:7], v15 offset:512
    ds_read_b64_tr_b16 a[8:9], v16 offset:0
    ds_read_b64_tr_b16 a[10:11], v16 offset:512
    ds_read_b64_tr_b16 a[12:13], v17 offset:0
    ds_read_b64_tr_b16 a[14:15], v17 offset:512
    s_waitcnt lgkmcnt(0)
    s_add_u32 m0, s40, 0
    s_add_u32 s41, s42, 1769472
    buffer_load_dwordx4 v18, s[44:47], s41 offen nt lds
    buffer_load_dwordx4 v19, s[44:47], s41 offen offset:1024 nt lds
    buffer_load_dwordx4 v20, s[44:47], s41 offen offset:2048 nt lds
    buffer_load_dwordx4 v21, s[44:47], s41 offen offset:3072 nt lds
    s_waitcnt vmcnt(12)
    ds_read_b64_tr_b16 a[16:17], v14 offset:4096
    ds_read_b64_tr_b16 a[18:19], v14 offset:4608
    ds_read_b64_tr_b16 a[20:21], v15 offset:4096
    ds_read_b64_tr_b16 a[22:23], v15 offset:4608
    ds_read_b64_tr_b16 a[24:25], v16 offset:4096
    ds_read_b64_tr_b16 a[26:27], v16 offset:4608
    ds_read_b64_tr_b16 a[28:29], v17 offset:4096
    ds_read_b64_tr_b16 a[30:31], v17 offset:4608
    s_waitcnt vmcnt(8)
    ds_read_b64_tr_b16 a[32:33], v14 offset:8192
    ds_read_b64_tr_b16 a[34:35], v14 offset:8704
    ds_read_b64_tr_b16 a[36:37], v15 offset:8192
    ds_read_b64_tr_b16 a[38:39], v15 offset:8704
    ds_read_b64_tr_b16 a[40:41], v16 offset:8192
    ds_read_b64_tr_b16 a[42:43], v16 offset:8704
    ds_read_b64_tr_b16 a[44:45], v17 offset:8192
    ds_read_b64_tr_b16 a[46:47], v17 offset:8704
    s_waitcnt vmcnt(4)
    ds_read_b64_tr_b16 a[48:49], v14 offset:12288
    ds_read_b64_tr_b16 a[50:51], v14 offset:12800
    ds_read_b64_tr_b16 a[52:53], v15 offset:12288
    ds_read_b64_tr_b16 a[54:55], v15 offset:12800
    ds_read_b64_tr_b16 a[56:57], v16 offset:12288
    ds_read_b64_tr_b16 a[58:59], v16 offset:12800
    ds_read_b64_tr_b16 a[60:61], v17 offset:12288
    ds_read_b64_tr_b16 a[62:63], v17 offset:12800
    s_waitcnt vmcnt(0)
    ds_read_b64_tr_b16 a[64:65], v14 offset:0
    ds_read_b64_tr_b16 a[66:67], v14 offset:512
    ds_read_b64_tr_b16 a[68:69], v15 offset:0
    ds_read_b64_tr_b16 a[70:71], v15 offset:512
    ds_read_b64_tr_b16 a[72:73], v16 offset:0
    ds_read_b64_tr_b16 a[74:75], v16 offset:512
    ds_read_b64_tr_b16 a[76:77], v17 offset:0
    ds_read_b64_tr_b16 a[78:79], v17 offset:512
    s_cmp_lg_u32 s3, 7
    s_cbranch_scc1 Lnofx
    v_mov_b32 v92, 0x3f803f80
    v_mov_b32 v93, 0x3f803f80
    v_mov_b32 v94, 0x3f803f80
    v_mov_b32 v95, 0x3f803f80
    v_add_u32 v4, 144384, v13
    ds_write_b128 v4, v[92:95]
    ds_write_b128 v4, v[92:95] offset:1024
    v_and_b32 v120, 31, v1
    v_lshlrev_b32 v120, 7, v120
    v_add_u32 v120, 8126464, v120
Lpt_12:
    s_sub_u32 s35, s35, 1
    s_cbranch_scc1 Lend
    s_sleep 2
    buffer_load_dwordx4 v[124:127], v120, s[28:31], 0 offen sc1
    s_waitcnt vmcnt(0)
    v_cmp_ne_u32 vcc, s34, v125
    v_cmp_ne_u32 s[36:37], s34, v127
    s_nop 0
    s_or_b64 s[36:37], s[36:37], vcc
    s_cbranch_scc1 Lpt_12
    v_mov_b32 v120, v124
    s_nop 1
    v_max_u32_dpp v120, v120, v120 row_ror:8 row_mask:0xf bank_mask:0xf
    s_nop 1
    v_max_u32_dpp v120, v120, v120 row_ror:4 row_mask:0xf bank_mask:0xf
    s_nop 1
    v_max_u32_dpp v120, v120, v120 row_ror:2 row_mask:0xf bank_mask:0xf
    s_nop 1
    v_max_u32_dpp v120, v120, v120 row_ror:1 row_mask:0xf bank_mask:0xf
    s_nop 0
    v_readlane_b32 s56, v120, 0
    v_readlane_b32 s36, v120, 16
    v_readlane_b32 s37, v120, 32
    v_readlane_b32 s38, v120, 48
    s_max_u32 s56, s56, s36
    s_max_u32 s37, s37, s38
    s_max_u32 s56, s56, s37
    v_cmp_eq_u32 vcc, s56, v124
    s_nop 1
    v_cndmask_b32 v120, v124, v126, vcc
    s_nop 1
    v_max_u32_dpp v120, v120, v120 row_ror:8 row_mask:0xf bank_mask:0xf
    s_nop 1
    v_max_u32_dpp v120, v120, v120 row_ror:4 row_mask:0xf bank_mask:0xf
    s_nop 1
    v_max_u32_dpp v120, v120, v120 row_ror:2 row_mask:0xf bank_mask:0xf
    s_nop 1
    v_max_u32_dpp v120, v120, v120 row_ror:1 row_mask:0xf bank_mask:0xf
    s_nop 0
    v_readlane_b32 s57, v120, 0
    v_readlane_b32 s36, v120, 16
    v_readlane_b32 s37, v120, 32
    v_readlane_b32 s38, v120, 48
    s_max_u32 s57, s57, s36
    s_max_u32 s37, s37, s38
    s_max_u32 s57, s57, s37
    s_and_b32 s36, s56, 0x7ff
    s_sub_u32 s36, 2047, s36
    s_and_b32 s37, s57, 0x7ff
    s_sub_u32 s37, 2047, s37
    s_mul_i32 s38, s36, 1280
    s_mul_i32 s39, s37, 1280
    s_mov_b32 m0, 141312
    v_mov_b32 v4, s36
    buffer_load_dwordx4 v13, s[52:55], s38 offen lds
    s_mov_b32 m0, 142848
    v_mov_b32 v5, s37
    buffer_load_dwordx4 v13, s[52:55], s39 offen lds
    s_mov_b64 exec, 0xffff
    buffer_load_dwordx4 v13, s[52:55], s39 offen offset:1024 lds
    s_mov_b32 m0, 141312
    s_mov_b32 vcc_lo, 0xaaaaaaaa
    buffer_load_dwordx4 v13, s[52:55], s38 offen offset:1024 lds
    s_mov_b64 exec, 3
    v_cndmask_b32 v4, v4, v5, vcc
    v_lshlrev_b32 v118, 3, v4
    v_add_u32 v118, 8192000, v118
    v_add_u32 v9, 132872, v12
Lxs_chk:
    s_sub_u32 s35, s35, 1
    s_cbranch_scc1 Lend
    buffer_load_dwordx2 v[116:117], v118, s[28:31], 0 offen sc1
    s_waitcnt vmcnt(0)
    v_cmp_ne_u32 vcc, s34, v117
    s_nop 0
    s_cbranch_vccnz Lxs_chk
    ds_write_b32 v9, v116
    s_mov_b64 exec, -1
    v_mov_b32 v10, 132868
    v_mov_b32 v7, 1
    s_mov_b64 exec, 1
    ds_add_u32 v10, v7
    s_mov_b64 exec, -1
Lnofx:
Lcw_13:
    s_sub_u32 s35, s35, 1
    s_cbranch_scc1 Lend
    s_sleep 2
    ds_read_b32 v7, v11
    s_waitcnt lgkmcnt(0)
    v_readfirstlane_b32 s38, v7
    s_nop 0
    s_cmp_lt_u32 s38, 9
    s_cbranch_scc1 Lcw_13
    s_add_u32 m0, s40, 4096
    s_add_u32 s41, s43, 0
    buffer_load_dwordx4 v22, s[48:51], s41 offen nt lds
    buffer_load_dwordx4 v23, s[48:51], s41 offen offset:1024 nt lds
    buffer_load_dwordx4 v24, s[48:51], s41 offen offset:2048 nt lds
    buffer_load_dwordx4 v25, s[48:51], s41 offen offset:3072 nt lds
    s_add_u32 m0, s40, 8192
    s_add_u32 s41, s43, 40960
    buffer_load_dwordx4 v22, s[48:51], s41 offen nt lds
    buffer_load_dwordx4 v23, s[48:51], s41 offen offset:1024 nt lds
    buffer_load_dwordx4 v24, s[48:51], s41 offen offset:2048 nt lds
    buffer_load_dwordx4 v25, s[48:51], s41 offen offset:3072 nt lds
    s_add_u32 m0, s40, 12288
    s_add_u32 s41, s43, 512
    buffer_load_dwordx4 v22, s[68:71], s41 offen nt lds
    buffer_load_dwordx4 v23, s[68:71], s41 offen offset:1024 nt lds
    buffer_load_dwordx4 v24, s[68:71], s41 offen offset:2048 nt lds
    buffer_load_dwordx4 v25, s[68:71], s41 offen offset:3072 nt lds
    s_add_u32 m0, s40, 0
    s_add_u32 s41, s43, 41472
    buffer_load_dwordx4 v22, s[68:71], s41 offen nt lds
    buffer_load_dwordx4 v23, s[68:71], s41 offen offset:1024 nt lds
    buffer_load_dwordx4 v24, s[68:71], s41 offen offset:2048 nt lds
    buffer_load_dwordx4 v25, s[68:71], s41 offen offset:3072 nt lds
Laux_mm:
    v_mov_b32 v10, 132868
Lcw_14:
    s_sub_u32 s35, s35, 1
    s_cbranch_scc1 Lend
    s_sleep 1
    ds_read_b32 v7, v10
    s_waitcnt lgkmcnt(0)
    v_readfirstlane_b32 s38, v7
    s_nop 0
    s_cmp_lt_u32 s38, 1
    s_cbranch_scc1 Lcw_14
    ds_read_b128 v[92:95], v26 offset:0
    ds_read_b128 v[96:99], v26 offset:256
    ds_read_b128 v[100:103], v26 offset:512
    ds_read_b128 v[104:107], v26 offset:768
    ds_read_b128 v[108:111], v26 offset:1024
    ds_read_b64 v[116:117], v10 offset:4
    s_waitcnt lgkmcnt(0)
    v_readfirstlane_b32 s56, v116
    v_readfirstlane_b32 s57, v117
    v_mfma_f32_16x16x32_bf16 v[112:115], a[0:3], v[92:95], 0
    v_mfma_f32_16x16x32_bf16 v[116:119], a[4:7], v[92:95], 0
    v_mfma_f32_16x16x32_bf16 v[120:123], a[8:11], v[92:95], 0
    v_mfma_f32_16x16x32_bf16 v[124:127], a[12:15], v[92:95], 0
    v_mfma_f32_16x16x32_bf16 v[112:115], a[16:19], v[96:99], v[112:115]
    v_mfma_f32_16x16x32_bf16 v[116:119], a[20:23], v[96:99], v[116:119]
    v_mfma_f32_16x16x32_bf16 v[120:123], a[24:27], v[96:99], v[120:123]
    v_mfma_f32_16x16x32_bf16 v[124:127], a[28:31], v[96:99], v[124:127]
    v_mfma_f32_16x16x32_bf16 v[112:115], a[32:35], v[100:103], v[112:115]
    v_mfma_f32_16x16x32_bf16 v[116:119], a[36:39], v[100:103], v[116:119]
    v_mfma_f32_16x16x32_bf16 v[120:123], a[40:43], v[100:103], v[120:123]
    v_mfma_f32_16x16x32_bf16 v[124:127], a[44:47], v[100:103], v[124:127]
    v_mfma_f32_16x16x32_bf16 v[112:115], a[48:51], v[104:107], v[112:115]
    v_mfma_f32_16x16x32_bf16 v[116:119], a[52:55], v[104:107], v[116:119]
    v_mfma_f32_16x16x32_bf16 v[120:123], a[56:59], v[104:107], v[120:123]
    v_mfma_f32_16x16x32_bf16 v[124:127], a[60:63], v[104:107], v[124:127]
    v_mfma_f32_16x16x32_bf16 v[112:115], a[64:67], v[108:111], v[112:115]
    v_mfma_f32_16x16x32_bf16 v[116:119], a[68:71], v[108:111], v[116:119]
    v_mfma_f32_16x16x32_bf16 v[120:123], a[72:75], v[108:111], v[120:123]
    v_mfma_f32_16x16x32_bf16 v[124:127], a[76:79], v[108:111], v[124:127]
    s_mul_i32 s36, s3, 768
    s_add_u32 s36, s36, 133120
    v_lshlrev_b32 v4, 8, v3
    v_lshl_add_u32 v4, v2, 4, v4
    v_add_u32 v4, s36, v4
    v_add_u32 v5, 133120, v12
    s_lshl_b32 s37, s3, 8
    s_add_u32 s37, s37, 139264
    v_lshl_add_u32 v6, v1, 1, s37
    v_and_b32 v7, 1, v1
    v_lshlrev_b32 v7, 7, v7
    v_lshl_add_u32 v7, v2, 4, v7
    v_add_u32 v7, s37, v7
    s_lshl_b32 s38, s56, 16
    s_lshl_b32 s39, s57, 16
    v_rcp_f32 v8, s38
    v_rcp_f32 v9, s39
    s_and_b32 s56, s56, 0xffff0000
    s_and_b32 s57, s57, 0xffff0000
    s_mov_b32 exec_lo, 0x00070007
    s_mov_b32 exec_hi, 0x00070007
    ds_write_b128 v4, v[112:115] offset:0
    ds_write_b128 v4, v[116:119] offset:64
    ds_write_b128 v4, v[120:123] offset:128
    ds_write_b128 v4, v[124:127] offset:192
    s_mov_b64 exec, -1
    s_waitcnt lgkmcnt(0)
    s_barrier
    ds_read2st64_b32 v[92:93], v5 offset0:0 offset1:1
    ds_read2st64_b32 v[94:95], v5 offset0:2 offset1:3
    ds_read2st64_b32 v[96:97], v5 offset0:4 offset1:5
    ds_read2st64_b32 v[98:99], v5 offset0:6 offset1:7
    ds_read2st64_b32 v[100:101], v5 offset0:8 offset1:9
    ds_read2st64_b32 v[102:103], v5 offset0:10 offset1:11
    ds_read2st64_b32 v[116:117], v5 offset0:12 offset1:13
    ds_read2st64_b32 v[118:119], v5 offset0:14 offset1:15
    ds_read2st64_b32 v[120:121], v5 offset0:16 offset1:17
    ds_read2st64_b32 v[122:123], v5 offset0:18 offset1:19
    ds_read2st64_b32 v[124:125], v5 offset0:20 offset1:21
    ds_read2st64_b32 v[126:127], v5 offset0:22 offset1:23
    v_cmp_eq_u32 s[72:73], 1, v2
    v_cmp_eq_u32 s[74:75], 2, v2
    v_cmp_eq_u32 s[76:77], 3, v2
    s_mul_i32 s37, s32, 10
    s_add_u32 s37, s37, s3
    s_lshl_b32 s37, s37, 10
    s_add_u32 s37, s37, 7405568
    s_waitcnt lgkmcnt(0)
    v_add_f32 v92, v92, v95
    v_add_f32 v98, v98, v101
    v_add_f32 v92, v92, v98
    v_add_f32 v93, v93, v96
    v_add_f32 v99, v99, v102
    v_add_f32 v93, v93, v99
    v_add_f32 v94, v94, v97
    v_add_f32 v100, v100, v103
    v_add_f32 v94, v94, v100
    v_add_f32 v116, v116, v119
    v_add_f32 v122, v122, v125
    v_add_f32 v116, v116, v122
    v_add_f32 v117, v117, v120
    v_add_f32 v123, v123, v126
    v_add_f32 v117, v117, v123
    v_add_f32 v118, v118, v121
    v_add_f32 v124, v124, v127
    v_add_f32 v118, v118, v124
    v_fmac_f32 v92, s56, v94
    v_mul_f32 v112, v92, v8
    v_fmac_f32 v93, s57, v94
    v_mul_f32 v113, v93, v9
    v_fmac_f32 v116, s56, v118
    v_mul_f32 v120, v116, v8
    v_fmac_f32 v117, s57, v118
    v_mul_f32 v121, v117, v9
    v_cvt_pk_bf16_f32 v113, v112, v113
    v_lshlrev_b32 v112, 16, v113
    v_and_b32 v113, 0xffff0000, v113
    v_cvt_pk_bf16_f32 v121, v120, v121
    v_lshlrev_b32 v120, 16, v121
    v_and_b32 v121, 0xffff0000, v121
    v_mul_f32 v114, 0xbfb8aa3b, v112
    v_mul_f32 v115, 0xbfb8aa3b, v113
    v_exp_f32 v114, v114
    v_exp_f32 v115, v115
    v_add_f32 v114, 1.0, v114
    v_add_f32 v115, 1.0, v115
    v_rcp_f32 v114, v114
    v_rcp_f32 v115, v115
    v_mul_f32 v114, v114, v112
    v_mul_f32 v115, v115, v113
    v_cvt_pk_bf16_f32 v115, v114, v115
    v_lshlrev_b32 v114, 16, v115
    v_and_b32 v115, 0xffff0000, v115
    v_mul_f32 v114, v114, v120
    v_mul_f32 v115, v115, v121
    v_cvt_pk_bf16_f32 v114, v114, v115
    ds_write_b16 v6, v114
    ds_write_b16_d16_hi v6, v114 offset:128
    ds_read_b128 v[92:95], v7 offset:0
    ds_read_b128 v[96:99], v7 offset:64
    v_mov_b32 v101, s34
    v_mov_b32 v103, s34
    s_waitcnt vmcnt(0)
    ds_read_b64_tr_b16 v[28:29], v14 offset:4096
    ds_read_b64_tr_b16 v[30:31], v14 offset:4608
    ds_read_b64_tr_b16 v[32:33], v15 offset:4096
    ds_read_b64_tr_b16 v[34:35], v15 offset:4608
    ds_read_b64_tr_b16 v[36:37], v16 offset:4096
    ds_read_b64_tr_b16 v[38:39], v16 offset:4608
    ds_read_b64_tr_b16 v[40:41], v17 offset:4096
    ds_read_b64_tr_b16 v[42:43], v17 offset:4608
    ds_read_b64_tr_b16 v[44:45], v14 offset:8192
    ds_read_b64_tr_b16 v[46:47], v14 offset:8704
    ds_read_b64_tr_b16 v[48:49], v15 offset:8192
    ds_read_b64_tr_b16 v[50:51], v15 offset:8704
    ds_read_b64_tr_b16 v[52:53], v16 offset:8192
    ds_read_b64_tr_b16 v[54:55], v16 offset:8704
    ds_read_b64_tr_b16 v[56:57], v17 offset:8192
    ds_read_b64_tr_b16 v[58:59], v17 offset:8704
    s_waitcnt lgkmcnt(0)
    v_mfma_f32_16x16x32_bf16 v[112:115], v[92:95], v[28:31], 0
    v_mfma_f32_16x16x32_bf16 v[116:119], v[92:95], v[32:35], 0
    v_mfma_f32_16x16x32_bf16 v[120:123], v[92:95], v[36:39], 0
    v_mfma_f32_16x16x32_bf16 v[124:127], v[92:95], v[40:43], 0
    v_mfma_f32_16x16x32_bf16 v[112:115], v[96:99], v[44:47], v[112:115]
    v_mfma_f32_16x16x32_bf16 v[116:119], v[96:99], v[48:51], v[116:119]
    v_mfma_f32_16x16x32_bf16 v[120:123], v[96:99], v[52:55], v[120:123]
    v_mfma_f32_16x16x32_bf16 v[124:127], v[96:99], v[56:59], v[124:127]
    s_nop 5
    v_cndmask_b32 v100, v112, v116, s[72:73]
    v_cndmask_b32 v100, v100, v120, s[74:75]
    v_cndmask_b32 v100, v100, v124, s[76:77]
    v_cndmask_b32 v102, v113, v117, s[72:73]
    v_cndmask_b32 v102, v102, v121, s[74:75]
    v_cndmask_b32 v102, v102, v125, s[76:77]
    buffer_store_dwordx4 v[100:103], v13, s[28:31], s37 offen sc1
    s_sub_u32 s36, s3, 4
    s_cmp_ge_u32 s36, 2
    s_cbranch_scc1 Laux_end
    s_add_u32 s37, s37, 4096
    ds_read_b64_tr_b16 v[60:61], v14 offset:12288
    ds_read_b64_tr_b16 v[62:63], v14 offset:12800
    ds_read_b64_tr_b16 v[64:65], v15 offset:12288
    ds_read_b64_tr_b16 v[66:67], v15 offset:12800
    ds_read_b64_tr_b16 v[68:69], v16 offset:12288
    ds_read_b64_tr_b16 v[70:71], v16 offset:12800
    ds_read_b64_tr_b16 v[72:73], v17 offset:12288
    ds_read_b64_tr_b16 v[74:75], v17 offset:12800
    ds_read_b64_tr_b16 v[76:77], v14 offset:0
    ds_read_b64_tr_b16 v[78:79], v14 offset:512
    ds_read_b64_tr_b16 v[80:81], v15 offset:0
    ds_read_b64_tr_b16 v[82:83], v15 offset:512
    ds_read_b64_tr_b16 v[84:85], v16 offset:0
    ds_read_b64_tr_b16 v[86:87], v16 offset:512
    ds_read_b64_tr_b16 v[88:89], v17 offset:0
    ds_read_b64_tr_b16 v[90:91], v17 offset:512
    s_waitcnt lgkmcnt(0)
    v_mfma_f32_16x16x32_bf16 v[112:115], v[92:95], v[60:63], 0
    v_mfma_f32_16x16x32_bf16 v[116:119], v[92:95], v[64:67], 0
    v_mfma_f32_16x16x32_bf16 v[120:123], v[92:95], v[68:71], 0
    v_mfma_f32_16x16x32_bf16 v[124:127], v[92:95], v[72:75], 0
    v_mfma_f32_16x16x32_bf16 v[112:115], v[96:99], v[76:79], v[112:115]
    v_mfma_f32_16x16x32_bf16 v[116:119], v[96:99], v[80:83], v[116:119]
    v_mfma_f32_16x16x32_bf16 v[120:123], v[96:99], v[84:87], v[120:123]
    v_mfma_f32_16x16x32_bf16 v[124:127], v[96:99], v[88:91], v[124:127]
    s_nop 5
    v_cndmask_b32 v100, v112, v116, s[72:73]
    v_cndmask_b32 v100, v100, v120, s[74:75]
    v_cndmask_b32 v100, v100, v124, s[76:77]
    v_cndmask_b32 v102, v113, v117, s[72:73]
    v_cndmask_b32 v102, v102, v121, s[74:75]
    v_cndmask_b32 v102, v102, v125, s[76:77]
    buffer_store_dwordx4 v[100:103], v13, s[28:31], s37 offen sc1
Laux_end:
    s_endpgm
Lmst:
    s_cmp_lg_u32 s3, 0
    s_cbranch_scc1 Lhelp_i
    s_waitcnt lgkmcnt(0)
    s_mov_b64 s[28:29], s[24:25]
    s_mov_b32 s30, 268435456
    s_mov_b32 s31, 0x20000
    s_load_dword s34, s[28:29], 0
    s_waitcnt lgkmcnt(0)
    s_add_u32 s34, s34, 0x9e3779b8
    s_or_b32 s34, s34, 1
    s_mov_b64 exec, 1
    s_lshl_b32 s36, s2, 2
    s_add_u32 s36, s36, 8323072
    v_mov_b32 v4, s34
    v_mov_b32 v5, s36
    buffer_store_dword v4, v5, s[28:31], 0 offen sc1
    s_mov_b64 exec, -1
    s_cmp_lg_u32 s32, 32
    s_cbranch_scc1 Lend
Lmst_bc:
    v_and_b32 v4, 31, v1
    v_lshlrev_b32 v4, 7, v4
    v_add_u32 v4, 8126464, v4
Lpt_15:
    s_sub_u32 s35, s35, 1
    s_cbranch_scc1 Lend
    s_sleep 8
    buffer_load_dwordx4 v[8:11], v4, s[28:31], 0 offen sc1
    s_waitcnt vmcnt(0)
    v_cmp_ne_u32 vcc, s34, v9
    v_cmp_ne_u32 s[36:37], s34, v11
    s_nop 0
    s_or_b64 s[36:37], s[36:37], vcc
    s_cbranch_scc1 Lpt_15
    v_mov_b32 v4, v8
    s_nop 1
    v_max_u32_dpp v4, v4, v4 row_ror:8 row_mask:0xf bank_mask:0xf
    s_nop 1
    v_max_u32_dpp v4, v4, v4 row_ror:4 row_mask:0xf bank_mask:0xf
    s_nop 1
    v_max_u32_dpp v4, v4, v4 row_ror:2 row_mask:0xf bank_mask:0xf
    s_nop 1
    v_max_u32_dpp v4, v4, v4 row_ror:1 row_mask:0xf bank_mask:0xf
    s_nop 0
    v_readlane_b32 s40, v4, 0
    v_readlane_b32 s36, v4, 16
    v_readlane_b32 s37, v4, 32
    v_readlane_b32 s38, v4, 48
    s_max_u32 s40, s40, s36
    s_max_u32 s37, s37, s38
    s_max_u32 s40, s40, s37
    v_cmp_eq_u32 vcc, s40, v8
    s_nop 1
    v_cndmask_b32 v4, v8, v10, vcc
    s_nop 1
    v_max_u32_dpp v4, v4, v4 row_ror:8 row_mask:0xf bank_mask:0xf
    s_nop 1
    v_max_u32_dpp v4, v4, v4 row_ror:4 row_mask:0xf bank_mask:0xf
    s_nop 1
    v_max_u32_dpp v4, v4, v4 row_ror:2 row_mask:0xf bank_mask:0xf
    s_nop 1
    v_max_u32_dpp v4, v4, v4 row_ror:1 row_mask:0xf bank_mask:0xf
    s_nop 0
    v_readlane_b32 s41, v4, 0
    v_readlane_b32 s36, v4, 16
    v_readlane_b32 s37, v4, 32
    v_readlane_b32 s38, v4, 48
    s_max_u32 s41, s41, s36
    s_max_u32 s37, s37, s38
    s_max_u32 s41, s41, s37
    v_mov_b32 v8, s40
    v_mov_b32 v9, s34
    v_mov_b32 v10, s41
    v_mov_b32 v11, s34
    s_mov_b32 s36, 8257536
    buffer_store_dwordx4 v[8:11], v13, s[28:31], s36 offen offset:0 sc1
    buffer_store_dwordx4 v[8:11], v13, s[28:31], s36 offen offset:1024 sc1
    buffer_store_dwordx4 v[8:11], v13, s[28:31], s36 offen offset:2048 sc1
    s_mov_b32 s36, 8323072
Lmaster:
    s_sub_u32 s35, s35, 1
    s_cbranch_scc1 Lend
    s_sleep 16
    buffer_load_dwordx4 v[4:7], v13, s[28:31], s36 offen sc1
    s_waitcnt vmcnt(0)
    v_xor_b32 v4, s34, v4
    v_xor_b32 v5, s34, v5
    v_xor_b32 v6, s34, v6
    v_xor_b32 v7, s34, v7
    v_or3_b32 v4, v4, v5, v6
    v_or_b32 v4, v4, v7
    v_cmp_ne_u32 vcc, 0, v4
    s_nop 0
    s_cbranch_vccnz Lmaster
    s_mov_b64 exec, 1
    buffer_store_dword v9, v4, s[28:31], 0 offen sc1
    s_endpgm
Lhelp_r:
    s_sub_u32 s72, s32, 27
    s_add_u32 s72, s72, 27
    s_mov_b32 s73, 5
    s_mov_b32 s37, 4
    s_branch Lhelp
Lhelp_i:
    s_cmp_eq_u32 s32, 32
    s_cbranch_scc1 Lend
    s_cmp_eq_u32 s27, 0
    s_cbranch_scc1 Lend
    s_sub_u32 s72, s32, 33
    s_mov_b32 s73, 3
    s_mov_b32 s37, 9
Lhelp:
    s_lshl_b32 s38, s26, 6
    v_add_u32 v4, s38, v1
    v_mul_u32_u24 v4, 1280, v4
    s_waitcnt lgkmcnt(0)
    s_mov_b64 s[68:69], s[18:19]
    s_mov_b32 s70, 2211840
    s_mov_b32 s71, 0x20000
Lhelp2:
    s_mul_i32 s38, s72, 9363
    s_lshr_b32 s38, s38, 16
    s_mul_i32 s39, s38, 7
    s_sub_u32 s39, s72, s39
    s_mul_i32 s39, s39, 327680
    s_lshl_b32 s38, s38, 7
    s_sub_u32 s39, s39, s38
    s_add_u32 s39, s39, 1152
    v_add_u32 v6, s39, v4
    buffer_load_dword v5, v6, s[68:71], 0 offen
    s_add_u32 s72, s72, s73
    s_sub_u32 s37, s37, 1
    s_cmp_lg_u32 s37, 0
    s_cbranch_scc1 Lhelp2
Lend:
    s_endpgm
.section .rodata,"a"
.p2align 6
.amdhsa_kernel recurrent_scan__sliding_local_dilated__moe_arch_mod__prompt_kernel
  .amdhsa_next_free_vgpr 256
  .amdhsa_next_free_sgpr 102
  .amdhsa_accum_offset 128
  .amdhsa_group_segment_fixed_size 0
  .amdhsa_kernarg_size 88
  .amdhsa_user_sgpr_count 2
  .amdhsa_user_sgpr_kernarg_segment_ptr 1
  .amdhsa_system_sgpr_workgroup_id_x 1
  .amdhsa_float_denorm_mode_32 3
.end_amdhsa_kernel
```

```asm
; @launch grid=(256,1,1) block=(512,1,1) lds=163840
.amdgcn_target "amdgcn-amd-amdhsa--gfx950"
.text
.globl recurrent_scan__sliding_local_dilated__moe_arch_mod__prompt_kernel
.p2align 8
.type recurrent_scan__sliding_local_dilated__moe_arch_mod__prompt_kernel,@function
recurrent_scan__sliding_local_dilated__moe_arch_mod__prompt_kernel:
    s_load_dwordx16 s[4:19], s[0:1], 0
    s_load_dwordx4 s[20:23], s[0:1], 64
    s_load_dwordx2 s[24:25], s[0:1], 80
    v_lshrrev_b32 v4, 6, v0
    v_and_b32 v1, 63, v0
    s_cmp_ge_u32 s2, 256
    s_cbranch_scc1 Lend
    v_readfirstlane_b32 s3, v4
    s_getpc_b64 s[36:37]
Lpc:
    s_and_b32 s38, s2, 0xf8
    v_add_u32 v5, s38, v4
    v_and_b32 v6, 1, v0
    v_lshl_add_u32 v5, v5, 1, v6
    v_lshlrev_b32 v5, 7, v5
    v_min_u32 v5, Lend-Lpc, v5
    v_mov_b32 v7, s37
    v_add_co_u32 v6, vcc, s36, v5
    s_nop 1
    v_addc_co_u32 v7, vcc, 0, v7, vcc
    global_load_dword v0, v[6:7], off
    v_lshrrev_b32 v2, 4, v1
    v_and_b32 v3, 15, v1
    v_lshlrev_b32 v12, 2, v1
    v_lshlrev_b32 v13, 4, v1
    s_mov_b32 s35, 2000000
    s_and_b32 s36, s2, 7
    s_lshr_b32 s37, s2, 3
    s_and_b32 s38, s36, 1
    s_lshr_b32 s36, s36, 1
    s_add_u32 s39, s38, 4
    s_and_b32 s26, s3, 3
    s_lshr_b32 s27, s3, 2
    s_cmp_lt_u32 s37, s39
    s_cbranch_scc1 Laux
    s_lshr_b32 s33, s36, 1
    s_and_b32 s36, s36, 1
    s_mul_i32 s36, s36, 55
    s_mul_i32 s38, s38, 28
    s_add_u32 s36, s36, s38
    s_add_u32 s36, s36, s37
    s_sub_u32 s36, s36, s39
    s_mul_i32 s32, s36, 13108
    s_lshr_b32 s32, s32, 16
    s_mul_i32 s37, s32, 5
    s_sub_u32 s36, s36, s37
    s_mul_i32 s33, s33, 5
    s_add_u32 s33, s33, s36
    s_add_u32 s42, s33, s32
    s_mul_i32 s36, s42, 13108
    s_lshr_b32 s36, s36, 16
    s_mul_i32 s36, s36, 5
    s_sub_u32 s42, s42, s36
    s_and_b32 s43, s2, 7
    s_lshl_b32 s43, s43, 2
    s_lshr_b32 s43, 0x30858530, s43
    s_and_b32 s43, s43, 15
    s_cmp_lg_u32 s3, 0
    s_cbranch_scc1 Lcomp
Lloader:
    s_setprio 3
    v_lshrrev_b32 v5, 3, v1
    v_and_b32 v6, 7, v1
    v_and_b32 v8, 1, v2
    v_lshlrev_b32 v8, 1, v8
    v_xor_b32 v8, v8, v6
    s_lshl_b32 s39, s33, 7
    v_lshl_add_u32 v50, v8, 4, s39
    v_mov_b32 v7, 3840
    v_mad_u32_u24 v28, v5, v7, v50
    v_xor_b32 v29, 64, v28
    v_add_u32 v29, 29696, v29
    v_add_u32 v30, 59392, v28
    v_add_u32 v31, 59392, v29
    v_add_u32 v32, 122880, v28
    v_add_u32 v33, 122880, v29
    v_add_u32 v34, 182272, v28
    v_add_u32 v35, 182272, v29
    s_lshl_b32 s79, s42, 2
    s_lshr_b32 s79, 0x21100, s79
    s_and_b32 s79, s79, 15
    s_add_u32 s79, s79, s43
    s_sub_u32 s38, s79, 10
    s_cmp_ge_u32 s79, 10
    s_cselect_b32 s79, s38, s79
    s_mul_i32 s68, s79, 245760
    s_lshl_b32 s78, s79, 7
    s_waitcnt lgkmcnt(0)
    s_mov_b64 s[48:49], s[6:7]
    s_mov_b32 s50, 2457600
    s_mov_b32 s51, 0x20000
    s_add_u32 s52, s6, 1280
    s_addc_u32 s53, s7, 0
    s_mov_b32 s54, 2456320
    s_mov_b32 s55, 0x20000
    s_add_u32 s56, s6, 2560
    s_addc_u32 s57, s7, 0
    s_mov_b32 s58, 2455040
    s_mov_b32 s59, 0x20000
    s_mov_b32 m0, 0
    s_mul_i32 s38, s32, 96
    s_sub_u32 s38, s38, 16
    v_add_u32 v7, s38, v5
    buffer_load_dwordx4 v28, s[48:51], s68 offen lds
    v_xor_b32 v9, v6, v2
    v_lshlrev_b32 v9, 4, v9
    buffer_load_dwordx4 v29, s[48:51], s68 offen offset:1024 lds
    v_xor_b32 v10, 64, v9
    v_mov_b32 v11, 2052
    buffer_load_dwordx4 v30, s[48:51], s68 offen offset:2048 lds
    v_mov_b32 v8, 1280
    v_add_u32 v36, 0, v7
    buffer_load_dwordx4 v31, s[48:51], s68 offen offset:3072 lds
    v_med3_i32 v36, v36, 0, v11
    v_mad_u32_u24 v36, v36, v8, v9
    s_mov_b32 m0, 8192
    v_add_u32 v36, 4096, v36
    v_add_u32 v37, 8, v7
    buffer_load_dwordx4 v28, s[52:55], s68 offen lds
    v_med3_i32 v37, v37, 0, v11
    v_mad_u32_u24 v37, v37, v8, v10
    v_add_u32 v37, 3072, v37
    buffer_load_dwordx4 v29, s[52:55], s68 offen offset:1024 lds
    v_add_u32 v38, 16, v7
    v_med3_i32 v38, v38, 0, v11
    buffer_load_dwordx4 v30, s[52:55], s68 offen offset:2048 lds
    v_mad_u32_u24 v38, v38, v8, v9
    v_add_u32 v38, 2048, v38
    buffer_load_dwordx4 v31, s[52:55], s68 offen offset:3072 lds
    v_add_u32 v39, 24, v7
    v_med3_i32 v39, v39, 0, v11
    s_mov_b32 m0, 16384
    v_mad_u32_u24 v39, v39, v8, v10
    v_add_u32 v39, 1024, v39
    buffer_load_dwordx4 v28, s[56:59], s68 offen lds
    v_add_u32 v40, 32, v7
    v_med3_i32 v40, v40, 0, v11
    buffer_load_dwordx4 v29, s[56:59], s68 offen offset:1024 lds
    v_mad_u32_u24 v40, v40, v8, v9
    v_add_u32 v40, 4096, v40
    v_add_u32 v41, 40, v7
    buffer_load_dwordx4 v30, s[56:59], s68 offen offset:2048 lds
    v_med3_i32 v41, v41, 0, v11
    v_mad_u32_u24 v41, v41, v8, v10
    buffer_load_dwordx4 v31, s[56:59], s68 offen offset:3072 lds
    v_add_u32 v41, 3072, v41
    v_add_u32 v42, 48, v7
    s_mov_b32 m0, 4096
    v_med3_i32 v42, v42, 0, v11
    v_mad_u32_u24 v42, v42, v8, v9
    buffer_load_dwordx4 v32, s[48:51], s68 offen lds
    v_add_u32 v42, 2048, v42
    v_add_u32 v43, 56, v7
    buffer_load_dwordx4 v33, s[48:51], s68 offen offset:1024 lds
    v_med3_i32 v43, v43, 0, v11
    v_mad_u32_u24 v43, v43, v8, v10
    buffer_load_dwordx4 v34, s[48:51], s68 offen offset:2048 lds
    v_add_u32 v43, 1024, v43
    v_add_u32 v44, 64, v7
    v_med3_i32 v44, v44, 0, v11
    buffer_load_dwordx4 v35, s[48:51], s68 offen offset:3072 lds
    v_mad_u32_u24 v44, v44, v8, v9
    v_add_u32 v44, 4096, v44
    s_mov_b32 m0, 12288
    v_add_u32 v45, 72, v7
    v_med3_i32 v45, v45, 0, v11
    buffer_load_dwordx4 v32, s[52:55], s68 offen lds
    v_mad_u32_u24 v45, v45, v8, v10
    v_add_u32 v45, 3072, v45
    buffer_load_dwordx4 v33, s[52:55], s68 offen offset:1024 lds
    v_add_u32 v46, 80, v7
    v_med3_i32 v46, v46, 0, v11
    buffer_load_dwordx4 v34, s[52:55], s68 offen offset:2048 lds
    v_mad_u32_u24 v46, v46, v8, v9
    v_add_u32 v46, 2048, v46
    buffer_load_dwordx4 v35, s[52:55], s68 offen offset:3072 lds
    v_add_u32 v47, 88, v7
    v_med3_i32 v47, v47, 0, v11
    v_mad_u32_u24 v47, v47, v8, v10
    s_mov_b32 m0, 20480
    v_add_u32 v47, 1024, v47
    v_add_u32 v48, 96, v7
    buffer_load_dwordx4 v32, s[56:59], s68 offen lds
    v_med3_i32 v48, v48, 0, v11
    v_mad_u32_u24 v48, v48, v8, v9
    buffer_load_dwordx4 v33, s[56:59], s68 offen offset:1024 lds
    v_add_u32 v48, 4096, v48
    v_add_u32 v49, 104, v7
    buffer_load_dwordx4 v34, s[56:59], s68 offen offset:2048 lds
    v_med3_i32 v49, v49, 0, v11
    v_mad_u32_u24 v49, v49, v8, v10
    buffer_load_dwordx4 v35, s[56:59], s68 offen offset:3072 lds
    v_add_u32 v49, 3072, v49
    s_sub_u32 s44, s4, 4096
    s_subb_u32 s45, s5, 0
    s_mov_b32 s46, 2625536
    s_mov_b32 s47, 0x20000
    s_mov_b32 m0, 24576
    s_nop 0
    buffer_load_dwordx4 v36, s[44:47], s78 offen lds
    buffer_load_dwordx4 v37, s[44:47], s78 offen offset:1024 lds
    buffer_load_dwordx4 v38, s[44:47], s78 offen offset:2048 lds
    buffer_load_dwordx4 v39, s[44:47], s78 offen offset:3072 lds
    s_mov_b32 m0, 28672
    s_nop 0
    buffer_load_dwordx4 v40, s[44:47], s78 offen lds
    buffer_load_dwordx4 v41, s[44:47], s78 offen offset:1024 lds
    buffer_load_dwordx4 v42, s[44:47], s78 offen offset:2048 lds
    buffer_load_dwordx4 v43, s[44:47], s78 offen offset:3072 lds
    s_mov_b32 m0, 32768
    s_nop 0
    buffer_load_dwordx4 v44, s[44:47], s78 offen lds
    buffer_load_dwordx4 v45, s[44:47], s78 offen offset:1024 lds
    buffer_load_dwordx4 v46, s[44:47], s78 offen offset:2048 lds
    buffer_load_dwordx4 v47, s[44:47], s78 offen offset:3072 lds
    s_mov_b32 m0, 36864
    s_nop 0
    buffer_load_dwordx4 v48, s[44:47], s78 offen lds
    buffer_load_dwordx4 v49, s[44:47], s78 offen offset:1024 lds
    s_mov_b32 s80, 0x65482310
    s_mov_b32 s81, 0x97
    s_cmp_eq_u32 s42, 1
    s_cselect_b32 s80, 0x65392410, s80
    s_cselect_b32 s81, 0x87, s81
    s_cmp_eq_u32 s42, 2
    s_cselect_b32 s80, 0x75436021, s80
    s_cselect_b32 s81, 0x98, s81
    s_cmp_eq_u32 s42, 3
    s_cselect_b32 s80, 0x76432501, s80
    s_cselect_b32 s81, 0x98, s81
    s_cmp_eq_u32 s42, 4
    s_cselect_b32 s80, 0x63547102, s80
    s_cselect_b32 s81, 0x98, s81
    s_lshr_b64 s[80:81], s[80:81], 4
    s_and_b32 s79, s80, 15
    s_add_u32 s79, s79, s43
    s_sub_u32 s38, s79, 10
    s_cmp_ge_u32 s79, 10
    s_cselect_b32 s79, s38, s79
    s_mov_b64 s[28:29], s[24:25]
    s_mov_b32 s30, 268435456
    s_mov_b32 s31, 0x20000
    s_load_dword s34, s[28:29], 0
    s_mov_b64 s[60:61], s[8:9]
    s_mov_b32 s62, 819200
    s_mov_b32 s63, 0x20000
    v_mov_b32 v51, 157984
    v_and_b32 v66, 7, v1
    v_max_u32 v66, 1, v66
    v_lshlrev_b32 v66, 2, v66
    v_add_u32 v66, 158016, v66
    s_mul_i32 s69, s79, 245760
    s_lshl_b32 s78, s79, 7
    s_mov_b32 m0, 63616
    s_nop 0
    buffer_load_dwordx4 v36, s[44:47], s78 offen lds
    buffer_load_dwordx4 v37, s[44:47], s78 offen offset:1024 lds
    buffer_load_dwordx4 v38, s[44:47], s78 offen offset:2048 lds
    buffer_load_dwordx4 v39, s[44:47], s78 offen offset:3072 lds
    s_mov_b32 m0, 39040
    s_nop 0
    buffer_load_dwordx4 v28, s[48:51], s69 offen lds
    buffer_load_dwordx4 v29, s[48:51], s69 offen offset:1024 lds
    buffer_load_dwordx4 v30, s[48:51], s69 offen offset:2048 lds
    buffer_load_dwordx4 v31, s[48:51], s69 offen offset:3072 lds
    s_mov_b32 m0, 67712
    s_nop 0
    buffer_load_dwordx4 v40, s[44:47], s78 offen lds
    buffer_load_dwordx4 v41, s[44:47], s78 offen offset:1024 lds
    buffer_load_dwordx4 v42, s[44:47], s78 offen offset:2048 lds
    buffer_load_dwordx4 v43, s[44:47], s78 offen offset:3072 lds
    s_mov_b32 m0, 47232
    s_nop 0
    buffer_load_dwordx4 v28, s[52:55], s69 offen lds
    buffer_load_dwordx4 v29, s[52:55], s69 offen offset:1024 lds
    buffer_load_dwordx4 v30, s[52:55], s69 offen offset:2048 lds
    buffer_load_dwordx4 v31, s[52:55], s69 offen offset:3072 lds
    s_mov_b32 m0, 71808
    s_nop 0
    buffer_load_dwordx4 v44, s[44:47], s78 offen lds
    buffer_load_dwordx4 v45, s[44:47], s78 offen offset:1024 lds
    buffer_load_dwordx4 v46, s[44:47], s78 offen offset:2048 lds
    buffer_load_dwordx4 v47, s[44:47], s78 offen offset:3072 lds
    s_mov_b32 m0, 55424
    s_nop 0
    buffer_load_dwordx4 v28, s[56:59], s69 offen lds
    buffer_load_dwordx4 v29, s[56:59], s69 offen offset:1024 lds
    buffer_load_dwordx4 v30, s[56:59], s69 offen offset:2048 lds
    buffer_load_dwordx4 v31, s[56:59], s69 offen offset:3072 lds
    s_mov_b32 m0, 75904
    s_nop 0
    buffer_load_dwordx4 v48, s[44:47], s78 offen lds
    s_waitcnt vmcnt(55)
    buffer_load_dwordx4 v49, s[44:47], s78 offen offset:1024 lds
    s_mov_b32 m0, 43136
    s_nop 0
    buffer_load_dwordx4 v32, s[48:51], s69 offen lds
    buffer_load_dwordx4 v33, s[48:51], s69 offen offset:1024 lds
    buffer_load_dwordx4 v34, s[48:51], s69 offen offset:2048 lds
    buffer_load_dwordx4 v35, s[48:51], s69 offen offset:3072 lds
    s_mov_b32 m0, 51328
    s_nop 0
    buffer_load_dwordx4 v32, s[52:55], s69 offen lds
    buffer_load_dwordx4 v33, s[52:55], s69 offen offset:1024 lds
    buffer_load_dwordx4 v34, s[52:55], s69 offen offset:2048 lds
    s_waitcnt vmcnt(55)
    buffer_load_dwordx4 v35, s[52:55], s69 offen offset:3072 lds
    s_mov_b32 m0, 59520
    s_nop 0
    buffer_load_dwordx4 v32, s[56:59], s69 offen lds
    buffer_load_dwordx4 v33, s[56:59], s69 offen offset:1024 lds
    buffer_load_dwordx4 v34, s[56:59], s69 offen offset:2048 lds
    buffer_load_dwordx4 v35, s[56:59], s69 offen offset:3072 lds
    s_waitcnt vmcnt(38) lgkmcnt(0)
    s_barrier
    s_add_u32 s34, s34, 0x9e3779b8
    s_or_b32 s34, s34, 1
    s_lshr_b64 s[80:81], s[80:81], 4
    s_and_b32 s79, s80, 15
    s_add_u32 s79, s79, s43
    s_sub_u32 s38, s79, 10
    s_cmp_ge_u32 s79, 10
    s_cselect_b32 s79, s38, s79
    s_mul_i32 s70, s79, 245760
    s_lshl_b32 s78, s79, 7
    s_mov_b32 m0, 102656
    s_nop 0
    buffer_load_dwordx4 v36, s[44:47], s78 offen lds
    buffer_load_dwordx4 v37, s[44:47], s78 offen offset:1024 lds
    buffer_load_dwordx4 v38, s[44:47], s78 offen offset:2048 lds
    buffer_load_dwordx4 v39, s[44:47], s78 offen offset:3072 lds
    s_mov_b32 m0, 78080
    s_nop 0
    buffer_load_dwordx4 v28, s[48:51], s70 offen lds
    buffer_load_dwordx4 v29, s[48:51], s70 offen offset:1024 lds
    buffer_load_dwordx4 v30, s[48:51], s70 offen offset:2048 lds
    buffer_load_dwordx4 v31, s[48:51], s70 offen offset:3072 lds
    s_mov_b32 m0, 106752
    s_nop 0
    buffer_load_dwordx4 v40, s[44:47], s78 offen lds
    buffer_load_dwordx4 v41, s[44:47], s78 offen offset:1024 lds
    buffer_load_dwordx4 v42, s[44:47], s78 offen offset:2048 lds
    buffer_load_dwordx4 v43, s[44:47], s78 offen offset:3072 lds
    s_mov_b32 m0, 86272
    s_nop 0
    buffer_load_dwordx4 v28, s[52:55], s70 offen lds
    buffer_load_dwordx4 v29, s[52:55], s70 offen offset:1024 lds
    buffer_load_dwordx4 v30, s[52:55], s70 offen offset:2048 lds
    buffer_load_dwordx4 v31, s[52:55], s70 offen offset:3072 lds
    s_mov_b32 m0, 110848
    s_nop 0
    buffer_load_dwordx4 v44, s[44:47], s78 offen lds
    buffer_load_dwordx4 v45, s[44:47], s78 offen offset:1024 lds
    buffer_load_dwordx4 v46, s[44:47], s78 offen offset:2048 lds
    buffer_load_dwordx4 v47, s[44:47], s78 offen offset:3072 lds
    s_mov_b32 m0, 94464
    s_nop 0
    buffer_load_dwordx4 v28, s[56:59], s70 offen lds
    buffer_load_dwordx4 v29, s[56:59], s70 offen offset:1024 lds
    buffer_load_dwordx4 v30, s[56:59], s70 offen offset:2048 lds
    buffer_load_dwordx4 v31, s[56:59], s70 offen offset:3072 lds
    s_mov_b32 m0, 114944
    s_nop 0
    buffer_load_dwordx4 v48, s[44:47], s78 offen lds
    s_waitcnt vmcnt(55)
    buffer_load_dwordx4 v49, s[44:47], s78 offen offset:1024 lds
    s_mov_b32 m0, 82176
    s_nop 0
    buffer_load_dwordx4 v32, s[48:51], s70 offen lds
    buffer_load_dwordx4 v33, s[48:51], s70 offen offset:1024 lds
    buffer_load_dwordx4 v34, s[48:51], s70 offen offset:2048 lds
    buffer_load_dwordx4 v35, s[48:51], s70 offen offset:3072 lds
    s_mov_b32 m0, 90368
    s_nop 0
    buffer_load_dwordx4 v32, s[52:55], s70 offen lds
    buffer_load_dwordx4 v33, s[52:55], s70 offen offset:1024 lds
    buffer_load_dwordx4 v34, s[52:55], s70 offen offset:2048 lds
    s_waitcnt vmcnt(55)
    buffer_load_dwordx4 v35, s[52:55], s70 offen offset:3072 lds
    s_mov_b32 m0, 98560
    s_nop 0
    buffer_load_dwordx4 v32, s[56:59], s70 offen lds
    buffer_load_dwordx4 v33, s[56:59], s70 offen offset:1024 lds
    buffer_load_dwordx4 v34, s[56:59], s70 offen offset:2048 lds
    buffer_load_dwordx4 v35, s[56:59], s70 offen offset:3072 lds
    s_waitcnt vmcnt(38) lgkmcnt(0)
    s_barrier
    s_lshr_b64 s[80:81], s[80:81], 4
    s_and_b32 s79, s80, 15
    s_add_u32 s79, s79, s43
    s_sub_u32 s38, s79, 10
    s_cmp_ge_u32 s79, 10
    s_cselect_b32 s79, s38, s79
    s_mul_i32 s71, s79, 245760
    s_lshl_b32 s78, s79, 7
    s_mov_b32 m0, 141696
    s_nop 0
    buffer_load_dwordx4 v36, s[44:47], s78 offen lds
    buffer_load_dwordx4 v37, s[44:47], s78 offen offset:1024 lds
    buffer_load_dwordx4 v38, s[44:47], s78 offen offset:2048 lds
    buffer_load_dwordx4 v39, s[44:47], s78 offen offset:3072 lds
    s_mov_b32 m0, 117120
    s_nop 0
    buffer_load_dwordx4 v28, s[48:51], s71 offen lds
    buffer_load_dwordx4 v29, s[48:51], s71 offen offset:1024 lds
    buffer_load_dwordx4 v30, s[48:51], s71 offen offset:2048 lds
    buffer_load_dwordx4 v31, s[48:51], s71 offen offset:3072 lds
    s_mov_b32 m0, 145792
    s_nop 0
    buffer_load_dwordx4 v40, s[44:47], s78 offen lds
    buffer_load_dwordx4 v41, s[44:47], s78 offen offset:1024 lds
    buffer_load_dwordx4 v42, s[44:47], s78 offen offset:2048 lds
    buffer_load_dwordx4 v43, s[44:47], s78 offen offset:3072 lds
    s_mov_b32 m0, 125312
    s_nop 0
    buffer_load_dwordx4 v28, s[52:55], s71 offen lds
    buffer_load_dwordx4 v29, s[52:55], s71 offen offset:1024 lds
    buffer_load_dwordx4 v30, s[52:55], s71 offen offset:2048 lds
    buffer_load_dwordx4 v31, s[52:55], s71 offen offset:3072 lds
    s_mov_b32 m0, 149888
    s_nop 0
    buffer_load_dwordx4 v44, s[44:47], s78 offen lds
    buffer_load_dwordx4 v45, s[44:47], s78 offen offset:1024 lds
    buffer_load_dwordx4 v46, s[44:47], s78 offen offset:2048 lds
    buffer_load_dwordx4 v47, s[44:47], s78 offen offset:3072 lds
    s_mov_b32 m0, 133504
    s_nop 0
    buffer_load_dwordx4 v28, s[56:59], s71 offen lds
    buffer_load_dwordx4 v29, s[56:59], s71 offen offset:1024 lds
    buffer_load_dwordx4 v30, s[56:59], s71 offen offset:2048 lds
    buffer_load_dwordx4 v31, s[56:59], s71 offen offset:3072 lds
    s_mov_b32 m0, 153984
    s_nop 0
    buffer_load_dwordx4 v48, s[44:47], s78 offen lds
    s_waitcnt vmcnt(55)
    buffer_load_dwordx4 v49, s[44:47], s78 offen offset:1024 lds
    s_mov_b32 m0, 121216
    s_nop 0
    buffer_load_dwordx4 v32, s[48:51], s71 offen lds
    buffer_load_dwordx4 v33, s[48:51], s71 offen offset:1024 lds
    buffer_load_dwordx4 v34, s[48:51], s71 offen offset:2048 lds
    buffer_load_dwordx4 v35, s[48:51], s71 offen offset:3072 lds
    s_mov_b32 m0, 129408
    s_nop 0
    buffer_load_dwordx4 v32, s[52:55], s71 offen lds
    buffer_load_dwordx4 v33, s[52:55], s71 offen offset:1024 lds
    buffer_load_dwordx4 v34, s[52:55], s71 offen offset:2048 lds
    s_waitcnt vmcnt(55)
    buffer_load_dwordx4 v35, s[52:55], s71 offen offset:3072 lds
    s_mov_b32 m0, 137600
    s_nop 0
    buffer_load_dwordx4 v32, s[56:59], s71 offen lds
    buffer_load_dwordx4 v33, s[56:59], s71 offen offset:1024 lds
    buffer_load_dwordx4 v34, s[56:59], s71 offen offset:2048 lds
    buffer_load_dwordx4 v35, s[56:59], s71 offen offset:3072 lds
    s_waitcnt vmcnt(38) lgkmcnt(0)
    s_barrier
    s_lshr_b64 s[80:81], s[80:81], 4
    s_and_b32 s79, s80, 15
    s_add_u32 s79, s79, s43
    s_sub_u32 s38, s79, 10
    s_cmp_ge_u32 s79, 10
    s_cselect_b32 s79, s38, s79
    s_mul_i32 s72, s79, 245760
    s_lshl_b32 s78, s79, 7
    s_mov_b32 m0, 24576
    s_nop 0
    buffer_load_dwordx4 v36, s[44:47], s78 offen lds
    buffer_load_dwordx4 v37, s[44:47], s78 offen offset:1024 lds
    buffer_load_dwordx4 v38, s[44:47], s78 offen offset:2048 lds
    buffer_load_dwordx4 v39, s[44:47], s78 offen offset:3072 lds
    s_mov_b32 m0, 0
    s_nop 0
    buffer_load_dwordx4 v28, s[48:51], s72 offen lds
    buffer_load_dwordx4 v29, s[48:51], s72 offen offset:1024 lds
    buffer_load_dwordx4 v30, s[48:51], s72 offen offset:2048 lds
    buffer_load_dwordx4 v31, s[48:51], s72 offen offset:3072 lds
    s_mov_b32 m0, 28672
    s_nop 0
    buffer_load_dwordx4 v40, s[44:47], s78 offen lds
    buffer_load_dwordx4 v41, s[44:47], s78 offen offset:1024 lds
    buffer_load_dwordx4 v42, s[44:47], s78 offen offset:2048 lds
    buffer_load_dwordx4 v43, s[44:47], s78 offen offset:3072 lds
    s_mov_b32 m0, 8192
    s_nop 0
    buffer_load_dwordx4 v28, s[52:55], s72 offen lds
    buffer_load_dwordx4 v29, s[52:55], s72 offen offset:1024 lds
    buffer_load_dwordx4 v30, s[52:55], s72 offen offset:2048 lds
    buffer_load_dwordx4 v31, s[52:55], s72 offen offset:3072 lds
    s_mov_b32 m0, 32768
    s_nop 0
    buffer_load_dwordx4 v44, s[44:47], s78 offen lds
    buffer_load_dwordx4 v45, s[44:47], s78 offen offset:1024 lds
    buffer_load_dwordx4 v46, s[44:47], s78 offen offset:2048 lds
    buffer_load_dwordx4 v47, s[44:47], s78 offen offset:3072 lds
    s_mov_b32 m0, 16384
    s_nop 0
    buffer_load_dwordx4 v28, s[56:59], s72 offen lds
    buffer_load_dwordx4 v29, s[56:59], s72 offen offset:1024 lds
    buffer_load_dwordx4 v30, s[56:59], s72 offen offset:2048 lds
    buffer_load_dwordx4 v31, s[56:59], s72 offen offset:3072 lds
    s_mov_b32 m0, 36864
    s_nop 0
    buffer_load_dwordx4 v48, s[44:47], s78 offen lds
    s_waitcnt vmcnt(55)
    buffer_load_dwordx4 v49, s[44:47], s78 offen offset:1024 lds
    s_mov_b32 m0, 4096
    s_nop 0
    buffer_load_dwordx4 v32, s[48:51], s72 offen lds
    buffer_load_dwordx4 v33, s[48:51], s72 offen offset:1024 lds
    buffer_load_dwordx4 v34, s[48:51], s72 offen offset:2048 lds
    buffer_load_dwordx4 v35, s[48:51], s72 offen offset:3072 lds
    s_mov_b32 m0, 12288
    s_nop 0
    buffer_load_dwordx4 v32, s[52:55], s72 offen lds
    buffer_load_dwordx4 v33, s[52:55], s72 offen offset:1024 lds
    buffer_load_dwordx4 v34, s[52:55], s72 offen offset:2048 lds
    s_waitcnt vmcnt(55)
    buffer_load_dwordx4 v35, s[52:55], s72 offen offset:3072 lds
    s_mov_b32 m0, 20480
    s_nop 0
    buffer_load_dwordx4 v32, s[56:59], s72 offen lds
    buffer_load_dwordx4 v33, s[56:59], s72 offen offset:1024 lds
    buffer_load_dwordx4 v34, s[56:59], s72 offen offset:2048 lds
    buffer_load_dwordx4 v35, s[56:59], s72 offen offset:3072 lds
    s_waitcnt vmcnt(38) lgkmcnt(0)
    s_barrier
    s_lshr_b64 s[80:81], s[80:81], 4
    s_and_b32 s79, s80, 15
    s_add_u32 s79, s79, s43
    s_sub_u32 s38, s79, 10
    s_cmp_ge_u32 s79, 10
    s_cselect_b32 s79, s38, s79
    s_mul_i32 s73, s79, 245760
    s_lshl_b32 s78, s79, 7
    s_mov_b32 m0, 63616
    s_nop 0
    buffer_load_dwordx4 v36, s[44:47], s78 offen lds
    buffer_load_dwordx4 v37, s[44:47], s78 offen offset:1024 lds
    buffer_load_dwordx4 v38, s[44:47], s78 offen offset:2048 lds
    buffer_load_dwordx4 v39, s[44:47], s78 offen offset:3072 lds
    s_mov_b32 m0, 39040
    s_nop 0
    buffer_load_dwordx4 v28, s[48:51], s73 offen lds
    buffer_load_dwordx4 v29, s[48:51], s73 offen offset:1024 lds
    buffer_load_dwordx4 v30, s[48:51], s73 offen offset:2048 lds
    buffer_load_dwordx4 v31, s[48:51], s73 offen offset:3072 lds
    s_mov_b32 m0, 67712
    s_nop 0
    buffer_load_dwordx4 v40, s[44:47], s78 offen lds
    buffer_load_dwordx4 v41, s[44:47], s78 offen offset:1024 lds
    buffer_load_dwordx4 v42, s[44:47], s78 offen offset:2048 lds
    buffer_load_dwordx4 v43, s[44:47], s78 offen offset:3072 lds
    s_mov_b32 m0, 47232
    s_nop 0
    buffer_load_dwordx4 v28, s[52:55], s73 offen lds
    buffer_load_dwordx4 v29, s[52:55], s73 offen offset:1024 lds
    buffer_load_dwordx4 v30, s[52:55], s73 offen offset:2048 lds
    buffer_load_dwordx4 v31, s[52:55], s73 offen offset:3072 lds
    s_mov_b32 m0, 71808
    s_nop 0
    buffer_load_dwordx4 v44, s[44:47], s78 offen lds
    buffer_load_dwordx4 v45, s[44:47], s78 offen offset:1024 lds
    buffer_load_dwordx4 v46, s[44:47], s78 offen offset:2048 lds
    buffer_load_dwordx4 v47, s[44:47], s78 offen offset:3072 lds
    s_mov_b32 m0, 55424
    s_nop 0
    buffer_load_dwordx4 v28, s[56:59], s73 offen lds
    buffer_load_dwordx4 v29, s[56:59], s73 offen offset:1024 lds
    buffer_load_dwordx4 v30, s[56:59], s73 offen offset:2048 lds
    buffer_load_dwordx4 v31, s[56:59], s73 offen offset:3072 lds
    s_mov_b32 m0, 75904
    s_nop 0
    buffer_load_dwordx4 v48, s[44:47], s78 offen lds
    s_waitcnt vmcnt(55)
    buffer_load_dwordx4 v49, s[44:47], s78 offen offset:1024 lds
    s_mov_b32 m0, 43136
    s_nop 0
    buffer_load_dwordx4 v32, s[48:51], s73 offen lds
    buffer_load_dwordx4 v33, s[48:51], s73 offen offset:1024 lds
    buffer_load_dwordx4 v34, s[48:51], s73 offen offset:2048 lds
    buffer_load_dwordx4 v35, s[48:51], s73 offen offset:3072 lds
    s_mov_b32 m0, 51328
    s_nop 0
    buffer_load_dwordx4 v32, s[52:55], s73 offen lds
    buffer_load_dwordx4 v33, s[52:55], s73 offen offset:1024 lds
    buffer_load_dwordx4 v34, s[52:55], s73 offen offset:2048 lds
    s_waitcnt vmcnt(55)
    buffer_load_dwordx4 v35, s[52:55], s73 offen offset:3072 lds
    s_mov_b32 m0, 59520
    s_nop 0
    buffer_load_dwordx4 v32, s[56:59], s73 offen lds
    buffer_load_dwordx4 v33, s[56:59], s73 offen offset:1024 lds
    buffer_load_dwordx4 v34, s[56:59], s73 offen offset:2048 lds
    buffer_load_dwordx4 v35, s[56:59], s73 offen offset:3072 lds
    s_waitcnt vmcnt(38) lgkmcnt(0)
    s_barrier
    s_lshr_b64 s[80:81], s[80:81], 4
    s_and_b32 s79, s80, 15
    s_add_u32 s79, s79, s43
    s_sub_u32 s38, s79, 10
    s_cmp_ge_u32 s79, 10
    s_cselect_b32 s79, s38, s79
    s_mul_i32 s74, s79, 245760
    s_lshl_b32 s78, s79, 7
    s_mov_b32 m0, 102656
    s_nop 0
    buffer_load_dwordx4 v36, s[44:47], s78 offen lds
    buffer_load_dwordx4 v37, s[44:47], s78 offen offset:1024 lds
    buffer_load_dwordx4 v38, s[44:47], s78 offen offset:2048 lds
    buffer_load_dwordx4 v39, s[44:47], s78 offen offset:3072 lds
    s_mov_b32 m0, 78080
    s_nop 0
    buffer_load_dwordx4 v28, s[48:51], s74 offen lds
    buffer_load_dwordx4 v29, s[48:51], s74 offen offset:1024 lds
    buffer_load_dwordx4 v30, s[48:51], s74 offen offset:2048 lds
    buffer_load_dwordx4 v31, s[48:51], s74 offen offset:3072 lds
    s_mov_b32 m0, 106752
    s_nop 0
    buffer_load_dwordx4 v40, s[44:47], s78 offen lds
    buffer_load_dwordx4 v41, s[44:47], s78 offen offset:1024 lds
    buffer_load_dwordx4 v42, s[44:47], s78 offen offset:2048 lds
    buffer_load_dwordx4 v43, s[44:47], s78 offen offset:3072 lds
    s_mov_b32 m0, 86272
    s_nop 0
    buffer_load_dwordx4 v28, s[52:55], s74 offen lds
    buffer_load_dwordx4 v29, s[52:55], s74 offen offset:1024 lds
    buffer_load_dwordx4 v30, s[52:55], s74 offen offset:2048 lds
    buffer_load_dwordx4 v31, s[52:55], s74 offen offset:3072 lds
    s_mov_b32 m0, 110848
    s_nop 0
    buffer_load_dwordx4 v44, s[44:47], s78 offen lds
    buffer_load_dwordx4 v45, s[44:47], s78 offen offset:1024 lds
    buffer_load_dwordx4 v46, s[44:47], s78 offen offset:2048 lds
    buffer_load_dwordx4 v47, s[44:47], s78 offen offset:3072 lds
    s_mov_b32 m0, 82176
    s_nop 0
    buffer_load_dwordx4 v32, s[48:51], s74 offen lds
    buffer_load_dwordx4 v33, s[48:51], s74 offen offset:1024 lds
    buffer_load_dwordx4 v34, s[48:51], s74 offen offset:2048 lds
    buffer_load_dwordx4 v35, s[48:51], s74 offen offset:3072 lds
    s_mov_b32 m0, 114944
    s_nop 0
    buffer_load_dwordx4 v48, s[44:47], s78 offen lds
    s_waitcnt vmcnt(55)
    buffer_load_dwordx4 v49, s[44:47], s78 offen offset:1024 lds
    s_mov_b32 m0, 90368
    s_nop 0
    buffer_load_dwordx4 v32, s[52:55], s74 offen lds
    buffer_load_dwordx4 v33, s[52:55], s74 offen offset:1024 lds
    buffer_load_dwordx4 v34, s[52:55], s74 offen offset:2048 lds
    buffer_load_dwordx4 v35, s[52:55], s74 offen offset:3072 lds
    s_waitcnt vmcnt(30) lgkmcnt(0)
    s_barrier
    s_lshr_b64 s[80:81], s[80:81], 4
    s_and_b32 s79, s80, 15
    s_add_u32 s79, s79, s43
    s_sub_u32 s38, s79, 10
    s_cmp_ge_u32 s79, 10
    s_cselect_b32 s79, s38, s79
    s_mul_i32 s75, s79, 245760
    s_lshl_b32 s78, s79, 7
    s_mov_b32 m0, 141696
    s_nop 0
    buffer_load_dwordx4 v36, s[44:47], s78 offen lds
    buffer_load_dwordx4 v37, s[44:47], s78 offen offset:1024 lds
    buffer_load_dwordx4 v38, s[44:47], s78 offen offset:2048 lds
    buffer_load_dwordx4 v39, s[44:47], s78 offen offset:3072 lds
    s_mov_b32 m0, 117120
    s_nop 0
    buffer_load_dwordx4 v28, s[48:51], s75 offen lds
    buffer_load_dwordx4 v29, s[48:51], s75 offen offset:1024 lds
    buffer_load_dwordx4 v30, s[48:51], s75 offen offset:2048 lds
    buffer_load_dwordx4 v31, s[48:51], s75 offen offset:3072 lds
    s_mov_b32 m0, 145792
    s_nop 0
    buffer_load_dwordx4 v40, s[44:47], s78 offen lds
    buffer_load_dwordx4 v41, s[44:47], s78 offen offset:1024 lds
    buffer_load_dwordx4 v42, s[44:47], s78 offen offset:2048 lds
    buffer_load_dwordx4 v43, s[44:47], s78 offen offset:3072 lds
    s_mov_b32 m0, 125312
    s_nop 0
    buffer_load_dwordx4 v28, s[52:55], s75 offen lds
    buffer_load_dwordx4 v29, s[52:55], s75 offen offset:1024 lds
    buffer_load_dwordx4 v30, s[52:55], s75 offen offset:2048 lds
    buffer_load_dwordx4 v31, s[52:55], s75 offen offset:3072 lds
    s_mov_b32 m0, 149888
    s_nop 0
    buffer_load_dwordx4 v44, s[44:47], s78 offen lds
    buffer_load_dwordx4 v45, s[44:47], s78 offen offset:1024 lds
    buffer_load_dwordx4 v46, s[44:47], s78 offen offset:2048 lds
    buffer_load_dwordx4 v47, s[44:47], s78 offen offset:3072 lds
    s_mov_b32 m0, 121216
    s_nop 0
    buffer_load_dwordx4 v32, s[48:51], s75 offen lds
    buffer_load_dwordx4 v33, s[48:51], s75 offen offset:1024 lds
    buffer_load_dwordx4 v34, s[48:51], s75 offen offset:2048 lds
    buffer_load_dwordx4 v35, s[48:51], s75 offen offset:3072 lds
    s_mov_b32 m0, 153984
    s_nop 0
    buffer_load_dwordx4 v48, s[44:47], s78 offen lds
    buffer_load_dwordx4 v49, s[44:47], s78 offen offset:1024 lds
    s_mov_b32 m0, 129408
    s_nop 0
    buffer_load_dwordx4 v32, s[52:55], s75 offen lds
    buffer_load_dwordx4 v33, s[52:55], s75 offen offset:1024 lds
    buffer_load_dwordx4 v34, s[52:55], s75 offen offset:2048 lds
    buffer_load_dwordx4 v35, s[52:55], s75 offen offset:3072 lds
    s_waitcnt vmcnt(30) lgkmcnt(0)
    s_barrier
    s_lshr_b64 s[80:81], s[80:81], 4
    s_and_b32 s79, s80, 15
    s_add_u32 s79, s79, s43
    s_sub_u32 s38, s79, 10
    s_cmp_ge_u32 s79, 10
    s_cselect_b32 s79, s38, s79
    s_mul_i32 s76, s79, 245760
    s_lshl_b32 s78, s79, 7
    s_mov_b32 m0, 24576
    s_nop 0
    buffer_load_dwordx4 v36, s[44:47], s78 offen lds
    buffer_load_dwordx4 v37, s[44:47], s78 offen offset:1024 lds
    buffer_load_dwordx4 v38, s[44:47], s78 offen offset:2048 lds
    buffer_load_dwordx4 v39, s[44:47], s78 offen offset:3072 lds
    s_mov_b32 m0, 0
    s_nop 0
    buffer_load_dwordx4 v28, s[48:51], s76 offen lds
    buffer_load_dwordx4 v29, s[48:51], s76 offen offset:1024 lds
    buffer_load_dwordx4 v30, s[48:51], s76 offen offset:2048 lds
    buffer_load_dwordx4 v31, s[48:51], s76 offen offset:3072 lds
    s_mov_b32 m0, 28672
    s_nop 0
    buffer_load_dwordx4 v40, s[44:47], s78 offen lds
    buffer_load_dwordx4 v41, s[44:47], s78 offen offset:1024 lds
    buffer_load_dwordx4 v42, s[44:47], s78 offen offset:2048 lds
    buffer_load_dwordx4 v43, s[44:47], s78 offen offset:3072 lds
    s_mov_b32 m0, 8192
    s_nop 0
    buffer_load_dwordx4 v28, s[52:55], s76 offen lds
    buffer_load_dwordx4 v29, s[52:55], s76 offen offset:1024 lds
    buffer_load_dwordx4 v30, s[52:55], s76 offen offset:2048 lds
    buffer_load_dwordx4 v31, s[52:55], s76 offen offset:3072 lds
    s_mov_b32 m0, 32768
    s_nop 0
    buffer_load_dwordx4 v44, s[44:47], s78 offen lds
    buffer_load_dwordx4 v45, s[44:47], s78 offen offset:1024 lds
    buffer_load_dwordx4 v46, s[44:47], s78 offen offset:2048 lds
    buffer_load_dwordx4 v47, s[44:47], s78 offen offset:3072 lds
    s_mov_b32 m0, 4096
    s_nop 0
    buffer_load_dwordx4 v32, s[48:51], s76 offen lds
    buffer_load_dwordx4 v33, s[48:51], s76 offen offset:1024 lds
    buffer_load_dwordx4 v34, s[48:51], s76 offen offset:2048 lds
    buffer_load_dwordx4 v35, s[48:51], s76 offen offset:3072 lds
    s_mov_b32 m0, 36864
    s_nop 0
    buffer_load_dwordx4 v48, s[44:47], s78 offen lds
    buffer_load_dwordx4 v49, s[44:47], s78 offen offset:1024 lds
    s_mov_b32 m0, 12288
    s_nop 0
    buffer_load_dwordx4 v32, s[52:55], s76 offen lds
    buffer_load_dwordx4 v33, s[52:55], s76 offen offset:1024 lds
    buffer_load_dwordx4 v34, s[52:55], s76 offen offset:2048 lds
    buffer_load_dwordx4 v35, s[52:55], s76 offen offset:3072 lds
    s_waitcnt vmcnt(30) lgkmcnt(0)
    s_barrier
    s_lshr_b64 s[80:81], s[80:81], 4
    s_and_b32 s79, s80, 15
    s_add_u32 s79, s79, s43
    s_sub_u32 s38, s79, 10
    s_cmp_ge_u32 s79, 10
    s_cselect_b32 s79, s38, s79
    s_mul_i32 s77, s79, 245760
    s_lshl_b32 s78, s79, 7
    s_mov_b32 m0, 63616
    s_nop 0
    buffer_load_dwordx4 v36, s[44:47], s78 offen lds
    buffer_load_dwordx4 v37, s[44:47], s78 offen offset:1024 lds
    buffer_load_dwordx4 v38, s[44:47], s78 offen offset:2048 lds
    buffer_load_dwordx4 v39, s[44:47], s78 offen offset:3072 lds
    s_mov_b32 m0, 39040
    s_nop 0
    buffer_load_dwordx4 v28, s[48:51], s77 offen lds
    buffer_load_dwordx4 v29, s[48:51], s77 offen offset:1024 lds
    buffer_load_dwordx4 v30, s[48:51], s77 offen offset:2048 lds
    buffer_load_dwordx4 v31, s[48:51], s77 offen offset:3072 lds
    s_mov_b32 m0, 67712
    s_nop 0
    buffer_load_dwordx4 v40, s[44:47], s78 offen lds
    buffer_load_dwordx4 v41, s[44:47], s78 offen offset:1024 lds
    buffer_load_dwordx4 v42, s[44:47], s78 offen offset:2048 lds
    buffer_load_dwordx4 v43, s[44:47], s78 offen offset:3072 lds
    s_mov_b32 m0, 47232
    s_nop 0
    buffer_load_dwordx4 v28, s[52:55], s77 offen lds
    buffer_load_dwordx4 v29, s[52:55], s77 offen offset:1024 lds
    buffer_load_dwordx4 v30, s[52:55], s77 offen offset:2048 lds
    buffer_load_dwordx4 v31, s[52:55], s77 offen offset:3072 lds
    s_mov_b32 m0, 71808
    s_nop 0
    buffer_load_dwordx4 v44, s[44:47], s78 offen lds
    buffer_load_dwordx4 v45, s[44:47], s78 offen offset:1024 lds
    buffer_load_dwordx4 v46, s[44:47], s78 offen offset:2048 lds
    buffer_load_dwordx4 v47, s[44:47], s78 offen offset:3072 lds
    s_mov_b32 m0, 43136
    s_nop 0
    buffer_load_dwordx4 v32, s[48:51], s77 offen lds
    buffer_load_dwordx4 v33, s[48:51], s77 offen offset:1024 lds
    buffer_load_dwordx4 v34, s[48:51], s77 offen offset:2048 lds
    buffer_load_dwordx4 v35, s[48:51], s77 offen offset:3072 lds
    s_mov_b32 m0, 75904
    s_nop 0
    buffer_load_dwordx4 v48, s[44:47], s78 offen lds
    buffer_load_dwordx4 v49, s[44:47], s78 offen offset:1024 lds
    s_mov_b32 m0, 51328
    s_nop 0
    buffer_load_dwordx4 v32, s[52:55], s77 offen lds
    buffer_load_dwordx4 v33, s[52:55], s77 offen offset:1024 lds
    buffer_load_dwordx4 v34, s[52:55], s77 offen offset:2048 lds
    buffer_load_dwordx4 v35, s[52:55], s77 offen offset:3072 lds
    s_waitcnt vmcnt(30) lgkmcnt(0)
    s_barrier
    s_lshr_b64 s[80:81], s[80:81], 4
    s_and_b32 s79, s80, 15
    s_add_u32 s79, s79, s43
    s_sub_u32 s38, s79, 10
    s_cmp_ge_u32 s79, 10
    s_cselect_b32 s79, s38, s79
    s_mov_b32 m0, 94464
    s_nop 0
    buffer_load_dwordx4 v28, s[56:59], s74 offen lds
    buffer_load_dwordx4 v29, s[56:59], s74 offen offset:1024 lds
    buffer_load_dwordx4 v30, s[56:59], s74 offen offset:2048 lds
    buffer_load_dwordx4 v31, s[56:59], s74 offen offset:3072 lds
    s_mov_b32 m0, 98560
    s_nop 0
    buffer_load_dwordx4 v32, s[56:59], s74 offen lds
    buffer_load_dwordx4 v33, s[56:59], s74 offen offset:1024 lds
    buffer_load_dwordx4 v34, s[56:59], s74 offen offset:2048 lds
    buffer_load_dwordx4 v35, s[56:59], s74 offen offset:3072 lds
    s_mov_b32 m0, 133504
    s_nop 0
    buffer_load_dwordx4 v28, s[56:59], s75 offen lds
    buffer_load_dwordx4 v29, s[56:59], s75 offen offset:1024 lds
    buffer_load_dwordx4 v30, s[56:59], s75 offen offset:2048 lds
    buffer_load_dwordx4 v31, s[56:59], s75 offen offset:3072 lds
    s_waitcnt vmcnt(12) lgkmcnt(0)
    s_barrier
    s_mov_b32 m0, 137600
    s_nop 0
    buffer_load_dwordx4 v32, s[56:59], s75 offen lds
    buffer_load_dwordx4 v33, s[56:59], s75 offen offset:1024 lds
    buffer_load_dwordx4 v34, s[56:59], s75 offen offset:2048 lds
    buffer_load_dwordx4 v35, s[56:59], s75 offen offset:3072 lds
    s_mov_b32 m0, 16384
    s_nop 0
    buffer_load_dwordx4 v28, s[56:59], s76 offen lds
    buffer_load_dwordx4 v29, s[56:59], s76 offen offset:1024 lds
    buffer_load_dwordx4 v30, s[56:59], s76 offen offset:2048 lds
    buffer_load_dwordx4 v31, s[56:59], s76 offen offset:3072 lds
    s_mov_b32 m0, 20480
    s_nop 0
    buffer_load_dwordx4 v32, s[56:59], s76 offen lds
    buffer_load_dwordx4 v33, s[56:59], s76 offen offset:1024 lds
    buffer_load_dwordx4 v34, s[56:59], s76 offen offset:2048 lds
    buffer_load_dwordx4 v35, s[56:59], s76 offen offset:3072 lds
    s_mov_b32 m0, 55424
    s_nop 0
    buffer_load_dwordx4 v28, s[56:59], s77 offen lds
    buffer_load_dwordx4 v29, s[56:59], s77 offen offset:1024 lds
    buffer_load_dwordx4 v30, s[56:59], s77 offen offset:2048 lds
    buffer_load_dwordx4 v31, s[56:59], s77 offen offset:3072 lds
    s_mov_b32 m0, 59520
    s_nop 0
    buffer_load_dwordx4 v32, s[56:59], s77 offen lds
    buffer_load_dwordx4 v33, s[56:59], s77 offen offset:1024 lds
    buffer_load_dwordx4 v34, s[56:59], s77 offen offset:2048 lds
    buffer_load_dwordx4 v35, s[56:59], s77 offen offset:3072 lds
    s_mov_b32 s10, 20480
    v_lshrrev_b32 v52, 5, v1
    v_lshlrev_b32 v52, 3, v52
    v_add_u32 v53, 2, v52
    v_add_u32 v54, 4, v52
    v_add_u32 v55, 6, v52
    v_add_u32 v56, 16, v52
    v_add_u32 v57, 18, v52
    v_add_u32 v58, 20, v52
    v_add_u32 v59, 22, v52
    v_and_b32 v7, 3, v5
    v_mul_u32_u24 v7, 1280, v7
    v_add_u32 v60, v7, v50
    v_xor_b32 v61, 64, v60
    v_add_u32 v61, 4096, v61
    v_add_u32 v62, 8192, v60
    v_add_u32 v63, 8192, v61
    s_mov_b32 s5, 0xbfe10856
    s_mov_b32 s6, 0xaff80255
    s_mov_b32 s7, 0xabfe4015
    s_mov_b32 s8, 0xaa7fd005
    s_mov_b32 s9, 0x6adfb401
    s_cmp_eq_u32 s42, 1
    s_cselect_b32 s5, 0xabfe4015, s5
    s_cselect_b32 s6, 0xaa7fd005, s6
    s_cselect_b32 s7, 0x6adfb401, s7
    s_cselect_b32 s8, 0xbfe10856, s8
    s_cselect_b32 s9, 0xaff80255, s9
    s_cmp_eq_u32 s42, 2
    s_cselect_b32 s5, 0x6adfb401, s5
    s_cselect_b32 s6, 0xbfe10856, s6
    s_cselect_b32 s7, 0xaff80255, s7
    s_cselect_b32 s8, 0xabfe4015, s8
    s_cselect_b32 s9, 0xaa7fd005, s9
    s_cmp_eq_u32 s42, 3
    s_cselect_b32 s5, 0xaff80255, s5
    s_cselect_b32 s6, 0xabfe4015, s6
    s_cselect_b32 s7, 0xaa7fd005, s7
    s_cselect_b32 s8, 0x6adfb401, s8
    s_cselect_b32 s9, 0xbfe10856, s9
    s_cmp_eq_u32 s42, 4
    s_cselect_b32 s5, 0xaa7fd005, s5
    s_cselect_b32 s6, 0x6adfb401, s6
    s_cselect_b32 s7, 0xbfe10856, s7
    s_cselect_b32 s8, 0xaff80255, s8
    s_cselect_b32 s9, 0xabfe4015, s9
    s_mul_i32 s4, s42, 163840
    s_mov_b32 m0, 0
    v_bfe_u32 v64, s5, v52, 2
    v_mad_u32_u24 v64, v64, s10, v60
    buffer_load_dwordx4 v64, s[60:63], s4 offen lds
    v_bfe_u32 v65, s5, v53, 2
    v_mad_u32_u24 v65, v65, s10, v61
    buffer_load_dwordx4 v65, s[60:63], s4 offen offset:1024 lds
    v_bfe_u32 v64, s5, v54, 2
    v_mad_u32_u24 v64, v64, s10, v62
    buffer_load_dwordx4 v64, s[60:63], s4 offen offset:2048 lds
    v_bfe_u32 v65, s5, v55, 2
    v_mad_u32_u24 v65, v65, s10, v63
    buffer_load_dwordx4 v65, s[60:63], s4 offen offset:3072 lds
    s_mov_b32 m0, 4096
    v_bfe_u32 v64, s5, v56, 2
    v_mad_u32_u24 v64, v64, s10, v60
    buffer_load_dwordx4 v64, s[60:63], s4 offen lds
    v_bfe_u32 v65, s5, v57, 2
    v_mad_u32_u24 v65, v65, s10, v61
    buffer_load_dwordx4 v65, s[60:63], s4 offen offset:1024 lds
    v_bfe_u32 v64, s5, v58, 2
    v_mad_u32_u24 v64, v64, s10, v62
    buffer_load_dwordx4 v64, s[60:63], s4 offen offset:2048 lds
    v_bfe_u32 v65, s5, v59, 2
    v_mad_u32_u24 v65, v65, s10, v63
    buffer_load_dwordx4 v65, s[60:63], s4 offen offset:3072 lds
    s_add_u32 s4, s4, 81920
    s_cmp_eq_u32 s4, 819200
    s_cselect_b32 s4, 0, s4
    s_mov_b32 m0, 8192
    v_bfe_u32 v64, s6, v52, 2
    v_mad_u32_u24 v64, v64, s10, v60
    buffer_load_dwordx4 v64, s[60:63], s4 offen lds
    v_bfe_u32 v65, s6, v53, 2
    v_mad_u32_u24 v65, v65, s10, v61
    buffer_load_dwordx4 v65, s[60:63], s4 offen offset:1024 lds
    v_bfe_u32 v64, s6, v54, 2
    v_mad_u32_u24 v64, v64, s10, v62
    buffer_load_dwordx4 v64, s[60:63], s4 offen offset:2048 lds
    v_bfe_u32 v65, s6, v55, 2
    v_mad_u32_u24 v65, v65, s10, v63
    buffer_load_dwordx4 v65, s[60:63], s4 offen offset:3072 lds
    s_mov_b32 m0, 12288
    v_bfe_u32 v64, s6, v56, 2
    v_mad_u32_u24 v64, v64, s10, v60
    buffer_load_dwordx4 v64, s[60:63], s4 offen lds
    v_bfe_u32 v65, s6, v57, 2
    v_mad_u32_u24 v65, v65, s10, v61
    buffer_load_dwordx4 v65, s[60:63], s4 offen offset:1024 lds
    v_bfe_u32 v64, s6, v58, 2
    v_mad_u32_u24 v64, v64, s10, v62
    buffer_load_dwordx4 v64, s[60:63], s4 offen offset:2048 lds
    v_bfe_u32 v65, s6, v59, 2
    v_mad_u32_u24 v65, v65, s10, v63
    buffer_load_dwordx4 v65, s[60:63], s4 offen offset:3072 lds
    s_add_u32 s4, s4, 81920
    s_cmp_eq_u32 s4, 819200
    s_cselect_b32 s4, 0, s4
    s_waitcnt vmcnt(16)
    v_mov_b32 v5, 157980
    v_mov_b32 v6, 1
    s_mov_b64 exec, 1
    ds_add_u32 v5, v6
    s_mov_b64 exec, -1
    v_mov_b32 v5, 157972
    v_mov_b32 v6, 1
    s_mov_b64 exec, 1
    ds_add_u32 v5, v6
    s_mov_b64 exec, -1
    s_mov_b32 m0, 24576
    v_bfe_u32 v64, s7, v52, 2
    v_mad_u32_u24 v64, v64, s10, v60
    buffer_load_dwordx4 v64, s[60:63], s4 offen lds
    v_bfe_u32 v65, s7, v53, 2
    v_mad_u32_u24 v65, v65, s10, v61
    buffer_load_dwordx4 v65, s[60:63], s4 offen offset:1024 lds
    v_bfe_u32 v64, s7, v54, 2
    v_mad_u32_u24 v64, v64, s10, v62
    buffer_load_dwordx4 v64, s[60:63], s4 offen offset:2048 lds
    v_bfe_u32 v65, s7, v55, 2
    v_mad_u32_u24 v65, v65, s10, v63
    buffer_load_dwordx4 v65, s[60:63], s4 offen offset:3072 lds
    s_mov_b32 m0, 28672
    v_bfe_u32 v64, s7, v56, 2
    v_mad_u32_u24 v64, v64, s10, v60
    buffer_load_dwordx4 v64, s[60:63], s4 offen lds
    v_bfe_u32 v65, s7, v57, 2
    v_mad_u32_u24 v65, v65, s10, v61
    buffer_load_dwordx4 v65, s[60:63], s4 offen offset:1024 lds
    v_bfe_u32 v64, s7, v58, 2
    v_mad_u32_u24 v64, v64, s10, v62
    buffer_load_dwordx4 v64, s[60:63], s4 offen offset:2048 lds
    v_bfe_u32 v65, s7, v59, 2
    v_mad_u32_u24 v65, v65, s10, v63
    buffer_load_dwordx4 v65, s[60:63], s4 offen offset:3072 lds
    s_add_u32 s4, s4, 81920
    s_cmp_eq_u32 s4, 819200
    s_cselect_b32 s4, 0, s4
    s_mov_b32 m0, 123136
    v_bfe_u32 v64, s8, v52, 2
    v_mad_u32_u24 v64, v64, s10, v60
    buffer_load_dwordx4 v64, s[60:63], s4 offen lds
    v_bfe_u32 v65, s8, v53, 2
    v_mad_u32_u24 v65, v65, s10, v61
    buffer_load_dwordx4 v65, s[60:63], s4 offen offset:1024 lds
    v_bfe_u32 v64, s8, v54, 2
    v_mad_u32_u24 v64, v64, s10, v62
    buffer_load_dwordx4 v64, s[60:63], s4 offen offset:2048 lds
    v_bfe_u32 v65, s8, v55, 2
    v_mad_u32_u24 v65, v65, s10, v63
    buffer_load_dwordx4 v65, s[60:63], s4 offen offset:3072 lds
    s_mov_b32 m0, 127232
    v_bfe_u32 v64, s8, v56, 2
    v_mad_u32_u24 v64, v64, s10, v60
    buffer_load_dwordx4 v64, s[60:63], s4 offen lds
    v_bfe_u32 v65, s8, v57, 2
    v_mad_u32_u24 v65, v65, s10, v61
    buffer_load_dwordx4 v65, s[60:63], s4 offen offset:1024 lds
    v_bfe_u32 v64, s8, v58, 2
    v_mad_u32_u24 v64, v64, s10, v62
    buffer_load_dwordx4 v64, s[60:63], s4 offen offset:2048 lds
    v_bfe_u32 v65, s8, v59, 2
    v_mad_u32_u24 v65, v65, s10, v63
    buffer_load_dwordx4 v65, s[60:63], s4 offen offset:3072 lds
    s_add_u32 s4, s4, 81920
    s_cmp_eq_u32 s4, 819200
    s_cselect_b32 s4, 0, s4
    s_mov_b32 m0, 80000
    v_bfe_u32 v64, s9, v52, 2
    v_mad_u32_u24 v64, v64, s10, v60
    buffer_load_dwordx4 v64, s[60:63], s4 offen lds
    v_bfe_u32 v65, s9, v53, 2
    v_mad_u32_u24 v65, v65, s10, v61
    buffer_load_dwordx4 v65, s[60:63], s4 offen offset:1024 lds
    v_bfe_u32 v64, s9, v54, 2
    v_mad_u32_u24 v64, v64, s10, v62
    buffer_load_dwordx4 v64, s[60:63], s4 offen offset:2048 lds
    v_bfe_u32 v65, s9, v55, 2
    v_mad_u32_u24 v65, v65, s10, v63
    buffer_load_dwordx4 v65, s[60:63], s4 offen offset:3072 lds
    s_mov_b32 m0, 84096
    v_bfe_u32 v64, s9, v56, 2
    v_mad_u32_u24 v64, v64, s10, v60
    buffer_load_dwordx4 v64, s[60:63], s4 offen lds
    v_bfe_u32 v65, s9, v57, 2
    v_mad_u32_u24 v65, v65, s10, v61
    buffer_load_dwordx4 v65, s[60:63], s4 offen offset:1024 lds
    v_bfe_u32 v64, s9, v58, 2
    v_mad_u32_u24 v64, v64, s10, v62
    buffer_load_dwordx4 v64, s[60:63], s4 offen offset:2048 lds
    v_bfe_u32 v65, s9, v59, 2
    v_mad_u32_u24 v65, v65, s10, v63
    buffer_load_dwordx4 v65, s[60:63], s4 offen offset:3072 lds
    s_add_u32 s4, s4, 81920
    s_cmp_eq_u32 s4, 819200
    s_cselect_b32 s4, 0, s4
    s_waitcnt vmcnt(0)
    v_mov_b32 v7, 157980
    v_mov_b32 v6, 1
    s_mov_b64 exec, 1
    ds_add_u32 v7, v6
    s_mov_b64 exec, -1
Lcw_7:
    s_sub_u32 s35, s35, 1
    s_cbranch_scc1 Lend
    s_sleep 2
    ds_read_b32 v6, v5
    s_waitcnt lgkmcnt(0)
    v_readfirstlane_b32 s38, v6
    s_nop 0
    s_cmp_lt_u32 s38, 8
    s_cbranch_scc1 Lcw_7
    s_lshl_b32 s36, s32, 7
    s_add_u32 s36, s36, 8257536
    v_mov_b32 v69, s36
    buffer_load_dwordx4 v[70:73], v69, s[28:31], 0 offen sc1
    v_mov_b32 v5, 157976
Lcw_8:
    s_sub_u32 s35, s35, 1
    s_cbranch_scc1 Lend
    s_sleep 2
    ds_read_b32 v6, v5
    s_waitcnt lgkmcnt(0)
    v_readfirstlane_b32 s38, v6
    s_nop 0
    s_cmp_lt_u32 s38, 7
    s_cbranch_scc1 Lcw_8
    s_mov_b32 m0, 32768
    v_bfe_u32 v64, s5, v52, 2
    v_mad_u32_u24 v64, v64, s10, v60
    buffer_load_dwordx4 v64, s[60:63], s4 offen lds
    v_bfe_u32 v65, s5, v53, 2
    v_mad_u32_u24 v65, v65, s10, v61
    buffer_load_dwordx4 v65, s[60:63], s4 offen offset:1024 lds
    v_bfe_u32 v64, s5, v54, 2
    v_mad_u32_u24 v64, v64, s10, v62
    buffer_load_dwordx4 v64, s[60:63], s4 offen offset:2048 lds
    v_bfe_u32 v65, s5, v55, 2
    v_mad_u32_u24 v65, v65, s10, v63
    buffer_load_dwordx4 v65, s[60:63], s4 offen offset:3072 lds
    s_mov_b32 m0, 36864
    v_bfe_u32 v64, s5, v56, 2
    v_mad_u32_u24 v64, v64, s10, v60
    buffer_load_dwordx4 v64, s[60:63], s4 offen lds
    v_bfe_u32 v65, s5, v57, 2
    v_mad_u32_u24 v65, v65, s10, v61
    buffer_load_dwordx4 v65, s[60:63], s4 offen offset:1024 lds
    v_bfe_u32 v64, s5, v58, 2
    v_mad_u32_u24 v64, v64, s10, v62
    buffer_load_dwordx4 v64, s[60:63], s4 offen offset:2048 lds
    v_bfe_u32 v65, s5, v59, 2
    v_mad_u32_u24 v65, v65, s10, v63
    buffer_load_dwordx4 v65, s[60:63], s4 offen offset:3072 lds
    s_add_u32 s4, s4, 81920
    s_cmp_eq_u32 s4, 819200
    s_cselect_b32 s4, 0, s4
    s_mov_b32 m0, 40960
    v_bfe_u32 v64, s6, v52, 2
    v_mad_u32_u24 v64, v64, s10, v60
    buffer_load_dwordx4 v64, s[60:63], s4 offen lds
    v_bfe_u32 v65, s6, v53, 2
    v_mad_u32_u24 v65, v65, s10, v61
    buffer_load_dwordx4 v65, s[60:63], s4 offen offset:1024 lds
    v_bfe_u32 v64, s6, v54, 2
    v_mad_u32_u24 v64, v64, s10, v62
    buffer_load_dwordx4 v64, s[60:63], s4 offen offset:2048 lds
    v_bfe_u32 v65, s6, v55, 2
    v_mad_u32_u24 v65, v65, s10, v63
    buffer_load_dwordx4 v65, s[60:63], s4 offen offset:3072 lds
    s_mov_b32 m0, 45056
    v_bfe_u32 v64, s6, v56, 2
    v_mad_u32_u24 v64, v64, s10, v60
    buffer_load_dwordx4 v64, s[60:63], s4 offen lds
    v_bfe_u32 v65, s6, v57, 2
    v_mad_u32_u24 v65, v65, s10, v61
    buffer_load_dwordx4 v65, s[60:63], s4 offen offset:1024 lds
    v_bfe_u32 v64, s6, v58, 2
    v_mad_u32_u24 v64, v64, s10, v62
    buffer_load_dwordx4 v64, s[60:63], s4 offen offset:2048 lds
    v_bfe_u32 v65, s6, v59, 2
    v_mad_u32_u24 v65, v65, s10, v63
    buffer_load_dwordx4 v65, s[60:63], s4 offen offset:3072 lds
    s_add_u32 s4, s4, 81920
    s_cmp_eq_u32 s4, 819200
    s_cselect_b32 s4, 0, s4
    s_mov_b32 m0, 63616
    v_bfe_u32 v64, s7, v52, 2
    v_mad_u32_u24 v64, v64, s10, v60
    buffer_load_dwordx4 v64, s[60:63], s4 offen lds
    v_bfe_u32 v65, s7, v53, 2
    v_mad_u32_u24 v65, v65, s10, v61
    buffer_load_dwordx4 v65, s[60:63], s4 offen offset:1024 lds
    v_bfe_u32 v64, s7, v54, 2
    v_mad_u32_u24 v64, v64, s10, v62
    buffer_load_dwordx4 v64, s[60:63], s4 offen offset:2048 lds
    v_bfe_u32 v65, s7, v55, 2
    v_mad_u32_u24 v65, v65, s10, v63
    buffer_load_dwordx4 v65, s[60:63], s4 offen offset:3072 lds
    s_mov_b32 m0, 67712
    v_bfe_u32 v64, s7, v56, 2
    v_mad_u32_u24 v64, v64, s10, v60
    buffer_load_dwordx4 v64, s[60:63], s4 offen lds
    v_bfe_u32 v65, s7, v57, 2
    v_mad_u32_u24 v65, v65, s10, v61
    buffer_load_dwordx4 v65, s[60:63], s4 offen offset:1024 lds
    v_bfe_u32 v64, s7, v58, 2
    v_mad_u32_u24 v64, v64, s10, v62
    buffer_load_dwordx4 v64, s[60:63], s4 offen offset:2048 lds
    v_bfe_u32 v65, s7, v59, 2
    v_mad_u32_u24 v65, v65, s10, v63
    buffer_load_dwordx4 v65, s[60:63], s4 offen offset:3072 lds
    s_add_u32 s4, s4, 81920
    s_cmp_eq_u32 s4, 819200
    s_cselect_b32 s4, 0, s4
    s_mov_b32 m0, 71808
    v_bfe_u32 v64, s8, v52, 2
    v_mad_u32_u24 v64, v64, s10, v60
    buffer_load_dwordx4 v64, s[60:63], s4 offen lds
    v_bfe_u32 v65, s8, v53, 2
    v_mad_u32_u24 v65, v65, s10, v61
    buffer_load_dwordx4 v65, s[60:63], s4 offen offset:1024 lds
    v_bfe_u32 v64, s8, v54, 2
    v_mad_u32_u24 v64, v64, s10, v62
    buffer_load_dwordx4 v64, s[60:63], s4 offen offset:2048 lds
    v_bfe_u32 v65, s8, v55, 2
    v_mad_u32_u24 v65, v65, s10, v63
    buffer_load_dwordx4 v65, s[60:63], s4 offen offset:3072 lds
    s_mov_b32 m0, 75904
    v_bfe_u32 v64, s8, v56, 2
    v_mad_u32_u24 v64, v64, s10, v60
    buffer_load_dwordx4 v64, s[60:63], s4 offen lds
    v_bfe_u32 v65, s8, v57, 2
    v_mad_u32_u24 v65, v65, s10, v61
    buffer_load_dwordx4 v65, s[60:63], s4 offen offset:1024 lds
    v_bfe_u32 v64, s8, v58, 2
    v_mad_u32_u24 v64, v64, s10, v62
    buffer_load_dwordx4 v64, s[60:63], s4 offen offset:2048 lds
    v_bfe_u32 v65, s8, v59, 2
    v_mad_u32_u24 v65, v65, s10, v63
    buffer_load_dwordx4 v65, s[60:63], s4 offen offset:3072 lds
    s_add_u32 s4, s4, 81920
    s_cmp_eq_u32 s4, 819200
    s_cselect_b32 s4, 0, s4
    s_mov_b32 m0, 49152
    v_bfe_u32 v64, s9, v52, 2
    v_mad_u32_u24 v64, v64, s10, v60
    buffer_load_dwordx4 v64, s[60:63], s4 offen lds
    v_bfe_u32 v65, s9, v53, 2
    v_mad_u32_u24 v65, v65, s10, v61
    buffer_load_dwordx4 v65, s[60:63], s4 offen offset:1024 lds
    v_bfe_u32 v64, s9, v54, 2
    v_mad_u32_u24 v64, v64, s10, v62
    buffer_load_dwordx4 v64, s[60:63], s4 offen offset:2048 lds
    v_bfe_u32 v65, s9, v55, 2
    v_mad_u32_u24 v65, v65, s10, v63
    buffer_load_dwordx4 v65, s[60:63], s4 offen offset:3072 lds
    s_mov_b32 m0, 88192
    v_bfe_u32 v64, s9, v56, 2
    v_mad_u32_u24 v64, v64, s10, v60
    buffer_load_dwordx4 v64, s[60:63], s4 offen lds
    v_bfe_u32 v65, s9, v57, 2
    v_mad_u32_u24 v65, v65, s10, v61
    buffer_load_dwordx4 v65, s[60:63], s4 offen offset:1024 lds
    v_bfe_u32 v64, s9, v58, 2
    v_mad_u32_u24 v64, v64, s10, v62
    buffer_load_dwordx4 v64, s[60:63], s4 offen offset:2048 lds
    v_bfe_u32 v65, s9, v59, 2
    v_mad_u32_u24 v65, v65, s10, v63
    buffer_load_dwordx4 v65, s[60:63], s4 offen offset:3072 lds
    s_add_u32 s4, s4, 81920
    s_cmp_eq_u32 s4, 819200
    s_cselect_b32 s4, 0, s4
    s_waitcnt vmcnt(0)
Lbc:
    v_readfirstlane_b32 s11, v70
    v_readfirstlane_b32 s36, v71
    v_readfirstlane_b32 s12, v72
    v_readfirstlane_b32 s37, v73
    s_cmp_eq_u32 s36, s34
    s_cselect_b32 s37, s37, s36
    s_cmp_eq_u32 s37, s34
    s_cbranch_scc1 Lbc_ok
Lbc_re:
    s_sub_u32 s35, s35, 1
    s_cbranch_scc1 Lend
    buffer_load_dwordx4 v[70:73], v69, s[28:31], 0 offen sc1
    s_waitcnt vmcnt(0)
    s_branch Lbc
Lbc_ok:
    s_mul_i32 s36, s32, 96
    s_and_b32 s13, s11, 0x7ff
    s_sub_u32 s13, 2047, s13
    s_sub_u32 s37, s13, s36
    s_cmp_lt_u32 s37, 96
    s_cselect_b32 s13, s13, -1
    s_and_b32 s14, s12, 0x7ff
    s_sub_u32 s14, 2047, s14
    s_sub_u32 s37, s14, s36
    s_cmp_lt_u32 s37, 96
    s_cselect_b32 s14, s14, -1
    v_mov_b32 v4, s13
    v_mov_b32 v5, s14
    v_mov_b32 v6, 157960
    s_cmp_lg_u32 s3, 0
    s_cbranch_scc1 Lag2
    ds_write_b64 v6, v[4:5]
    s_branch Lw0_done
Lag2:
    s_and_b32 s37, s13, s14
    s_cmp_eq_u32 s37, -1
    s_cbranch_scc1 Lw0_done
    s_max_i32 s36, s13, 0
    s_mul_i32 s36, s36, 1280
    s_lshl_b32 s37, s33, 7
    s_add_u32 s36, s36, s37
    s_add_u32 s36, s36, 4096
    v_lshlrev_b32 v8, 1, v1
    buffer_load_ushort v124, v8, s[44:47], s36 offen
    s_max_i32 s36, s14, 0
    s_mul_i32 s36, s36, 1280
    s_lshl_b32 s37, s33, 7
    s_add_u32 s36, s36, s37
    s_add_u32 s36, s36, 4096
    v_lshlrev_b32 v8, 1, v1
    buffer_load_ushort v125, v8, s[44:47], s36 offen
    v_min_u32 v7, 26, v1
    v_mul_u32_u24 v7, 10240, v7
Ly_poll:
    s_sub_u32 s35, s35, 1
    s_cbranch_scc1 Lend
    s_sleep 4
    s_lshl_b32 s36, s33, 10
    s_add_u32 s36, s36, 7405568
    buffer_load_dword v4, v7, s[28:31], s36 offen offset:1020 sc1
    s_waitcnt vmcnt(0)
    v_cmp_ne_u32 vcc, s34, v4
    s_nop 0
    s_cbranch_vccnz Ly_poll
    buffer_load_dwordx4 v[16:19], v13, s[28:31], s36 offen sc1
    s_add_u32 s36, s36, 10240
    buffer_load_dwordx4 v[20:23], v13, s[28:31], s36 offen sc1
    s_add_u32 s36, s36, 10240
    buffer_load_dwordx4 v[24:27], v13, s[28:31], s36 offen sc1
    s_add_u32 s36, s36, 10240
    buffer_load_dwordx4 v[28:31], v13, s[28:31], s36 offen sc1
    s_add_u32 s36, s36, 10240
    buffer_load_dwordx4 v[32:35], v13, s[28:31], s36 offen sc1
    s_add_u32 s36, s36, 10240
    buffer_load_dwordx4 v[36:39], v13, s[28:31], s36 offen sc1
    s_add_u32 s36, s36, 10240
    buffer_load_dwordx4 v[40:43], v13, s[28:31], s36 offen sc1
    s_add_u32 s36, s36, 10240
    buffer_load_dwordx4 v[44:47], v13, s[28:31], s36 offen sc1
    s_add_u32 s36, s36, 10240
    buffer_load_dwordx4 v[48:51], v13, s[28:31], s36 offen sc1
    s_add_u32 s36, s36, 10240
    buffer_load_dwordx4 v[52:55], v13, s[28:31], s36 offen sc1
    s_add_u32 s36, s36, 10240
    buffer_load_dwordx4 v[56:59], v13, s[28:31], s36 offen sc1
    s_add_u32 s36, s36, 10240
    buffer_load_dwordx4 v[60:63], v13, s[28:31], s36 offen sc1
    s_add_u32 s36, s36, 10240
    buffer_load_dwordx4 v[64:67], v13, s[28:31], s36 offen sc1
    s_add_u32 s36, s36, 10240
    buffer_load_dwordx4 v[68:71], v13, s[28:31], s36 offen sc1
    s_add_u32 s36, s36, 10240
    buffer_load_dwordx4 v[72:75], v13, s[28:31], s36 offen sc1
    s_add_u32 s36, s36, 10240
    buffer_load_dwordx4 v[76:79], v13, s[28:31], s36 offen sc1
    s_add_u32 s36, s36, 10240
    buffer_load_dwordx4 v[80:83], v13, s[28:31], s36 offen sc1
    s_add_u32 s36, s36, 10240
    buffer_load_dwordx4 v[84:87], v13, s[28:31], s36 offen sc1
    s_add_u32 s36, s36, 10240
    buffer_load_dwordx4 v[88:91], v13, s[28:31], s36 offen sc1
    s_add_u32 s36, s36, 10240
    buffer_load_dwordx4 v[92:95], v13, s[28:31], s36 offen sc1
    s_add_u32 s36, s36, 10240
    buffer_load_dwordx4 v[96:99], v13, s[28:31], s36 offen sc1
    s_add_u32 s36, s36, 10240
    buffer_load_dwordx4 v[100:103], v13, s[28:31], s36 offen sc1
    s_add_u32 s36, s36, 10240
    buffer_load_dwordx4 v[104:107], v13, s[28:31], s36 offen sc1
    s_add_u32 s36, s36, 10240
    buffer_load_dwordx4 v[108:111], v13, s[28:31], s36 offen sc1
    s_add_u32 s36, s36, 10240
    buffer_load_dwordx4 v[112:115], v13, s[28:31], s36 offen sc1
    s_add_u32 s36, s36, 10240
    buffer_load_dwordx4 v[116:119], v13, s[28:31], s36 offen sc1
    s_add_u32 s36, s36, 10240
    buffer_load_dwordx4 v[120:123], v13, s[28:31], s36 offen sc1
    s_add_u32 s36, s36, 10240
    s_waitcnt vmcnt(0)
    v_xor_b32 v4, s34, v17
    v_xor_b32 v5, s34, v19
    v_or_b32 v4, v4, v5
    v_xor_b32 v5, s34, v21
    v_or_b32 v4, v4, v5
    v_xor_b32 v5, s34, v23
    v_or_b32 v4, v4, v5
    v_xor_b32 v5, s34, v25
    v_or_b32 v4, v4, v5
    v_xor_b32 v5, s34, v27
    v_or_b32 v4, v4, v5
    v_xor_b32 v5, s34, v29
    v_or_b32 v4, v4, v5
    v_xor_b32 v5, s34, v31
    v_or_b32 v4, v4, v5
    v_xor_b32 v5, s34, v33
    v_or_b32 v4, v4, v5
    v_xor_b32 v5, s34, v35
    v_or_b32 v4, v4, v5
    v_xor_b32 v5, s34, v37
    v_or_b32 v4, v4, v5
    v_xor_b32 v5, s34, v39
    v_or_b32 v4, v4, v5
    v_xor_b32 v5, s34, v41
    v_or_b32 v4, v4, v5
    v_xor_b32 v5, s34, v43
    v_or_b32 v4, v4, v5
    v_xor_b32 v5, s34, v45
    v_or_b32 v4, v4, v5
    v_xor_b32 v5, s34, v47
    v_or_b32 v4, v4, v5
    v_xor_b32 v5, s34, v49
    v_or_b32 v4, v4, v5
    v_xor_b32 v5, s34, v51
    v_or_b32 v4, v4, v5
    v_xor_b32 v5, s34, v53
    v_or_b32 v4, v4, v5
    v_xor_b32 v5, s34, v55
    v_or_b32 v4, v4, v5
    v_xor_b32 v5, s34, v57
    v_or_b32 v4, v4, v5
    v_xor_b32 v5, s34, v59
    v_or_b32 v4, v4, v5
    v_xor_b32 v5, s34, v61
    v_or_b32 v4, v4, v5
    v_xor_b32 v5, s34, v63
    v_or_b32 v4, v4, v5
    v_xor_b32 v5, s34, v65
    v_or_b32 v4, v4, v5
    v_xor_b32 v5, s34, v67
    v_or_b32 v4, v4, v5
    v_xor_b32 v5, s34, v69
    v_or_b32 v4, v4, v5
    v_xor_b32 v5, s34, v71
    v_or_b32 v4, v4, v5
    v_xor_b32 v5, s34, v73
    v_or_b32 v4, v4, v5
    v_xor_b32 v5, s34, v75
    v_or_b32 v4, v4, v5
    v_xor_b32 v5, s34, v77
    v_or_b32 v4, v4, v5
    v_xor_b32 v5, s34, v79
    v_or_b32 v4, v4, v5
    v_xor_b32 v5, s34, v81
    v_or_b32 v4, v4, v5
    v_xor_b32 v5, s34, v83
    v_or_b32 v4, v4, v5
    v_xor_b32 v5, s34, v85
    v_or_b32 v4, v4, v5
    v_xor_b32 v5, s34, v87
    v_or_b32 v4, v4, v5
    v_xor_b32 v5, s34, v89
    v_or_b32 v4, v4, v5
    v_xor_b32 v5, s34, v91
    v_or_b32 v4, v4, v5
    v_xor_b32 v5, s34, v93
    v_or_b32 v4, v4, v5
    v_xor_b32 v5, s34, v95
    v_or_b32 v4, v4, v5
    v_xor_b32 v5, s34, v97
    v_or_b32 v4, v4, v5
    v_xor_b32 v5, s34, v99
    v_or_b32 v4, v4, v5
    v_xor_b32 v5, s34, v101
    v_or_b32 v4, v4, v5
    v_xor_b32 v5, s34, v103
    v_or_b32 v4, v4, v5
    v_xor_b32 v5, s34, v105
    v_or_b32 v4, v4, v5
    v_xor_b32 v5, s34, v107
    v_or_b32 v4, v4, v5
    v_xor_b32 v5, s34, v109
    v_or_b32 v4, v4, v5
    v_xor_b32 v5, s34, v111
    v_or_b32 v4, v4, v5
    v_xor_b32 v5, s34, v113
    v_or_b32 v4, v4, v5
    v_xor_b32 v5, s34, v115
    v_or_b32 v4, v4, v5
    v_xor_b32 v5, s34, v117
    v_or_b32 v4, v4, v5
    v_xor_b32 v5, s34, v119
    v_or_b32 v4, v4, v5
    v_xor_b32 v5, s34, v121
    v_or_b32 v4, v4, v5
    v_xor_b32 v5, s34, v123
    v_or_b32 v4, v4, v5
    v_cmp_ne_u32 vcc, 0, v4
    s_nop 0
    s_cmp_lg_u64 vcc, 0
    s_cbranch_scc1 Ly_poll
    v_add_f32 v16, v16, v20
    v_add_f32 v18, v18, v22
    v_add_f32 v16, v16, v24
    v_add_f32 v18, v18, v26
    v_add_f32 v16, v16, v28
    v_add_f32 v18, v18, v30
    v_add_f32 v16, v16, v32
    v_add_f32 v18, v18, v34
    v_add_f32 v16, v16, v36
    v_add_f32 v18, v18, v38
    v_add_f32 v16, v16, v40
    v_add_f32 v18, v18, v42
    v_add_f32 v16, v16, v44
    v_add_f32 v18, v18, v46
    v_add_f32 v16, v16, v48
    v_add_f32 v18, v18, v50
    v_add_f32 v16, v16, v52
    v_add_f32 v18, v18, v54
    v_add_f32 v16, v16, v56
    v_add_f32 v18, v18, v58
    v_add_f32 v16, v16, v60
    v_add_f32 v18, v18, v62
    v_add_f32 v16, v16, v64
    v_add_f32 v18, v18, v66
    v_add_f32 v16, v16, v68
    v_add_f32 v18, v18, v70
    v_add_f32 v16, v16, v72
    v_add_f32 v18, v18, v74
    v_add_f32 v16, v16, v76
    v_add_f32 v18, v18, v78
    v_add_f32 v16, v16, v80
    v_add_f32 v18, v18, v82
    v_add_f32 v16, v16, v84
    v_add_f32 v18, v18, v86
    v_add_f32 v16, v16, v88
    v_add_f32 v18, v18, v90
    v_add_f32 v16, v16, v92
    v_add_f32 v18, v18, v94
    v_add_f32 v16, v16, v96
    v_add_f32 v18, v18, v98
    v_add_f32 v16, v16, v100
    v_add_f32 v18, v18, v102
    v_add_f32 v16, v16, v104
    v_add_f32 v18, v18, v106
    v_add_f32 v16, v16, v108
    v_add_f32 v18, v18, v110
    v_add_f32 v16, v16, v112
    v_add_f32 v18, v18, v114
    v_add_f32 v16, v16, v116
    v_add_f32 v18, v18, v118
    v_add_f32 v16, v16, v120
    v_add_f32 v18, v18, v122
    s_lshr_b32 s36, s11, 16
    s_cmp_ge_u32 s36, 0x8000
    s_cselect_b32 s37, 0x8000, -1
    s_xor_b32 s36, s36, s37
    s_lshl_b32 s36, s36, 16
    v_mov_b32 v4, s36
    v_mul_f32 v4, 0xbfb8aa3b, v4
    v_exp_f32 v4, v4
    s_nop 0
    v_add_f32 v4, 1.0, v4
    v_rcp_f32 v4, v4
    s_nop 0
    v_cvt_pk_bf16_f32 v4, v4, v4
    v_lshlrev_b32 v4, 16, v4
    v_cvt_pk_bf16_f32 v16, v16, v16
    v_lshlrev_b32 v16, 16, v16
    v_mul_f32 v16, v16, v4
    v_cvt_pk_bf16_f32 v16, v16, v16
    v_lshlrev_b32 v16, 16, v16
    s_lshr_b32 s36, s12, 16
    s_cmp_ge_u32 s36, 0x8000
    s_cselect_b32 s37, 0x8000, -1
    s_xor_b32 s36, s36, s37
    s_lshl_b32 s36, s36, 16
    v_mov_b32 v4, s36
    v_mul_f32 v4, 0xbfb8aa3b, v4
    v_exp_f32 v4, v4
    s_nop 0
    v_add_f32 v4, 1.0, v4
    v_rcp_f32 v4, v4
    s_nop 0
    v_cvt_pk_bf16_f32 v4, v4, v4
    v_lshlrev_b32 v4, 16, v4
    v_cvt_pk_bf16_f32 v18, v18, v18
    v_lshlrev_b32 v18, 16, v18
    v_mul_f32 v18, v18, v4
    v_cvt_pk_bf16_f32 v18, v18, v18
    v_lshlrev_b32 v18, 16, v18
    s_mul_i32 s36, s32, 96
    s_sub_u32 s36, s13, s36
    s_max_i32 s36, s36, 0
    s_lshl_b32 s36, s36, 2
    s_add_u32 s36, s36, 156288
    v_mov_b32 v4, s36
    ds_read2st64_b32 v[4:5], v4 offset0:0 offset1:2
    v_lshlrev_b32 v124, 16, v124
    s_waitcnt lgkmcnt(0)
    v_add_f32 v20, v124, v4
    v_cvt_pk_bf16_f32 v20, v20, v20
    v_lshlrev_b32 v20, 16, v20
    v_mul_f32 v20, v20, v5
    v_cvt_pk_bf16_f32 v20, v20, v20
    v_lshlrev_b32 v20, 16, v20
    v_add_f32 v20, v20, v16
    v_cvt_pk_bf16_f32 v20, v20, v20
    v_lshlrev_b32 v20, 16, v20
    v_mul_f32 v16, 0xbfb8aa3b, v20
    v_exp_f32 v16, v16
    s_nop 0
    v_add_f32 v16, 1.0, v16
    v_rcp_f32 v16, v16
    s_nop 0
    v_mul_f32 v16, v16, v20
    v_cvt_pk_bf16_f32 v16, v16, v16
    v_lshlrev_b32 v16, 16, v16
    s_mul_i32 s36, s32, 96
    s_sub_u32 s36, s14, s36
    s_max_i32 s36, s36, 0
    s_lshl_b32 s36, s36, 2
    s_add_u32 s36, s36, 156288
    v_mov_b32 v4, s36
    ds_read2st64_b32 v[4:5], v4 offset0:0 offset1:2
    v_lshlrev_b32 v125, 16, v125
    s_waitcnt lgkmcnt(0)
    v_add_f32 v22, v125, v4
    v_cvt_pk_bf16_f32 v22, v22, v22
    v_lshlrev_b32 v22, 16, v22
    v_mul_f32 v22, v22, v5
    v_cvt_pk_bf16_f32 v22, v22, v22
    v_lshlrev_b32 v22, 16, v22
    v_add_f32 v22, v22, v18
    v_cvt_pk_bf16_f32 v22, v22, v22
    v_lshlrev_b32 v22, 16, v22
    v_mul_f32 v18, 0xbfb8aa3b, v22
    v_exp_f32 v18, v18
    s_nop 0
    v_add_f32 v18, 1.0, v18
    v_rcp_f32 v18, v18
    s_nop 0
    v_mul_f32 v18, v18, v22
    v_cvt_pk_bf16_f32 v18, v18, v18
    v_lshlrev_b32 v18, 16, v18
    v_add_u32 v5, 158208, v12
    ds_write2st64_b32 v5, v16, v18 offset0:0 offset1:1
    v_mov_b32 v6, 157956
    v_mov_b32 v7, 1
    s_mov_b64 exec, 1
    ds_add_u32 v6, v7
    s_mov_b64 exec, -1
Lw0_done:
    s_endpgm
Lagent:
    s_sub_u32 s44, s4, 4096
    s_subb_u32 s45, s5, 0
    s_mov_b32 s46, 2625536
    s_mov_b32 s47, 0x20000
    s_lshl_b32 s36, s32, 7
    s_add_u32 s36, s36, 8257536
    v_mov_b32 v69, s36
    s_branch Lbc_re
Lcomp:
    s_lshl_b32 s44, s26, 1
    s_add_u32 s44, s44, s27
    s_sub_u32 s36, s33, 5
    s_cmp_ge_u32 s33, 5
    s_cselect_b32 s40, s36, s33
    s_mov_b32 s41, 0xbfe10856
    s_cmp_eq_u32 s40, 1
    s_cselect_b32 s41, 0xaff80255, s41
    s_cmp_eq_u32 s40, 2
    s_cselect_b32 s41, 0xabfe4015, s41
    s_cmp_eq_u32 s40, 3
    s_cselect_b32 s41, 0xaa7fd005, s41
    s_cmp_eq_u32 s40, 4
    s_cselect_b32 s41, 0x6adfb401, s41
    s_lshl_b32 s37, s27, 13
    s_cmp_eq_u32 s44, 1
    s_cselect_b32 s37, 0, s37
    v_bfe_u32 v7, v1, 2, 2
    v_and_b32 v8, 3, v1
    v_lshl_add_u32 v18, v2, 3, v7
    v_lshlrev_b32 v18, 7, v18
    v_lshlrev_b32 v19, 2, v1
    v_and_b32 v19, 0x60, v19
    v_lshlrev_b32 v10, 1, v8
    v_add_u32 v9, s37, v18
    v_add_u32 v11, 0, v10
    v_bfe_u32 v11, s41, v11, 2
    v_lshl_add_u32 v11, v11, 2, v8
    v_lshlrev_b32 v11, 3, v11
    v_xad_u32 v20, v11, v19, v9
    v_add_u32 v11, 8, v10
    v_bfe_u32 v11, s41, v11, 2
    v_lshl_add_u32 v11, v11, 2, v8
    v_lshlrev_b32 v11, 3, v11
    v_xad_u32 v21, v11, v19, v9
    v_add_u32 v11, 16, v10
    v_bfe_u32 v11, s41, v11, 2
    v_lshl_add_u32 v11, v11, 2, v8
    v_lshlrev_b32 v11, 3, v11
    v_xad_u32 v22, v11, v19, v9
    v_add_u32 v11, 24, v10
    v_bfe_u32 v11, s41, v11, 2
    v_lshl_add_u32 v11, v11, 2, v8
    v_lshlrev_b32 v11, 3, v11
    v_xad_u32 v23, v11, v19, v9
    v_add_u32 v24, 78080, v20
    v_add_u32 v25, 78080, v21
    v_add_u32 v26, 78080, v22
    v_add_u32 v27, 78080, v23
    v_lshrrev_b32 v10, 1, v3
    v_xor_b32 v9, v10, v2
    v_lshlrev_b32 v9, 4, v9
    v_lshl_add_u32 v9, v3, 7, v9
    s_lshl_b32 s36, s44, 11
    s_xor_b32 s38, s36, 2048
    s_add_u32 s36, s36, 22528
    s_add_u32 s38, s38, 22528
    v_add_u32 v76, s36, v9
    v_add_u32 v78, s38, v9
    s_mul_i32 s39, s26, 6144
    s_add_u32 s39, s39, 98560
    v_add_u32 v125, s39, v13
    s_lshl_b32 s45, s44, 11
    s_add_u32 s45, s45, 139648
    s_waitcnt lgkmcnt(0)
    s_mov_b64 s[28:29], s[24:25]
    s_mov_b32 s30, 268435456
    s_mov_b32 s31, 0x20000
    s_load_dword s34, s[28:29], 0
    s_cmp_eq_u32 s44, 1
    s_cbranch_scc1 Lhalo
    v_xor_b32 v77, 64, v76
    v_xor_b32 v79, 64, v78
    v_add_u32 v80, 78080, v76
    v_add_u32 v81, 78080, v77
    v_add_u32 v82, 78080, v78
    v_add_u32 v83, 78080, v79
    s_cmp_eq_u32 s27, 0
    s_cselect_b64 vcc, 0, -1
    s_sub_u32 s37, 16384, s37
    v_cndmask_b32 v84, v20, v22, vcc
    v_cndmask_b32 v85, v21, v23, vcc
    v_add_u32 v84, s37, v84
    v_add_u32 v85, s37, v85
    v_add_u32 v86, 78080, v84
    v_add_u32 v87, 78080, v85
    v_lshrrev_b32 v8, 1, v2
    v_xor_b32 v8, v8, v10
    v_lshlrev_b32 v8, 4, v8
    v_lshl_add_u32 v8, v3, 7, v8
    v_and_b32 v7, 1, v2
    v_lshl_add_u32 v124, v7, 3, v8
    s_lshl_b32 s46, s42, 12
    s_mov_b32 s38, 0x87652310
    s_mov_b32 s39, 0x94
    s_cmp_eq_u32 s42, 1
    s_cselect_b32 s38, 0x87625310, s38
    s_cselect_b32 s39, 0x49, s39
    s_cmp_eq_u32 s42, 2
    s_cselect_b32 s38, 0x73654102, s38
    s_cselect_b32 s39, 0x98, s39
    s_cmp_eq_u32 s42, 3
    s_cselect_b32 s38, 0x76254301, s38
    s_cselect_b32 s39, 0x98, s39
    s_cmp_eq_u32 s42, 4
    s_cselect_b32 s38, 0x37546021, s38
    s_cselect_b32 s39, 0x98, s39
    s_sub_u32 s42, s33, s43
    s_cselect_b32 s43, 10, 0
    s_add_u32 s42, s42, s43
    s_lshl_b32 s42, s42, 2
    s_lshr_b64 s[38:39], s[38:39], s42
    s_and_b32 s42, s38, 15
    s_and_b32 s38, s42, 3
    s_mul_i32 s38, s38, 39040
    s_add_u32 s38, s38, s36
    v_add_u32 v4, s38, v124
    v_xor_b32 v5, 32, v4
    v_xor_b32 v6, 64, v4
    v_xor_b32 v7, 0x60, v4
    s_mov_b64 s[48:49], s[20:21]
    s_mov_b32 s50, 2621440
    s_mov_b32 s51, 0x20000
    v_mov_b32 v14, 0x3f803f80
    v_mov_b32 v15, 0x3f803f80
    v_mov_b32 v16, 0x3f803f80
    v_mov_b32 v17, 0x3f803f80
    s_mov_b32 s4, 0xaae00455
    s_cmp_eq_u32 s40, 1
    s_cselect_b32 s4, 0xaaf80155, s4
    s_cmp_eq_u32 s40, 2
    s_cselect_b32 s4, 0xaafe4055, s4
    s_cmp_eq_u32 s40, 3
    s_cselect_b32 s4, 0xaabfd055, s4
    s_cmp_eq_u32 s40, 4
    s_cselect_b32 s4, 0xaaeff455, s4
    v_lshlrev_b32 v10, 1, v2
    v_add_u32 v10, 8, v10
    v_bfe_u32 v10, s4, v10, 2
    v_cmp_eq_u32 s[6:7], 0, v10
    v_cmp_eq_u32 s[8:9], 3, v10
    v_cmp_eq_u32 s[10:11], 1, v10
    v_lshlrev_b32 v10, 1, v2
    v_add_u32 v10, 16, v10
    v_bfe_u32 v10, s4, v10, 2
    v_cmp_eq_u32 s[12:13], 0, v10
    v_cmp_eq_u32 s[14:15], 3, v10
    v_cmp_eq_u32 s[16:17], 2, v10
    s_mov_b32 s4, 0xaaaaaaaa
    s_mov_b32 s5, 0xaaaaaaaa
    s_mov_b32 s18, 0xfff0ffff
    s_mov_b32 s19, 0xf000ff00
    s_mov_b32 s20, 0xffc0fffc
    s_mov_b32 s21, 0xc000fc00
    v_mov_b32 v8, 0xffff
    v_not_b32 v9, v8
    v_cndmask_b32 v8, v8, v9, s[4:5]
    v_cndmask_b32 v118, 0, v8, s[18:19]
    v_cndmask_b32 v119, 0, v8, s[20:21]
    v_xor_b32 v116, v118, v8
    v_xor_b32 v117, v119, v8
    s_cmp_eq_u32 s32, 0
    s_cselect_b32 s36, s44, 0
    s_cmp_eq_u32 s36, 2
    s_cselect_b32 s22, 0xff800000, 0
    s_mul_i32 s36, s32, 6
    s_add_u32 s36, s36, s44
    s_sub_u32 s36, s36, 2
    s_lshl_b32 s24, s36, 7
    s_add_u32 s24, s24, 7340032
    s_mul_i32 s52, s36, 20480
    s_add_u32 s52, s52, 4194304
    s_lshl_b32 s36, s33, 11
    s_add_u32 s23, s36, s52
    s_add_u32 s53, s52, s46
    s_add_u32 s46, s46, 4096
    s_cmp_eq_u32 s46, 20480
    s_cselect_b32 s46, 0, s46
    s_add_u32 s54, s52, s46
    s_add_u32 s46, s46, 4096
    s_cmp_eq_u32 s46, 20480
    s_cselect_b32 s46, 0, s46
    s_add_u32 s55, s52, s46
    s_add_u32 s46, s46, 4096
    s_cmp_eq_u32 s46, 20480
    s_cselect_b32 s46, 0, s46
    s_add_u32 s56, s52, s46
    s_add_u32 s46, s46, 4096
    s_cmp_eq_u32 s46, 20480
    s_cselect_b32 s46, 0, s46
    s_add_u32 s57, s52, s46
    s_add_u32 s46, s46, 4096
    s_cmp_eq_u32 s46, 20480
    s_cselect_b32 s46, 0, s46
    s_mul_i32 s36, s32, 10
    s_add_u32 s36, s36, s33
    s_mul_i32 s58, s36, 6144
    s_lshl_b32 s36, s44, 10
    s_add_u32 s58, s58, s36
    s_add_u32 s58, s58, 1046528
    s_sub_u32 s59, s58, 6144
    s_add_u32 s60, s58, 6144
    s_cmp_eq_u32 s40, 0
    s_cselect_b32 s61, 0, -1
    s_cmp_eq_u32 s40, 4
    s_cselect_b32 s62, 0, -1
    s_lshl_b32 s36, s33, 2
    v_mov_b32 v97, s36
    s_mov_b32 s25, 0x3ea52b5c
    s_lshl_b32 s36, s44, 6
    s_add_u32 s36, s36, 156160
    v_lshl_add_u32 v94, v3, 2, s36
    v_and_b32 v8, 1, v1
    v_lshl_add_u32 v8, v2, 2, v8
    v_lshl_add_u32 v8, v8, 2, s36
    v_subrev_u32 v9, 64, v8
    v_cndmask_b32 v92, v9, v8, s[18:19]
    v_cndmask_b32 v93, v9, v8, s[20:21]
    v_lshlrev_b32 v95, 4, v2
    s_lshl_b32 s36, s27, 8
    s_add_u32 s36, s36, 157184
    v_add_u32 v95, s36, v95
    v_mov_b32 v96, 157968
    s_lshl_b32 s36, s27, 11
    v_add_u32 v99, s36, v125
    v_mov_b32 v100, -1
    v_mov_b32 v101, -1
    v_mov_b32 v102, -1
    v_mov_b32 v103, -1
    v_mov_b32 v127, 157984
    s_lshl_b32 s36, s3, 2
    s_add_u32 s36, s36, 158016
    v_mov_b32 v10, s36
    v_xor_b32 v11, 16, v10
    v_cndmask_b32 v127, v127, v11, s[4:5]
    s_waitcnt vmcnt(0)
    s_waitcnt lgkmcnt(0)
    s_barrier
    ds_read_b128 a[64:67], v76 offset:0
    ds_read_b128 a[68:71], v78 offset:0
    ds_read_b64_tr_b16 a[80:81], v20 offset:0
    ds_read_b64_tr_b16 a[82:83], v20 offset:512
    ds_read_b64_tr_b16 a[84:85], v21 offset:0
    ds_read_b64_tr_b16 a[86:87], v21 offset:512
    ds_read_b64_tr_b16 a[88:89], v22 offset:0
    ds_read_b64_tr_b16 a[90:91], v22 offset:512
    ds_read_b64_tr_b16 a[92:93], v23 offset:0
    ds_read_b64_tr_b16 a[94:95], v23 offset:512
    ds_read_b64_tr_b16 a[96:97], v84 offset:0
    ds_read_b64_tr_b16 a[98:99], v84 offset:512
    ds_read_b64_tr_b16 a[100:101], v85 offset:0
    ds_read_b64_tr_b16 a[102:103], v85 offset:512
    s_add_u32 s34, s34, 0x9e3779b8
    s_or_b32 s34, s34, 1
    s_cmp_eq_u32 s42, 0
    s_cbranch_scc1 Lxe0
Lxe0_b:
    s_setprio 1
    s_waitcnt lgkmcnt(10)
    v_mfma_f32_16x16x32_bf16 v[28:31], a[80:83], a[64:67], 0
    ds_read_b128 a[72:75], v77 offset:0
    ds_read_b128 a[76:79], v79 offset:0
    v_mfma_f32_16x16x32_bf16 v[44:47], a[80:83], a[68:71], 0
    ds_read_b64_tr_b16 a[104:105], v20 offset:4096
    s_waitcnt lgkmcnt(11)
    v_mfma_f32_16x16x32_bf16 v[48:51], a[84:87], a[68:71], 0
    ds_read_b64_tr_b16 a[106:107], v20 offset:4608
    v_mfma_f32_16x16x32_bf16 v[32:35], a[84:87], a[64:67], 0
    ds_read_b64_tr_b16 a[108:109], v21 offset:4096
    s_waitcnt lgkmcnt(11)
    v_mfma_f32_16x16x32_bf16 v[36:39], a[88:91], a[64:67], 0
    ds_read_b64_tr_b16 a[110:111], v21 offset:4608
    ds_read_b64_tr_b16 a[112:113], v22 offset:4096
    v_mfma_f32_16x16x32_bf16 v[52:55], a[88:91], a[68:71], 0
    ds_read_b64_tr_b16 a[114:115], v22 offset:4608
    s_setprio 0
    s_waitcnt lgkmcnt(12)
    v_mfma_f32_16x16x32_bf16 v[56:59], a[92:95], a[68:71], 0
    ds_read_b64_tr_b16 a[116:117], v23 offset:4096
    v_mfma_f32_16x16x32_bf16 v[40:43], a[92:95], a[64:67], 0
    ds_read_b64_tr_b16 a[118:119], v23 offset:4608
    s_waitcnt lgkmcnt(12)
    v_mfma_f32_16x16x32_bf16 v[60:63], a[64:67], a[96:99], 0
    ds_read_b64_tr_b16 a[120:121], v84 offset:4096
    v_mfma_f32_16x16x32_bf16 v[68:71], a[68:71], a[96:99], 0
    ds_read_b64_tr_b16 a[122:123], v84 offset:4608
    s_waitcnt lgkmcnt(12)
    v_mfma_f32_16x16x32_bf16 v[72:75], a[68:71], a[100:103], 0
    ds_read_b64_tr_b16 a[124:125], v85 offset:4096
    v_mfma_f32_16x16x32_bf16 v[64:67], a[64:67], a[100:103], 0
    ds_read_b64_tr_b16 a[126:127], v85 offset:4608
    s_barrier
    s_setprio 3
    s_waitcnt lgkmcnt(10)
    v_mfma_f32_16x16x32_bf16 v[28:31], a[104:107], a[72:75], v[28:31]
    ds_read_b128 a[64:67], v76 offset:39040
    ds_read_b128 a[68:71], v78 offset:39040
    v_mfma_f32_16x16x32_bf16 v[44:47], a[104:107], a[76:79], v[44:47]
    ds_read_b64_tr_b16 a[80:81], v20 offset:39040
    s_waitcnt lgkmcnt(11)
    v_mfma_f32_16x16x32_bf16 v[48:51], a[108:111], a[76:79], v[48:51]
    ds_read_b64_tr_b16 a[82:83], v20 offset:39552
    v_mfma_f32_16x16x32_bf16 v[32:35], a[108:111], a[72:75], v[32:35]
    ds_read_b64_tr_b16 a[84:85], v21 offset:39040
    s_waitcnt lgkmcnt(11)
    v_mfma_f32_16x16x32_bf16 v[36:39], a[112:115], a[72:75], v[36:39]
    ds_read_b64_tr_b16 a[86:87], v21 offset:39552
    v_mfma_f32_16x16x32_bf16 v[52:55], a[112:115], a[76:79], v[52:55]
    ds_read_b64_tr_b16 a[88:89], v22 offset:39040
    s_setprio 2
    s_waitcnt lgkmcnt(11)
    v_mfma_f32_16x16x32_bf16 v[56:59], a[116:119], a[76:79], v[56:59]
    ds_read_b64_tr_b16 a[90:91], v22 offset:39552
    ds_read_b64_tr_b16 a[92:93], v23 offset:39040
    v_mfma_f32_16x16x32_bf16 v[40:43], a[116:119], a[72:75], v[40:43]
    ds_read_b64_tr_b16 a[94:95], v23 offset:39552
    s_waitcnt lgkmcnt(12)
    v_mfma_f32_16x16x32_bf16 v[60:63], a[72:75], a[120:123], v[60:63]
    ds_read_b64_tr_b16 a[96:97], v84 offset:39040
    v_mfma_f32_16x16x32_bf16 v[68:71], a[76:79], a[120:123], v[68:71]
    ds_read_b64_tr_b16 a[98:99], v84 offset:39552
    s_waitcnt lgkmcnt(12)
    v_mfma_f32_16x16x32_bf16 v[72:75], a[76:79], a[124:127], v[72:75]
    ds_read_b64_tr_b16 a[100:101], v85 offset:39040
    v_mfma_f32_16x16x32_bf16 v[64:67], a[72:75], a[124:127], v[64:67]
    ds_read_b64_tr_b16 a[102:103], v85 offset:39552
    s_cmp_eq_u32 s42, 1
    s_cbranch_scc1 Lxe1
Lxe1_b:
    s_setprio 1
    s_waitcnt lgkmcnt(10)
    v_mfma_f32_16x16x32_bf16 v[28:31], a[80:83], a[64:67], v[28:31]
    ds_read_b128 a[72:75], v77 offset:39040
    ds_read_b128 a[76:79], v79 offset:39040
    v_mfma_f32_16x16x32_bf16 v[44:47], a[80:83], a[68:71], v[44:47]
    ds_read_b64_tr_b16 a[104:105], v20 offset:43136
    s_waitcnt lgkmcnt(11)
    v_mfma_f32_16x16x32_bf16 v[48:51], a[84:87], a[68:71], v[48:51]
    ds_read_b64_tr_b16 a[106:107], v20 offset:43648
    v_mfma_f32_16x16x32_bf16 v[32:35], a[84:87], a[64:67], v[32:35]
    ds_read_b64_tr_b16 a[108:109], v21 offset:43136
    s_waitcnt lgkmcnt(11)
    v_mfma_f32_16x16x32_bf16 v[36:39], a[88:91], a[64:67], v[36:39]
    ds_read_b64_tr_b16 a[110:111], v21 offset:43648
    ds_read_b64_tr_b16 a[112:113], v22 offset:43136
    v_mfma_f32_16x16x32_bf16 v[52:55], a[88:91], a[68:71], v[52:55]
    ds_read_b64_tr_b16 a[114:115], v22 offset:43648
    s_setprio 0
    s_waitcnt lgkmcnt(12)
    v_mfma_f32_16x16x32_bf16 v[56:59], a[92:95], a[68:71], v[56:59]
    ds_read_b64_tr_b16 a[116:117], v23 offset:43136
    v_mfma_f32_16x16x32_bf16 v[40:43], a[92:95], a[64:67], v[40:43]
    ds_read_b64_tr_b16 a[118:119], v23 offset:43648
    s_waitcnt lgkmcnt(12)
    v_mfma_f32_16x16x32_bf16 v[60:63], a[64:67], a[96:99], v[60:63]
    ds_read_b64_tr_b16 a[120:121], v84 offset:43136
    v_mfma_f32_16x16x32_bf16 v[68:71], a[68:71], a[96:99], v[68:71]
    ds_read_b64_tr_b16 a[122:123], v84 offset:43648
    s_waitcnt lgkmcnt(12)
    v_mfma_f32_16x16x32_bf16 v[72:75], a[68:71], a[100:103], v[72:75]
    ds_read_b64_tr_b16 a[124:125], v85 offset:43136
    v_mfma_f32_16x16x32_bf16 v[64:67], a[64:67], a[100:103], v[64:67]
    ds_read_b64_tr_b16 a[126:127], v85 offset:43648
    s_barrier
    s_setprio 3
    s_waitcnt lgkmcnt(10)
    v_mfma_f32_16x16x32_bf16 v[28:31], a[104:107], a[72:75], v[28:31]
    ds_read_b128 a[64:67], v80 offset:0
    ds_read_b128 a[68:71], v82 offset:0
    v_mfma_f32_16x16x32_bf16 v[44:47], a[104:107], a[76:79], v[44:47]
    ds_read_b64_tr_b16 a[80:81], v24 offset:0
    s_waitcnt lgkmcnt(11)
    v_mfma_f32_16x16x32_bf16 v[48:51], a[108:111], a[76:79], v[48:51]
    ds_read_b64_tr_b16 a[82:83], v24 offset:512
    v_mfma_f32_16x16x32_bf16 v[32:35], a[108:111], a[72:75], v[32:35]
    ds_read_b64_tr_b16 a[84:85], v25 offset:0
    s_waitcnt lgkmcnt(11)
    v_mfma_f32_16x16x32_bf16 v[36:39], a[112:115], a[72:75], v[36:39]
    ds_read_b64_tr_b16 a[86:87], v25 offset:512
    v_mfma_f32_16x16x32_bf16 v[52:55], a[112:115], a[76:79], v[52:55]
    ds_read_b64_tr_b16 a[88:89], v26 offset:0
    s_setprio 2
    s_waitcnt lgkmcnt(11)
    v_mfma_f32_16x16x32_bf16 v[56:59], a[116:119], a[76:79], v[56:59]
    ds_read_b64_tr_b16 a[90:91], v26 offset:512
    ds_read_b64_tr_b16 a[92:93], v27 offset:0
    v_mfma_f32_16x16x32_bf16 v[40:43], a[116:119], a[72:75], v[40:43]
    ds_read_b64_tr_b16 a[94:95], v27 offset:512
    s_waitcnt lgkmcnt(12)
    v_mfma_f32_16x16x32_bf16 v[60:63], a[72:75], a[120:123], v[60:63]
    ds_read_b64_tr_b16 a[96:97], v86 offset:0
    v_mfma_f32_16x16x32_bf16 v[68:71], a[76:79], a[120:123], v[68:71]
    ds_read_b64_tr_b16 a[98:99], v86 offset:512
    s_waitcnt lgkmcnt(12)
    v_mfma_f32_16x16x32_bf16 v[72:75], a[76:79], a[124:127], v[72:75]
    ds_read_b64_tr_b16 a[100:101], v87 offset:0
    v_mfma_f32_16x16x32_bf16 v[64:67], a[72:75], a[124:127], v[64:67]
    ds_read_b64_tr_b16 a[102:103], v87 offset:512
    buffer_store_dwordx4 v[100:103], v13, s[28:31], s58 offen sc1
    s_cmp_eq_u32 s42, 2
    s_cbranch_scc1 Lxe2
Lxe2_b:
    s_setprio 1
    s_waitcnt lgkmcnt(10)
    v_mfma_f32_16x16x32_bf16 v[28:31], a[80:83], a[64:67], v[28:31]
    ds_read_b128 a[72:75], v81 offset:0
    ds_read_b128 a[76:79], v83 offset:0
    v_mfma_f32_16x16x32_bf16 v[44:47], a[80:83], a[68:71], v[44:47]
    ds_read_b64_tr_b16 a[104:105], v24 offset:4096
    s_waitcnt lgkmcnt(11)
    v_mfma_f32_16x16x32_bf16 v[48:51], a[84:87], a[68:71], v[48:51]
    ds_read_b64_tr_b16 a[106:107], v24 offset:4608
    v_mfma_f32_16x16x32_bf16 v[32:35], a[84:87], a[64:67], v[32:35]
    ds_read_b64_tr_b16 a[108:109], v25 offset:4096
    s_waitcnt lgkmcnt(11)
    v_mfma_f32_16x16x32_bf16 v[36:39], a[88:91], a[64:67], v[36:39]
    ds_read_b64_tr_b16 a[110:111], v25 offset:4608
    ds_read_b64_tr_b16 a[112:113], v26 offset:4096
    v_mfma_f32_16x16x32_bf16 v[52:55], a[88:91], a[68:71], v[52:55]
    ds_read_b64_tr_b16 a[114:115], v26 offset:4608
    s_setprio 0
    s_waitcnt lgkmcnt(12)
    v_mfma_f32_16x16x32_bf16 v[56:59], a[92:95], a[68:71], v[56:59]
    ds_read_b64_tr_b16 a[116:117], v27 offset:4096
    v_mfma_f32_16x16x32_bf16 v[40:43], a[92:95], a[64:67], v[40:43]
    ds_read_b64_tr_b16 a[118:119], v27 offset:4608
    s_waitcnt lgkmcnt(12)
    v_mfma_f32_16x16x32_bf16 v[60:63], a[64:67], a[96:99], v[60:63]
    ds_read_b64_tr_b16 a[120:121], v86 offset:4096
    v_mfma_f32_16x16x32_bf16 v[68:71], a[68:71], a[96:99], v[68:71]
    ds_read_b64_tr_b16 a[122:123], v86 offset:4608
    s_waitcnt lgkmcnt(12)
    v_mfma_f32_16x16x32_bf16 v[72:75], a[68:71], a[100:103], v[72:75]
    ds_read_b64_tr_b16 a[124:125], v87 offset:4096
    v_mfma_f32_16x16x32_bf16 v[64:67], a[64:67], a[100:103], v[64:67]
    ds_read_b64_tr_b16 a[126:127], v87 offset:4608
    s_barrier
    s_setprio 3
    s_waitcnt lgkmcnt(10)
    v_mfma_f32_16x16x32_bf16 v[28:31], a[104:107], a[72:75], v[28:31]
    ds_read_b128 a[64:67], v80 offset:39040
    ds_read_b128 a[68:71], v82 offset:39040
    v_mfma_f32_16x16x32_bf16 v[44:47], a[104:107], a[76:79], v[44:47]
    ds_read_b64_tr_b16 a[80:81], v24 offset:39040
    s_waitcnt lgkmcnt(11)
    v_mfma_f32_16x16x32_bf16 v[48:51], a[108:111], a[76:79], v[48:51]
    ds_read_b64_tr_b16 a[82:83], v24 offset:39552
    v_mfma_f32_16x16x32_bf16 v[32:35], a[108:111], a[72:75], v[32:35]
    ds_read_b64_tr_b16 a[84:85], v25 offset:39040
    s_waitcnt lgkmcnt(11)
    v_mfma_f32_16x16x32_bf16 v[36:39], a[112:115], a[72:75], v[36:39]
    ds_read_b64_tr_b16 a[86:87], v25 offset:39552
    v_mfma_f32_16x16x32_bf16 v[52:55], a[112:115], a[76:79], v[52:55]
    ds_read_b64_tr_b16 a[88:89], v26 offset:39040
    s_setprio 2
    s_waitcnt lgkmcnt(11)
    v_mfma_f32_16x16x32_bf16 v[56:59], a[116:119], a[76:79], v[56:59]
    ds_read_b64_tr_b16 a[90:91], v26 offset:39552
    ds_read_b64_tr_b16 a[92:93], v27 offset:39040
    v_mfma_f32_16x16x32_bf16 v[40:43], a[116:119], a[72:75], v[40:43]
    ds_read_b64_tr_b16 a[94:95], v27 offset:39552
    s_waitcnt lgkmcnt(12)
    v_mfma_f32_16x16x32_bf16 v[60:63], a[72:75], a[120:123], v[60:63]
    ds_read_b64_tr_b16 a[96:97], v86 offset:39040
    v_mfma_f32_16x16x32_bf16 v[68:71], a[76:79], a[120:123], v[68:71]
    ds_read_b64_tr_b16 a[98:99], v86 offset:39552
    s_waitcnt lgkmcnt(12)
    v_mfma_f32_16x16x32_bf16 v[72:75], a[76:79], a[124:127], v[72:75]
    ds_read_b64_tr_b16 a[100:101], v87 offset:39040
    v_mfma_f32_16x16x32_bf16 v[64:67], a[72:75], a[124:127], v[64:67]
    ds_read_b64_tr_b16 a[102:103], v87 offset:39552
    s_cmp_eq_u32 s42, 3
    s_cbranch_scc1 Lxe3
Lxe3_b:
    s_setprio 1
    s_waitcnt lgkmcnt(10)
    v_mfma_f32_16x16x32_bf16 v[28:31], a[80:83], a[64:67], v[28:31]
    ds_read_b128 a[72:75], v81 offset:39040
    ds_read_b128 a[76:79], v83 offset:39040
    v_mfma_f32_16x16x32_bf16 v[44:47], a[80:83], a[68:71], v[44:47]
    ds_read_b64_tr_b16 a[104:105], v24 offset:43136
    s_waitcnt lgkmcnt(11)
    v_mfma_f32_16x16x32_bf16 v[48:51], a[84:87], a[68:71], v[48:51]
    ds_read_b64_tr_b16 a[106:107], v24 offset:43648
    v_mfma_f32_16x16x32_bf16 v[32:35], a[84:87], a[64:67], v[32:35]
    ds_read_b64_tr_b16 a[108:109], v25 offset:43136
    s_waitcnt lgkmcnt(11)
    v_mfma_f32_16x16x32_bf16 v[36:39], a[88:91], a[64:67], v[36:39]
    ds_read_b64_tr_b16 a[110:111], v25 offset:43648
    ds_read_b64_tr_b16 a[112:113], v26 offset:43136
    v_mfma_f32_16x16x32_bf16 v[52:55], a[88:91], a[68:71], v[52:55]
    ds_read_b64_tr_b16 a[114:115], v26 offset:43648
    s_setprio 0
    s_waitcnt lgkmcnt(12)
    v_mfma_f32_16x16x32_bf16 v[56:59], a[92:95], a[68:71], v[56:59]
    ds_read_b64_tr_b16 a[116:117], v27 offset:43136
    v_mfma_f32_16x16x32_bf16 v[40:43], a[92:95], a[64:67], v[40:43]
    ds_read_b64_tr_b16 a[118:119], v27 offset:43648
    s_waitcnt lgkmcnt(12)
    v_mfma_f32_16x16x32_bf16 v[60:63], a[64:67], a[96:99], v[60:63]
    ds_read_b64_tr_b16 a[120:121], v86 offset:43136
    v_mfma_f32_16x16x32_bf16 v[68:71], a[68:71], a[96:99], v[68:71]
    ds_read_b64_tr_b16 a[122:123], v86 offset:43648
    s_waitcnt lgkmcnt(12)
    v_mfma_f32_16x16x32_bf16 v[72:75], a[68:71], a[100:103], v[72:75]
    ds_read_b64_tr_b16 a[124:125], v87 offset:43136
    v_mfma_f32_16x16x32_bf16 v[64:67], a[64:67], a[100:103], v[64:67]
    ds_read_b64_tr_b16 a[126:127], v87 offset:43648
    s_barrier
    s_setprio 3
    s_waitcnt lgkmcnt(10)
    v_mfma_f32_16x16x32_bf16 v[28:31], a[104:107], a[72:75], v[28:31]
    ds_read_b128 a[64:67], v76 offset:0
    ds_read_b128 a[68:71], v78 offset:0
    v_mfma_f32_16x16x32_bf16 v[44:47], a[104:107], a[76:79], v[44:47]
    ds_read_b64_tr_b16 a[80:81], v20 offset:0
    s_waitcnt lgkmcnt(11)
    v_mfma_f32_16x16x32_bf16 v[48:51], a[108:111], a[76:79], v[48:51]
    ds_read_b64_tr_b16 a[82:83], v20 offset:512
    v_mfma_f32_16x16x32_bf16 v[32:35], a[108:111], a[72:75], v[32:35]
    ds_read_b64_tr_b16 a[84:85], v21 offset:0
    s_waitcnt lgkmcnt(11)
    v_mfma_f32_16x16x32_bf16 v[36:39], a[112:115], a[72:75], v[36:39]
    ds_read_b64_tr_b16 a[86:87], v21 offset:512
    v_mfma_f32_16x16x32_bf16 v[52:55], a[112:115], a[76:79], v[52:55]
    ds_read_b64_tr_b16 a[88:89], v22 offset:0
    s_setprio 2
    s_waitcnt lgkmcnt(11)
    v_mfma_f32_16x16x32_bf16 v[56:59], a[116:119], a[76:79], v[56:59]
    ds_read_b64_tr_b16 a[90:91], v22 offset:512
    ds_read_b64_tr_b16 a[92:93], v23 offset:0
    v_mfma_f32_16x16x32_bf16 v[40:43], a[116:119], a[72:75], v[40:43]
    ds_read_b64_tr_b16 a[94:95], v23 offset:512
    s_waitcnt lgkmcnt(12)
    v_mfma_f32_16x16x32_bf16 v[60:63], a[72:75], a[120:123], v[60:63]
    ds_read_b64_tr_b16 a[96:97], v84 offset:0
    v_mfma_f32_16x16x32_bf16 v[68:71], a[76:79], a[120:123], v[68:71]
    ds_read_b64_tr_b16 a[98:99], v84 offset:512
    s_waitcnt lgkmcnt(12)
    v_mfma_f32_16x16x32_bf16 v[72:75], a[76:79], a[124:127], v[72:75]
    ds_read_b64_tr_b16 a[100:101], v85 offset:0
    v_mfma_f32_16x16x32_bf16 v[64:67], a[72:75], a[124:127], v[64:67]
    ds_read_b64_tr_b16 a[102:103], v85 offset:512
    buffer_store_dwordx4 v[100:103], v13, s[28:31], s23 offen offset:0 sc1
    s_cmp_eq_u32 s42, 4
    s_cbranch_scc1 Lxe4
Lxe4_b:
    s_setprio 1
    s_waitcnt lgkmcnt(10)
    v_mfma_f32_16x16x32_bf16 v[28:31], a[80:83], a[64:67], v[28:31]
    ds_read_b128 a[72:75], v77 offset:0
    ds_read_b128 a[76:79], v79 offset:0
    v_mfma_f32_16x16x32_bf16 v[44:47], a[80:83], a[68:71], v[44:47]
    ds_read_b64_tr_b16 a[104:105], v20 offset:4096
    s_waitcnt lgkmcnt(11)
    v_mfma_f32_16x16x32_bf16 v[48:51], a[84:87], a[68:71], v[48:51]
    ds_read_b64_tr_b16 a[106:107], v20 offset:4608
    v_mfma_f32_16x16x32_bf16 v[32:35], a[84:87], a[64:67], v[32:35]
    ds_read_b64_tr_b16 a[108:109], v21 offset:4096
    s_waitcnt lgkmcnt(11)
    v_mfma_f32_16x16x32_bf16 v[36:39], a[88:91], a[64:67], v[36:39]
    ds_read_b64_tr_b16 a[110:111], v21 offset:4608
    ds_read_b64_tr_b16 a[112:113], v22 offset:4096
    v_mfma_f32_16x16x32_bf16 v[52:55], a[88:91], a[68:71], v[52:55]
    ds_read_b64_tr_b16 a[114:115], v22 offset:4608
    s_setprio 0
    s_waitcnt lgkmcnt(12)
    v_mfma_f32_16x16x32_bf16 v[56:59], a[92:95], a[68:71], v[56:59]
    ds_read_b64_tr_b16 a[116:117], v23 offset:4096
    v_mfma_f32_16x16x32_bf16 v[40:43], a[92:95], a[64:67], v[40:43]
    ds_read_b64_tr_b16 a[118:119], v23 offset:4608
    s_waitcnt lgkmcnt(12)
    v_mfma_f32_16x16x32_bf16 v[60:63], a[64:67], a[96:99], v[60:63]
    ds_read_b64_tr_b16 a[120:121], v84 offset:4096
    v_mfma_f32_16x16x32_bf16 v[68:71], a[68:71], a[96:99], v[68:71]
    ds_read_b64_tr_b16 a[122:123], v84 offset:4608
    s_waitcnt lgkmcnt(12)
    v_mfma_f32_16x16x32_bf16 v[72:75], a[68:71], a[100:103], v[72:75]
    ds_read_b64_tr_b16 a[124:125], v85 offset:4096
    v_mfma_f32_16x16x32_bf16 v[64:67], a[64:67], a[100:103], v[64:67]
    ds_read_b64_tr_b16 a[126:127], v85 offset:4608
    s_barrier
    s_setprio 3
    s_waitcnt lgkmcnt(10)
    v_mfma_f32_16x16x32_bf16 v[28:31], a[104:107], a[72:75], v[28:31]
    ds_read_b128 a[64:67], v76 offset:39040
    ds_read_b128 a[68:71], v78 offset:39040
    v_mfma_f32_16x16x32_bf16 v[44:47], a[104:107], a[76:79], v[44:47]
    ds_read_b64_tr_b16 a[80:81], v20 offset:39040
    s_waitcnt lgkmcnt(11)
    v_mfma_f32_16x16x32_bf16 v[48:51], a[108:111], a[76:79], v[48:51]
    ds_read_b64_tr_b16 a[82:83], v20 offset:39552
    v_mfma_f32_16x16x32_bf16 v[32:35], a[108:111], a[72:75], v[32:35]
    ds_read_b64_tr_b16 a[84:85], v21 offset:39040
    s_waitcnt lgkmcnt(11)
    v_mfma_f32_16x16x32_bf16 v[36:39], a[112:115], a[72:75], v[36:39]
    ds_read_b64_tr_b16 a[86:87], v21 offset:39552
    v_mfma_f32_16x16x32_bf16 v[52:55], a[112:115], a[76:79], v[52:55]
    ds_read_b64_tr_b16 a[88:89], v22 offset:39040
    s_setprio 2
    s_waitcnt lgkmcnt(11)
    v_mfma_f32_16x16x32_bf16 v[56:59], a[116:119], a[76:79], v[56:59]
    ds_read_b64_tr_b16 a[90:91], v22 offset:39552
    ds_read_b64_tr_b16 a[92:93], v23 offset:39040
    v_mfma_f32_16x16x32_bf16 v[40:43], a[116:119], a[72:75], v[40:43]
    ds_read_b64_tr_b16 a[94:95], v23 offset:39552
    s_waitcnt lgkmcnt(12)
    v_mfma_f32_16x16x32_bf16 v[60:63], a[72:75], a[120:123], v[60:63]
    ds_read_b64_tr_b16 a[96:97], v84 offset:39040
    v_mfma_f32_16x16x32_bf16 v[68:71], a[76:79], a[120:123], v[68:71]
    ds_read_b64_tr_b16 a[98:99], v84 offset:39552
    s_waitcnt lgkmcnt(12)
    v_mfma_f32_16x16x32_bf16 v[72:75], a[76:79], a[124:127], v[72:75]
    ds_read_b64_tr_b16 a[100:101], v85 offset:39040
    v_mfma_f32_16x16x32_bf16 v[64:67], a[72:75], a[124:127], v[64:67]
    ds_read_b64_tr_b16 a[102:103], v85 offset:39552
    s_cmp_eq_u32 s42, 5
    s_cbranch_scc1 Lxe5
Lxe5_b:
    s_setprio 1
    s_waitcnt lgkmcnt(10)
    v_mfma_f32_16x16x32_bf16 v[28:31], a[80:83], a[64:67], v[28:31]
    ds_read_b128 a[72:75], v77 offset:39040
    ds_read_b128 a[76:79], v79 offset:39040
    v_mfma_f32_16x16x32_bf16 v[44:47], a[80:83], a[68:71], v[44:47]
    ds_read_b64_tr_b16 a[104:105], v20 offset:43136
    s_waitcnt lgkmcnt(11)
    v_mfma_f32_16x16x32_bf16 v[48:51], a[84:87], a[68:71], v[48:51]
    ds_read_b64_tr_b16 a[106:107], v20 offset:43648
    v_mfma_f32_16x16x32_bf16 v[32:35], a[84:87], a[64:67], v[32:35]
    ds_read_b64_tr_b16 a[108:109], v21 offset:43136
    s_waitcnt lgkmcnt(11)
    v_mfma_f32_16x16x32_bf16 v[36:39], a[88:91], a[64:67], v[36:39]
    ds_read_b64_tr_b16 a[110:111], v21 offset:43648
    ds_read_b64_tr_b16 a[112:113], v22 offset:43136
    v_mfma_f32_16x16x32_bf16 v[52:55], a[88:91], a[68:71], v[52:55]
    ds_read_b64_tr_b16 a[114:115], v22 offset:43648
    s_setprio 0
    s_waitcnt lgkmcnt(12)
    v_mfma_f32_16x16x32_bf16 v[56:59], a[92:95], a[68:71], v[56:59]
    ds_read_b64_tr_b16 a[116:117], v23 offset:43136
    v_mfma_f32_16x16x32_bf16 v[40:43], a[92:95], a[64:67], v[40:43]
    ds_read_b64_tr_b16 a[118:119], v23 offset:43648
    s_waitcnt lgkmcnt(12)
    v_mfma_f32_16x16x32_bf16 v[60:63], a[64:67], a[96:99], v[60:63]
    ds_read_b64_tr_b16 a[120:121], v84 offset:43136
    v_mfma_f32_16x16x32_bf16 v[68:71], a[68:71], a[96:99], v[68:71]
    ds_read_b64_tr_b16 a[122:123], v84 offset:43648
    s_waitcnt lgkmcnt(12)
    v_mfma_f32_16x16x32_bf16 v[72:75], a[68:71], a[100:103], v[72:75]
    ds_read_b64_tr_b16 a[124:125], v85 offset:43136
    v_mfma_f32_16x16x32_bf16 v[64:67], a[64:67], a[100:103], v[64:67]
    ds_read_b64_tr_b16 a[126:127], v85 offset:43648
    s_barrier
    s_setprio 3
    s_waitcnt lgkmcnt(10)
    v_mfma_f32_16x16x32_bf16 v[28:31], a[104:107], a[72:75], v[28:31]
    ds_read_b128 a[0:3], v80 offset:0
    v_mfma_f32_16x16x32_bf16 v[44:47], a[104:107], a[76:79], v[44:47]
    ds_read_b128 a[4:7], v82 offset:0
    s_waitcnt lgkmcnt(10)
    v_mfma_f32_16x16x32_bf16 v[48:51], a[108:111], a[76:79], v[48:51]
    ds_read_b64_tr_b16 a[80:81], v24 offset:0
    v_mfma_f32_16x16x32_bf16 v[32:35], a[108:111], a[72:75], v[32:35]
    ds_read_b64_tr_b16 a[82:83], v24 offset:512
    s_waitcnt lgkmcnt(10)
    v_mfma_f32_16x16x32_bf16 v[36:39], a[112:115], a[72:75], v[36:39]
    ds_read_b64_tr_b16 a[84:85], v25 offset:0
    v_mfma_f32_16x16x32_bf16 v[52:55], a[112:115], a[76:79], v[52:55]
    s_setprio 2
    s_waitcnt lgkmcnt(9)
    v_mfma_f32_16x16x32_bf16 v[56:59], a[116:119], a[76:79], v[56:59]
    ds_read_b64_tr_b16 a[86:87], v25 offset:512
    v_mfma_f32_16x16x32_bf16 v[40:43], a[116:119], a[72:75], v[40:43]
    ds_read_b64_tr_b16 a[88:89], v26 offset:0
    s_waitcnt lgkmcnt(9)
    v_mfma_f32_16x16x32_bf16 v[60:63], a[72:75], a[120:123], v[60:63]
    ds_read_b64_tr_b16 a[90:91], v26 offset:512
    v_mfma_f32_16x16x32_bf16 v[68:71], a[76:79], a[120:123], v[68:71]
    ds_read_b64_tr_b16 a[92:93], v27 offset:0
    s_waitcnt lgkmcnt(9)
    v_mfma_f32_16x16x32_bf16 v[72:75], a[76:79], a[124:127], v[72:75]
    ds_read_b64_tr_b16 a[94:95], v27 offset:512
    v_mfma_f32_16x16x32_bf16 v[64:67], a[72:75], a[124:127], v[64:67]
    buffer_store_dwordx4 v[100:103], v13, s[28:31], s23 offen offset:1024 sc1
    s_cmp_eq_u32 s42, 6
    s_cbranch_scc1 Lxe6
Lxe6_b:
    s_setprio 1
    s_waitcnt lgkmcnt(6)
    v_mfma_f32_16x16x32_bf16 v[28:31], a[80:83], a[0:3], v[28:31]
    ds_read_b128 a[8:11], v81 offset:0
    ds_read_b128 a[12:15], v83 offset:0
    v_mfma_f32_16x16x32_bf16 v[44:47], a[80:83], a[4:7], v[44:47]
    ds_read_b64_tr_b16 a[104:105], v24 offset:4096
    s_waitcnt lgkmcnt(7)
    v_mfma_f32_16x16x32_bf16 v[48:51], a[84:87], a[4:7], v[48:51]
    ds_read_b64_tr_b16 a[106:107], v24 offset:4608
    ds_read_b64_tr_b16 a[108:109], v25 offset:4096
    v_mfma_f32_16x16x32_bf16 v[32:35], a[84:87], a[0:3], v[32:35]
    ds_read_b64_tr_b16 a[110:111], v25 offset:4608
    s_setprio 0
    s_waitcnt lgkmcnt(8)
    v_mfma_f32_16x16x32_bf16 v[36:39], a[88:91], a[0:3], v[36:39]
    v_mfma_f32_16x16x32_bf16 v[52:55], a[88:91], a[4:7], v[52:55]
    ds_read_b64_tr_b16 a[112:113], v26 offset:4096
    ds_read_b64_tr_b16 a[114:115], v26 offset:4608
    s_waitcnt lgkmcnt(8)
    v_mfma_f32_16x16x32_bf16 v[56:59], a[92:95], a[4:7], v[56:59]
    ds_read_b64_tr_b16 a[116:117], v27 offset:4096
    v_mfma_f32_16x16x32_bf16 v[40:43], a[92:95], a[0:3], v[40:43]
    ds_read_b64_tr_b16 a[118:119], v27 offset:4608
    s_barrier
    s_setprio 3
    s_waitcnt lgkmcnt(6)
    v_mfma_f32_16x16x32_bf16 v[28:31], a[104:107], a[8:11], v[28:31]
    ds_read_b128 a[16:19], v80 offset:39040
    ds_read_b128 a[20:23], v82 offset:39040
    v_mfma_f32_16x16x32_bf16 v[44:47], a[104:107], a[12:15], v[44:47]
    ds_read_b64_tr_b16 a[80:81], v24 offset:39040
    s_waitcnt lgkmcnt(7)
    v_mfma_f32_16x16x32_bf16 v[48:51], a[108:111], a[12:15], v[48:51]
    ds_read_b64_tr_b16 a[82:83], v24 offset:39552
    v_mfma_f32_16x16x32_bf16 v[32:35], a[108:111], a[8:11], v[32:35]
    ds_read_b64_tr_b16 a[84:85], v25 offset:39040
    s_setprio 2
    s_waitcnt lgkmcnt(7)
    v_mfma_f32_16x16x32_bf16 v[36:39], a[112:115], a[8:11], v[36:39]
    ds_read_b64_tr_b16 a[86:87], v25 offset:39552
    ds_read_b64_tr_b16 a[88:89], v26 offset:39040
    v_mfma_f32_16x16x32_bf16 v[52:55], a[112:115], a[12:15], v[52:55]
    ds_read_b64_tr_b16 a[90:91], v26 offset:39552
    s_waitcnt lgkmcnt(8)
    v_mfma_f32_16x16x32_bf16 v[56:59], a[116:119], a[12:15], v[56:59]
    ds_read_b64_tr_b16 a[92:93], v27 offset:39040
    v_mfma_f32_16x16x32_bf16 v[40:43], a[116:119], a[8:11], v[40:43]
    ds_read_b64_tr_b16 a[94:95], v27 offset:39552
    s_cmp_eq_u32 s42, 7
    s_cbranch_scc1 Lxe7
Lxe7_b:
    s_setprio 1
    s_waitcnt lgkmcnt(6)
    v_mfma_f32_16x16x32_bf16 v[28:31], a[80:83], a[16:19], v[28:31]
    ds_read_b128 a[24:27], v81 offset:39040
    ds_read_b128 a[28:31], v83 offset:39040
    v_mfma_f32_16x16x32_bf16 v[44:47], a[80:83], a[20:23], v[44:47]
    ds_read_b64_tr_b16 a[104:105], v24 offset:43136
    s_waitcnt lgkmcnt(7)
    v_mfma_f32_16x16x32_bf16 v[48:51], a[84:87], a[20:23], v[48:51]
    ds_read_b64_tr_b16 a[106:107], v24 offset:43648
    ds_read_b64_tr_b16 a[108:109], v25 offset:43136
    v_mfma_f32_16x16x32_bf16 v[32:35], a[84:87], a[16:19], v[32:35]
    ds_read_b64_tr_b16 a[110:111], v25 offset:43648
    s_setprio 0
    s_waitcnt lgkmcnt(8)
    v_mfma_f32_16x16x32_bf16 v[36:39], a[88:91], a[16:19], v[36:39]
    v_mfma_f32_16x16x32_bf16 v[52:55], a[88:91], a[20:23], v[52:55]
    ds_read_b64_tr_b16 a[112:113], v26 offset:43136
    ds_read_b64_tr_b16 a[114:115], v26 offset:43648
    s_waitcnt lgkmcnt(8)
    v_mfma_f32_16x16x32_bf16 v[56:59], a[92:95], a[20:23], v[56:59]
    ds_read_b64_tr_b16 a[116:117], v27 offset:43136
    v_mfma_f32_16x16x32_bf16 v[40:43], a[92:95], a[16:19], v[40:43]
    ds_read_b64_tr_b16 a[118:119], v27 offset:43648
    s_barrier
    s_setprio 3
    s_waitcnt lgkmcnt(6)
    v_mfma_f32_16x16x32_bf16 v[28:31], a[104:107], a[24:27], v[28:31]
    ds_read_b128 a[32:35], v76 offset:0
    ds_read_b128 a[36:39], v78 offset:0
    v_mfma_f32_16x16x32_bf16 v[44:47], a[104:107], a[28:31], v[44:47]
    ds_read_b64_tr_b16 a[80:81], v20 offset:0
    s_waitcnt lgkmcnt(7)
    v_mfma_f32_16x16x32_bf16 v[48:51], a[108:111], a[28:31], v[48:51]
    ds_read_b64_tr_b16 a[82:83], v20 offset:512
    v_mfma_f32_16x16x32_bf16 v[32:35], a[108:111], a[24:27], v[32:35]
    ds_read_b64_tr_b16 a[84:85], v21 offset:0
    s_setprio 2
    s_waitcnt lgkmcnt(7)
    v_mfma_f32_16x16x32_bf16 v[36:39], a[112:115], a[24:27], v[36:39]
    ds_read_b64_tr_b16 a[86:87], v21 offset:512
    ds_read_b64_tr_b16 a[88:89], v22 offset:0
    v_mfma_f32_16x16x32_bf16 v[52:55], a[112:115], a[28:31], v[52:55]
    ds_read_b64_tr_b16 a[90:91], v22 offset:512
    s_waitcnt lgkmcnt(8)
    v_mfma_f32_16x16x32_bf16 v[56:59], a[116:119], a[28:31], v[56:59]
    ds_read_b64_tr_b16 a[92:93], v23 offset:0
    v_mfma_f32_16x16x32_bf16 v[40:43], a[116:119], a[24:27], v[40:43]
    ds_read_b64_tr_b16 a[94:95], v23 offset:512
    s_cmp_eq_u32 s42, 8
    s_cbranch_scc1 Lxe8
Lxe8_b:
    s_setprio 1
    s_waitcnt lgkmcnt(6)
    v_mfma_f32_16x16x32_bf16 v[28:31], a[80:83], a[32:35], v[28:31]
    ds_read_b128 a[40:43], v77 offset:0
    ds_read_b128 a[44:47], v79 offset:0
    v_mfma_f32_16x16x32_bf16 v[44:47], a[80:83], a[36:39], v[44:47]
    ds_read_b64_tr_b16 a[104:105], v20 offset:4096
    s_waitcnt lgkmcnt(7)
    v_mfma_f32_16x16x32_bf16 v[48:51], a[84:87], a[36:39], v[48:51]
    ds_read_b64_tr_b16 a[106:107], v20 offset:4608
    v_mfma_f32_16x16x32_bf16 v[32:35], a[84:87], a[32:35], v[32:35]
    ds_read_b64_tr_b16 a[108:109], v21 offset:4096
    s_setprio 0
    s_waitcnt lgkmcnt(7)
    v_mfma_f32_16x16x32_bf16 v[36:39], a[88:91], a[32:35], v[36:39]
    ds_read_b64_tr_b16 a[110:111], v21 offset:4608
    ds_read_b64_tr_b16 a[112:113], v22 offset:4096
    v_mfma_f32_16x16x32_bf16 v[52:55], a[88:91], a[36:39], v[52:55]
    ds_read_b64_tr_b16 a[114:115], v22 offset:4608
    s_waitcnt lgkmcnt(8)
    v_mfma_f32_16x16x32_bf16 v[56:59], a[92:95], a[36:39], v[56:59]
    ds_read_b64_tr_b16 a[116:117], v23 offset:4096
    v_mfma_f32_16x16x32_bf16 v[40:43], a[92:95], a[32:35], v[40:43]
    ds_read_b64_tr_b16 a[118:119], v23 offset:4608
    s_waitcnt lgkmcnt(0)
    s_barrier
    s_setprio 3
    v_mfma_f32_16x16x32_bf16 v[28:31], a[104:107], a[40:43], v[28:31]
    ds_read_b128 a[48:51], v76 offset:39040
    ds_read_b128 a[52:55], v78 offset:39040
    v_mfma_f32_16x16x32_bf16 v[44:47], a[104:107], a[44:47], v[44:47]
    ds_read_b64_tr_b16 a[80:81], v20 offset:39040
    v_mfma_f32_16x16x32_bf16 v[48:51], a[108:111], a[44:47], v[48:51]
    ds_read_b64_tr_b16 a[82:83], v20 offset:39552
    v_mfma_f32_16x16x32_bf16 v[32:35], a[108:111], a[40:43], v[32:35]
    ds_read_b64_tr_b16 a[84:85], v21 offset:39040
    s_setprio 2
    v_mfma_f32_16x16x32_bf16 v[36:39], a[112:115], a[40:43], v[36:39]
    ds_read_b64_tr_b16 a[86:87], v21 offset:39552
    ds_read_b64_tr_b16 a[88:89], v22 offset:39040
    v_mfma_f32_16x16x32_bf16 v[52:55], a[112:115], a[44:47], v[52:55]
    ds_read_b64_tr_b16 a[90:91], v22 offset:39552
    v_mfma_f32_16x16x32_bf16 v[56:59], a[116:119], a[44:47], v[56:59]
    ds_read_b64_tr_b16 a[92:93], v23 offset:39040
    v_mfma_f32_16x16x32_bf16 v[40:43], a[116:119], a[40:43], v[40:43]
    ds_read_b64_tr_b16 a[94:95], v23 offset:39552
    v_mov_b32 v98, s34
    s_waitcnt vmcnt(0)
    s_mov_b64 exec, 1
    buffer_store_dword v98, v97, s[28:31], s24 offen sc1
    s_mov_b64 exec, -1
    s_cmp_eq_u32 s42, 9
    s_cbranch_scc1 Lxe9
Lxe9_b:
    s_setprio 1
    s_waitcnt lgkmcnt(6)
    v_mfma_f32_16x16x32_bf16 v[28:31], a[80:83], a[48:51], v[28:31]
    ds_read_b128 a[56:59], v77 offset:39040
    ds_read_b128 a[60:63], v79 offset:39040
    ds_read_b64_tr_b16 a[104:105], v20 offset:43136
    v_mfma_f32_16x16x32_bf16 v[44:47], a[80:83], a[52:55], v[44:47]
    ds_read_b64_tr_b16 a[106:107], v20 offset:43648
    ds_read_b64_tr_b16 a[108:109], v21 offset:43136
    s_waitcnt lgkmcnt(9)
    v_mfma_f32_16x16x32_bf16 v[48:51], a[84:87], a[52:55], v[48:51]
    ds_read_b64_tr_b16 a[110:111], v21 offset:43648
    ds_read_b64_tr_b16 a[112:113], v22 offset:43136
    ds_read_b64_tr_b16 a[114:115], v22 offset:43648
    v_mfma_f32_16x16x32_bf16 v[32:35], a[84:87], a[48:51], v[32:35]
    ds_read_b64_tr_b16 a[116:117], v23 offset:43136
    ds_read_b64_tr_b16 a[118:119], v23 offset:43648
    s_setprio 0
    s_waitcnt lgkmcnt(12)
    v_mfma_f32_16x16x32_bf16 v[36:39], a[88:91], a[48:51], v[36:39]
    ds_read_b32 v120, v94
    ds_read_b32 v121, v94 offset:512
    v_xor_b32 v94, 64, v94
    v_mfma_f32_16x16x32_bf16 v[52:55], a[88:91], a[52:55], v[52:55]
    ds_read_b32 v122, v94
    ds_read_b32 v123, v92 offset:512
    s_waitcnt lgkmcnt(14)
    v_mfma_f32_16x16x32_bf16 v[56:59], a[92:95], a[52:55], v[56:59]
    ds_read_b32 v126, v93 offset:520
    v_mov_b32 v24, v84
    v_mov_b32 v25, v85
    v_mfma_f32_16x16x32_bf16 v[40:43], a[92:95], a[48:51], v[40:43]
    v_mov_b32 v26, v86
    v_mov_b32 v27, v87
    s_waitcnt lgkmcnt(5)
    v_mfma_f32_16x16x32_bf16 v[44:47], a[104:107], a[60:63], v[44:47]
    v_mfma_f32_16x16x32_bf16 v[48:51], a[108:111], a[60:63], v[48:51]
    v_mfma_f32_16x16x32_bf16 v[52:55], a[112:115], a[60:63], v[52:55]
    v_mfma_f32_16x16x32_bf16 v[56:59], a[116:119], a[60:63], v[56:59]
    v_mfma_f32_16x16x32_bf16 v[28:31], a[104:107], a[56:59], v[28:31]
    v_mfma_f32_16x16x32_bf16 v[32:35], a[108:111], a[56:59], v[32:35]
    ds_read_b32 v7, v96
    ds_read_b128 v[76:79], v95 offset:0
    ds_read_b128 v[80:83], v95 offset:64
    ds_read_b128 v[84:87], v95 offset:128
    ds_read_b128 v[88:91], v95 offset:192
    v_mfma_f32_16x16x32_bf16 v[36:39], a[112:115], a[56:59], v[36:39]
    v_mfma_f32_16x16x32_bf16 v[40:43], a[116:119], a[56:59], v[40:43]
    s_waitcnt lgkmcnt(0)
Lqf:
    v_readfirstlane_b32 s38, v7
    s_nop 0
    s_cmp_eq_u32 s38, 0
    s_cbranch_scc1 Lqf_re
    s_cmp_eq_u32 s27, 0
    v_fmac_f32 v44, v76, v122
    v_fmac_f32 v45, v77, v122
    v_fmac_f32 v46, v78, v122
    v_fmac_f32 v47, v79, v122
    v_cvt_pk_bf16_f32 v44, v44, v45
    v_cvt_pk_bf16_f32 v45, v46, v47
    v_fmac_f32 v48, v80, v122
    v_fmac_f32 v49, v81, v122
    v_fmac_f32 v50, v82, v122
    v_fmac_f32 v51, v83, v122
    v_cvt_pk_bf16_f32 v46, v48, v49
    v_cvt_pk_bf16_f32 v47, v50, v51
    v_fmac_f32 v52, v84, v122
    v_fmac_f32 v53, v85, v122
    v_fmac_f32 v54, v86, v122
    v_fmac_f32 v55, v87, v122
    v_cvt_pk_bf16_f32 v48, v52, v53
    v_cvt_pk_bf16_f32 v49, v54, v55
    v_fmac_f32 v56, v88, v122
    v_fmac_f32 v57, v89, v122
    v_fmac_f32 v58, v90, v122
    v_fmac_f32 v59, v91, v122
    v_cvt_pk_bf16_f32 v50, v56, v57
    v_cvt_pk_bf16_f32 v51, v58, v59
    s_cbranch_scc1 Lh1
    s_setprio 3
    ds_write_b128 v125, v[44:47] offset:2048
    ds_write_b128 v125, v[48:51] offset:3072
    v_fmac_f32 v28, v76, v120
    v_fmac_f32 v29, v77, v120
    v_fmac_f32 v30, v78, v120
    v_fmac_f32 v31, v79, v120
    v_cvt_pk_bf16_f32 v52, v28, v29
    v_cvt_pk_bf16_f32 v53, v30, v31
    v_fmac_f32 v32, v80, v120
    v_fmac_f32 v33, v81, v120
    v_fmac_f32 v34, v82, v120
    v_fmac_f32 v35, v83, v120
    v_cvt_pk_bf16_f32 v54, v32, v33
    v_cvt_pk_bf16_f32 v55, v34, v35
    v_fmac_f32 v36, v84, v120
    v_fmac_f32 v37, v85, v120
    v_fmac_f32 v38, v86, v120
    v_fmac_f32 v39, v87, v120
    v_cvt_pk_bf16_f32 v56, v36, v37
    v_cvt_pk_bf16_f32 v57, v38, v39
    v_fmac_f32 v40, v88, v120
    v_fmac_f32 v41, v89, v120
    v_fmac_f32 v42, v90, v120
    v_fmac_f32 v43, v91, v120
    v_cvt_pk_bf16_f32 v58, v40, v41
    v_cvt_pk_bf16_f32 v59, v42, v43
    ds_write_b128 v125, v[52:55] offset:4096
    ds_write_b128 v125, v[56:59] offset:5120
    v_mov_b32 v5, 157972
    v_mov_b32 v6, 1
    s_mov_b64 exec, 1
    ds_add_u32 v5, v6
    s_mov_b64 exec, -1
    v_mov_b32 v8, s22
    v_mov_b32 v9, s22
    v_mov_b32 v10, s22
    v_mov_b32 v11, s22
Lcw_1:
    s_sub_u32 s35, s35, 1
    s_cbranch_scc1 Lend
    ds_read_b32 v6, v5
    s_waitcnt lgkmcnt(0)
    v_readfirstlane_b32 s38, v6
    s_nop 0
    s_cmp_lt_u32 s38, 8
    s_cbranch_scc1 Lcw_1
    ds_read_b128 v[28:31], v125 offset:0
    ds_read_b128 v[32:35], v125 offset:1024
Lh_join:
    buffer_load_dword v20, v12, s[28:31], s24 offen sc1
    ds_read_b64_tr_b16 a[64:65], v26 offset:0
    ds_read_b64_tr_b16 a[66:67], v26 offset:512
    ds_read_b64_tr_b16 a[68:69], v27 offset:0
    ds_read_b64_tr_b16 a[70:71], v27 offset:512
    ds_read_b64_tr_b16 a[72:73], v26 offset:4096
    ds_read_b64_tr_b16 a[74:75], v26 offset:4608
    ds_read_b64_tr_b16 a[76:77], v27 offset:4096
    ds_read_b64_tr_b16 a[78:79], v27 offset:4608
    s_waitcnt lgkmcnt(8)
    s_setprio 3
    v_cndmask_b32 v92, 0, v30, s[6:7]
    v_cndmask_b32 v93, 0, v31, s[6:7]
    v_cndmask_b32 v94, 0, v32, s[12:13]
    v_cndmask_b32 v95, 0, v33, s[12:13]
    v_cndmask_b32 v104, 0, v30, s[8:9]
    v_cndmask_b32 v105, 0, v31, s[8:9]
    v_mfma_f32_16x16x32_bf16 v[76:79], v[46:49], v[92:95], v[8:11]
    v_mfma_f32_16x16x32_bf16 v[80:83], v[54:57], v[92:95], 0
    v_cndmask_b32 v106, 0, v32, s[14:15]
    v_cndmask_b32 v107, 0, v33, s[14:15]
    v_mov_b32 v96, v28
    v_mov_b32 v97, v29
    v_mfma_f32_16x16x32_bf16 v[84:87], v[46:49], v[104:107], v[8:11]
    v_mfma_f32_16x16x32_bf16 v[88:91], v[54:57], v[104:107], 0
    v_cndmask_b32 v98, 0, v30, s[10:11]
    v_cndmask_b32 v99, 0, v31, s[10:11]
    v_cndmask_b32 v100, 0, v32, s[16:17]
    v_cndmask_b32 v101, 0, v33, s[16:17]
    v_mfma_f32_16x16x32_bf16 v[36:39], v[44:47], v[96:99], v[8:11]
    v_mfma_f32_16x16x32_bf16 v[40:43], v[52:55], v[96:99], 0
    v_cndmask_b32 v76, v76, v77, s[4:5]
    v_cndmask_b32 v80, v80, v81, s[4:5]
    v_cndmask_b32 v78, v78, v79, s[4:5]
    v_cndmask_b32 v82, v82, v83, s[4:5]
    v_cndmask_b32 v92, v76, v80, s[18:19]
    v_cndmask_b32 v94, v78, v82, s[20:21]
    v_min_u32 v4, -2, v92
    v_min_u32 v5, -2, v94
    v_cndmask_b32 v84, v84, v85, s[4:5]
    v_cndmask_b32 v88, v88, v89, s[4:5]
    v_cndmask_b32 v86, v86, v87, s[4:5]
    v_cndmask_b32 v90, v90, v91, s[4:5]
    v_cndmask_b32 v104, v84, v88, s[18:19]
    v_cndmask_b32 v106, v86, v90, s[20:21]
    v_min_u32 v6, -2, v104
    v_min_u32 v7, -2, v106
    buffer_store_dwordx4 v[4:7], v13, s[28:31], s58 offen sc0 sc1
    s_setprio 2
    ds_read_b64_tr_b16 a[80:81], v26 offset:39040
    ds_read_b64_tr_b16 a[82:83], v26 offset:39552
    ds_read_b64_tr_b16 a[84:85], v27 offset:39040
    ds_read_b64_tr_b16 a[86:87], v27 offset:39552
    ds_read_b64_tr_b16 a[88:89], v26 offset:43136
    ds_read_b64_tr_b16 a[90:91], v26 offset:43648
    ds_read_b64_tr_b16 a[92:93], v27 offset:43136
    ds_read_b64_tr_b16 a[94:95], v27 offset:43648
    ds_read_b64_tr_b16 a[96:97], v24 offset:0
    ds_read_b64_tr_b16 a[98:99], v24 offset:512
    ds_read_b64_tr_b16 a[100:101], v25 offset:0
    ds_read_b64_tr_b16 a[102:103], v25 offset:512
    ds_read_b64_tr_b16 a[104:105], v24 offset:4096
    ds_read_b64_tr_b16 a[106:107], v24 offset:4608
    ds_read_b64_tr_b16 a[108:109], v25 offset:4096
    ds_read_b64_tr_b16 a[110:111], v25 offset:4608
    ds_read_b64_tr_b16 a[112:113], v24 offset:39040
    ds_read_b64_tr_b16 a[114:115], v24 offset:39552
    ds_read_b64_tr_b16 a[116:117], v25 offset:39040
    ds_read_b64_tr_b16 a[118:119], v25 offset:39552
    ds_read_b64_tr_b16 a[120:121], v24 offset:43136
    ds_read_b64_tr_b16 a[122:123], v24 offset:43648
    ds_read_b64_tr_b16 a[124:125], v25 offset:43136
    ds_read_b64_tr_b16 a[126:127], v25 offset:43648
    s_waitcnt lgkmcnt(15)
    v_mfma_f32_16x16x32_bf16 v[60:63], a[0:3], a[64:67], v[60:63]
    v_mov_b32 v102, v34
    v_mov_b32 v103, v35
    v_mul_f32 v4, s25, v121
    v_mfma_f32_16x16x32_bf16 v[68:71], a[4:7], a[64:67], v[68:71]
    v_mfma_f32_16x16x32_bf16 v[76:79], v[48:51], v[100:103], v[8:11]
    v_mfma_f32_16x16x32_bf16 v[80:83], v[56:59], v[100:103], 0
    v_mul_f32 v123, v123, v4
    v_mfma_f32_16x16x32_bf16 v[64:67], a[0:3], a[68:71], v[64:67]
    v_mul_f32 v126, v126, v4
    v_cndmask_b32 v36, v36, v37, s[4:5]
    v_cndmask_b32 v40, v40, v41, s[4:5]
    v_mfma_f32_16x16x32_bf16 v[72:75], a[4:7], a[68:71], v[72:75]
    v_cndmask_b32 v38, v38, v39, s[4:5]
    v_cndmask_b32 v42, v42, v43, s[4:5]
    v_cndmask_b32 v96, v36, v40, s[18:19]
    v_mfma_f32_16x16x32_bf16 v[60:63], a[8:11], a[72:75], v[60:63]
    v_cndmask_b32 v98, v38, v42, s[20:21]
    v_cndmask_b32 v76, v76, v77, s[4:5]
    v_cndmask_b32 v80, v80, v81, s[4:5]
    v_mfma_f32_16x16x32_bf16 v[68:71], a[12:15], a[72:75], v[68:71]
    v_cndmask_b32 v78, v78, v79, s[4:5]
    v_cndmask_b32 v82, v82, v83, s[4:5]
    v_cndmask_b32 v100, v76, v80, s[18:19]
    v_mfma_f32_16x16x32_bf16 v[64:67], a[8:11], a[76:79], v[64:67]
    v_cndmask_b32 v102, v78, v82, s[20:21]
    v_mul_f32 v96, v96, v123
    v_mul_f32 v98, v98, v126
    v_mfma_f32_16x16x32_bf16 v[72:75], a[12:15], a[76:79], v[72:75]
    v_mul_f32 v100, v100, v123
    v_mul_f32 v102, v102, v126
    v_max_f32 v4, v96, v98
    v_mfma_f32_16x16x32_bf16 v[60:63], a[16:19], a[80:83], v[60:63]
    v_max_f32 v5, v100, v102
    v_mov_b32 v6, v4
    v_mov_b32 v7, v5
    v_mfma_f32_16x16x32_bf16 v[68:71], a[20:23], a[80:83], v[68:71]
    v_permlane32_swap_b32 v4, v6
    v_permlane32_swap_b32 v5, v7
    v_max_f32 v4, v4, v6
    v_mfma_f32_16x16x32_bf16 v[64:67], a[16:19], a[84:87], v[64:67]
    v_max_f32 v5, v5, v7
    v_mov_b32 v6, v4
    v_mov_b32 v7, v5
    v_mfma_f32_16x16x32_bf16 v[72:75], a[20:23], a[84:87], v[72:75]
    v_permlane16_swap_b32 v4, v6
    v_permlane16_swap_b32 v5, v7
    s_setprio 1
    v_mfma_f32_16x16x32_bf16 v[60:63], a[24:27], a[88:91], v[60:63]
    v_max_f32 v4, v4, v6
    v_max_f32 v5, v5, v7
    v_sub_f32 v96, v96, v4
    v_mfma_f32_16x16x32_bf16 v[68:71], a[28:31], a[88:91], v[68:71]
    v_sub_f32 v98, v98, v4
    v_sub_f32 v100, v100, v5
    v_sub_f32 v102, v102, v5
    v_mfma_f32_16x16x32_bf16 v[64:67], a[24:27], a[92:95], v[64:67]
    v_exp_f32 v96, v96
    v_exp_f32 v98, v98
    v_exp_f32 v100, v100
    v_mfma_f32_16x16x32_bf16 v[72:75], a[28:31], a[92:95], v[72:75]
    v_exp_f32 v102, v102
    v_cvt_pk_bf16_f32 v96, v96, v96
    s_waitcnt lgkmcnt(12)
    v_mfma_f32_16x16x32_bf16 v[60:63], a[32:35], a[96:99], v[60:63]
    v_cvt_pk_bf16_f32 v97, v98, v98
    v_cvt_pk_bf16_f32 v100, v100, v100
    v_cvt_pk_bf16_f32 v101, v102, v102
    v_mfma_f32_16x16x32_bf16 v[68:71], a[36:39], a[96:99], v[68:71]
    v_and_b32 v98, v96, v118
    v_and_b32 v99, v97, v119
    v_and_b32 v96, v96, v116
    v_mfma_f32_16x16x32_bf16 v[64:67], a[32:35], a[100:103], v[64:67]
    v_and_b32 v97, v97, v117
    v_and_b32 v102, v100, v118
    v_and_b32 v103, v101, v119
    v_mfma_f32_16x16x32_bf16 v[72:75], a[36:39], a[100:103], v[72:75]
    v_and_b32 v100, v100, v116
    v_and_b32 v101, v101, v117
    s_waitcnt lgkmcnt(8)
    v_mfma_f32_16x16x32_bf16 v[60:63], a[40:43], a[104:107], v[60:63]
    s_lshl_b32 s36, s44, 6
    s_add_u32 s36, s36, 156160
    v_lshl_add_u32 v48, v2, 4, s36
    v_xor_b32 v49, 64, v48
    ds_read_b128 v[28:31], v48 offset:0
    v_mfma_f32_16x16x32_bf16 v[68:71], a[44:47], a[104:107], v[68:71]
    ds_read_b128 v[32:35], v48 offset:512
    ds_read_b128 v[36:39], v49 offset:0
    ds_read_b128 v[40:43], v49 offset:512
    s_lshl_b32 s36, s27, 3
    s_add_u32 s36, s36, 157696
    v_mfma_f32_16x16x32_bf16 v[64:67], a[40:43], a[108:111], v[64:67]
    v_lshl_add_u32 v48, v3, 4, s36
    v_mov_b32 v49, 157952
    v_lshl_add_u32 v125, v1, 3, s45
    s_lshl_b32 s36, s27, 10
    v_add_u32 v50, s36, v125
    v_mfma_f32_16x16x32_bf16 v[72:75], a[44:47], a[108:111], v[72:75]
    s_lshl_b32 s37, s27, 12
    s_sub_u32 s37, 2048, s37
    v_add_u32 v51, s37, v50
    v_subrev_u32 v125, 2048, v125
    s_setprio 0
    s_waitcnt lgkmcnt(8)
    v_mfma_f32_16x16x32_bf16 v[60:63], a[48:51], a[112:115], v[60:63]
    v_mfma_f32_16x16x32_bf16 v[68:71], a[52:55], a[112:115], v[68:71]
    v_mfma_f32_16x16x32_bf16 v[64:67], a[48:51], a[116:119], v[64:67]
    v_mfma_f32_16x16x32_bf16 v[72:75], a[52:55], a[116:119], v[72:75]
    s_waitcnt vmcnt(1)
Lfl_chk:
    v_cmp_eq_u32 vcc, s34, v20
    s_nop 0
    s_and_b32 s36, vcc_lo, 0x3ff
    s_cmp_lg_u32 s36, 0x3ff
    s_cbranch_scc1 Lfl_re
    buffer_load_dwordx2 v[52:53], v13, s[28:31], s59 offen offset:8 sc1
    buffer_load_dwordx2 v[54:55], v13, s[28:31], s60 offen offset:0 sc1
    s_waitcnt lgkmcnt(4)
    v_mfma_f32_16x16x32_bf16 v[60:63], a[56:59], a[120:123], v[60:63]
    v_mfma_f32_16x16x32_bf16 v[68:71], a[60:63], a[120:123], v[68:71]
    v_mfma_f32_16x16x32_bf16 v[64:67], a[56:59], a[124:127], v[64:67]
    v_mfma_f32_16x16x32_bf16 v[72:75], a[60:63], a[124:127], v[72:75]
    ds_read_b32 v46, v49
    ds_read_b64 v[44:45], v48
    s_waitcnt lgkmcnt(0)
Lcsv:
    v_readfirstlane_b32 s38, v46
    s_nop 0
    s_cmp_eq_u32 s38, 0
    s_cbranch_scc1 Lcsv_re
    v_fmac_f32 v60, v28, v44
    v_fmac_f32 v61, v29, v44
    v_fmac_f32 v62, v30, v44
    v_fmac_f32 v63, v31, v44
    v_mul_f32 v60, v60, v32
    v_mul_f32 v61, v61, v33
    v_mul_f32 v62, v62, v34
    v_mul_f32 v63, v63, v35
    v_cvt_pk_bf16_f32 v60, v60, v61
    v_cvt_pk_bf16_f32 v61, v62, v63
    ds_write_b64 v50, v[60:61] offset:0
    v_fmac_f32 v64, v28, v45
    v_fmac_f32 v65, v29, v45
    v_fmac_f32 v66, v30, v45
    v_fmac_f32 v67, v31, v45
    v_mul_f32 v64, v64, v32
    v_mul_f32 v65, v65, v33
    v_mul_f32 v66, v66, v34
    v_mul_f32 v67, v67, v35
    v_cvt_pk_bf16_f32 v64, v64, v65
    v_cvt_pk_bf16_f32 v65, v66, v67
    ds_write_b64 v50, v[64:65] offset:512
    v_fmac_f32 v68, v36, v44
    v_fmac_f32 v69, v37, v44
    v_fmac_f32 v70, v38, v44
    v_fmac_f32 v71, v39, v44
    v_mul_f32 v68, v68, v40
    v_mul_f32 v69, v69, v41
    v_mul_f32 v70, v70, v42
    v_mul_f32 v71, v71, v43
    v_cvt_pk_bf16_f32 v68, v68, v69
    v_cvt_pk_bf16_f32 v69, v70, v71
    ds_write_b64 v51, v[68:69] offset:0
    v_fmac_f32 v72, v36, v45
    v_fmac_f32 v73, v37, v45
    v_fmac_f32 v74, v38, v45
    v_fmac_f32 v75, v39, v45
    v_mul_f32 v72, v72, v40
    v_mul_f32 v73, v73, v41
    v_mul_f32 v74, v74, v42
    v_mul_f32 v75, v75, v43
    v_cvt_pk_bf16_f32 v72, v72, v73
    v_cvt_pk_bf16_f32 v73, v74, v75
    ds_write_b64 v51, v[72:73] offset:512
    v_mov_b32 v8, 157976
    v_mov_b32 v9, 1
    s_mov_b64 exec, 1
    ds_add_u32 v8, v9
    s_mov_b64 exec, -1
    s_waitcnt vmcnt(0)
Lrx_chk:
    v_and_b32 v52, s61, v52
    v_and_b32 v53, s61, v53
    v_and_b32 v54, s62, v54
    v_and_b32 v55, s62, v55
    v_max3_u32 v4, v52, v53, v54
    v_max_u32 v4, v4, v55
    v_cmp_eq_u32 vcc, -1, v4
    s_nop 0
    s_cbranch_vccnz Lrx_re
    v_add_f32 v92, v92, v52
    v_add_f32 v94, v94, v53
    v_add_f32 v104, v104, v54
    v_add_f32 v106, v106, v55
Lcw_4:
    s_sub_u32 s35, s35, 1
    s_cbranch_scc1 Lend
    ds_read_b32 v9, v8
    s_waitcnt lgkmcnt(0)
    v_readfirstlane_b32 s38, v9
    s_nop 0
    s_cmp_lt_u32 s38, 7
    s_cbranch_scc1 Lcw_4
    s_setprio 2
    ds_read2st64_b64 v[60:63], v125 offset0:0 offset1:4
    ds_read2st64_b64 v[64:67], v125 offset0:1 offset1:5
    ds_read2st64_b64 v[68:71], v125 offset0:2 offset1:6
    ds_read2st64_b64 v[72:75], v125 offset0:3 offset1:7
    v_mul_f32 v92, v92, v123
    v_mul_f32 v94, v94, v126
    v_mul_f32 v104, v104, v123
    v_mul_f32 v106, v106, v126
    v_max_f32 v4, v92, v94
    v_max_f32 v5, v104, v106
    v_mov_b32 v6, v4
    v_mov_b32 v7, v5
    s_nop 0
    v_permlane32_swap_b32 v4, v6
    v_permlane32_swap_b32 v5, v7
    v_max_f32 v4, v4, v6
    v_max_f32 v5, v5, v7
    s_waitcnt lgkmcnt(0)
    v_mov_b32 v6, v4
    v_mfma_f32_16x16x32_bf16 v[80:83], v[14:17], v[96:99], 0
    v_mov_b32 v7, v5
    v_permlane16_swap_b32 v4, v6
    s_nop 0
    v_permlane16_swap_b32 v5, v7
    v_max_f32 v4, v4, v6
    v_mfma_f32_16x16x32_bf16 v[84:87], v[14:17], v[100:103], 0
    v_max_f32 v5, v5, v7
    v_sub_f32 v92, v92, v4
    v_sub_f32 v94, v94, v4
    v_sub_f32 v104, v104, v5
    v_mfma_f32_16x16x32_bf16 v[28:31], v[60:63], v[96:99], 0
    v_sub_f32 v106, v106, v5
    v_exp_f32 v92, v92
    v_exp_f32 v94, v94
    v_exp_f32 v104, v104
    v_exp_f32 v106, v106
    v_mfma_f32_16x16x32_bf16 v[32:35], v[64:67], v[96:99], 0
    v_cvt_pk_bf16_f32 v92, v92, v92
    v_cvt_pk_bf16_f32 v93, v94, v94
    v_cvt_pk_bf16_f32 v104, v104, v104
    v_cvt_pk_bf16_f32 v105, v106, v106
    v_mfma_f32_16x16x32_bf16 v[36:39], v[68:71], v[100:103], 0
    v_and_b32 v94, v92, v118
    v_and_b32 v95, v93, v119
    v_and_b32 v92, v92, v116
    v_and_b32 v93, v93, v117
    v_mfma_f32_16x16x32_bf16 v[40:43], v[72:75], v[100:103], 0
    v_and_b32 v106, v104, v118
    v_and_b32 v107, v105, v119
    v_and_b32 v104, v104, v116
    v_and_b32 v105, v105, v117
    v_mfma_f32_16x16x32_bf16 v[76:79], v[14:17], v[92:95], 0
    v_rcp_f32 v80, v80
    v_rcp_f32 v84, v84
    v_mfma_f32_16x16x32_bf16 v[88:91], v[14:17], v[104:107], 0
    v_mul_f32 v28, v28, v80
    v_mul_f32 v29, v29, v80
    v_mfma_f32_16x16x32_bf16 v[44:47], v[64:67], v[92:95], 0
    v_mul_f32 v30, v30, v80
    v_mfma_f32_16x16x32_bf16 v[48:51], v[68:71], v[92:95], 0
    v_mul_f32 v31, v31, v80
    v_cvt_pk_bf16_f32 v4, v28, v29
    v_mfma_f32_16x16x32_bf16 v[52:55], v[64:67], v[104:107], 0
    v_cvt_pk_bf16_f32 v5, v30, v31
    v_min_u32 v4, -2, v4
    v_mfma_f32_16x16x32_bf16 v[56:59], v[68:71], v[104:107], 0
    v_min_u32 v5, -2, v5
    v_mul_f32 v40, v40, v84
    v_mul_f32 v41, v41, v84
    v_mul_f32 v42, v42, v84
    v_mul_f32 v43, v43, v84
    v_cvt_pk_bf16_f32 v10, v40, v41
    v_cvt_pk_bf16_f32 v11, v42, v43
    v_min_u32 v10, -2, v10
    v_min_u32 v11, -2, v11
    v_rcp_f32 v76, v76
    v_rcp_f32 v88, v88
    v_cndmask_b32 v82, v80, v76, s[6:7]
    v_cndmask_b32 v82, v82, v88, s[8:9]
    v_cndmask_b32 v32, v32, v44, s[6:7]
    v_cndmask_b32 v33, v33, v45, s[6:7]
    v_cndmask_b32 v34, v34, v46, s[6:7]
    v_cndmask_b32 v35, v35, v47, s[6:7]
    v_cndmask_b32 v32, v32, v52, s[8:9]
    v_cndmask_b32 v33, v33, v53, s[8:9]
    v_cndmask_b32 v34, v34, v54, s[8:9]
    v_cndmask_b32 v35, v35, v55, s[8:9]
    v_mul_f32 v32, v32, v82
    v_mul_f32 v33, v33, v82
    v_mul_f32 v34, v34, v82
    v_mul_f32 v35, v35, v82
    v_cvt_pk_bf16_f32 v6, v32, v33
    v_cvt_pk_bf16_f32 v7, v34, v35
    v_min_u32 v6, -2, v6
    v_min_u32 v7, -2, v7
    buffer_store_dwordx4 v[4:7], v13, s[28:31], s23 offen offset:0 sc0 sc1
    v_cndmask_b32 v86, v84, v76, s[12:13]
    v_cndmask_b32 v86, v86, v88, s[14:15]
    v_cndmask_b32 v36, v36, v48, s[12:13]
    v_cndmask_b32 v37, v37, v49, s[12:13]
    v_cndmask_b32 v38, v38, v50, s[12:13]
    v_cndmask_b32 v39, v39, v51, s[12:13]
    v_cndmask_b32 v36, v36, v56, s[14:15]
    v_cndmask_b32 v37, v37, v57, s[14:15]
    v_cndmask_b32 v38, v38, v58, s[14:15]
    v_cndmask_b32 v39, v39, v59, s[14:15]
    v_mul_f32 v36, v36, v86
    v_mul_f32 v37, v37, v86
    v_mul_f32 v38, v38, v86
    v_mul_f32 v39, v39, v86
    v_cvt_pk_bf16_f32 v8, v36, v37
    v_cvt_pk_bf16_f32 v9, v38, v39
    v_min_u32 v8, -2, v8
    v_min_u32 v9, -2, v9
    buffer_store_dwordx4 v[8:11], v13, s[28:31], s23 offen offset:1024 sc0 sc1
    s_setprio 1
    s_nop 0
    v_mov_b32 v10, 157980
    v_and_b32 v6, 3, v1
    v_lshl_add_u32 v6, v6, 3, v19
    v_add_u32 v20, v6, v18
    v_xor_b32 v21, 32, v20
    v_xor_b32 v22, 64, v20
    v_xor_b32 v23, 96, v20
    v_add_u32 v24, 63616, v20
    v_add_u32 v25, 63616, v21
    v_add_u32 v26, 63616, v22
    v_add_u32 v27, 63616, v23
Lcw_3:
    s_sub_u32 s35, s35, 1
    s_cbranch_scc1 Lend
    ds_read_b32 v11, v10
    s_waitcnt lgkmcnt(0)
    v_readfirstlane_b32 s38, v11
    s_nop 0
    s_cmp_lt_u32 s38, 2
    s_cbranch_scc1 Lcw_3
    s_mul_i32 s36, s32, 96
    s_lshl_b32 s37, s44, 4
    s_add_u32 s36, s36, s37
    s_sub_u32 s36, s36, 32
    v_add_u32 v126, s36, v3
    v_lshrrev_b32 v6, 3, v1
    v_add_u32 v6, s36, v6
    v_mul_u32_u24 v6, 1280, v6
    v_and_b32 v7, 7, v1
    v_xor_b32 v7, v7, v2
    v_lshl_add_u32 v122, v7, 4, v6
    v_xor_b32 v123, 64, v122
    v_add_u32 v123, 10240, v123
    s_lshl_b32 s36, s44, 11
    s_add_u32 s36, s36, 102656
    v_add_u32 v124, s36, v124
    v_add_u32 v125, s36, v13
    s_lshl_b32 s24, s33, 7
    v_mov_b32 v10, 157960
    s_mov_b32 s41, 0
    s_mov_b32 s47, 3
    v_lshlrev_b32 v28, 16, v108
    ds_read_b64_tr_b16 a[0:1], v20 offset:0
    ds_read_b64_tr_b16 a[2:3], v20 offset:512
    ds_read_b64_tr_b16 a[4:5], v21 offset:0
    ds_read_b64_tr_b16 a[6:7], v21 offset:512
    ds_read_b64_tr_b16 a[8:9], v22 offset:0
    ds_read_b64_tr_b16 a[10:11], v22 offset:512
    ds_read_b64_tr_b16 a[12:13], v23 offset:0
    ds_read_b64_tr_b16 a[14:15], v23 offset:512
    v_and_b32 v29, 0xffff0000, v108
    v_lshlrev_b32 v30, 16, v109
    v_and_b32 v31, 0xffff0000, v109
    v_lshlrev_b32 v32, 16, v110
    v_and_b32 v33, 0xffff0000, v110
    v_lshlrev_b32 v34, 16, v111
    v_and_b32 v35, 0xffff0000, v111
    v_lshlrev_b32 v36, 16, v112
    v_and_b32 v37, 0xffff0000, v112
    v_lshlrev_b32 v38, 16, v113
    v_and_b32 v39, 0xffff0000, v113
    v_lshlrev_b32 v40, 16, v114
    v_and_b32 v41, 0xffff0000, v114
    v_lshlrev_b32 v42, 16, v115
    ds_read_b64_tr_b16 a[16:17], v20 offset:4096
    ds_read_b64_tr_b16 a[18:19], v20 offset:4608
    ds_read_b64_tr_b16 a[20:21], v21 offset:4096
    ds_read_b64_tr_b16 a[22:23], v21 offset:4608
    ds_read_b64_tr_b16 a[24:25], v22 offset:4096
    ds_read_b64_tr_b16 a[26:27], v22 offset:4608
    ds_read_b64_tr_b16 a[28:29], v23 offset:4096
    ds_read_b64_tr_b16 a[30:31], v23 offset:4608
    v_and_b32 v43, 0xffff0000, v115
    v_mul_f32 v4, v120, v121
    v_mul_f32 v5, 0xbfb8aa3b, v121
    v_mul_f32 v6, 0xbfb8aa3b, v4
    v_fma_f32 v44, v28, v5, v6
    v_fma_f32 v45, v29, v5, v6
    v_fma_f32 v46, v30, v5, v6
    v_fma_f32 v47, v31, v5, v6
    v_fma_f32 v48, v32, v5, v6
    v_fma_f32 v49, v33, v5, v6
    v_fma_f32 v50, v34, v5, v6
    v_fma_f32 v51, v35, v5, v6
    v_fma_f32 v52, v36, v5, v6
    v_fma_f32 v53, v37, v5, v6
    ds_read_b64_tr_b16 a[32:33], v20 offset:8192
    ds_read_b64_tr_b16 a[34:35], v20 offset:8704
    ds_read_b64_tr_b16 a[36:37], v21 offset:8192
    ds_read_b64_tr_b16 a[38:39], v21 offset:8704
    ds_read_b64_tr_b16 a[40:41], v22 offset:8192
    ds_read_b64_tr_b16 a[42:43], v22 offset:8704
    ds_read_b64_tr_b16 a[44:45], v23 offset:8192
    ds_read_b64_tr_b16 a[46:47], v23 offset:8704
    v_fma_f32 v54, v38, v5, v6
    v_fma_f32 v55, v39, v5, v6
    v_fma_f32 v56, v40, v5, v6
    v_fma_f32 v57, v41, v5, v6
    v_fma_f32 v58, v42, v5, v6
    v_fma_f32 v59, v43, v5, v6
    v_exp_f32 v44, v44
    v_exp_f32 v45, v45
    v_exp_f32 v46, v46
    v_exp_f32 v47, v47
    v_exp_f32 v48, v48
    v_exp_f32 v49, v49
    v_exp_f32 v50, v50
    v_exp_f32 v51, v51
    v_exp_f32 v52, v52
    ds_read_b64_tr_b16 a[48:49], v20 offset:12288
    ds_read_b64_tr_b16 a[50:51], v20 offset:12800
    ds_read_b64_tr_b16 a[52:53], v21 offset:12288
    ds_read_b64_tr_b16 a[54:55], v21 offset:12800
    ds_read_b64_tr_b16 a[56:57], v22 offset:12288
    ds_read_b64_tr_b16 a[58:59], v22 offset:12800
    ds_read_b64_tr_b16 a[60:61], v23 offset:12288
    ds_read_b64_tr_b16 a[62:63], v23 offset:12800
    v_exp_f32 v53, v53
    v_exp_f32 v54, v54
    v_exp_f32 v55, v55
    v_exp_f32 v56, v56
    v_exp_f32 v57, v57
    v_exp_f32 v58, v58
    v_exp_f32 v59, v59
    v_fma_f32 v92, v28, v121, v4
    v_fma_f32 v93, v29, v121, v4
    v_fma_f32 v94, v30, v121, v4
    v_fma_f32 v95, v31, v121, v4
    v_fma_f32 v96, v32, v121, v4
    v_fma_f32 v97, v33, v121, v4
    v_fma_f32 v98, v34, v121, v4
    ds_read_b64_tr_b16 a[64:65], v20 offset:24576
    ds_read_b64_tr_b16 a[66:67], v20 offset:25088
    ds_read_b64_tr_b16 a[68:69], v21 offset:24576
    ds_read_b64_tr_b16 a[70:71], v21 offset:25088
    ds_read_b64_tr_b16 a[72:73], v22 offset:24576
    ds_read_b64_tr_b16 a[74:75], v22 offset:25088
    ds_read_b64_tr_b16 a[76:77], v23 offset:24576
    ds_read_b64_tr_b16 a[78:79], v23 offset:25088
    v_fma_f32 v99, v35, v121, v4
    v_fma_f32 v100, v36, v121, v4
    v_fma_f32 v101, v37, v121, v4
    v_fma_f32 v102, v38, v121, v4
    v_fma_f32 v103, v39, v121, v4
    v_fma_f32 v104, v40, v121, v4
    v_fma_f32 v105, v41, v121, v4
    v_fma_f32 v106, v42, v121, v4
    v_fma_f32 v107, v43, v121, v4
    v_add_f32 v44, 1.0, v44
    v_add_f32 v45, 1.0, v45
    v_add_f32 v46, 1.0, v46
    v_add_f32 v47, 1.0, v47
    v_add_f32 v48, 1.0, v48
    ds_read_b64_tr_b16 a[80:81], v20 offset:28672
    ds_read_b64_tr_b16 a[82:83], v20 offset:29184
    ds_read_b64_tr_b16 a[84:85], v21 offset:28672
    ds_read_b64_tr_b16 a[86:87], v21 offset:29184
    ds_read_b64_tr_b16 a[88:89], v22 offset:28672
    ds_read_b64_tr_b16 a[90:91], v22 offset:29184
    ds_read_b64_tr_b16 a[92:93], v23 offset:28672
    ds_read_b64_tr_b16 a[94:95], v23 offset:29184
    v_add_f32 v49, 1.0, v49
    v_add_f32 v50, 1.0, v50
    v_add_f32 v51, 1.0, v51
    v_add_f32 v52, 1.0, v52
    v_add_f32 v53, 1.0, v53
    v_add_f32 v54, 1.0, v54
    v_add_f32 v55, 1.0, v55
    v_add_f32 v56, 1.0, v56
    v_add_f32 v57, 1.0, v57
    v_add_f32 v58, 1.0, v58
    v_add_f32 v59, 1.0, v59
    v_rcp_f32 v44, v44
    v_rcp_f32 v45, v45
    v_rcp_f32 v46, v46
    v_rcp_f32 v47, v47
    ds_read_b64_tr_b16 a[96:97], v24 offset:59520
    ds_read_b64_tr_b16 a[98:99], v24 offset:60032
    ds_read_b64_tr_b16 a[100:101], v25 offset:59520
    ds_read_b64_tr_b16 a[102:103], v25 offset:60032
    ds_read_b64_tr_b16 a[104:105], v26 offset:59520
    ds_read_b64_tr_b16 a[106:107], v26 offset:60032
    ds_read_b64_tr_b16 a[108:109], v27 offset:59520
    ds_read_b64_tr_b16 a[110:111], v27 offset:60032
    v_rcp_f32 v48, v48
    v_rcp_f32 v49, v49
    v_rcp_f32 v50, v50
    v_rcp_f32 v51, v51
    v_rcp_f32 v52, v52
    v_rcp_f32 v53, v53
    v_rcp_f32 v54, v54
    v_rcp_f32 v55, v55
    v_rcp_f32 v56, v56
    v_rcp_f32 v57, v57
    v_rcp_f32 v58, v58
    v_rcp_f32 v59, v59
    v_mul_f32 v44, v44, v92
    v_mul_f32 v45, v45, v93
    ds_read_b64_tr_b16 a[112:113], v24 offset:63616
    ds_read_b64_tr_b16 a[114:115], v24 offset:64128
    ds_read_b64_tr_b16 a[116:117], v25 offset:63616
    ds_read_b64_tr_b16 a[118:119], v25 offset:64128
    ds_read_b64_tr_b16 a[120:121], v26 offset:63616
    ds_read_b64_tr_b16 a[122:123], v26 offset:64128
    ds_read_b64_tr_b16 a[124:125], v27 offset:63616
    ds_read_b64_tr_b16 a[126:127], v27 offset:64128
    v_mul_f32 v46, v46, v94
    v_mul_f32 v47, v47, v95
    v_mul_f32 v48, v48, v96
    v_mul_f32 v49, v49, v97
    v_mul_f32 v50, v50, v98
    v_mul_f32 v51, v51, v99
    v_mul_f32 v52, v52, v100
    v_mul_f32 v53, v53, v101
    v_mul_f32 v54, v54, v102
    v_mul_f32 v55, v55, v103
    v_mul_f32 v56, v56, v104
    v_mul_f32 v57, v57, v105
    v_mul_f32 v58, v58, v106
    v_mul_f32 v59, v59, v107
    buffer_load_dwordx4 v[60:63], v13, s[28:31], s53 offen offset:0 sc1
    buffer_load_dwordx4 v[64:67], v13, s[28:31], s53 offen offset:1024 sc1
    buffer_load_dwordx4 v[68:71], v13, s[28:31], s53 offen offset:2048 sc1
    buffer_load_dwordx4 v[72:75], v13, s[28:31], s53 offen offset:3072 sc1
    buffer_load_dwordx4 v[76:79], v13, s[28:31], s54 offen offset:0 sc1
    buffer_load_dwordx4 v[80:83], v13, s[28:31], s54 offen offset:1024 sc1
    buffer_load_dwordx4 v[84:87], v13, s[28:31], s54 offen offset:2048 sc1
    buffer_load_dwordx4 v[88:91], v13, s[28:31], s54 offen offset:3072 sc1
    s_setprio 0
Lwo_go:
    s_setprio 3
    ds_read_b64 v[8:9], v10
    s_waitcnt vmcnt(6)
    v_max3_u32 v4, v60, v61, v62
    v_max3_u32 v5, v64, v65, v66
    v_max3_u32 v4, v4, v63, v67
    v_max_u32 v4, v4, v5
    v_cmp_eq_u32 vcc, -1, v4
    s_nop 0
    s_cbranch_vccnz Lre_0
Lck_0:
    s_waitcnt lgkmcnt(15)
    v_mfma_f32_16x16x32_bf16 v[108:111], a[0:3], v[60:63], 0
    ds_read_b64_tr_b16 a[0:1], v24 offset:16384
    ds_read_b64_tr_b16 a[2:3], v24 offset:16896
    buffer_load_dwordx4 v[92:95], v13, s[28:31], s55 offen offset:0 sc1
    v_mfma_f32_16x16x32_bf16 v[112:115], a[4:7], v[60:63], 0
    ds_read_b64_tr_b16 a[4:5], v25 offset:16384
    ds_read_b64_tr_b16 a[6:7], v25 offset:16896
    v_mfma_f32_16x16x32_bf16 v[116:119], a[8:11], v[60:63], 0
    ds_read_b64_tr_b16 a[8:9], v26 offset:16384
    buffer_load_dwordx4 v[96:99], v13, s[28:31], s55 offen offset:1024 sc1
    v_mfma_f32_16x16x32_bf16 v[14:17], a[12:15], v[60:63], 0
    ds_read_b64_tr_b16 a[10:11], v26 offset:16896
    ds_read_b64_tr_b16 a[12:13], v27 offset:16384
    v_mfma_f32_16x16x32_bf16 v[108:111], a[16:19], v[64:67], v[108:111]
    ds_read_b64_tr_b16 a[14:15], v27 offset:16896
    s_waitcnt vmcnt(6)
    v_max3_u32 v4, v68, v69, v70
    v_mfma_f32_16x16x32_bf16 v[112:115], a[20:23], v[64:67], v[112:115]
    ds_read_b64_tr_b16 a[16:17], v24 offset:20480
    ds_read_b64_tr_b16 a[18:19], v24 offset:20992
    v_max3_u32 v5, v72, v73, v74
    v_max3_u32 v4, v4, v71, v75
    v_mfma_f32_16x16x32_bf16 v[116:119], a[24:27], v[64:67], v[116:119]
    ds_read_b64_tr_b16 a[20:21], v25 offset:20480
    ds_read_b64_tr_b16 a[22:23], v25 offset:20992
    v_max_u32 v4, v4, v5
    v_cmp_eq_u32 vcc, -1, v4
    v_mfma_f32_16x16x32_bf16 v[14:17], a[28:31], v[64:67], v[14:17]
    ds_read_b64_tr_b16 a[24:25], v26 offset:20480
    s_cbranch_vccnz Lre_1
Lck_1:
    s_waitcnt lgkmcnt(13)
Linfo:
    v_readfirstlane_b32 s39, v8
    s_nop 0
    s_cmp_eq_u32 s39, -2
    s_cbranch_scc1 Linfo_re
    v_mfma_f32_16x16x32_bf16 v[108:111], a[32:35], v[68:71], v[108:111]
    ds_read_b64_tr_b16 a[26:27], v26 offset:20992
    ds_read_b64_tr_b16 a[28:29], v27 offset:20480
    buffer_load_dwordx4 v[100:103], v13, s[28:31], s55 offen offset:2048 sc1
    v_mfma_f32_16x16x32_bf16 v[112:115], a[36:39], v[68:71], v[112:115]
    ds_read_b64_tr_b16 a[30:31], v27 offset:20992
    v_mfma_f32_16x16x32_bf16 v[116:119], a[40:43], v[68:71], v[116:119]
    ds_read_b64_tr_b16 a[32:33], v20 offset:32768
    ds_read_b64_tr_b16 a[34:35], v20 offset:33280
    buffer_load_dwordx4 v[104:107], v13, s[28:31], s55 offen offset:3072 sc1
    v_mfma_f32_16x16x32_bf16 v[14:17], a[44:47], v[68:71], v[14:17]
    ds_read_b64_tr_b16 a[36:37], v21 offset:32768
    ds_read_b64_tr_b16 a[38:39], v21 offset:33280
    v_mfma_f32_16x16x32_bf16 v[108:111], a[48:51], v[72:75], v[108:111]
    ds_read_b64_tr_b16 a[40:41], v22 offset:32768
    s_waitcnt vmcnt(6)
    v_max3_u32 v4, v76, v77, v78
    v_mfma_f32_16x16x32_bf16 v[112:115], a[52:55], v[72:75], v[112:115]
    ds_read_b64_tr_b16 a[42:43], v22 offset:33280
    ds_read_b64_tr_b16 a[44:45], v23 offset:32768
    v_max3_u32 v5, v80, v81, v82
    v_max3_u32 v4, v4, v79, v83
    v_mfma_f32_16x16x32_bf16 v[116:119], a[56:59], v[72:75], v[116:119]
    ds_read_b64_tr_b16 a[46:47], v23 offset:33280
    v_max_u32 v4, v4, v5
    v_cmp_eq_u32 vcc, -1, v4
    v_mfma_f32_16x16x32_bf16 v[14:17], a[60:63], v[72:75], v[14:17]
    ds_read_b64_tr_b16 a[48:49], v20 offset:36864
    ds_read_b64_tr_b16 a[50:51], v20 offset:37376
    s_cbranch_vccnz Lre_2
Lck_2:
    v_mfma_f32_16x16x32_bf16 v[108:111], a[64:67], v[76:79], v[108:111]
    ds_read_b64_tr_b16 a[52:53], v21 offset:36864
    ds_read_b64_tr_b16 a[54:55], v21 offset:37376
    buffer_load_dwordx4 v[60:63], v13, s[28:31], s56 offen offset:0 sc1
    v_mfma_f32_16x16x32_bf16 v[112:115], a[68:71], v[76:79], v[112:115]
    ds_read_b64_tr_b16 a[56:57], v22 offset:36864
    v_mfma_f32_16x16x32_bf16 v[116:119], a[72:75], v[76:79], v[116:119]
    ds_read_b64_tr_b16 a[58:59], v22 offset:37376
    ds_read_b64_tr_b16 a[60:61], v23 offset:36864
    buffer_load_dwordx4 v[64:67], v13, s[28:31], s56 offen offset:1024 sc1
    v_mfma_f32_16x16x32_bf16 v[14:17], a[76:79], v[76:79], v[14:17]
    ds_read_b64_tr_b16 a[62:63], v23 offset:37376
    v_mfma_f32_16x16x32_bf16 v[108:111], a[80:83], v[80:83], v[108:111]
    ds_read_b64_tr_b16 a[64:65], v20 offset:40960
    ds_read_b64_tr_b16 a[66:67], v20 offset:41472
    s_waitcnt vmcnt(6)
    v_max3_u32 v4, v84, v85, v86
    v_mfma_f32_16x16x32_bf16 v[112:115], a[84:87], v[80:83], v[112:115]
    ds_read_b64_tr_b16 a[68:69], v21 offset:40960
    ds_read_b64_tr_b16 a[70:71], v21 offset:41472
    v_max3_u32 v5, v88, v89, v90
    v_max3_u32 v4, v4, v87, v91
    v_mfma_f32_16x16x32_bf16 v[116:119], a[88:91], v[80:83], v[116:119]
    ds_read_b64_tr_b16 a[72:73], v22 offset:40960
    v_max_u32 v4, v4, v5
    v_cmp_eq_u32 vcc, -1, v4
    v_mfma_f32_16x16x32_bf16 v[14:17], a[92:95], v[80:83], v[14:17]
    ds_read_b64_tr_b16 a[74:75], v22 offset:41472
    ds_read_b64_tr_b16 a[76:77], v23 offset:40960
    s_cbranch_vccnz Lre_3
Lck_3:
    s_setprio 2
    v_mfma_f32_16x16x32_bf16 v[108:111], a[96:99], v[84:87], v[108:111]
    ds_read_b64_tr_b16 a[78:79], v23 offset:41472
    buffer_load_dwordx4 v[68:71], v13, s[28:31], s56 offen offset:2048 sc1
    v_mfma_f32_16x16x32_bf16 v[112:115], a[100:103], v[84:87], v[112:115]
    ds_read_b64_tr_b16 a[80:81], v20 offset:45056
    ds_read_b64_tr_b16 a[82:83], v20 offset:45568
    v_mfma_f32_16x16x32_bf16 v[116:119], a[104:107], v[84:87], v[116:119]
    ds_read_b64_tr_b16 a[84:85], v21 offset:45056
    ds_read_b64_tr_b16 a[86:87], v21 offset:45568
    buffer_load_dwordx4 v[72:75], v13, s[28:31], s56 offen offset:3072 sc1
    v_mfma_f32_16x16x32_bf16 v[14:17], a[108:111], v[84:87], v[14:17]
    ds_read_b64_tr_b16 a[88:89], v22 offset:45056
    v_mfma_f32_16x16x32_bf16 v[108:111], a[112:115], v[88:91], v[108:111]
    ds_read_b64_tr_b16 a[90:91], v22 offset:45568
    ds_read_b64_tr_b16 a[92:93], v23 offset:45056
    s_waitcnt vmcnt(6)
    v_max3_u32 v4, v92, v93, v94
    v_mfma_f32_16x16x32_bf16 v[112:115], a[116:119], v[88:91], v[112:115]
    ds_read_b64_tr_b16 a[94:95], v23 offset:45568
    v_max3_u32 v5, v96, v97, v98
    v_max3_u32 v4, v4, v95, v99
    v_mfma_f32_16x16x32_bf16 v[116:119], a[120:123], v[88:91], v[116:119]
    ds_read_b64_tr_b16 a[96:97], v24 offset:0
    ds_read_b64_tr_b16 a[98:99], v24 offset:512
    v_max_u32 v4, v4, v5
    v_cmp_eq_u32 vcc, -1, v4
    v_mfma_f32_16x16x32_bf16 v[14:17], a[124:127], v[88:91], v[14:17]
    ds_read_b64_tr_b16 a[100:101], v25 offset:0
    ds_read_b64_tr_b16 a[102:103], v25 offset:512
    s_cbranch_vccnz Lre_4
Lck_4:
    s_waitcnt lgkmcnt(15)
    v_mfma_f32_16x16x32_bf16 v[108:111], a[0:3], v[92:95], v[108:111]
    ds_read_b64_tr_b16 a[104:105], v26 offset:0
    buffer_load_dwordx4 v[76:79], v13, s[28:31], s57 offen offset:0 sc1
    v_mfma_f32_16x16x32_bf16 v[112:115], a[4:7], v[92:95], v[112:115]
    ds_read_b64_tr_b16 a[106:107], v26 offset:512
    ds_read_b64_tr_b16 a[108:109], v27 offset:0
    v_mfma_f32_16x16x32_bf16 v[116:119], a[8:11], v[92:95], v[116:119]
    ds_read_b64_tr_b16 a[110:111], v27 offset:512
    buffer_load_dwordx4 v[80:83], v13, s[28:31], s57 offen offset:1024 sc1
    v_mfma_f32_16x16x32_bf16 v[14:17], a[12:15], v[92:95], v[14:17]
    ds_read_b64_tr_b16 a[112:113], v24 offset:4096
    ds_read_b64_tr_b16 a[114:115], v24 offset:4608
    v_mfma_f32_16x16x32_bf16 v[108:111], a[16:19], v[96:99], v[108:111]
    ds_read_b64_tr_b16 a[116:117], v25 offset:4096
    ds_read_b64_tr_b16 a[118:119], v25 offset:4608
    s_waitcnt vmcnt(6)
    v_max3_u32 v4, v100, v101, v102
    v_mfma_f32_16x16x32_bf16 v[112:115], a[20:23], v[96:99], v[112:115]
    ds_read_b64_tr_b16 a[120:121], v26 offset:4096
    v_max3_u32 v5, v104, v105, v106
    v_max3_u32 v4, v4, v103, v107
    v_mfma_f32_16x16x32_bf16 v[116:119], a[24:27], v[96:99], v[116:119]
    ds_read_b64_tr_b16 a[122:123], v26 offset:4608
    ds_read_b64_tr_b16 a[124:125], v27 offset:4096
    v_max_u32 v4, v4, v5
    v_cmp_eq_u32 vcc, -1, v4
    v_mfma_f32_16x16x32_bf16 v[14:17], a[28:31], v[96:99], v[14:17]
    ds_read_b64_tr_b16 a[126:127], v27 offset:4608
    s_cbranch_vccnz Lre_5
Lck_5:
    v_mfma_f32_16x16x32_bf16 v[108:111], a[32:35], v[100:103], v[108:111]
    ds_read_b64_tr_b16 a[0:1], v24 offset:8192
    ds_read_b64_tr_b16 a[2:3], v24 offset:8704
    buffer_load_dwordx4 v[84:87], v13, s[28:31], s57 offen offset:2048 sc1
    v_mfma_f32_16x16x32_bf16 v[112:115], a[36:39], v[100:103], v[112:115]
    ds_read_b64_tr_b16 a[4:5], v25 offset:8192
    ds_read_b64_tr_b16 a[6:7], v25 offset:8704
    v_mfma_f32_16x16x32_bf16 v[116:119], a[40:43], v[100:103], v[116:119]
    ds_read_b64_tr_b16 a[8:9], v26 offset:8192
    buffer_load_dwordx4 v[88:91], v13, s[28:31], s57 offen offset:3072 sc1
    v_mfma_f32_16x16x32_bf16 v[14:17], a[44:47], v[100:103], v[14:17]
    ds_read_b64_tr_b16 a[10:11], v26 offset:8704
    ds_read_b64_tr_b16 a[12:13], v27 offset:8192
    v_mfma_f32_16x16x32_bf16 v[108:111], a[48:51], v[104:107], v[108:111]
    ds_read_b64_tr_b16 a[14:15], v27 offset:8704
    s_waitcnt vmcnt(6)
    v_max3_u32 v4, v60, v61, v62
    v_mfma_f32_16x16x32_bf16 v[112:115], a[52:55], v[104:107], v[112:115]
    ds_read_b64_tr_b16 a[16:17], v24 offset:12288
    ds_read_b64_tr_b16 a[18:19], v24 offset:12800
    v_max3_u32 v5, v64, v65, v66
    v_max3_u32 v4, v4, v63, v67
    v_mfma_f32_16x16x32_bf16 v[116:119], a[56:59], v[104:107], v[116:119]
    ds_read_b64_tr_b16 a[20:21], v25 offset:12288
    ds_read_b64_tr_b16 a[22:23], v25 offset:12800
    v_max_u32 v4, v4, v5
    v_cmp_eq_u32 vcc, -1, v4
    v_mfma_f32_16x16x32_bf16 v[14:17], a[60:63], v[104:107], v[14:17]
    ds_read_b64_tr_b16 a[24:25], v26 offset:12288
    s_cbranch_vccnz Lre_6
Lck_6:
    s_setprio 1
    s_waitcnt lgkmcnt(15)
    v_mfma_f32_16x16x32_bf16 v[108:111], a[64:67], v[60:63], v[108:111]
    ds_read_b64_tr_b16 a[26:27], v26 offset:12800
    ds_read_b64_tr_b16 a[28:29], v27 offset:12288
    v_mfma_f32_16x16x32_bf16 v[112:115], a[68:71], v[60:63], v[112:115]
    ds_read_b64_tr_b16 a[30:31], v27 offset:12800
    v_mfma_f32_16x16x32_bf16 v[116:119], a[72:75], v[60:63], v[116:119]
    ds_read_b64_tr_b16 a[32:33], v20 offset:49152
    ds_read_b64_tr_b16 a[34:35], v20 offset:49664
    v_mfma_f32_16x16x32_bf16 v[14:17], a[76:79], v[60:63], v[14:17]
    ds_read_b64_tr_b16 a[36:37], v21 offset:49152
    ds_read_b64_tr_b16 a[38:39], v21 offset:49664
    v_mfma_f32_16x16x32_bf16 v[108:111], a[80:83], v[64:67], v[108:111]
    ds_read_b64_tr_b16 a[40:41], v22 offset:49152
    s_waitcnt vmcnt(4)
    v_max3_u32 v4, v68, v69, v70
    v_mfma_f32_16x16x32_bf16 v[112:115], a[84:87], v[64:67], v[112:115]
    ds_read_b64_tr_b16 a[42:43], v22 offset:49664
    ds_read_b64_tr_b16 a[44:45], v23 offset:49152
    v_max3_u32 v5, v72, v73, v74
    v_max3_u32 v4, v4, v71, v75
    v_mfma_f32_16x16x32_bf16 v[116:119], a[88:91], v[64:67], v[116:119]
    ds_read_b64_tr_b16 a[46:47], v23 offset:49664
    v_max_u32 v4, v4, v5
    v_cmp_eq_u32 vcc, -1, v4
    v_mfma_f32_16x16x32_bf16 v[14:17], a[92:95], v[64:67], v[14:17]
    ds_read_b64_tr_b16 a[48:49], v24 offset:24576
    ds_read_b64_tr_b16 a[50:51], v24 offset:25088
    s_cbranch_vccnz Lre_7
Lck_7:
    v_mfma_f32_16x16x32_bf16 v[108:111], a[96:99], v[68:71], v[108:111]
    ds_read_b64_tr_b16 a[52:53], v25 offset:24576
    ds_read_b64_tr_b16 a[54:55], v25 offset:25088
    v_mfma_f32_16x16x32_bf16 v[112:115], a[100:103], v[68:71], v[112:115]
    ds_read_b64_tr_b16 a[56:57], v26 offset:24576
    v_mfma_f32_16x16x32_bf16 v[116:119], a[104:107], v[68:71], v[116:119]
    ds_read_b64_tr_b16 a[58:59], v26 offset:25088
    ds_read_b64_tr_b16 a[60:61], v27 offset:24576
    v_mfma_f32_16x16x32_bf16 v[14:17], a[108:111], v[68:71], v[14:17]
    ds_read_b64_tr_b16 a[62:63], v27 offset:25088
    s_waitcnt lgkmcnt(15)
    v_mfma_f32_16x16x32_bf16 v[108:111], a[112:115], v[72:75], v[108:111]
    s_waitcnt vmcnt(2)
    v_max3_u32 v4, v76, v77, v78
    v_mfma_f32_16x16x32_bf16 v[112:115], a[116:119], v[72:75], v[112:115]
    v_max3_u32 v5, v80, v81, v82
    v_max3_u32 v4, v4, v79, v83
    v_mfma_f32_16x16x32_bf16 v[116:119], a[120:123], v[72:75], v[116:119]
    v_max_u32 v4, v4, v5
    v_cmp_eq_u32 vcc, -1, v4
    v_mfma_f32_16x16x32_bf16 v[14:17], a[124:127], v[72:75], v[14:17]
    s_cbranch_vccnz Lre_8
Lck_8:
    s_setprio 0
    v_mfma_f32_16x16x32_bf16 v[108:111], a[0:3], v[76:79], v[108:111]
    v_mfma_f32_16x16x32_bf16 v[112:115], a[4:7], v[76:79], v[112:115]
    v_mfma_f32_16x16x32_bf16 v[116:119], a[8:11], v[76:79], v[116:119]
    v_mfma_f32_16x16x32_bf16 v[14:17], a[12:15], v[76:79], v[14:17]
    v_mfma_f32_16x16x32_bf16 v[108:111], a[16:19], v[80:83], v[108:111]
    s_waitcnt vmcnt(0)
    v_max3_u32 v4, v84, v85, v86
    v_mfma_f32_16x16x32_bf16 v[112:115], a[20:23], v[80:83], v[112:115]
    v_max3_u32 v5, v88, v89, v90
    v_max3_u32 v4, v4, v87, v91
    v_mfma_f32_16x16x32_bf16 v[116:119], a[24:27], v[80:83], v[116:119]
    v_max_u32 v4, v4, v5
    v_cmp_eq_u32 vcc, -1, v4
    v_mfma_f32_16x16x32_bf16 v[14:17], a[28:31], v[80:83], v[14:17]
    s_cbranch_vccnz Lre_9
Lck_9:
    s_waitcnt lgkmcnt(8)
    v_mfma_f32_16x16x32_bf16 v[108:111], a[32:35], v[84:87], v[108:111]
    v_mfma_f32_16x16x32_bf16 v[112:115], a[36:39], v[84:87], v[112:115]
    v_mfma_f32_16x16x32_bf16 v[116:119], a[40:43], v[84:87], v[116:119]
    v_mfma_f32_16x16x32_bf16 v[14:17], a[44:47], v[84:87], v[14:17]
    s_waitcnt lgkmcnt(0)
    v_mfma_f32_16x16x32_bf16 v[108:111], a[48:51], v[88:91], v[108:111]
    v_mfma_f32_16x16x32_bf16 v[112:115], a[52:55], v[88:91], v[112:115]
    v_mfma_f32_16x16x32_bf16 v[116:119], a[56:59], v[88:91], v[116:119]
    v_mfma_f32_16x16x32_bf16 v[14:17], a[60:63], v[88:91], v[14:17]
    v_xor_b32 v60, 32, v124
    v_xor_b32 v61, 64, v124
    v_xor_b32 v62, 96, v124
    v_cmp_eq_u32 s[36:37], v8, v126
    v_cmp_eq_u32 s[38:39], v9, v126
    s_nop 0
    s_or_b64 vcc, s[36:37], s[38:39]
    s_cbranch_scc1 Lfix
Lnofix:
    v_fma_f32 v108, v108, v44, v28
    v_fma_f32 v109, v109, v45, v29
    v_fma_f32 v110, v110, v46, v30
    v_fma_f32 v111, v111, v47, v31
    v_cvt_pk_bf16_f32 v68, v108, v109
    v_cvt_pk_bf16_f32 v69, v110, v111
    ds_write_b64 v124, v[68:69]
    v_fma_f32 v112, v112, v48, v32
    v_fma_f32 v113, v113, v49, v33
    v_fma_f32 v114, v114, v50, v34
    v_fma_f32 v115, v115, v51, v35
    v_cvt_pk_bf16_f32 v70, v112, v113
    v_cvt_pk_bf16_f32 v71, v114, v115
    ds_write_b64 v60, v[70:71]
    v_fma_f32 v116, v116, v52, v36
    v_fma_f32 v117, v117, v53, v37
    v_fma_f32 v118, v118, v54, v38
    v_fma_f32 v119, v119, v55, v39
    v_cvt_pk_bf16_f32 v72, v116, v117
    v_cvt_pk_bf16_f32 v73, v118, v119
    ds_write_b64 v61, v[72:73]
    v_fma_f32 v14, v14, v56, v40
    v_fma_f32 v15, v15, v57, v41
    v_fma_f32 v16, v16, v58, v42
    v_fma_f32 v17, v17, v59, v43
    v_cvt_pk_bf16_f32 v74, v14, v15
    v_cvt_pk_bf16_f32 v75, v16, v17
    ds_write_b64 v62, v[74:75]
    ds_read_b128 v[76:79], v125 offset:0
    ds_read_b128 v[80:83], v125 offset:1024
    s_waitcnt lgkmcnt(1)
    buffer_store_dwordx4 v[76:79], v122, s[48:51], s24 offen sc0 sc1
    s_waitcnt lgkmcnt(0)
    buffer_store_dwordx4 v[80:83], v123, s[48:51], s24 offen sc0 sc1
    s_endpgm
Lh1:
    ds_write_b128 v125, v[44:47] offset:0
    ds_write_b128 v125, v[48:51] offset:1024
    v_mov_b32 v5, 157972
    v_mov_b32 v6, 1
    s_mov_b64 exec, 1
    ds_add_u32 v5, v6
    s_mov_b64 exec, -1
    v_fmac_f32 v28, v76, v120
    v_fmac_f32 v29, v77, v120
    v_fmac_f32 v30, v78, v120
    v_fmac_f32 v31, v79, v120
    v_cvt_pk_bf16_f32 v28, v28, v29
    v_cvt_pk_bf16_f32 v29, v30, v31
    v_fmac_f32 v32, v80, v120
    v_fmac_f32 v33, v81, v120
    v_fmac_f32 v34, v82, v120
    v_fmac_f32 v35, v83, v120
    v_cvt_pk_bf16_f32 v30, v32, v33
    v_cvt_pk_bf16_f32 v31, v34, v35
    v_fmac_f32 v36, v84, v120
    v_fmac_f32 v37, v85, v120
    v_fmac_f32 v38, v86, v120
    v_fmac_f32 v39, v87, v120
    v_cvt_pk_bf16_f32 v32, v36, v37
    v_cvt_pk_bf16_f32 v33, v38, v39
    v_fmac_f32 v40, v88, v120
    v_fmac_f32 v41, v89, v120
    v_fmac_f32 v42, v90, v120
    v_fmac_f32 v43, v91, v120
    v_cvt_pk_bf16_f32 v34, v40, v41
    v_cvt_pk_bf16_f32 v35, v42, v43
    v_subrev_u32 v4, 6144, v125
    v_mov_b32 v8, s22
    v_mov_b32 v9, s22
    v_mov_b32 v10, s22
    v_mov_b32 v11, s22
Lcw_2:
    s_sub_u32 s35, s35, 1
    s_cbranch_scc1 Lend
    ds_read_b32 v6, v5
    s_waitcnt lgkmcnt(0)
    v_readfirstlane_b32 s38, v6
    s_nop 0
    s_cmp_lt_u32 s38, 8
    s_cbranch_scc1 Lcw_2
    ds_read_b128 v[52:55], v125 offset:2048
    ds_read_b128 v[56:59], v125 offset:3072
    ds_read_b128 v[44:47], v4 offset:4096
    ds_read_b128 v[48:51], v4 offset:5120
    s_branch Lh_join
Lqf_re:
    s_sub_u32 s35, s35, 1
    s_cbranch_scc1 Lend
    ds_read_b32 v7, v96
    ds_read_b128 v[76:79], v95 offset:0
    ds_read_b128 v[80:83], v95 offset:64
    ds_read_b128 v[84:87], v95 offset:128
    ds_read_b128 v[88:91], v95 offset:192
    s_waitcnt lgkmcnt(0)
    s_branch Lqf
Lcsv_re:
    s_sub_u32 s35, s35, 1
    s_cbranch_scc1 Lend
    ds_read_b32 v46, v49
    ds_read_b64 v[44:45], v48
    s_waitcnt lgkmcnt(0)
    s_branch Lcsv
Lrx_re:
    s_sub_u32 s35, s35, 1
    s_cbranch_scc1 Lend
    buffer_load_dwordx2 v[52:53], v13, s[28:31], s59 offen offset:8 sc1
    buffer_load_dwordx2 v[54:55], v13, s[28:31], s60 offen offset:0 sc1
    s_waitcnt vmcnt(0)
    s_branch Lrx_chk
Linfo_re:
    s_sub_u32 s35, s35, 1
    s_cbranch_scc1 Lend
    ds_read_b64 v[8:9], v10
    s_waitcnt lgkmcnt(0)
    s_branch Linfo
Lfl_re:
    s_sub_u32 s35, s35, 1
    s_cbranch_scc1 Lend
    buffer_load_dword v20, v12, s[28:31], s24 offen sc1
    s_waitcnt vmcnt(0)
    s_branch Lfl_chk
Lxe0:
    ds_read_b64 v[108:109], v4
    ds_read_b64 v[110:111], v5
    ds_read_b64 v[112:113], v6
    ds_read_b64 v[114:115], v7
    s_branch Lxe0_b
Lxe1:
    ds_read_b64 v[108:109], v4
    ds_read_b64 v[110:111], v5
    ds_read_b64 v[112:113], v6
    ds_read_b64 v[114:115], v7
    s_branch Lxe1_b
Lxe2:
    ds_read_b64 v[108:109], v4
    ds_read_b64 v[110:111], v5
    ds_read_b64 v[112:113], v6
    ds_read_b64 v[114:115], v7
    s_branch Lxe2_b
Lxe3:
    ds_read_b64 v[108:109], v4
    ds_read_b64 v[110:111], v5
    ds_read_b64 v[112:113], v6
    ds_read_b64 v[114:115], v7
    s_branch Lxe3_b
Lxe4:
    ds_read_b64 v[108:109], v4
    ds_read_b64 v[110:111], v5
    ds_read_b64 v[112:113], v6
    ds_read_b64 v[114:115], v7
    s_branch Lxe4_b
Lxe5:
    ds_read_b64 v[108:109], v4
    ds_read_b64 v[110:111], v5
    ds_read_b64 v[112:113], v6
    ds_read_b64 v[114:115], v7
    s_branch Lxe5_b
Lxe6:
    ds_read_b64 v[108:109], v4
    ds_read_b64 v[110:111], v5
    ds_read_b64 v[112:113], v6
    ds_read_b64 v[114:115], v7
    s_branch Lxe6_b
Lxe7:
    ds_read_b64 v[108:109], v4
    ds_read_b64 v[110:111], v5
    ds_read_b64 v[112:113], v6
    ds_read_b64 v[114:115], v7
    s_branch Lxe7_b
Lxe8:
    ds_read_b64 v[108:109], v4
    ds_read_b64 v[110:111], v5
    ds_read_b64 v[112:113], v6
    ds_read_b64 v[114:115], v7
    s_branch Lxe8_b
Lxe9:
    ds_read_b64 v[108:109], v4
    ds_read_b64 v[110:111], v5
    ds_read_b64 v[112:113], v6
    ds_read_b64 v[114:115], v7
    s_branch Lxe9_b
Lre_0:
    s_mov_b32 s41, 1
    s_sub_u32 s35, s35, 1
    s_cbranch_scc1 Lend
    s_sleep 2
    buffer_load_dwordx4 v[60:63], v13, s[28:31], s53 offen offset:0 sc1
    buffer_load_dwordx4 v[64:67], v13, s[28:31], s53 offen offset:1024 sc1
    s_waitcnt vmcnt(0)
    v_max3_u32 v4, v60, v61, v62
    v_max3_u32 v5, v64, v65, v66
    v_max3_u32 v4, v4, v63, v67
    v_max_u32 v4, v4, v5
    v_cmp_eq_u32 vcc, -1, v4
    s_nop 0
    s_cbranch_vccnz Lre_0
    buffer_load_dwordx4 v[68:71], v13, s[28:31], s53 offen offset:2048 sc1
    buffer_load_dwordx4 v[72:75], v13, s[28:31], s53 offen offset:3072 sc1
    buffer_load_dwordx4 v[76:79], v13, s[28:31], s54 offen offset:0 sc1
    buffer_load_dwordx4 v[80:83], v13, s[28:31], s54 offen offset:1024 sc1
    buffer_load_dwordx4 v[84:87], v13, s[28:31], s54 offen offset:2048 sc1
    buffer_load_dwordx4 v[88:91], v13, s[28:31], s54 offen offset:3072 sc1
    s_branch Lck_0
Lre_1:
    s_mov_b32 s41, 1
    s_sub_u32 s35, s35, 1
    s_cbranch_scc1 Lend
    s_sleep 2
    buffer_load_dwordx4 v[68:71], v13, s[28:31], s53 offen offset:2048 sc1
    buffer_load_dwordx4 v[72:75], v13, s[28:31], s53 offen offset:3072 sc1
    s_waitcnt vmcnt(0)
    v_max3_u32 v4, v68, v69, v70
    v_max3_u32 v5, v72, v73, v74
    v_max3_u32 v4, v4, v71, v75
    v_max_u32 v4, v4, v5
    v_cmp_eq_u32 vcc, -1, v4
    s_nop 0
    s_cbranch_vccnz Lre_1
    buffer_load_dwordx4 v[76:79], v13, s[28:31], s54 offen offset:0 sc1
    buffer_load_dwordx4 v[80:83], v13, s[28:31], s54 offen offset:1024 sc1
    buffer_load_dwordx4 v[84:87], v13, s[28:31], s54 offen offset:2048 sc1
    buffer_load_dwordx4 v[88:91], v13, s[28:31], s54 offen offset:3072 sc1
    buffer_load_dwordx4 v[92:95], v13, s[28:31], s55 offen offset:0 sc1
    buffer_load_dwordx4 v[96:99], v13, s[28:31], s55 offen offset:1024 sc1
    s_branch Lck_1
Lre_2:
    s_mov_b32 s41, 1
    s_sub_u32 s35, s35, 1
    s_cbranch_scc1 Lend
    s_sleep 2
    buffer_load_dwordx4 v[76:79], v13, s[28:31], s54 offen offset:0 sc1
    buffer_load_dwordx4 v[80:83], v13, s[28:31], s54 offen offset:1024 sc1
    s_waitcnt vmcnt(0)
    v_max3_u32 v4, v76, v77, v78
    v_max3_u32 v5, v80, v81, v82
    v_max3_u32 v4, v4, v79, v83
    v_max_u32 v4, v4, v5
    v_cmp_eq_u32 vcc, -1, v4
    s_nop 0
    s_cbranch_vccnz Lre_2
    buffer_load_dwordx4 v[84:87], v13, s[28:31], s54 offen offset:2048 sc1
    buffer_load_dwordx4 v[88:91], v13, s[28:31], s54 offen offset:3072 sc1
    buffer_load_dwordx4 v[92:95], v13, s[28:31], s55 offen offset:0 sc1
    buffer_load_dwordx4 v[96:99], v13, s[28:31], s55 offen offset:1024 sc1
    buffer_load_dwordx4 v[100:103], v13, s[28:31], s55 offen offset:2048 sc1
    buffer_load_dwordx4 v[104:107], v13, s[28:31], s55 offen offset:3072 sc1
    s_branch Lck_2
Lre_3:
    s_mov_b32 s41, 1
    s_sub_u32 s35, s35, 1
    s_cbranch_scc1 Lend
    s_sleep 2
    buffer_load_dwordx4 v[84:87], v13, s[28:31], s54 offen offset:2048 sc1
    buffer_load_dwordx4 v[88:91], v13, s[28:31], s54 offen offset:3072 sc1
    s_waitcnt vmcnt(0)
    v_max3_u32 v4, v84, v85, v86
    v_max3_u32 v5, v88, v89, v90
    v_max3_u32 v4, v4, v87, v91
    v_max_u32 v4, v4, v5
    v_cmp_eq_u32 vcc, -1, v4
    s_nop 0
    s_cbranch_vccnz Lre_3
    buffer_load_dwordx4 v[92:95], v13, s[28:31], s55 offen offset:0 sc1
    buffer_load_dwordx4 v[96:99], v13, s[28:31], s55 offen offset:1024 sc1
    buffer_load_dwordx4 v[100:103], v13, s[28:31], s55 offen offset:2048 sc1
    buffer_load_dwordx4 v[104:107], v13, s[28:31], s55 offen offset:3072 sc1
    buffer_load_dwordx4 v[60:63], v13, s[28:31], s56 offen offset:0 sc1
    buffer_load_dwordx4 v[64:67], v13, s[28:31], s56 offen offset:1024 sc1
    s_branch Lck_3
Lre_4:
    s_mov_b32 s41, 1
    s_sub_u32 s35, s35, 1
    s_cbranch_scc1 Lend
    s_sleep 2
    buffer_load_dwordx4 v[92:95], v13, s[28:31], s55 offen offset:0 sc1
    buffer_load_dwordx4 v[96:99], v13, s[28:31], s55 offen offset:1024 sc1
    s_waitcnt vmcnt(0)
    v_max3_u32 v4, v92, v93, v94
    v_max3_u32 v5, v96, v97, v98
    v_max3_u32 v4, v4, v95, v99
    v_max_u32 v4, v4, v5
    v_cmp_eq_u32 vcc, -1, v4
    s_nop 0
    s_cbranch_vccnz Lre_4
    buffer_load_dwordx4 v[100:103], v13, s[28:31], s55 offen offset:2048 sc1
    buffer_load_dwordx4 v[104:107], v13, s[28:31], s55 offen offset:3072 sc1
    buffer_load_dwordx4 v[60:63], v13, s[28:31], s56 offen offset:0 sc1
    buffer_load_dwordx4 v[64:67], v13, s[28:31], s56 offen offset:1024 sc1
    buffer_load_dwordx4 v[68:71], v13, s[28:31], s56 offen offset:2048 sc1
    buffer_load_dwordx4 v[72:75], v13, s[28:31], s56 offen offset:3072 sc1
    s_branch Lck_4
Lre_5:
    s_mov_b32 s41, 1
    s_sub_u32 s35, s35, 1
    s_cbranch_scc1 Lend
    s_sleep 2
    buffer_load_dwordx4 v[100:103], v13, s[28:31], s55 offen offset:2048 sc1
    buffer_load_dwordx4 v[104:107], v13, s[28:31], s55 offen offset:3072 sc1
    s_waitcnt vmcnt(0)
    v_max3_u32 v4, v100, v101, v102
    v_max3_u32 v5, v104, v105, v106
    v_max3_u32 v4, v4, v103, v107
    v_max_u32 v4, v4, v5
    v_cmp_eq_u32 vcc, -1, v4
    s_nop 0
    s_cbranch_vccnz Lre_5
    buffer_load_dwordx4 v[60:63], v13, s[28:31], s56 offen offset:0 sc1
    buffer_load_dwordx4 v[64:67], v13, s[28:31], s56 offen offset:1024 sc1
    buffer_load_dwordx4 v[68:71], v13, s[28:31], s56 offen offset:2048 sc1
    buffer_load_dwordx4 v[72:75], v13, s[28:31], s56 offen offset:3072 sc1
    buffer_load_dwordx4 v[76:79], v13, s[28:31], s57 offen offset:0 sc1
    buffer_load_dwordx4 v[80:83], v13, s[28:31], s57 offen offset:1024 sc1
    s_branch Lck_5
Lre_6:
    s_mov_b32 s41, 1
    s_sub_u32 s35, s35, 1
    s_cbranch_scc1 Lend
    s_sleep 2
    buffer_load_dwordx4 v[60:63], v13, s[28:31], s56 offen offset:0 sc1
    buffer_load_dwordx4 v[64:67], v13, s[28:31], s56 offen offset:1024 sc1
    s_waitcnt vmcnt(0)
    v_max3_u32 v4, v60, v61, v62
    v_max3_u32 v5, v64, v65, v66
    v_max3_u32 v4, v4, v63, v67
    v_max_u32 v4, v4, v5
    v_cmp_eq_u32 vcc, -1, v4
    s_nop 0
    s_cbranch_vccnz Lre_6
    buffer_load_dwordx4 v[68:71], v13, s[28:31], s56 offen offset:2048 sc1
    buffer_load_dwordx4 v[72:75], v13, s[28:31], s56 offen offset:3072 sc1
    buffer_load_dwordx4 v[76:79], v13, s[28:31], s57 offen offset:0 sc1
    buffer_load_dwordx4 v[80:83], v13, s[28:31], s57 offen offset:1024 sc1
    buffer_load_dwordx4 v[84:87], v13, s[28:31], s57 offen offset:2048 sc1
    buffer_load_dwordx4 v[88:91], v13, s[28:31], s57 offen offset:3072 sc1
    s_branch Lck_6
Lre_7:
    s_mov_b32 s41, 1
    s_sub_u32 s35, s35, 1
    s_cbranch_scc1 Lend
    s_sleep 2
    buffer_load_dwordx4 v[68:71], v13, s[28:31], s56 offen offset:2048 sc1
    buffer_load_dwordx4 v[72:75], v13, s[28:31], s56 offen offset:3072 sc1
    s_waitcnt vmcnt(0)
    v_max3_u32 v4, v68, v69, v70
    v_max3_u32 v5, v72, v73, v74
    v_max3_u32 v4, v4, v71, v75
    v_max_u32 v4, v4, v5
    v_cmp_eq_u32 vcc, -1, v4
    s_nop 0
    s_cbranch_vccnz Lre_7
    buffer_load_dwordx4 v[76:79], v13, s[28:31], s57 offen offset:0 sc1
    buffer_load_dwordx4 v[80:83], v13, s[28:31], s57 offen offset:1024 sc1
    buffer_load_dwordx4 v[84:87], v13, s[28:31], s57 offen offset:2048 sc1
    buffer_load_dwordx4 v[88:91], v13, s[28:31], s57 offen offset:3072 sc1
    s_branch Lck_7
Lre_8:
    s_mov_b32 s41, 1
    s_sub_u32 s35, s35, 1
    s_cbranch_scc1 Lend
    s_sleep 2
    buffer_load_dwordx4 v[76:79], v13, s[28:31], s57 offen offset:0 sc1
    buffer_load_dwordx4 v[80:83], v13, s[28:31], s57 offen offset:1024 sc1
    s_waitcnt vmcnt(0)
    v_max3_u32 v4, v76, v77, v78
    v_max3_u32 v5, v80, v81, v82
    v_max3_u32 v4, v4, v79, v83
    v_max_u32 v4, v4, v5
    v_cmp_eq_u32 vcc, -1, v4
    s_nop 0
    s_cbranch_vccnz Lre_8
    buffer_load_dwordx4 v[84:87], v13, s[28:31], s57 offen offset:2048 sc1
    buffer_load_dwordx4 v[88:91], v13, s[28:31], s57 offen offset:3072 sc1
    s_branch Lck_8
Lre_9:
    s_mov_b32 s41, 1
    s_sub_u32 s35, s35, 1
    s_cbranch_scc1 Lend
    s_sleep 2
    buffer_load_dwordx4 v[84:87], v13, s[28:31], s57 offen offset:2048 sc1
    buffer_load_dwordx4 v[88:91], v13, s[28:31], s57 offen offset:3072 sc1
    s_waitcnt vmcnt(0)
    v_max3_u32 v4, v84, v85, v86
    v_max3_u32 v5, v88, v89, v90
    v_max3_u32 v4, v4, v87, v91
    v_max_u32 v4, v4, v5
    v_cmp_eq_u32 vcc, -1, v4
    s_nop 0
    s_cbranch_vccnz Lre_9
    s_branch Lck_9
Lfix:
    s_mov_b64 vcc, s[38:39]
    v_lshlrev_b32 v6, 4, v2
    v_add_u32 v6, 158208, v6
    v_mov_b32 v10, 157956
Lcw_5:
    s_sub_u32 s35, s35, 1
    s_cbranch_scc1 Lend
    ds_read_b32 v11, v10
    s_waitcnt lgkmcnt(0)
    v_readfirstlane_b32 s38, v11
    s_nop 0
    s_cmp_lt_u32 s38, 1
    s_cbranch_scc1 Lcw_5
    s_mov_b64 exec, s[36:37]
    ds_read_b128 v[44:47], v6 offset:0
    ds_read_b128 v[48:51], v6 offset:64
    ds_read_b128 v[52:55], v6 offset:128
    ds_read_b128 v[56:59], v6 offset:192
    s_mov_b64 exec, vcc
    ds_read_b128 v[44:47], v6 offset:256
    ds_read_b128 v[48:51], v6 offset:320
    ds_read_b128 v[52:55], v6 offset:384
    ds_read_b128 v[56:59], v6 offset:448
    s_mov_b64 exec, -1
    s_waitcnt lgkmcnt(0)
    s_branch Lnofix
Lhalo:
    s_mov_b32 vcc_lo, 0x00010001
    s_mov_b32 vcc_hi, 0x00010001
    v_mov_b32 v11, 38912
    v_cndmask_b32 v76, v76, v11, vcc
    v_xor_b32 v77, 64, v76
    v_add_u32 v80, 78080, v76
    v_add_u32 v81, 78080, v77
    v_mov_b32 v14, 0x3f803f80
    v_mov_b32 v15, 0x3f803f80
    v_mov_b32 v16, 0x3f803f80
    v_mov_b32 v17, 0x3f803f80
    v_and_b32 v4, 7, v1
    v_lshlrev_b32 v4, 4, v4
    v_mul_u32_u24 v5, 39040, v2
    v_add_u32 v4, v4, v5
    ds_write_b128 v4, v[14:17] offset:38912
    v_mov_b32 v4, 157952
    v_mov_b32 v8, 0
    v_mov_b32 v9, 0
    v_mov_b32 v10, -2
    v_mov_b32 v11, -2
    ds_write_b128 v4, v[8:11]
    v_min_u32 v5, 23, v1
    v_lshl_add_u32 v5, v5, 2, v4
    ds_write_b32 v5, v8 offset:16
    s_mul_i32 s36, s32, 96
    s_sub_u32 s36, s36, 16
    v_add_u32 v96, s36, v1
    v_min_u32 v5, 47, v1
    v_add3_u32 v97, s36, v5, 64
    v_mov_b32 v6, 2047
    v_med3_i32 v96, v96, 0, v6
    v_med3_i32 v97, v97, 0, v6
    v_lshlrev_b32 v96, 3, v96
    v_lshlrev_b32 v97, 3, v97
    s_mov_b32 s46, 8192000
    v_mov_b32 v127, 157984
    s_lshl_b32 s36, s3, 2
    s_add_u32 s36, s36, 158016
    v_mov_b32 v10, s36
    s_mov_b32 vcc_lo, 0x00010001
    s_mov_b32 vcc_hi, 0x00010001
    v_cndmask_b32 v116, 0, v14, vcc
    v_cndmask_b32 v117, 0, v15, vcc
    v_cndmask_b32 v118, 0, v16, vcc
    v_cndmask_b32 v119, 0, v17, vcc
    s_waitcnt vmcnt(0)
    s_waitcnt lgkmcnt(0)
    s_barrier
    s_add_u32 s34, s34, 0x9e3779b8
    s_or_b32 s34, s34, 1
    ds_read_b128 v[108:111], v76 offset:0
    ds_read_b128 v[112:115], v77 offset:0
    ds_read_b64_tr_b16 a[0:1], v20 offset:0
    ds_read_b64_tr_b16 a[2:3], v20 offset:512
    ds_read_b64_tr_b16 a[4:5], v21 offset:0
    ds_read_b64_tr_b16 a[6:7], v21 offset:512
    ds_read_b64_tr_b16 a[8:9], v22 offset:0
    ds_read_b64_tr_b16 a[10:11], v22 offset:512
    ds_read_b64_tr_b16 a[12:13], v23 offset:0
    ds_read_b64_tr_b16 a[14:15], v23 offset:512
    ds_read_b64_tr_b16 a[16:17], v20 offset:8192
    ds_read_b64_tr_b16 a[18:19], v20 offset:8704
    ds_read_b64_tr_b16 a[20:21], v21 offset:8192
    ds_read_b64_tr_b16 a[22:23], v21 offset:8704
    ds_read_b64_tr_b16 a[24:25], v22 offset:8192
    ds_read_b64_tr_b16 a[26:27], v22 offset:8704
    s_waitcnt lgkmcnt(12)
    v_mfma_f32_16x16x32_bf16 v[28:31], a[0:3], v[116:119], 0
    ds_read_b64_tr_b16 a[28:29], v23 offset:8192
    ds_read_b64_tr_b16 a[30:31], v23 offset:8704
    s_waitcnt lgkmcnt(12)
    v_mfma_f32_16x16x32_bf16 v[32:35], a[4:7], v[116:119], 0
    ds_read_b64_tr_b16 a[32:33], v20 offset:16384
    ds_read_b64_tr_b16 a[34:35], v20 offset:16896
    s_waitcnt lgkmcnt(12)
    v_mfma_f32_16x16x32_bf16 v[36:39], a[8:11], v[116:119], 0
    ds_read_b64_tr_b16 a[36:37], v21 offset:16384
    ds_read_b64_tr_b16 a[38:39], v21 offset:16896
    s_waitcnt lgkmcnt(12)
    v_mfma_f32_16x16x32_bf16 v[40:43], a[12:15], v[116:119], 0
    ds_read_b64_tr_b16 a[40:41], v22 offset:16384
    ds_read_b64_tr_b16 a[42:43], v22 offset:16896
    s_waitcnt lgkmcnt(12)
    v_mfma_f32_16x16x32_bf16 v[44:47], a[16:19], v[108:111], 0
    ds_read_b64_tr_b16 a[44:45], v23 offset:16384
    ds_read_b64_tr_b16 a[46:47], v23 offset:16896
    s_waitcnt lgkmcnt(12)
    v_mfma_f32_16x16x32_bf16 v[48:51], a[20:23], v[108:111], 0
    ds_read_b64_tr_b16 a[48:49], v20 offset:4096
    ds_read_b64_tr_b16 a[50:51], v20 offset:4608
    s_waitcnt lgkmcnt(12)
    v_mfma_f32_16x16x32_bf16 v[52:55], a[24:27], v[108:111], 0
    ds_read_b64_tr_b16 a[52:53], v21 offset:4096
    ds_read_b64_tr_b16 a[54:55], v21 offset:4608
    s_waitcnt lgkmcnt(12)
    v_mfma_f32_16x16x32_bf16 v[56:59], a[28:31], v[108:111], 0
    ds_read_b64_tr_b16 a[56:57], v22 offset:4096
    ds_read_b64_tr_b16 a[58:59], v22 offset:4608
    s_waitcnt lgkmcnt(12)
    v_mfma_f32_16x16x32_bf16 v[60:63], v[108:111], a[32:35], 0
    ds_read_b64_tr_b16 a[60:61], v23 offset:4096
    ds_read_b64_tr_b16 a[62:63], v23 offset:4608
    s_waitcnt lgkmcnt(12)
    v_mfma_f32_16x16x32_bf16 v[64:67], v[108:111], a[36:39], 0
    ds_read_b64_tr_b16 a[64:65], v20 offset:12288
    ds_read_b64_tr_b16 a[66:67], v20 offset:12800
    s_waitcnt lgkmcnt(12)
    v_mfma_f32_16x16x32_bf16 v[68:71], v[108:111], a[40:43], 0
    ds_read_b64_tr_b16 a[68:69], v21 offset:12288
    ds_read_b64_tr_b16 a[70:71], v21 offset:12800
    s_waitcnt lgkmcnt(12)
    v_mfma_f32_16x16x32_bf16 v[72:75], v[108:111], a[44:47], 0
    ds_read_b64_tr_b16 a[72:73], v22 offset:12288
    ds_read_b64_tr_b16 a[74:75], v22 offset:12800
    s_waitcnt lgkmcnt(12)
    v_mfma_f32_16x16x32_bf16 v[28:31], a[48:51], v[116:119], v[28:31]
    ds_read_b64_tr_b16 a[76:77], v23 offset:12288
    ds_read_b64_tr_b16 a[78:79], v23 offset:12800
    s_waitcnt lgkmcnt(12)
    v_mfma_f32_16x16x32_bf16 v[32:35], a[52:55], v[116:119], v[32:35]
    ds_read_b64_tr_b16 a[80:81], v20 offset:20480
    ds_read_b64_tr_b16 a[82:83], v20 offset:20992
    s_waitcnt lgkmcnt(12)
    v_mfma_f32_16x16x32_bf16 v[36:39], a[56:59], v[116:119], v[36:39]
    ds_read_b64_tr_b16 a[84:85], v21 offset:20480
    ds_read_b64_tr_b16 a[86:87], v21 offset:20992
    s_waitcnt lgkmcnt(12)
    v_mfma_f32_16x16x32_bf16 v[40:43], a[60:63], v[116:119], v[40:43]
    ds_read_b64_tr_b16 a[88:89], v22 offset:20480
    ds_read_b64_tr_b16 a[90:91], v22 offset:20992
    s_waitcnt lgkmcnt(12)
    v_mfma_f32_16x16x32_bf16 v[44:47], a[64:67], v[112:115], v[44:47]
    ds_read_b64_tr_b16 a[92:93], v23 offset:20480
    ds_read_b64_tr_b16 a[94:95], v23 offset:20992
    s_waitcnt lgkmcnt(12)
    v_mfma_f32_16x16x32_bf16 v[48:51], a[68:71], v[112:115], v[48:51]
    s_waitcnt lgkmcnt(10)
    v_mfma_f32_16x16x32_bf16 v[52:55], a[72:75], v[112:115], v[52:55]
    s_waitcnt lgkmcnt(8)
    v_mfma_f32_16x16x32_bf16 v[56:59], a[76:79], v[112:115], v[56:59]
    s_waitcnt lgkmcnt(6)
    v_mfma_f32_16x16x32_bf16 v[60:63], v[112:115], a[80:83], v[60:63]
    s_waitcnt lgkmcnt(4)
    v_mfma_f32_16x16x32_bf16 v[64:67], v[112:115], a[84:87], v[64:67]
    s_waitcnt lgkmcnt(2)
    v_mfma_f32_16x16x32_bf16 v[68:71], v[112:115], a[88:91], v[68:71]
    s_waitcnt lgkmcnt(0)
    v_mfma_f32_16x16x32_bf16 v[72:75], v[112:115], a[92:95], v[72:75]
    s_barrier
    ds_read_b128 v[108:111], v76 offset:39040
    ds_read_b128 v[112:115], v77 offset:39040
    ds_read_b64_tr_b16 a[0:1], v20 offset:39040
    ds_read_b64_tr_b16 a[2:3], v20 offset:39552
    ds_read_b64_tr_b16 a[4:5], v21 offset:39040
    ds_read_b64_tr_b16 a[6:7], v21 offset:39552
    ds_read_b64_tr_b16 a[8:9], v22 offset:39040
    ds_read_b64_tr_b16 a[10:11], v22 offset:39552
    ds_read_b64_tr_b16 a[12:13], v23 offset:39040
    ds_read_b64_tr_b16 a[14:15], v23 offset:39552
    ds_read_b64_tr_b16 a[16:17], v20 offset:47232
    ds_read_b64_tr_b16 a[18:19], v20 offset:47744
    ds_read_b64_tr_b16 a[20:21], v21 offset:47232
    ds_read_b64_tr_b16 a[22:23], v21 offset:47744
    ds_read_b64_tr_b16 a[24:25], v22 offset:47232
    ds_read_b64_tr_b16 a[26:27], v22 offset:47744
    s_waitcnt lgkmcnt(12)
    v_mfma_f32_16x16x32_bf16 v[28:31], a[0:3], v[116:119], v[28:31]
    ds_read_b64_tr_b16 a[28:29], v23 offset:47232
    ds_read_b64_tr_b16 a[30:31], v23 offset:47744
    s_waitcnt lgkmcnt(12)
    v_mfma_f32_16x16x32_bf16 v[32:35], a[4:7], v[116:119], v[32:35]
    ds_read_b64_tr_b16 a[32:33], v20 offset:55424
    ds_read_b64_tr_b16 a[34:35], v20 offset:55936
    s_waitcnt lgkmcnt(12)
    v_mfma_f32_16x16x32_bf16 v[36:39], a[8:11], v[116:119], v[36:39]
    ds_read_b64_tr_b16 a[36:37], v21 offset:55424
    ds_read_b64_tr_b16 a[38:39], v21 offset:55936
    s_waitcnt lgkmcnt(12)
    v_mfma_f32_16x16x32_bf16 v[40:43], a[12:15], v[116:119], v[40:43]
    ds_read_b64_tr_b16 a[40:41], v22 offset:55424
    ds_read_b64_tr_b16 a[42:43], v22 offset:55936
    s_waitcnt lgkmcnt(12)
    v_mfma_f32_16x16x32_bf16 v[44:47], a[16:19], v[108:111], v[44:47]
    ds_read_b64_tr_b16 a[44:45], v23 offset:55424
    ds_read_b64_tr_b16 a[46:47], v23 offset:55936
    s_waitcnt lgkmcnt(12)
    v_mfma_f32_16x16x32_bf16 v[48:51], a[20:23], v[108:111], v[48:51]
    ds_read_b64_tr_b16 a[48:49], v20 offset:43136
    ds_read_b64_tr_b16 a[50:51], v20 offset:43648
    s_waitcnt lgkmcnt(12)
    v_mfma_f32_16x16x32_bf16 v[52:55], a[24:27], v[108:111], v[52:55]
    ds_read_b64_tr_b16 a[52:53], v21 offset:43136
    ds_read_b64_tr_b16 a[54:55], v21 offset:43648
    s_waitcnt lgkmcnt(12)
    v_mfma_f32_16x16x32_bf16 v[56:59], a[28:31], v[108:111], v[56:59]
    ds_read_b64_tr_b16 a[56:57], v22 offset:43136
    ds_read_b64_tr_b16 a[58:59], v22 offset:43648
    s_waitcnt lgkmcnt(12)
    v_mfma_f32_16x16x32_bf16 v[60:63], v[108:111], a[32:35], v[60:63]
    ds_read_b64_tr_b16 a[60:61], v23 offset:43136
    ds_read_b64_tr_b16 a[62:63], v23 offset:43648
    s_waitcnt lgkmcnt(12)
    v_mfma_f32_16x16x32_bf16 v[64:67], v[108:111], a[36:39], v[64:67]
    ds_read_b64_tr_b16 a[64:65], v20 offset:51328
    ds_read_b64_tr_b16 a[66:67], v20 offset:51840
    s_waitcnt lgkmcnt(12)
    v_mfma_f32_16x16x32_bf16 v[68:71], v[108:111], a[40:43], v[68:71]
    ds_read_b64_tr_b16 a[68:69], v21 offset:51328
    ds_read_b64_tr_b16 a[70:71], v21 offset:51840
    s_waitcnt lgkmcnt(12)
    v_mfma_f32_16x16x32_bf16 v[72:75], v[108:111], a[44:47], v[72:75]
    ds_read_b64_tr_b16 a[72:73], v22 offset:51328
    ds_read_b64_tr_b16 a[74:75], v22 offset:51840
    s_waitcnt lgkmcnt(12)
    v_mfma_f32_16x16x32_bf16 v[28:31], a[48:51], v[116:119], v[28:31]
    ds_read_b64_tr_b16 a[76:77], v23 offset:51328
    ds_read_b64_tr_b16 a[78:79], v23 offset:51840
    s_waitcnt lgkmcnt(12)
    v_mfma_f32_16x16x32_bf16 v[32:35], a[52:55], v[116:119], v[32:35]
    ds_read_b64_tr_b16 a[80:81], v20 offset:59520
    ds_read_b64_tr_b16 a[82:83], v20 offset:60032
    s_waitcnt lgkmcnt(12)
    v_mfma_f32_16x16x32_bf16 v[36:39], a[56:59], v[116:119], v[36:39]
    ds_read_b64_tr_b16 a[84:85], v21 offset:59520
    ds_read_b64_tr_b16 a[86:87], v21 offset:60032
    s_waitcnt lgkmcnt(12)
    v_mfma_f32_16x16x32_bf16 v[40:43], a[60:63], v[116:119], v[40:43]
    ds_read_b64_tr_b16 a[88:89], v22 offset:59520
    ds_read_b64_tr_b16 a[90:91], v22 offset:60032
    s_waitcnt lgkmcnt(12)
    v_mfma_f32_16x16x32_bf16 v[44:47], a[64:67], v[112:115], v[44:47]
    ds_read_b64_tr_b16 a[92:93], v23 offset:59520
    ds_read_b64_tr_b16 a[94:95], v23 offset:60032
    s_waitcnt lgkmcnt(12)
    v_mfma_f32_16x16x32_bf16 v[48:51], a[68:71], v[112:115], v[48:51]
    s_waitcnt lgkmcnt(10)
    v_mfma_f32_16x16x32_bf16 v[52:55], a[72:75], v[112:115], v[52:55]
    s_waitcnt lgkmcnt(8)
    v_mfma_f32_16x16x32_bf16 v[56:59], a[76:79], v[112:115], v[56:59]
    s_waitcnt lgkmcnt(6)
    v_mfma_f32_16x16x32_bf16 v[60:63], v[112:115], a[80:83], v[60:63]
    s_waitcnt lgkmcnt(4)
    v_mfma_f32_16x16x32_bf16 v[64:67], v[112:115], a[84:87], v[64:67]
    s_waitcnt lgkmcnt(2)
    v_mfma_f32_16x16x32_bf16 v[68:71], v[112:115], a[88:91], v[68:71]
    s_waitcnt lgkmcnt(0)
    v_mfma_f32_16x16x32_bf16 v[72:75], v[112:115], a[92:95], v[72:75]
    s_mov_b64 exec, 1
    s_lshl_b32 s36, s2, 2
    s_add_u32 s36, s36, 8323072
    v_mov_b32 v4, s34
    v_mov_b32 v5, s36
    buffer_store_dword v4, v5, s[28:31], 0 offen sc1
    s_mov_b64 exec, -1
    s_barrier
    ds_read_b128 v[108:111], v80 offset:0
    ds_read_b128 v[112:115], v81 offset:0
    ds_read_b64_tr_b16 a[0:1], v24 offset:0
    ds_read_b64_tr_b16 a[2:3], v24 offset:512
    ds_read_b64_tr_b16 a[4:5], v25 offset:0
    ds_read_b64_tr_b16 a[6:7], v25 offset:512
    ds_read_b64_tr_b16 a[8:9], v26 offset:0
    ds_read_b64_tr_b16 a[10:11], v26 offset:512
    ds_read_b64_tr_b16 a[12:13], v27 offset:0
    ds_read_b64_tr_b16 a[14:15], v27 offset:512
    ds_read_b64_tr_b16 a[16:17], v24 offset:8192
    ds_read_b64_tr_b16 a[18:19], v24 offset:8704
    ds_read_b64_tr_b16 a[20:21], v25 offset:8192
    ds_read_b64_tr_b16 a[22:23], v25 offset:8704
    ds_read_b64_tr_b16 a[24:25], v26 offset:8192
    ds_read_b64_tr_b16 a[26:27], v26 offset:8704
    s_waitcnt lgkmcnt(12)
    v_mfma_f32_16x16x32_bf16 v[28:31], a[0:3], v[116:119], v[28:31]
    ds_read_b64_tr_b16 a[28:29], v27 offset:8192
    ds_read_b64_tr_b16 a[30:31], v27 offset:8704
    s_waitcnt lgkmcnt(12)
    v_mfma_f32_16x16x32_bf16 v[32:35], a[4:7], v[116:119], v[32:35]
    ds_read_b64_tr_b16 a[32:33], v24 offset:16384
    ds_read_b64_tr_b16 a[34:35], v24 offset:16896
    s_waitcnt lgkmcnt(12)
    v_mfma_f32_16x16x32_bf16 v[36:39], a[8:11], v[116:119], v[36:39]
    ds_read_b64_tr_b16 a[36:37], v25 offset:16384
    ds_read_b64_tr_b16 a[38:39], v25 offset:16896
    s_waitcnt lgkmcnt(12)
    v_mfma_f32_16x16x32_bf16 v[40:43], a[12:15], v[116:119], v[40:43]
    ds_read_b64_tr_b16 a[40:41], v26 offset:16384
    ds_read_b64_tr_b16 a[42:43], v26 offset:16896
    s_waitcnt lgkmcnt(12)
    v_mfma_f32_16x16x32_bf16 v[44:47], a[16:19], v[108:111], v[44:47]
    ds_read_b64_tr_b16 a[44:45], v27 offset:16384
    ds_read_b64_tr_b16 a[46:47], v27 offset:16896
    s_waitcnt lgkmcnt(12)
    v_mfma_f32_16x16x32_bf16 v[48:51], a[20:23], v[108:111], v[48:51]
    ds_read_b64_tr_b16 a[48:49], v24 offset:4096
    ds_read_b64_tr_b16 a[50:51], v24 offset:4608
    s_waitcnt lgkmcnt(12)
    v_mfma_f32_16x16x32_bf16 v[52:55], a[24:27], v[108:111], v[52:55]
    ds_read_b64_tr_b16 a[52:53], v25 offset:4096
    ds_read_b64_tr_b16 a[54:55], v25 offset:4608
    s_waitcnt lgkmcnt(12)
    v_mfma_f32_16x16x32_bf16 v[56:59], a[28:31], v[108:111], v[56:59]
    ds_read_b64_tr_b16 a[56:57], v26 offset:4096
    ds_read_b64_tr_b16 a[58:59], v26 offset:4608
    s_waitcnt lgkmcnt(12)
    v_mfma_f32_16x16x32_bf16 v[60:63], v[108:111], a[32:35], v[60:63]
    ds_read_b64_tr_b16 a[60:61], v27 offset:4096
    ds_read_b64_tr_b16 a[62:63], v27 offset:4608
    s_waitcnt lgkmcnt(12)
    v_mfma_f32_16x16x32_bf16 v[64:67], v[108:111], a[36:39], v[64:67]
    ds_read_b64_tr_b16 a[64:65], v24 offset:12288
    ds_read_b64_tr_b16 a[66:67], v24 offset:12800
    s_waitcnt lgkmcnt(12)
    v_mfma_f32_16x16x32_bf16 v[68:71], v[108:111], a[40:43], v[68:71]
    ds_read_b64_tr_b16 a[68:69], v25 offset:12288
    ds_read_b64_tr_b16 a[70:71], v25 offset:12800
    s_waitcnt lgkmcnt(12)
    v_mfma_f32_16x16x32_bf16 v[72:75], v[108:111], a[44:47], v[72:75]
    ds_read_b64_tr_b16 a[72:73], v26 offset:12288
    ds_read_b64_tr_b16 a[74:75], v26 offset:12800
    s_waitcnt lgkmcnt(12)
    v_mfma_f32_16x16x32_bf16 v[28:31], a[48:51], v[116:119], v[28:31]
    ds_read_b64_tr_b16 a[76:77], v27 offset:12288
    ds_read_b64_tr_b16 a[78:79], v27 offset:12800
    s_waitcnt lgkmcnt(12)
    v_mfma_f32_16x16x32_bf16 v[32:35], a[52:55], v[116:119], v[32:35]
    ds_read_b64_tr_b16 a[80:81], v24 offset:20480
    ds_read_b64_tr_b16 a[82:83], v24 offset:20992
    s_waitcnt lgkmcnt(12)
    v_mfma_f32_16x16x32_bf16 v[36:39], a[56:59], v[116:119], v[36:39]
    ds_read_b64_tr_b16 a[84:85], v25 offset:20480
    ds_read_b64_tr_b16 a[86:87], v25 offset:20992
    s_waitcnt lgkmcnt(12)
    v_mfma_f32_16x16x32_bf16 v[40:43], a[60:63], v[116:119], v[40:43]
    ds_read_b64_tr_b16 a[88:89], v26 offset:20480
    ds_read_b64_tr_b16 a[90:91], v26 offset:20992
    s_waitcnt lgkmcnt(12)
    v_mfma_f32_16x16x32_bf16 v[44:47], a[64:67], v[112:115], v[44:47]
    ds_read_b64_tr_b16 a[92:93], v27 offset:20480
    ds_read_b64_tr_b16 a[94:95], v27 offset:20992
    s_waitcnt lgkmcnt(12)
    v_mfma_f32_16x16x32_bf16 v[48:51], a[68:71], v[112:115], v[48:51]
    s_waitcnt lgkmcnt(10)
    v_mfma_f32_16x16x32_bf16 v[52:55], a[72:75], v[112:115], v[52:55]
    s_waitcnt lgkmcnt(8)
    v_mfma_f32_16x16x32_bf16 v[56:59], a[76:79], v[112:115], v[56:59]
    s_waitcnt lgkmcnt(6)
    v_mfma_f32_16x16x32_bf16 v[60:63], v[112:115], a[80:83], v[60:63]
    s_waitcnt lgkmcnt(4)
    v_mfma_f32_16x16x32_bf16 v[64:67], v[112:115], a[84:87], v[64:67]
    s_waitcnt lgkmcnt(2)
    v_mfma_f32_16x16x32_bf16 v[68:71], v[112:115], a[88:91], v[68:71]
    s_waitcnt lgkmcnt(0)
    v_mfma_f32_16x16x32_bf16 v[72:75], v[112:115], a[92:95], v[72:75]
    s_barrier
    ds_read_b128 v[108:111], v80 offset:39040
    ds_read_b128 v[112:115], v81 offset:39040
    ds_read_b64_tr_b16 a[0:1], v24 offset:39040
    ds_read_b64_tr_b16 a[2:3], v24 offset:39552
    ds_read_b64_tr_b16 a[4:5], v25 offset:39040
    ds_read_b64_tr_b16 a[6:7], v25 offset:39552
    ds_read_b64_tr_b16 a[8:9], v26 offset:39040
    ds_read_b64_tr_b16 a[10:11], v26 offset:39552
    ds_read_b64_tr_b16 a[12:13], v27 offset:39040
    ds_read_b64_tr_b16 a[14:15], v27 offset:39552
    ds_read_b64_tr_b16 a[16:17], v24 offset:47232
    ds_read_b64_tr_b16 a[18:19], v24 offset:47744
    ds_read_b64_tr_b16 a[20:21], v25 offset:47232
    ds_read_b64_tr_b16 a[22:23], v25 offset:47744
    ds_read_b64_tr_b16 a[24:25], v26 offset:47232
    ds_read_b64_tr_b16 a[26:27], v26 offset:47744
    s_waitcnt lgkmcnt(12)
    v_mfma_f32_16x16x32_bf16 v[28:31], a[0:3], v[116:119], v[28:31]
    ds_read_b64_tr_b16 a[28:29], v27 offset:47232
    ds_read_b64_tr_b16 a[30:31], v27 offset:47744
    s_waitcnt lgkmcnt(12)
    v_mfma_f32_16x16x32_bf16 v[32:35], a[4:7], v[116:119], v[32:35]
    ds_read_b64_tr_b16 a[32:33], v24 offset:55424
    ds_read_b64_tr_b16 a[34:35], v24 offset:55936
    s_waitcnt lgkmcnt(12)
    v_mfma_f32_16x16x32_bf16 v[36:39], a[8:11], v[116:119], v[36:39]
    ds_read_b64_tr_b16 a[36:37], v25 offset:55424
    ds_read_b64_tr_b16 a[38:39], v25 offset:55936
    s_waitcnt lgkmcnt(12)
    v_mfma_f32_16x16x32_bf16 v[40:43], a[12:15], v[116:119], v[40:43]
    ds_read_b64_tr_b16 a[40:41], v26 offset:55424
    ds_read_b64_tr_b16 a[42:43], v26 offset:55936
    s_waitcnt lgkmcnt(12)
    v_mfma_f32_16x16x32_bf16 v[44:47], a[16:19], v[108:111], v[44:47]
    ds_read_b64_tr_b16 a[44:45], v27 offset:55424
    ds_read_b64_tr_b16 a[46:47], v27 offset:55936
    s_waitcnt lgkmcnt(12)
    v_mfma_f32_16x16x32_bf16 v[48:51], a[20:23], v[108:111], v[48:51]
    ds_read_b64_tr_b16 a[48:49], v24 offset:43136
    ds_read_b64_tr_b16 a[50:51], v24 offset:43648
    s_waitcnt lgkmcnt(12)
    v_mfma_f32_16x16x32_bf16 v[52:55], a[24:27], v[108:111], v[52:55]
    ds_read_b64_tr_b16 a[52:53], v25 offset:43136
    ds_read_b64_tr_b16 a[54:55], v25 offset:43648
    s_waitcnt lgkmcnt(12)
    v_mfma_f32_16x16x32_bf16 v[56:59], a[28:31], v[108:111], v[56:59]
    ds_read_b64_tr_b16 a[56:57], v26 offset:43136
    ds_read_b64_tr_b16 a[58:59], v26 offset:43648
    s_waitcnt lgkmcnt(12)
    v_mfma_f32_16x16x32_bf16 v[60:63], v[108:111], a[32:35], v[60:63]
    ds_read_b64_tr_b16 a[60:61], v27 offset:43136
    ds_read_b64_tr_b16 a[62:63], v27 offset:43648
    s_waitcnt lgkmcnt(12)
    v_mfma_f32_16x16x32_bf16 v[64:67], v[108:111], a[36:39], v[64:67]
    ds_read_b64_tr_b16 a[64:65], v24 offset:51328
    ds_read_b64_tr_b16 a[66:67], v24 offset:51840
    s_waitcnt lgkmcnt(12)
    v_mfma_f32_16x16x32_bf16 v[68:71], v[108:111], a[40:43], v[68:71]
    ds_read_b64_tr_b16 a[68:69], v25 offset:51328
    ds_read_b64_tr_b16 a[70:71], v25 offset:51840
    s_waitcnt lgkmcnt(12)
    v_mfma_f32_16x16x32_bf16 v[72:75], v[108:111], a[44:47], v[72:75]
    ds_read_b64_tr_b16 a[72:73], v26 offset:51328
    ds_read_b64_tr_b16 a[74:75], v26 offset:51840
    s_waitcnt lgkmcnt(12)
    v_mfma_f32_16x16x32_bf16 v[28:31], a[48:51], v[116:119], v[28:31]
    ds_read_b64_tr_b16 a[76:77], v27 offset:51328
    ds_read_b64_tr_b16 a[78:79], v27 offset:51840
    s_waitcnt lgkmcnt(12)
    v_mfma_f32_16x16x32_bf16 v[32:35], a[52:55], v[116:119], v[32:35]
    ds_read_b64_tr_b16 a[80:81], v24 offset:59520
    ds_read_b64_tr_b16 a[82:83], v24 offset:60032
    s_waitcnt lgkmcnt(12)
    v_mfma_f32_16x16x32_bf16 v[36:39], a[56:59], v[116:119], v[36:39]
    ds_read_b64_tr_b16 a[84:85], v25 offset:59520
    ds_read_b64_tr_b16 a[86:87], v25 offset:60032
    s_waitcnt lgkmcnt(12)
    v_mfma_f32_16x16x32_bf16 v[40:43], a[60:63], v[116:119], v[40:43]
    ds_read_b64_tr_b16 a[88:89], v26 offset:59520
    ds_read_b64_tr_b16 a[90:91], v26 offset:60032
    s_waitcnt lgkmcnt(12)
    v_mfma_f32_16x16x32_bf16 v[44:47], a[64:67], v[112:115], v[44:47]
    ds_read_b64_tr_b16 a[92:93], v27 offset:59520
    ds_read_b64_tr_b16 a[94:95], v27 offset:60032
    s_waitcnt lgkmcnt(12)
    v_mfma_f32_16x16x32_bf16 v[48:51], a[68:71], v[112:115], v[48:51]
    s_waitcnt lgkmcnt(10)
    v_mfma_f32_16x16x32_bf16 v[52:55], a[72:75], v[112:115], v[52:55]
    s_waitcnt lgkmcnt(8)
    v_mfma_f32_16x16x32_bf16 v[56:59], a[76:79], v[112:115], v[56:59]
    s_waitcnt lgkmcnt(6)
    v_mfma_f32_16x16x32_bf16 v[60:63], v[112:115], a[80:83], v[60:63]
    s_waitcnt lgkmcnt(4)
    v_mfma_f32_16x16x32_bf16 v[64:67], v[112:115], a[84:87], v[64:67]
    s_waitcnt lgkmcnt(2)
    v_mfma_f32_16x16x32_bf16 v[68:71], v[112:115], a[88:91], v[68:71]
    s_waitcnt lgkmcnt(0)
    v_mfma_f32_16x16x32_bf16 v[72:75], v[112:115], a[92:95], v[72:75]
    v_add_u32 v4, 156224, v12
    v_min_u32 v5, 47, v1
    v_lshlrev_b32 v5, 2, v5
    v_add_u32 v5, 156480, v5
    v_lshlrev_b32 v6, 4, v2
    v_add_u32 v6, 157184, v6
    v_mov_b32 v7, 157968
    v_lshlrev_b32 v11, 2, v3
    v_add_u32 v11, 156224, v11
    s_barrier
    ds_read_b128 v[108:111], v76 offset:0
    ds_read_b128 v[112:115], v77 offset:0
    ds_read_b64_tr_b16 a[0:1], v20 offset:0
    ds_read_b64_tr_b16 a[2:3], v20 offset:512
    ds_read_b64_tr_b16 a[4:5], v21 offset:0
    ds_read_b64_tr_b16 a[6:7], v21 offset:512
    ds_read_b64_tr_b16 a[8:9], v22 offset:0
    ds_read_b64_tr_b16 a[10:11], v22 offset:512
    ds_read_b64_tr_b16 a[12:13], v23 offset:0
    ds_read_b64_tr_b16 a[14:15], v23 offset:512
    ds_read_b64_tr_b16 a[16:17], v20 offset:8192
    ds_read_b64_tr_b16 a[18:19], v20 offset:8704
    ds_read_b64_tr_b16 a[20:21], v21 offset:8192
    ds_read_b64_tr_b16 a[22:23], v21 offset:8704
    ds_read_b64_tr_b16 a[24:25], v22 offset:8192
    ds_read_b64_tr_b16 a[26:27], v22 offset:8704
    s_waitcnt lgkmcnt(12)
    v_mfma_f32_16x16x32_bf16 v[28:31], a[0:3], v[116:119], v[28:31]
    ds_read_b64_tr_b16 a[28:29], v23 offset:8192
    ds_read_b64_tr_b16 a[30:31], v23 offset:8704
    s_waitcnt lgkmcnt(12)
    v_mfma_f32_16x16x32_bf16 v[32:35], a[4:7], v[116:119], v[32:35]
    ds_read_b64_tr_b16 a[32:33], v20 offset:16384
    ds_read_b64_tr_b16 a[34:35], v20 offset:16896
    s_waitcnt lgkmcnt(12)
    v_mfma_f32_16x16x32_bf16 v[36:39], a[8:11], v[116:119], v[36:39]
    ds_read_b64_tr_b16 a[36:37], v21 offset:16384
    ds_read_b64_tr_b16 a[38:39], v21 offset:16896
    s_waitcnt lgkmcnt(12)
    v_mfma_f32_16x16x32_bf16 v[40:43], a[12:15], v[116:119], v[40:43]
    ds_read_b64_tr_b16 a[40:41], v22 offset:16384
    ds_read_b64_tr_b16 a[42:43], v22 offset:16896
    s_waitcnt lgkmcnt(12)
    v_mfma_f32_16x16x32_bf16 v[44:47], a[16:19], v[108:111], v[44:47]
    ds_read_b64_tr_b16 a[44:45], v23 offset:16384
    ds_read_b64_tr_b16 a[46:47], v23 offset:16896
    s_waitcnt lgkmcnt(12)
    v_mfma_f32_16x16x32_bf16 v[48:51], a[20:23], v[108:111], v[48:51]
    ds_read_b64_tr_b16 a[48:49], v20 offset:4096
    ds_read_b64_tr_b16 a[50:51], v20 offset:4608
    s_waitcnt lgkmcnt(12)
    v_mfma_f32_16x16x32_bf16 v[52:55], a[24:27], v[108:111], v[52:55]
    ds_read_b64_tr_b16 a[52:53], v21 offset:4096
    ds_read_b64_tr_b16 a[54:55], v21 offset:4608
    s_waitcnt lgkmcnt(12)
    v_mfma_f32_16x16x32_bf16 v[56:59], a[28:31], v[108:111], v[56:59]
    ds_read_b64_tr_b16 a[56:57], v22 offset:4096
    ds_read_b64_tr_b16 a[58:59], v22 offset:4608
    s_waitcnt lgkmcnt(12)
    v_mfma_f32_16x16x32_bf16 v[60:63], v[108:111], a[32:35], v[60:63]
    ds_read_b64_tr_b16 a[60:61], v23 offset:4096
    ds_read_b64_tr_b16 a[62:63], v23 offset:4608
    s_waitcnt lgkmcnt(12)
    v_mfma_f32_16x16x32_bf16 v[64:67], v[108:111], a[36:39], v[64:67]
    ds_read_b64_tr_b16 a[64:65], v20 offset:12288
    ds_read_b64_tr_b16 a[66:67], v20 offset:12800
    s_waitcnt lgkmcnt(12)
    v_mfma_f32_16x16x32_bf16 v[68:71], v[108:111], a[40:43], v[68:71]
    ds_read_b64_tr_b16 a[68:69], v21 offset:12288
    ds_read_b64_tr_b16 a[70:71], v21 offset:12800
    s_waitcnt lgkmcnt(12)
    v_mfma_f32_16x16x32_bf16 v[72:75], v[108:111], a[44:47], v[72:75]
    ds_read_b64_tr_b16 a[72:73], v22 offset:12288
    ds_read_b64_tr_b16 a[74:75], v22 offset:12800
    s_waitcnt lgkmcnt(12)
    v_mfma_f32_16x16x32_bf16 v[28:31], a[48:51], v[116:119], v[28:31]
    ds_read_b64_tr_b16 a[76:77], v23 offset:12288
    ds_read_b64_tr_b16 a[78:79], v23 offset:12800
    s_waitcnt lgkmcnt(12)
    v_mfma_f32_16x16x32_bf16 v[32:35], a[52:55], v[116:119], v[32:35]
    ds_read_b64_tr_b16 a[80:81], v20 offset:20480
    ds_read_b64_tr_b16 a[82:83], v20 offset:20992
    s_waitcnt lgkmcnt(12)
    v_mfma_f32_16x16x32_bf16 v[36:39], a[56:59], v[116:119], v[36:39]
    ds_read_b64_tr_b16 a[84:85], v21 offset:20480
    ds_read_b64_tr_b16 a[86:87], v21 offset:20992
    s_waitcnt lgkmcnt(12)
    v_mfma_f32_16x16x32_bf16 v[40:43], a[60:63], v[116:119], v[40:43]
    ds_read_b64_tr_b16 a[88:89], v22 offset:20480
    ds_read_b64_tr_b16 a[90:91], v22 offset:20992
    s_waitcnt lgkmcnt(12)
    v_mfma_f32_16x16x32_bf16 v[44:47], a[64:67], v[112:115], v[44:47]
    ds_read_b64_tr_b16 a[92:93], v23 offset:20480
    ds_read_b64_tr_b16 a[94:95], v23 offset:20992
    s_waitcnt lgkmcnt(12)
    v_mfma_f32_16x16x32_bf16 v[48:51], a[68:71], v[112:115], v[48:51]
    s_waitcnt lgkmcnt(10)
    v_mfma_f32_16x16x32_bf16 v[52:55], a[72:75], v[112:115], v[52:55]
    s_waitcnt lgkmcnt(8)
    v_mfma_f32_16x16x32_bf16 v[56:59], a[76:79], v[112:115], v[56:59]
    s_waitcnt lgkmcnt(6)
    v_mfma_f32_16x16x32_bf16 v[60:63], v[112:115], a[80:83], v[60:63]
    s_waitcnt lgkmcnt(4)
    v_mfma_f32_16x16x32_bf16 v[64:67], v[112:115], a[84:87], v[64:67]
    s_waitcnt lgkmcnt(2)
    v_mfma_f32_16x16x32_bf16 v[68:71], v[112:115], a[88:91], v[68:71]
    s_waitcnt lgkmcnt(0)
    v_mfma_f32_16x16x32_bf16 v[72:75], v[112:115], a[92:95], v[72:75]
    s_barrier
    ds_read_b128 v[108:111], v76 offset:39040
    ds_read_b128 v[112:115], v77 offset:39040
    ds_read_b64_tr_b16 a[0:1], v20 offset:39040
    ds_read_b64_tr_b16 a[2:3], v20 offset:39552
    ds_read_b64_tr_b16 a[4:5], v21 offset:39040
    ds_read_b64_tr_b16 a[6:7], v21 offset:39552
    ds_read_b64_tr_b16 a[8:9], v22 offset:39040
    ds_read_b64_tr_b16 a[10:11], v22 offset:39552
    ds_read_b64_tr_b16 a[12:13], v23 offset:39040
    ds_read_b64_tr_b16 a[14:15], v23 offset:39552
    ds_read_b64_tr_b16 a[16:17], v20 offset:47232
    ds_read_b64_tr_b16 a[18:19], v20 offset:47744
    ds_read_b64_tr_b16 a[20:21], v21 offset:47232
    ds_read_b64_tr_b16 a[22:23], v21 offset:47744
    ds_read_b64_tr_b16 a[24:25], v22 offset:47232
    ds_read_b64_tr_b16 a[26:27], v22 offset:47744
    s_waitcnt lgkmcnt(12)
    v_mfma_f32_16x16x32_bf16 v[28:31], a[0:3], v[116:119], v[28:31]
    ds_read_b64_tr_b16 a[28:29], v23 offset:47232
    ds_read_b64_tr_b16 a[30:31], v23 offset:47744
    s_waitcnt lgkmcnt(12)
    v_mfma_f32_16x16x32_bf16 v[32:35], a[4:7], v[116:119], v[32:35]
    ds_read_b64_tr_b16 a[32:33], v20 offset:55424
    ds_read_b64_tr_b16 a[34:35], v20 offset:55936
    s_waitcnt lgkmcnt(12)
    v_mfma_f32_16x16x32_bf16 v[36:39], a[8:11], v[116:119], v[36:39]
    ds_read_b64_tr_b16 a[36:37], v21 offset:55424
    ds_read_b64_tr_b16 a[38:39], v21 offset:55936
    s_waitcnt lgkmcnt(12)
    v_mfma_f32_16x16x32_bf16 v[40:43], a[12:15], v[116:119], v[40:43]
    ds_read_b64_tr_b16 a[40:41], v22 offset:55424
    ds_read_b64_tr_b16 a[42:43], v22 offset:55936
    s_waitcnt lgkmcnt(12)
    v_mfma_f32_16x16x32_bf16 v[44:47], a[16:19], v[108:111], v[44:47]
    ds_read_b64_tr_b16 a[44:45], v23 offset:55424
    ds_read_b64_tr_b16 a[46:47], v23 offset:55936
    s_waitcnt lgkmcnt(12)
    v_mfma_f32_16x16x32_bf16 v[48:51], a[20:23], v[108:111], v[48:51]
    ds_read_b64_tr_b16 a[48:49], v20 offset:43136
    ds_read_b64_tr_b16 a[50:51], v20 offset:43648
    s_waitcnt lgkmcnt(12)
    v_mfma_f32_16x16x32_bf16 v[52:55], a[24:27], v[108:111], v[52:55]
    ds_read_b64_tr_b16 a[52:53], v21 offset:43136
    ds_read_b64_tr_b16 a[54:55], v21 offset:43648
    s_waitcnt lgkmcnt(12)
    v_mfma_f32_16x16x32_bf16 v[56:59], a[28:31], v[108:111], v[56:59]
    ds_read_b64_tr_b16 a[56:57], v22 offset:43136
    ds_read_b64_tr_b16 a[58:59], v22 offset:43648
    s_waitcnt lgkmcnt(12)
    v_mfma_f32_16x16x32_bf16 v[60:63], v[108:111], a[32:35], v[60:63]
    ds_read_b64_tr_b16 a[60:61], v23 offset:43136
    ds_read_b64_tr_b16 a[62:63], v23 offset:43648
    s_waitcnt lgkmcnt(12)
    v_mfma_f32_16x16x32_bf16 v[64:67], v[108:111], a[36:39], v[64:67]
    ds_read_b64_tr_b16 a[64:65], v20 offset:51328
    ds_read_b64_tr_b16 a[66:67], v20 offset:51840
    s_waitcnt lgkmcnt(12)
    v_mfma_f32_16x16x32_bf16 v[68:71], v[108:111], a[40:43], v[68:71]
    ds_read_b64_tr_b16 a[68:69], v21 offset:51328
    ds_read_b64_tr_b16 a[70:71], v21 offset:51840
    s_waitcnt lgkmcnt(12)
    v_mfma_f32_16x16x32_bf16 v[72:75], v[108:111], a[44:47], v[72:75]
    ds_read_b64_tr_b16 a[72:73], v22 offset:51328
    ds_read_b64_tr_b16 a[74:75], v22 offset:51840
    s_waitcnt lgkmcnt(12)
    v_mfma_f32_16x16x32_bf16 v[28:31], a[48:51], v[116:119], v[28:31]
    ds_read_b64_tr_b16 a[76:77], v23 offset:51328
    ds_read_b64_tr_b16 a[78:79], v23 offset:51840
    s_waitcnt lgkmcnt(12)
    v_mfma_f32_16x16x32_bf16 v[32:35], a[52:55], v[116:119], v[32:35]
    ds_read_b64_tr_b16 a[80:81], v20 offset:59520
    ds_read_b64_tr_b16 a[82:83], v20 offset:60032
    s_waitcnt lgkmcnt(12)
    v_mfma_f32_16x16x32_bf16 v[36:39], a[56:59], v[116:119], v[36:39]
    ds_read_b64_tr_b16 a[84:85], v21 offset:59520
    ds_read_b64_tr_b16 a[86:87], v21 offset:60032
    s_waitcnt lgkmcnt(12)
    v_mfma_f32_16x16x32_bf16 v[40:43], a[60:63], v[116:119], v[40:43]
    ds_read_b64_tr_b16 a[88:89], v22 offset:59520
    ds_read_b64_tr_b16 a[90:91], v22 offset:60032
    s_waitcnt lgkmcnt(12)
    v_mfma_f32_16x16x32_bf16 v[44:47], a[64:67], v[112:115], v[44:47]
    ds_read_b64_tr_b16 a[92:93], v23 offset:59520
    ds_read_b64_tr_b16 a[94:95], v23 offset:60032
    s_waitcnt lgkmcnt(12)
    v_mfma_f32_16x16x32_bf16 v[48:51], a[68:71], v[112:115], v[48:51]
    s_waitcnt lgkmcnt(10)
    v_mfma_f32_16x16x32_bf16 v[52:55], a[72:75], v[112:115], v[52:55]
    s_waitcnt lgkmcnt(8)
    v_mfma_f32_16x16x32_bf16 v[56:59], a[76:79], v[112:115], v[56:59]
    s_waitcnt lgkmcnt(6)
    v_mfma_f32_16x16x32_bf16 v[60:63], v[112:115], a[80:83], v[60:63]
    s_waitcnt lgkmcnt(4)
    v_mfma_f32_16x16x32_bf16 v[64:67], v[112:115], a[84:87], v[64:67]
    s_waitcnt lgkmcnt(2)
    v_mfma_f32_16x16x32_bf16 v[68:71], v[112:115], a[88:91], v[68:71]
    s_waitcnt lgkmcnt(0)
    v_mfma_f32_16x16x32_bf16 v[72:75], v[112:115], a[92:95], v[72:75]
    s_barrier
    ds_read_b128 a[96:99], v80 offset:0
    ds_read_b128 a[100:103], v81 offset:0
    ds_read_b64_tr_b16 a[0:1], v24 offset:0
    ds_read_b64_tr_b16 a[2:3], v24 offset:512
    ds_read_b64_tr_b16 a[4:5], v25 offset:0
    ds_read_b64_tr_b16 a[6:7], v25 offset:512
    ds_read_b64_tr_b16 a[8:9], v26 offset:0
    ds_read_b64_tr_b16 a[10:11], v26 offset:512
    ds_read_b64_tr_b16 a[12:13], v27 offset:0
    ds_read_b64_tr_b16 a[14:15], v27 offset:512
    ds_read_b64_tr_b16 a[16:17], v24 offset:8192
    ds_read_b64_tr_b16 a[18:19], v24 offset:8704
    ds_read_b64_tr_b16 a[20:21], v25 offset:8192
    ds_read_b64_tr_b16 a[22:23], v25 offset:8704
    ds_read_b64_tr_b16 a[24:25], v26 offset:8192
    ds_read_b64_tr_b16 a[26:27], v26 offset:8704
    s_waitcnt lgkmcnt(12)
    v_mfma_f32_16x16x32_bf16 v[28:31], a[0:3], v[116:119], v[28:31]
    ds_read_b64_tr_b16 a[28:29], v27 offset:8192
    ds_read_b64_tr_b16 a[30:31], v27 offset:8704
    s_waitcnt lgkmcnt(12)
    v_mfma_f32_16x16x32_bf16 v[32:35], a[4:7], v[116:119], v[32:35]
    ds_read_b64_tr_b16 a[48:49], v24 offset:4096
    ds_read_b64_tr_b16 a[50:51], v24 offset:4608
    s_waitcnt lgkmcnt(12)
    v_mfma_f32_16x16x32_bf16 v[36:39], a[8:11], v[116:119], v[36:39]
    ds_read_b64_tr_b16 a[52:53], v25 offset:4096
    ds_read_b64_tr_b16 a[54:55], v25 offset:4608
    s_waitcnt lgkmcnt(12)
    v_mfma_f32_16x16x32_bf16 v[40:43], a[12:15], v[116:119], v[40:43]
    ds_read_b64_tr_b16 a[56:57], v26 offset:4096
    ds_read_b64_tr_b16 a[58:59], v26 offset:4608
    s_waitcnt lgkmcnt(12)
    v_mfma_f32_16x16x32_bf16 v[44:47], a[16:19], a[96:99], v[44:47]
    ds_read_b64_tr_b16 a[60:61], v27 offset:4096
    ds_read_b64_tr_b16 a[62:63], v27 offset:4608
    s_waitcnt lgkmcnt(12)
    v_mfma_f32_16x16x32_bf16 v[48:51], a[20:23], a[96:99], v[48:51]
    ds_read_b64_tr_b16 a[64:65], v24 offset:12288
    ds_read_b64_tr_b16 a[66:67], v24 offset:12800
    s_waitcnt lgkmcnt(12)
    v_mfma_f32_16x16x32_bf16 v[52:55], a[24:27], a[96:99], v[52:55]
    ds_read_b64_tr_b16 a[68:69], v25 offset:12288
    ds_read_b64_tr_b16 a[70:71], v25 offset:12800
    s_waitcnt lgkmcnt(12)
    v_mfma_f32_16x16x32_bf16 v[56:59], a[28:31], a[96:99], v[56:59]
    ds_read_b64_tr_b16 a[72:73], v26 offset:12288
    ds_read_b64_tr_b16 a[74:75], v26 offset:12800
    s_waitcnt lgkmcnt(12)
    v_mfma_f32_16x16x32_bf16 v[28:31], a[48:51], v[116:119], v[28:31]
    ds_read_b64_tr_b16 a[76:77], v27 offset:12288
    ds_read_b64_tr_b16 a[78:79], v27 offset:12800
    s_waitcnt lgkmcnt(12)
    v_mfma_f32_16x16x32_bf16 v[32:35], a[52:55], v[116:119], v[32:35]
    s_waitcnt lgkmcnt(10)
    v_mfma_f32_16x16x32_bf16 v[36:39], a[56:59], v[116:119], v[36:39]
    s_waitcnt lgkmcnt(8)
    v_mfma_f32_16x16x32_bf16 v[40:43], a[60:63], v[116:119], v[40:43]
    s_waitcnt lgkmcnt(6)
    v_mfma_f32_16x16x32_bf16 v[44:47], a[64:67], a[100:103], v[44:47]
    s_waitcnt lgkmcnt(4)
    v_mfma_f32_16x16x32_bf16 v[48:51], a[68:71], a[100:103], v[48:51]
    s_waitcnt lgkmcnt(2)
    v_mfma_f32_16x16x32_bf16 v[52:55], a[72:75], a[100:103], v[52:55]
    s_waitcnt lgkmcnt(0)
    v_mfma_f32_16x16x32_bf16 v[56:59], a[76:79], a[100:103], v[56:59]
    s_barrier
    ds_read_b128 a[104:107], v80 offset:39040
    ds_read_b128 a[108:111], v81 offset:39040
    ds_read_b64_tr_b16 a[0:1], v24 offset:39040
    ds_read_b64_tr_b16 a[2:3], v24 offset:39552
    ds_read_b64_tr_b16 a[4:5], v25 offset:39040
    ds_read_b64_tr_b16 a[6:7], v25 offset:39552
    ds_read_b64_tr_b16 a[8:9], v26 offset:39040
    ds_read_b64_tr_b16 a[10:11], v26 offset:39552
    ds_read_b64_tr_b16 a[12:13], v27 offset:39040
    ds_read_b64_tr_b16 a[14:15], v27 offset:39552
    ds_read_b64_tr_b16 a[16:17], v24 offset:47232
    ds_read_b64_tr_b16 a[18:19], v24 offset:47744
    ds_read_b64_tr_b16 a[20:21], v25 offset:47232
    ds_read_b64_tr_b16 a[22:23], v25 offset:47744
    ds_read_b64_tr_b16 a[24:25], v26 offset:47232
    ds_read_b64_tr_b16 a[26:27], v26 offset:47744
    s_waitcnt lgkmcnt(12)
    v_mfma_f32_16x16x32_bf16 v[28:31], a[0:3], v[116:119], v[28:31]
    ds_read_b64_tr_b16 a[28:29], v27 offset:47232
    ds_read_b64_tr_b16 a[30:31], v27 offset:47744
    s_waitcnt lgkmcnt(12)
    v_mfma_f32_16x16x32_bf16 v[32:35], a[4:7], v[116:119], v[32:35]
    ds_read_b64_tr_b16 a[48:49], v24 offset:43136
    ds_read_b64_tr_b16 a[50:51], v24 offset:43648
    s_waitcnt lgkmcnt(12)
    v_mfma_f32_16x16x32_bf16 v[36:39], a[8:11], v[116:119], v[36:39]
    ds_read_b64_tr_b16 a[52:53], v25 offset:43136
    ds_read_b64_tr_b16 a[54:55], v25 offset:43648
    s_waitcnt lgkmcnt(12)
    v_mfma_f32_16x16x32_bf16 v[40:43], a[12:15], v[116:119], v[40:43]
    ds_read_b64_tr_b16 a[56:57], v26 offset:43136
    ds_read_b64_tr_b16 a[58:59], v26 offset:43648
    s_waitcnt lgkmcnt(12)
    v_mfma_f32_16x16x32_bf16 v[44:47], a[16:19], a[104:107], v[44:47]
    ds_read_b64_tr_b16 a[60:61], v27 offset:43136
    ds_read_b64_tr_b16 a[62:63], v27 offset:43648
    s_waitcnt lgkmcnt(12)
    v_mfma_f32_16x16x32_bf16 v[48:51], a[20:23], a[104:107], v[48:51]
    ds_read_b64_tr_b16 a[64:65], v24 offset:51328
    ds_read_b64_tr_b16 a[66:67], v24 offset:51840
    s_waitcnt lgkmcnt(12)
    v_mfma_f32_16x16x32_bf16 v[52:55], a[24:27], a[104:107], v[52:55]
    ds_read_b64_tr_b16 a[68:69], v25 offset:51328
    ds_read_b64_tr_b16 a[70:71], v25 offset:51840
    s_waitcnt lgkmcnt(12)
    v_mfma_f32_16x16x32_bf16 v[56:59], a[28:31], a[104:107], v[56:59]
    ds_read_b64_tr_b16 a[72:73], v26 offset:51328
    ds_read_b64_tr_b16 a[74:75], v26 offset:51840
    s_waitcnt lgkmcnt(12)
    v_mfma_f32_16x16x32_bf16 v[28:31], a[48:51], v[116:119], v[28:31]
    ds_read_b64_tr_b16 a[76:77], v27 offset:51328
    ds_read_b64_tr_b16 a[78:79], v27 offset:51840
    s_waitcnt lgkmcnt(12)
    v_mfma_f32_16x16x32_bf16 v[32:35], a[52:55], v[116:119], v[32:35]
    s_waitcnt lgkmcnt(10)
    v_mfma_f32_16x16x32_bf16 v[36:39], a[56:59], v[116:119], v[36:39]
    s_waitcnt lgkmcnt(8)
    v_mfma_f32_16x16x32_bf16 v[40:43], a[60:63], v[116:119], v[40:43]
    s_waitcnt lgkmcnt(6)
    v_mfma_f32_16x16x32_bf16 v[44:47], a[64:67], a[108:111], v[44:47]
    s_waitcnt lgkmcnt(4)
    v_mfma_f32_16x16x32_bf16 v[48:51], a[68:71], a[108:111], v[48:51]
    s_waitcnt lgkmcnt(2)
    v_mfma_f32_16x16x32_bf16 v[52:55], a[72:75], a[108:111], v[52:55]
    s_waitcnt lgkmcnt(0)
    v_mfma_f32_16x16x32_bf16 v[56:59], a[76:79], a[108:111], v[56:59]
    buffer_load_dwordx2 v[92:93], v96, s[28:31], s46 offen sc1
    buffer_load_dwordx2 v[94:95], v97, s[28:31], s46 offen sc1
    s_barrier
    ds_read_b128 a[112:115], v76 offset:0
    ds_read_b128 a[116:119], v77 offset:0
    ds_read_b64_tr_b16 a[0:1], v20 offset:0
    ds_read_b64_tr_b16 a[2:3], v20 offset:512
    ds_read_b64_tr_b16 a[4:5], v21 offset:0
    ds_read_b64_tr_b16 a[6:7], v21 offset:512
    ds_read_b64_tr_b16 a[8:9], v22 offset:0
    ds_read_b64_tr_b16 a[10:11], v22 offset:512
    ds_read_b64_tr_b16 a[12:13], v23 offset:0
    ds_read_b64_tr_b16 a[14:15], v23 offset:512
    ds_read_b64_tr_b16 a[16:17], v20 offset:8192
    ds_read_b64_tr_b16 a[18:19], v20 offset:8704
    ds_read_b64_tr_b16 a[20:21], v21 offset:8192
    ds_read_b64_tr_b16 a[22:23], v21 offset:8704
    ds_read_b64_tr_b16 a[24:25], v22 offset:8192
    ds_read_b64_tr_b16 a[26:27], v22 offset:8704
    s_waitcnt lgkmcnt(12)
    v_mfma_f32_16x16x32_bf16 v[28:31], a[0:3], v[116:119], v[28:31]
    ds_read_b64_tr_b16 a[28:29], v23 offset:8192
    ds_read_b64_tr_b16 a[30:31], v23 offset:8704
    s_waitcnt lgkmcnt(12)
    v_mfma_f32_16x16x32_bf16 v[32:35], a[4:7], v[116:119], v[32:35]
    ds_read_b64_tr_b16 a[48:49], v20 offset:4096
    ds_read_b64_tr_b16 a[50:51], v20 offset:4608
    s_waitcnt lgkmcnt(12)
    v_mfma_f32_16x16x32_bf16 v[36:39], a[8:11], v[116:119], v[36:39]
    ds_read_b64_tr_b16 a[52:53], v21 offset:4096
    ds_read_b64_tr_b16 a[54:55], v21 offset:4608
    s_waitcnt lgkmcnt(12)
    v_mfma_f32_16x16x32_bf16 v[40:43], a[12:15], v[116:119], v[40:43]
    ds_read_b64_tr_b16 a[56:57], v22 offset:4096
    ds_read_b64_tr_b16 a[58:59], v22 offset:4608
    s_waitcnt lgkmcnt(12)
    v_mfma_f32_16x16x32_bf16 v[44:47], a[16:19], a[112:115], v[44:47]
    ds_read_b64_tr_b16 a[60:61], v23 offset:4096
    ds_read_b64_tr_b16 a[62:63], v23 offset:4608
    s_waitcnt lgkmcnt(12)
    v_mfma_f32_16x16x32_bf16 v[48:51], a[20:23], a[112:115], v[48:51]
    ds_read_b64_tr_b16 a[64:65], v20 offset:12288
    ds_read_b64_tr_b16 a[66:67], v20 offset:12800
    s_waitcnt lgkmcnt(12)
    v_mfma_f32_16x16x32_bf16 v[52:55], a[24:27], a[112:115], v[52:55]
    ds_read_b64_tr_b16 a[68:69], v21 offset:12288
    ds_read_b64_tr_b16 a[70:71], v21 offset:12800
    s_waitcnt lgkmcnt(12)
    v_mfma_f32_16x16x32_bf16 v[56:59], a[28:31], a[112:115], v[56:59]
    ds_read_b64_tr_b16 a[72:73], v22 offset:12288
    ds_read_b64_tr_b16 a[74:75], v22 offset:12800
    s_waitcnt lgkmcnt(12)
    v_mfma_f32_16x16x32_bf16 v[28:31], a[48:51], v[116:119], v[28:31]
    ds_read_b64_tr_b16 a[76:77], v23 offset:12288
    ds_read_b64_tr_b16 a[78:79], v23 offset:12800
    s_waitcnt lgkmcnt(12)
    v_mfma_f32_16x16x32_bf16 v[32:35], a[52:55], v[116:119], v[32:35]
    s_waitcnt lgkmcnt(10)
    v_mfma_f32_16x16x32_bf16 v[36:39], a[56:59], v[116:119], v[36:39]
    s_waitcnt vmcnt(0)
Lst_chk:
    v_cmp_ne_u32 vcc, s34, v93
    v_cmp_ne_u32 s[36:37], s34, v95
    s_nop 0
    s_or_b64 s[36:37], s[36:37], vcc
    s_cbranch_scc1 Lst_re
    v_lshlrev_b32 v93, 16, v92
    s_waitcnt lgkmcnt(8)
    v_mfma_f32_16x16x32_bf16 v[40:43], a[60:63], v[116:119], v[40:43]
    v_and_b32 v92, 0xffff0000, v92
    v_rcp_f32 v93, v93
    s_waitcnt lgkmcnt(6)
    v_mfma_f32_16x16x32_bf16 v[44:47], a[64:67], a[116:119], v[44:47]
    v_lshlrev_b32 v95, 16, v94
    v_and_b32 v94, 0xffff0000, v94
    s_waitcnt lgkmcnt(4)
    v_mfma_f32_16x16x32_bf16 v[48:51], a[68:71], a[116:119], v[48:51]
    v_rcp_f32 v95, v95
    ds_write2st64_b32 v4, v92, v93 offset0:0 offset1:2
    s_waitcnt lgkmcnt(3)
    v_mfma_f32_16x16x32_bf16 v[52:55], a[72:75], a[116:119], v[52:55]
    ds_write2st64_b32 v5, v94, v95 offset0:0 offset1:2
    ds_read_b32 v120, v11
    s_waitcnt lgkmcnt(3)
    v_mfma_f32_16x16x32_bf16 v[56:59], a[76:79], a[116:119], v[56:59]
    s_waitcnt lgkmcnt(0)
    s_barrier
    ds_read_b128 a[120:123], v76 offset:39040
    ds_read_b128 a[124:127], v77 offset:39040
    ds_read_b64_tr_b16 a[0:1], v20 offset:39040
    ds_read_b64_tr_b16 a[2:3], v20 offset:39552
    ds_read_b64_tr_b16 a[4:5], v21 offset:39040
    ds_read_b64_tr_b16 a[6:7], v21 offset:39552
    ds_read_b64_tr_b16 a[8:9], v22 offset:39040
    ds_read_b64_tr_b16 a[10:11], v22 offset:39552
    ds_read_b64_tr_b16 a[12:13], v23 offset:39040
    ds_read_b64_tr_b16 a[14:15], v23 offset:39552
    ds_read_b64_tr_b16 a[16:17], v20 offset:47232
    ds_read_b64_tr_b16 a[18:19], v20 offset:47744
    ds_read_b64_tr_b16 a[20:21], v21 offset:47232
    ds_read_b64_tr_b16 a[22:23], v21 offset:47744
    ds_read_b64_tr_b16 a[24:25], v22 offset:47232
    ds_read_b64_tr_b16 a[26:27], v22 offset:47744
    s_waitcnt lgkmcnt(12)
    v_mfma_f32_16x16x32_bf16 v[28:31], a[0:3], v[116:119], v[28:31]
    ds_read_b64_tr_b16 a[28:29], v23 offset:47232
    ds_read_b64_tr_b16 a[30:31], v23 offset:47744
    s_waitcnt lgkmcnt(12)
    v_mfma_f32_16x16x32_bf16 v[32:35], a[4:7], v[116:119], v[32:35]
    ds_read_b64_tr_b16 a[48:49], v20 offset:43136
    ds_read_b64_tr_b16 a[50:51], v20 offset:43648
    s_waitcnt lgkmcnt(12)
    v_mfma_f32_16x16x32_bf16 v[36:39], a[8:11], v[116:119], v[36:39]
    ds_read_b64_tr_b16 a[52:53], v21 offset:43136
    ds_read_b64_tr_b16 a[54:55], v21 offset:43648
    s_waitcnt lgkmcnt(12)
    v_mfma_f32_16x16x32_bf16 v[40:43], a[12:15], v[116:119], v[40:43]
    ds_read_b64_tr_b16 a[56:57], v22 offset:43136
    ds_read_b64_tr_b16 a[58:59], v22 offset:43648
    s_waitcnt lgkmcnt(12)
    v_mfma_f32_16x16x32_bf16 v[44:47], a[16:19], a[120:123], v[44:47]
    ds_read_b64_tr_b16 a[60:61], v23 offset:43136
    ds_read_b64_tr_b16 a[62:63], v23 offset:43648
    s_waitcnt lgkmcnt(12)
    v_mfma_f32_16x16x32_bf16 v[48:51], a[20:23], a[120:123], v[48:51]
    ds_read_b64_tr_b16 a[64:65], v20 offset:51328
    ds_read_b64_tr_b16 a[66:67], v20 offset:51840
    s_waitcnt lgkmcnt(12)
    v_mfma_f32_16x16x32_bf16 v[52:55], a[24:27], a[120:123], v[52:55]
    ds_read_b64_tr_b16 a[68:69], v21 offset:51328
    ds_read_b64_tr_b16 a[70:71], v21 offset:51840
    s_waitcnt lgkmcnt(12)
    v_mfma_f32_16x16x32_bf16 v[56:59], a[28:31], a[120:123], v[56:59]
    ds_read_b64_tr_b16 a[72:73], v22 offset:51328
    ds_read_b64_tr_b16 a[74:75], v22 offset:51840
    s_waitcnt lgkmcnt(12)
    v_mfma_f32_16x16x32_bf16 v[28:31], a[48:51], v[116:119], v[28:31]
    ds_read_b64_tr_b16 a[76:77], v23 offset:51328
    ds_read_b64_tr_b16 a[78:79], v23 offset:51840
    s_waitcnt lgkmcnt(12)
    v_mfma_f32_16x16x32_bf16 v[32:35], a[52:55], v[116:119], v[32:35]
    s_waitcnt lgkmcnt(10)
    v_mfma_f32_16x16x32_bf16 v[36:39], a[56:59], v[116:119], v[36:39]
    s_waitcnt lgkmcnt(8)
    v_mfma_f32_16x16x32_bf16 v[40:43], a[60:63], v[116:119], v[40:43]
    s_waitcnt lgkmcnt(6)
    v_mfma_f32_16x16x32_bf16 v[44:47], a[64:67], a[124:127], v[44:47]
    s_waitcnt lgkmcnt(4)
    v_mfma_f32_16x16x32_bf16 v[48:51], a[68:71], a[124:127], v[48:51]
    s_waitcnt lgkmcnt(2)
    v_mfma_f32_16x16x32_bf16 v[52:55], a[72:75], a[124:127], v[52:55]
    s_waitcnt lgkmcnt(0)
    v_mfma_f32_16x16x32_bf16 v[56:59], a[76:79], a[124:127], v[56:59]
    s_mov_b32 exec_lo, 0x00010001
    s_mov_b32 exec_hi, 0x00010001
    ds_write_b128 v6, v[28:31] offset:0
    ds_write_b128 v6, v[32:35] offset:64
    ds_write_b128 v6, v[36:39] offset:128
    ds_write_b128 v6, v[40:43] offset:192
    ds_write_b128 v6, v[44:47] offset:256
    ds_write_b128 v6, v[48:51] offset:320
    ds_write_b128 v6, v[52:55] offset:384
    ds_write_b128 v6, v[56:59] offset:448
    ds_write_b32 v7, v7
    s_mov_b64 exec, -1
    ds_read_b128 v[76:79], v6 offset:256
    ds_read_b128 v[80:83], v6 offset:320
    ds_read_b128 v[84:87], v6 offset:384
    ds_read_b128 v[88:91], v6 offset:448
    s_waitcnt lgkmcnt(0)
    v_fmac_f32 v44, v76, v120
    v_fmac_f32 v45, v77, v120
    v_fmac_f32 v46, v78, v120
    v_fmac_f32 v47, v79, v120
    v_cvt_pk_bf16_f32 v44, v44, v45
    v_cvt_pk_bf16_f32 v45, v46, v47
    v_fmac_f32 v48, v80, v120
    v_fmac_f32 v49, v81, v120
    v_fmac_f32 v50, v82, v120
    v_fmac_f32 v51, v83, v120
    v_cvt_pk_bf16_f32 v46, v48, v49
    v_cvt_pk_bf16_f32 v47, v50, v51
    v_fmac_f32 v52, v84, v120
    v_fmac_f32 v53, v85, v120
    v_fmac_f32 v54, v86, v120
    v_fmac_f32 v55, v87, v120
    v_cvt_pk_bf16_f32 v48, v52, v53
    v_cvt_pk_bf16_f32 v49, v54, v55
    v_fmac_f32 v56, v88, v120
    v_fmac_f32 v57, v89, v120
    v_fmac_f32 v58, v90, v120
    v_fmac_f32 v59, v91, v120
    v_cvt_pk_bf16_f32 v50, v56, v57
    v_cvt_pk_bf16_f32 v51, v58, v59
    ds_write_b128 v125, v[44:47] offset:4096
    ds_write_b128 v125, v[48:51] offset:5120
    v_mov_b32 v5, 157972
    v_mov_b32 v6, 1
    s_mov_b64 exec, 1
    ds_add_u32 v5, v6
    s_mov_b64 exec, -1
    v_mov_b32 v5, 157980
Lcw_6:
    s_sub_u32 s35, s35, 1
    s_cbranch_scc1 Lend
    ds_read_b32 v6, v5
    s_waitcnt lgkmcnt(0)
    v_readfirstlane_b32 s38, v6
    s_nop 0
    s_cmp_lt_u32 s38, 1
    s_cbranch_scc1 Lcw_6
    ds_read_b64_tr_b16 a[0:1], v24 offset:16384
    ds_read_b64_tr_b16 a[2:3], v24 offset:16896
    ds_read_b64_tr_b16 a[4:5], v25 offset:16384
    ds_read_b64_tr_b16 a[6:7], v25 offset:16896
    ds_read_b64_tr_b16 a[8:9], v26 offset:16384
    ds_read_b64_tr_b16 a[10:11], v26 offset:16896
    ds_read_b64_tr_b16 a[12:13], v27 offset:16384
    ds_read_b64_tr_b16 a[14:15], v27 offset:16896
    ds_read_b64_tr_b16 a[16:17], v24 offset:20480
    ds_read_b64_tr_b16 a[18:19], v24 offset:20992
    ds_read_b64_tr_b16 a[20:21], v25 offset:20480
    ds_read_b64_tr_b16 a[22:23], v25 offset:20992
    ds_read_b64_tr_b16 a[24:25], v26 offset:20480
    ds_read_b64_tr_b16 a[26:27], v26 offset:20992
    ds_read_b64_tr_b16 a[28:29], v27 offset:20480
    ds_read_b64_tr_b16 a[30:31], v27 offset:20992
    ds_read_b64_tr_b16 a[32:33], v24 offset:55424
    ds_read_b64_tr_b16 a[34:35], v24 offset:55936
    ds_read_b64_tr_b16 a[36:37], v25 offset:55424
    ds_read_b64_tr_b16 a[38:39], v25 offset:55936
    ds_read_b64_tr_b16 a[40:41], v26 offset:55424
    ds_read_b64_tr_b16 a[42:43], v26 offset:55936
    ds_read_b64_tr_b16 a[44:45], v27 offset:55424
    ds_read_b64_tr_b16 a[46:47], v27 offset:55936
    ds_read_b64_tr_b16 a[48:49], v24 offset:59520
    ds_read_b64_tr_b16 a[50:51], v24 offset:60032
    ds_read_b64_tr_b16 a[52:53], v25 offset:59520
    ds_read_b64_tr_b16 a[54:55], v25 offset:60032
    ds_read_b64_tr_b16 a[56:57], v26 offset:59520
    ds_read_b64_tr_b16 a[58:59], v26 offset:60032
    ds_read_b64_tr_b16 a[60:61], v27 offset:59520
    ds_read_b64_tr_b16 a[62:63], v27 offset:60032
    ds_read_b64_tr_b16 a[64:65], v20 offset:16384
    ds_read_b64_tr_b16 a[66:67], v20 offset:16896
    ds_read_b64_tr_b16 a[68:69], v21 offset:16384
    ds_read_b64_tr_b16 a[70:71], v21 offset:16896
    ds_read_b64_tr_b16 a[72:73], v22 offset:16384
    ds_read_b64_tr_b16 a[74:75], v22 offset:16896
    ds_read_b64_tr_b16 a[76:77], v23 offset:16384
    ds_read_b64_tr_b16 a[78:79], v23 offset:16896
    ds_read_b64_tr_b16 a[80:81], v20 offset:20480
    ds_read_b64_tr_b16 a[82:83], v20 offset:20992
    ds_read_b64_tr_b16 a[84:85], v21 offset:20480
    ds_read_b64_tr_b16 a[86:87], v21 offset:20992
    ds_read_b64_tr_b16 a[88:89], v22 offset:20480
    ds_read_b64_tr_b16 a[90:91], v22 offset:20992
    ds_read_b64_tr_b16 a[92:93], v23 offset:20480
    ds_read_b64_tr_b16 a[94:95], v23 offset:20992
    s_waitcnt lgkmcnt(15)
    v_mfma_f32_16x16x32_bf16 v[60:63], a[96:99], a[0:3], v[60:63]
    v_mfma_f32_16x16x32_bf16 v[64:67], a[96:99], a[4:7], v[64:67]
    v_mfma_f32_16x16x32_bf16 v[68:71], a[96:99], a[8:11], v[68:71]
    v_mfma_f32_16x16x32_bf16 v[72:75], a[96:99], a[12:15], v[72:75]
    ds_read_b64_tr_b16 a[0:1], v20 offset:55424
    ds_read_b64_tr_b16 a[2:3], v20 offset:55936
    ds_read_b64_tr_b16 a[4:5], v21 offset:55424
    ds_read_b64_tr_b16 a[6:7], v21 offset:55936
    ds_read_b64_tr_b16 a[8:9], v22 offset:55424
    ds_read_b64_tr_b16 a[10:11], v22 offset:55936
    ds_read_b64_tr_b16 a[12:13], v23 offset:55424
    ds_read_b64_tr_b16 a[14:15], v23 offset:55936
    v_mfma_f32_16x16x32_bf16 v[60:63], a[100:103], a[16:19], v[60:63]
    v_mfma_f32_16x16x32_bf16 v[64:67], a[100:103], a[20:23], v[64:67]
    v_mfma_f32_16x16x32_bf16 v[68:71], a[100:103], a[24:27], v[68:71]
    v_mfma_f32_16x16x32_bf16 v[72:75], a[100:103], a[28:31], v[72:75]
    ds_read_b64_tr_b16 a[16:17], v20 offset:59520
    ds_read_b64_tr_b16 a[18:19], v20 offset:60032
    ds_read_b64_tr_b16 a[20:21], v21 offset:59520
    ds_read_b64_tr_b16 a[22:23], v21 offset:60032
    ds_read_b64_tr_b16 a[24:25], v22 offset:59520
    ds_read_b64_tr_b16 a[26:27], v22 offset:60032
    ds_read_b64_tr_b16 a[28:29], v23 offset:59520
    ds_read_b64_tr_b16 a[30:31], v23 offset:60032
    v_mfma_f32_16x16x32_bf16 v[60:63], a[104:107], a[32:35], v[60:63]
    v_mfma_f32_16x16x32_bf16 v[64:67], a[104:107], a[36:39], v[64:67]
    v_mfma_f32_16x16x32_bf16 v[68:71], a[104:107], a[40:43], v[68:71]
    v_mfma_f32_16x16x32_bf16 v[72:75], a[104:107], a[44:47], v[72:75]
    v_mfma_f32_16x16x32_bf16 v[60:63], a[108:111], a[48:51], v[60:63]
    v_mfma_f32_16x16x32_bf16 v[64:67], a[108:111], a[52:55], v[64:67]
    v_mfma_f32_16x16x32_bf16 v[68:71], a[108:111], a[56:59], v[68:71]
    v_mfma_f32_16x16x32_bf16 v[72:75], a[108:111], a[60:63], v[72:75]
    s_waitcnt lgkmcnt(15)
    v_mfma_f32_16x16x32_bf16 v[60:63], a[112:115], a[64:67], v[60:63]
    v_mfma_f32_16x16x32_bf16 v[64:67], a[112:115], a[68:71], v[64:67]
    v_mfma_f32_16x16x32_bf16 v[68:71], a[112:115], a[72:75], v[68:71]
    v_mfma_f32_16x16x32_bf16 v[72:75], a[112:115], a[76:79], v[72:75]
    v_mfma_f32_16x16x32_bf16 v[60:63], a[116:119], a[80:83], v[60:63]
    v_mfma_f32_16x16x32_bf16 v[64:67], a[116:119], a[84:87], v[64:67]
    v_mfma_f32_16x16x32_bf16 v[68:71], a[116:119], a[88:91], v[68:71]
    v_mfma_f32_16x16x32_bf16 v[72:75], a[116:119], a[92:95], v[72:75]
    s_waitcnt lgkmcnt(8)
    v_mfma_f32_16x16x32_bf16 v[60:63], a[120:123], a[0:3], v[60:63]
    v_mfma_f32_16x16x32_bf16 v[64:67], a[120:123], a[4:7], v[64:67]
    v_mfma_f32_16x16x32_bf16 v[68:71], a[120:123], a[8:11], v[68:71]
    v_mfma_f32_16x16x32_bf16 v[72:75], a[120:123], a[12:15], v[72:75]
    s_waitcnt lgkmcnt(0)
    v_mfma_f32_16x16x32_bf16 v[60:63], a[124:127], a[16:19], v[60:63]
    v_mfma_f32_16x16x32_bf16 v[64:67], a[124:127], a[20:23], v[64:67]
    v_mfma_f32_16x16x32_bf16 v[68:71], a[124:127], a[24:27], v[68:71]
    v_mfma_f32_16x16x32_bf16 v[72:75], a[124:127], a[28:31], v[72:75]
    v_lshlrev_b32 v5, 4, v3
    v_add_u32 v5, 157696, v5
    v_mov_b32 v6, 157952
    v_lshlrev_b32 v4, 4, v2
    v_add_u32 v4, 156224, v4
    v_lshl_add_u32 v125, v1, 3, s45
    s_mov_b64 exec, 0xffff
    ds_write_b32 v5, v60 offset:0
    ds_write_b32 v5, v64 offset:4
    ds_write_b32 v5, v68 offset:8
    ds_write_b32 v5, v72 offset:12
    ds_write_b32 v6, v6
    s_mov_b64 exec, -1
    ds_read_b128 v[36:39], v5
    ds_read_b128 v[28:31], v4
    ds_read_b128 v[32:35], v4 offset:512
    s_waitcnt lgkmcnt(0)
    v_fmac_f32 v60, v28, v36
    v_fmac_f32 v61, v29, v36
    v_fmac_f32 v62, v30, v36
    v_fmac_f32 v63, v31, v36
    v_mul_f32 v60, v60, v32
    v_mul_f32 v61, v61, v33
    v_mul_f32 v62, v62, v34
    v_mul_f32 v63, v63, v35
    v_cvt_pk_bf16_f32 v60, v60, v61
    v_cvt_pk_bf16_f32 v61, v62, v63
    ds_write_b64 v125, v[60:61] offset:0
    v_fmac_f32 v64, v28, v37
    v_fmac_f32 v65, v29, v37
    v_fmac_f32 v66, v30, v37
    v_fmac_f32 v67, v31, v37
    v_mul_f32 v64, v64, v32
    v_mul_f32 v65, v65, v33
    v_mul_f32 v66, v66, v34
    v_mul_f32 v67, v67, v35
    v_cvt_pk_bf16_f32 v64, v64, v65
    v_cvt_pk_bf16_f32 v65, v66, v67
    ds_write_b64 v125, v[64:65] offset:512
    v_fmac_f32 v68, v28, v38
    v_fmac_f32 v69, v29, v38
    v_fmac_f32 v70, v30, v38
    v_fmac_f32 v71, v31, v38
    v_mul_f32 v68, v68, v32
    v_mul_f32 v69, v69, v33
    v_mul_f32 v70, v70, v34
    v_mul_f32 v71, v71, v35
    v_cvt_pk_bf16_f32 v68, v68, v69
    v_cvt_pk_bf16_f32 v69, v70, v71
    ds_write_b64 v125, v[68:69] offset:1024
    v_fmac_f32 v72, v28, v39
    v_fmac_f32 v73, v29, v39
    v_fmac_f32 v74, v30, v39
    v_fmac_f32 v75, v31, v39
    v_mul_f32 v72, v72, v32
    v_mul_f32 v73, v73, v33
    v_mul_f32 v74, v74, v34
    v_mul_f32 v75, v75, v35
    v_cvt_pk_bf16_f32 v72, v72, v73
    v_cvt_pk_bf16_f32 v73, v74, v75
    ds_write_b64 v125, v[72:73] offset:1536
    v_mov_b32 v8, 157976
    v_mov_b32 v9, 1
    s_mov_b64 exec, 1
    ds_add_u32 v8, v9
    s_mov_b64 exec, -1
    s_branch Lagent
Lst_re:
    s_sub_u32 s35, s35, 1
    s_cbranch_scc1 Lend
    buffer_load_dwordx2 v[92:93], v96, s[28:31], s46 offen sc1
    buffer_load_dwordx2 v[94:95], v97, s[28:31], s46 offen sc1
    s_waitcnt vmcnt(0)
    s_branch Lst_chk
Laux:
    s_lshl_b32 s32, s37, 3
    s_lshl_b32 s39, s38, 2
    s_add_u32 s32, s32, s36
    s_cmp_lt_u32 s37, 4
    s_cselect_b32 s39, s39, 0
    s_add_u32 s32, s32, s39
    s_and_b32 s33, s2, 3
    s_lshl_b32 s33, s33, 3
    s_and_b32 s39, s2, 4
    s_add_u32 s33, s33, s39
    s_add_u32 s33, s33, s37
    s_cmp_ge_u32 s32, 32
    s_cbranch_scc1 Lmst
    v_lshrrev_b32 v5, 3, v1
    v_and_b32 v6, 7, v1
    s_lshl_b32 s40, s3, 14
    s_cmp_eq_u32 s27, 0
    s_cbranch_scc0 Laux_u
    s_lshl_b32 s36, s33, 6
    s_lshl_b32 s37, s26, 4
    s_add_u32 s36, s36, s37
    v_add_u32 v7, s36, v5
    v_mul_u32_u24 v7, 1280, v7
    v_xor_b32 v8, v6, v2
    v_lshl_add_u32 v92, v8, 4, v7
    v_add_u32 v92, 4096, v92
    v_xor_b32 v93, 64, v92
    v_add_u32 v93, 9216, v93
    v_subrev_u32 v94, 1920, v92
    v_subrev_u32 v95, 1920, v93
    s_waitcnt lgkmcnt(0)
    s_sub_u32 s52, s4, 4096
    s_subb_u32 s53, s5, 0
    s_mov_b32 s54, 2625536
    s_mov_b32 s55, 0x20000
    s_mov_b64 s[60:61], s[12:13]
    s_mov_b32 s62, 1280
    s_mov_b32 s63, 0x20000
    s_mov_b32 m0, 131072
    s_nop 0
    buffer_load_dwordx4 v13, s[60:63], 0 offen lds
    s_mov_b64 exec, 0xffff
    buffer_load_dwordx4 v13, s[60:63], 0 offen offset:1024 lds
    s_mov_b64 exec, -1
    s_add_u32 m0, s40, 0
    s_mov_b32 s41, 0
    buffer_load_dwordx4 v92, s[52:55], s41 offen lds
    buffer_load_dwordx4 v93, s[52:55], s41 offen offset:1024 lds
    buffer_load_dwordx4 v94, s[52:55], s41 offen offset:2048 lds
    buffer_load_dwordx4 v95, s[52:55], s41 offen offset:3072 lds
    s_add_u32 m0, s40, 4096
    s_mov_b32 s41, 256
    buffer_load_dwordx4 v92, s[52:55], s41 offen lds
    buffer_load_dwordx4 v93, s[52:55], s41 offen offset:1024 lds
    buffer_load_dwordx4 v94, s[52:55], s41 offen offset:2048 lds
    buffer_load_dwordx4 v95, s[52:55], s41 offen offset:3072 lds
    s_add_u32 m0, s40, 8192
    s_mov_b32 s41, 512
    buffer_load_dwordx4 v92, s[52:55], s41 offen lds
    buffer_load_dwordx4 v93, s[52:55], s41 offen offset:1024 lds
    buffer_load_dwordx4 v94, s[52:55], s41 offen offset:2048 lds
    buffer_load_dwordx4 v95, s[52:55], s41 offen offset:3072 lds
    s_add_u32 m0, s40, 12288
    s_mov_b32 s41, 768
    buffer_load_dwordx4 v92, s[52:55], s41 offen lds
    buffer_load_dwordx4 v93, s[52:55], s41 offen offset:1024 lds
    buffer_load_dwordx4 v94, s[52:55], s41 offen offset:2048 lds
    buffer_load_dwordx4 v95, s[52:55], s41 offen offset:3072 lds
    s_mov_b64 s[28:29], s[24:25]
    s_mov_b32 s30, 268435456
    s_mov_b32 s31, 0x20000
    s_load_dword s34, s[28:29], 0
    s_mov_b64 s[44:45], s[14:15]
    s_mov_b32 s46, 2211840
    s_mov_b32 s47, 0x20000
    s_mov_b64 s[48:49], s[18:19]
    s_mov_b32 s50, 2211840
    s_mov_b32 s51, 0x20000
    v_and_b32 v8, 1, v2
    v_lshlrev_b32 v8, 1, v8
    v_xor_b32 v8, v8, v6
    v_lshlrev_b32 v8, 4, v8
    v_mul_u32_u24 v9, 3456, v5
    s_lshl_b32 s38, s32, 7
    v_add3_u32 v18, v9, v8, s38
    v_xor_b32 v19, 64, v18
    v_add_u32 v19, 26624, v19
    v_add_u32 v20, 53248, v18
    v_add_u32 v21, 53248, v19
    s_mul_i32 s42, s26, 110592
    v_mul_u32_u24 v9, 1280, v5
    v_add_u32 v22, v9, v8
    v_xor_b32 v23, 64, v22
    v_add_u32 v23, 9216, v23
    v_add_u32 v24, 18432, v22
    v_add_u32 v25, 18432, v23
    s_mul_i32 s43, s32, 81920
    s_lshl_b32 s38, s3, 7
    s_add_u32 s43, s43, s38
    v_mov_b32 v96, 0x3f803f80
    v_mov_b32 v97, 0x3f803f80
    v_mov_b32 v98, 0x3f803f80
    v_mov_b32 v99, 0x3f803f80
    v_lshlrev_b32 v100, 4, v2
    v_add_u32 v100, 131072, v100
    v_lshrrev_b32 v10, 1, v3
    v_xor_b32 v10, v10, v2
    v_lshlrev_b32 v10, 4, v10
    v_lshl_add_u32 v10, v3, 7, v10
    v_add_u32 v102, s40, v10
    v_xor_b32 v103, 64, v102
    s_mov_b32 s58, 0xaaaaaaaa
    s_mov_b32 s59, 0xaaaaaaaa
    s_mov_b32 s64, 0xcccccccc
    s_mov_b32 s65, 0xcccccccc
    v_lshrrev_b32 v101, 2, v3
    v_lshl_add_u32 v101, v101, 4, v3
    v_lshlrev_b32 v101, 2, v101
    s_lshl_b32 s36, s26, 4
    v_add_u32 v10, s36, v3
    s_lshl_b32 s37, s33, 6
    s_sub_u32 s37, 2047, s37
    v_sub_u32 v106, s37, v10
    v_lshlrev_b32 v107, 2, v10
    v_add_u32 v107, 132608, v107
    s_lshl_b32 s36, s33, 9
    s_add_u32 s36, s36, 8192000
    v_lshl_add_u32 v108, v10, 3, s36
    v_bfe_u32 v10, v1, 2, 2
    v_and_b32 v8, 3, v1
    v_lshl_add_u32 v14, v2, 3, v10
    v_lshlrev_b32 v14, 7, v14
    v_lshlrev_b32 v9, 2, v1
    v_and_b32 v9, 0x60, v9
    v_add3_u32 v14, v14, v9, s40
    v_lshl_add_u32 v14, v8, 3, v14
    v_xor_b32 v15, 32, v14
    v_xor_b32 v16, 64, v14
    v_xor_b32 v17, 96, v14
    s_lshl_b32 s36, s26, 6
    s_add_u32 s36, s36, 141312
    v_lshl_add_u32 v26, v2, 4, s36
    v_min_u32 v8, 2, v3
    v_mul_u32_u24 v8, 1536, v8
    v_add_u32 v26, v26, v8
    v_add_u32 v4, 132864, v12
    v_mov_b32 v5, 0
    ds_write_b32 v4, v5
    s_waitcnt lgkmcnt(0)
    s_add_u32 s34, s34, 0x9e3779b8
    s_or_b32 s34, s34, 1
    s_waitcnt vmcnt(12)
    ds_read_b128 a[80:83], v102 offset:0
    ds_read_b128 a[84:87], v100 offset:0
    ds_read_b128 a[88:91], v103 offset:0
    ds_read_b128 a[92:95], v100 offset:64
    ds_read_b128 a[96:99], v102 offset:2048
    ds_read_b128 a[100:103], v100 offset:128
    ds_read_b128 a[104:107], v103 offset:2048
    ds_read_b128 a[108:111], v100 offset:192
    s_waitcnt lgkmcnt(0)
    s_add_u32 m0, s40, 0
    s_mov_b32 s41, 1024
    buffer_load_dwordx4 v92, s[52:55], s41 offen lds
    buffer_load_dwordx4 v93, s[52:55], s41 offen offset:1024 lds
    buffer_load_dwordx4 v94, s[52:55], s41 offen offset:2048 lds
    buffer_load_dwordx4 v95, s[52:55], s41 offen offset:3072 lds
    s_barrier
    v_mfma_f32_16x16x32_bf16 v[116:119], a[80:83], a[80:83], 0
    v_mfma_f32_16x16x32_bf16 v[112:115], v[96:99], a[80:83], 0
    v_mfma_f32_16x16x32_bf16 v[120:123], a[84:87], a[80:83], 0
    v_mfma_f32_16x16x32_bf16 v[124:127], a[84:87], v[96:99], 0
    v_mfma_f32_16x16x32_bf16 v[116:119], a[88:91], a[88:91], v[116:119]
    v_mfma_f32_16x16x32_bf16 v[112:115], v[96:99], a[88:91], v[112:115]
    v_mfma_f32_16x16x32_bf16 v[120:123], a[92:95], a[88:91], v[120:123]
    v_mfma_f32_16x16x32_bf16 v[124:127], a[92:95], v[96:99], v[124:127]
    v_mfma_f32_16x16x32_bf16 v[116:119], a[96:99], a[96:99], v[116:119]
    v_mfma_f32_16x16x32_bf16 v[112:115], v[96:99], a[96:99], v[112:115]
    v_mfma_f32_16x16x32_bf16 v[120:123], a[100:103], a[96:99], v[120:123]
    v_mfma_f32_16x16x32_bf16 v[124:127], a[100:103], v[96:99], v[124:127]
    v_mfma_f32_16x16x32_bf16 v[116:119], a[104:107], a[104:107], v[116:119]
    v_mfma_f32_16x16x32_bf16 v[112:115], v[96:99], a[104:107], v[112:115]
    v_mfma_f32_16x16x32_bf16 v[120:123], a[108:111], a[104:107], v[120:123]
    v_mfma_f32_16x16x32_bf16 v[124:127], a[108:111], v[96:99], v[124:127]
    s_waitcnt vmcnt(12)
    ds_read_b128 a[80:83], v102 offset:4096
    ds_read_b128 a[84:87], v100 offset:256
    ds_read_b128 a[88:91], v103 offset:4096
    ds_read_b128 a[92:95], v100 offset:320
    ds_read_b128 a[96:99], v102 offset:6144
    ds_read_b128 a[100:103], v100 offset:384
    ds_read_b128 a[104:107], v103 offset:6144
    ds_read_b128 a[108:111], v100 offset:448
    s_waitcnt lgkmcnt(0)
    v_mfma_f32_16x16x32_bf16 v[116:119], a[80:83], a[80:83], v[116:119]
    v_mfma_f32_16x16x32_bf16 v[112:115], v[96:99], a[80:83], v[112:115]
    v_mfma_f32_16x16x32_bf16 v[120:123], a[84:87], a[80:83], v[120:123]
    v_mfma_f32_16x16x32_bf16 v[124:127], a[84:87], v[96:99], v[124:127]
    v_mfma_f32_16x16x32_bf16 v[116:119], a[88:91], a[88:91], v[116:119]
    v_mfma_f32_16x16x32_bf16 v[112:115], v[96:99], a[88:91], v[112:115]
    v_mfma_f32_16x16x32_bf16 v[120:123], a[92:95], a[88:91], v[120:123]
    v_mfma_f32_16x16x32_bf16 v[124:127], a[92:95], v[96:99], v[124:127]
    v_mfma_f32_16x16x32_bf16 v[116:119], a[96:99], a[96:99], v[116:119]
    v_mfma_f32_16x16x32_bf16 v[112:115], v[96:99], a[96:99], v[112:115]
    v_mfma_f32_16x16x32_bf16 v[120:123], a[100:103], a[96:99], v[120:123]
    v_mfma_f32_16x16x32_bf16 v[124:127], a[100:103], v[96:99], v[124:127]
    v_mfma_f32_16x16x32_bf16 v[116:119], a[104:107], a[104:107], v[116:119]
    v_mfma_f32_16x16x32_bf16 v[112:115], v[96:99], a[104:107], v[112:115]
    v_mfma_f32_16x16x32_bf16 v[120:123], a[108:111], a[104:107], v[120:123]
    v_mfma_f32_16x16x32_bf16 v[124:127], a[108:111], v[96:99], v[124:127]
    s_waitcnt vmcnt(8)
    ds_read_b128 a[80:83], v102 offset:8192
    ds_read_b128 a[84:87], v100 offset:512
    ds_read_b128 a[88:91], v103 offset:8192
    ds_read_b128 a[92:95], v100 offset:576
    ds_read_b128 a[96:99], v102 offset:10240
    ds_read_b128 a[100:103], v100 offset:640
    ds_read_b128 a[104:107], v103 offset:10240
    ds_read_b128 a[108:111], v100 offset:704
    s_waitcnt lgkmcnt(0)
    v_mfma_f32_16x16x32_bf16 v[116:119], a[80:83], a[80:83], v[116:119]
    v_mfma_f32_16x16x32_bf16 v[112:115], v[96:99], a[80:83], v[112:115]
    v_mfma_f32_16x16x32_bf16 v[120:123], a[84:87], a[80:83], v[120:123]
    v_mfma_f32_16x16x32_bf16 v[124:127], a[84:87], v[96:99], v[124:127]
    v_mfma_f32_16x16x32_bf16 v[116:119], a[88:91], a[88:91], v[116:119]
    v_mfma_f32_16x16x32_bf16 v[112:115], v[96:99], a[88:91], v[112:115]
    v_mfma_f32_16x16x32_bf16 v[120:123], a[92:95], a[88:91], v[120:123]
    v_mfma_f32_16x16x32_bf16 v[124:127], a[92:95], v[96:99], v[124:127]
    v_mfma_f32_16x16x32_bf16 v[116:119], a[96:99], a[96:99], v[116:119]
    v_mfma_f32_16x16x32_bf16 v[112:115], v[96:99], a[96:99], v[112:115]
    v_mfma_f32_16x16x32_bf16 v[120:123], a[100:103], a[96:99], v[120:123]
    v_mfma_f32_16x16x32_bf16 v[124:127], a[100:103], v[96:99], v[124:127]
    v_mfma_f32_16x16x32_bf16 v[116:119], a[104:107], a[104:107], v[116:119]
    v_mfma_f32_16x16x32_bf16 v[112:115], v[96:99], a[104:107], v[112:115]
    v_mfma_f32_16x16x32_bf16 v[120:123], a[108:111], a[104:107], v[120:123]
    v_mfma_f32_16x16x32_bf16 v[124:127], a[108:111], v[96:99], v[124:127]
    s_waitcnt vmcnt(4)
    ds_read_b128 a[80:83], v102 offset:12288
    ds_read_b128 a[84:87], v100 offset:768
    ds_read_b128 a[88:91], v103 offset:12288
    ds_read_b128 a[92:95], v100 offset:832
    ds_read_b128 a[96:99], v102 offset:14336
    ds_read_b128 a[100:103], v100 offset:896
    ds_read_b128 a[104:107], v103 offset:14336
    ds_read_b128 a[108:111], v100 offset:960
    s_waitcnt lgkmcnt(0)
    v_mfma_f32_16x16x32_bf16 v[116:119], a[80:83], a[80:83], v[116:119]
    v_mfma_f32_16x16x32_bf16 v[112:115], v[96:99], a[80:83], v[112:115]
    v_mfma_f32_16x16x32_bf16 v[120:123], a[84:87], a[80:83], v[120:123]
    v_mfma_f32_16x16x32_bf16 v[124:127], a[84:87], v[96:99], v[124:127]
    v_mfma_f32_16x16x32_bf16 v[116:119], a[88:91], a[88:91], v[116:119]
    v_mfma_f32_16x16x32_bf16 v[112:115], v[96:99], a[88:91], v[112:115]
    v_mfma_f32_16x16x32_bf16 v[120:123], a[92:95], a[88:91], v[120:123]
    v_mfma_f32_16x16x32_bf16 v[124:127], a[92:95], v[96:99], v[124:127]
    v_mfma_f32_16x16x32_bf16 v[116:119], a[96:99], a[96:99], v[116:119]
    v_mfma_f32_16x16x32_bf16 v[112:115], v[96:99], a[96:99], v[112:115]
    v_mfma_f32_16x16x32_bf16 v[120:123], a[100:103], a[96:99], v[120:123]
    v_mfma_f32_16x16x32_bf16 v[124:127], a[100:103], v[96:99], v[124:127]
    v_mfma_f32_16x16x32_bf16 v[116:119], a[104:107], a[104:107], v[116:119]
    v_mfma_f32_16x16x32_bf16 v[112:115], v[96:99], a[104:107], v[112:115]
    v_mfma_f32_16x16x32_bf16 v[120:123], a[108:111], a[104:107], v[120:123]
    v_mfma_f32_16x16x32_bf16 v[124:127], a[108:111], v[96:99], v[124:127]
    s_waitcnt vmcnt(0)
    ds_read_b128 a[80:83], v102 offset:0
    ds_read_b128 a[84:87], v100 offset:1024
    ds_read_b128 a[88:91], v103 offset:0
    ds_read_b128 a[92:95], v100 offset:1088
    ds_read_b128 a[96:99], v102 offset:2048
    ds_read_b128 a[100:103], v100 offset:1152
    ds_read_b128 a[104:107], v103 offset:2048
    ds_read_b128 a[108:111], v100 offset:1216
    s_waitcnt lgkmcnt(0)
    v_mfma_f32_16x16x32_bf16 v[116:119], a[80:83], a[80:83], v[116:119]
    v_mfma_f32_16x16x32_bf16 v[112:115], v[96:99], a[80:83], v[112:115]
    v_mfma_f32_16x16x32_bf16 v[120:123], a[84:87], a[80:83], v[120:123]
    v_mfma_f32_16x16x32_bf16 v[124:127], a[84:87], v[96:99], v[124:127]
    v_mfma_f32_16x16x32_bf16 v[116:119], a[88:91], a[88:91], v[116:119]
    v_mfma_f32_16x16x32_bf16 v[112:115], v[96:99], a[88:91], v[112:115]
    v_mfma_f32_16x16x32_bf16 v[120:123], a[92:95], a[88:91], v[120:123]
    v_mfma_f32_16x16x32_bf16 v[124:127], a[92:95], v[96:99], v[124:127]
    v_mfma_f32_16x16x32_bf16 v[116:119], a[96:99], a[96:99], v[116:119]
    v_mfma_f32_16x16x32_bf16 v[112:115], v[96:99], a[96:99], v[112:115]
    v_mfma_f32_16x16x32_bf16 v[120:123], a[100:103], a[96:99], v[120:123]
    v_mfma_f32_16x16x32_bf16 v[124:127], a[100:103], v[96:99], v[124:127]
    v_mfma_f32_16x16x32_bf16 v[116:119], a[104:107], a[104:107], v[116:119]
    v_mfma_f32_16x16x32_bf16 v[112:115], v[96:99], a[104:107], v[112:115]
    v_mfma_f32_16x16x32_bf16 v[120:123], a[108:111], a[104:107], v[120:123]
    v_mfma_f32_16x16x32_bf16 v[124:127], a[108:111], v[96:99], v[124:127]
    s_nop 4
    v_cndmask_b32 v4, v116, v117, s[58:59]
    v_cndmask_b32 v5, v118, v119, s[58:59]
    v_cndmask_b32 v4, v4, v5, s[64:65]
    ds_bpermute_b32 v4, v101, v4
    v_mul_f32 v5, 0xbacccccd, v112
    v_cvt_pk_bf16_f32 v104, v5, v5
    v_lshlrev_b32 v104, 16, v104
    v_mul_f32 v5, v5, v5
    v_mov_b32 v6, 0x3acccccd
    s_waitcnt lgkmcnt(0)
    v_fma_f32 v4, v4, v6, -v5
    v_max_f32 v4, 0, v4
    v_cvt_pk_bf16_f32 v4, v4, v4
    v_lshlrev_b32 v4, 16, v4
    v_add_f32 v4, 0x3727c5ac, v4
    v_cvt_pk_bf16_f32 v4, v4, v4
    v_lshlrev_b32 v4, 16, v4
    v_sqrt_f32 v4, v4
    s_nop 0
    v_cvt_pk_bf16_f32 v4, v4, v4
    v_lshlrev_b32 v4, 16, v4
    v_rcp_f32 v105, v4
    v_lshrrev_b32 v8, 16, v4
    v_fma_f32 v4, v104, v124, v120
    v_mul_f32 v4, v4, v105
    v_cvt_pk_bf16_f32 v4, v4, v4
    v_ashrrev_i32 v5, 31, v4
    v_or_b32 v5, 0x80000000, v5
    v_xor_b32 v4, v4, v5
    v_and_b32 v4, 0xffff0000, v4
    v_or_b32 v4, v4, v106
    ds_write_b32 v107, v4
    v_mov_b32 v11, 132864
    v_mov_b32 v7, 1
    s_mov_b64 exec, 1
    ds_add_u32 v11, v7
    s_mov_b64 exec, -1
    v_or_b32 v8, v8, v104
    v_mov_b32 v9, s34
    s_mov_b64 exec, 0xffff
    buffer_store_dwordx2 v[8:9], v108, s[28:31], 0 offen sc1
    s_mov_b64 exec, -1
    s_cmp_lg_u32 s26, 0
    s_cbranch_scc1 Lpub_done
    s_setprio 3
Lcw_9:
    s_sub_u32 s35, s35, 1
    s_cbranch_scc1 Lend
    ds_read_b32 v7, v11
    s_waitcnt lgkmcnt(0)
    v_readfirstlane_b32 s38, v7
    s_nop 0
    s_cmp_lt_u32 s38, 4
    s_cbranch_scc1 Lcw_9
    v_add_u32 v5, 132608, v12
    ds_read_b32 v6, v5
    s_waitcnt lgkmcnt(0)
    v_mov_b32 v4, v6
    s_nop 1
    v_max_u32_dpp v4, v4, v4 row_ror:8 row_mask:0xf bank_mask:0xf
    s_nop 1
    v_max_u32_dpp v4, v4, v4 row_ror:4 row_mask:0xf bank_mask:0xf
    s_nop 1
    v_max_u32_dpp v4, v4, v4 row_ror:2 row_mask:0xf bank_mask:0xf
    s_nop 1
    v_max_u32_dpp v4, v4, v4 row_ror:1 row_mask:0xf bank_mask:0xf
    s_nop 0
    v_readlane_b32 s66, v4, 0
    v_readlane_b32 s36, v4, 16
    v_readlane_b32 s37, v4, 32
    v_readlane_b32 s38, v4, 48
    s_max_u32 s66, s66, s36
    s_max_u32 s37, s37, s38
    s_max_u32 s66, s66, s37
    v_cmp_eq_u32 vcc, s66, v6
    s_nop 1
    v_cndmask_b32 v4, v6, 0, vcc
    s_nop 1
    v_max_u32_dpp v4, v4, v4 row_ror:8 row_mask:0xf bank_mask:0xf
    s_nop 1
    v_max_u32_dpp v4, v4, v4 row_ror:4 row_mask:0xf bank_mask:0xf
    s_nop 1
    v_max_u32_dpp v4, v4, v4 row_ror:2 row_mask:0xf bank_mask:0xf
    s_nop 1
    v_max_u32_dpp v4, v4, v4 row_ror:1 row_mask:0xf bank_mask:0xf
    s_nop 0
    v_readlane_b32 s67, v4, 0
    v_readlane_b32 s36, v4, 16
    v_readlane_b32 s37, v4, 32
    v_readlane_b32 s38, v4, 48
    s_max_u32 s67, s67, s36
    s_max_u32 s37, s37, s38
    s_max_u32 s67, s67, s37
    v_mov_b32 v112, s66
    v_mov_b32 v113, s34
    v_mov_b32 v114, s67
    v_mov_b32 v115, s34
    s_lshl_b32 s36, s32, 7
    s_add_u32 s36, s36, 8126464
    s_mov_b64 exec, 0xff
    buffer_store_dwordx4 v[112:115], v13, s[28:31], s36 offen sc1
    s_mov_b64 exec, -1
    v_mov_b32 v11, 132864
    v_mov_b32 v7, 1
    s_mov_b64 exec, 1
    ds_add_u32 v11, v7
    s_mov_b64 exec, -1
    s_mov_b64 exec, 1
    s_lshl_b32 s36, s2, 2
    s_add_u32 s36, s36, 8323072
    v_mov_b32 v4, s34
    v_mov_b32 v5, s36
    buffer_store_dword v4, v5, s[28:31], 0 offen sc1
    s_mov_b64 exec, -1
    s_setprio 0
Lpub_done:
Lcw_10:
    s_sub_u32 s35, s35, 1
    s_cbranch_scc1 Lend
    ds_read_b32 v7, v11
    s_waitcnt lgkmcnt(0)
    v_readfirstlane_b32 s38, v7
    s_nop 0
    s_cmp_lt_u32 s38, 5
    s_cbranch_scc1 Lcw_10
    s_cmp_ge_u32 s32, 27
    s_cbranch_scc1 Lhelp_r
    s_add_u32 m0, s40, 0
    s_add_u32 s41, s42, 0
    buffer_load_dwordx4 v18, s[44:47], s41 offen nt lds
    buffer_load_dwordx4 v19, s[44:47], s41 offen offset:1024 nt lds
    buffer_load_dwordx4 v20, s[44:47], s41 offen offset:2048 nt lds
    buffer_load_dwordx4 v21, s[44:47], s41 offen offset:3072 nt lds
    s_add_u32 m0, s40, 4096
    s_add_u32 s41, s42, 442368
    buffer_load_dwordx4 v18, s[44:47], s41 offen nt lds
    buffer_load_dwordx4 v19, s[44:47], s41 offen offset:1024 nt lds
    buffer_load_dwordx4 v20, s[44:47], s41 offen offset:2048 nt lds
    buffer_load_dwordx4 v21, s[44:47], s41 offen offset:3072 nt lds
    s_add_u32 m0, s40, 8192
    s_add_u32 s41, s42, 884736
    buffer_load_dwordx4 v18, s[44:47], s41 offen nt lds
    buffer_load_dwordx4 v19, s[44:47], s41 offen offset:1024 nt lds
    buffer_load_dwordx4 v20, s[44:47], s41 offen offset:2048 nt lds
    buffer_load_dwordx4 v21, s[44:47], s41 offen offset:3072 nt lds
    s_add_u32 m0, s40, 12288
    s_add_u32 s41, s42, 1327104
    buffer_load_dwordx4 v18, s[44:47], s41 offen nt lds
    buffer_load_dwordx4 v19, s[44:47], s41 offen offset:1024 nt lds
    buffer_load_dwordx4 v20, s[44:47], s41 offen offset:2048 nt lds
    buffer_load_dwordx4 v21, s[44:47], s41 offen offset:3072 nt lds
    s_waitcnt vmcnt(12)
    ds_read_b64_tr_b16 a[0:1], v14 offset:0
    ds_read_b64_tr_b16 a[2:3], v14 offset:512
    ds_read_b64_tr_b16 a[4:5], v15 offset:0
    ds_read_b64_tr_b16 a[6:7], v15 offset:512
    ds_read_b64_tr_b16 a[8:9], v16 offset:0
    ds_read_b64_tr_b16 a[10:11], v16 offset:512
    ds_read_b64_tr_b16 a[12:13], v17 offset:0
    ds_read_b64_tr_b16 a[14:15], v17 offset:512
    s_waitcnt lgkmcnt(0)
    s_add_u32 m0, s40, 0
    s_add_u32 s41, s42, 1769472
    buffer_load_dwordx4 v18, s[44:47], s41 offen nt lds
    buffer_load_dwordx4 v19, s[44:47], s41 offen offset:1024 nt lds
    buffer_load_dwordx4 v20, s[44:47], s41 offen offset:2048 nt lds
    buffer_load_dwordx4 v21, s[44:47], s41 offen offset:3072 nt lds
    v_mov_b32 v11, 132864
    v_mov_b32 v7, 1
    s_mov_b64 exec, 1
    ds_add_u32 v11, v7
    s_mov_b64 exec, -1
    s_waitcnt vmcnt(12)
    ds_read_b64_tr_b16 a[16:17], v14 offset:4096
    ds_read_b64_tr_b16 a[18:19], v14 offset:4608
    ds_read_b64_tr_b16 a[20:21], v15 offset:4096
    ds_read_b64_tr_b16 a[22:23], v15 offset:4608
    ds_read_b64_tr_b16 a[24:25], v16 offset:4096
    ds_read_b64_tr_b16 a[26:27], v16 offset:4608
    ds_read_b64_tr_b16 a[28:29], v17 offset:4096
    ds_read_b64_tr_b16 a[30:31], v17 offset:4608
    s_waitcnt lgkmcnt(0)
    s_add_u32 m0, s40, 4096
    s_add_u32 s41, s43, 0
    buffer_load_dwordx4 v22, s[48:51], s41 offen nt lds
    buffer_load_dwordx4 v23, s[48:51], s41 offen offset:1024 nt lds
    buffer_load_dwordx4 v24, s[48:51], s41 offen offset:2048 nt lds
    buffer_load_dwordx4 v25, s[48:51], s41 offen offset:3072 nt lds
    s_waitcnt vmcnt(12)
    ds_read_b64_tr_b16 a[32:33], v14 offset:8192
    ds_read_b64_tr_b16 a[34:35], v14 offset:8704
    ds_read_b64_tr_b16 a[36:37], v15 offset:8192
    ds_read_b64_tr_b16 a[38:39], v15 offset:8704
    ds_read_b64_tr_b16 a[40:41], v16 offset:8192
    ds_read_b64_tr_b16 a[42:43], v16 offset:8704
    ds_read_b64_tr_b16 a[44:45], v17 offset:8192
    ds_read_b64_tr_b16 a[46:47], v17 offset:8704
    s_waitcnt lgkmcnt(0)
    s_add_u32 m0, s40, 8192
    s_add_u32 s41, s43, 40960
    buffer_load_dwordx4 v22, s[48:51], s41 offen nt lds
    buffer_load_dwordx4 v23, s[48:51], s41 offen offset:1024 nt lds
    buffer_load_dwordx4 v24, s[48:51], s41 offen offset:2048 nt lds
    buffer_load_dwordx4 v25, s[48:51], s41 offen offset:3072 nt lds
    s_waitcnt vmcnt(12)
    ds_read_b64_tr_b16 a[48:49], v14 offset:12288
    ds_read_b64_tr_b16 a[50:51], v14 offset:12800
    ds_read_b64_tr_b16 a[52:53], v15 offset:12288
    ds_read_b64_tr_b16 a[54:55], v15 offset:12800
    ds_read_b64_tr_b16 a[56:57], v16 offset:12288
    ds_read_b64_tr_b16 a[58:59], v16 offset:12800
    ds_read_b64_tr_b16 a[60:61], v17 offset:12288
    ds_read_b64_tr_b16 a[62:63], v17 offset:12800
    s_waitcnt vmcnt(8)
    ds_read_b64_tr_b16 a[64:65], v14 offset:0
    ds_read_b64_tr_b16 a[66:67], v14 offset:512
    ds_read_b64_tr_b16 a[68:69], v15 offset:0
    ds_read_b64_tr_b16 a[70:71], v15 offset:512
    ds_read_b64_tr_b16 a[72:73], v16 offset:0
    ds_read_b64_tr_b16 a[74:75], v16 offset:512
    ds_read_b64_tr_b16 a[76:77], v17 offset:0
    ds_read_b64_tr_b16 a[78:79], v17 offset:512
    s_branch Laux_mm
Laux_u:
    s_cmp_ge_u32 s32, 27
    s_cbranch_scc1 Lend
    v_and_b32 v8, 1, v2
    v_lshlrev_b32 v8, 1, v8
    v_xor_b32 v8, v8, v6
    v_lshlrev_b32 v8, 4, v8
    v_mul_u32_u24 v9, 3456, v5
    s_lshl_b32 s38, s32, 7
    v_add3_u32 v18, v9, v8, s38
    v_xor_b32 v19, 64, v18
    v_add_u32 v19, 26624, v19
    v_add_u32 v20, 53248, v18
    v_add_u32 v21, 53248, v19
    s_mul_i32 s42, s26, 110592
    v_mul_u32_u24 v9, 1280, v5
    v_add_u32 v22, v9, v8
    v_xor_b32 v23, 64, v22
    v_add_u32 v23, 9216, v23
    v_add_u32 v24, 18432, v22
    v_add_u32 v25, 18432, v23
    s_mul_i32 s43, s32, 81920
    s_lshl_b32 s38, s3, 7
    s_add_u32 s43, s43, s38
    s_waitcnt lgkmcnt(0)
    s_mov_b64 s[44:45], s[16:17]
    s_mov_b32 s46, 2211840
    s_mov_b32 s47, 0x20000
    s_mov_b64 s[28:29], s[24:25]
    s_mov_b32 s30, 268435456
    s_mov_b32 s31, 0x20000
    s_load_dword s34, s[28:29], 0
    s_mov_b64 s[52:53], s[4:5]
    s_mov_b32 s54, 2621440
    s_mov_b32 s55, 0x20000
    s_mov_b64 s[48:49], s[18:19]
    s_mov_b32 s50, 2211840
    s_mov_b32 s51, 0x20000
    s_mov_b64 s[68:69], s[18:19]
    s_mov_b32 s70, 2211840
    s_mov_b32 s71, 0x20000
    s_cmp_ge_u32 s26, 2
    s_cselect_b32 s70, 0, s70
    v_bfe_u32 v10, v1, 2, 2
    v_and_b32 v8, 3, v1
    v_lshl_add_u32 v14, v2, 3, v10
    v_lshlrev_b32 v14, 7, v14
    v_lshlrev_b32 v9, 2, v1
    v_and_b32 v9, 0x60, v9
    v_add3_u32 v14, v14, v9, s40
    v_lshl_add_u32 v14, v8, 3, v14
    v_xor_b32 v15, 32, v14
    v_xor_b32 v16, 64, v14
    v_xor_b32 v17, 96, v14
    s_lshl_b32 s36, s26, 6
    s_add_u32 s36, s36, 141312
    v_lshl_add_u32 v26, v2, 4, s36
    v_min_u32 v8, 2, v3
    v_mul_u32_u24 v8, 1536, v8
    v_add_u32 v26, v26, v8
    s_waitcnt lgkmcnt(0)
    s_add_u32 s34, s34, 0x9e3779b8
    s_or_b32 s34, s34, 1
    s_cmp_lg_u32 s3, 7
    s_cbranch_scc1 Lnop7
    s_setprio 3
Lnop7:
    s_barrier
    s_add_u32 m0, s40, 0
    s_add_u32 s41, s42, 0
    buffer_load_dwordx4 v18, s[44:47], s41 offen nt lds
    buffer_load_dwordx4 v19, s[44:47], s41 offen offset:1024 nt lds
    buffer_load_dwordx4 v20, s[44:47], s41 offen offset:2048 nt lds
    buffer_load_dwordx4 v21, s[44:47], s41 offen offset:3072 nt lds
    s_add_u32 m0, s40, 4096
    s_add_u32 s41, s42, 442368
    buffer_load_dwordx4 v18, s[44:47], s41 offen nt lds
    buffer_load_dwordx4 v19, s[44:47], s41 offen offset:1024 nt lds
    buffer_load_dwordx4 v20, s[44:47], s41 offen offset:2048 nt lds
    buffer_load_dwordx4 v21, s[44:47], s41 offen offset:3072 nt lds
    s_add_u32 m0, s40, 8192
    s_add_u32 s41, s42, 884736
    buffer_load_dwordx4 v18, s[44:47], s41 offen nt lds
    buffer_load_dwordx4 v19, s[44:47], s41 offen offset:1024 nt lds
    buffer_load_dwordx4 v20, s[44:47], s41 offen offset:2048 nt lds
    buffer_load_dwordx4 v21, s[44:47], s41 offen offset:3072 nt lds
    s_add_u32 m0, s40, 12288
    s_add_u32 s41, s42, 1327104
    buffer_load_dwordx4 v18, s[44:47], s41 offen nt lds
    buffer_load_dwordx4 v19, s[44:47], s41 offen offset:1024 nt lds
    buffer_load_dwordx4 v20, s[44:47], s41 offen offset:2048 nt lds
    buffer_load_dwordx4 v21, s[44:47], s41 offen offset:3072 nt lds
    v_mov_b32 v11, 132864
Lcw_11:
    s_sub_u32 s35, s35, 1
    s_cbranch_scc1 Lend
    s_sleep 4
    ds_read_b32 v7, v11
    s_waitcnt lgkmcnt(0)
    v_readfirstlane_b32 s38, v7
    s_nop 0
    s_cmp_lt_u32 s38, 5
    s_cbranch_scc1 Lcw_11
    s_waitcnt vmcnt(12)
    ds_read_b64_tr_b16 a[0:1], v14 offset:0
    ds_read_b64_tr_b16 a[2:3], v14 offset:512
    ds_read_b64_tr_b16 a[4:5], v15 offset:0
    ds_read_b64_tr_b16 a[6:7], v15 offset:512
    ds_read_b64_tr_b16 a[8:9], v16 offset:0
    ds_read_b64_tr_b16 a[10:11], v16 offset:512
    ds_read_b64_tr_b16 a[12:13], v17 offset:0
    ds_read_b64_tr_b16 a[14:15], v17 offset:512
    s_waitcnt lgkmcnt(0)
    s_add_u32 m0, s40, 0
    s_add_u32 s41, s42, 1769472
    buffer_load_dwordx4 v18, s[44:47], s41 offen nt lds
    buffer_load_dwordx4 v19, s[44:47], s41 offen offset:1024 nt lds
    buffer_load_dwordx4 v20, s[44:47], s41 offen offset:2048 nt lds
    buffer_load_dwordx4 v21, s[44:47], s41 offen offset:3072 nt lds
    s_waitcnt vmcnt(12)
    ds_read_b64_tr_b16 a[16:17], v14 offset:4096
    ds_read_b64_tr_b16 a[18:19], v14 offset:4608
    ds_read_b64_tr_b16 a[20:21], v15 offset:4096
    ds_read_b64_tr_b16 a[22:23], v15 offset:4608
    ds_read_b64_tr_b16 a[24:25], v16 offset:4096
    ds_read_b64_tr_b16 a[26:27], v16 offset:4608
    ds_read_b64_tr_b16 a[28:29], v17 offset:4096
    ds_read_b64_tr_b16 a[30:31], v17 offset:4608
    s_waitcnt vmcnt(8)
    ds_read_b64_tr_b16 a[32:33], v14 offset:8192
    ds_read_b64_tr_b16 a[34:35], v14 offset:8704
    ds_read_b64_tr_b16 a[36:37], v15 offset:8192
    ds_read_b64_tr_b16 a[38:39], v15 offset:8704
    ds_read_b64_tr_b16 a[40:41], v16 offset:8192
    ds_read_b64_tr_b16 a[42:43], v16 offset:8704
    ds_read_b64_tr_b16 a[44:45], v17 offset:8192
    ds_read_b64_tr_b16 a[46:47], v17 offset:8704
    s_waitcnt vmcnt(4)
    ds_read_b64_tr_b16 a[48:49], v14 offset:12288
    ds_read_b64_tr_b16 a[50:51], v14 offset:12800
    ds_read_b64_tr_b16 a[52:53], v15 offset:12288
    ds_read_b64_tr_b16 a[54:55], v15 offset:12800
    ds_read_b64_tr_b16 a[56:57], v16 offset:12288
    ds_read_b64_tr_b16 a[58:59], v16 offset:12800
    ds_read_b64_tr_b16 a[60:61], v17 offset:12288
    ds_read_b64_tr_b16 a[62:63], v17 offset:12800
    s_waitcnt vmcnt(0)
    ds_read_b64_tr_b16 a[64:65], v14 offset:0
    ds_read_b64_tr_b16 a[66:67], v14 offset:512
    ds_read_b64_tr_b16 a[68:69], v15 offset:0
    ds_read_b64_tr_b16 a[70:71], v15 offset:512
    ds_read_b64_tr_b16 a[72:73], v16 offset:0
    ds_read_b64_tr_b16 a[74:75], v16 offset:512
    ds_read_b64_tr_b16 a[76:77], v17 offset:0
    ds_read_b64_tr_b16 a[78:79], v17 offset:512
    s_cmp_lg_u32 s3, 7
    s_cbranch_scc1 Lnofx
    v_mov_b32 v92, 0x3f803f80
    v_mov_b32 v93, 0x3f803f80
    v_mov_b32 v94, 0x3f803f80
    v_mov_b32 v95, 0x3f803f80
    v_add_u32 v4, 144384, v13
    ds_write_b128 v4, v[92:95]
    ds_write_b128 v4, v[92:95] offset:1024
    v_and_b32 v120, 31, v1
    v_lshlrev_b32 v120, 7, v120
    v_add_u32 v120, 8126464, v120
Lpt_12:
    s_sub_u32 s35, s35, 1
    s_cbranch_scc1 Lend
    s_sleep 2
    buffer_load_dwordx4 v[124:127], v120, s[28:31], 0 offen sc1
    s_waitcnt vmcnt(0)
    v_cmp_ne_u32 vcc, s34, v125
    v_cmp_ne_u32 s[36:37], s34, v127
    s_nop 0
    s_or_b64 s[36:37], s[36:37], vcc
    s_cbranch_scc1 Lpt_12
    v_mov_b32 v120, v124
    s_nop 1
    v_max_u32_dpp v120, v120, v120 row_ror:8 row_mask:0xf bank_mask:0xf
    s_nop 1
    v_max_u32_dpp v120, v120, v120 row_ror:4 row_mask:0xf bank_mask:0xf
    s_nop 1
    v_max_u32_dpp v120, v120, v120 row_ror:2 row_mask:0xf bank_mask:0xf
    s_nop 1
    v_max_u32_dpp v120, v120, v120 row_ror:1 row_mask:0xf bank_mask:0xf
    s_nop 0
    v_readlane_b32 s56, v120, 0
    v_readlane_b32 s36, v120, 16
    v_readlane_b32 s37, v120, 32
    v_readlane_b32 s38, v120, 48
    s_max_u32 s56, s56, s36
    s_max_u32 s37, s37, s38
    s_max_u32 s56, s56, s37
    v_cmp_eq_u32 vcc, s56, v124
    s_nop 1
    v_cndmask_b32 v120, v124, v126, vcc
    s_nop 1
    v_max_u32_dpp v120, v120, v120 row_ror:8 row_mask:0xf bank_mask:0xf
    s_nop 1
    v_max_u32_dpp v120, v120, v120 row_ror:4 row_mask:0xf bank_mask:0xf
    s_nop 1
    v_max_u32_dpp v120, v120, v120 row_ror:2 row_mask:0xf bank_mask:0xf
    s_nop 1
    v_max_u32_dpp v120, v120, v120 row_ror:1 row_mask:0xf bank_mask:0xf
    s_nop 0
    v_readlane_b32 s57, v120, 0
    v_readlane_b32 s36, v120, 16
    v_readlane_b32 s37, v120, 32
    v_readlane_b32 s38, v120, 48
    s_max_u32 s57, s57, s36
    s_max_u32 s37, s37, s38
    s_max_u32 s57, s57, s37
    s_and_b32 s36, s56, 0x7ff
    s_sub_u32 s36, 2047, s36
    s_and_b32 s37, s57, 0x7ff
    s_sub_u32 s37, 2047, s37
    s_mul_i32 s38, s36, 1280
    s_mul_i32 s39, s37, 1280
    s_mov_b32 m0, 141312
    v_mov_b32 v4, s36
    buffer_load_dwordx4 v13, s[52:55], s38 offen lds
    s_mov_b32 m0, 142848
    v_mov_b32 v5, s37
    buffer_load_dwordx4 v13, s[52:55], s39 offen lds
    s_mov_b64 exec, 0xffff
    buffer_load_dwordx4 v13, s[52:55], s39 offen offset:1024 lds
    s_mov_b32 m0, 141312
    s_mov_b32 vcc_lo, 0xaaaaaaaa
    buffer_load_dwordx4 v13, s[52:55], s38 offen offset:1024 lds
    s_mov_b64 exec, 3
    v_cndmask_b32 v4, v4, v5, vcc
    v_lshlrev_b32 v118, 3, v4
    v_add_u32 v118, 8192000, v118
    v_add_u32 v9, 132872, v12
Lxs_chk:
    s_sub_u32 s35, s35, 1
    s_cbranch_scc1 Lend
    buffer_load_dwordx2 v[116:117], v118, s[28:31], 0 offen sc1
    s_waitcnt vmcnt(0)
    v_cmp_ne_u32 vcc, s34, v117
    s_nop 0
    s_cbranch_vccnz Lxs_chk
    ds_write_b32 v9, v116
    s_mov_b64 exec, -1
    v_mov_b32 v10, 132868
    v_mov_b32 v7, 1
    s_mov_b64 exec, 1
    ds_add_u32 v10, v7
    s_mov_b64 exec, -1
Lnofx:
Lcw_13:
    s_sub_u32 s35, s35, 1
    s_cbranch_scc1 Lend
    s_sleep 2
    ds_read_b32 v7, v11
    s_waitcnt lgkmcnt(0)
    v_readfirstlane_b32 s38, v7
    s_nop 0
    s_cmp_lt_u32 s38, 9
    s_cbranch_scc1 Lcw_13
    s_add_u32 m0, s40, 4096
    s_add_u32 s41, s43, 0
    buffer_load_dwordx4 v22, s[48:51], s41 offen nt lds
    buffer_load_dwordx4 v23, s[48:51], s41 offen offset:1024 nt lds
    buffer_load_dwordx4 v24, s[48:51], s41 offen offset:2048 nt lds
    buffer_load_dwordx4 v25, s[48:51], s41 offen offset:3072 nt lds
    s_add_u32 m0, s40, 8192
    s_add_u32 s41, s43, 40960
    buffer_load_dwordx4 v22, s[48:51], s41 offen nt lds
    buffer_load_dwordx4 v23, s[48:51], s41 offen offset:1024 nt lds
    buffer_load_dwordx4 v24, s[48:51], s41 offen offset:2048 nt lds
    buffer_load_dwordx4 v25, s[48:51], s41 offen offset:3072 nt lds
    s_add_u32 m0, s40, 12288
    s_add_u32 s41, s43, 512
    buffer_load_dwordx4 v22, s[68:71], s41 offen nt lds
    buffer_load_dwordx4 v23, s[68:71], s41 offen offset:1024 nt lds
    buffer_load_dwordx4 v24, s[68:71], s41 offen offset:2048 nt lds
    buffer_load_dwordx4 v25, s[68:71], s41 offen offset:3072 nt lds
    s_add_u32 m0, s40, 0
    s_add_u32 s41, s43, 41472
    buffer_load_dwordx4 v22, s[68:71], s41 offen nt lds
    buffer_load_dwordx4 v23, s[68:71], s41 offen offset:1024 nt lds
    buffer_load_dwordx4 v24, s[68:71], s41 offen offset:2048 nt lds
    buffer_load_dwordx4 v25, s[68:71], s41 offen offset:3072 nt lds
Laux_mm:
    v_mov_b32 v10, 132868
Lcw_14:
    s_sub_u32 s35, s35, 1
    s_cbranch_scc1 Lend
    s_sleep 1
    ds_read_b32 v7, v10
    s_waitcnt lgkmcnt(0)
    v_readfirstlane_b32 s38, v7
    s_nop 0
    s_cmp_lt_u32 s38, 1
    s_cbranch_scc1 Lcw_14
    ds_read_b128 v[92:95], v26 offset:0
    ds_read_b128 v[96:99], v26 offset:256
    ds_read_b128 v[100:103], v26 offset:512
    ds_read_b128 v[104:107], v26 offset:768
    ds_read_b128 v[108:111], v26 offset:1024
    ds_read_b64 v[116:117], v10 offset:4
    s_waitcnt lgkmcnt(0)
    v_readfirstlane_b32 s56, v116
    v_readfirstlane_b32 s57, v117
    v_mfma_f32_16x16x32_bf16 v[112:115], a[0:3], v[92:95], 0
    v_mfma_f32_16x16x32_bf16 v[116:119], a[4:7], v[92:95], 0
    v_mfma_f32_16x16x32_bf16 v[120:123], a[8:11], v[92:95], 0
    v_mfma_f32_16x16x32_bf16 v[124:127], a[12:15], v[92:95], 0
    v_mfma_f32_16x16x32_bf16 v[112:115], a[16:19], v[96:99], v[112:115]
    v_mfma_f32_16x16x32_bf16 v[116:119], a[20:23], v[96:99], v[116:119]
    v_mfma_f32_16x16x32_bf16 v[120:123], a[24:27], v[96:99], v[120:123]
    v_mfma_f32_16x16x32_bf16 v[124:127], a[28:31], v[96:99], v[124:127]
    v_mfma_f32_16x16x32_bf16 v[112:115], a[32:35], v[100:103], v[112:115]
    v_mfma_f32_16x16x32_bf16 v[116:119], a[36:39], v[100:103], v[116:119]
    v_mfma_f32_16x16x32_bf16 v[120:123], a[40:43], v[100:103], v[120:123]
    v_mfma_f32_16x16x32_bf16 v[124:127], a[44:47], v[100:103], v[124:127]
    v_mfma_f32_16x16x32_bf16 v[112:115], a[48:51], v[104:107], v[112:115]
    v_mfma_f32_16x16x32_bf16 v[116:119], a[52:55], v[104:107], v[116:119]
    v_mfma_f32_16x16x32_bf16 v[120:123], a[56:59], v[104:107], v[120:123]
    v_mfma_f32_16x16x32_bf16 v[124:127], a[60:63], v[104:107], v[124:127]
    v_mfma_f32_16x16x32_bf16 v[112:115], a[64:67], v[108:111], v[112:115]
    v_mfma_f32_16x16x32_bf16 v[116:119], a[68:71], v[108:111], v[116:119]
    v_mfma_f32_16x16x32_bf16 v[120:123], a[72:75], v[108:111], v[120:123]
    v_mfma_f32_16x16x32_bf16 v[124:127], a[76:79], v[108:111], v[124:127]
    s_mul_i32 s36, s3, 768
    s_add_u32 s36, s36, 133120
    v_lshlrev_b32 v4, 8, v3
    v_lshl_add_u32 v4, v2, 4, v4
    v_add_u32 v4, s36, v4
    v_add_u32 v5, 133120, v12
    s_lshl_b32 s37, s3, 8
    s_add_u32 s37, s37, 139264
    v_lshl_add_u32 v6, v1, 1, s37
    v_and_b32 v7, 1, v1
    v_lshlrev_b32 v7, 7, v7
    v_lshl_add_u32 v7, v2, 4, v7
    v_add_u32 v7, s37, v7
    s_lshl_b32 s38, s56, 16
    s_lshl_b32 s39, s57, 16
    v_rcp_f32 v8, s38
    v_rcp_f32 v9, s39
    s_and_b32 s56, s56, 0xffff0000
    s_and_b32 s57, s57, 0xffff0000
    s_mov_b32 exec_lo, 0x00070007
    s_mov_b32 exec_hi, 0x00070007
    ds_write_b128 v4, v[112:115] offset:0
    ds_write_b128 v4, v[116:119] offset:64
    ds_write_b128 v4, v[120:123] offset:128
    ds_write_b128 v4, v[124:127] offset:192
    s_mov_b64 exec, -1
    s_waitcnt lgkmcnt(0)
    s_barrier
    ds_read2st64_b32 v[92:93], v5 offset0:0 offset1:1
    ds_read2st64_b32 v[94:95], v5 offset0:2 offset1:3
    ds_read2st64_b32 v[96:97], v5 offset0:4 offset1:5
    ds_read2st64_b32 v[98:99], v5 offset0:6 offset1:7
    ds_read2st64_b32 v[100:101], v5 offset0:8 offset1:9
    ds_read2st64_b32 v[102:103], v5 offset0:10 offset1:11
    ds_read2st64_b32 v[116:117], v5 offset0:12 offset1:13
    ds_read2st64_b32 v[118:119], v5 offset0:14 offset1:15
    ds_read2st64_b32 v[120:121], v5 offset0:16 offset1:17
    ds_read2st64_b32 v[122:123], v5 offset0:18 offset1:19
    ds_read2st64_b32 v[124:125], v5 offset0:20 offset1:21
    ds_read2st64_b32 v[126:127], v5 offset0:22 offset1:23
    v_cmp_eq_u32 s[72:73], 1, v2
    v_cmp_eq_u32 s[74:75], 2, v2
    v_cmp_eq_u32 s[76:77], 3, v2
    s_mul_i32 s37, s32, 10
    s_add_u32 s37, s37, s3
    s_lshl_b32 s37, s37, 10
    s_add_u32 s37, s37, 7405568
    s_waitcnt lgkmcnt(0)
    v_add_f32 v92, v92, v95
    v_add_f32 v98, v98, v101
    v_add_f32 v92, v92, v98
    v_add_f32 v93, v93, v96
    v_add_f32 v99, v99, v102
    v_add_f32 v93, v93, v99
    v_add_f32 v94, v94, v97
    v_add_f32 v100, v100, v103
    v_add_f32 v94, v94, v100
    v_add_f32 v116, v116, v119
    v_add_f32 v122, v122, v125
    v_add_f32 v116, v116, v122
    v_add_f32 v117, v117, v120
    v_add_f32 v123, v123, v126
    v_add_f32 v117, v117, v123
    v_add_f32 v118, v118, v121
    v_add_f32 v124, v124, v127
    v_add_f32 v118, v118, v124
    v_fmac_f32 v92, s56, v94
    v_mul_f32 v112, v92, v8
    v_fmac_f32 v93, s57, v94
    v_mul_f32 v113, v93, v9
    v_fmac_f32 v116, s56, v118
    v_mul_f32 v120, v116, v8
    v_fmac_f32 v117, s57, v118
    v_mul_f32 v121, v117, v9
    v_cvt_pk_bf16_f32 v113, v112, v113
    v_lshlrev_b32 v112, 16, v113
    v_and_b32 v113, 0xffff0000, v113
    v_cvt_pk_bf16_f32 v121, v120, v121
    v_lshlrev_b32 v120, 16, v121
    v_and_b32 v121, 0xffff0000, v121
    v_mul_f32 v114, 0xbfb8aa3b, v112
    v_mul_f32 v115, 0xbfb8aa3b, v113
    v_exp_f32 v114, v114
    v_exp_f32 v115, v115
    v_add_f32 v114, 1.0, v114
    v_add_f32 v115, 1.0, v115
    v_rcp_f32 v114, v114
    v_rcp_f32 v115, v115
    v_mul_f32 v114, v114, v112
    v_mul_f32 v115, v115, v113
    v_cvt_pk_bf16_f32 v115, v114, v115
    v_lshlrev_b32 v114, 16, v115
    v_and_b32 v115, 0xffff0000, v115
    v_mul_f32 v114, v114, v120
    v_mul_f32 v115, v115, v121
    v_cvt_pk_bf16_f32 v114, v114, v115
    ds_write_b16 v6, v114
    ds_write_b16_d16_hi v6, v114 offset:128
    ds_read_b128 v[92:95], v7 offset:0
    ds_read_b128 v[96:99], v7 offset:64
    v_mov_b32 v101, s34
    v_mov_b32 v103, s34
    s_waitcnt vmcnt(0)
    ds_read_b64_tr_b16 v[28:29], v14 offset:4096
    ds_read_b64_tr_b16 v[30:31], v14 offset:4608
    ds_read_b64_tr_b16 v[32:33], v15 offset:4096
    ds_read_b64_tr_b16 v[34:35], v15 offset:4608
    ds_read_b64_tr_b16 v[36:37], v16 offset:4096
    ds_read_b64_tr_b16 v[38:39], v16 offset:4608
    ds_read_b64_tr_b16 v[40:41], v17 offset:4096
    ds_read_b64_tr_b16 v[42:43], v17 offset:4608
    ds_read_b64_tr_b16 v[44:45], v14 offset:8192
    ds_read_b64_tr_b16 v[46:47], v14 offset:8704
    ds_read_b64_tr_b16 v[48:49], v15 offset:8192
    ds_read_b64_tr_b16 v[50:51], v15 offset:8704
    ds_read_b64_tr_b16 v[52:53], v16 offset:8192
    ds_read_b64_tr_b16 v[54:55], v16 offset:8704
    ds_read_b64_tr_b16 v[56:57], v17 offset:8192
    ds_read_b64_tr_b16 v[58:59], v17 offset:8704
    s_waitcnt lgkmcnt(0)
    v_mfma_f32_16x16x32_bf16 v[112:115], v[92:95], v[28:31], 0
    v_mfma_f32_16x16x32_bf16 v[116:119], v[92:95], v[32:35], 0
    v_mfma_f32_16x16x32_bf16 v[120:123], v[92:95], v[36:39], 0
    v_mfma_f32_16x16x32_bf16 v[124:127], v[92:95], v[40:43], 0
    v_mfma_f32_16x16x32_bf16 v[112:115], v[96:99], v[44:47], v[112:115]
    v_mfma_f32_16x16x32_bf16 v[116:119], v[96:99], v[48:51], v[116:119]
    v_mfma_f32_16x16x32_bf16 v[120:123], v[96:99], v[52:55], v[120:123]
    v_mfma_f32_16x16x32_bf16 v[124:127], v[96:99], v[56:59], v[124:127]
    s_nop 5
    v_cndmask_b32 v100, v112, v116, s[72:73]
    v_cndmask_b32 v100, v100, v120, s[74:75]
    v_cndmask_b32 v100, v100, v124, s[76:77]
    v_cndmask_b32 v102, v113, v117, s[72:73]
    v_cndmask_b32 v102, v102, v121, s[74:75]
    v_cndmask_b32 v102, v102, v125, s[76:77]
    buffer_store_dwordx4 v[100:103], v13, s[28:31], s37 offen sc1
    s_sub_u32 s36, s3, 4
    s_cmp_ge_u32 s36, 2
    s_cbranch_scc1 Laux_end
    s_add_u32 s37, s37, 4096
    ds_read_b64_tr_b16 v[60:61], v14 offset:12288
    ds_read_b64_tr_b16 v[62:63], v14 offset:12800
    ds_read_b64_tr_b16 v[64:65], v15 offset:12288
    ds_read_b64_tr_b16 v[66:67], v15 offset:12800
    ds_read_b64_tr_b16 v[68:69], v16 offset:12288
    ds_read_b64_tr_b16 v[70:71], v16 offset:12800
    ds_read_b64_tr_b16 v[72:73], v17 offset:12288
    ds_read_b64_tr_b16 v[74:75], v17 offset:12800
    ds_read_b64_tr_b16 v[76:77], v14 offset:0
    ds_read_b64_tr_b16 v[78:79], v14 offset:512
    ds_read_b64_tr_b16 v[80:81], v15 offset:0
    ds_read_b64_tr_b16 v[82:83], v15 offset:512
    ds_read_b64_tr_b16 v[84:85], v16 offset:0
    ds_read_b64_tr_b16 v[86:87], v16 offset:512
    ds_read_b64_tr_b16 v[88:89], v17 offset:0
    ds_read_b64_tr_b16 v[90:91], v17 offset:512
    s_waitcnt lgkmcnt(0)
    v_mfma_f32_16x16x32_bf16 v[112:115], v[92:95], v[60:63], 0
    v_mfma_f32_16x16x32_bf16 v[116:119], v[92:95], v[64:67], 0
    v_mfma_f32_16x16x32_bf16 v[120:123], v[92:95], v[68:71], 0
    v_mfma_f32_16x16x32_bf16 v[124:127], v[92:95], v[72:75], 0
    v_mfma_f32_16x16x32_bf16 v[112:115], v[96:99], v[76:79], v[112:115]
    v_mfma_f32_16x16x32_bf16 v[116:119], v[96:99], v[80:83], v[116:119]
    v_mfma_f32_16x16x32_bf16 v[120:123], v[96:99], v[84:87], v[120:123]
    v_mfma_f32_16x16x32_bf16 v[124:127], v[96:99], v[88:91], v[124:127]
    s_nop 5
    v_cndmask_b32 v100, v112, v116, s[72:73]
    v_cndmask_b32 v100, v100, v120, s[74:75]
    v_cndmask_b32 v100, v100, v124, s[76:77]
    v_cndmask_b32 v102, v113, v117, s[72:73]
    v_cndmask_b32 v102, v102, v121, s[74:75]
    v_cndmask_b32 v102, v102, v125, s[76:77]
    buffer_store_dwordx4 v[100:103], v13, s[28:31], s37 offen sc1
Laux_end:
    s_endpgm
Lmst:
    s_cmp_lg_u32 s3, 0
    s_cbranch_scc1 Lhelp_i
    s_waitcnt lgkmcnt(0)
    s_mov_b64 s[28:29], s[24:25]
    s_mov_b32 s30, 268435456
    s_mov_b32 s31, 0x20000
    s_load_dword s34, s[28:29], 0
    s_waitcnt lgkmcnt(0)
    s_add_u32 s34, s34, 0x9e3779b8
    s_or_b32 s34, s34, 1
    s_mov_b64 exec, 1
    s_lshl_b32 s36, s2, 2
    s_add_u32 s36, s36, 8323072
    v_mov_b32 v4, s34
    v_mov_b32 v5, s36
    buffer_store_dword v4, v5, s[28:31], 0 offen sc1
    s_mov_b64 exec, -1
    s_cmp_lg_u32 s32, 32
    s_cbranch_scc1 Lend
Lmst_bc:
    v_and_b32 v4, 31, v1
    v_lshlrev_b32 v4, 7, v4
    v_add_u32 v4, 8126464, v4
Lpt_15:
    s_sub_u32 s35, s35, 1
    s_cbranch_scc1 Lend
    s_sleep 8
    buffer_load_dwordx4 v[8:11], v4, s[28:31], 0 offen sc1
    s_waitcnt vmcnt(0)
    v_cmp_ne_u32 vcc, s34, v9
    v_cmp_ne_u32 s[36:37], s34, v11
    s_nop 0
    s_or_b64 s[36:37], s[36:37], vcc
    s_cbranch_scc1 Lpt_15
    v_mov_b32 v4, v8
    s_nop 1
    v_max_u32_dpp v4, v4, v4 row_ror:8 row_mask:0xf bank_mask:0xf
    s_nop 1
    v_max_u32_dpp v4, v4, v4 row_ror:4 row_mask:0xf bank_mask:0xf
    s_nop 1
    v_max_u32_dpp v4, v4, v4 row_ror:2 row_mask:0xf bank_mask:0xf
    s_nop 1
    v_max_u32_dpp v4, v4, v4 row_ror:1 row_mask:0xf bank_mask:0xf
    s_nop 0
    v_readlane_b32 s40, v4, 0
    v_readlane_b32 s36, v4, 16
    v_readlane_b32 s37, v4, 32
    v_readlane_b32 s38, v4, 48
    s_max_u32 s40, s40, s36
    s_max_u32 s37, s37, s38
    s_max_u32 s40, s40, s37
    v_cmp_eq_u32 vcc, s40, v8
    s_nop 1
    v_cndmask_b32 v4, v8, v10, vcc
    s_nop 1
    v_max_u32_dpp v4, v4, v4 row_ror:8 row_mask:0xf bank_mask:0xf
    s_nop 1
    v_max_u32_dpp v4, v4, v4 row_ror:4 row_mask:0xf bank_mask:0xf
    s_nop 1
    v_max_u32_dpp v4, v4, v4 row_ror:2 row_mask:0xf bank_mask:0xf
    s_nop 1
    v_max_u32_dpp v4, v4, v4 row_ror:1 row_mask:0xf bank_mask:0xf
    s_nop 0
    v_readlane_b32 s41, v4, 0
    v_readlane_b32 s36, v4, 16
    v_readlane_b32 s37, v4, 32
    v_readlane_b32 s38, v4, 48
    s_max_u32 s41, s41, s36
    s_max_u32 s37, s37, s38
    s_max_u32 s41, s41, s37
    v_mov_b32 v8, s40
    v_mov_b32 v9, s34
    v_mov_b32 v10, s41
    v_mov_b32 v11, s34
    s_mov_b32 s36, 8257536
    buffer_store_dwordx4 v[8:11], v13, s[28:31], s36 offen offset:0 sc1
    buffer_store_dwordx4 v[8:11], v13, s[28:31], s36 offen offset:1024 sc1
    buffer_store_dwordx4 v[8:11], v13, s[28:31], s36 offen offset:2048 sc1
    s_mov_b32 s36, 8323072
Lmaster:
    s_sub_u32 s35, s35, 1
    s_cbranch_scc1 Lend
    s_sleep 16
    buffer_load_dwordx4 v[4:7], v13, s[28:31], s36 offen sc1
    s_waitcnt vmcnt(0)
    v_xor_b32 v4, s34, v4
    v_xor_b32 v5, s34, v5
    v_xor_b32 v6, s34, v6
    v_xor_b32 v7, s34, v7
    v_or3_b32 v4, v4, v5, v6
    v_or_b32 v4, v4, v7
    v_cmp_ne_u32 vcc, 0, v4
    s_nop 0
    s_cbranch_vccnz Lmaster
    s_mov_b64 exec, 1
    buffer_store_dword v9, v4, s[28:31], 0 offen sc1
    s_endpgm
Lhelp_r:
    s_sub_u32 s72, s32, 27
    s_add_u32 s72, s72, 27
    s_mov_b32 s73, 5
    s_mov_b32 s37, 4
    s_branch Lhelp
Lhelp_i:
    s_cmp_eq_u32 s32, 32
    s_cbranch_scc1 Lend
    s_cmp_eq_u32 s27, 0
    s_cbranch_scc1 Lend
    s_sub_u32 s72, s32, 33
    s_mov_b32 s73, 3
    s_mov_b32 s37, 9
Lhelp:
    s_lshl_b32 s38, s26, 6
    v_add_u32 v4, s38, v1
    v_mul_u32_u24 v4, 1280, v4
    s_waitcnt lgkmcnt(0)
    s_mov_b64 s[68:69], s[18:19]
    s_mov_b32 s70, 2211840
    s_mov_b32 s71, 0x20000
Lhelp2:
    s_mul_i32 s38, s72, 9363
    s_lshr_b32 s38, s38, 16
    s_mul_i32 s39, s38, 7
    s_sub_u32 s39, s72, s39
    s_mul_i32 s39, s39, 327680
    s_lshl_b32 s38, s38, 7
    s_sub_u32 s39, s39, s38
    s_add_u32 s39, s39, 1152
    v_add_u32 v6, s39, v4
    buffer_load_dword v5, v6, s[68:71], 0 offen
    s_add_u32 s72, s72, s73
    s_sub_u32 s37, s37, 1
    s_cmp_lg_u32 s37, 0
    s_cbranch_scc1 Lhelp2
Lend:
    s_endpgm
.section .rodata,"a"
.p2align 6
.amdhsa_kernel recurrent_scan__sliding_local_dilated__moe_arch_mod__prompt_kernel
  .amdhsa_next_free_vgpr 256
  .amdhsa_next_free_sgpr 102
  .amdhsa_accum_offset 128
  .amdhsa_group_segment_fixed_size 0
  .amdhsa_kernarg_size 88
  .amdhsa_user_sgpr_count 2
  .amdhsa_user_sgpr_kernarg_segment_ptr 1
  .amdhsa_system_sgpr_workgroup_id_x 1
  .amdhsa_float_denorm_mode_32 3
.end_amdhsa_kernel
```

```asm
; @launch grid=(256,1,1) block=(512,1,1) lds=163840
.amdgcn_target "amdgcn-amd-amdhsa--gfx950"
.text
.globl recurrent_scan__sliding_local_dilated__moe_arch_mod__prompt_kernel
.p2align 8
.type recurrent_scan__sliding_local_dilated__moe_arch_mod__prompt_kernel,@function
recurrent_scan__sliding_local_dilated__moe_arch_mod__prompt_kernel:
    s_load_dwordx16 s[4:19], s[0:1], 0
    s_load_dwordx4 s[20:23], s[0:1], 64
    s_load_dwordx2 s[24:25], s[0:1], 80
    v_lshrrev_b32 v4, 6, v0
    v_and_b32 v1, 63, v0
    s_cmp_ge_u32 s2, 256
    s_cbranch_scc1 Lend
    v_readfirstlane_b32 s3, v4
    s_getpc_b64 s[36:37]
Lpc:
    s_and_b32 s38, s2, 0xf8
    v_add_u32 v5, s38, v4
    v_and_b32 v6, 1, v0
    v_lshl_add_u32 v5, v5, 1, v6
    v_lshlrev_b32 v5, 7, v5
    v_min_u32 v5, Lend-Lpc, v5
    v_mov_b32 v7, s37
    v_add_co_u32 v6, vcc, s36, v5
    s_nop 1
    v_addc_co_u32 v7, vcc, 0, v7, vcc
    global_load_dword v0, v[6:7], off
    v_lshrrev_b32 v2, 4, v1
    v_and_b32 v3, 15, v1
    v_lshlrev_b32 v12, 2, v1
    v_lshlrev_b32 v13, 4, v1
    s_mov_b32 s35, 2000000
    s_and_b32 s36, s2, 7
    s_lshr_b32 s37, s2, 3
    s_and_b32 s38, s36, 1
    s_lshr_b32 s36, s36, 1
    s_add_u32 s39, s38, 4
    s_and_b32 s26, s3, 3
    s_lshr_b32 s27, s3, 2
    s_cmp_lt_u32 s37, s39
    s_cbranch_scc1 Laux
    s_lshr_b32 s33, s36, 1
    s_and_b32 s36, s36, 1
    s_mul_i32 s36, s36, 55
    s_mul_i32 s38, s38, 28
    s_add_u32 s36, s36, s38
    s_add_u32 s36, s36, s37
    s_sub_u32 s36, s36, s39
    s_mul_i32 s32, s36, 13108
    s_lshr_b32 s32, s32, 16
    s_mul_i32 s37, s32, 5
    s_sub_u32 s36, s36, s37
    s_mul_i32 s33, s33, 5
    s_add_u32 s33, s33, s36
    s_add_u32 s42, s33, s32
    s_mul_i32 s36, s42, 13108
    s_lshr_b32 s36, s36, 16
    s_mul_i32 s36, s36, 5
    s_sub_u32 s42, s42, s36
    s_and_b32 s43, s2, 7
    s_lshl_b32 s43, s43, 2
    s_lshr_b32 s43, 0x30858530, s43
    s_and_b32 s43, s43, 15
    s_cmp_lg_u32 s3, 0
    s_cbranch_scc1 Lcomp
Lloader:
    s_setprio 3
    v_lshrrev_b32 v5, 3, v1
    v_and_b32 v6, 7, v1
    v_and_b32 v8, 1, v2
    v_lshlrev_b32 v8, 1, v8
    v_xor_b32 v8, v8, v6
    s_lshl_b32 s39, s33, 7
    v_lshl_add_u32 v50, v8, 4, s39
    v_mov_b32 v7, 3840
    v_mad_u32_u24 v28, v5, v7, v50
    v_xor_b32 v29, 64, v28
    v_add_u32 v29, 29696, v29
    v_add_u32 v30, 59392, v28
    v_add_u32 v31, 59392, v29
    v_add_u32 v32, 122880, v28
    v_add_u32 v33, 122880, v29
    v_add_u32 v34, 182272, v28
    v_add_u32 v35, 182272, v29
    s_lshl_b32 s79, s42, 2
    s_lshr_b32 s79, 0x11000, s79
    s_and_b32 s79, s79, 15
    s_add_u32 s79, s79, s43
    s_sub_u32 s38, s79, 10
    s_cmp_ge_u32 s79, 10
    s_cselect_b32 s79, s38, s79
    s_mul_i32 s68, s79, 245760
    s_lshl_b32 s78, s79, 7
    s_waitcnt lgkmcnt(0)
    s_mov_b64 s[48:49], s[6:7]
    s_mov_b32 s50, 2457600
    s_mov_b32 s51, 0x20000
    s_add_u32 s52, s6, 1280
    s_addc_u32 s53, s7, 0
    s_mov_b32 s54, 2456320
    s_mov_b32 s55, 0x20000
    s_add_u32 s56, s6, 2560
    s_addc_u32 s57, s7, 0
    s_mov_b32 s58, 2455040
    s_mov_b32 s59, 0x20000
    s_lshr_b32 s69, 10, s42
    s_and_b32 s69, s69, 1
    s_mul_i32 s70, s69, 122880
    s_sub_u32 s71, 122880, s70
    s_add_u32 s70, s70, s68
    s_add_u32 s71, s71, s68
    s_lshl_b32 s72, s69, 12
    s_xor_b32 s73, s72, 4096
    s_add_u32 m0, s72, 0
    s_mul_i32 s38, s32, 96
    s_sub_u32 s38, s38, 16
    v_add_u32 v7, s38, v5
    v_xor_b32 v9, v6, v2
    v_lshlrev_b32 v9, 4, v9
    buffer_load_dwordx4 v28, s[48:51], s70 offen lds
    v_xor_b32 v10, 64, v9
    v_mov_b32 v11, 2052
    v_mov_b32 v8, 1280
    v_add_u32 v36, 0, v7
    buffer_load_dwordx4 v29, s[48:51], s70 offen offset:1024 lds
    v_med3_i32 v36, v36, 0, v11
    v_mad_u32_u24 v36, v36, v8, v9
    v_add_u32 v36, 4096, v36
    v_add_u32 v37, 8, v7
    buffer_load_dwordx4 v30, s[48:51], s70 offen offset:2048 lds
    v_med3_i32 v37, v37, 0, v11
    v_mad_u32_u24 v37, v37, v8, v10
    v_add_u32 v37, 3072, v37
    v_add_u32 v38, 16, v7
    v_med3_i32 v38, v38, 0, v11
    buffer_load_dwordx4 v31, s[48:51], s70 offen offset:3072 lds
    v_mad_u32_u24 v38, v38, v8, v9
    v_add_u32 v38, 2048, v38
    v_add_u32 v39, 24, v7
    v_med3_i32 v39, v39, 0, v11
    s_add_u32 m0, s72, 8192
    v_mad_u32_u24 v39, v39, v8, v10
    v_add_u32 v39, 1024, v39
    v_add_u32 v40, 32, v7
    v_med3_i32 v40, v40, 0, v11
    buffer_load_dwordx4 v28, s[52:55], s70 offen lds
    v_mad_u32_u24 v40, v40, v8, v9
    v_add_u32 v40, 4096, v40
    v_add_u32 v41, 40, v7
    v_med3_i32 v41, v41, 0, v11
    v_mad_u32_u24 v41, v41, v8, v10
    buffer_load_dwordx4 v29, s[52:55], s70 offen offset:1024 lds
    v_add_u32 v41, 3072, v41
    v_add_u32 v42, 48, v7
    v_med3_i32 v42, v42, 0, v11
    v_mad_u32_u24 v42, v42, v8, v9
    buffer_load_dwordx4 v30, s[52:55], s70 offen offset:2048 lds
    v_add_u32 v42, 2048, v42
    v_add_u32 v43, 56, v7
    v_med3_i32 v43, v43, 0, v11
    v_mad_u32_u24 v43, v43, v8, v10
    buffer_load_dwordx4 v31, s[52:55], s70 offen offset:3072 lds
    v_add_u32 v43, 1024, v43
    v_add_u32 v44, 64, v7
    v_med3_i32 v44, v44, 0, v11
    v_mad_u32_u24 v44, v44, v8, v9
    v_add_u32 v44, 4096, v44
    s_add_u32 m0, s72, 16384
    v_add_u32 v45, 72, v7
    v_med3_i32 v45, v45, 0, v11
    v_mad_u32_u24 v45, v45, v8, v10
    v_add_u32 v45, 3072, v45
    buffer_load_dwordx4 v28, s[56:59], s70 offen lds
    v_add_u32 v46, 80, v7
    v_med3_i32 v46, v46, 0, v11
    v_mad_u32_u24 v46, v46, v8, v9
    v_add_u32 v46, 2048, v46
    buffer_load_dwordx4 v29, s[56:59], s70 offen offset:1024 lds
    v_add_u32 v47, 88, v7
    v_med3_i32 v47, v47, 0, v11
    v_mad_u32_u24 v47, v47, v8, v10
    v_add_u32 v47, 1024, v47
    v_add_u32 v48, 96, v7
    buffer_load_dwordx4 v30, s[56:59], s70 offen offset:2048 lds
    v_med3_i32 v48, v48, 0, v11
    v_mad_u32_u24 v48, v48, v8, v9
    v_add_u32 v48, 4096, v48
    v_add_u32 v49, 104, v7
    buffer_load_dwordx4 v31, s[56:59], s70 offen offset:3072 lds
    v_med3_i32 v49, v49, 0, v11
    v_mad_u32_u24 v49, v49, v8, v10
    v_add_u32 v49, 3072, v49
    s_sub_u32 s44, s4, 4096
    s_subb_u32 s45, s5, 0
    s_mov_b32 s46, 2625536
    s_mov_b32 s47, 0x20000
    s_mov_b32 m0, 24576
    s_nop 0
    buffer_load_dwordx4 v36, s[44:47], s78 offen lds
    buffer_load_dwordx4 v37, s[44:47], s78 offen offset:1024 lds
    buffer_load_dwordx4 v38, s[44:47], s78 offen offset:2048 lds
    buffer_load_dwordx4 v39, s[44:47], s78 offen offset:3072 lds
    s_mov_b32 m0, 28672
    s_nop 0
    buffer_load_dwordx4 v40, s[44:47], s78 offen lds
    buffer_load_dwordx4 v41, s[44:47], s78 offen offset:1024 lds
    buffer_load_dwordx4 v42, s[44:47], s78 offen offset:2048 lds
    buffer_load_dwordx4 v43, s[44:47], s78 offen offset:3072 lds
    s_mov_b32 m0, 32768
    s_nop 0
    buffer_load_dwordx4 v44, s[44:47], s78 offen lds
    buffer_load_dwordx4 v45, s[44:47], s78 offen offset:1024 lds
    buffer_load_dwordx4 v46, s[44:47], s78 offen offset:2048 lds
    buffer_load_dwordx4 v47, s[44:47], s78 offen offset:3072 lds
    s_mov_b32 m0, 36864
    s_nop 0
    buffer_load_dwordx4 v48, s[44:47], s78 offen lds
    buffer_load_dwordx4 v49, s[44:47], s78 offen offset:1024 lds
    s_add_u32 m0, s73, 0
    s_nop 0
    buffer_load_dwordx4 v28, s[48:51], s71 offen lds
    buffer_load_dwordx4 v29, s[48:51], s71 offen offset:1024 lds
    buffer_load_dwordx4 v30, s[48:51], s71 offen offset:2048 lds
    buffer_load_dwordx4 v31, s[48:51], s71 offen offset:3072 lds
    s_add_u32 m0, s73, 8192
    s_nop 0
    buffer_load_dwordx4 v28, s[52:55], s71 offen lds
    buffer_load_dwordx4 v29, s[52:55], s71 offen offset:1024 lds
    buffer_load_dwordx4 v30, s[52:55], s71 offen offset:2048 lds
    buffer_load_dwordx4 v31, s[52:55], s71 offen offset:3072 lds
    s_add_u32 m0, s73, 16384
    s_nop 0
    buffer_load_dwordx4 v28, s[56:59], s71 offen lds
    buffer_load_dwordx4 v29, s[56:59], s71 offen offset:1024 lds
    buffer_load_dwordx4 v30, s[56:59], s71 offen offset:2048 lds
    buffer_load_dwordx4 v31, s[56:59], s71 offen offset:3072 lds
    s_mov_b32 s80, 0x86542310
    s_mov_b32 s81, 0x97
    s_cmp_eq_u32 s42, 1
    s_cselect_b32 s80, 0x76453210, s80
    s_cselect_b32 s81, 0x98, s81
    s_cmp_eq_u32 s42, 2
    s_cselect_b32 s80, 0x67543120, s80
    s_cselect_b32 s81, 0x98, s81
    s_cmp_eq_u32 s42, 3
    s_cselect_b32 s80, 0x76534201, s80
    s_cselect_b32 s81, 0x89, s81
    s_cmp_eq_u32 s42, 4
    s_cselect_b32 s80, 0x75643201, s80
    s_cselect_b32 s81, 0x98, s81
    s_lshr_b64 s[80:81], s[80:81], 4
    s_and_b32 s79, s80, 15
    s_add_u32 s79, s79, s43
    s_sub_u32 s38, s79, 10
    s_cmp_ge_u32 s79, 10
    s_cselect_b32 s79, s38, s79
    s_mov_b64 s[28:29], s[24:25]
    s_mov_b32 s30, 268435456
    s_mov_b32 s31, 0x20000
    s_load_dword s34, s[28:29], 0
    s_mov_b64 s[60:61], s[8:9]
    s_mov_b32 s62, 819200
    s_mov_b32 s63, 0x20000
    v_mov_b32 v51, 157984
    v_and_b32 v66, 7, v1
    v_max_u32 v66, 1, v66
    v_lshlrev_b32 v66, 2, v66
    v_add_u32 v66, 158016, v66
    s_mul_i32 s69, s79, 245760
    s_lshl_b32 s78, s79, 7
    s_mov_b32 m0, 63616
    s_nop 0
    buffer_load_dwordx4 v36, s[44:47], s78 offen lds
    buffer_load_dwordx4 v37, s[44:47], s78 offen offset:1024 lds
    buffer_load_dwordx4 v38, s[44:47], s78 offen offset:2048 lds
    buffer_load_dwordx4 v39, s[44:47], s78 offen offset:3072 lds
    s_mov_b32 m0, 39040
    s_nop 0
    buffer_load_dwordx4 v28, s[48:51], s69 offen lds
    buffer_load_dwordx4 v29, s[48:51], s69 offen offset:1024 lds
    buffer_load_dwordx4 v30, s[48:51], s69 offen offset:2048 lds
    buffer_load_dwordx4 v31, s[48:51], s69 offen offset:3072 lds
    s_mov_b32 m0, 67712
    s_nop 0
    buffer_load_dwordx4 v40, s[44:47], s78 offen lds
    buffer_load_dwordx4 v41, s[44:47], s78 offen offset:1024 lds
    buffer_load_dwordx4 v42, s[44:47], s78 offen offset:2048 lds
    buffer_load_dwordx4 v43, s[44:47], s78 offen offset:3072 lds
    s_mov_b32 m0, 47232
    s_nop 0
    buffer_load_dwordx4 v28, s[52:55], s69 offen lds
    buffer_load_dwordx4 v29, s[52:55], s69 offen offset:1024 lds
    buffer_load_dwordx4 v30, s[52:55], s69 offen offset:2048 lds
    buffer_load_dwordx4 v31, s[52:55], s69 offen offset:3072 lds
    s_mov_b32 m0, 71808
    s_nop 0
    buffer_load_dwordx4 v44, s[44:47], s78 offen lds
    buffer_load_dwordx4 v45, s[44:47], s78 offen offset:1024 lds
    buffer_load_dwordx4 v46, s[44:47], s78 offen offset:2048 lds
    buffer_load_dwordx4 v47, s[44:47], s78 offen offset:3072 lds
    s_mov_b32 m0, 55424
    s_nop 0
    buffer_load_dwordx4 v28, s[56:59], s69 offen lds
    buffer_load_dwordx4 v29, s[56:59], s69 offen offset:1024 lds
    buffer_load_dwordx4 v30, s[56:59], s69 offen offset:2048 lds
    buffer_load_dwordx4 v31, s[56:59], s69 offen offset:3072 lds
    s_mov_b32 m0, 75904
    s_nop 0
    buffer_load_dwordx4 v48, s[44:47], s78 offen lds
    s_waitcnt vmcnt(55)
    buffer_load_dwordx4 v49, s[44:47], s78 offen offset:1024 lds
    s_mov_b32 m0, 43136
    s_nop 0
    buffer_load_dwordx4 v32, s[48:51], s69 offen lds
    buffer_load_dwordx4 v33, s[48:51], s69 offen offset:1024 lds
    buffer_load_dwordx4 v34, s[48:51], s69 offen offset:2048 lds
    buffer_load_dwordx4 v35, s[48:51], s69 offen offset:3072 lds
    s_mov_b32 m0, 51328
    s_nop 0
    buffer_load_dwordx4 v32, s[52:55], s69 offen lds
    buffer_load_dwordx4 v33, s[52:55], s69 offen offset:1024 lds
    buffer_load_dwordx4 v34, s[52:55], s69 offen offset:2048 lds
    s_waitcnt vmcnt(55)
    buffer_load_dwordx4 v35, s[52:55], s69 offen offset:3072 lds
    s_mov_b32 m0, 59520
    s_nop 0
    buffer_load_dwordx4 v32, s[56:59], s69 offen lds
    buffer_load_dwordx4 v33, s[56:59], s69 offen offset:1024 lds
    buffer_load_dwordx4 v34, s[56:59], s69 offen offset:2048 lds
    buffer_load_dwordx4 v35, s[56:59], s69 offen offset:3072 lds
    s_waitcnt vmcnt(38) lgkmcnt(0)
    s_barrier
    s_add_u32 s34, s34, 0x9e3779b8
    s_or_b32 s34, s34, 1
    s_lshr_b64 s[80:81], s[80:81], 4
    s_and_b32 s79, s80, 15
    s_add_u32 s79, s79, s43
    s_sub_u32 s38, s79, 10
    s_cmp_ge_u32 s79, 10
    s_cselect_b32 s79, s38, s79
    s_mul_i32 s70, s79, 245760
    s_lshl_b32 s78, s79, 7
    s_mov_b32 m0, 102656
    s_nop 0
    buffer_load_dwordx4 v36, s[44:47], s78 offen lds
    buffer_load_dwordx4 v37, s[44:47], s78 offen offset:1024 lds
    buffer_load_dwordx4 v38, s[44:47], s78 offen offset:2048 lds
    buffer_load_dwordx4 v39, s[44:47], s78 offen offset:3072 lds
    s_mov_b32 m0, 78080
    s_nop 0
    buffer_load_dwordx4 v28, s[48:51], s70 offen lds
    buffer_load_dwordx4 v29, s[48:51], s70 offen offset:1024 lds
    buffer_load_dwordx4 v30, s[48:51], s70 offen offset:2048 lds
    buffer_load_dwordx4 v31, s[48:51], s70 offen offset:3072 lds
    s_mov_b32 m0, 106752
    s_nop 0
    buffer_load_dwordx4 v40, s[44:47], s78 offen lds
    buffer_load_dwordx4 v41, s[44:47], s78 offen offset:1024 lds
    buffer_load_dwordx4 v42, s[44:47], s78 offen offset:2048 lds
    buffer_load_dwordx4 v43, s[44:47], s78 offen offset:3072 lds
    s_mov_b32 m0, 86272
    s_nop 0
    buffer_load_dwordx4 v28, s[52:55], s70 offen lds
    buffer_load_dwordx4 v29, s[52:55], s70 offen offset:1024 lds
    buffer_load_dwordx4 v30, s[52:55], s70 offen offset:2048 lds
    buffer_load_dwordx4 v31, s[52:55], s70 offen offset:3072 lds
    s_mov_b32 m0, 110848
    s_nop 0
    buffer_load_dwordx4 v44, s[44:47], s78 offen lds
    buffer_load_dwordx4 v45, s[44:47], s78 offen offset:1024 lds
    buffer_load_dwordx4 v46, s[44:47], s78 offen offset:2048 lds
    buffer_load_dwordx4 v47, s[44:47], s78 offen offset:3072 lds
    s_mov_b32 m0, 94464
    s_nop 0
    buffer_load_dwordx4 v28, s[56:59], s70 offen lds
    buffer_load_dwordx4 v29, s[56:59], s70 offen offset:1024 lds
    buffer_load_dwordx4 v30, s[56:59], s70 offen offset:2048 lds
    buffer_load_dwordx4 v31, s[56:59], s70 offen offset:3072 lds
    s_mov_b32 m0, 114944
    s_nop 0
    buffer_load_dwordx4 v48, s[44:47], s78 offen lds
    s_waitcnt vmcnt(55)
    buffer_load_dwordx4 v49, s[44:47], s78 offen offset:1024 lds
    s_mov_b32 m0, 82176
    s_nop 0
    buffer_load_dwordx4 v32, s[48:51], s70 offen lds
    buffer_load_dwordx4 v33, s[48:51], s70 offen offset:1024 lds
    buffer_load_dwordx4 v34, s[48:51], s70 offen offset:2048 lds
    buffer_load_dwordx4 v35, s[48:51], s70 offen offset:3072 lds
    s_mov_b32 m0, 90368
    s_nop 0
    buffer_load_dwordx4 v32, s[52:55], s70 offen lds
    buffer_load_dwordx4 v33, s[52:55], s70 offen offset:1024 lds
    buffer_load_dwordx4 v34, s[52:55], s70 offen offset:2048 lds
    s_waitcnt vmcnt(55)
    buffer_load_dwordx4 v35, s[52:55], s70 offen offset:3072 lds
    s_mov_b32 m0, 98560
    s_nop 0
    buffer_load_dwordx4 v32, s[56:59], s70 offen lds
    buffer_load_dwordx4 v33, s[56:59], s70 offen offset:1024 lds
    buffer_load_dwordx4 v34, s[56:59], s70 offen offset:2048 lds
    buffer_load_dwordx4 v35, s[56:59], s70 offen offset:3072 lds
    s_waitcnt vmcnt(38) lgkmcnt(0)
    s_barrier
    s_lshr_b64 s[80:81], s[80:81], 4
    s_and_b32 s79, s80, 15
    s_add_u32 s79, s79, s43
    s_sub_u32 s38, s79, 10
    s_cmp_ge_u32 s79, 10
    s_cselect_b32 s79, s38, s79
    s_mul_i32 s71, s79, 245760
    s_lshl_b32 s78, s79, 7
    s_mov_b32 m0, 141696
    s_nop 0
    buffer_load_dwordx4 v36, s[44:47], s78 offen lds
    buffer_load_dwordx4 v37, s[44:47], s78 offen offset:1024 lds
    buffer_load_dwordx4 v38, s[44:47], s78 offen offset:2048 lds
    buffer_load_dwordx4 v39, s[44:47], s78 offen offset:3072 lds
    s_mov_b32 m0, 117120
    s_nop 0
    buffer_load_dwordx4 v28, s[48:51], s71 offen lds
    buffer_load_dwordx4 v29, s[48:51], s71 offen offset:1024 lds
    buffer_load_dwordx4 v30, s[48:51], s71 offen offset:2048 lds
    buffer_load_dwordx4 v31, s[48:51], s71 offen offset:3072 lds
    s_mov_b32 m0, 145792
    s_nop 0
    buffer_load_dwordx4 v40, s[44:47], s78 offen lds
    buffer_load_dwordx4 v41, s[44:47], s78 offen offset:1024 lds
    buffer_load_dwordx4 v42, s[44:47], s78 offen offset:2048 lds
    buffer_load_dwordx4 v43, s[44:47], s78 offen offset:3072 lds
    s_mov_b32 m0, 125312
    s_nop 0
    buffer_load_dwordx4 v28, s[52:55], s71 offen lds
    buffer_load_dwordx4 v29, s[52:55], s71 offen offset:1024 lds
    buffer_load_dwordx4 v30, s[52:55], s71 offen offset:2048 lds
    buffer_load_dwordx4 v31, s[52:55], s71 offen offset:3072 lds
    s_mov_b32 m0, 149888
    s_nop 0
    buffer_load_dwordx4 v44, s[44:47], s78 offen lds
    buffer_load_dwordx4 v45, s[44:47], s78 offen offset:1024 lds
    buffer_load_dwordx4 v46, s[44:47], s78 offen offset:2048 lds
    buffer_load_dwordx4 v47, s[44:47], s78 offen offset:3072 lds
    s_mov_b32 m0, 133504
    s_nop 0
    buffer_load_dwordx4 v28, s[56:59], s71 offen lds
    buffer_load_dwordx4 v29, s[56:59], s71 offen offset:1024 lds
    buffer_load_dwordx4 v30, s[56:59], s71 offen offset:2048 lds
    buffer_load_dwordx4 v31, s[56:59], s71 offen offset:3072 lds
    s_mov_b32 m0, 153984
    s_nop 0
    buffer_load_dwordx4 v48, s[44:47], s78 offen lds
    s_waitcnt vmcnt(55)
    buffer_load_dwordx4 v49, s[44:47], s78 offen offset:1024 lds
    s_mov_b32 m0, 121216
    s_nop 0
    buffer_load_dwordx4 v32, s[48:51], s71 offen lds
    buffer_load_dwordx4 v33, s[48:51], s71 offen offset:1024 lds
    buffer_load_dwordx4 v34, s[48:51], s71 offen offset:2048 lds
    buffer_load_dwordx4 v35, s[48:51], s71 offen offset:3072 lds
    s_mov_b32 m0, 129408
    s_nop 0
    buffer_load_dwordx4 v32, s[52:55], s71 offen lds
    buffer_load_dwordx4 v33, s[52:55], s71 offen offset:1024 lds
    buffer_load_dwordx4 v34, s[52:55], s71 offen offset:2048 lds
    s_waitcnt vmcnt(55)
    buffer_load_dwordx4 v35, s[52:55], s71 offen offset:3072 lds
    s_mov_b32 m0, 137600
    s_nop 0
    buffer_load_dwordx4 v32, s[56:59], s71 offen lds
    buffer_load_dwordx4 v33, s[56:59], s71 offen offset:1024 lds
    buffer_load_dwordx4 v34, s[56:59], s71 offen offset:2048 lds
    buffer_load_dwordx4 v35, s[56:59], s71 offen offset:3072 lds
    s_waitcnt vmcnt(38) lgkmcnt(0)
    s_barrier
    s_lshr_b64 s[80:81], s[80:81], 4
    s_and_b32 s79, s80, 15
    s_add_u32 s79, s79, s43
    s_sub_u32 s38, s79, 10
    s_cmp_ge_u32 s79, 10
    s_cselect_b32 s79, s38, s79
    s_mul_i32 s72, s79, 245760
    s_lshl_b32 s78, s79, 7
    s_mov_b32 m0, 24576
    s_nop 0
    buffer_load_dwordx4 v36, s[44:47], s78 offen lds
    buffer_load_dwordx4 v37, s[44:47], s78 offen offset:1024 lds
    buffer_load_dwordx4 v38, s[44:47], s78 offen offset:2048 lds
    buffer_load_dwordx4 v39, s[44:47], s78 offen offset:3072 lds
    s_mov_b32 m0, 0
    s_nop 0
    buffer_load_dwordx4 v28, s[48:51], s72 offen lds
    buffer_load_dwordx4 v29, s[48:51], s72 offen offset:1024 lds
    buffer_load_dwordx4 v30, s[48:51], s72 offen offset:2048 lds
    buffer_load_dwordx4 v31, s[48:51], s72 offen offset:3072 lds
    s_mov_b32 m0, 28672
    s_nop 0
    buffer_load_dwordx4 v40, s[44:47], s78 offen lds
    buffer_load_dwordx4 v41, s[44:47], s78 offen offset:1024 lds
    buffer_load_dwordx4 v42, s[44:47], s78 offen offset:2048 lds
    buffer_load_dwordx4 v43, s[44:47], s78 offen offset:3072 lds
    s_mov_b32 m0, 8192
    s_nop 0
    buffer_load_dwordx4 v28, s[52:55], s72 offen lds
    buffer_load_dwordx4 v29, s[52:55], s72 offen offset:1024 lds
    buffer_load_dwordx4 v30, s[52:55], s72 offen offset:2048 lds
    buffer_load_dwordx4 v31, s[52:55], s72 offen offset:3072 lds
    s_mov_b32 m0, 32768
    s_nop 0
    buffer_load_dwordx4 v44, s[44:47], s78 offen lds
    buffer_load_dwordx4 v45, s[44:47], s78 offen offset:1024 lds
    buffer_load_dwordx4 v46, s[44:47], s78 offen offset:2048 lds
    buffer_load_dwordx4 v47, s[44:47], s78 offen offset:3072 lds
    s_mov_b32 m0, 16384
    s_nop 0
    buffer_load_dwordx4 v28, s[56:59], s72 offen lds
    buffer_load_dwordx4 v29, s[56:59], s72 offen offset:1024 lds
    buffer_load_dwordx4 v30, s[56:59], s72 offen offset:2048 lds
    buffer_load_dwordx4 v31, s[56:59], s72 offen offset:3072 lds
    s_mov_b32 m0, 36864
    s_nop 0
    buffer_load_dwordx4 v48, s[44:47], s78 offen lds
    s_waitcnt vmcnt(55)
    buffer_load_dwordx4 v49, s[44:47], s78 offen offset:1024 lds
    s_mov_b32 m0, 4096
    s_nop 0
    buffer_load_dwordx4 v32, s[48:51], s72 offen lds
    buffer_load_dwordx4 v33, s[48:51], s72 offen offset:1024 lds
    buffer_load_dwordx4 v34, s[48:51], s72 offen offset:2048 lds
    buffer_load_dwordx4 v35, s[48:51], s72 offen offset:3072 lds
    s_mov_b32 m0, 12288
    s_nop 0
    buffer_load_dwordx4 v32, s[52:55], s72 offen lds
    buffer_load_dwordx4 v33, s[52:55], s72 offen offset:1024 lds
    buffer_load_dwordx4 v34, s[52:55], s72 offen offset:2048 lds
    s_waitcnt vmcnt(55)
    buffer_load_dwordx4 v35, s[52:55], s72 offen offset:3072 lds
    s_mov_b32 m0, 20480
    s_nop 0
    buffer_load_dwordx4 v32, s[56:59], s72 offen lds
    buffer_load_dwordx4 v33, s[56:59], s72 offen offset:1024 lds
    buffer_load_dwordx4 v34, s[56:59], s72 offen offset:2048 lds
    buffer_load_dwordx4 v35, s[56:59], s72 offen offset:3072 lds
    s_waitcnt vmcnt(38) lgkmcnt(0)
    s_barrier
    s_lshr_b64 s[80:81], s[80:81], 4
    s_and_b32 s79, s80, 15
    s_add_u32 s79, s79, s43
    s_sub_u32 s38, s79, 10
    s_cmp_ge_u32 s79, 10
    s_cselect_b32 s79, s38, s79
    s_mul_i32 s73, s79, 245760
    s_lshl_b32 s78, s79, 7
    s_mov_b32 m0, 63616
    s_nop 0
    buffer_load_dwordx4 v36, s[44:47], s78 offen lds
    buffer_load_dwordx4 v37, s[44:47], s78 offen offset:1024 lds
    buffer_load_dwordx4 v38, s[44:47], s78 offen offset:2048 lds
    buffer_load_dwordx4 v39, s[44:47], s78 offen offset:3072 lds
    s_mov_b32 m0, 39040
    s_nop 0
    buffer_load_dwordx4 v28, s[48:51], s73 offen lds
    buffer_load_dwordx4 v29, s[48:51], s73 offen offset:1024 lds
    buffer_load_dwordx4 v30, s[48:51], s73 offen offset:2048 lds
    buffer_load_dwordx4 v31, s[48:51], s73 offen offset:3072 lds
    s_mov_b32 m0, 67712
    s_nop 0
    buffer_load_dwordx4 v40, s[44:47], s78 offen lds
    buffer_load_dwordx4 v41, s[44:47], s78 offen offset:1024 lds
    buffer_load_dwordx4 v42, s[44:47], s78 offen offset:2048 lds
    buffer_load_dwordx4 v43, s[44:47], s78 offen offset:3072 lds
    s_mov_b32 m0, 47232
    s_nop 0
    buffer_load_dwordx4 v28, s[52:55], s73 offen lds
    buffer_load_dwordx4 v29, s[52:55], s73 offen offset:1024 lds
    buffer_load_dwordx4 v30, s[52:55], s73 offen offset:2048 lds
    buffer_load_dwordx4 v31, s[52:55], s73 offen offset:3072 lds
    s_mov_b32 m0, 71808
    s_nop 0
    buffer_load_dwordx4 v44, s[44:47], s78 offen lds
    buffer_load_dwordx4 v45, s[44:47], s78 offen offset:1024 lds
    buffer_load_dwordx4 v46, s[44:47], s78 offen offset:2048 lds
    buffer_load_dwordx4 v47, s[44:47], s78 offen offset:3072 lds
    s_mov_b32 m0, 55424
    s_nop 0
    buffer_load_dwordx4 v28, s[56:59], s73 offen lds
    buffer_load_dwordx4 v29, s[56:59], s73 offen offset:1024 lds
    buffer_load_dwordx4 v30, s[56:59], s73 offen offset:2048 lds
    buffer_load_dwordx4 v31, s[56:59], s73 offen offset:3072 lds
    s_mov_b32 m0, 75904
    s_nop 0
    buffer_load_dwordx4 v48, s[44:47], s78 offen lds
    s_waitcnt vmcnt(55)
    buffer_load_dwordx4 v49, s[44:47], s78 offen offset:1024 lds
    s_mov_b32 m0, 43136
    s_nop 0
    buffer_load_dwordx4 v32, s[48:51], s73 offen lds
    buffer_load_dwordx4 v33, s[48:51], s73 offen offset:1024 lds
    buffer_load_dwordx4 v34, s[48:51], s73 offen offset:2048 lds
    buffer_load_dwordx4 v35, s[48:51], s73 offen offset:3072 lds
    s_mov_b32 m0, 51328
    s_nop 0
    buffer_load_dwordx4 v32, s[52:55], s73 offen lds
    buffer_load_dwordx4 v33, s[52:55], s73 offen offset:1024 lds
    buffer_load_dwordx4 v34, s[52:55], s73 offen offset:2048 lds
    s_waitcnt vmcnt(55)
    buffer_load_dwordx4 v35, s[52:55], s73 offen offset:3072 lds
    s_mov_b32 m0, 59520
    s_nop 0
    buffer_load_dwordx4 v32, s[56:59], s73 offen lds
    buffer_load_dwordx4 v33, s[56:59], s73 offen offset:1024 lds
    buffer_load_dwordx4 v34, s[56:59], s73 offen offset:2048 lds
    buffer_load_dwordx4 v35, s[56:59], s73 offen offset:3072 lds
    s_waitcnt vmcnt(38) lgkmcnt(0)
    s_barrier
    s_lshr_b64 s[80:81], s[80:81], 4
    s_and_b32 s79, s80, 15
    s_add_u32 s79, s79, s43
    s_sub_u32 s38, s79, 10
    s_cmp_ge_u32 s79, 10
    s_cselect_b32 s79, s38, s79
    s_mul_i32 s74, s79, 245760
    s_lshl_b32 s78, s79, 7
    s_mov_b32 m0, 102656
    s_nop 0
    buffer_load_dwordx4 v36, s[44:47], s78 offen lds
    buffer_load_dwordx4 v37, s[44:47], s78 offen offset:1024 lds
    buffer_load_dwordx4 v38, s[44:47], s78 offen offset:2048 lds
    buffer_load_dwordx4 v39, s[44:47], s78 offen offset:3072 lds
    s_mov_b32 m0, 78080
    s_nop 0
    buffer_load_dwordx4 v28, s[48:51], s74 offen lds
    buffer_load_dwordx4 v29, s[48:51], s74 offen offset:1024 lds
    buffer_load_dwordx4 v30, s[48:51], s74 offen offset:2048 lds
    buffer_load_dwordx4 v31, s[48:51], s74 offen offset:3072 lds
    s_mov_b32 m0, 106752
    s_nop 0
    buffer_load_dwordx4 v40, s[44:47], s78 offen lds
    buffer_load_dwordx4 v41, s[44:47], s78 offen offset:1024 lds
    buffer_load_dwordx4 v42, s[44:47], s78 offen offset:2048 lds
    buffer_load_dwordx4 v43, s[44:47], s78 offen offset:3072 lds
    s_mov_b32 m0, 86272
    s_nop 0
    buffer_load_dwordx4 v28, s[52:55], s74 offen lds
    buffer_load_dwordx4 v29, s[52:55], s74 offen offset:1024 lds
    buffer_load_dwordx4 v30, s[52:55], s74 offen offset:2048 lds
    buffer_load_dwordx4 v31, s[52:55], s74 offen offset:3072 lds
    s_mov_b32 m0, 110848
    s_nop 0
    buffer_load_dwordx4 v44, s[44:47], s78 offen lds
    buffer_load_dwordx4 v45, s[44:47], s78 offen offset:1024 lds
    buffer_load_dwordx4 v46, s[44:47], s78 offen offset:2048 lds
    buffer_load_dwordx4 v47, s[44:47], s78 offen offset:3072 lds
    s_mov_b32 m0, 82176
    s_nop 0
    buffer_load_dwordx4 v32, s[48:51], s74 offen lds
    buffer_load_dwordx4 v33, s[48:51], s74 offen offset:1024 lds
    buffer_load_dwordx4 v34, s[48:51], s74 offen offset:2048 lds
    buffer_load_dwordx4 v35, s[48:51], s74 offen offset:3072 lds
    s_mov_b32 m0, 114944
    s_nop 0
    buffer_load_dwordx4 v48, s[44:47], s78 offen lds
    s_waitcnt vmcnt(55)
    buffer_load_dwordx4 v49, s[44:47], s78 offen offset:1024 lds
    s_mov_b32 m0, 90368
    s_nop 0
    buffer_load_dwordx4 v32, s[52:55], s74 offen lds
    buffer_load_dwordx4 v33, s[52:55], s74 offen offset:1024 lds
    buffer_load_dwordx4 v34, s[52:55], s74 offen offset:2048 lds
    buffer_load_dwordx4 v35, s[52:55], s74 offen offset:3072 lds
    s_waitcnt vmcnt(30) lgkmcnt(0)
    s_barrier
    s_lshr_b64 s[80:81], s[80:81], 4
    s_and_b32 s79, s80, 15
    s_add_u32 s79, s79, s43
    s_sub_u32 s38, s79, 10
    s_cmp_ge_u32 s79, 10
    s_cselect_b32 s79, s38, s79
    s_mul_i32 s75, s79, 245760
    s_lshl_b32 s78, s79, 7
    s_mov_b32 m0, 141696
    s_nop 0
    buffer_load_dwordx4 v36, s[44:47], s78 offen lds
    buffer_load_dwordx4 v37, s[44:47], s78 offen offset:1024 lds
    buffer_load_dwordx4 v38, s[44:47], s78 offen offset:2048 lds
    buffer_load_dwordx4 v39, s[44:47], s78 offen offset:3072 lds
    s_mov_b32 m0, 117120
    s_nop 0
    buffer_load_dwordx4 v28, s[48:51], s75 offen lds
    buffer_load_dwordx4 v29, s[48:51], s75 offen offset:1024 lds
    buffer_load_dwordx4 v30, s[48:51], s75 offen offset:2048 lds
    buffer_load_dwordx4 v31, s[48:51], s75 offen offset:3072 lds
    s_mov_b32 m0, 145792
    s_nop 0
    buffer_load_dwordx4 v40, s[44:47], s78 offen lds
    buffer_load_dwordx4 v41, s[44:47], s78 offen offset:1024 lds
    buffer_load_dwordx4 v42, s[44:47], s78 offen offset:2048 lds
    buffer_load_dwordx4 v43, s[44:47], s78 offen offset:3072 lds
    s_mov_b32 m0, 125312
    s_nop 0
    buffer_load_dwordx4 v28, s[52:55], s75 offen lds
    buffer_load_dwordx4 v29, s[52:55], s75 offen offset:1024 lds
    buffer_load_dwordx4 v30, s[52:55], s75 offen offset:2048 lds
    buffer_load_dwordx4 v31, s[52:55], s75 offen offset:3072 lds
    s_mov_b32 m0, 149888
    s_nop 0
    buffer_load_dwordx4 v44, s[44:47], s78 offen lds
    buffer_load_dwordx4 v45, s[44:47], s78 offen offset:1024 lds
    buffer_load_dwordx4 v46, s[44:47], s78 offen offset:2048 lds
    buffer_load_dwordx4 v47, s[44:47], s78 offen offset:3072 lds
    s_mov_b32 m0, 121216
    s_nop 0
    buffer_load_dwordx4 v32, s[48:51], s75 offen lds
    buffer_load_dwordx4 v33, s[48:51], s75 offen offset:1024 lds
    buffer_load_dwordx4 v34, s[48:51], s75 offen offset:2048 lds
    buffer_load_dwordx4 v35, s[48:51], s75 offen offset:3072 lds
    s_mov_b32 m0, 153984
    s_nop 0
    buffer_load_dwordx4 v48, s[44:47], s78 offen lds
    buffer_load_dwordx4 v49, s[44:47], s78 offen offset:1024 lds
    s_mov_b32 m0, 129408
    s_nop 0
    buffer_load_dwordx4 v32, s[52:55], s75 offen lds
    buffer_load_dwordx4 v33, s[52:55], s75 offen offset:1024 lds
    buffer_load_dwordx4 v34, s[52:55], s75 offen offset:2048 lds
    buffer_load_dwordx4 v35, s[52:55], s75 offen offset:3072 lds
    s_waitcnt vmcnt(30) lgkmcnt(0)
    s_barrier
    s_lshr_b64 s[80:81], s[80:81], 4
    s_and_b32 s79, s80, 15
    s_add_u32 s79, s79, s43
    s_sub_u32 s38, s79, 10
    s_cmp_ge_u32 s79, 10
    s_cselect_b32 s79, s38, s79
    s_mul_i32 s76, s79, 245760
    s_lshl_b32 s78, s79, 7
    s_mov_b32 m0, 24576
    s_nop 0
    buffer_load_dwordx4 v36, s[44:47], s78 offen lds
    buffer_load_dwordx4 v37, s[44:47], s78 offen offset:1024 lds
    buffer_load_dwordx4 v38, s[44:47], s78 offen offset:2048 lds
    buffer_load_dwordx4 v39, s[44:47], s78 offen offset:3072 lds
    s_mov_b32 m0, 0
    s_nop 0
    buffer_load_dwordx4 v28, s[48:51], s76 offen lds
    buffer_load_dwordx4 v29, s[48:51], s76 offen offset:1024 lds
    buffer_load_dwordx4 v30, s[48:51], s76 offen offset:2048 lds
    buffer_load_dwordx4 v31, s[48:51], s76 offen offset:3072 lds
    s_mov_b32 m0, 28672
    s_nop 0
    buffer_load_dwordx4 v40, s[44:47], s78 offen lds
    buffer_load_dwordx4 v41, s[44:47], s78 offen offset:1024 lds
    buffer_load_dwordx4 v42, s[44:47], s78 offen offset:2048 lds
    buffer_load_dwordx4 v43, s[44:47], s78 offen offset:3072 lds
    s_mov_b32 m0, 8192
    s_nop 0
    buffer_load_dwordx4 v28, s[52:55], s76 offen lds
    buffer_load_dwordx4 v29, s[52:55], s76 offen offset:1024 lds
    buffer_load_dwordx4 v30, s[52:55], s76 offen offset:2048 lds
    buffer_load_dwordx4 v31, s[52:55], s76 offen offset:3072 lds
    s_mov_b32 m0, 32768
    s_nop 0
    buffer_load_dwordx4 v44, s[44:47], s78 offen lds
    buffer_load_dwordx4 v45, s[44:47], s78 offen offset:1024 lds
    buffer_load_dwordx4 v46, s[44:47], s78 offen offset:2048 lds
    buffer_load_dwordx4 v47, s[44:47], s78 offen offset:3072 lds
    s_mov_b32 m0, 4096
    s_nop 0
    buffer_load_dwordx4 v32, s[48:51], s76 offen lds
    buffer_load_dwordx4 v33, s[48:51], s76 offen offset:1024 lds
    buffer_load_dwordx4 v34, s[48:51], s76 offen offset:2048 lds
    buffer_load_dwordx4 v35, s[48:51], s76 offen offset:3072 lds
    s_mov_b32 m0, 36864
    s_nop 0
    buffer_load_dwordx4 v48, s[44:47], s78 offen lds
    buffer_load_dwordx4 v49, s[44:47], s78 offen offset:1024 lds
    s_mov_b32 m0, 12288
    s_nop 0
    buffer_load_dwordx4 v32, s[52:55], s76 offen lds
    buffer_load_dwordx4 v33, s[52:55], s76 offen offset:1024 lds
    buffer_load_dwordx4 v34, s[52:55], s76 offen offset:2048 lds
    buffer_load_dwordx4 v35, s[52:55], s76 offen offset:3072 lds
    s_waitcnt vmcnt(30) lgkmcnt(0)
    s_barrier
    s_lshr_b64 s[80:81], s[80:81], 4
    s_and_b32 s79, s80, 15
    s_add_u32 s79, s79, s43
    s_sub_u32 s38, s79, 10
    s_cmp_ge_u32 s79, 10
    s_cselect_b32 s79, s38, s79
    s_mul_i32 s77, s79, 245760
    s_lshl_b32 s78, s79, 7
    s_mov_b32 m0, 63616
    s_nop 0
    buffer_load_dwordx4 v36, s[44:47], s78 offen lds
    buffer_load_dwordx4 v37, s[44:47], s78 offen offset:1024 lds
    buffer_load_dwordx4 v38, s[44:47], s78 offen offset:2048 lds
    buffer_load_dwordx4 v39, s[44:47], s78 offen offset:3072 lds
    s_mov_b32 m0, 39040
    s_nop 0
    buffer_load_dwordx4 v28, s[48:51], s77 offen lds
    buffer_load_dwordx4 v29, s[48:51], s77 offen offset:1024 lds
    buffer_load_dwordx4 v30, s[48:51], s77 offen offset:2048 lds
    buffer_load_dwordx4 v31, s[48:51], s77 offen offset:3072 lds
    s_mov_b32 m0, 67712
    s_nop 0
    buffer_load_dwordx4 v40, s[44:47], s78 offen lds
    buffer_load_dwordx4 v41, s[44:47], s78 offen offset:1024 lds
    buffer_load_dwordx4 v42, s[44:47], s78 offen offset:2048 lds
    buffer_load_dwordx4 v43, s[44:47], s78 offen offset:3072 lds
    s_mov_b32 m0, 47232
    s_nop 0
    buffer_load_dwordx4 v28, s[52:55], s77 offen lds
    buffer_load_dwordx4 v29, s[52:55], s77 offen offset:1024 lds
    buffer_load_dwordx4 v30, s[52:55], s77 offen offset:2048 lds
    buffer_load_dwordx4 v31, s[52:55], s77 offen offset:3072 lds
    s_mov_b32 m0, 71808
    s_nop 0
    buffer_load_dwordx4 v44, s[44:47], s78 offen lds
    buffer_load_dwordx4 v45, s[44:47], s78 offen offset:1024 lds
    buffer_load_dwordx4 v46, s[44:47], s78 offen offset:2048 lds
    buffer_load_dwordx4 v47, s[44:47], s78 offen offset:3072 lds
    s_mov_b32 m0, 43136
    s_nop 0
    buffer_load_dwordx4 v32, s[48:51], s77 offen lds
    buffer_load_dwordx4 v33, s[48:51], s77 offen offset:1024 lds
    buffer_load_dwordx4 v34, s[48:51], s77 offen offset:2048 lds
    buffer_load_dwordx4 v35, s[48:51], s77 offen offset:3072 lds
    s_mov_b32 m0, 75904
    s_nop 0
    buffer_load_dwordx4 v48, s[44:47], s78 offen lds
    buffer_load_dwordx4 v49, s[44:47], s78 offen offset:1024 lds
    s_mov_b32 m0, 51328
    s_nop 0
    buffer_load_dwordx4 v32, s[52:55], s77 offen lds
    buffer_load_dwordx4 v33, s[52:55], s77 offen offset:1024 lds
    buffer_load_dwordx4 v34, s[52:55], s77 offen offset:2048 lds
    buffer_load_dwordx4 v35, s[52:55], s77 offen offset:3072 lds
    s_waitcnt vmcnt(30) lgkmcnt(0)
    s_barrier
    s_lshr_b64 s[80:81], s[80:81], 4
    s_and_b32 s79, s80, 15
    s_add_u32 s79, s79, s43
    s_sub_u32 s38, s79, 10
    s_cmp_ge_u32 s79, 10
    s_cselect_b32 s79, s38, s79
    s_mov_b32 m0, 94464
    s_nop 0
    buffer_load_dwordx4 v28, s[56:59], s74 offen lds
    buffer_load_dwordx4 v29, s[56:59], s74 offen offset:1024 lds
    buffer_load_dwordx4 v30, s[56:59], s74 offen offset:2048 lds
    buffer_load_dwordx4 v31, s[56:59], s74 offen offset:3072 lds
    s_mov_b32 m0, 98560
    s_nop 0
    buffer_load_dwordx4 v32, s[56:59], s74 offen lds
    buffer_load_dwordx4 v33, s[56:59], s74 offen offset:1024 lds
    buffer_load_dwordx4 v34, s[56:59], s74 offen offset:2048 lds
    buffer_load_dwordx4 v35, s[56:59], s74 offen offset:3072 lds
    s_mov_b32 m0, 133504
    s_nop 0
    buffer_load_dwordx4 v28, s[56:59], s75 offen lds
    buffer_load_dwordx4 v29, s[56:59], s75 offen offset:1024 lds
    buffer_load_dwordx4 v30, s[56:59], s75 offen offset:2048 lds
    buffer_load_dwordx4 v31, s[56:59], s75 offen offset:3072 lds
    s_waitcnt vmcnt(12) lgkmcnt(0)
    s_barrier
    s_mov_b32 m0, 137600
    s_nop 0
    buffer_load_dwordx4 v32, s[56:59], s75 offen lds
    buffer_load_dwordx4 v33, s[56:59], s75 offen offset:1024 lds
    buffer_load_dwordx4 v34, s[56:59], s75 offen offset:2048 lds
    buffer_load_dwordx4 v35, s[56:59], s75 offen offset:3072 lds
    s_mov_b32 m0, 16384
    s_nop 0
    buffer_load_dwordx4 v28, s[56:59], s76 offen lds
    buffer_load_dwordx4 v29, s[56:59], s76 offen offset:1024 lds
    buffer_load_dwordx4 v30, s[56:59], s76 offen offset:2048 lds
    buffer_load_dwordx4 v31, s[56:59], s76 offen offset:3072 lds
    s_mov_b32 m0, 20480
    s_nop 0
    buffer_load_dwordx4 v32, s[56:59], s76 offen lds
    buffer_load_dwordx4 v33, s[56:59], s76 offen offset:1024 lds
    buffer_load_dwordx4 v34, s[56:59], s76 offen offset:2048 lds
    buffer_load_dwordx4 v35, s[56:59], s76 offen offset:3072 lds
    s_mov_b32 m0, 55424
    s_nop 0
    buffer_load_dwordx4 v28, s[56:59], s77 offen lds
    buffer_load_dwordx4 v29, s[56:59], s77 offen offset:1024 lds
    buffer_load_dwordx4 v30, s[56:59], s77 offen offset:2048 lds
    buffer_load_dwordx4 v31, s[56:59], s77 offen offset:3072 lds
    s_mov_b32 m0, 59520
    s_nop 0
    buffer_load_dwordx4 v32, s[56:59], s77 offen lds
    buffer_load_dwordx4 v33, s[56:59], s77 offen offset:1024 lds
    buffer_load_dwordx4 v34, s[56:59], s77 offen offset:2048 lds
    buffer_load_dwordx4 v35, s[56:59], s77 offen offset:3072 lds
    s_mov_b32 s10, 20480
    v_lshrrev_b32 v52, 5, v1
    v_lshlrev_b32 v52, 3, v52
    v_add_u32 v53, 2, v52
    v_add_u32 v54, 4, v52
    v_add_u32 v55, 6, v52
    v_add_u32 v56, 16, v52
    v_add_u32 v57, 18, v52
    v_add_u32 v58, 20, v52
    v_add_u32 v59, 22, v52
    v_and_b32 v7, 3, v5
    v_mul_u32_u24 v7, 1280, v7
    v_add_u32 v60, v7, v50
    v_xor_b32 v61, 64, v60
    v_add_u32 v61, 4096, v61
    v_add_u32 v62, 8192, v60
    v_add_u32 v63, 8192, v61
    s_mov_b32 s42, 0
    s_mov_b32 s5, 0xbfe10856
    s_mov_b32 s6, 0xaff80255
    s_mov_b32 s7, 0xabfe4015
    s_mov_b32 s8, 0xaa7fd005
    s_mov_b32 s9, 0x6adfb401
    s_cmp_eq_u32 s42, 1
    s_cselect_b32 s5, 0xabfe4015, s5
    s_cselect_b32 s6, 0xaa7fd005, s6
    s_cselect_b32 s7, 0x6adfb401, s7
    s_cselect_b32 s8, 0xbfe10856, s8
    s_cselect_b32 s9, 0xaff80255, s9
    s_cmp_eq_u32 s42, 2
    s_cselect_b32 s5, 0x6adfb401, s5
    s_cselect_b32 s6, 0xbfe10856, s6
    s_cselect_b32 s7, 0xaff80255, s7
    s_cselect_b32 s8, 0xabfe4015, s8
    s_cselect_b32 s9, 0xaa7fd005, s9
    s_cmp_eq_u32 s42, 3
    s_cselect_b32 s5, 0xaff80255, s5
    s_cselect_b32 s6, 0xabfe4015, s6
    s_cselect_b32 s7, 0xaa7fd005, s7
    s_cselect_b32 s8, 0x6adfb401, s8
    s_cselect_b32 s9, 0xbfe10856, s9
    s_cmp_eq_u32 s42, 4
    s_cselect_b32 s5, 0xaa7fd005, s5
    s_cselect_b32 s6, 0x6adfb401, s6
    s_cselect_b32 s7, 0xbfe10856, s7
    s_cselect_b32 s8, 0xaff80255, s8
    s_cselect_b32 s9, 0xabfe4015, s9
    s_mul_i32 s4, s42, 163840
    s_mov_b32 m0, 0
    v_bfe_u32 v64, s5, v52, 2
    v_mad_u32_u24 v64, v64, s10, v60
    buffer_load_dwordx4 v64, s[60:63], s4 offen lds
    v_bfe_u32 v65, s5, v53, 2
    v_mad_u32_u24 v65, v65, s10, v61
    buffer_load_dwordx4 v65, s[60:63], s4 offen offset:1024 lds
    v_bfe_u32 v64, s5, v54, 2
    v_mad_u32_u24 v64, v64, s10, v62
    buffer_load_dwordx4 v64, s[60:63], s4 offen offset:2048 lds
    v_bfe_u32 v65, s5, v55, 2
    v_mad_u32_u24 v65, v65, s10, v63
    buffer_load_dwordx4 v65, s[60:63], s4 offen offset:3072 lds
    s_mov_b32 m0, 4096
    v_bfe_u32 v64, s5, v56, 2
    v_mad_u32_u24 v64, v64, s10, v60
    buffer_load_dwordx4 v64, s[60:63], s4 offen lds
    v_bfe_u32 v65, s5, v57, 2
    v_mad_u32_u24 v65, v65, s10, v61
    buffer_load_dwordx4 v65, s[60:63], s4 offen offset:1024 lds
    v_bfe_u32 v64, s5, v58, 2
    v_mad_u32_u24 v64, v64, s10, v62
    buffer_load_dwordx4 v64, s[60:63], s4 offen offset:2048 lds
    v_bfe_u32 v65, s5, v59, 2
    v_mad_u32_u24 v65, v65, s10, v63
    buffer_load_dwordx4 v65, s[60:63], s4 offen offset:3072 lds
    s_add_u32 s4, s4, 81920
    s_cmp_eq_u32 s4, 819200
    s_cselect_b32 s4, 0, s4
    s_mov_b32 m0, 8192
    v_bfe_u32 v64, s6, v52, 2
    v_mad_u32_u24 v64, v64, s10, v60
    buffer_load_dwordx4 v64, s[60:63], s4 offen lds
    v_bfe_u32 v65, s6, v53, 2
    v_mad_u32_u24 v65, v65, s10, v61
    buffer_load_dwordx4 v65, s[60:63], s4 offen offset:1024 lds
    v_bfe_u32 v64, s6, v54, 2
    v_mad_u32_u24 v64, v64, s10, v62
    buffer_load_dwordx4 v64, s[60:63], s4 offen offset:2048 lds
    v_bfe_u32 v65, s6, v55, 2
    v_mad_u32_u24 v65, v65, s10, v63
    buffer_load_dwordx4 v65, s[60:63], s4 offen offset:3072 lds
    s_mov_b32 m0, 12288
    v_bfe_u32 v64, s6, v56, 2
    v_mad_u32_u24 v64, v64, s10, v60
    buffer_load_dwordx4 v64, s[60:63], s4 offen lds
    v_bfe_u32 v65, s6, v57, 2
    v_mad_u32_u24 v65, v65, s10, v61
    buffer_load_dwordx4 v65, s[60:63], s4 offen offset:1024 lds
    v_bfe_u32 v64, s6, v58, 2
    v_mad_u32_u24 v64, v64, s10, v62
    buffer_load_dwordx4 v64, s[60:63], s4 offen offset:2048 lds
    v_bfe_u32 v65, s6, v59, 2
    v_mad_u32_u24 v65, v65, s10, v63
    buffer_load_dwordx4 v65, s[60:63], s4 offen offset:3072 lds
    s_add_u32 s4, s4, 81920
    s_cmp_eq_u32 s4, 819200
    s_cselect_b32 s4, 0, s4
    s_waitcnt vmcnt(16)
    v_mov_b32 v5, 157980
    v_mov_b32 v6, 1
    s_mov_b64 exec, 1
    ds_add_u32 v5, v6
    s_mov_b64 exec, -1
    v_mov_b32 v5, 157972
    v_mov_b32 v6, 1
    s_mov_b64 exec, 1
    ds_add_u32 v5, v6
    s_mov_b64 exec, -1
    s_mov_b32 m0, 24576
    v_bfe_u32 v64, s7, v52, 2
    v_mad_u32_u24 v64, v64, s10, v60
    buffer_load_dwordx4 v64, s[60:63], s4 offen lds
    v_bfe_u32 v65, s7, v53, 2
    v_mad_u32_u24 v65, v65, s10, v61
    buffer_load_dwordx4 v65, s[60:63], s4 offen offset:1024 lds
    v_bfe_u32 v64, s7, v54, 2
    v_mad_u32_u24 v64, v64, s10, v62
    buffer_load_dwordx4 v64, s[60:63], s4 offen offset:2048 lds
    v_bfe_u32 v65, s7, v55, 2
    v_mad_u32_u24 v65, v65, s10, v63
    buffer_load_dwordx4 v65, s[60:63], s4 offen offset:3072 lds
    s_mov_b32 m0, 28672
    v_bfe_u32 v64, s7, v56, 2
    v_mad_u32_u24 v64, v64, s10, v60
    buffer_load_dwordx4 v64, s[60:63], s4 offen lds
    v_bfe_u32 v65, s7, v57, 2
    v_mad_u32_u24 v65, v65, s10, v61
    buffer_load_dwordx4 v65, s[60:63], s4 offen offset:1024 lds
    v_bfe_u32 v64, s7, v58, 2
    v_mad_u32_u24 v64, v64, s10, v62
    buffer_load_dwordx4 v64, s[60:63], s4 offen offset:2048 lds
    v_bfe_u32 v65, s7, v59, 2
    v_mad_u32_u24 v65, v65, s10, v63
    buffer_load_dwordx4 v65, s[60:63], s4 offen offset:3072 lds
    s_add_u32 s4, s4, 81920
    s_cmp_eq_u32 s4, 819200
    s_cselect_b32 s4, 0, s4
    s_mov_b32 m0, 123136
    v_bfe_u32 v64, s8, v52, 2
    v_mad_u32_u24 v64, v64, s10, v60
    buffer_load_dwordx4 v64, s[60:63], s4 offen lds
    v_bfe_u32 v65, s8, v53, 2
    v_mad_u32_u24 v65, v65, s10, v61
    buffer_load_dwordx4 v65, s[60:63], s4 offen offset:1024 lds
    v_bfe_u32 v64, s8, v54, 2
    v_mad_u32_u24 v64, v64, s10, v62
    buffer_load_dwordx4 v64, s[60:63], s4 offen offset:2048 lds
    v_bfe_u32 v65, s8, v55, 2
    v_mad_u32_u24 v65, v65, s10, v63
    buffer_load_dwordx4 v65, s[60:63], s4 offen offset:3072 lds
    s_mov_b32 m0, 127232
    v_bfe_u32 v64, s8, v56, 2
    v_mad_u32_u24 v64, v64, s10, v60
    buffer_load_dwordx4 v64, s[60:63], s4 offen lds
    v_bfe_u32 v65, s8, v57, 2
    v_mad_u32_u24 v65, v65, s10, v61
    buffer_load_dwordx4 v65, s[60:63], s4 offen offset:1024 lds
    v_bfe_u32 v64, s8, v58, 2
    v_mad_u32_u24 v64, v64, s10, v62
    buffer_load_dwordx4 v64, s[60:63], s4 offen offset:2048 lds
    v_bfe_u32 v65, s8, v59, 2
    v_mad_u32_u24 v65, v65, s10, v63
    buffer_load_dwordx4 v65, s[60:63], s4 offen offset:3072 lds
    s_add_u32 s4, s4, 81920
    s_cmp_eq_u32 s4, 819200
    s_cselect_b32 s4, 0, s4
    s_mov_b32 m0, 80000
    v_bfe_u32 v64, s9, v52, 2
    v_mad_u32_u24 v64, v64, s10, v60
    buffer_load_dwordx4 v64, s[60:63], s4 offen lds
    v_bfe_u32 v65, s9, v53, 2
    v_mad_u32_u24 v65, v65, s10, v61
    buffer_load_dwordx4 v65, s[60:63], s4 offen offset:1024 lds
    v_bfe_u32 v64, s9, v54, 2
    v_mad_u32_u24 v64, v64, s10, v62
    buffer_load_dwordx4 v64, s[60:63], s4 offen offset:2048 lds
    v_bfe_u32 v65, s9, v55, 2
    v_mad_u32_u24 v65, v65, s10, v63
    buffer_load_dwordx4 v65, s[60:63], s4 offen offset:3072 lds
    s_mov_b32 m0, 84096
    v_bfe_u32 v64, s9, v56, 2
    v_mad_u32_u24 v64, v64, s10, v60
    buffer_load_dwordx4 v64, s[60:63], s4 offen lds
    v_bfe_u32 v65, s9, v57, 2
    v_mad_u32_u24 v65, v65, s10, v61
    buffer_load_dwordx4 v65, s[60:63], s4 offen offset:1024 lds
    v_bfe_u32 v64, s9, v58, 2
    v_mad_u32_u24 v64, v64, s10, v62
    buffer_load_dwordx4 v64, s[60:63], s4 offen offset:2048 lds
    v_bfe_u32 v65, s9, v59, 2
    v_mad_u32_u24 v65, v65, s10, v63
    buffer_load_dwordx4 v65, s[60:63], s4 offen offset:3072 lds
    s_add_u32 s4, s4, 81920
    s_cmp_eq_u32 s4, 819200
    s_cselect_b32 s4, 0, s4
    s_waitcnt vmcnt(0)
    v_mov_b32 v7, 157980
    v_mov_b32 v6, 1
    s_mov_b64 exec, 1
    ds_add_u32 v7, v6
    s_mov_b64 exec, -1
Lcw_7:
    s_sub_u32 s35, s35, 1
    s_cbranch_scc1 Lend
    s_sleep 2
    ds_read_b32 v6, v5
    s_waitcnt lgkmcnt(0)
    v_readfirstlane_b32 s38, v6
    s_nop 0
    s_cmp_lt_u32 s38, 8
    s_cbranch_scc1 Lcw_7
    s_lshl_b32 s36, s32, 7
    s_add_u32 s36, s36, 8257536
    v_mov_b32 v69, s36
    buffer_load_dwordx4 v[70:73], v69, s[28:31], 0 offen sc1
    v_mov_b32 v5, 157976
Lcw_8:
    s_sub_u32 s35, s35, 1
    s_cbranch_scc1 Lend
    s_sleep 2
    ds_read_b32 v6, v5
    s_waitcnt lgkmcnt(0)
    v_readfirstlane_b32 s38, v6
    s_nop 0
    s_cmp_lt_u32 s38, 7
    s_cbranch_scc1 Lcw_8
    s_mov_b32 m0, 32768
    v_bfe_u32 v64, s5, v52, 2
    v_mad_u32_u24 v64, v64, s10, v60
    buffer_load_dwordx4 v64, s[60:63], s4 offen lds
    v_bfe_u32 v65, s5, v53, 2
    v_mad_u32_u24 v65, v65, s10, v61
    buffer_load_dwordx4 v65, s[60:63], s4 offen offset:1024 lds
    v_bfe_u32 v64, s5, v54, 2
    v_mad_u32_u24 v64, v64, s10, v62
    buffer_load_dwordx4 v64, s[60:63], s4 offen offset:2048 lds
    v_bfe_u32 v65, s5, v55, 2
    v_mad_u32_u24 v65, v65, s10, v63
    buffer_load_dwordx4 v65, s[60:63], s4 offen offset:3072 lds
    s_mov_b32 m0, 36864
    v_bfe_u32 v64, s5, v56, 2
    v_mad_u32_u24 v64, v64, s10, v60
    buffer_load_dwordx4 v64, s[60:63], s4 offen lds
    v_bfe_u32 v65, s5, v57, 2
    v_mad_u32_u24 v65, v65, s10, v61
    buffer_load_dwordx4 v65, s[60:63], s4 offen offset:1024 lds
    v_bfe_u32 v64, s5, v58, 2
    v_mad_u32_u24 v64, v64, s10, v62
    buffer_load_dwordx4 v64, s[60:63], s4 offen offset:2048 lds
    v_bfe_u32 v65, s5, v59, 2
    v_mad_u32_u24 v65, v65, s10, v63
    buffer_load_dwordx4 v65, s[60:63], s4 offen offset:3072 lds
    s_add_u32 s4, s4, 81920
    s_cmp_eq_u32 s4, 819200
    s_cselect_b32 s4, 0, s4
    s_mov_b32 m0, 40960
    v_bfe_u32 v64, s6, v52, 2
    v_mad_u32_u24 v64, v64, s10, v60
    buffer_load_dwordx4 v64, s[60:63], s4 offen lds
    v_bfe_u32 v65, s6, v53, 2
    v_mad_u32_u24 v65, v65, s10, v61
    buffer_load_dwordx4 v65, s[60:63], s4 offen offset:1024 lds
    v_bfe_u32 v64, s6, v54, 2
    v_mad_u32_u24 v64, v64, s10, v62
    buffer_load_dwordx4 v64, s[60:63], s4 offen offset:2048 lds
    v_bfe_u32 v65, s6, v55, 2
    v_mad_u32_u24 v65, v65, s10, v63
    buffer_load_dwordx4 v65, s[60:63], s4 offen offset:3072 lds
    s_mov_b32 m0, 45056
    v_bfe_u32 v64, s6, v56, 2
    v_mad_u32_u24 v64, v64, s10, v60
    buffer_load_dwordx4 v64, s[60:63], s4 offen lds
    v_bfe_u32 v65, s6, v57, 2
    v_mad_u32_u24 v65, v65, s10, v61
    buffer_load_dwordx4 v65, s[60:63], s4 offen offset:1024 lds
    v_bfe_u32 v64, s6, v58, 2
    v_mad_u32_u24 v64, v64, s10, v62
    buffer_load_dwordx4 v64, s[60:63], s4 offen offset:2048 lds
    v_bfe_u32 v65, s6, v59, 2
    v_mad_u32_u24 v65, v65, s10, v63
    buffer_load_dwordx4 v65, s[60:63], s4 offen offset:3072 lds
    s_add_u32 s4, s4, 81920
    s_cmp_eq_u32 s4, 819200
    s_cselect_b32 s4, 0, s4
    s_mov_b32 m0, 63616
    v_bfe_u32 v64, s7, v52, 2
    v_mad_u32_u24 v64, v64, s10, v60
    buffer_load_dwordx4 v64, s[60:63], s4 offen lds
    v_bfe_u32 v65, s7, v53, 2
    v_mad_u32_u24 v65, v65, s10, v61
    buffer_load_dwordx4 v65, s[60:63], s4 offen offset:1024 lds
    v_bfe_u32 v64, s7, v54, 2
    v_mad_u32_u24 v64, v64, s10, v62
    buffer_load_dwordx4 v64, s[60:63], s4 offen offset:2048 lds
    v_bfe_u32 v65, s7, v55, 2
    v_mad_u32_u24 v65, v65, s10, v63
    buffer_load_dwordx4 v65, s[60:63], s4 offen offset:3072 lds
    s_mov_b32 m0, 67712
    v_bfe_u32 v64, s7, v56, 2
    v_mad_u32_u24 v64, v64, s10, v60
    buffer_load_dwordx4 v64, s[60:63], s4 offen lds
    v_bfe_u32 v65, s7, v57, 2
    v_mad_u32_u24 v65, v65, s10, v61
    buffer_load_dwordx4 v65, s[60:63], s4 offen offset:1024 lds
    v_bfe_u32 v64, s7, v58, 2
    v_mad_u32_u24 v64, v64, s10, v62
    buffer_load_dwordx4 v64, s[60:63], s4 offen offset:2048 lds
    v_bfe_u32 v65, s7, v59, 2
    v_mad_u32_u24 v65, v65, s10, v63
    buffer_load_dwordx4 v65, s[60:63], s4 offen offset:3072 lds
    s_add_u32 s4, s4, 81920
    s_cmp_eq_u32 s4, 819200
    s_cselect_b32 s4, 0, s4
    s_mov_b32 m0, 71808
    v_bfe_u32 v64, s8, v52, 2
    v_mad_u32_u24 v64, v64, s10, v60
    buffer_load_dwordx4 v64, s[60:63], s4 offen lds
    v_bfe_u32 v65, s8, v53, 2
    v_mad_u32_u24 v65, v65, s10, v61
    buffer_load_dwordx4 v65, s[60:63], s4 offen offset:1024 lds
    v_bfe_u32 v64, s8, v54, 2
    v_mad_u32_u24 v64, v64, s10, v62
    buffer_load_dwordx4 v64, s[60:63], s4 offen offset:2048 lds
    v_bfe_u32 v65, s8, v55, 2
    v_mad_u32_u24 v65, v65, s10, v63
    buffer_load_dwordx4 v65, s[60:63], s4 offen offset:3072 lds
    s_mov_b32 m0, 75904
    v_bfe_u32 v64, s8, v56, 2
    v_mad_u32_u24 v64, v64, s10, v60
    buffer_load_dwordx4 v64, s[60:63], s4 offen lds
    v_bfe_u32 v65, s8, v57, 2
    v_mad_u32_u24 v65, v65, s10, v61
    buffer_load_dwordx4 v65, s[60:63], s4 offen offset:1024 lds
    v_bfe_u32 v64, s8, v58, 2
    v_mad_u32_u24 v64, v64, s10, v62
    buffer_load_dwordx4 v64, s[60:63], s4 offen offset:2048 lds
    v_bfe_u32 v65, s8, v59, 2
    v_mad_u32_u24 v65, v65, s10, v63
    buffer_load_dwordx4 v65, s[60:63], s4 offen offset:3072 lds
    s_add_u32 s4, s4, 81920
    s_cmp_eq_u32 s4, 819200
    s_cselect_b32 s4, 0, s4
    s_mov_b32 m0, 49152
    v_bfe_u32 v64, s9, v52, 2
    v_mad_u32_u24 v64, v64, s10, v60
    buffer_load_dwordx4 v64, s[60:63], s4 offen lds
    v_bfe_u32 v65, s9, v53, 2
    v_mad_u32_u24 v65, v65, s10, v61
    buffer_load_dwordx4 v65, s[60:63], s4 offen offset:1024 lds
    v_bfe_u32 v64, s9, v54, 2
    v_mad_u32_u24 v64, v64, s10, v62
    buffer_load_dwordx4 v64, s[60:63], s4 offen offset:2048 lds
    v_bfe_u32 v65, s9, v55, 2
    v_mad_u32_u24 v65, v65, s10, v63
    buffer_load_dwordx4 v65, s[60:63], s4 offen offset:3072 lds
    s_mov_b32 m0, 88192
    v_bfe_u32 v64, s9, v56, 2
    v_mad_u32_u24 v64, v64, s10, v60
    buffer_load_dwordx4 v64, s[60:63], s4 offen lds
    v_bfe_u32 v65, s9, v57, 2
    v_mad_u32_u24 v65, v65, s10, v61
    buffer_load_dwordx4 v65, s[60:63], s4 offen offset:1024 lds
    v_bfe_u32 v64, s9, v58, 2
    v_mad_u32_u24 v64, v64, s10, v62
    buffer_load_dwordx4 v64, s[60:63], s4 offen offset:2048 lds
    v_bfe_u32 v65, s9, v59, 2
    v_mad_u32_u24 v65, v65, s10, v63
    buffer_load_dwordx4 v65, s[60:63], s4 offen offset:3072 lds
    s_add_u32 s4, s4, 81920
    s_cmp_eq_u32 s4, 819200
    s_cselect_b32 s4, 0, s4
    s_waitcnt vmcnt(0)
Lbc:
    v_readfirstlane_b32 s11, v70
    v_readfirstlane_b32 s36, v71
    v_readfirstlane_b32 s12, v72
    v_readfirstlane_b32 s37, v73
    s_cmp_eq_u32 s36, s34
    s_cselect_b32 s37, s37, s36
    s_cmp_eq_u32 s37, s34
    s_cbranch_scc1 Lbc_ok
Lbc_re:
    s_sub_u32 s35, s35, 1
    s_cbranch_scc1 Lend
    buffer_load_dwordx4 v[70:73], v69, s[28:31], 0 offen sc1
    s_waitcnt vmcnt(0)
    s_branch Lbc
Lbc_ok:
    s_mul_i32 s36, s32, 96
    s_and_b32 s13, s11, 0x7ff
    s_sub_u32 s13, 2047, s13
    s_sub_u32 s37, s13, s36
    s_cmp_lt_u32 s37, 96
    s_cselect_b32 s13, s13, -1
    s_and_b32 s14, s12, 0x7ff
    s_sub_u32 s14, 2047, s14
    s_sub_u32 s37, s14, s36
    s_cmp_lt_u32 s37, 96
    s_cselect_b32 s14, s14, -1
    v_mov_b32 v4, s13
    v_mov_b32 v5, s14
    v_mov_b32 v6, 157960
    s_cmp_lg_u32 s3, 0
    s_cbranch_scc1 Lag2
    ds_write_b64 v6, v[4:5]
    s_branch Lw0_done
Lag2:
    s_and_b32 s37, s13, s14
    s_cmp_eq_u32 s37, -1
    s_cbranch_scc1 Lw0_done
    s_max_i32 s36, s13, 0
    s_mul_i32 s36, s36, 1280
    s_lshl_b32 s37, s33, 7
    s_add_u32 s36, s36, s37
    s_add_u32 s36, s36, 4096
    v_lshlrev_b32 v8, 1, v1
    buffer_load_ushort v124, v8, s[44:47], s36 offen
    s_max_i32 s36, s14, 0
    s_mul_i32 s36, s36, 1280
    s_lshl_b32 s37, s33, 7
    s_add_u32 s36, s36, s37
    s_add_u32 s36, s36, 4096
    v_lshlrev_b32 v8, 1, v1
    buffer_load_ushort v125, v8, s[44:47], s36 offen
    v_min_u32 v7, 26, v1
    v_mul_u32_u24 v7, 10240, v7
Ly_poll:
    s_sub_u32 s35, s35, 1
    s_cbranch_scc1 Lend
    s_sleep 4
    s_lshl_b32 s36, s33, 10
    s_add_u32 s36, s36, 7405568
    buffer_load_dword v4, v7, s[28:31], s36 offen offset:1020 sc1
    s_waitcnt vmcnt(0)
    v_cmp_ne_u32 vcc, s34, v4
    s_nop 0
    s_cbranch_vccnz Ly_poll
    buffer_load_dwordx4 v[16:19], v13, s[28:31], s36 offen sc1
    s_add_u32 s36, s36, 10240
    buffer_load_dwordx4 v[20:23], v13, s[28:31], s36 offen sc1
    s_add_u32 s36, s36, 10240
    buffer_load_dwordx4 v[24:27], v13, s[28:31], s36 offen sc1
    s_add_u32 s36, s36, 10240
    buffer_load_dwordx4 v[28:31], v13, s[28:31], s36 offen sc1
    s_add_u32 s36, s36, 10240
    buffer_load_dwordx4 v[32:35], v13, s[28:31], s36 offen sc1
    s_add_u32 s36, s36, 10240
    buffer_load_dwordx4 v[36:39], v13, s[28:31], s36 offen sc1
    s_add_u32 s36, s36, 10240
    buffer_load_dwordx4 v[40:43], v13, s[28:31], s36 offen sc1
    s_add_u32 s36, s36, 10240
    buffer_load_dwordx4 v[44:47], v13, s[28:31], s36 offen sc1
    s_add_u32 s36, s36, 10240
    buffer_load_dwordx4 v[48:51], v13, s[28:31], s36 offen sc1
    s_add_u32 s36, s36, 10240
    buffer_load_dwordx4 v[52:55], v13, s[28:31], s36 offen sc1
    s_add_u32 s36, s36, 10240
    buffer_load_dwordx4 v[56:59], v13, s[28:31], s36 offen sc1
    s_add_u32 s36, s36, 10240
    buffer_load_dwordx4 v[60:63], v13, s[28:31], s36 offen sc1
    s_add_u32 s36, s36, 10240
    buffer_load_dwordx4 v[64:67], v13, s[28:31], s36 offen sc1
    s_add_u32 s36, s36, 10240
    buffer_load_dwordx4 v[68:71], v13, s[28:31], s36 offen sc1
    s_add_u32 s36, s36, 10240
    buffer_load_dwordx4 v[72:75], v13, s[28:31], s36 offen sc1
    s_add_u32 s36, s36, 10240
    buffer_load_dwordx4 v[76:79], v13, s[28:31], s36 offen sc1
    s_add_u32 s36, s36, 10240
    buffer_load_dwordx4 v[80:83], v13, s[28:31], s36 offen sc1
    s_add_u32 s36, s36, 10240
    buffer_load_dwordx4 v[84:87], v13, s[28:31], s36 offen sc1
    s_add_u32 s36, s36, 10240
    buffer_load_dwordx4 v[88:91], v13, s[28:31], s36 offen sc1
    s_add_u32 s36, s36, 10240
    buffer_load_dwordx4 v[92:95], v13, s[28:31], s36 offen sc1
    s_add_u32 s36, s36, 10240
    buffer_load_dwordx4 v[96:99], v13, s[28:31], s36 offen sc1
    s_add_u32 s36, s36, 10240
    buffer_load_dwordx4 v[100:103], v13, s[28:31], s36 offen sc1
    s_add_u32 s36, s36, 10240
    buffer_load_dwordx4 v[104:107], v13, s[28:31], s36 offen sc1
    s_add_u32 s36, s36, 10240
    buffer_load_dwordx4 v[108:111], v13, s[28:31], s36 offen sc1
    s_add_u32 s36, s36, 10240
    buffer_load_dwordx4 v[112:115], v13, s[28:31], s36 offen sc1
    s_add_u32 s36, s36, 10240
    buffer_load_dwordx4 v[116:119], v13, s[28:31], s36 offen sc1
    s_add_u32 s36, s36, 10240
    buffer_load_dwordx4 v[120:123], v13, s[28:31], s36 offen sc1
    s_add_u32 s36, s36, 10240
    s_waitcnt vmcnt(0)
    v_xor_b32 v4, s34, v17
    v_xor_b32 v5, s34, v19
    v_or_b32 v4, v4, v5
    v_xor_b32 v5, s34, v21
    v_or_b32 v4, v4, v5
    v_xor_b32 v5, s34, v23
    v_or_b32 v4, v4, v5
    v_xor_b32 v5, s34, v25
    v_or_b32 v4, v4, v5
    v_xor_b32 v5, s34, v27
    v_or_b32 v4, v4, v5
    v_xor_b32 v5, s34, v29
    v_or_b32 v4, v4, v5
    v_xor_b32 v5, s34, v31
    v_or_b32 v4, v4, v5
    v_xor_b32 v5, s34, v33
    v_or_b32 v4, v4, v5
    v_xor_b32 v5, s34, v35
    v_or_b32 v4, v4, v5
    v_xor_b32 v5, s34, v37
    v_or_b32 v4, v4, v5
    v_xor_b32 v5, s34, v39
    v_or_b32 v4, v4, v5
    v_xor_b32 v5, s34, v41
    v_or_b32 v4, v4, v5
    v_xor_b32 v5, s34, v43
    v_or_b32 v4, v4, v5
    v_xor_b32 v5, s34, v45
    v_or_b32 v4, v4, v5
    v_xor_b32 v5, s34, v47
    v_or_b32 v4, v4, v5
    v_xor_b32 v5, s34, v49
    v_or_b32 v4, v4, v5
    v_xor_b32 v5, s34, v51
    v_or_b32 v4, v4, v5
    v_xor_b32 v5, s34, v53
    v_or_b32 v4, v4, v5
    v_xor_b32 v5, s34, v55
    v_or_b32 v4, v4, v5
    v_xor_b32 v5, s34, v57
    v_or_b32 v4, v4, v5
    v_xor_b32 v5, s34, v59
    v_or_b32 v4, v4, v5
    v_xor_b32 v5, s34, v61
    v_or_b32 v4, v4, v5
    v_xor_b32 v5, s34, v63
    v_or_b32 v4, v4, v5
    v_xor_b32 v5, s34, v65
    v_or_b32 v4, v4, v5
    v_xor_b32 v5, s34, v67
    v_or_b32 v4, v4, v5
    v_xor_b32 v5, s34, v69
    v_or_b32 v4, v4, v5
    v_xor_b32 v5, s34, v71
    v_or_b32 v4, v4, v5
    v_xor_b32 v5, s34, v73
    v_or_b32 v4, v4, v5
    v_xor_b32 v5, s34, v75
    v_or_b32 v4, v4, v5
    v_xor_b32 v5, s34, v77
    v_or_b32 v4, v4, v5
    v_xor_b32 v5, s34, v79
    v_or_b32 v4, v4, v5
    v_xor_b32 v5, s34, v81
    v_or_b32 v4, v4, v5
    v_xor_b32 v5, s34, v83
    v_or_b32 v4, v4, v5
    v_xor_b32 v5, s34, v85
    v_or_b32 v4, v4, v5
    v_xor_b32 v5, s34, v87
    v_or_b32 v4, v4, v5
    v_xor_b32 v5, s34, v89
    v_or_b32 v4, v4, v5
    v_xor_b32 v5, s34, v91
    v_or_b32 v4, v4, v5
    v_xor_b32 v5, s34, v93
    v_or_b32 v4, v4, v5
    v_xor_b32 v5, s34, v95
    v_or_b32 v4, v4, v5
    v_xor_b32 v5, s34, v97
    v_or_b32 v4, v4, v5
    v_xor_b32 v5, s34, v99
    v_or_b32 v4, v4, v5
    v_xor_b32 v5, s34, v101
    v_or_b32 v4, v4, v5
    v_xor_b32 v5, s34, v103
    v_or_b32 v4, v4, v5
    v_xor_b32 v5, s34, v105
    v_or_b32 v4, v4, v5
    v_xor_b32 v5, s34, v107
    v_or_b32 v4, v4, v5
    v_xor_b32 v5, s34, v109
    v_or_b32 v4, v4, v5
    v_xor_b32 v5, s34, v111
    v_or_b32 v4, v4, v5
    v_xor_b32 v5, s34, v113
    v_or_b32 v4, v4, v5
    v_xor_b32 v5, s34, v115
    v_or_b32 v4, v4, v5
    v_xor_b32 v5, s34, v117
    v_or_b32 v4, v4, v5
    v_xor_b32 v5, s34, v119
    v_or_b32 v4, v4, v5
    v_xor_b32 v5, s34, v121
    v_or_b32 v4, v4, v5
    v_xor_b32 v5, s34, v123
    v_or_b32 v4, v4, v5
    v_cmp_ne_u32 vcc, 0, v4
    s_nop 0
    s_cmp_lg_u64 vcc, 0
    s_cbranch_scc1 Ly_poll
    v_add_f32 v16, v16, v20
    v_add_f32 v18, v18, v22
    v_add_f32 v16, v16, v24
    v_add_f32 v18, v18, v26
    v_add_f32 v16, v16, v28
    v_add_f32 v18, v18, v30
    v_add_f32 v16, v16, v32
    v_add_f32 v18, v18, v34
    v_add_f32 v16, v16, v36
    v_add_f32 v18, v18, v38
    v_add_f32 v16, v16, v40
    v_add_f32 v18, v18, v42
    v_add_f32 v16, v16, v44
    v_add_f32 v18, v18, v46
    v_add_f32 v16, v16, v48
    v_add_f32 v18, v18, v50
    v_add_f32 v16, v16, v52
    v_add_f32 v18, v18, v54
    v_add_f32 v16, v16, v56
    v_add_f32 v18, v18, v58
    v_add_f32 v16, v16, v60
    v_add_f32 v18, v18, v62
    v_add_f32 v16, v16, v64
    v_add_f32 v18, v18, v66
    v_add_f32 v16, v16, v68
    v_add_f32 v18, v18, v70
    v_add_f32 v16, v16, v72
    v_add_f32 v18, v18, v74
    v_add_f32 v16, v16, v76
    v_add_f32 v18, v18, v78
    v_add_f32 v16, v16, v80
    v_add_f32 v18, v18, v82
    v_add_f32 v16, v16, v84
    v_add_f32 v18, v18, v86
    v_add_f32 v16, v16, v88
    v_add_f32 v18, v18, v90
    v_add_f32 v16, v16, v92
    v_add_f32 v18, v18, v94
    v_add_f32 v16, v16, v96
    v_add_f32 v18, v18, v98
    v_add_f32 v16, v16, v100
    v_add_f32 v18, v18, v102
    v_add_f32 v16, v16, v104
    v_add_f32 v18, v18, v106
    v_add_f32 v16, v16, v108
    v_add_f32 v18, v18, v110
    v_add_f32 v16, v16, v112
    v_add_f32 v18, v18, v114
    v_add_f32 v16, v16, v116
    v_add_f32 v18, v18, v118
    v_add_f32 v16, v16, v120
    v_add_f32 v18, v18, v122
    s_lshr_b32 s36, s11, 16
    s_cmp_ge_u32 s36, 0x8000
    s_cselect_b32 s37, 0x8000, -1
    s_xor_b32 s36, s36, s37
    s_lshl_b32 s36, s36, 16
    v_mov_b32 v4, s36
    v_mul_f32 v4, 0xbfb8aa3b, v4
    v_exp_f32 v4, v4
    s_nop 0
    v_add_f32 v4, 1.0, v4
    v_rcp_f32 v4, v4
    s_nop 0
    v_cvt_pk_bf16_f32 v4, v4, v4
    v_lshlrev_b32 v4, 16, v4
    v_cvt_pk_bf16_f32 v16, v16, v16
    v_lshlrev_b32 v16, 16, v16
    v_mul_f32 v16, v16, v4
    v_cvt_pk_bf16_f32 v16, v16, v16
    v_lshlrev_b32 v16, 16, v16
    s_lshr_b32 s36, s12, 16
    s_cmp_ge_u32 s36, 0x8000
    s_cselect_b32 s37, 0x8000, -1
    s_xor_b32 s36, s36, s37
    s_lshl_b32 s36, s36, 16
    v_mov_b32 v4, s36
    v_mul_f32 v4, 0xbfb8aa3b, v4
    v_exp_f32 v4, v4
    s_nop 0
    v_add_f32 v4, 1.0, v4
    v_rcp_f32 v4, v4
    s_nop 0
    v_cvt_pk_bf16_f32 v4, v4, v4
    v_lshlrev_b32 v4, 16, v4
    v_cvt_pk_bf16_f32 v18, v18, v18
    v_lshlrev_b32 v18, 16, v18
    v_mul_f32 v18, v18, v4
    v_cvt_pk_bf16_f32 v18, v18, v18
    v_lshlrev_b32 v18, 16, v18
    s_mul_i32 s36, s32, 96
    s_sub_u32 s36, s13, s36
    s_max_i32 s36, s36, 0
    s_lshl_b32 s36, s36, 2
    s_add_u32 s36, s36, 156288
    v_mov_b32 v4, s36
    ds_read2st64_b32 v[4:5], v4 offset0:0 offset1:2
    v_lshlrev_b32 v124, 16, v124
    s_waitcnt lgkmcnt(0)
    v_add_f32 v20, v124, v4
    v_cvt_pk_bf16_f32 v20, v20, v20
    v_lshlrev_b32 v20, 16, v20
    v_mul_f32 v20, v20, v5
    v_cvt_pk_bf16_f32 v20, v20, v20
    v_lshlrev_b32 v20, 16, v20
    v_add_f32 v20, v20, v16
    v_cvt_pk_bf16_f32 v20, v20, v20
    v_lshlrev_b32 v20, 16, v20
    v_mul_f32 v16, 0xbfb8aa3b, v20
    v_exp_f32 v16, v16
    s_nop 0
    v_add_f32 v16, 1.0, v16
    v_rcp_f32 v16, v16
    s_nop 0
    v_mul_f32 v16, v16, v20
    v_cvt_pk_bf16_f32 v16, v16, v16
    v_lshlrev_b32 v16, 16, v16
    s_mul_i32 s36, s32, 96
    s_sub_u32 s36, s14, s36
    s_max_i32 s36, s36, 0
    s_lshl_b32 s36, s36, 2
    s_add_u32 s36, s36, 156288
    v_mov_b32 v4, s36
    ds_read2st64_b32 v[4:5], v4 offset0:0 offset1:2
    v_lshlrev_b32 v125, 16, v125
    s_waitcnt lgkmcnt(0)
    v_add_f32 v22, v125, v4
    v_cvt_pk_bf16_f32 v22, v22, v22
    v_lshlrev_b32 v22, 16, v22
    v_mul_f32 v22, v22, v5
    v_cvt_pk_bf16_f32 v22, v22, v22
    v_lshlrev_b32 v22, 16, v22
    v_add_f32 v22, v22, v18
    v_cvt_pk_bf16_f32 v22, v22, v22
    v_lshlrev_b32 v22, 16, v22
    v_mul_f32 v18, 0xbfb8aa3b, v22
    v_exp_f32 v18, v18
    s_nop 0
    v_add_f32 v18, 1.0, v18
    v_rcp_f32 v18, v18
    s_nop 0
    v_mul_f32 v18, v18, v22
    v_cvt_pk_bf16_f32 v18, v18, v18
    v_lshlrev_b32 v18, 16, v18
    v_add_u32 v5, 158208, v12
    ds_write2st64_b32 v5, v16, v18 offset0:0 offset1:1
    v_mov_b32 v6, 157956
    v_mov_b32 v7, 1
    s_mov_b64 exec, 1
    ds_add_u32 v6, v7
    s_mov_b64 exec, -1
Lw0_done:
    s_endpgm
Lagent:
    s_sub_u32 s44, s4, 4096
    s_subb_u32 s45, s5, 0
    s_mov_b32 s46, 2625536
    s_mov_b32 s47, 0x20000
    s_lshl_b32 s36, s32, 7
    s_add_u32 s36, s36, 8257536
    v_mov_b32 v69, s36
    s_branch Lbc_re
Lcomp:
    s_lshl_b32 s44, s26, 1
    s_add_u32 s44, s44, s27
    s_sub_u32 s36, s33, 5
    s_cmp_ge_u32 s33, 5
    s_cselect_b32 s40, s36, s33
    s_mov_b32 s41, 0xbfe10856
    s_cmp_eq_u32 s40, 1
    s_cselect_b32 s41, 0xaff80255, s41
    s_cmp_eq_u32 s40, 2
    s_cselect_b32 s41, 0xabfe4015, s41
    s_cmp_eq_u32 s40, 3
    s_cselect_b32 s41, 0xaa7fd005, s41
    s_cmp_eq_u32 s40, 4
    s_cselect_b32 s41, 0x6adfb401, s41
    s_lshl_b32 s37, s27, 13
    s_cmp_eq_u32 s44, 1
    s_cselect_b32 s37, 0, s37
    v_bfe_u32 v7, v1, 2, 2
    v_and_b32 v8, 3, v1
    v_lshl_add_u32 v18, v2, 3, v7
    v_lshlrev_b32 v18, 7, v18
    v_lshlrev_b32 v19, 2, v1
    v_and_b32 v19, 0x60, v19
    v_lshlrev_b32 v10, 1, v8
    v_add_u32 v9, s37, v18
    v_add_u32 v11, 0, v10
    v_bfe_u32 v11, s41, v11, 2
    v_lshl_add_u32 v11, v11, 2, v8
    v_lshlrev_b32 v11, 3, v11
    v_xad_u32 v20, v11, v19, v9
    v_add_u32 v11, 8, v10
    v_bfe_u32 v11, s41, v11, 2
    v_lshl_add_u32 v11, v11, 2, v8
    v_lshlrev_b32 v11, 3, v11
    v_xad_u32 v21, v11, v19, v9
    v_add_u32 v11, 16, v10
    v_bfe_u32 v11, s41, v11, 2
    v_lshl_add_u32 v11, v11, 2, v8
    v_lshlrev_b32 v11, 3, v11
    v_xad_u32 v22, v11, v19, v9
    v_add_u32 v11, 24, v10
    v_bfe_u32 v11, s41, v11, 2
    v_lshl_add_u32 v11, v11, 2, v8
    v_lshlrev_b32 v11, 3, v11
    v_xad_u32 v23, v11, v19, v9
    v_add_u32 v24, 78080, v20
    v_add_u32 v25, 78080, v21
    v_add_u32 v26, 78080, v22
    v_add_u32 v27, 78080, v23
    v_lshrrev_b32 v10, 1, v3
    v_xor_b32 v9, v10, v2
    v_lshlrev_b32 v9, 4, v9
    v_lshl_add_u32 v9, v3, 7, v9
    s_lshl_b32 s36, s44, 11
    s_xor_b32 s38, s36, 2048
    s_add_u32 s36, s36, 22528
    s_add_u32 s38, s38, 22528
    v_add_u32 v76, s36, v9
    v_add_u32 v78, s38, v9
    s_mul_i32 s39, s26, 6144
    s_add_u32 s39, s39, 98560
    v_add_u32 v125, s39, v13
    s_lshl_b32 s45, s44, 11
    s_add_u32 s45, s45, 139648
    s_waitcnt lgkmcnt(0)
    s_mov_b64 s[28:29], s[24:25]
    s_mov_b32 s30, 268435456
    s_mov_b32 s31, 0x20000
    s_load_dword s34, s[28:29], 0
    s_cmp_eq_u32 s44, 1
    s_cbranch_scc1 Lhalo
    v_xor_b32 v77, 64, v76
    v_xor_b32 v79, 64, v78
    v_add_u32 v80, 78080, v76
    v_add_u32 v81, 78080, v77
    v_add_u32 v82, 78080, v78
    v_add_u32 v83, 78080, v79
    s_cmp_eq_u32 s27, 0
    s_cselect_b64 vcc, 0, -1
    s_sub_u32 s37, 16384, s37
    v_cndmask_b32 v84, v20, v22, vcc
    v_cndmask_b32 v85, v21, v23, vcc
    v_add_u32 v84, s37, v84
    v_add_u32 v85, s37, v85
    v_add_u32 v86, 78080, v84
    v_add_u32 v87, 78080, v85
    v_lshrrev_b32 v8, 1, v2
    v_xor_b32 v8, v8, v10
    v_lshlrev_b32 v8, 4, v8
    v_lshl_add_u32 v8, v3, 7, v8
    v_and_b32 v7, 1, v2
    v_lshl_add_u32 v124, v7, 3, v8
    s_mov_b32 s46, 0
    s_mov_b32 s38, 0x86542310
    s_mov_b32 s39, 0x97
    s_cmp_eq_u32 s42, 1
    s_cselect_b32 s38, 0x76453210, s38
    s_cselect_b32 s39, 0x98, s39
    s_cmp_eq_u32 s42, 2
    s_cselect_b32 s38, 0x67543120, s38
    s_cselect_b32 s39, 0x98, s39
    s_cmp_eq_u32 s42, 3
    s_cselect_b32 s38, 0x76534201, s38
    s_cselect_b32 s39, 0x89, s39
    s_cmp_eq_u32 s42, 4
    s_cselect_b32 s38, 0x75643201, s38
    s_cselect_b32 s39, 0x98, s39
    s_sub_u32 s42, s33, s43
    s_cselect_b32 s43, 10, 0
    s_add_u32 s42, s42, s43
    s_lshl_b32 s42, s42, 2
    s_lshr_b64 s[38:39], s[38:39], s42
    s_and_b32 s42, s38, 15
    s_and_b32 s38, s42, 3
    s_mul_i32 s38, s38, 39040
    s_add_u32 s38, s38, s36
    v_add_u32 v4, s38, v124
    v_xor_b32 v5, 32, v4
    v_xor_b32 v6, 64, v4
    v_xor_b32 v7, 0x60, v4
    s_mov_b64 s[48:49], s[20:21]
    s_mov_b32 s50, 2621440
    s_mov_b32 s51, 0x20000
    v_mov_b32 v14, 0x3f803f80
    v_mov_b32 v15, 0x3f803f80
    v_mov_b32 v16, 0x3f803f80
    v_mov_b32 v17, 0x3f803f80
    s_mov_b32 s4, 0xaae00455
    s_cmp_eq_u32 s40, 1
    s_cselect_b32 s4, 0xaaf80155, s4
    s_cmp_eq_u32 s40, 2
    s_cselect_b32 s4, 0xaafe4055, s4
    s_cmp_eq_u32 s40, 3
    s_cselect_b32 s4, 0xaabfd055, s4
    s_cmp_eq_u32 s40, 4
    s_cselect_b32 s4, 0xaaeff455, s4
    v_lshlrev_b32 v10, 1, v2
    v_add_u32 v10, 8, v10
    v_bfe_u32 v10, s4, v10, 2
    v_cmp_eq_u32 s[6:7], 0, v10
    v_cmp_eq_u32 s[8:9], 3, v10
    v_cmp_eq_u32 s[10:11], 1, v10
    v_lshlrev_b32 v10, 1, v2
    v_add_u32 v10, 16, v10
    v_bfe_u32 v10, s4, v10, 2
    v_cmp_eq_u32 s[12:13], 0, v10
    v_cmp_eq_u32 s[14:15], 3, v10
    v_cmp_eq_u32 s[16:17], 2, v10
    s_mov_b32 s4, 0xaaaaaaaa
    s_mov_b32 s5, 0xaaaaaaaa
    s_mov_b32 s18, 0xfff0ffff
    s_mov_b32 s19, 0xf000ff00
    s_mov_b32 s20, 0xffc0fffc
    s_mov_b32 s21, 0xc000fc00
    v_mov_b32 v8, 0xffff
    v_not_b32 v9, v8
    v_cndmask_b32 v8, v8, v9, s[4:5]
    v_cndmask_b32 v118, 0, v8, s[18:19]
    v_cndmask_b32 v119, 0, v8, s[20:21]
    v_xor_b32 v116, v118, v8
    v_xor_b32 v117, v119, v8
    s_cmp_eq_u32 s32, 0
    s_cselect_b32 s36, s44, 0
    s_cmp_eq_u32 s36, 2
    s_cselect_b32 s22, 0xff800000, 0
    s_mul_i32 s36, s32, 6
    s_add_u32 s36, s36, s44
    s_sub_u32 s36, s36, 2
    s_lshl_b32 s24, s36, 7
    s_add_u32 s24, s24, 7340032
    s_mul_i32 s52, s36, 20480
    s_add_u32 s52, s52, 4194304
    s_lshl_b32 s36, s33, 11
    s_add_u32 s23, s36, s52
    s_add_u32 s53, s52, s46
    s_add_u32 s46, s46, 4096
    s_cmp_eq_u32 s46, 20480
    s_cselect_b32 s46, 0, s46
    s_add_u32 s54, s52, s46
    s_add_u32 s46, s46, 4096
    s_cmp_eq_u32 s46, 20480
    s_cselect_b32 s46, 0, s46
    s_add_u32 s55, s52, s46
    s_add_u32 s46, s46, 4096
    s_cmp_eq_u32 s46, 20480
    s_cselect_b32 s46, 0, s46
    s_add_u32 s56, s52, s46
    s_add_u32 s46, s46, 4096
    s_cmp_eq_u32 s46, 20480
    s_cselect_b32 s46, 0, s46
    s_add_u32 s57, s52, s46
    s_add_u32 s46, s46, 4096
    s_cmp_eq_u32 s46, 20480
    s_cselect_b32 s46, 0, s46
    s_mul_i32 s36, s32, 10
    s_add_u32 s36, s36, s33
    s_mul_i32 s58, s36, 6144
    s_lshl_b32 s36, s44, 10
    s_add_u32 s58, s58, s36
    s_add_u32 s58, s58, 1046528
    s_sub_u32 s59, s58, 6144
    s_add_u32 s60, s58, 6144
    s_cmp_eq_u32 s40, 0
    s_cselect_b32 s61, 0, -1
    s_cmp_eq_u32 s40, 4
    s_cselect_b32 s62, 0, -1
    s_lshl_b32 s36, s33, 2
    v_mov_b32 v97, s36
    s_mov_b32 s25, 0x3ea52b5c
    s_lshl_b32 s36, s44, 6
    s_add_u32 s36, s36, 156160
    v_lshl_add_u32 v94, v3, 2, s36
    v_and_b32 v8, 1, v1
    v_lshl_add_u32 v8, v2, 2, v8
    v_lshl_add_u32 v8, v8, 2, s36
    v_subrev_u32 v9, 64, v8
    v_cndmask_b32 v92, v9, v8, s[18:19]
    v_cndmask_b32 v93, v9, v8, s[20:21]
    v_lshlrev_b32 v95, 4, v2
    s_lshl_b32 s36, s27, 8
    s_add_u32 s36, s36, 157184
    v_add_u32 v95, s36, v95
    v_mov_b32 v96, 157968
    s_lshl_b32 s36, s27, 11
    v_add_u32 v99, s36, v125
    v_mov_b32 v100, -1
    v_mov_b32 v101, -1
    v_mov_b32 v102, -1
    v_mov_b32 v103, -1
    v_mov_b32 v127, 157984
    s_lshl_b32 s36, s3, 2
    s_add_u32 s36, s36, 158016
    v_mov_b32 v10, s36
    v_xor_b32 v11, 16, v10
    v_cndmask_b32 v127, v127, v11, s[4:5]
    s_waitcnt vmcnt(0)
    s_waitcnt lgkmcnt(0)
    s_barrier
    ds_read_b128 a[64:67], v76 offset:0
    ds_read_b128 a[68:71], v78 offset:0
    ds_read_b64_tr_b16 a[80:81], v20 offset:0
    ds_read_b64_tr_b16 a[82:83], v20 offset:512
    ds_read_b64_tr_b16 a[84:85], v21 offset:0
    ds_read_b64_tr_b16 a[86:87], v21 offset:512
    ds_read_b64_tr_b16 a[88:89], v22 offset:0
    ds_read_b64_tr_b16 a[90:91], v22 offset:512
    ds_read_b64_tr_b16 a[92:93], v23 offset:0
    ds_read_b64_tr_b16 a[94:95], v23 offset:512
    ds_read_b64_tr_b16 a[96:97], v84 offset:0
    ds_read_b64_tr_b16 a[98:99], v84 offset:512
    ds_read_b64_tr_b16 a[100:101], v85 offset:0
    ds_read_b64_tr_b16 a[102:103], v85 offset:512
    s_add_u32 s34, s34, 0x9e3779b8
    s_or_b32 s34, s34, 1
    s_cmp_eq_u32 s42, 0
    s_cbranch_scc1 Lxe0
Lxe0_b:
    s_setprio 1
    s_waitcnt lgkmcnt(10)
    v_mfma_f32_16x16x32_bf16 v[28:31], a[80:83], a[64:67], 0
    ds_read_b128 a[72:75], v77 offset:0
    ds_read_b128 a[76:79], v79 offset:0
    v_mfma_f32_16x16x32_bf16 v[44:47], a[80:83], a[68:71], 0
    ds_read_b64_tr_b16 a[104:105], v20 offset:4096
    s_waitcnt lgkmcnt(11)
    v_mfma_f32_16x16x32_bf16 v[48:51], a[84:87], a[68:71], 0
    ds_read_b64_tr_b16 a[106:107], v20 offset:4608
    v_mfma_f32_16x16x32_bf16 v[32:35], a[84:87], a[64:67], 0
    ds_read_b64_tr_b16 a[108:109], v21 offset:4096
    s_waitcnt lgkmcnt(11)
    v_mfma_f32_16x16x32_bf16 v[36:39], a[88:91], a[64:67], 0
    ds_read_b64_tr_b16 a[110:111], v21 offset:4608
    ds_read_b64_tr_b16 a[112:113], v22 offset:4096
    v_mfma_f32_16x16x32_bf16 v[52:55], a[88:91], a[68:71], 0
    ds_read_b64_tr_b16 a[114:115], v22 offset:4608
    s_setprio 0
    s_waitcnt lgkmcnt(12)
    v_mfma_f32_16x16x32_bf16 v[56:59], a[92:95], a[68:71], 0
    ds_read_b64_tr_b16 a[116:117], v23 offset:4096
    v_mfma_f32_16x16x32_bf16 v[40:43], a[92:95], a[64:67], 0
    ds_read_b64_tr_b16 a[118:119], v23 offset:4608
    s_waitcnt lgkmcnt(12)
    v_mfma_f32_16x16x32_bf16 v[60:63], a[64:67], a[96:99], 0
    ds_read_b64_tr_b16 a[120:121], v84 offset:4096
    v_mfma_f32_16x16x32_bf16 v[68:71], a[68:71], a[96:99], 0
    ds_read_b64_tr_b16 a[122:123], v84 offset:4608
    s_waitcnt lgkmcnt(12)
    v_mfma_f32_16x16x32_bf16 v[72:75], a[68:71], a[100:103], 0
    ds_read_b64_tr_b16 a[124:125], v85 offset:4096
    v_mfma_f32_16x16x32_bf16 v[64:67], a[64:67], a[100:103], 0
    ds_read_b64_tr_b16 a[126:127], v85 offset:4608
    s_barrier
    s_setprio 3
    s_waitcnt lgkmcnt(10)
    v_mfma_f32_16x16x32_bf16 v[28:31], a[104:107], a[72:75], v[28:31]
    ds_read_b128 a[64:67], v76 offset:39040
    ds_read_b128 a[68:71], v78 offset:39040
    v_mfma_f32_16x16x32_bf16 v[44:47], a[104:107], a[76:79], v[44:47]
    ds_read_b64_tr_b16 a[80:81], v20 offset:39040
    s_waitcnt lgkmcnt(11)
    v_mfma_f32_16x16x32_bf16 v[48:51], a[108:111], a[76:79], v[48:51]
    ds_read_b64_tr_b16 a[82:83], v20 offset:39552
    v_mfma_f32_16x16x32_bf16 v[32:35], a[108:111], a[72:75], v[32:35]
    ds_read_b64_tr_b16 a[84:85], v21 offset:39040
    s_waitcnt lgkmcnt(11)
    v_mfma_f32_16x16x32_bf16 v[36:39], a[112:115], a[72:75], v[36:39]
    ds_read_b64_tr_b16 a[86:87], v21 offset:39552
    v_mfma_f32_16x16x32_bf16 v[52:55], a[112:115], a[76:79], v[52:55]
    ds_read_b64_tr_b16 a[88:89], v22 offset:39040
    s_setprio 2
    s_waitcnt lgkmcnt(11)
    v_mfma_f32_16x16x32_bf16 v[56:59], a[116:119], a[76:79], v[56:59]
    ds_read_b64_tr_b16 a[90:91], v22 offset:39552
    ds_read_b64_tr_b16 a[92:93], v23 offset:39040
    v_mfma_f32_16x16x32_bf16 v[40:43], a[116:119], a[72:75], v[40:43]
    ds_read_b64_tr_b16 a[94:95], v23 offset:39552
    s_waitcnt lgkmcnt(12)
    v_mfma_f32_16x16x32_bf16 v[60:63], a[72:75], a[120:123], v[60:63]
    ds_read_b64_tr_b16 a[96:97], v84 offset:39040
    v_mfma_f32_16x16x32_bf16 v[68:71], a[76:79], a[120:123], v[68:71]
    ds_read_b64_tr_b16 a[98:99], v84 offset:39552
    s_waitcnt lgkmcnt(12)
    v_mfma_f32_16x16x32_bf16 v[72:75], a[76:79], a[124:127], v[72:75]
    ds_read_b64_tr_b16 a[100:101], v85 offset:39040
    v_mfma_f32_16x16x32_bf16 v[64:67], a[72:75], a[124:127], v[64:67]
    ds_read_b64_tr_b16 a[102:103], v85 offset:39552
    s_cmp_eq_u32 s42, 1
    s_cbranch_scc1 Lxe1
Lxe1_b:
    s_setprio 1
    s_waitcnt lgkmcnt(10)
    v_mfma_f32_16x16x32_bf16 v[28:31], a[80:83], a[64:67], v[28:31]
    ds_read_b128 a[72:75], v77 offset:39040
    ds_read_b128 a[76:79], v79 offset:39040
    v_mfma_f32_16x16x32_bf16 v[44:47], a[80:83], a[68:71], v[44:47]
    ds_read_b64_tr_b16 a[104:105], v20 offset:43136
    s_waitcnt lgkmcnt(11)
    v_mfma_f32_16x16x32_bf16 v[48:51], a[84:87], a[68:71], v[48:51]
    ds_read_b64_tr_b16 a[106:107], v20 offset:43648
    v_mfma_f32_16x16x32_bf16 v[32:35], a[84:87], a[64:67], v[32:35]
    ds_read_b64_tr_b16 a[108:109], v21 offset:43136
    s_waitcnt lgkmcnt(11)
    v_mfma_f32_16x16x32_bf16 v[36:39], a[88:91], a[64:67], v[36:39]
    ds_read_b64_tr_b16 a[110:111], v21 offset:43648
    ds_read_b64_tr_b16 a[112:113], v22 offset:43136
    v_mfma_f32_16x16x32_bf16 v[52:55], a[88:91], a[68:71], v[52:55]
    ds_read_b64_tr_b16 a[114:115], v22 offset:43648
    s_setprio 0
    s_waitcnt lgkmcnt(12)
    v_mfma_f32_16x16x32_bf16 v[56:59], a[92:95], a[68:71], v[56:59]
    ds_read_b64_tr_b16 a[116:117], v23 offset:43136
    v_mfma_f32_16x16x32_bf16 v[40:43], a[92:95], a[64:67], v[40:43]
    ds_read_b64_tr_b16 a[118:119], v23 offset:43648
    s_waitcnt lgkmcnt(12)
    v_mfma_f32_16x16x32_bf16 v[60:63], a[64:67], a[96:99], v[60:63]
    ds_read_b64_tr_b16 a[120:121], v84 offset:43136
    v_mfma_f32_16x16x32_bf16 v[68:71], a[68:71], a[96:99], v[68:71]
    ds_read_b64_tr_b16 a[122:123], v84 offset:43648
    s_waitcnt lgkmcnt(12)
    v_mfma_f32_16x16x32_bf16 v[72:75], a[68:71], a[100:103], v[72:75]
    ds_read_b64_tr_b16 a[124:125], v85 offset:43136
    v_mfma_f32_16x16x32_bf16 v[64:67], a[64:67], a[100:103], v[64:67]
    ds_read_b64_tr_b16 a[126:127], v85 offset:43648
    s_barrier
    s_setprio 3
    s_waitcnt lgkmcnt(10)
    v_mfma_f32_16x16x32_bf16 v[28:31], a[104:107], a[72:75], v[28:31]
    ds_read_b128 a[64:67], v80 offset:0
    ds_read_b128 a[68:71], v82 offset:0
    v_mfma_f32_16x16x32_bf16 v[44:47], a[104:107], a[76:79], v[44:47]
    ds_read_b64_tr_b16 a[80:81], v24 offset:0
    s_waitcnt lgkmcnt(11)
    v_mfma_f32_16x16x32_bf16 v[48:51], a[108:111], a[76:79], v[48:51]
    ds_read_b64_tr_b16 a[82:83], v24 offset:512
    v_mfma_f32_16x16x32_bf16 v[32:35], a[108:111], a[72:75], v[32:35]
    ds_read_b64_tr_b16 a[84:85], v25 offset:0
    s_waitcnt lgkmcnt(11)
    v_mfma_f32_16x16x32_bf16 v[36:39], a[112:115], a[72:75], v[36:39]
    ds_read_b64_tr_b16 a[86:87], v25 offset:512
    v_mfma_f32_16x16x32_bf16 v[52:55], a[112:115], a[76:79], v[52:55]
    ds_read_b64_tr_b16 a[88:89], v26 offset:0
    s_setprio 2
    s_waitcnt lgkmcnt(11)
    v_mfma_f32_16x16x32_bf16 v[56:59], a[116:119], a[76:79], v[56:59]
    ds_read_b64_tr_b16 a[90:91], v26 offset:512
    ds_read_b64_tr_b16 a[92:93], v27 offset:0
    v_mfma_f32_16x16x32_bf16 v[40:43], a[116:119], a[72:75], v[40:43]
    ds_read_b64_tr_b16 a[94:95], v27 offset:512
    s_waitcnt lgkmcnt(12)
    v_mfma_f32_16x16x32_bf16 v[60:63], a[72:75], a[120:123], v[60:63]
    ds_read_b64_tr_b16 a[96:97], v86 offset:0
    v_mfma_f32_16x16x32_bf16 v[68:71], a[76:79], a[120:123], v[68:71]
    ds_read_b64_tr_b16 a[98:99], v86 offset:512
    s_waitcnt lgkmcnt(12)
    v_mfma_f32_16x16x32_bf16 v[72:75], a[76:79], a[124:127], v[72:75]
    ds_read_b64_tr_b16 a[100:101], v87 offset:0
    v_mfma_f32_16x16x32_bf16 v[64:67], a[72:75], a[124:127], v[64:67]
    ds_read_b64_tr_b16 a[102:103], v87 offset:512
    buffer_store_dwordx4 v[100:103], v13, s[28:31], s58 offen sc1
    s_cmp_eq_u32 s42, 2
    s_cbranch_scc1 Lxe2
Lxe2_b:
    s_setprio 1
    s_waitcnt lgkmcnt(10)
    v_mfma_f32_16x16x32_bf16 v[28:31], a[80:83], a[64:67], v[28:31]
    ds_read_b128 a[72:75], v81 offset:0
    ds_read_b128 a[76:79], v83 offset:0
    v_mfma_f32_16x16x32_bf16 v[44:47], a[80:83], a[68:71], v[44:47]
    ds_read_b64_tr_b16 a[104:105], v24 offset:4096
    s_waitcnt lgkmcnt(11)
    v_mfma_f32_16x16x32_bf16 v[48:51], a[84:87], a[68:71], v[48:51]
    ds_read_b64_tr_b16 a[106:107], v24 offset:4608
    v_mfma_f32_16x16x32_bf16 v[32:35], a[84:87], a[64:67], v[32:35]
    ds_read_b64_tr_b16 a[108:109], v25 offset:4096
    s_waitcnt lgkmcnt(11)
    v_mfma_f32_16x16x32_bf16 v[36:39], a[88:91], a[64:67], v[36:39]
    ds_read_b64_tr_b16 a[110:111], v25 offset:4608
    ds_read_b64_tr_b16 a[112:113], v26 offset:4096
    v_mfma_f32_16x16x32_bf16 v[52:55], a[88:91], a[68:71], v[52:55]
    ds_read_b64_tr_b16 a[114:115], v26 offset:4608
    s_setprio 0
    s_waitcnt lgkmcnt(12)
    v_mfma_f32_16x16x32_bf16 v[56:59], a[92:95], a[68:71], v[56:59]
    ds_read_b64_tr_b16 a[116:117], v27 offset:4096
    v_mfma_f32_16x16x32_bf16 v[40:43], a[92:95], a[64:67], v[40:43]
    ds_read_b64_tr_b16 a[118:119], v27 offset:4608
    s_waitcnt lgkmcnt(12)
    v_mfma_f32_16x16x32_bf16 v[60:63], a[64:67], a[96:99], v[60:63]
    ds_read_b64_tr_b16 a[120:121], v86 offset:4096
    v_mfma_f32_16x16x32_bf16 v[68:71], a[68:71], a[96:99], v[68:71]
    ds_read_b64_tr_b16 a[122:123], v86 offset:4608
    s_waitcnt lgkmcnt(12)
    v_mfma_f32_16x16x32_bf16 v[72:75], a[68:71], a[100:103], v[72:75]
    ds_read_b64_tr_b16 a[124:125], v87 offset:4096
    v_mfma_f32_16x16x32_bf16 v[64:67], a[64:67], a[100:103], v[64:67]
    ds_read_b64_tr_b16 a[126:127], v87 offset:4608
    s_barrier
    s_setprio 3
    s_waitcnt lgkmcnt(10)
    v_mfma_f32_16x16x32_bf16 v[28:31], a[104:107], a[72:75], v[28:31]
    ds_read_b128 a[64:67], v80 offset:39040
    ds_read_b128 a[68:71], v82 offset:39040
    v_mfma_f32_16x16x32_bf16 v[44:47], a[104:107], a[76:79], v[44:47]
    ds_read_b64_tr_b16 a[80:81], v24 offset:39040
    s_waitcnt lgkmcnt(11)
    v_mfma_f32_16x16x32_bf16 v[48:51], a[108:111], a[76:79], v[48:51]
    ds_read_b64_tr_b16 a[82:83], v24 offset:39552
    v_mfma_f32_16x16x32_bf16 v[32:35], a[108:111], a[72:75], v[32:35]
    ds_read_b64_tr_b16 a[84:85], v25 offset:39040
    s_waitcnt lgkmcnt(11)
    v_mfma_f32_16x16x32_bf16 v[36:39], a[112:115], a[72:75], v[36:39]
    ds_read_b64_tr_b16 a[86:87], v25 offset:39552
    v_mfma_f32_16x16x32_bf16 v[52:55], a[112:115], a[76:79], v[52:55]
    ds_read_b64_tr_b16 a[88:89], v26 offset:39040
    s_setprio 2
    s_waitcnt lgkmcnt(11)
    v_mfma_f32_16x16x32_bf16 v[56:59], a[116:119], a[76:79], v[56:59]
    ds_read_b64_tr_b16 a[90:91], v26 offset:39552
    ds_read_b64_tr_b16 a[92:93], v27 offset:39040
    v_mfma_f32_16x16x32_bf16 v[40:43], a[116:119], a[72:75], v[40:43]
    ds_read_b64_tr_b16 a[94:95], v27 offset:39552
    s_waitcnt lgkmcnt(12)
    v_mfma_f32_16x16x32_bf16 v[60:63], a[72:75], a[120:123], v[60:63]
    ds_read_b64_tr_b16 a[96:97], v86 offset:39040
    v_mfma_f32_16x16x32_bf16 v[68:71], a[76:79], a[120:123], v[68:71]
    ds_read_b64_tr_b16 a[98:99], v86 offset:39552
    s_waitcnt lgkmcnt(12)
    v_mfma_f32_16x16x32_bf16 v[72:75], a[76:79], a[124:127], v[72:75]
    ds_read_b64_tr_b16 a[100:101], v87 offset:39040
    v_mfma_f32_16x16x32_bf16 v[64:67], a[72:75], a[124:127], v[64:67]
    ds_read_b64_tr_b16 a[102:103], v87 offset:39552
    s_cmp_eq_u32 s42, 3
    s_cbranch_scc1 Lxe3
Lxe3_b:
    s_setprio 1
    s_waitcnt lgkmcnt(10)
    v_mfma_f32_16x16x32_bf16 v[28:31], a[80:83], a[64:67], v[28:31]
    ds_read_b128 a[72:75], v81 offset:39040
    ds_read_b128 a[76:79], v83 offset:39040
    v_mfma_f32_16x16x32_bf16 v[44:47], a[80:83], a[68:71], v[44:47]
    ds_read_b64_tr_b16 a[104:105], v24 offset:43136
    s_waitcnt lgkmcnt(11)
    v_mfma_f32_16x16x32_bf16 v[48:51], a[84:87], a[68:71], v[48:51]
    ds_read_b64_tr_b16 a[106:107], v24 offset:43648
    v_mfma_f32_16x16x32_bf16 v[32:35], a[84:87], a[64:67], v[32:35]
    ds_read_b64_tr_b16 a[108:109], v25 offset:43136
    s_waitcnt lgkmcnt(11)
    v_mfma_f32_16x16x32_bf16 v[36:39], a[88:91], a[64:67], v[36:39]
    ds_read_b64_tr_b16 a[110:111], v25 offset:43648
    ds_read_b64_tr_b16 a[112:113], v26 offset:43136
    v_mfma_f32_16x16x32_bf16 v[52:55], a[88:91], a[68:71], v[52:55]
    ds_read_b64_tr_b16 a[114:115], v26 offset:43648
    s_setprio 0
    s_waitcnt lgkmcnt(12)
    v_mfma_f32_16x16x32_bf16 v[56:59], a[92:95], a[68:71], v[56:59]
    ds_read_b64_tr_b16 a[116:117], v27 offset:43136
    v_mfma_f32_16x16x32_bf16 v[40:43], a[92:95], a[64:67], v[40:43]
    ds_read_b64_tr_b16 a[118:119], v27 offset:43648
    s_waitcnt lgkmcnt(12)
    v_mfma_f32_16x16x32_bf16 v[60:63], a[64:67], a[96:99], v[60:63]
    ds_read_b64_tr_b16 a[120:121], v86 offset:43136
    v_mfma_f32_16x16x32_bf16 v[68:71], a[68:71], a[96:99], v[68:71]
    ds_read_b64_tr_b16 a[122:123], v86 offset:43648
    s_waitcnt lgkmcnt(12)
    v_mfma_f32_16x16x32_bf16 v[72:75], a[68:71], a[100:103], v[72:75]
    ds_read_b64_tr_b16 a[124:125], v87 offset:43136
    v_mfma_f32_16x16x32_bf16 v[64:67], a[64:67], a[100:103], v[64:67]
    ds_read_b64_tr_b16 a[126:127], v87 offset:43648
    s_barrier
    s_setprio 3
    s_waitcnt lgkmcnt(10)
    v_mfma_f32_16x16x32_bf16 v[28:31], a[104:107], a[72:75], v[28:31]
    ds_read_b128 a[64:67], v76 offset:0
    ds_read_b128 a[68:71], v78 offset:0
    v_mfma_f32_16x16x32_bf16 v[44:47], a[104:107], a[76:79], v[44:47]
    ds_read_b64_tr_b16 a[80:81], v20 offset:0
    s_waitcnt lgkmcnt(11)
    v_mfma_f32_16x16x32_bf16 v[48:51], a[108:111], a[76:79], v[48:51]
    ds_read_b64_tr_b16 a[82:83], v20 offset:512
    v_mfma_f32_16x16x32_bf16 v[32:35], a[108:111], a[72:75], v[32:35]
    ds_read_b64_tr_b16 a[84:85], v21 offset:0
    s_waitcnt lgkmcnt(11)
    v_mfma_f32_16x16x32_bf16 v[36:39], a[112:115], a[72:75], v[36:39]
    ds_read_b64_tr_b16 a[86:87], v21 offset:512
    v_mfma_f32_16x16x32_bf16 v[52:55], a[112:115], a[76:79], v[52:55]
    ds_read_b64_tr_b16 a[88:89], v22 offset:0
    s_setprio 2
    s_waitcnt lgkmcnt(11)
    v_mfma_f32_16x16x32_bf16 v[56:59], a[116:119], a[76:79], v[56:59]
    ds_read_b64_tr_b16 a[90:91], v22 offset:512
    ds_read_b64_tr_b16 a[92:93], v23 offset:0
    v_mfma_f32_16x16x32_bf16 v[40:43], a[116:119], a[72:75], v[40:43]
    ds_read_b64_tr_b16 a[94:95], v23 offset:512
    s_waitcnt lgkmcnt(12)
    v_mfma_f32_16x16x32_bf16 v[60:63], a[72:75], a[120:123], v[60:63]
    ds_read_b64_tr_b16 a[96:97], v84 offset:0
    v_mfma_f32_16x16x32_bf16 v[68:71], a[76:79], a[120:123], v[68:71]
    ds_read_b64_tr_b16 a[98:99], v84 offset:512
    s_waitcnt lgkmcnt(12)
    v_mfma_f32_16x16x32_bf16 v[72:75], a[76:79], a[124:127], v[72:75]
    ds_read_b64_tr_b16 a[100:101], v85 offset:0
    v_mfma_f32_16x16x32_bf16 v[64:67], a[72:75], a[124:127], v[64:67]
    ds_read_b64_tr_b16 a[102:103], v85 offset:512
    buffer_store_dwordx4 v[100:103], v13, s[28:31], s23 offen offset:0 sc1
    s_cmp_eq_u32 s42, 4
    s_cbranch_scc1 Lxe4
Lxe4_b:
    s_setprio 1
    s_waitcnt lgkmcnt(10)
    v_mfma_f32_16x16x32_bf16 v[28:31], a[80:83], a[64:67], v[28:31]
    ds_read_b128 a[72:75], v77 offset:0
    ds_read_b128 a[76:79], v79 offset:0
    v_mfma_f32_16x16x32_bf16 v[44:47], a[80:83], a[68:71], v[44:47]
    ds_read_b64_tr_b16 a[104:105], v20 offset:4096
    s_waitcnt lgkmcnt(11)
    v_mfma_f32_16x16x32_bf16 v[48:51], a[84:87], a[68:71], v[48:51]
    ds_read_b64_tr_b16 a[106:107], v20 offset:4608
    v_mfma_f32_16x16x32_bf16 v[32:35], a[84:87], a[64:67], v[32:35]
    ds_read_b64_tr_b16 a[108:109], v21 offset:4096
    s_waitcnt lgkmcnt(11)
    v_mfma_f32_16x16x32_bf16 v[36:39], a[88:91], a[64:67], v[36:39]
    ds_read_b64_tr_b16 a[110:111], v21 offset:4608
    ds_read_b64_tr_b16 a[112:113], v22 offset:4096
    v_mfma_f32_16x16x32_bf16 v[52:55], a[88:91], a[68:71], v[52:55]
    ds_read_b64_tr_b16 a[114:115], v22 offset:4608
    s_setprio 0
    s_waitcnt lgkmcnt(12)
    v_mfma_f32_16x16x32_bf16 v[56:59], a[92:95], a[68:71], v[56:59]
    ds_read_b64_tr_b16 a[116:117], v23 offset:4096
    v_mfma_f32_16x16x32_bf16 v[40:43], a[92:95], a[64:67], v[40:43]
    ds_read_b64_tr_b16 a[118:119], v23 offset:4608
    s_waitcnt lgkmcnt(12)
    v_mfma_f32_16x16x32_bf16 v[60:63], a[64:67], a[96:99], v[60:63]
    ds_read_b64_tr_b16 a[120:121], v84 offset:4096
    v_mfma_f32_16x16x32_bf16 v[68:71], a[68:71], a[96:99], v[68:71]
    ds_read_b64_tr_b16 a[122:123], v84 offset:4608
    s_waitcnt lgkmcnt(12)
    v_mfma_f32_16x16x32_bf16 v[72:75], a[68:71], a[100:103], v[72:75]
    ds_read_b64_tr_b16 a[124:125], v85 offset:4096
    v_mfma_f32_16x16x32_bf16 v[64:67], a[64:67], a[100:103], v[64:67]
    ds_read_b64_tr_b16 a[126:127], v85 offset:4608
    s_barrier
    s_setprio 3
    s_waitcnt lgkmcnt(10)
    v_mfma_f32_16x16x32_bf16 v[28:31], a[104:107], a[72:75], v[28:31]
    ds_read_b128 a[64:67], v76 offset:39040
    ds_read_b128 a[68:71], v78 offset:39040
    v_mfma_f32_16x16x32_bf16 v[44:47], a[104:107], a[76:79], v[44:47]
    ds_read_b64_tr_b16 a[80:81], v20 offset:39040
    s_waitcnt lgkmcnt(11)
    v_mfma_f32_16x16x32_bf16 v[48:51], a[108:111], a[76:79], v[48:51]
    ds_read_b64_tr_b16 a[82:83], v20 offset:39552
    v_mfma_f32_16x16x32_bf16 v[32:35], a[108:111], a[72:75], v[32:35]
    ds_read_b64_tr_b16 a[84:85], v21 offset:39040
    s_waitcnt lgkmcnt(11)
    v_mfma_f32_16x16x32_bf16 v[36:39], a[112:115], a[72:75], v[36:39]
    ds_read_b64_tr_b16 a[86:87], v21 offset:39552
    v_mfma_f32_16x16x32_bf16 v[52:55], a[112:115], a[76:79], v[52:55]
    ds_read_b64_tr_b16 a[88:89], v22 offset:39040
    s_setprio 2
    s_waitcnt lgkmcnt(11)
    v_mfma_f32_16x16x32_bf16 v[56:59], a[116:119], a[76:79], v[56:59]
    ds_read_b64_tr_b16 a[90:91], v22 offset:39552
    ds_read_b64_tr_b16 a[92:93], v23 offset:39040
    v_mfma_f32_16x16x32_bf16 v[40:43], a[116:119], a[72:75], v[40:43]
    ds_read_b64_tr_b16 a[94:95], v23 offset:39552
    s_waitcnt lgkmcnt(12)
    v_mfma_f32_16x16x32_bf16 v[60:63], a[72:75], a[120:123], v[60:63]
    ds_read_b64_tr_b16 a[96:97], v84 offset:39040
    v_mfma_f32_16x16x32_bf16 v[68:71], a[76:79], a[120:123], v[68:71]
    ds_read_b64_tr_b16 a[98:99], v84 offset:39552
    s_waitcnt lgkmcnt(12)
    v_mfma_f32_16x16x32_bf16 v[72:75], a[76:79], a[124:127], v[72:75]
    ds_read_b64_tr_b16 a[100:101], v85 offset:39040
    v_mfma_f32_16x16x32_bf16 v[64:67], a[72:75], a[124:127], v[64:67]
    ds_read_b64_tr_b16 a[102:103], v85 offset:39552
    s_cmp_eq_u32 s42, 5
    s_cbranch_scc1 Lxe5
Lxe5_b:
    s_setprio 1
    s_waitcnt lgkmcnt(10)
    v_mfma_f32_16x16x32_bf16 v[28:31], a[80:83], a[64:67], v[28:31]
    ds_read_b128 a[72:75], v77 offset:39040
    ds_read_b128 a[76:79], v79 offset:39040
    v_mfma_f32_16x16x32_bf16 v[44:47], a[80:83], a[68:71], v[44:47]
    ds_read_b64_tr_b16 a[104:105], v20 offset:43136
    s_waitcnt lgkmcnt(11)
    v_mfma_f32_16x16x32_bf16 v[48:51], a[84:87], a[68:71], v[48:51]
    ds_read_b64_tr_b16 a[106:107], v20 offset:43648
    v_mfma_f32_16x16x32_bf16 v[32:35], a[84:87], a[64:67], v[32:35]
    ds_read_b64_tr_b16 a[108:109], v21 offset:43136
    s_waitcnt lgkmcnt(11)
    v_mfma_f32_16x16x32_bf16 v[36:39], a[88:91], a[64:67], v[36:39]
    ds_read_b64_tr_b16 a[110:111], v21 offset:43648
    ds_read_b64_tr_b16 a[112:113], v22 offset:43136
    v_mfma_f32_16x16x32_bf16 v[52:55], a[88:91], a[68:71], v[52:55]
    ds_read_b64_tr_b16 a[114:115], v22 offset:43648
    s_setprio 0
    s_waitcnt lgkmcnt(12)
    v_mfma_f32_16x16x32_bf16 v[56:59], a[92:95], a[68:71], v[56:59]
    ds_read_b64_tr_b16 a[116:117], v23 offset:43136
    v_mfma_f32_16x16x32_bf16 v[40:43], a[92:95], a[64:67], v[40:43]
    ds_read_b64_tr_b16 a[118:119], v23 offset:43648
    s_waitcnt lgkmcnt(12)
    v_mfma_f32_16x16x32_bf16 v[60:63], a[64:67], a[96:99], v[60:63]
    ds_read_b64_tr_b16 a[120:121], v84 offset:43136
    v_mfma_f32_16x16x32_bf16 v[68:71], a[68:71], a[96:99], v[68:71]
    ds_read_b64_tr_b16 a[122:123], v84 offset:43648
    s_waitcnt lgkmcnt(12)
    v_mfma_f32_16x16x32_bf16 v[72:75], a[68:71], a[100:103], v[72:75]
    ds_read_b64_tr_b16 a[124:125], v85 offset:43136
    v_mfma_f32_16x16x32_bf16 v[64:67], a[64:67], a[100:103], v[64:67]
    ds_read_b64_tr_b16 a[126:127], v85 offset:43648
    s_barrier
    s_setprio 3
    s_waitcnt lgkmcnt(10)
    v_mfma_f32_16x16x32_bf16 v[28:31], a[104:107], a[72:75], v[28:31]
    ds_read_b128 a[0:3], v80 offset:0
    v_mfma_f32_16x16x32_bf16 v[44:47], a[104:107], a[76:79], v[44:47]
    ds_read_b128 a[4:7], v82 offset:0
    s_waitcnt lgkmcnt(10)
    v_mfma_f32_16x16x32_bf16 v[48:51], a[108:111], a[76:79], v[48:51]
    ds_read_b64_tr_b16 a[80:81], v24 offset:0
    v_mfma_f32_16x16x32_bf16 v[32:35], a[108:111], a[72:75], v[32:35]
    ds_read_b64_tr_b16 a[82:83], v24 offset:512
    s_waitcnt lgkmcnt(10)
    v_mfma_f32_16x16x32_bf16 v[36:39], a[112:115], a[72:75], v[36:39]
    ds_read_b64_tr_b16 a[84:85], v25 offset:0
    v_mfma_f32_16x16x32_bf16 v[52:55], a[112:115], a[76:79], v[52:55]
    s_setprio 2
    s_waitcnt lgkmcnt(9)
    v_mfma_f32_16x16x32_bf16 v[56:59], a[116:119], a[76:79], v[56:59]
    ds_read_b64_tr_b16 a[86:87], v25 offset:512
    v_mfma_f32_16x16x32_bf16 v[40:43], a[116:119], a[72:75], v[40:43]
    ds_read_b64_tr_b16 a[88:89], v26 offset:0
    s_waitcnt lgkmcnt(9)
    v_mfma_f32_16x16x32_bf16 v[60:63], a[72:75], a[120:123], v[60:63]
    ds_read_b64_tr_b16 a[90:91], v26 offset:512
    v_mfma_f32_16x16x32_bf16 v[68:71], a[76:79], a[120:123], v[68:71]
    ds_read_b64_tr_b16 a[92:93], v27 offset:0
    s_waitcnt lgkmcnt(9)
    v_mfma_f32_16x16x32_bf16 v[72:75], a[76:79], a[124:127], v[72:75]
    ds_read_b64_tr_b16 a[94:95], v27 offset:512
    v_mfma_f32_16x16x32_bf16 v[64:67], a[72:75], a[124:127], v[64:67]
    buffer_store_dwordx4 v[100:103], v13, s[28:31], s23 offen offset:1024 sc1
    s_cmp_eq_u32 s42, 6
    s_cbranch_scc1 Lxe6
Lxe6_b:
    s_setprio 1
    s_waitcnt lgkmcnt(6)
    v_mfma_f32_16x16x32_bf16 v[28:31], a[80:83], a[0:3], v[28:31]
    ds_read_b128 a[8:11], v81 offset:0
    ds_read_b128 a[12:15], v83 offset:0
    v_mfma_f32_16x16x32_bf16 v[44:47], a[80:83], a[4:7], v[44:47]
    ds_read_b64_tr_b16 a[104:105], v24 offset:4096
    s_waitcnt lgkmcnt(7)
    v_mfma_f32_16x16x32_bf16 v[48:51], a[84:87], a[4:7], v[48:51]
    ds_read_b64_tr_b16 a[106:107], v24 offset:4608
    ds_read_b64_tr_b16 a[108:109], v25 offset:4096
    v_mfma_f32_16x16x32_bf16 v[32:35], a[84:87], a[0:3], v[32:35]
    ds_read_b64_tr_b16 a[110:111], v25 offset:4608
    s_setprio 0
    s_waitcnt lgkmcnt(8)
    v_mfma_f32_16x16x32_bf16 v[36:39], a[88:91], a[0:3], v[36:39]
    v_mfma_f32_16x16x32_bf16 v[52:55], a[88:91], a[4:7], v[52:55]
    ds_read_b64_tr_b16 a[112:113], v26 offset:4096
    ds_read_b64_tr_b16 a[114:115], v26 offset:4608
    s_waitcnt lgkmcnt(8)
    v_mfma_f32_16x16x32_bf16 v[56:59], a[92:95], a[4:7], v[56:59]
    ds_read_b64_tr_b16 a[116:117], v27 offset:4096
    v_mfma_f32_16x16x32_bf16 v[40:43], a[92:95], a[0:3], v[40:43]
    ds_read_b64_tr_b16 a[118:119], v27 offset:4608
    s_barrier
    s_setprio 3
    s_waitcnt lgkmcnt(6)
    v_mfma_f32_16x16x32_bf16 v[28:31], a[104:107], a[8:11], v[28:31]
    ds_read_b128 a[16:19], v80 offset:39040
    ds_read_b128 a[20:23], v82 offset:39040
    v_mfma_f32_16x16x32_bf16 v[44:47], a[104:107], a[12:15], v[44:47]
    ds_read_b64_tr_b16 a[80:81], v24 offset:39040
    s_waitcnt lgkmcnt(7)
    v_mfma_f32_16x16x32_bf16 v[48:51], a[108:111], a[12:15], v[48:51]
    ds_read_b64_tr_b16 a[82:83], v24 offset:39552
    v_mfma_f32_16x16x32_bf16 v[32:35], a[108:111], a[8:11], v[32:35]
    ds_read_b64_tr_b16 a[84:85], v25 offset:39040
    s_setprio 2
    s_waitcnt lgkmcnt(7)
    v_mfma_f32_16x16x32_bf16 v[36:39], a[112:115], a[8:11], v[36:39]
    ds_read_b64_tr_b16 a[86:87], v25 offset:39552
    ds_read_b64_tr_b16 a[88:89], v26 offset:39040
    v_mfma_f32_16x16x32_bf16 v[52:55], a[112:115], a[12:15], v[52:55]
    ds_read_b64_tr_b16 a[90:91], v26 offset:39552
    s_waitcnt lgkmcnt(8)
    v_mfma_f32_16x16x32_bf16 v[56:59], a[116:119], a[12:15], v[56:59]
    ds_read_b64_tr_b16 a[92:93], v27 offset:39040
    v_mfma_f32_16x16x32_bf16 v[40:43], a[116:119], a[8:11], v[40:43]
    ds_read_b64_tr_b16 a[94:95], v27 offset:39552
    s_cmp_eq_u32 s42, 7
    s_cbranch_scc1 Lxe7
Lxe7_b:
    s_setprio 1
    s_waitcnt lgkmcnt(6)
    v_mfma_f32_16x16x32_bf16 v[28:31], a[80:83], a[16:19], v[28:31]
    ds_read_b128 a[24:27], v81 offset:39040
    ds_read_b128 a[28:31], v83 offset:39040
    v_mfma_f32_16x16x32_bf16 v[44:47], a[80:83], a[20:23], v[44:47]
    ds_read_b64_tr_b16 a[104:105], v24 offset:43136
    s_waitcnt lgkmcnt(7)
    v_mfma_f32_16x16x32_bf16 v[48:51], a[84:87], a[20:23], v[48:51]
    ds_read_b64_tr_b16 a[106:107], v24 offset:43648
    ds_read_b64_tr_b16 a[108:109], v25 offset:43136
    v_mfma_f32_16x16x32_bf16 v[32:35], a[84:87], a[16:19], v[32:35]
    ds_read_b64_tr_b16 a[110:111], v25 offset:43648
    s_setprio 0
    s_waitcnt lgkmcnt(8)
    v_mfma_f32_16x16x32_bf16 v[36:39], a[88:91], a[16:19], v[36:39]
    v_mfma_f32_16x16x32_bf16 v[52:55], a[88:91], a[20:23], v[52:55]
    ds_read_b64_tr_b16 a[112:113], v26 offset:43136
    ds_read_b64_tr_b16 a[114:115], v26 offset:43648
    s_waitcnt lgkmcnt(8)
    v_mfma_f32_16x16x32_bf16 v[56:59], a[92:95], a[20:23], v[56:59]
    ds_read_b64_tr_b16 a[116:117], v27 offset:43136
    v_mfma_f32_16x16x32_bf16 v[40:43], a[92:95], a[16:19], v[40:43]
    ds_read_b64_tr_b16 a[118:119], v27 offset:43648
    s_barrier
    s_setprio 3
    s_waitcnt lgkmcnt(6)
    v_mfma_f32_16x16x32_bf16 v[28:31], a[104:107], a[24:27], v[28:31]
    ds_read_b128 a[32:35], v76 offset:0
    ds_read_b128 a[36:39], v78 offset:0
    v_mfma_f32_16x16x32_bf16 v[44:47], a[104:107], a[28:31], v[44:47]
    ds_read_b64_tr_b16 a[80:81], v20 offset:0
    s_waitcnt lgkmcnt(7)
    v_mfma_f32_16x16x32_bf16 v[48:51], a[108:111], a[28:31], v[48:51]
    ds_read_b64_tr_b16 a[82:83], v20 offset:512
    v_mfma_f32_16x16x32_bf16 v[32:35], a[108:111], a[24:27], v[32:35]
    ds_read_b64_tr_b16 a[84:85], v21 offset:0
    s_setprio 2
    s_waitcnt lgkmcnt(7)
    v_mfma_f32_16x16x32_bf16 v[36:39], a[112:115], a[24:27], v[36:39]
    ds_read_b64_tr_b16 a[86:87], v21 offset:512
    ds_read_b64_tr_b16 a[88:89], v22 offset:0
    v_mfma_f32_16x16x32_bf16 v[52:55], a[112:115], a[28:31], v[52:55]
    ds_read_b64_tr_b16 a[90:91], v22 offset:512
    s_waitcnt lgkmcnt(8)
    v_mfma_f32_16x16x32_bf16 v[56:59], a[116:119], a[28:31], v[56:59]
    ds_read_b64_tr_b16 a[92:93], v23 offset:0
    v_mfma_f32_16x16x32_bf16 v[40:43], a[116:119], a[24:27], v[40:43]
    ds_read_b64_tr_b16 a[94:95], v23 offset:512
    s_cmp_eq_u32 s42, 8
    s_cbranch_scc1 Lxe8
Lxe8_b:
    s_setprio 1
    s_waitcnt lgkmcnt(6)
    v_mfma_f32_16x16x32_bf16 v[28:31], a[80:83], a[32:35], v[28:31]
    ds_read_b128 a[40:43], v77 offset:0
    ds_read_b128 a[44:47], v79 offset:0
    v_mfma_f32_16x16x32_bf16 v[44:47], a[80:83], a[36:39], v[44:47]
    ds_read_b64_tr_b16 a[104:105], v20 offset:4096
    s_waitcnt lgkmcnt(7)
    v_mfma_f32_16x16x32_bf16 v[48:51], a[84:87], a[36:39], v[48:51]
    ds_read_b64_tr_b16 a[106:107], v20 offset:4608
    v_mfma_f32_16x16x32_bf16 v[32:35], a[84:87], a[32:35], v[32:35]
    ds_read_b64_tr_b16 a[108:109], v21 offset:4096
    s_setprio 0
    s_waitcnt lgkmcnt(7)
    v_mfma_f32_16x16x32_bf16 v[36:39], a[88:91], a[32:35], v[36:39]
    ds_read_b64_tr_b16 a[110:111], v21 offset:4608
    ds_read_b64_tr_b16 a[112:113], v22 offset:4096
    v_mfma_f32_16x16x32_bf16 v[52:55], a[88:91], a[36:39], v[52:55]
    ds_read_b64_tr_b16 a[114:115], v22 offset:4608
    s_waitcnt lgkmcnt(8)
    v_mfma_f32_16x16x32_bf16 v[56:59], a[92:95], a[36:39], v[56:59]
    ds_read_b64_tr_b16 a[116:117], v23 offset:4096
    v_mfma_f32_16x16x32_bf16 v[40:43], a[92:95], a[32:35], v[40:43]
    ds_read_b64_tr_b16 a[118:119], v23 offset:4608
    s_waitcnt lgkmcnt(0)
    s_barrier
    s_setprio 3
    v_mfma_f32_16x16x32_bf16 v[28:31], a[104:107], a[40:43], v[28:31]
    ds_read_b128 a[48:51], v76 offset:39040
    ds_read_b128 a[52:55], v78 offset:39040
    v_mfma_f32_16x16x32_bf16 v[44:47], a[104:107], a[44:47], v[44:47]
    ds_read_b64_tr_b16 a[80:81], v20 offset:39040
    v_mfma_f32_16x16x32_bf16 v[48:51], a[108:111], a[44:47], v[48:51]
    ds_read_b64_tr_b16 a[82:83], v20 offset:39552
    v_mfma_f32_16x16x32_bf16 v[32:35], a[108:111], a[40:43], v[32:35]
    ds_read_b64_tr_b16 a[84:85], v21 offset:39040
    s_setprio 2
    v_mfma_f32_16x16x32_bf16 v[36:39], a[112:115], a[40:43], v[36:39]
    ds_read_b64_tr_b16 a[86:87], v21 offset:39552
    ds_read_b64_tr_b16 a[88:89], v22 offset:39040
    v_mfma_f32_16x16x32_bf16 v[52:55], a[112:115], a[44:47], v[52:55]
    ds_read_b64_tr_b16 a[90:91], v22 offset:39552
    v_mfma_f32_16x16x32_bf16 v[56:59], a[116:119], a[44:47], v[56:59]
    ds_read_b64_tr_b16 a[92:93], v23 offset:39040
    v_mfma_f32_16x16x32_bf16 v[40:43], a[116:119], a[40:43], v[40:43]
    ds_read_b64_tr_b16 a[94:95], v23 offset:39552
    v_mov_b32 v98, s34
    s_waitcnt vmcnt(0)
    s_mov_b64 exec, 1
    buffer_store_dword v98, v97, s[28:31], s24 offen sc1
    s_mov_b64 exec, -1
    s_cmp_eq_u32 s42, 9
    s_cbranch_scc1 Lxe9
Lxe9_b:
    s_setprio 1
    s_waitcnt lgkmcnt(6)
    v_mfma_f32_16x16x32_bf16 v[28:31], a[80:83], a[48:51], v[28:31]
    ds_read_b128 a[56:59], v77 offset:39040
    ds_read_b128 a[60:63], v79 offset:39040
    ds_read_b64_tr_b16 a[104:105], v20 offset:43136
    v_mfma_f32_16x16x32_bf16 v[44:47], a[80:83], a[52:55], v[44:47]
    ds_read_b64_tr_b16 a[106:107], v20 offset:43648
    ds_read_b64_tr_b16 a[108:109], v21 offset:43136
    s_waitcnt lgkmcnt(9)
    v_mfma_f32_16x16x32_bf16 v[48:51], a[84:87], a[52:55], v[48:51]
    ds_read_b64_tr_b16 a[110:111], v21 offset:43648
    ds_read_b64_tr_b16 a[112:113], v22 offset:43136
    ds_read_b64_tr_b16 a[114:115], v22 offset:43648
    v_mfma_f32_16x16x32_bf16 v[32:35], a[84:87], a[48:51], v[32:35]
    ds_read_b64_tr_b16 a[116:117], v23 offset:43136
    ds_read_b64_tr_b16 a[118:119], v23 offset:43648
    s_setprio 0
    s_waitcnt lgkmcnt(12)
    v_mfma_f32_16x16x32_bf16 v[36:39], a[88:91], a[48:51], v[36:39]
    ds_read_b32 v120, v94
    ds_read_b32 v121, v94 offset:512
    v_xor_b32 v94, 64, v94
    v_mfma_f32_16x16x32_bf16 v[52:55], a[88:91], a[52:55], v[52:55]
    ds_read_b32 v122, v94
    ds_read_b32 v123, v92 offset:512
    s_waitcnt lgkmcnt(14)
    v_mfma_f32_16x16x32_bf16 v[56:59], a[92:95], a[52:55], v[56:59]
    ds_read_b32 v126, v93 offset:520
    v_mov_b32 v24, v84
    v_mov_b32 v25, v85
    v_mfma_f32_16x16x32_bf16 v[40:43], a[92:95], a[48:51], v[40:43]
    v_mov_b32 v26, v86
    v_mov_b32 v27, v87
    s_waitcnt lgkmcnt(5)
    v_mfma_f32_16x16x32_bf16 v[44:47], a[104:107], a[60:63], v[44:47]
    v_mfma_f32_16x16x32_bf16 v[48:51], a[108:111], a[60:63], v[48:51]
    v_mfma_f32_16x16x32_bf16 v[52:55], a[112:115], a[60:63], v[52:55]
    v_mfma_f32_16x16x32_bf16 v[56:59], a[116:119], a[60:63], v[56:59]
    v_mfma_f32_16x16x32_bf16 v[28:31], a[104:107], a[56:59], v[28:31]
    v_mfma_f32_16x16x32_bf16 v[32:35], a[108:111], a[56:59], v[32:35]
    ds_read_b32 v7, v96
    ds_read_b128 v[76:79], v95 offset:0
    ds_read_b128 v[80:83], v95 offset:64
    ds_read_b128 v[84:87], v95 offset:128
    ds_read_b128 v[88:91], v95 offset:192
    v_mfma_f32_16x16x32_bf16 v[36:39], a[112:115], a[56:59], v[36:39]
    v_mfma_f32_16x16x32_bf16 v[40:43], a[116:119], a[56:59], v[40:43]
    s_waitcnt lgkmcnt(0)
Lqf:
    v_readfirstlane_b32 s38, v7
    s_nop 0
    s_cmp_eq_u32 s38, 0
    s_cbranch_scc1 Lqf_re
    s_cmp_eq_u32 s27, 0
    v_fmac_f32 v44, v76, v122
    v_fmac_f32 v45, v77, v122
    v_fmac_f32 v46, v78, v122
    v_fmac_f32 v47, v79, v122
    v_cvt_pk_bf16_f32 v44, v44, v45
    v_cvt_pk_bf16_f32 v45, v46, v47
    v_fmac_f32 v48, v80, v122
    v_fmac_f32 v49, v81, v122
    v_fmac_f32 v50, v82, v122
    v_fmac_f32 v51, v83, v122
    v_cvt_pk_bf16_f32 v46, v48, v49
    v_cvt_pk_bf16_f32 v47, v50, v51
    v_fmac_f32 v52, v84, v122
    v_fmac_f32 v53, v85, v122
    v_fmac_f32 v54, v86, v122
    v_fmac_f32 v55, v87, v122
    v_cvt_pk_bf16_f32 v48, v52, v53
    v_cvt_pk_bf16_f32 v49, v54, v55
    v_fmac_f32 v56, v88, v122
    v_fmac_f32 v57, v89, v122
    v_fmac_f32 v58, v90, v122
    v_fmac_f32 v59, v91, v122
    v_cvt_pk_bf16_f32 v50, v56, v57
    v_cvt_pk_bf16_f32 v51, v58, v59
    s_cbranch_scc1 Lh1
    s_setprio 3
    ds_write_b128 v125, v[44:47] offset:2048
    ds_write_b128 v125, v[48:51] offset:3072
    v_fmac_f32 v28, v76, v120
    v_fmac_f32 v29, v77, v120
    v_fmac_f32 v30, v78, v120
    v_fmac_f32 v31, v79, v120
    v_cvt_pk_bf16_f32 v52, v28, v29
    v_cvt_pk_bf16_f32 v53, v30, v31
    v_fmac_f32 v32, v80, v120
    v_fmac_f32 v33, v81, v120
    v_fmac_f32 v34, v82, v120
    v_fmac_f32 v35, v83, v120
    v_cvt_pk_bf16_f32 v54, v32, v33
    v_cvt_pk_bf16_f32 v55, v34, v35
    v_fmac_f32 v36, v84, v120
    v_fmac_f32 v37, v85, v120
    v_fmac_f32 v38, v86, v120
    v_fmac_f32 v39, v87, v120
    v_cvt_pk_bf16_f32 v56, v36, v37
    v_cvt_pk_bf16_f32 v57, v38, v39
    v_fmac_f32 v40, v88, v120
    v_fmac_f32 v41, v89, v120
    v_fmac_f32 v42, v90, v120
    v_fmac_f32 v43, v91, v120
    v_cvt_pk_bf16_f32 v58, v40, v41
    v_cvt_pk_bf16_f32 v59, v42, v43
    ds_write_b128 v125, v[52:55] offset:4096
    ds_write_b128 v125, v[56:59] offset:5120
    v_mov_b32 v5, 157972
    v_mov_b32 v6, 1
    s_mov_b64 exec, 1
    ds_add_u32 v5, v6
    s_mov_b64 exec, -1
    v_mov_b32 v8, s22
    v_mov_b32 v9, s22
    v_mov_b32 v10, s22
    v_mov_b32 v11, s22
Lcw_1:
    s_sub_u32 s35, s35, 1
    s_cbranch_scc1 Lend
    ds_read_b32 v6, v5
    s_waitcnt lgkmcnt(0)
    v_readfirstlane_b32 s38, v6
    s_nop 0
    s_cmp_lt_u32 s38, 8
    s_cbranch_scc1 Lcw_1
    ds_read_b128 v[28:31], v125 offset:0
    ds_read_b128 v[32:35], v125 offset:1024
Lh_join:
    buffer_load_dword v20, v12, s[28:31], s24 offen sc1
    ds_read_b64_tr_b16 a[64:65], v26 offset:0
    ds_read_b64_tr_b16 a[66:67], v26 offset:512
    ds_read_b64_tr_b16 a[68:69], v27 offset:0
    ds_read_b64_tr_b16 a[70:71], v27 offset:512
    ds_read_b64_tr_b16 a[72:73], v26 offset:4096
    ds_read_b64_tr_b16 a[74:75], v26 offset:4608
    ds_read_b64_tr_b16 a[76:77], v27 offset:4096
    ds_read_b64_tr_b16 a[78:79], v27 offset:4608
    s_waitcnt lgkmcnt(8)
    s_setprio 3
    v_cndmask_b32 v92, 0, v30, s[6:7]
    v_cndmask_b32 v93, 0, v31, s[6:7]
    v_cndmask_b32 v94, 0, v32, s[12:13]
    v_cndmask_b32 v95, 0, v33, s[12:13]
    v_cndmask_b32 v104, 0, v30, s[8:9]
    v_cndmask_b32 v105, 0, v31, s[8:9]
    v_mfma_f32_16x16x32_bf16 v[76:79], v[46:49], v[92:95], v[8:11]
    v_mfma_f32_16x16x32_bf16 v[80:83], v[54:57], v[92:95], 0
    v_cndmask_b32 v106, 0, v32, s[14:15]
    v_cndmask_b32 v107, 0, v33, s[14:15]
    v_mov_b32 v96, v28
    v_mov_b32 v97, v29
    v_mfma_f32_16x16x32_bf16 v[84:87], v[46:49], v[104:107], v[8:11]
    v_mfma_f32_16x16x32_bf16 v[88:91], v[54:57], v[104:107], 0
    v_cndmask_b32 v98, 0, v30, s[10:11]
    v_cndmask_b32 v99, 0, v31, s[10:11]
    v_cndmask_b32 v100, 0, v32, s[16:17]
    v_cndmask_b32 v101, 0, v33, s[16:17]
    v_mfma_f32_16x16x32_bf16 v[36:39], v[44:47], v[96:99], v[8:11]
    v_mfma_f32_16x16x32_bf16 v[40:43], v[52:55], v[96:99], 0
    v_cndmask_b32 v76, v76, v77, s[4:5]
    v_cndmask_b32 v80, v80, v81, s[4:5]
    v_cndmask_b32 v78, v78, v79, s[4:5]
    v_cndmask_b32 v82, v82, v83, s[4:5]
    v_cndmask_b32 v92, v76, v80, s[18:19]
    v_cndmask_b32 v94, v78, v82, s[20:21]
    v_min_u32 v4, -2, v92
    v_min_u32 v5, -2, v94
    v_cndmask_b32 v84, v84, v85, s[4:5]
    v_cndmask_b32 v88, v88, v89, s[4:5]
    v_cndmask_b32 v86, v86, v87, s[4:5]
    v_cndmask_b32 v90, v90, v91, s[4:5]
    v_cndmask_b32 v104, v84, v88, s[18:19]
    v_cndmask_b32 v106, v86, v90, s[20:21]
    v_min_u32 v6, -2, v104
    v_min_u32 v7, -2, v106
    buffer_store_dwordx4 v[4:7], v13, s[28:31], s58 offen sc0 sc1
    s_setprio 2
    ds_read_b64_tr_b16 a[80:81], v26 offset:39040
    ds_read_b64_tr_b16 a[82:83], v26 offset:39552
    ds_read_b64_tr_b16 a[84:85], v27 offset:39040
    ds_read_b64_tr_b16 a[86:87], v27 offset:39552
    ds_read_b64_tr_b16 a[88:89], v26 offset:43136
    ds_read_b64_tr_b16 a[90:91], v26 offset:43648
    ds_read_b64_tr_b16 a[92:93], v27 offset:43136
    ds_read_b64_tr_b16 a[94:95], v27 offset:43648
    ds_read_b64_tr_b16 a[96:97], v24 offset:0
    ds_read_b64_tr_b16 a[98:99], v24 offset:512
    ds_read_b64_tr_b16 a[100:101], v25 offset:0
    ds_read_b64_tr_b16 a[102:103], v25 offset:512
    ds_read_b64_tr_b16 a[104:105], v24 offset:4096
    ds_read_b64_tr_b16 a[106:107], v24 offset:4608
    ds_read_b64_tr_b16 a[108:109], v25 offset:4096
    ds_read_b64_tr_b16 a[110:111], v25 offset:4608
    ds_read_b64_tr_b16 a[112:113], v24 offset:39040
    ds_read_b64_tr_b16 a[114:115], v24 offset:39552
    ds_read_b64_tr_b16 a[116:117], v25 offset:39040
    ds_read_b64_tr_b16 a[118:119], v25 offset:39552
    ds_read_b64_tr_b16 a[120:121], v24 offset:43136
    ds_read_b64_tr_b16 a[122:123], v24 offset:43648
    ds_read_b64_tr_b16 a[124:125], v25 offset:43136
    ds_read_b64_tr_b16 a[126:127], v25 offset:43648
    s_waitcnt lgkmcnt(15)
    v_mfma_f32_16x16x32_bf16 v[60:63], a[0:3], a[64:67], v[60:63]
    v_mov_b32 v102, v34
    v_mov_b32 v103, v35
    v_mul_f32 v4, s25, v121
    v_mfma_f32_16x16x32_bf16 v[68:71], a[4:7], a[64:67], v[68:71]
    v_mfma_f32_16x16x32_bf16 v[76:79], v[48:51], v[100:103], v[8:11]
    v_mfma_f32_16x16x32_bf16 v[80:83], v[56:59], v[100:103], 0
    v_mul_f32 v123, v123, v4
    v_mfma_f32_16x16x32_bf16 v[64:67], a[0:3], a[68:71], v[64:67]
    v_mul_f32 v126, v126, v4
    v_cndmask_b32 v36, v36, v37, s[4:5]
    v_cndmask_b32 v40, v40, v41, s[4:5]
    v_mfma_f32_16x16x32_bf16 v[72:75], a[4:7], a[68:71], v[72:75]
    v_cndmask_b32 v38, v38, v39, s[4:5]
    v_cndmask_b32 v42, v42, v43, s[4:5]
    v_cndmask_b32 v96, v36, v40, s[18:19]
    v_mfma_f32_16x16x32_bf16 v[60:63], a[8:11], a[72:75], v[60:63]
    v_cndmask_b32 v98, v38, v42, s[20:21]
    v_cndmask_b32 v76, v76, v77, s[4:5]
    v_cndmask_b32 v80, v80, v81, s[4:5]
    v_mfma_f32_16x16x32_bf16 v[68:71], a[12:15], a[72:75], v[68:71]
    v_cndmask_b32 v78, v78, v79, s[4:5]
    v_cndmask_b32 v82, v82, v83, s[4:5]
    v_cndmask_b32 v100, v76, v80, s[18:19]
    v_mfma_f32_16x16x32_bf16 v[64:67], a[8:11], a[76:79], v[64:67]
    v_cndmask_b32 v102, v78, v82, s[20:21]
    v_mul_f32 v96, v96, v123
    v_mul_f32 v98, v98, v126
    v_mfma_f32_16x16x32_bf16 v[72:75], a[12:15], a[76:79], v[72:75]
    v_mul_f32 v100, v100, v123
    v_mul_f32 v102, v102, v126
    v_max_f32 v4, v96, v98
    v_mfma_f32_16x16x32_bf16 v[60:63], a[16:19], a[80:83], v[60:63]
    v_max_f32 v5, v100, v102
    v_mov_b32 v6, v4
    v_mov_b32 v7, v5
    v_mfma_f32_16x16x32_bf16 v[68:71], a[20:23], a[80:83], v[68:71]
    v_permlane32_swap_b32 v4, v6
    v_permlane32_swap_b32 v5, v7
    v_max_f32 v4, v4, v6
    v_mfma_f32_16x16x32_bf16 v[64:67], a[16:19], a[84:87], v[64:67]
    v_max_f32 v5, v5, v7
    v_mov_b32 v6, v4
    v_mov_b32 v7, v5
    v_mfma_f32_16x16x32_bf16 v[72:75], a[20:23], a[84:87], v[72:75]
    v_permlane16_swap_b32 v4, v6
    v_permlane16_swap_b32 v5, v7
    s_setprio 1
    v_mfma_f32_16x16x32_bf16 v[60:63], a[24:27], a[88:91], v[60:63]
    v_max_f32 v4, v4, v6
    v_max_f32 v5, v5, v7
    v_sub_f32 v96, v96, v4
    v_mfma_f32_16x16x32_bf16 v[68:71], a[28:31], a[88:91], v[68:71]
    v_sub_f32 v98, v98, v4
    v_sub_f32 v100, v100, v5
    v_sub_f32 v102, v102, v5
    v_mfma_f32_16x16x32_bf16 v[64:67], a[24:27], a[92:95], v[64:67]
    v_exp_f32 v96, v96
    v_exp_f32 v98, v98
    v_exp_f32 v100, v100
    v_mfma_f32_16x16x32_bf16 v[72:75], a[28:31], a[92:95], v[72:75]
    v_exp_f32 v102, v102
    v_cvt_pk_bf16_f32 v96, v96, v96
    s_waitcnt lgkmcnt(12)
    v_mfma_f32_16x16x32_bf16 v[60:63], a[32:35], a[96:99], v[60:63]
    v_cvt_pk_bf16_f32 v97, v98, v98
    v_cvt_pk_bf16_f32 v100, v100, v100
    v_cvt_pk_bf16_f32 v101, v102, v102
    v_mfma_f32_16x16x32_bf16 v[68:71], a[36:39], a[96:99], v[68:71]
    v_and_b32 v98, v96, v118
    v_and_b32 v99, v97, v119
    v_and_b32 v96, v96, v116
    v_mfma_f32_16x16x32_bf16 v[64:67], a[32:35], a[100:103], v[64:67]
    v_and_b32 v97, v97, v117
    v_and_b32 v102, v100, v118
    v_and_b32 v103, v101, v119
    v_mfma_f32_16x16x32_bf16 v[72:75], a[36:39], a[100:103], v[72:75]
    v_and_b32 v100, v100, v116
    v_and_b32 v101, v101, v117
    s_waitcnt lgkmcnt(8)
    v_mfma_f32_16x16x32_bf16 v[60:63], a[40:43], a[104:107], v[60:63]
    s_lshl_b32 s36, s44, 6
    s_add_u32 s36, s36, 156160
    v_lshl_add_u32 v48, v2, 4, s36
    v_xor_b32 v49, 64, v48
    ds_read_b128 v[28:31], v48 offset:0
    v_mfma_f32_16x16x32_bf16 v[68:71], a[44:47], a[104:107], v[68:71]
    ds_read_b128 v[32:35], v48 offset:512
    ds_read_b128 v[36:39], v49 offset:0
    ds_read_b128 v[40:43], v49 offset:512
    s_lshl_b32 s36, s27, 3
    s_add_u32 s36, s36, 157696
    v_mfma_f32_16x16x32_bf16 v[64:67], a[40:43], a[108:111], v[64:67]
    v_lshl_add_u32 v48, v3, 4, s36
    v_mov_b32 v49, 157952
    v_lshl_add_u32 v125, v1, 3, s45
    s_lshl_b32 s36, s27, 10
    v_add_u32 v50, s36, v125
    v_mfma_f32_16x16x32_bf16 v[72:75], a[44:47], a[108:111], v[72:75]
    s_lshl_b32 s37, s27, 12
    s_sub_u32 s37, 2048, s37
    v_add_u32 v51, s37, v50
    v_subrev_u32 v125, 2048, v125
    s_setprio 0
    s_waitcnt lgkmcnt(8)
    v_mfma_f32_16x16x32_bf16 v[60:63], a[48:51], a[112:115], v[60:63]
    v_mfma_f32_16x16x32_bf16 v[68:71], a[52:55], a[112:115], v[68:71]
    v_mfma_f32_16x16x32_bf16 v[64:67], a[48:51], a[116:119], v[64:67]
    v_mfma_f32_16x16x32_bf16 v[72:75], a[52:55], a[116:119], v[72:75]
    s_waitcnt vmcnt(1)
Lfl_chk:
    v_cmp_eq_u32 vcc, s34, v20
    s_nop 0
    s_and_b32 s36, vcc_lo, 0x3ff
    s_cmp_lg_u32 s36, 0x3ff
    s_cbranch_scc1 Lfl_re
    buffer_load_dwordx2 v[52:53], v13, s[28:31], s59 offen offset:8 sc1
    buffer_load_dwordx2 v[54:55], v13, s[28:31], s60 offen offset:0 sc1
    s_waitcnt lgkmcnt(4)
    v_mfma_f32_16x16x32_bf16 v[60:63], a[56:59], a[120:123], v[60:63]
    v_mfma_f32_16x16x32_bf16 v[68:71], a[60:63], a[120:123], v[68:71]
    v_mfma_f32_16x16x32_bf16 v[64:67], a[56:59], a[124:127], v[64:67]
    v_mfma_f32_16x16x32_bf16 v[72:75], a[60:63], a[124:127], v[72:75]
    ds_read_b32 v46, v49
    ds_read_b64 v[44:45], v48
    s_waitcnt lgkmcnt(0)
Lcsv:
    v_readfirstlane_b32 s38, v46
    s_nop 0
    s_cmp_eq_u32 s38, 0
    s_cbranch_scc1 Lcsv_re
    v_fmac_f32 v60, v28, v44
    v_fmac_f32 v61, v29, v44
    v_fmac_f32 v62, v30, v44
    v_fmac_f32 v63, v31, v44
    v_mul_f32 v60, v60, v32
    v_mul_f32 v61, v61, v33
    v_mul_f32 v62, v62, v34
    v_mul_f32 v63, v63, v35
    v_cvt_pk_bf16_f32 v60, v60, v61
    v_cvt_pk_bf16_f32 v61, v62, v63
    ds_write_b64 v50, v[60:61] offset:0
    v_fmac_f32 v64, v28, v45
    v_fmac_f32 v65, v29, v45
    v_fmac_f32 v66, v30, v45
    v_fmac_f32 v67, v31, v45
    v_mul_f32 v64, v64, v32
    v_mul_f32 v65, v65, v33
    v_mul_f32 v66, v66, v34
    v_mul_f32 v67, v67, v35
    v_cvt_pk_bf16_f32 v64, v64, v65
    v_cvt_pk_bf16_f32 v65, v66, v67
    ds_write_b64 v50, v[64:65] offset:512
    v_fmac_f32 v68, v36, v44
    v_fmac_f32 v69, v37, v44
    v_fmac_f32 v70, v38, v44
    v_fmac_f32 v71, v39, v44
    v_mul_f32 v68, v68, v40
    v_mul_f32 v69, v69, v41
    v_mul_f32 v70, v70, v42
    v_mul_f32 v71, v71, v43
    v_cvt_pk_bf16_f32 v68, v68, v69
    v_cvt_pk_bf16_f32 v69, v70, v71
    ds_write_b64 v51, v[68:69] offset:0
    v_fmac_f32 v72, v36, v45
    v_fmac_f32 v73, v37, v45
    v_fmac_f32 v74, v38, v45
    v_fmac_f32 v75, v39, v45
    v_mul_f32 v72, v72, v40
    v_mul_f32 v73, v73, v41
    v_mul_f32 v74, v74, v42
    v_mul_f32 v75, v75, v43
    v_cvt_pk_bf16_f32 v72, v72, v73
    v_cvt_pk_bf16_f32 v73, v74, v75
    ds_write_b64 v51, v[72:73] offset:512
    v_mov_b32 v8, 157976
    v_mov_b32 v9, 1
    s_mov_b64 exec, 1
    ds_add_u32 v8, v9
    s_mov_b64 exec, -1
    s_waitcnt vmcnt(0)
Lrx_chk:
    v_and_b32 v52, s61, v52
    v_and_b32 v53, s61, v53
    v_and_b32 v54, s62, v54
    v_and_b32 v55, s62, v55
    v_max3_u32 v4, v52, v53, v54
    v_max_u32 v4, v4, v55
    v_cmp_eq_u32 vcc, -1, v4
    s_nop 0
    s_cbranch_vccnz Lrx_re
    v_add_f32 v92, v92, v52
    v_add_f32 v94, v94, v53
    v_add_f32 v104, v104, v54
    v_add_f32 v106, v106, v55
Lcw_4:
    s_sub_u32 s35, s35, 1
    s_cbranch_scc1 Lend
    ds_read_b32 v9, v8
    s_waitcnt lgkmcnt(0)
    v_readfirstlane_b32 s38, v9
    s_nop 0
    s_cmp_lt_u32 s38, 7
    s_cbranch_scc1 Lcw_4
    s_setprio 2
    ds_read2st64_b64 v[60:63], v125 offset0:0 offset1:4
    ds_read2st64_b64 v[64:67], v125 offset0:1 offset1:5
    ds_read2st64_b64 v[68:71], v125 offset0:2 offset1:6
    ds_read2st64_b64 v[72:75], v125 offset0:3 offset1:7
    v_mul_f32 v92, v92, v123
    v_mul_f32 v94, v94, v126
    v_mul_f32 v104, v104, v123
    v_mul_f32 v106, v106, v126
    v_max_f32 v4, v92, v94
    v_max_f32 v5, v104, v106
    v_mov_b32 v6, v4
    v_mov_b32 v7, v5
    s_nop 0
    v_permlane32_swap_b32 v4, v6
    v_permlane32_swap_b32 v5, v7
    v_max_f32 v4, v4, v6
    v_max_f32 v5, v5, v7
    s_waitcnt lgkmcnt(0)
    v_mov_b32 v6, v4
    v_mfma_f32_16x16x32_bf16 v[80:83], v[14:17], v[96:99], 0
    v_mov_b32 v7, v5
    v_permlane16_swap_b32 v4, v6
    s_nop 0
    v_permlane16_swap_b32 v5, v7
    v_max_f32 v4, v4, v6
    v_mfma_f32_16x16x32_bf16 v[84:87], v[14:17], v[100:103], 0
    v_max_f32 v5, v5, v7
    v_sub_f32 v92, v92, v4
    v_sub_f32 v94, v94, v4
    v_sub_f32 v104, v104, v5
    v_mfma_f32_16x16x32_bf16 v[28:31], v[60:63], v[96:99], 0
    v_sub_f32 v106, v106, v5
    v_exp_f32 v92, v92
    v_exp_f32 v94, v94
    v_exp_f32 v104, v104
    v_exp_f32 v106, v106
    v_mfma_f32_16x16x32_bf16 v[32:35], v[64:67], v[96:99], 0
    v_cvt_pk_bf16_f32 v92, v92, v92
    v_cvt_pk_bf16_f32 v93, v94, v94
    v_cvt_pk_bf16_f32 v104, v104, v104
    v_cvt_pk_bf16_f32 v105, v106, v106
    v_mfma_f32_16x16x32_bf16 v[36:39], v[68:71], v[100:103], 0
    v_and_b32 v94, v92, v118
    v_and_b32 v95, v93, v119
    v_and_b32 v92, v92, v116
    v_and_b32 v93, v93, v117
    v_mfma_f32_16x16x32_bf16 v[40:43], v[72:75], v[100:103], 0
    v_and_b32 v106, v104, v118
    v_and_b32 v107, v105, v119
    v_and_b32 v104, v104, v116
    v_and_b32 v105, v105, v117
    v_mfma_f32_16x16x32_bf16 v[76:79], v[14:17], v[92:95], 0
    v_rcp_f32 v80, v80
    v_rcp_f32 v84, v84
    v_mfma_f32_16x16x32_bf16 v[88:91], v[14:17], v[104:107], 0
    v_mul_f32 v28, v28, v80
    v_mul_f32 v29, v29, v80
    v_mfma_f32_16x16x32_bf16 v[44:47], v[64:67], v[92:95], 0
    v_mul_f32 v30, v30, v80
    v_mfma_f32_16x16x32_bf16 v[48:51], v[68:71], v[92:95], 0
    v_mul_f32 v31, v31, v80
    v_cvt_pk_bf16_f32 v4, v28, v29
    v_mfma_f32_16x16x32_bf16 v[52:55], v[64:67], v[104:107], 0
    v_cvt_pk_bf16_f32 v5, v30, v31
    v_min_u32 v4, -2, v4
    v_mfma_f32_16x16x32_bf16 v[56:59], v[68:71], v[104:107], 0
    v_min_u32 v5, -2, v5
    v_mul_f32 v40, v40, v84
    v_mul_f32 v41, v41, v84
    v_mul_f32 v42, v42, v84
    v_mul_f32 v43, v43, v84
    v_cvt_pk_bf16_f32 v10, v40, v41
    v_cvt_pk_bf16_f32 v11, v42, v43
    v_min_u32 v10, -2, v10
    v_min_u32 v11, -2, v11
    v_rcp_f32 v76, v76
    v_rcp_f32 v88, v88
    v_cndmask_b32 v82, v80, v76, s[6:7]
    v_cndmask_b32 v82, v82, v88, s[8:9]
    v_cndmask_b32 v32, v32, v44, s[6:7]
    v_cndmask_b32 v33, v33, v45, s[6:7]
    v_cndmask_b32 v34, v34, v46, s[6:7]
    v_cndmask_b32 v35, v35, v47, s[6:7]
    v_cndmask_b32 v32, v32, v52, s[8:9]
    v_cndmask_b32 v33, v33, v53, s[8:9]
    v_cndmask_b32 v34, v34, v54, s[8:9]
    v_cndmask_b32 v35, v35, v55, s[8:9]
    v_mul_f32 v32, v32, v82
    v_mul_f32 v33, v33, v82
    v_mul_f32 v34, v34, v82
    v_mul_f32 v35, v35, v82
    v_cvt_pk_bf16_f32 v6, v32, v33
    v_cvt_pk_bf16_f32 v7, v34, v35
    v_min_u32 v6, -2, v6
    v_min_u32 v7, -2, v7
    buffer_store_dwordx4 v[4:7], v13, s[28:31], s23 offen offset:0 sc0 sc1
    v_cndmask_b32 v86, v84, v76, s[12:13]
    v_cndmask_b32 v86, v86, v88, s[14:15]
    v_cndmask_b32 v36, v36, v48, s[12:13]
    v_cndmask_b32 v37, v37, v49, s[12:13]
    v_cndmask_b32 v38, v38, v50, s[12:13]
    v_cndmask_b32 v39, v39, v51, s[12:13]
    v_cndmask_b32 v36, v36, v56, s[14:15]
    v_cndmask_b32 v37, v37, v57, s[14:15]
    v_cndmask_b32 v38, v38, v58, s[14:15]
    v_cndmask_b32 v39, v39, v59, s[14:15]
    v_mul_f32 v36, v36, v86
    v_mul_f32 v37, v37, v86
    v_mul_f32 v38, v38, v86
    v_mul_f32 v39, v39, v86
    v_cvt_pk_bf16_f32 v8, v36, v37
    v_cvt_pk_bf16_f32 v9, v38, v39
    v_min_u32 v8, -2, v8
    v_min_u32 v9, -2, v9
    buffer_store_dwordx4 v[8:11], v13, s[28:31], s23 offen offset:1024 sc0 sc1
    s_setprio 1
    s_nop 0
    v_mov_b32 v10, 157980
    v_and_b32 v6, 3, v1
    v_lshl_add_u32 v6, v6, 3, v19
    v_add_u32 v20, v6, v18
    v_xor_b32 v21, 32, v20
    v_xor_b32 v22, 64, v20
    v_xor_b32 v23, 96, v20
    v_add_u32 v24, 63616, v20
    v_add_u32 v25, 63616, v21
    v_add_u32 v26, 63616, v22
    v_add_u32 v27, 63616, v23
Lcw_3:
    s_sub_u32 s35, s35, 1
    s_cbranch_scc1 Lend
    ds_read_b32 v11, v10
    s_waitcnt lgkmcnt(0)
    v_readfirstlane_b32 s38, v11
    s_nop 0
    s_cmp_lt_u32 s38, 2
    s_cbranch_scc1 Lcw_3
    s_mul_i32 s36, s32, 96
    s_lshl_b32 s37, s44, 4
    s_add_u32 s36, s36, s37
    s_sub_u32 s36, s36, 32
    v_add_u32 v126, s36, v3
    v_lshrrev_b32 v6, 3, v1
    v_add_u32 v6, s36, v6
    v_mul_u32_u24 v6, 1280, v6
    v_and_b32 v7, 7, v1
    v_xor_b32 v7, v7, v2
    v_lshl_add_u32 v122, v7, 4, v6
    v_xor_b32 v123, 64, v122
    v_add_u32 v123, 10240, v123
    s_lshl_b32 s36, s44, 11
    s_add_u32 s36, s36, 102656
    v_add_u32 v124, s36, v124
    v_add_u32 v125, s36, v13
    s_lshl_b32 s24, s33, 7
    v_mov_b32 v10, 157960
    s_mov_b32 s41, 0
    s_mov_b32 s47, 3
    v_lshlrev_b32 v28, 16, v108
    ds_read_b64_tr_b16 a[0:1], v20 offset:0
    ds_read_b64_tr_b16 a[2:3], v20 offset:512
    ds_read_b64_tr_b16 a[4:5], v21 offset:0
    ds_read_b64_tr_b16 a[6:7], v21 offset:512
    ds_read_b64_tr_b16 a[8:9], v22 offset:0
    ds_read_b64_tr_b16 a[10:11], v22 offset:512
    ds_read_b64_tr_b16 a[12:13], v23 offset:0
    ds_read_b64_tr_b16 a[14:15], v23 offset:512
    v_and_b32 v29, 0xffff0000, v108
    v_lshlrev_b32 v30, 16, v109
    v_and_b32 v31, 0xffff0000, v109
    v_lshlrev_b32 v32, 16, v110
    v_and_b32 v33, 0xffff0000, v110
    v_lshlrev_b32 v34, 16, v111
    v_and_b32 v35, 0xffff0000, v111
    v_lshlrev_b32 v36, 16, v112
    v_and_b32 v37, 0xffff0000, v112
    v_lshlrev_b32 v38, 16, v113
    v_and_b32 v39, 0xffff0000, v113
    v_lshlrev_b32 v40, 16, v114
    v_and_b32 v41, 0xffff0000, v114
    v_lshlrev_b32 v42, 16, v115
    ds_read_b64_tr_b16 a[16:17], v20 offset:4096
    ds_read_b64_tr_b16 a[18:19], v20 offset:4608
    ds_read_b64_tr_b16 a[20:21], v21 offset:4096
    ds_read_b64_tr_b16 a[22:23], v21 offset:4608
    ds_read_b64_tr_b16 a[24:25], v22 offset:4096
    ds_read_b64_tr_b16 a[26:27], v22 offset:4608
    ds_read_b64_tr_b16 a[28:29], v23 offset:4096
    ds_read_b64_tr_b16 a[30:31], v23 offset:4608
    v_and_b32 v43, 0xffff0000, v115
    v_mul_f32 v4, v120, v121
    v_mul_f32 v5, 0xbfb8aa3b, v121
    v_mul_f32 v6, 0xbfb8aa3b, v4
    v_fma_f32 v44, v28, v5, v6
    v_fma_f32 v45, v29, v5, v6
    v_fma_f32 v46, v30, v5, v6
    v_fma_f32 v47, v31, v5, v6
    v_fma_f32 v48, v32, v5, v6
    v_fma_f32 v49, v33, v5, v6
    v_fma_f32 v50, v34, v5, v6
    v_fma_f32 v51, v35, v5, v6
    v_fma_f32 v52, v36, v5, v6
    v_fma_f32 v53, v37, v5, v6
    ds_read_b64_tr_b16 a[32:33], v20 offset:8192
    ds_read_b64_tr_b16 a[34:35], v20 offset:8704
    ds_read_b64_tr_b16 a[36:37], v21 offset:8192
    ds_read_b64_tr_b16 a[38:39], v21 offset:8704
    ds_read_b64_tr_b16 a[40:41], v22 offset:8192
    ds_read_b64_tr_b16 a[42:43], v22 offset:8704
    ds_read_b64_tr_b16 a[44:45], v23 offset:8192
    ds_read_b64_tr_b16 a[46:47], v23 offset:8704
    v_fma_f32 v54, v38, v5, v6
    v_fma_f32 v55, v39, v5, v6
    v_fma_f32 v56, v40, v5, v6
    v_fma_f32 v57, v41, v5, v6
    v_fma_f32 v58, v42, v5, v6
    v_fma_f32 v59, v43, v5, v6
    v_exp_f32 v44, v44
    v_exp_f32 v45, v45
    v_exp_f32 v46, v46
    v_exp_f32 v47, v47
    v_exp_f32 v48, v48
    v_exp_f32 v49, v49
    v_exp_f32 v50, v50
    v_exp_f32 v51, v51
    v_exp_f32 v52, v52
    ds_read_b64_tr_b16 a[48:49], v20 offset:12288
    ds_read_b64_tr_b16 a[50:51], v20 offset:12800
    ds_read_b64_tr_b16 a[52:53], v21 offset:12288
    ds_read_b64_tr_b16 a[54:55], v21 offset:12800
    ds_read_b64_tr_b16 a[56:57], v22 offset:12288
    ds_read_b64_tr_b16 a[58:59], v22 offset:12800
    ds_read_b64_tr_b16 a[60:61], v23 offset:12288
    ds_read_b64_tr_b16 a[62:63], v23 offset:12800
    v_exp_f32 v53, v53
    v_exp_f32 v54, v54
    v_exp_f32 v55, v55
    v_exp_f32 v56, v56
    v_exp_f32 v57, v57
    v_exp_f32 v58, v58
    v_exp_f32 v59, v59
    v_fma_f32 v92, v28, v121, v4
    v_fma_f32 v93, v29, v121, v4
    v_fma_f32 v94, v30, v121, v4
    v_fma_f32 v95, v31, v121, v4
    v_fma_f32 v96, v32, v121, v4
    v_fma_f32 v97, v33, v121, v4
    v_fma_f32 v98, v34, v121, v4
    ds_read_b64_tr_b16 a[64:65], v20 offset:24576
    ds_read_b64_tr_b16 a[66:67], v20 offset:25088
    ds_read_b64_tr_b16 a[68:69], v21 offset:24576
    ds_read_b64_tr_b16 a[70:71], v21 offset:25088
    ds_read_b64_tr_b16 a[72:73], v22 offset:24576
    ds_read_b64_tr_b16 a[74:75], v22 offset:25088
    ds_read_b64_tr_b16 a[76:77], v23 offset:24576
    ds_read_b64_tr_b16 a[78:79], v23 offset:25088
    v_fma_f32 v99, v35, v121, v4
    v_fma_f32 v100, v36, v121, v4
    v_fma_f32 v101, v37, v121, v4
    v_fma_f32 v102, v38, v121, v4
    v_fma_f32 v103, v39, v121, v4
    v_fma_f32 v104, v40, v121, v4
    v_fma_f32 v105, v41, v121, v4
    v_fma_f32 v106, v42, v121, v4
    v_fma_f32 v107, v43, v121, v4
    v_add_f32 v44, 1.0, v44
    v_add_f32 v45, 1.0, v45
    v_add_f32 v46, 1.0, v46
    v_add_f32 v47, 1.0, v47
    v_add_f32 v48, 1.0, v48
    ds_read_b64_tr_b16 a[80:81], v20 offset:28672
    ds_read_b64_tr_b16 a[82:83], v20 offset:29184
    ds_read_b64_tr_b16 a[84:85], v21 offset:28672
    ds_read_b64_tr_b16 a[86:87], v21 offset:29184
    ds_read_b64_tr_b16 a[88:89], v22 offset:28672
    ds_read_b64_tr_b16 a[90:91], v22 offset:29184
    ds_read_b64_tr_b16 a[92:93], v23 offset:28672
    ds_read_b64_tr_b16 a[94:95], v23 offset:29184
    v_add_f32 v49, 1.0, v49
    v_add_f32 v50, 1.0, v50
    v_add_f32 v51, 1.0, v51
    v_add_f32 v52, 1.0, v52
    v_add_f32 v53, 1.0, v53
    v_add_f32 v54, 1.0, v54
    v_add_f32 v55, 1.0, v55
    v_add_f32 v56, 1.0, v56
    v_add_f32 v57, 1.0, v57
    v_add_f32 v58, 1.0, v58
    v_add_f32 v59, 1.0, v59
    v_rcp_f32 v44, v44
    v_rcp_f32 v45, v45
    v_rcp_f32 v46, v46
    v_rcp_f32 v47, v47
    ds_read_b64_tr_b16 a[96:97], v24 offset:59520
    ds_read_b64_tr_b16 a[98:99], v24 offset:60032
    ds_read_b64_tr_b16 a[100:101], v25 offset:59520
    ds_read_b64_tr_b16 a[102:103], v25 offset:60032
    ds_read_b64_tr_b16 a[104:105], v26 offset:59520
    ds_read_b64_tr_b16 a[106:107], v26 offset:60032
    ds_read_b64_tr_b16 a[108:109], v27 offset:59520
    ds_read_b64_tr_b16 a[110:111], v27 offset:60032
    v_rcp_f32 v48, v48
    v_rcp_f32 v49, v49
    v_rcp_f32 v50, v50
    v_rcp_f32 v51, v51
    v_rcp_f32 v52, v52
    v_rcp_f32 v53, v53
    v_rcp_f32 v54, v54
    v_rcp_f32 v55, v55
    v_rcp_f32 v56, v56
    v_rcp_f32 v57, v57
    v_rcp_f32 v58, v58
    v_rcp_f32 v59, v59
    v_mul_f32 v44, v44, v92
    v_mul_f32 v45, v45, v93
    ds_read_b64_tr_b16 a[112:113], v24 offset:63616
    ds_read_b64_tr_b16 a[114:115], v24 offset:64128
    ds_read_b64_tr_b16 a[116:117], v25 offset:63616
    ds_read_b64_tr_b16 a[118:119], v25 offset:64128
    ds_read_b64_tr_b16 a[120:121], v26 offset:63616
    ds_read_b64_tr_b16 a[122:123], v26 offset:64128
    ds_read_b64_tr_b16 a[124:125], v27 offset:63616
    ds_read_b64_tr_b16 a[126:127], v27 offset:64128
    v_mul_f32 v46, v46, v94
    v_mul_f32 v47, v47, v95
    v_mul_f32 v48, v48, v96
    v_mul_f32 v49, v49, v97
    v_mul_f32 v50, v50, v98
    v_mul_f32 v51, v51, v99
    v_mul_f32 v52, v52, v100
    v_mul_f32 v53, v53, v101
    v_mul_f32 v54, v54, v102
    v_mul_f32 v55, v55, v103
    v_mul_f32 v56, v56, v104
    v_mul_f32 v57, v57, v105
    v_mul_f32 v58, v58, v106
    v_mul_f32 v59, v59, v107
    buffer_load_dwordx4 v[60:63], v13, s[28:31], s53 offen offset:0 sc1
    buffer_load_dwordx4 v[64:67], v13, s[28:31], s53 offen offset:1024 sc1
    buffer_load_dwordx4 v[68:71], v13, s[28:31], s53 offen offset:2048 sc1
    buffer_load_dwordx4 v[72:75], v13, s[28:31], s53 offen offset:3072 sc1
    buffer_load_dwordx4 v[76:79], v13, s[28:31], s54 offen offset:0 sc1
    buffer_load_dwordx4 v[80:83], v13, s[28:31], s54 offen offset:1024 sc1
    buffer_load_dwordx4 v[84:87], v13, s[28:31], s54 offen offset:2048 sc1
    buffer_load_dwordx4 v[88:91], v13, s[28:31], s54 offen offset:3072 sc1
    s_setprio 0
Lwo_go:
    s_setprio 3
    ds_read_b64 v[8:9], v10
    s_waitcnt vmcnt(6)
    v_max3_u32 v4, v60, v61, v62
    v_max3_u32 v5, v64, v65, v66
    v_max3_u32 v4, v4, v63, v67
    v_max_u32 v4, v4, v5
    v_cmp_eq_u32 vcc, -1, v4
    s_nop 0
    s_cbranch_vccnz Lre_0
Lck_0:
    s_waitcnt lgkmcnt(15)
    v_mfma_f32_16x16x32_bf16 v[108:111], a[0:3], v[60:63], 0
    ds_read_b64_tr_b16 a[0:1], v24 offset:16384
    ds_read_b64_tr_b16 a[2:3], v24 offset:16896
    buffer_load_dwordx4 v[92:95], v13, s[28:31], s55 offen offset:0 sc1
    v_mfma_f32_16x16x32_bf16 v[112:115], a[4:7], v[60:63], 0
    ds_read_b64_tr_b16 a[4:5], v25 offset:16384
    ds_read_b64_tr_b16 a[6:7], v25 offset:16896
    v_mfma_f32_16x16x32_bf16 v[116:119], a[8:11], v[60:63], 0
    ds_read_b64_tr_b16 a[8:9], v26 offset:16384
    buffer_load_dwordx4 v[96:99], v13, s[28:31], s55 offen offset:1024 sc1
    v_mfma_f32_16x16x32_bf16 v[14:17], a[12:15], v[60:63], 0
    ds_read_b64_tr_b16 a[10:11], v26 offset:16896
    ds_read_b64_tr_b16 a[12:13], v27 offset:16384
    v_mfma_f32_16x16x32_bf16 v[108:111], a[16:19], v[64:67], v[108:111]
    ds_read_b64_tr_b16 a[14:15], v27 offset:16896
    s_waitcnt vmcnt(6)
    v_max3_u32 v4, v68, v69, v70
    v_mfma_f32_16x16x32_bf16 v[112:115], a[20:23], v[64:67], v[112:115]
    ds_read_b64_tr_b16 a[16:17], v24 offset:20480
    ds_read_b64_tr_b16 a[18:19], v24 offset:20992
    v_max3_u32 v5, v72, v73, v74
    v_max3_u32 v4, v4, v71, v75
    v_mfma_f32_16x16x32_bf16 v[116:119], a[24:27], v[64:67], v[116:119]
    ds_read_b64_tr_b16 a[20:21], v25 offset:20480
    ds_read_b64_tr_b16 a[22:23], v25 offset:20992
    v_max_u32 v4, v4, v5
    v_cmp_eq_u32 vcc, -1, v4
    v_mfma_f32_16x16x32_bf16 v[14:17], a[28:31], v[64:67], v[14:17]
    ds_read_b64_tr_b16 a[24:25], v26 offset:20480
    s_cbranch_vccnz Lre_1
Lck_1:
    s_waitcnt lgkmcnt(13)
Linfo:
    v_readfirstlane_b32 s39, v8
    s_nop 0
    s_cmp_eq_u32 s39, -2
    s_cbranch_scc1 Linfo_re
    v_mfma_f32_16x16x32_bf16 v[108:111], a[32:35], v[68:71], v[108:111]
    ds_read_b64_tr_b16 a[26:27], v26 offset:20992
    ds_read_b64_tr_b16 a[28:29], v27 offset:20480
    buffer_load_dwordx4 v[100:103], v13, s[28:31], s55 offen offset:2048 sc1
    v_mfma_f32_16x16x32_bf16 v[112:115], a[36:39], v[68:71], v[112:115]
    ds_read_b64_tr_b16 a[30:31], v27 offset:20992
    v_mfma_f32_16x16x32_bf16 v[116:119], a[40:43], v[68:71], v[116:119]
    ds_read_b64_tr_b16 a[32:33], v20 offset:32768
    ds_read_b64_tr_b16 a[34:35], v20 offset:33280
    buffer_load_dwordx4 v[104:107], v13, s[28:31], s55 offen offset:3072 sc1
    v_mfma_f32_16x16x32_bf16 v[14:17], a[44:47], v[68:71], v[14:17]
    ds_read_b64_tr_b16 a[36:37], v21 offset:32768
    ds_read_b64_tr_b16 a[38:39], v21 offset:33280
    v_mfma_f32_16x16x32_bf16 v[108:111], a[48:51], v[72:75], v[108:111]
    ds_read_b64_tr_b16 a[40:41], v22 offset:32768
    s_waitcnt vmcnt(6)
    v_max3_u32 v4, v76, v77, v78
    v_mfma_f32_16x16x32_bf16 v[112:115], a[52:55], v[72:75], v[112:115]
    ds_read_b64_tr_b16 a[42:43], v22 offset:33280
    ds_read_b64_tr_b16 a[44:45], v23 offset:32768
    v_max3_u32 v5, v80, v81, v82
    v_max3_u32 v4, v4, v79, v83
    v_mfma_f32_16x16x32_bf16 v[116:119], a[56:59], v[72:75], v[116:119]
    ds_read_b64_tr_b16 a[46:47], v23 offset:33280
    v_max_u32 v4, v4, v5
    v_cmp_eq_u32 vcc, -1, v4
    v_mfma_f32_16x16x32_bf16 v[14:17], a[60:63], v[72:75], v[14:17]
    ds_read_b64_tr_b16 a[48:49], v20 offset:36864
    ds_read_b64_tr_b16 a[50:51], v20 offset:37376
    s_cbranch_vccnz Lre_2
Lck_2:
    v_mfma_f32_16x16x32_bf16 v[108:111], a[64:67], v[76:79], v[108:111]
    ds_read_b64_tr_b16 a[52:53], v21 offset:36864
    ds_read_b64_tr_b16 a[54:55], v21 offset:37376
    buffer_load_dwordx4 v[60:63], v13, s[28:31], s56 offen offset:0 sc1
    v_mfma_f32_16x16x32_bf16 v[112:115], a[68:71], v[76:79], v[112:115]
    ds_read_b64_tr_b16 a[56:57], v22 offset:36864
    v_mfma_f32_16x16x32_bf16 v[116:119], a[72:75], v[76:79], v[116:119]
    ds_read_b64_tr_b16 a[58:59], v22 offset:37376
    ds_read_b64_tr_b16 a[60:61], v23 offset:36864
    buffer_load_dwordx4 v[64:67], v13, s[28:31], s56 offen offset:1024 sc1
    v_mfma_f32_16x16x32_bf16 v[14:17], a[76:79], v[76:79], v[14:17]
    ds_read_b64_tr_b16 a[62:63], v23 offset:37376
    v_mfma_f32_16x16x32_bf16 v[108:111], a[80:83], v[80:83], v[108:111]
    ds_read_b64_tr_b16 a[64:65], v20 offset:40960
    ds_read_b64_tr_b16 a[66:67], v20 offset:41472
    s_waitcnt vmcnt(6)
    v_max3_u32 v4, v84, v85, v86
    v_mfma_f32_16x16x32_bf16 v[112:115], a[84:87], v[80:83], v[112:115]
    ds_read_b64_tr_b16 a[68:69], v21 offset:40960
    ds_read_b64_tr_b16 a[70:71], v21 offset:41472
    v_max3_u32 v5, v88, v89, v90
    v_max3_u32 v4, v4, v87, v91
    v_mfma_f32_16x16x32_bf16 v[116:119], a[88:91], v[80:83], v[116:119]
    ds_read_b64_tr_b16 a[72:73], v22 offset:40960
    v_max_u32 v4, v4, v5
    v_cmp_eq_u32 vcc, -1, v4
    v_mfma_f32_16x16x32_bf16 v[14:17], a[92:95], v[80:83], v[14:17]
    ds_read_b64_tr_b16 a[74:75], v22 offset:41472
    ds_read_b64_tr_b16 a[76:77], v23 offset:40960
    s_cbranch_vccnz Lre_3
Lck_3:
    s_setprio 2
    v_mfma_f32_16x16x32_bf16 v[108:111], a[96:99], v[84:87], v[108:111]
    ds_read_b64_tr_b16 a[78:79], v23 offset:41472
    buffer_load_dwordx4 v[68:71], v13, s[28:31], s56 offen offset:2048 sc1
    v_mfma_f32_16x16x32_bf16 v[112:115], a[100:103], v[84:87], v[112:115]
    ds_read_b64_tr_b16 a[80:81], v20 offset:45056
    ds_read_b64_tr_b16 a[82:83], v20 offset:45568
    v_mfma_f32_16x16x32_bf16 v[116:119], a[104:107], v[84:87], v[116:119]
    ds_read_b64_tr_b16 a[84:85], v21 offset:45056
    ds_read_b64_tr_b16 a[86:87], v21 offset:45568
    buffer_load_dwordx4 v[72:75], v13, s[28:31], s56 offen offset:3072 sc1
    v_mfma_f32_16x16x32_bf16 v[14:17], a[108:111], v[84:87], v[14:17]
    ds_read_b64_tr_b16 a[88:89], v22 offset:45056
    v_mfma_f32_16x16x32_bf16 v[108:111], a[112:115], v[88:91], v[108:111]
    ds_read_b64_tr_b16 a[90:91], v22 offset:45568
    ds_read_b64_tr_b16 a[92:93], v23 offset:45056
    s_waitcnt vmcnt(6)
    v_max3_u32 v4, v92, v93, v94
    v_mfma_f32_16x16x32_bf16 v[112:115], a[116:119], v[88:91], v[112:115]
    ds_read_b64_tr_b16 a[94:95], v23 offset:45568
    v_max3_u32 v5, v96, v97, v98
    v_max3_u32 v4, v4, v95, v99
    v_mfma_f32_16x16x32_bf16 v[116:119], a[120:123], v[88:91], v[116:119]
    ds_read_b64_tr_b16 a[96:97], v24 offset:0
    ds_read_b64_tr_b16 a[98:99], v24 offset:512
    v_max_u32 v4, v4, v5
    v_cmp_eq_u32 vcc, -1, v4
    v_mfma_f32_16x16x32_bf16 v[14:17], a[124:127], v[88:91], v[14:17]
    ds_read_b64_tr_b16 a[100:101], v25 offset:0
    ds_read_b64_tr_b16 a[102:103], v25 offset:512
    s_cbranch_vccnz Lre_4
Lck_4:
    s_waitcnt lgkmcnt(15)
    v_mfma_f32_16x16x32_bf16 v[108:111], a[0:3], v[92:95], v[108:111]
    ds_read_b64_tr_b16 a[104:105], v26 offset:0
    buffer_load_dwordx4 v[76:79], v13, s[28:31], s57 offen offset:0 sc1
    v_mfma_f32_16x16x32_bf16 v[112:115], a[4:7], v[92:95], v[112:115]
    ds_read_b64_tr_b16 a[106:107], v26 offset:512
    ds_read_b64_tr_b16 a[108:109], v27 offset:0
    v_mfma_f32_16x16x32_bf16 v[116:119], a[8:11], v[92:95], v[116:119]
    ds_read_b64_tr_b16 a[110:111], v27 offset:512
    buffer_load_dwordx4 v[80:83], v13, s[28:31], s57 offen offset:1024 sc1
    v_mfma_f32_16x16x32_bf16 v[14:17], a[12:15], v[92:95], v[14:17]
    ds_read_b64_tr_b16 a[112:113], v24 offset:4096
    ds_read_b64_tr_b16 a[114:115], v24 offset:4608
    v_mfma_f32_16x16x32_bf16 v[108:111], a[16:19], v[96:99], v[108:111]
    ds_read_b64_tr_b16 a[116:117], v25 offset:4096
    ds_read_b64_tr_b16 a[118:119], v25 offset:4608
    s_waitcnt vmcnt(6)
    v_max3_u32 v4, v100, v101, v102
    v_mfma_f32_16x16x32_bf16 v[112:115], a[20:23], v[96:99], v[112:115]
    ds_read_b64_tr_b16 a[120:121], v26 offset:4096
    v_max3_u32 v5, v104, v105, v106
    v_max3_u32 v4, v4, v103, v107
    v_mfma_f32_16x16x32_bf16 v[116:119], a[24:27], v[96:99], v[116:119]
    ds_read_b64_tr_b16 a[122:123], v26 offset:4608
    ds_read_b64_tr_b16 a[124:125], v27 offset:4096
    v_max_u32 v4, v4, v5
    v_cmp_eq_u32 vcc, -1, v4
    v_mfma_f32_16x16x32_bf16 v[14:17], a[28:31], v[96:99], v[14:17]
    ds_read_b64_tr_b16 a[126:127], v27 offset:4608
    s_cbranch_vccnz Lre_5
Lck_5:
    v_mfma_f32_16x16x32_bf16 v[108:111], a[32:35], v[100:103], v[108:111]
    ds_read_b64_tr_b16 a[0:1], v24 offset:8192
    ds_read_b64_tr_b16 a[2:3], v24 offset:8704
    buffer_load_dwordx4 v[84:87], v13, s[28:31], s57 offen offset:2048 sc1
    v_mfma_f32_16x16x32_bf16 v[112:115], a[36:39], v[100:103], v[112:115]
    ds_read_b64_tr_b16 a[4:5], v25 offset:8192
    ds_read_b64_tr_b16 a[6:7], v25 offset:8704
    v_mfma_f32_16x16x32_bf16 v[116:119], a[40:43], v[100:103], v[116:119]
    ds_read_b64_tr_b16 a[8:9], v26 offset:8192
    buffer_load_dwordx4 v[88:91], v13, s[28:31], s57 offen offset:3072 sc1
    v_mfma_f32_16x16x32_bf16 v[14:17], a[44:47], v[100:103], v[14:17]
    ds_read_b64_tr_b16 a[10:11], v26 offset:8704
    ds_read_b64_tr_b16 a[12:13], v27 offset:8192
    v_mfma_f32_16x16x32_bf16 v[108:111], a[48:51], v[104:107], v[108:111]
    ds_read_b64_tr_b16 a[14:15], v27 offset:8704
    s_waitcnt vmcnt(6)
    v_max3_u32 v4, v60, v61, v62
    v_mfma_f32_16x16x32_bf16 v[112:115], a[52:55], v[104:107], v[112:115]
    ds_read_b64_tr_b16 a[16:17], v24 offset:12288
    ds_read_b64_tr_b16 a[18:19], v24 offset:12800
    v_max3_u32 v5, v64, v65, v66
    v_max3_u32 v4, v4, v63, v67
    v_mfma_f32_16x16x32_bf16 v[116:119], a[56:59], v[104:107], v[116:119]
    ds_read_b64_tr_b16 a[20:21], v25 offset:12288
    ds_read_b64_tr_b16 a[22:23], v25 offset:12800
    v_max_u32 v4, v4, v5
    v_cmp_eq_u32 vcc, -1, v4
    v_mfma_f32_16x16x32_bf16 v[14:17], a[60:63], v[104:107], v[14:17]
    ds_read_b64_tr_b16 a[24:25], v26 offset:12288
    s_cbranch_vccnz Lre_6
Lck_6:
    s_setprio 1
    s_waitcnt lgkmcnt(15)
    v_mfma_f32_16x16x32_bf16 v[108:111], a[64:67], v[60:63], v[108:111]
    ds_read_b64_tr_b16 a[26:27], v26 offset:12800
    ds_read_b64_tr_b16 a[28:29], v27 offset:12288
    v_mfma_f32_16x16x32_bf16 v[112:115], a[68:71], v[60:63], v[112:115]
    ds_read_b64_tr_b16 a[30:31], v27 offset:12800
    v_mfma_f32_16x16x32_bf16 v[116:119], a[72:75], v[60:63], v[116:119]
    ds_read_b64_tr_b16 a[32:33], v20 offset:49152
    ds_read_b64_tr_b16 a[34:35], v20 offset:49664
    v_mfma_f32_16x16x32_bf16 v[14:17], a[76:79], v[60:63], v[14:17]
    ds_read_b64_tr_b16 a[36:37], v21 offset:49152
    ds_read_b64_tr_b16 a[38:39], v21 offset:49664
    v_mfma_f32_16x16x32_bf16 v[108:111], a[80:83], v[64:67], v[108:111]
    ds_read_b64_tr_b16 a[40:41], v22 offset:49152
    s_waitcnt vmcnt(4)
    v_max3_u32 v4, v68, v69, v70
    v_mfma_f32_16x16x32_bf16 v[112:115], a[84:87], v[64:67], v[112:115]
    ds_read_b64_tr_b16 a[42:43], v22 offset:49664
    ds_read_b64_tr_b16 a[44:45], v23 offset:49152
    v_max3_u32 v5, v72, v73, v74
    v_max3_u32 v4, v4, v71, v75
    v_mfma_f32_16x16x32_bf16 v[116:119], a[88:91], v[64:67], v[116:119]
    ds_read_b64_tr_b16 a[46:47], v23 offset:49664
    v_max_u32 v4, v4, v5
    v_cmp_eq_u32 vcc, -1, v4
    v_mfma_f32_16x16x32_bf16 v[14:17], a[92:95], v[64:67], v[14:17]
    ds_read_b64_tr_b16 a[48:49], v24 offset:24576
    ds_read_b64_tr_b16 a[50:51], v24 offset:25088
    s_cbranch_vccnz Lre_7
Lck_7:
    v_mfma_f32_16x16x32_bf16 v[108:111], a[96:99], v[68:71], v[108:111]
    ds_read_b64_tr_b16 a[52:53], v25 offset:24576
    ds_read_b64_tr_b16 a[54:55], v25 offset:25088
    v_mfma_f32_16x16x32_bf16 v[112:115], a[100:103], v[68:71], v[112:115]
    ds_read_b64_tr_b16 a[56:57], v26 offset:24576
    v_mfma_f32_16x16x32_bf16 v[116:119], a[104:107], v[68:71], v[116:119]
    ds_read_b64_tr_b16 a[58:59], v26 offset:25088
    ds_read_b64_tr_b16 a[60:61], v27 offset:24576
    v_mfma_f32_16x16x32_bf16 v[14:17], a[108:111], v[68:71], v[14:17]
    ds_read_b64_tr_b16 a[62:63], v27 offset:25088
    s_waitcnt lgkmcnt(15)
    v_mfma_f32_16x16x32_bf16 v[108:111], a[112:115], v[72:75], v[108:111]
    s_waitcnt vmcnt(2)
    v_max3_u32 v4, v76, v77, v78
    v_mfma_f32_16x16x32_bf16 v[112:115], a[116:119], v[72:75], v[112:115]
    v_max3_u32 v5, v80, v81, v82
    v_max3_u32 v4, v4, v79, v83
    v_mfma_f32_16x16x32_bf16 v[116:119], a[120:123], v[72:75], v[116:119]
    v_max_u32 v4, v4, v5
    v_cmp_eq_u32 vcc, -1, v4
    v_mfma_f32_16x16x32_bf16 v[14:17], a[124:127], v[72:75], v[14:17]
    s_cbranch_vccnz Lre_8
Lck_8:
    s_setprio 0
    v_mfma_f32_16x16x32_bf16 v[108:111], a[0:3], v[76:79], v[108:111]
    v_mfma_f32_16x16x32_bf16 v[112:115], a[4:7], v[76:79], v[112:115]
    v_mfma_f32_16x16x32_bf16 v[116:119], a[8:11], v[76:79], v[116:119]
    v_mfma_f32_16x16x32_bf16 v[14:17], a[12:15], v[76:79], v[14:17]
    v_mfma_f32_16x16x32_bf16 v[108:111], a[16:19], v[80:83], v[108:111]
    s_waitcnt vmcnt(0)
    v_max3_u32 v4, v84, v85, v86
    v_mfma_f32_16x16x32_bf16 v[112:115], a[20:23], v[80:83], v[112:115]
    v_max3_u32 v5, v88, v89, v90
    v_max3_u32 v4, v4, v87, v91
    v_mfma_f32_16x16x32_bf16 v[116:119], a[24:27], v[80:83], v[116:119]
    v_max_u32 v4, v4, v5
    v_cmp_eq_u32 vcc, -1, v4
    v_mfma_f32_16x16x32_bf16 v[14:17], a[28:31], v[80:83], v[14:17]
    s_cbranch_vccnz Lre_9
Lck_9:
    s_waitcnt lgkmcnt(8)
    v_mfma_f32_16x16x32_bf16 v[108:111], a[32:35], v[84:87], v[108:111]
    v_mfma_f32_16x16x32_bf16 v[112:115], a[36:39], v[84:87], v[112:115]
    v_mfma_f32_16x16x32_bf16 v[116:119], a[40:43], v[84:87], v[116:119]
    v_mfma_f32_16x16x32_bf16 v[14:17], a[44:47], v[84:87], v[14:17]
    s_waitcnt lgkmcnt(0)
    v_mfma_f32_16x16x32_bf16 v[108:111], a[48:51], v[88:91], v[108:111]
    v_mfma_f32_16x16x32_bf16 v[112:115], a[52:55], v[88:91], v[112:115]
    v_mfma_f32_16x16x32_bf16 v[116:119], a[56:59], v[88:91], v[116:119]
    v_mfma_f32_16x16x32_bf16 v[14:17], a[60:63], v[88:91], v[14:17]
    v_xor_b32 v60, 32, v124
    v_xor_b32 v61, 64, v124
    v_xor_b32 v62, 96, v124
    v_cmp_eq_u32 s[36:37], v8, v126
    v_cmp_eq_u32 s[38:39], v9, v126
    s_nop 0
    s_or_b64 vcc, s[36:37], s[38:39]
    s_cbranch_scc1 Lfix
Lnofix:
    v_fma_f32 v108, v108, v44, v28
    v_fma_f32 v109, v109, v45, v29
    v_fma_f32 v110, v110, v46, v30
    v_fma_f32 v111, v111, v47, v31
    v_cvt_pk_bf16_f32 v68, v108, v109
    v_cvt_pk_bf16_f32 v69, v110, v111
    ds_write_b64 v124, v[68:69]
    v_fma_f32 v112, v112, v48, v32
    v_fma_f32 v113, v113, v49, v33
    v_fma_f32 v114, v114, v50, v34
    v_fma_f32 v115, v115, v51, v35
    v_cvt_pk_bf16_f32 v70, v112, v113
    v_cvt_pk_bf16_f32 v71, v114, v115
    ds_write_b64 v60, v[70:71]
    v_fma_f32 v116, v116, v52, v36
    v_fma_f32 v117, v117, v53, v37
    v_fma_f32 v118, v118, v54, v38
    v_fma_f32 v119, v119, v55, v39
    v_cvt_pk_bf16_f32 v72, v116, v117
    v_cvt_pk_bf16_f32 v73, v118, v119
    ds_write_b64 v61, v[72:73]
    v_fma_f32 v14, v14, v56, v40
    v_fma_f32 v15, v15, v57, v41
    v_fma_f32 v16, v16, v58, v42
    v_fma_f32 v17, v17, v59, v43
    v_cvt_pk_bf16_f32 v74, v14, v15
    v_cvt_pk_bf16_f32 v75, v16, v17
    ds_write_b64 v62, v[74:75]
    ds_read_b128 v[76:79], v125 offset:0
    ds_read_b128 v[80:83], v125 offset:1024
    s_waitcnt lgkmcnt(1)
    buffer_store_dwordx4 v[76:79], v122, s[48:51], s24 offen sc0 sc1
    s_waitcnt lgkmcnt(0)
    buffer_store_dwordx4 v[80:83], v123, s[48:51], s24 offen sc0 sc1
    s_endpgm
Lh1:
    ds_write_b128 v125, v[44:47] offset:0
    ds_write_b128 v125, v[48:51] offset:1024
    v_mov_b32 v5, 157972
    v_mov_b32 v6, 1
    s_mov_b64 exec, 1
    ds_add_u32 v5, v6
    s_mov_b64 exec, -1
    v_fmac_f32 v28, v76, v120
    v_fmac_f32 v29, v77, v120
    v_fmac_f32 v30, v78, v120
    v_fmac_f32 v31, v79, v120
    v_cvt_pk_bf16_f32 v28, v28, v29
    v_cvt_pk_bf16_f32 v29, v30, v31
    v_fmac_f32 v32, v80, v120
    v_fmac_f32 v33, v81, v120
    v_fmac_f32 v34, v82, v120
    v_fmac_f32 v35, v83, v120
    v_cvt_pk_bf16_f32 v30, v32, v33
    v_cvt_pk_bf16_f32 v31, v34, v35
    v_fmac_f32 v36, v84, v120
    v_fmac_f32 v37, v85, v120
    v_fmac_f32 v38, v86, v120
    v_fmac_f32 v39, v87, v120
    v_cvt_pk_bf16_f32 v32, v36, v37
    v_cvt_pk_bf16_f32 v33, v38, v39
    v_fmac_f32 v40, v88, v120
    v_fmac_f32 v41, v89, v120
    v_fmac_f32 v42, v90, v120
    v_fmac_f32 v43, v91, v120
    v_cvt_pk_bf16_f32 v34, v40, v41
    v_cvt_pk_bf16_f32 v35, v42, v43
    v_subrev_u32 v4, 6144, v125
    v_mov_b32 v8, s22
    v_mov_b32 v9, s22
    v_mov_b32 v10, s22
    v_mov_b32 v11, s22
Lcw_2:
    s_sub_u32 s35, s35, 1
    s_cbranch_scc1 Lend
    ds_read_b32 v6, v5
    s_waitcnt lgkmcnt(0)
    v_readfirstlane_b32 s38, v6
    s_nop 0
    s_cmp_lt_u32 s38, 8
    s_cbranch_scc1 Lcw_2
    ds_read_b128 v[52:55], v125 offset:2048
    ds_read_b128 v[56:59], v125 offset:3072
    ds_read_b128 v[44:47], v4 offset:4096
    ds_read_b128 v[48:51], v4 offset:5120
    s_branch Lh_join
Lqf_re:
    s_sub_u32 s35, s35, 1
    s_cbranch_scc1 Lend
    ds_read_b32 v7, v96
    ds_read_b128 v[76:79], v95 offset:0
    ds_read_b128 v[80:83], v95 offset:64
    ds_read_b128 v[84:87], v95 offset:128
    ds_read_b128 v[88:91], v95 offset:192
    s_waitcnt lgkmcnt(0)
    s_branch Lqf
Lcsv_re:
    s_sub_u32 s35, s35, 1
    s_cbranch_scc1 Lend
    ds_read_b32 v46, v49
    ds_read_b64 v[44:45], v48
    s_waitcnt lgkmcnt(0)
    s_branch Lcsv
Lrx_re:
    s_sub_u32 s35, s35, 1
    s_cbranch_scc1 Lend
    buffer_load_dwordx2 v[52:53], v13, s[28:31], s59 offen offset:8 sc1
    buffer_load_dwordx2 v[54:55], v13, s[28:31], s60 offen offset:0 sc1
    s_waitcnt vmcnt(0)
    s_branch Lrx_chk
Linfo_re:
    s_sub_u32 s35, s35, 1
    s_cbranch_scc1 Lend
    ds_read_b64 v[8:9], v10
    s_waitcnt lgkmcnt(0)
    s_branch Linfo
Lfl_re:
    s_sub_u32 s35, s35, 1
    s_cbranch_scc1 Lend
    buffer_load_dword v20, v12, s[28:31], s24 offen sc1
    s_waitcnt vmcnt(0)
    s_branch Lfl_chk
Lxe0:
    ds_read_b64 v[108:109], v4
    ds_read_b64 v[110:111], v5
    ds_read_b64 v[112:113], v6
    ds_read_b64 v[114:115], v7
    s_branch Lxe0_b
Lxe1:
    ds_read_b64 v[108:109], v4
    ds_read_b64 v[110:111], v5
    ds_read_b64 v[112:113], v6
    ds_read_b64 v[114:115], v7
    s_branch Lxe1_b
Lxe2:
    ds_read_b64 v[108:109], v4
    ds_read_b64 v[110:111], v5
    ds_read_b64 v[112:113], v6
    ds_read_b64 v[114:115], v7
    s_branch Lxe2_b
Lxe3:
    ds_read_b64 v[108:109], v4
    ds_read_b64 v[110:111], v5
    ds_read_b64 v[112:113], v6
    ds_read_b64 v[114:115], v7
    s_branch Lxe3_b
Lxe4:
    ds_read_b64 v[108:109], v4
    ds_read_b64 v[110:111], v5
    ds_read_b64 v[112:113], v6
    ds_read_b64 v[114:115], v7
    s_branch Lxe4_b
Lxe5:
    ds_read_b64 v[108:109], v4
    ds_read_b64 v[110:111], v5
    ds_read_b64 v[112:113], v6
    ds_read_b64 v[114:115], v7
    s_branch Lxe5_b
Lxe6:
    ds_read_b64 v[108:109], v4
    ds_read_b64 v[110:111], v5
    ds_read_b64 v[112:113], v6
    ds_read_b64 v[114:115], v7
    s_branch Lxe6_b
Lxe7:
    ds_read_b64 v[108:109], v4
    ds_read_b64 v[110:111], v5
    ds_read_b64 v[112:113], v6
    ds_read_b64 v[114:115], v7
    s_branch Lxe7_b
Lxe8:
    ds_read_b64 v[108:109], v4
    ds_read_b64 v[110:111], v5
    ds_read_b64 v[112:113], v6
    ds_read_b64 v[114:115], v7
    s_branch Lxe8_b
Lxe9:
    ds_read_b64 v[108:109], v4
    ds_read_b64 v[110:111], v5
    ds_read_b64 v[112:113], v6
    ds_read_b64 v[114:115], v7
    s_branch Lxe9_b
Lre_0:
    s_mov_b32 s41, 1
    s_sub_u32 s35, s35, 1
    s_cbranch_scc1 Lend
    s_sleep 2
    buffer_load_dwordx4 v[60:63], v13, s[28:31], s53 offen offset:0 sc1
    buffer_load_dwordx4 v[64:67], v13, s[28:31], s53 offen offset:1024 sc1
    s_waitcnt vmcnt(0)
    v_max3_u32 v4, v60, v61, v62
    v_max3_u32 v5, v64, v65, v66
    v_max3_u32 v4, v4, v63, v67
    v_max_u32 v4, v4, v5
    v_cmp_eq_u32 vcc, -1, v4
    s_nop 0
    s_cbranch_vccnz Lre_0
    buffer_load_dwordx4 v[68:71], v13, s[28:31], s53 offen offset:2048 sc1
    buffer_load_dwordx4 v[72:75], v13, s[28:31], s53 offen offset:3072 sc1
    buffer_load_dwordx4 v[76:79], v13, s[28:31], s54 offen offset:0 sc1
    buffer_load_dwordx4 v[80:83], v13, s[28:31], s54 offen offset:1024 sc1
    buffer_load_dwordx4 v[84:87], v13, s[28:31], s54 offen offset:2048 sc1
    buffer_load_dwordx4 v[88:91], v13, s[28:31], s54 offen offset:3072 sc1
    s_branch Lck_0
Lre_1:
    s_mov_b32 s41, 1
    s_sub_u32 s35, s35, 1
    s_cbranch_scc1 Lend
    s_sleep 2
    buffer_load_dwordx4 v[68:71], v13, s[28:31], s53 offen offset:2048 sc1
    buffer_load_dwordx4 v[72:75], v13, s[28:31], s53 offen offset:3072 sc1
    s_waitcnt vmcnt(0)
    v_max3_u32 v4, v68, v69, v70
    v_max3_u32 v5, v72, v73, v74
    v_max3_u32 v4, v4, v71, v75
    v_max_u32 v4, v4, v5
    v_cmp_eq_u32 vcc, -1, v4
    s_nop 0
    s_cbranch_vccnz Lre_1
    buffer_load_dwordx4 v[76:79], v13, s[28:31], s54 offen offset:0 sc1
    buffer_load_dwordx4 v[80:83], v13, s[28:31], s54 offen offset:1024 sc1
    buffer_load_dwordx4 v[84:87], v13, s[28:31], s54 offen offset:2048 sc1
    buffer_load_dwordx4 v[88:91], v13, s[28:31], s54 offen offset:3072 sc1
    buffer_load_dwordx4 v[92:95], v13, s[28:31], s55 offen offset:0 sc1
    buffer_load_dwordx4 v[96:99], v13, s[28:31], s55 offen offset:1024 sc1
    s_branch Lck_1
Lre_2:
    s_mov_b32 s41, 1
    s_sub_u32 s35, s35, 1
    s_cbranch_scc1 Lend
    s_sleep 2
    buffer_load_dwordx4 v[76:79], v13, s[28:31], s54 offen offset:0 sc1
    buffer_load_dwordx4 v[80:83], v13, s[28:31], s54 offen offset:1024 sc1
    s_waitcnt vmcnt(0)
    v_max3_u32 v4, v76, v77, v78
    v_max3_u32 v5, v80, v81, v82
    v_max3_u32 v4, v4, v79, v83
    v_max_u32 v4, v4, v5
    v_cmp_eq_u32 vcc, -1, v4
    s_nop 0
    s_cbranch_vccnz Lre_2
    buffer_load_dwordx4 v[84:87], v13, s[28:31], s54 offen offset:2048 sc1
    buffer_load_dwordx4 v[88:91], v13, s[28:31], s54 offen offset:3072 sc1
    buffer_load_dwordx4 v[92:95], v13, s[28:31], s55 offen offset:0 sc1
    buffer_load_dwordx4 v[96:99], v13, s[28:31], s55 offen offset:1024 sc1
    buffer_load_dwordx4 v[100:103], v13, s[28:31], s55 offen offset:2048 sc1
    buffer_load_dwordx4 v[104:107], v13, s[28:31], s55 offen offset:3072 sc1
    s_branch Lck_2
Lre_3:
    s_mov_b32 s41, 1
    s_sub_u32 s35, s35, 1
    s_cbranch_scc1 Lend
    s_sleep 2
    buffer_load_dwordx4 v[84:87], v13, s[28:31], s54 offen offset:2048 sc1
    buffer_load_dwordx4 v[88:91], v13, s[28:31], s54 offen offset:3072 sc1
    s_waitcnt vmcnt(0)
    v_max3_u32 v4, v84, v85, v86
    v_max3_u32 v5, v88, v89, v90
    v_max3_u32 v4, v4, v87, v91
    v_max_u32 v4, v4, v5
    v_cmp_eq_u32 vcc, -1, v4
    s_nop 0
    s_cbranch_vccnz Lre_3
    buffer_load_dwordx4 v[92:95], v13, s[28:31], s55 offen offset:0 sc1
    buffer_load_dwordx4 v[96:99], v13, s[28:31], s55 offen offset:1024 sc1
    buffer_load_dwordx4 v[100:103], v13, s[28:31], s55 offen offset:2048 sc1
    buffer_load_dwordx4 v[104:107], v13, s[28:31], s55 offen offset:3072 sc1
    buffer_load_dwordx4 v[60:63], v13, s[28:31], s56 offen offset:0 sc1
    buffer_load_dwordx4 v[64:67], v13, s[28:31], s56 offen offset:1024 sc1
    s_branch Lck_3
Lre_4:
    s_mov_b32 s41, 1
    s_sub_u32 s35, s35, 1
    s_cbranch_scc1 Lend
    s_sleep 2
    buffer_load_dwordx4 v[92:95], v13, s[28:31], s55 offen offset:0 sc1
    buffer_load_dwordx4 v[96:99], v13, s[28:31], s55 offen offset:1024 sc1
    s_waitcnt vmcnt(0)
    v_max3_u32 v4, v92, v93, v94
    v_max3_u32 v5, v96, v97, v98
    v_max3_u32 v4, v4, v95, v99
    v_max_u32 v4, v4, v5
    v_cmp_eq_u32 vcc, -1, v4
    s_nop 0
    s_cbranch_vccnz Lre_4
    buffer_load_dwordx4 v[100:103], v13, s[28:31], s55 offen offset:2048 sc1
    buffer_load_dwordx4 v[104:107], v13, s[28:31], s55 offen offset:3072 sc1
    buffer_load_dwordx4 v[60:63], v13, s[28:31], s56 offen offset:0 sc1
    buffer_load_dwordx4 v[64:67], v13, s[28:31], s56 offen offset:1024 sc1
    buffer_load_dwordx4 v[68:71], v13, s[28:31], s56 offen offset:2048 sc1
    buffer_load_dwordx4 v[72:75], v13, s[28:31], s56 offen offset:3072 sc1
    s_branch Lck_4
Lre_5:
    s_mov_b32 s41, 1
    s_sub_u32 s35, s35, 1
    s_cbranch_scc1 Lend
    s_sleep 2
    buffer_load_dwordx4 v[100:103], v13, s[28:31], s55 offen offset:2048 sc1
    buffer_load_dwordx4 v[104:107], v13, s[28:31], s55 offen offset:3072 sc1
    s_waitcnt vmcnt(0)
    v_max3_u32 v4, v100, v101, v102
    v_max3_u32 v5, v104, v105, v106
    v_max3_u32 v4, v4, v103, v107
    v_max_u32 v4, v4, v5
    v_cmp_eq_u32 vcc, -1, v4
    s_nop 0
    s_cbranch_vccnz Lre_5
    buffer_load_dwordx4 v[60:63], v13, s[28:31], s56 offen offset:0 sc1
    buffer_load_dwordx4 v[64:67], v13, s[28:31], s56 offen offset:1024 sc1
    buffer_load_dwordx4 v[68:71], v13, s[28:31], s56 offen offset:2048 sc1
    buffer_load_dwordx4 v[72:75], v13, s[28:31], s56 offen offset:3072 sc1
    buffer_load_dwordx4 v[76:79], v13, s[28:31], s57 offen offset:0 sc1
    buffer_load_dwordx4 v[80:83], v13, s[28:31], s57 offen offset:1024 sc1
    s_branch Lck_5
Lre_6:
    s_mov_b32 s41, 1
    s_sub_u32 s35, s35, 1
    s_cbranch_scc1 Lend
    s_sleep 2
    buffer_load_dwordx4 v[60:63], v13, s[28:31], s56 offen offset:0 sc1
    buffer_load_dwordx4 v[64:67], v13, s[28:31], s56 offen offset:1024 sc1
    s_waitcnt vmcnt(0)
    v_max3_u32 v4, v60, v61, v62
    v_max3_u32 v5, v64, v65, v66
    v_max3_u32 v4, v4, v63, v67
    v_max_u32 v4, v4, v5
    v_cmp_eq_u32 vcc, -1, v4
    s_nop 0
    s_cbranch_vccnz Lre_6
    buffer_load_dwordx4 v[68:71], v13, s[28:31], s56 offen offset:2048 sc1
    buffer_load_dwordx4 v[72:75], v13, s[28:31], s56 offen offset:3072 sc1
    buffer_load_dwordx4 v[76:79], v13, s[28:31], s57 offen offset:0 sc1
    buffer_load_dwordx4 v[80:83], v13, s[28:31], s57 offen offset:1024 sc1
    buffer_load_dwordx4 v[84:87], v13, s[28:31], s57 offen offset:2048 sc1
    buffer_load_dwordx4 v[88:91], v13, s[28:31], s57 offen offset:3072 sc1
    s_branch Lck_6
Lre_7:
    s_mov_b32 s41, 1
    s_sub_u32 s35, s35, 1
    s_cbranch_scc1 Lend
    s_sleep 2
    buffer_load_dwordx4 v[68:71], v13, s[28:31], s56 offen offset:2048 sc1
    buffer_load_dwordx4 v[72:75], v13, s[28:31], s56 offen offset:3072 sc1
    s_waitcnt vmcnt(0)
    v_max3_u32 v4, v68, v69, v70
    v_max3_u32 v5, v72, v73, v74
    v_max3_u32 v4, v4, v71, v75
    v_max_u32 v4, v4, v5
    v_cmp_eq_u32 vcc, -1, v4
    s_nop 0
    s_cbranch_vccnz Lre_7
    buffer_load_dwordx4 v[76:79], v13, s[28:31], s57 offen offset:0 sc1
    buffer_load_dwordx4 v[80:83], v13, s[28:31], s57 offen offset:1024 sc1
    buffer_load_dwordx4 v[84:87], v13, s[28:31], s57 offen offset:2048 sc1
    buffer_load_dwordx4 v[88:91], v13, s[28:31], s57 offen offset:3072 sc1
    s_branch Lck_7
Lre_8:
    s_mov_b32 s41, 1
    s_sub_u32 s35, s35, 1
    s_cbranch_scc1 Lend
    s_sleep 2
    buffer_load_dwordx4 v[76:79], v13, s[28:31], s57 offen offset:0 sc1
    buffer_load_dwordx4 v[80:83], v13, s[28:31], s57 offen offset:1024 sc1
    s_waitcnt vmcnt(0)
    v_max3_u32 v4, v76, v77, v78
    v_max3_u32 v5, v80, v81, v82
    v_max3_u32 v4, v4, v79, v83
    v_max_u32 v4, v4, v5
    v_cmp_eq_u32 vcc, -1, v4
    s_nop 0
    s_cbranch_vccnz Lre_8
    buffer_load_dwordx4 v[84:87], v13, s[28:31], s57 offen offset:2048 sc1
    buffer_load_dwordx4 v[88:91], v13, s[28:31], s57 offen offset:3072 sc1
    s_branch Lck_8
Lre_9:
    s_mov_b32 s41, 1
    s_sub_u32 s35, s35, 1
    s_cbranch_scc1 Lend
    s_sleep 2
    buffer_load_dwordx4 v[84:87], v13, s[28:31], s57 offen offset:2048 sc1
    buffer_load_dwordx4 v[88:91], v13, s[28:31], s57 offen offset:3072 sc1
    s_waitcnt vmcnt(0)
    v_max3_u32 v4, v84, v85, v86
    v_max3_u32 v5, v88, v89, v90
    v_max3_u32 v4, v4, v87, v91
    v_max_u32 v4, v4, v5
    v_cmp_eq_u32 vcc, -1, v4
    s_nop 0
    s_cbranch_vccnz Lre_9
    s_branch Lck_9
Lfix:
    s_mov_b64 vcc, s[38:39]
    v_lshlrev_b32 v6, 4, v2
    v_add_u32 v6, 158208, v6
    v_mov_b32 v10, 157956
Lcw_5:
    s_sub_u32 s35, s35, 1
    s_cbranch_scc1 Lend
    ds_read_b32 v11, v10
    s_waitcnt lgkmcnt(0)
    v_readfirstlane_b32 s38, v11
    s_nop 0
    s_cmp_lt_u32 s38, 1
    s_cbranch_scc1 Lcw_5
    s_mov_b64 exec, s[36:37]
    ds_read_b128 v[44:47], v6 offset:0
    ds_read_b128 v[48:51], v6 offset:64
    ds_read_b128 v[52:55], v6 offset:128
    ds_read_b128 v[56:59], v6 offset:192
    s_mov_b64 exec, vcc
    ds_read_b128 v[44:47], v6 offset:256
    ds_read_b128 v[48:51], v6 offset:320
    ds_read_b128 v[52:55], v6 offset:384
    ds_read_b128 v[56:59], v6 offset:448
    s_mov_b64 exec, -1
    s_waitcnt lgkmcnt(0)
    s_branch Lnofix
Lhalo:
    s_mov_b32 vcc_lo, 0x00010001
    s_mov_b32 vcc_hi, 0x00010001
    v_mov_b32 v11, 38912
    v_cndmask_b32 v76, v76, v11, vcc
    v_xor_b32 v77, 64, v76
    v_add_u32 v80, 78080, v76
    v_add_u32 v81, 78080, v77
    v_mov_b32 v14, 0x3f803f80
    v_mov_b32 v15, 0x3f803f80
    v_mov_b32 v16, 0x3f803f80
    v_mov_b32 v17, 0x3f803f80
    v_and_b32 v4, 7, v1
    v_lshlrev_b32 v4, 4, v4
    v_mul_u32_u24 v5, 39040, v2
    v_add_u32 v4, v4, v5
    ds_write_b128 v4, v[14:17] offset:38912
    v_mov_b32 v4, 157952
    v_mov_b32 v8, 0
    v_mov_b32 v9, 0
    v_mov_b32 v10, -2
    v_mov_b32 v11, -2
    ds_write_b128 v4, v[8:11]
    v_min_u32 v5, 23, v1
    v_lshl_add_u32 v5, v5, 2, v4
    ds_write_b32 v5, v8 offset:16
    s_mul_i32 s36, s32, 96
    s_sub_u32 s36, s36, 16
    v_add_u32 v96, s36, v1
    v_min_u32 v5, 47, v1
    v_add3_u32 v97, s36, v5, 64
    v_mov_b32 v6, 2047
    v_med3_i32 v96, v96, 0, v6
    v_med3_i32 v97, v97, 0, v6
    v_lshlrev_b32 v96, 3, v96
    v_lshlrev_b32 v97, 3, v97
    s_mov_b32 s46, 8192000
    v_mov_b32 v127, 157984
    s_lshl_b32 s36, s3, 2
    s_add_u32 s36, s36, 158016
    v_mov_b32 v10, s36
    s_mov_b32 vcc_lo, 0x00010001
    s_mov_b32 vcc_hi, 0x00010001
    v_cndmask_b32 v116, 0, v14, vcc
    v_cndmask_b32 v117, 0, v15, vcc
    v_cndmask_b32 v118, 0, v16, vcc
    v_cndmask_b32 v119, 0, v17, vcc
    s_waitcnt vmcnt(0)
    s_waitcnt lgkmcnt(0)
    s_barrier
    s_add_u32 s34, s34, 0x9e3779b8
    s_or_b32 s34, s34, 1
    ds_read_b128 v[108:111], v76 offset:0
    ds_read_b128 v[112:115], v77 offset:0
    ds_read_b64_tr_b16 a[0:1], v20 offset:0
    ds_read_b64_tr_b16 a[2:3], v20 offset:512
    ds_read_b64_tr_b16 a[4:5], v21 offset:0
    ds_read_b64_tr_b16 a[6:7], v21 offset:512
    ds_read_b64_tr_b16 a[8:9], v22 offset:0
    ds_read_b64_tr_b16 a[10:11], v22 offset:512
    ds_read_b64_tr_b16 a[12:13], v23 offset:0
    ds_read_b64_tr_b16 a[14:15], v23 offset:512
    ds_read_b64_tr_b16 a[16:17], v20 offset:8192
    ds_read_b64_tr_b16 a[18:19], v20 offset:8704
    ds_read_b64_tr_b16 a[20:21], v21 offset:8192
    ds_read_b64_tr_b16 a[22:23], v21 offset:8704
    ds_read_b64_tr_b16 a[24:25], v22 offset:8192
    ds_read_b64_tr_b16 a[26:27], v22 offset:8704
    s_waitcnt lgkmcnt(12)
    v_mfma_f32_16x16x32_bf16 v[28:31], a[0:3], v[116:119], 0
    ds_read_b64_tr_b16 a[28:29], v23 offset:8192
    ds_read_b64_tr_b16 a[30:31], v23 offset:8704
    s_waitcnt lgkmcnt(12)
    v_mfma_f32_16x16x32_bf16 v[32:35], a[4:7], v[116:119], 0
    ds_read_b64_tr_b16 a[32:33], v20 offset:16384
    ds_read_b64_tr_b16 a[34:35], v20 offset:16896
    s_waitcnt lgkmcnt(12)
    v_mfma_f32_16x16x32_bf16 v[36:39], a[8:11], v[116:119], 0
    ds_read_b64_tr_b16 a[36:37], v21 offset:16384
    ds_read_b64_tr_b16 a[38:39], v21 offset:16896
    s_waitcnt lgkmcnt(12)
    v_mfma_f32_16x16x32_bf16 v[40:43], a[12:15], v[116:119], 0
    ds_read_b64_tr_b16 a[40:41], v22 offset:16384
    ds_read_b64_tr_b16 a[42:43], v22 offset:16896
    s_waitcnt lgkmcnt(12)
    v_mfma_f32_16x16x32_bf16 v[44:47], a[16:19], v[108:111], 0
    ds_read_b64_tr_b16 a[44:45], v23 offset:16384
    ds_read_b64_tr_b16 a[46:47], v23 offset:16896
    s_waitcnt lgkmcnt(12)
    v_mfma_f32_16x16x32_bf16 v[48:51], a[20:23], v[108:111], 0
    ds_read_b64_tr_b16 a[48:49], v20 offset:4096
    ds_read_b64_tr_b16 a[50:51], v20 offset:4608
    s_waitcnt lgkmcnt(12)
    v_mfma_f32_16x16x32_bf16 v[52:55], a[24:27], v[108:111], 0
    ds_read_b64_tr_b16 a[52:53], v21 offset:4096
    ds_read_b64_tr_b16 a[54:55], v21 offset:4608
    s_waitcnt lgkmcnt(12)
    v_mfma_f32_16x16x32_bf16 v[56:59], a[28:31], v[108:111], 0
    ds_read_b64_tr_b16 a[56:57], v22 offset:4096
    ds_read_b64_tr_b16 a[58:59], v22 offset:4608
    s_waitcnt lgkmcnt(12)
    v_mfma_f32_16x16x32_bf16 v[60:63], v[108:111], a[32:35], 0
    ds_read_b64_tr_b16 a[60:61], v23 offset:4096
    ds_read_b64_tr_b16 a[62:63], v23 offset:4608
    s_waitcnt lgkmcnt(12)
    v_mfma_f32_16x16x32_bf16 v[64:67], v[108:111], a[36:39], 0
    ds_read_b64_tr_b16 a[64:65], v20 offset:12288
    ds_read_b64_tr_b16 a[66:67], v20 offset:12800
    s_waitcnt lgkmcnt(12)
    v_mfma_f32_16x16x32_bf16 v[68:71], v[108:111], a[40:43], 0
    ds_read_b64_tr_b16 a[68:69], v21 offset:12288
    ds_read_b64_tr_b16 a[70:71], v21 offset:12800
    s_waitcnt lgkmcnt(12)
    v_mfma_f32_16x16x32_bf16 v[72:75], v[108:111], a[44:47], 0
    ds_read_b64_tr_b16 a[72:73], v22 offset:12288
    ds_read_b64_tr_b16 a[74:75], v22 offset:12800
    s_waitcnt lgkmcnt(12)
    v_mfma_f32_16x16x32_bf16 v[28:31], a[48:51], v[116:119], v[28:31]
    ds_read_b64_tr_b16 a[76:77], v23 offset:12288
    ds_read_b64_tr_b16 a[78:79], v23 offset:12800
    s_waitcnt lgkmcnt(12)
    v_mfma_f32_16x16x32_bf16 v[32:35], a[52:55], v[116:119], v[32:35]
    ds_read_b64_tr_b16 a[80:81], v20 offset:20480
    ds_read_b64_tr_b16 a[82:83], v20 offset:20992
    s_waitcnt lgkmcnt(12)
    v_mfma_f32_16x16x32_bf16 v[36:39], a[56:59], v[116:119], v[36:39]
    ds_read_b64_tr_b16 a[84:85], v21 offset:20480
    ds_read_b64_tr_b16 a[86:87], v21 offset:20992
    s_waitcnt lgkmcnt(12)
    v_mfma_f32_16x16x32_bf16 v[40:43], a[60:63], v[116:119], v[40:43]
    ds_read_b64_tr_b16 a[88:89], v22 offset:20480
    ds_read_b64_tr_b16 a[90:91], v22 offset:20992
    s_waitcnt lgkmcnt(12)
    v_mfma_f32_16x16x32_bf16 v[44:47], a[64:67], v[112:115], v[44:47]
    ds_read_b64_tr_b16 a[92:93], v23 offset:20480
    ds_read_b64_tr_b16 a[94:95], v23 offset:20992
    s_waitcnt lgkmcnt(12)
    v_mfma_f32_16x16x32_bf16 v[48:51], a[68:71], v[112:115], v[48:51]
    s_waitcnt lgkmcnt(10)
    v_mfma_f32_16x16x32_bf16 v[52:55], a[72:75], v[112:115], v[52:55]
    s_waitcnt lgkmcnt(8)
    v_mfma_f32_16x16x32_bf16 v[56:59], a[76:79], v[112:115], v[56:59]
    s_waitcnt lgkmcnt(6)
    v_mfma_f32_16x16x32_bf16 v[60:63], v[112:115], a[80:83], v[60:63]
    s_waitcnt lgkmcnt(4)
    v_mfma_f32_16x16x32_bf16 v[64:67], v[112:115], a[84:87], v[64:67]
    s_waitcnt lgkmcnt(2)
    v_mfma_f32_16x16x32_bf16 v[68:71], v[112:115], a[88:91], v[68:71]
    s_waitcnt lgkmcnt(0)
    v_mfma_f32_16x16x32_bf16 v[72:75], v[112:115], a[92:95], v[72:75]
    s_barrier
    ds_read_b128 v[108:111], v76 offset:39040
    ds_read_b128 v[112:115], v77 offset:39040
    ds_read_b64_tr_b16 a[0:1], v20 offset:39040
    ds_read_b64_tr_b16 a[2:3], v20 offset:39552
    ds_read_b64_tr_b16 a[4:5], v21 offset:39040
    ds_read_b64_tr_b16 a[6:7], v21 offset:39552
    ds_read_b64_tr_b16 a[8:9], v22 offset:39040
    ds_read_b64_tr_b16 a[10:11], v22 offset:39552
    ds_read_b64_tr_b16 a[12:13], v23 offset:39040
    ds_read_b64_tr_b16 a[14:15], v23 offset:39552
    ds_read_b64_tr_b16 a[16:17], v20 offset:47232
    ds_read_b64_tr_b16 a[18:19], v20 offset:47744
    ds_read_b64_tr_b16 a[20:21], v21 offset:47232
    ds_read_b64_tr_b16 a[22:23], v21 offset:47744
    ds_read_b64_tr_b16 a[24:25], v22 offset:47232
    ds_read_b64_tr_b16 a[26:27], v22 offset:47744
    s_waitcnt lgkmcnt(12)
    v_mfma_f32_16x16x32_bf16 v[28:31], a[0:3], v[116:119], v[28:31]
    ds_read_b64_tr_b16 a[28:29], v23 offset:47232
    ds_read_b64_tr_b16 a[30:31], v23 offset:47744
    s_waitcnt lgkmcnt(12)
    v_mfma_f32_16x16x32_bf16 v[32:35], a[4:7], v[116:119], v[32:35]
    ds_read_b64_tr_b16 a[32:33], v20 offset:55424
    ds_read_b64_tr_b16 a[34:35], v20 offset:55936
    s_waitcnt lgkmcnt(12)
    v_mfma_f32_16x16x32_bf16 v[36:39], a[8:11], v[116:119], v[36:39]
    ds_read_b64_tr_b16 a[36:37], v21 offset:55424
    ds_read_b64_tr_b16 a[38:39], v21 offset:55936
    s_waitcnt lgkmcnt(12)
    v_mfma_f32_16x16x32_bf16 v[40:43], a[12:15], v[116:119], v[40:43]
    ds_read_b64_tr_b16 a[40:41], v22 offset:55424
    ds_read_b64_tr_b16 a[42:43], v22 offset:55936
    s_waitcnt lgkmcnt(12)
    v_mfma_f32_16x16x32_bf16 v[44:47], a[16:19], v[108:111], v[44:47]
    ds_read_b64_tr_b16 a[44:45], v23 offset:55424
    ds_read_b64_tr_b16 a[46:47], v23 offset:55936
    s_waitcnt lgkmcnt(12)
    v_mfma_f32_16x16x32_bf16 v[48:51], a[20:23], v[108:111], v[48:51]
    ds_read_b64_tr_b16 a[48:49], v20 offset:43136
    ds_read_b64_tr_b16 a[50:51], v20 offset:43648
    s_waitcnt lgkmcnt(12)
    v_mfma_f32_16x16x32_bf16 v[52:55], a[24:27], v[108:111], v[52:55]
    ds_read_b64_tr_b16 a[52:53], v21 offset:43136
    ds_read_b64_tr_b16 a[54:55], v21 offset:43648
    s_waitcnt lgkmcnt(12)
    v_mfma_f32_16x16x32_bf16 v[56:59], a[28:31], v[108:111], v[56:59]
    ds_read_b64_tr_b16 a[56:57], v22 offset:43136
    ds_read_b64_tr_b16 a[58:59], v22 offset:43648
    s_waitcnt lgkmcnt(12)
    v_mfma_f32_16x16x32_bf16 v[60:63], v[108:111], a[32:35], v[60:63]
    ds_read_b64_tr_b16 a[60:61], v23 offset:43136
    ds_read_b64_tr_b16 a[62:63], v23 offset:43648
    s_waitcnt lgkmcnt(12)
    v_mfma_f32_16x16x32_bf16 v[64:67], v[108:111], a[36:39], v[64:67]
    ds_read_b64_tr_b16 a[64:65], v20 offset:51328
    ds_read_b64_tr_b16 a[66:67], v20 offset:51840
    s_waitcnt lgkmcnt(12)
    v_mfma_f32_16x16x32_bf16 v[68:71], v[108:111], a[40:43], v[68:71]
    ds_read_b64_tr_b16 a[68:69], v21 offset:51328
    ds_read_b64_tr_b16 a[70:71], v21 offset:51840
    s_waitcnt lgkmcnt(12)
    v_mfma_f32_16x16x32_bf16 v[72:75], v[108:111], a[44:47], v[72:75]
    ds_read_b64_tr_b16 a[72:73], v22 offset:51328
    ds_read_b64_tr_b16 a[74:75], v22 offset:51840
    s_waitcnt lgkmcnt(12)
    v_mfma_f32_16x16x32_bf16 v[28:31], a[48:51], v[116:119], v[28:31]
    ds_read_b64_tr_b16 a[76:77], v23 offset:51328
    ds_read_b64_tr_b16 a[78:79], v23 offset:51840
    s_waitcnt lgkmcnt(12)
    v_mfma_f32_16x16x32_bf16 v[32:35], a[52:55], v[116:119], v[32:35]
    ds_read_b64_tr_b16 a[80:81], v20 offset:59520
    ds_read_b64_tr_b16 a[82:83], v20 offset:60032
    s_waitcnt lgkmcnt(12)
    v_mfma_f32_16x16x32_bf16 v[36:39], a[56:59], v[116:119], v[36:39]
    ds_read_b64_tr_b16 a[84:85], v21 offset:59520
    ds_read_b64_tr_b16 a[86:87], v21 offset:60032
    s_waitcnt lgkmcnt(12)
    v_mfma_f32_16x16x32_bf16 v[40:43], a[60:63], v[116:119], v[40:43]
    ds_read_b64_tr_b16 a[88:89], v22 offset:59520
    ds_read_b64_tr_b16 a[90:91], v22 offset:60032
    s_waitcnt lgkmcnt(12)
    v_mfma_f32_16x16x32_bf16 v[44:47], a[64:67], v[112:115], v[44:47]
    ds_read_b64_tr_b16 a[92:93], v23 offset:59520
    ds_read_b64_tr_b16 a[94:95], v23 offset:60032
    s_waitcnt lgkmcnt(12)
    v_mfma_f32_16x16x32_bf16 v[48:51], a[68:71], v[112:115], v[48:51]
    s_waitcnt lgkmcnt(10)
    v_mfma_f32_16x16x32_bf16 v[52:55], a[72:75], v[112:115], v[52:55]
    s_waitcnt lgkmcnt(8)
    v_mfma_f32_16x16x32_bf16 v[56:59], a[76:79], v[112:115], v[56:59]
    s_waitcnt lgkmcnt(6)
    v_mfma_f32_16x16x32_bf16 v[60:63], v[112:115], a[80:83], v[60:63]
    s_waitcnt lgkmcnt(4)
    v_mfma_f32_16x16x32_bf16 v[64:67], v[112:115], a[84:87], v[64:67]
    s_waitcnt lgkmcnt(2)
    v_mfma_f32_16x16x32_bf16 v[68:71], v[112:115], a[88:91], v[68:71]
    s_waitcnt lgkmcnt(0)
    v_mfma_f32_16x16x32_bf16 v[72:75], v[112:115], a[92:95], v[72:75]
    s_mov_b64 exec, 1
    s_lshl_b32 s36, s2, 2
    s_add_u32 s36, s36, 8323072
    v_mov_b32 v4, s34
    v_mov_b32 v5, s36
    buffer_store_dword v4, v5, s[28:31], 0 offen sc1
    s_mov_b64 exec, -1
    s_barrier
    ds_read_b128 v[108:111], v80 offset:0
    ds_read_b128 v[112:115], v81 offset:0
    ds_read_b64_tr_b16 a[0:1], v24 offset:0
    ds_read_b64_tr_b16 a[2:3], v24 offset:512
    ds_read_b64_tr_b16 a[4:5], v25 offset:0
    ds_read_b64_tr_b16 a[6:7], v25 offset:512
    ds_read_b64_tr_b16 a[8:9], v26 offset:0
    ds_read_b64_tr_b16 a[10:11], v26 offset:512
    ds_read_b64_tr_b16 a[12:13], v27 offset:0
    ds_read_b64_tr_b16 a[14:15], v27 offset:512
    ds_read_b64_tr_b16 a[16:17], v24 offset:8192
    ds_read_b64_tr_b16 a[18:19], v24 offset:8704
    ds_read_b64_tr_b16 a[20:21], v25 offset:8192
    ds_read_b64_tr_b16 a[22:23], v25 offset:8704
    ds_read_b64_tr_b16 a[24:25], v26 offset:8192
    ds_read_b64_tr_b16 a[26:27], v26 offset:8704
    s_waitcnt lgkmcnt(12)
    v_mfma_f32_16x16x32_bf16 v[28:31], a[0:3], v[116:119], v[28:31]
    ds_read_b64_tr_b16 a[28:29], v27 offset:8192
    ds_read_b64_tr_b16 a[30:31], v27 offset:8704
    s_waitcnt lgkmcnt(12)
    v_mfma_f32_16x16x32_bf16 v[32:35], a[4:7], v[116:119], v[32:35]
    ds_read_b64_tr_b16 a[32:33], v24 offset:16384
    ds_read_b64_tr_b16 a[34:35], v24 offset:16896
    s_waitcnt lgkmcnt(12)
    v_mfma_f32_16x16x32_bf16 v[36:39], a[8:11], v[116:119], v[36:39]
    ds_read_b64_tr_b16 a[36:37], v25 offset:16384
    ds_read_b64_tr_b16 a[38:39], v25 offset:16896
    s_waitcnt lgkmcnt(12)
    v_mfma_f32_16x16x32_bf16 v[40:43], a[12:15], v[116:119], v[40:43]
    ds_read_b64_tr_b16 a[40:41], v26 offset:16384
    ds_read_b64_tr_b16 a[42:43], v26 offset:16896
    s_waitcnt lgkmcnt(12)
    v_mfma_f32_16x16x32_bf16 v[44:47], a[16:19], v[108:111], v[44:47]
    ds_read_b64_tr_b16 a[44:45], v27 offset:16384
    ds_read_b64_tr_b16 a[46:47], v27 offset:16896
    s_waitcnt lgkmcnt(12)
    v_mfma_f32_16x16x32_bf16 v[48:51], a[20:23], v[108:111], v[48:51]
    ds_read_b64_tr_b16 a[48:49], v24 offset:4096
    ds_read_b64_tr_b16 a[50:51], v24 offset:4608
    s_waitcnt lgkmcnt(12)
    v_mfma_f32_16x16x32_bf16 v[52:55], a[24:27], v[108:111], v[52:55]
    ds_read_b64_tr_b16 a[52:53], v25 offset:4096
    ds_read_b64_tr_b16 a[54:55], v25 offset:4608
    s_waitcnt lgkmcnt(12)
    v_mfma_f32_16x16x32_bf16 v[56:59], a[28:31], v[108:111], v[56:59]
    ds_read_b64_tr_b16 a[56:57], v26 offset:4096
    ds_read_b64_tr_b16 a[58:59], v26 offset:4608
    s_waitcnt lgkmcnt(12)
    v_mfma_f32_16x16x32_bf16 v[60:63], v[108:111], a[32:35], v[60:63]
    ds_read_b64_tr_b16 a[60:61], v27 offset:4096
    ds_read_b64_tr_b16 a[62:63], v27 offset:4608
    s_waitcnt lgkmcnt(12)
    v_mfma_f32_16x16x32_bf16 v[64:67], v[108:111], a[36:39], v[64:67]
    ds_read_b64_tr_b16 a[64:65], v24 offset:12288
    ds_read_b64_tr_b16 a[66:67], v24 offset:12800
    s_waitcnt lgkmcnt(12)
    v_mfma_f32_16x16x32_bf16 v[68:71], v[108:111], a[40:43], v[68:71]
    ds_read_b64_tr_b16 a[68:69], v25 offset:12288
    ds_read_b64_tr_b16 a[70:71], v25 offset:12800
    s_waitcnt lgkmcnt(12)
    v_mfma_f32_16x16x32_bf16 v[72:75], v[108:111], a[44:47], v[72:75]
    ds_read_b64_tr_b16 a[72:73], v26 offset:12288
    ds_read_b64_tr_b16 a[74:75], v26 offset:12800
    s_waitcnt lgkmcnt(12)
    v_mfma_f32_16x16x32_bf16 v[28:31], a[48:51], v[116:119], v[28:31]
    ds_read_b64_tr_b16 a[76:77], v27 offset:12288
    ds_read_b64_tr_b16 a[78:79], v27 offset:12800
    s_waitcnt lgkmcnt(12)
    v_mfma_f32_16x16x32_bf16 v[32:35], a[52:55], v[116:119], v[32:35]
    ds_read_b64_tr_b16 a[80:81], v24 offset:20480
    ds_read_b64_tr_b16 a[82:83], v24 offset:20992
    s_waitcnt lgkmcnt(12)
    v_mfma_f32_16x16x32_bf16 v[36:39], a[56:59], v[116:119], v[36:39]
    ds_read_b64_tr_b16 a[84:85], v25 offset:20480
    ds_read_b64_tr_b16 a[86:87], v25 offset:20992
    s_waitcnt lgkmcnt(12)
    v_mfma_f32_16x16x32_bf16 v[40:43], a[60:63], v[116:119], v[40:43]
    ds_read_b64_tr_b16 a[88:89], v26 offset:20480
    ds_read_b64_tr_b16 a[90:91], v26 offset:20992
    s_waitcnt lgkmcnt(12)
    v_mfma_f32_16x16x32_bf16 v[44:47], a[64:67], v[112:115], v[44:47]
    ds_read_b64_tr_b16 a[92:93], v27 offset:20480
    ds_read_b64_tr_b16 a[94:95], v27 offset:20992
    s_waitcnt lgkmcnt(12)
    v_mfma_f32_16x16x32_bf16 v[48:51], a[68:71], v[112:115], v[48:51]
    s_waitcnt lgkmcnt(10)
    v_mfma_f32_16x16x32_bf16 v[52:55], a[72:75], v[112:115], v[52:55]
    s_waitcnt lgkmcnt(8)
    v_mfma_f32_16x16x32_bf16 v[56:59], a[76:79], v[112:115], v[56:59]
    s_waitcnt lgkmcnt(6)
    v_mfma_f32_16x16x32_bf16 v[60:63], v[112:115], a[80:83], v[60:63]
    s_waitcnt lgkmcnt(4)
    v_mfma_f32_16x16x32_bf16 v[64:67], v[112:115], a[84:87], v[64:67]
    s_waitcnt lgkmcnt(2)
    v_mfma_f32_16x16x32_bf16 v[68:71], v[112:115], a[88:91], v[68:71]
    s_waitcnt lgkmcnt(0)
    v_mfma_f32_16x16x32_bf16 v[72:75], v[112:115], a[92:95], v[72:75]
    s_barrier
    ds_read_b128 v[108:111], v80 offset:39040
    ds_read_b128 v[112:115], v81 offset:39040
    ds_read_b64_tr_b16 a[0:1], v24 offset:39040
    ds_read_b64_tr_b16 a[2:3], v24 offset:39552
    ds_read_b64_tr_b16 a[4:5], v25 offset:39040
    ds_read_b64_tr_b16 a[6:7], v25 offset:39552
    ds_read_b64_tr_b16 a[8:9], v26 offset:39040
    ds_read_b64_tr_b16 a[10:11], v26 offset:39552
    ds_read_b64_tr_b16 a[12:13], v27 offset:39040
    ds_read_b64_tr_b16 a[14:15], v27 offset:39552
    ds_read_b64_tr_b16 a[16:17], v24 offset:47232
    ds_read_b64_tr_b16 a[18:19], v24 offset:47744
    ds_read_b64_tr_b16 a[20:21], v25 offset:47232
    ds_read_b64_tr_b16 a[22:23], v25 offset:47744
    ds_read_b64_tr_b16 a[24:25], v26 offset:47232
    ds_read_b64_tr_b16 a[26:27], v26 offset:47744
    s_waitcnt lgkmcnt(12)
    v_mfma_f32_16x16x32_bf16 v[28:31], a[0:3], v[116:119], v[28:31]
    ds_read_b64_tr_b16 a[28:29], v27 offset:47232
    ds_read_b64_tr_b16 a[30:31], v27 offset:47744
    s_waitcnt lgkmcnt(12)
    v_mfma_f32_16x16x32_bf16 v[32:35], a[4:7], v[116:119], v[32:35]
    ds_read_b64_tr_b16 a[32:33], v24 offset:55424
    ds_read_b64_tr_b16 a[34:35], v24 offset:55936
    s_waitcnt lgkmcnt(12)
    v_mfma_f32_16x16x32_bf16 v[36:39], a[8:11], v[116:119], v[36:39]
    ds_read_b64_tr_b16 a[36:37], v25 offset:55424
    ds_read_b64_tr_b16 a[38:39], v25 offset:55936
    s_waitcnt lgkmcnt(12)
    v_mfma_f32_16x16x32_bf16 v[40:43], a[12:15], v[116:119], v[40:43]
    ds_read_b64_tr_b16 a[40:41], v26 offset:55424
    ds_read_b64_tr_b16 a[42:43], v26 offset:55936
    s_waitcnt lgkmcnt(12)
    v_mfma_f32_16x16x32_bf16 v[44:47], a[16:19], v[108:111], v[44:47]
    ds_read_b64_tr_b16 a[44:45], v27 offset:55424
    ds_read_b64_tr_b16 a[46:47], v27 offset:55936
    s_waitcnt lgkmcnt(12)
    v_mfma_f32_16x16x32_bf16 v[48:51], a[20:23], v[108:111], v[48:51]
    ds_read_b64_tr_b16 a[48:49], v24 offset:43136
    ds_read_b64_tr_b16 a[50:51], v24 offset:43648
    s_waitcnt lgkmcnt(12)
    v_mfma_f32_16x16x32_bf16 v[52:55], a[24:27], v[108:111], v[52:55]
    ds_read_b64_tr_b16 a[52:53], v25 offset:43136
    ds_read_b64_tr_b16 a[54:55], v25 offset:43648
    s_waitcnt lgkmcnt(12)
    v_mfma_f32_16x16x32_bf16 v[56:59], a[28:31], v[108:111], v[56:59]
    ds_read_b64_tr_b16 a[56:57], v26 offset:43136
    ds_read_b64_tr_b16 a[58:59], v26 offset:43648
    s_waitcnt lgkmcnt(12)
    v_mfma_f32_16x16x32_bf16 v[60:63], v[108:111], a[32:35], v[60:63]
    ds_read_b64_tr_b16 a[60:61], v27 offset:43136
    ds_read_b64_tr_b16 a[62:63], v27 offset:43648
    s_waitcnt lgkmcnt(12)
    v_mfma_f32_16x16x32_bf16 v[64:67], v[108:111], a[36:39], v[64:67]
    ds_read_b64_tr_b16 a[64:65], v24 offset:51328
    ds_read_b64_tr_b16 a[66:67], v24 offset:51840
    s_waitcnt lgkmcnt(12)
    v_mfma_f32_16x16x32_bf16 v[68:71], v[108:111], a[40:43], v[68:71]
    ds_read_b64_tr_b16 a[68:69], v25 offset:51328
    ds_read_b64_tr_b16 a[70:71], v25 offset:51840
    s_waitcnt lgkmcnt(12)
    v_mfma_f32_16x16x32_bf16 v[72:75], v[108:111], a[44:47], v[72:75]
    ds_read_b64_tr_b16 a[72:73], v26 offset:51328
    ds_read_b64_tr_b16 a[74:75], v26 offset:51840
    s_waitcnt lgkmcnt(12)
    v_mfma_f32_16x16x32_bf16 v[28:31], a[48:51], v[116:119], v[28:31]
    ds_read_b64_tr_b16 a[76:77], v27 offset:51328
    ds_read_b64_tr_b16 a[78:79], v27 offset:51840
    s_waitcnt lgkmcnt(12)
    v_mfma_f32_16x16x32_bf16 v[32:35], a[52:55], v[116:119], v[32:35]
    ds_read_b64_tr_b16 a[80:81], v24 offset:59520
    ds_read_b64_tr_b16 a[82:83], v24 offset:60032
    s_waitcnt lgkmcnt(12)
    v_mfma_f32_16x16x32_bf16 v[36:39], a[56:59], v[116:119], v[36:39]
    ds_read_b64_tr_b16 a[84:85], v25 offset:59520
    ds_read_b64_tr_b16 a[86:87], v25 offset:60032
    s_waitcnt lgkmcnt(12)
    v_mfma_f32_16x16x32_bf16 v[40:43], a[60:63], v[116:119], v[40:43]
    ds_read_b64_tr_b16 a[88:89], v26 offset:59520
    ds_read_b64_tr_b16 a[90:91], v26 offset:60032
    s_waitcnt lgkmcnt(12)
    v_mfma_f32_16x16x32_bf16 v[44:47], a[64:67], v[112:115], v[44:47]
    ds_read_b64_tr_b16 a[92:93], v27 offset:59520
    ds_read_b64_tr_b16 a[94:95], v27 offset:60032
    s_waitcnt lgkmcnt(12)
    v_mfma_f32_16x16x32_bf16 v[48:51], a[68:71], v[112:115], v[48:51]
    s_waitcnt lgkmcnt(10)
    v_mfma_f32_16x16x32_bf16 v[52:55], a[72:75], v[112:115], v[52:55]
    s_waitcnt lgkmcnt(8)
    v_mfma_f32_16x16x32_bf16 v[56:59], a[76:79], v[112:115], v[56:59]
    s_waitcnt lgkmcnt(6)
    v_mfma_f32_16x16x32_bf16 v[60:63], v[112:115], a[80:83], v[60:63]
    s_waitcnt lgkmcnt(4)
    v_mfma_f32_16x16x32_bf16 v[64:67], v[112:115], a[84:87], v[64:67]
    s_waitcnt lgkmcnt(2)
    v_mfma_f32_16x16x32_bf16 v[68:71], v[112:115], a[88:91], v[68:71]
    s_waitcnt lgkmcnt(0)
    v_mfma_f32_16x16x32_bf16 v[72:75], v[112:115], a[92:95], v[72:75]
    v_add_u32 v4, 156224, v12
    v_min_u32 v5, 47, v1
    v_lshlrev_b32 v5, 2, v5
    v_add_u32 v5, 156480, v5
    v_lshlrev_b32 v6, 4, v2
    v_add_u32 v6, 157184, v6
    v_mov_b32 v7, 157968
    v_lshlrev_b32 v11, 2, v3
    v_add_u32 v11, 156224, v11
    s_barrier
    ds_read_b128 v[108:111], v76 offset:0
    ds_read_b128 v[112:115], v77 offset:0
    ds_read_b64_tr_b16 a[0:1], v20 offset:0
    ds_read_b64_tr_b16 a[2:3], v20 offset:512
    ds_read_b64_tr_b16 a[4:5], v21 offset:0
    ds_read_b64_tr_b16 a[6:7], v21 offset:512
    ds_read_b64_tr_b16 a[8:9], v22 offset:0
    ds_read_b64_tr_b16 a[10:11], v22 offset:512
    ds_read_b64_tr_b16 a[12:13], v23 offset:0
    ds_read_b64_tr_b16 a[14:15], v23 offset:512
    ds_read_b64_tr_b16 a[16:17], v20 offset:8192
    ds_read_b64_tr_b16 a[18:19], v20 offset:8704
    ds_read_b64_tr_b16 a[20:21], v21 offset:8192
    ds_read_b64_tr_b16 a[22:23], v21 offset:8704
    ds_read_b64_tr_b16 a[24:25], v22 offset:8192
    ds_read_b64_tr_b16 a[26:27], v22 offset:8704
    s_waitcnt lgkmcnt(12)
    v_mfma_f32_16x16x32_bf16 v[28:31], a[0:3], v[116:119], v[28:31]
    ds_read_b64_tr_b16 a[28:29], v23 offset:8192
    ds_read_b64_tr_b16 a[30:31], v23 offset:8704
    s_waitcnt lgkmcnt(12)
    v_mfma_f32_16x16x32_bf16 v[32:35], a[4:7], v[116:119], v[32:35]
    ds_read_b64_tr_b16 a[32:33], v20 offset:16384
    ds_read_b64_tr_b16 a[34:35], v20 offset:16896
    s_waitcnt lgkmcnt(12)
    v_mfma_f32_16x16x32_bf16 v[36:39], a[8:11], v[116:119], v[36:39]
    ds_read_b64_tr_b16 a[36:37], v21 offset:16384
    ds_read_b64_tr_b16 a[38:39], v21 offset:16896
    s_waitcnt lgkmcnt(12)
    v_mfma_f32_16x16x32_bf16 v[40:43], a[12:15], v[116:119], v[40:43]
    ds_read_b64_tr_b16 a[40:41], v22 offset:16384
    ds_read_b64_tr_b16 a[42:43], v22 offset:16896
    s_waitcnt lgkmcnt(12)
    v_mfma_f32_16x16x32_bf16 v[44:47], a[16:19], v[108:111], v[44:47]
    ds_read_b64_tr_b16 a[44:45], v23 offset:16384
    ds_read_b64_tr_b16 a[46:47], v23 offset:16896
    s_waitcnt lgkmcnt(12)
    v_mfma_f32_16x16x32_bf16 v[48:51], a[20:23], v[108:111], v[48:51]
    ds_read_b64_tr_b16 a[48:49], v20 offset:4096
    ds_read_b64_tr_b16 a[50:51], v20 offset:4608
    s_waitcnt lgkmcnt(12)
    v_mfma_f32_16x16x32_bf16 v[52:55], a[24:27], v[108:111], v[52:55]
    ds_read_b64_tr_b16 a[52:53], v21 offset:4096
    ds_read_b64_tr_b16 a[54:55], v21 offset:4608
    s_waitcnt lgkmcnt(12)
    v_mfma_f32_16x16x32_bf16 v[56:59], a[28:31], v[108:111], v[56:59]
    ds_read_b64_tr_b16 a[56:57], v22 offset:4096
    ds_read_b64_tr_b16 a[58:59], v22 offset:4608
    s_waitcnt lgkmcnt(12)
    v_mfma_f32_16x16x32_bf16 v[60:63], v[108:111], a[32:35], v[60:63]
    ds_read_b64_tr_b16 a[60:61], v23 offset:4096
    ds_read_b64_tr_b16 a[62:63], v23 offset:4608
    s_waitcnt lgkmcnt(12)
    v_mfma_f32_16x16x32_bf16 v[64:67], v[108:111], a[36:39], v[64:67]
    ds_read_b64_tr_b16 a[64:65], v20 offset:12288
    ds_read_b64_tr_b16 a[66:67], v20 offset:12800
    s_waitcnt lgkmcnt(12)
    v_mfma_f32_16x16x32_bf16 v[68:71], v[108:111], a[40:43], v[68:71]
    ds_read_b64_tr_b16 a[68:69], v21 offset:12288
    ds_read_b64_tr_b16 a[70:71], v21 offset:12800
    s_waitcnt lgkmcnt(12)
    v_mfma_f32_16x16x32_bf16 v[72:75], v[108:111], a[44:47], v[72:75]
    ds_read_b64_tr_b16 a[72:73], v22 offset:12288
    ds_read_b64_tr_b16 a[74:75], v22 offset:12800
    s_waitcnt lgkmcnt(12)
    v_mfma_f32_16x16x32_bf16 v[28:31], a[48:51], v[116:119], v[28:31]
    ds_read_b64_tr_b16 a[76:77], v23 offset:12288
    ds_read_b64_tr_b16 a[78:79], v23 offset:12800
    s_waitcnt lgkmcnt(12)
    v_mfma_f32_16x16x32_bf16 v[32:35], a[52:55], v[116:119], v[32:35]
    ds_read_b64_tr_b16 a[80:81], v20 offset:20480
    ds_read_b64_tr_b16 a[82:83], v20 offset:20992
    s_waitcnt lgkmcnt(12)
    v_mfma_f32_16x16x32_bf16 v[36:39], a[56:59], v[116:119], v[36:39]
    ds_read_b64_tr_b16 a[84:85], v21 offset:20480
    ds_read_b64_tr_b16 a[86:87], v21 offset:20992
    s_waitcnt lgkmcnt(12)
    v_mfma_f32_16x16x32_bf16 v[40:43], a[60:63], v[116:119], v[40:43]
    ds_read_b64_tr_b16 a[88:89], v22 offset:20480
    ds_read_b64_tr_b16 a[90:91], v22 offset:20992
    s_waitcnt lgkmcnt(12)
    v_mfma_f32_16x16x32_bf16 v[44:47], a[64:67], v[112:115], v[44:47]
    ds_read_b64_tr_b16 a[92:93], v23 offset:20480
    ds_read_b64_tr_b16 a[94:95], v23 offset:20992
    s_waitcnt lgkmcnt(12)
    v_mfma_f32_16x16x32_bf16 v[48:51], a[68:71], v[112:115], v[48:51]
    s_waitcnt lgkmcnt(10)
    v_mfma_f32_16x16x32_bf16 v[52:55], a[72:75], v[112:115], v[52:55]
    s_waitcnt lgkmcnt(8)
    v_mfma_f32_16x16x32_bf16 v[56:59], a[76:79], v[112:115], v[56:59]
    s_waitcnt lgkmcnt(6)
    v_mfma_f32_16x16x32_bf16 v[60:63], v[112:115], a[80:83], v[60:63]
    s_waitcnt lgkmcnt(4)
    v_mfma_f32_16x16x32_bf16 v[64:67], v[112:115], a[84:87], v[64:67]
    s_waitcnt lgkmcnt(2)
    v_mfma_f32_16x16x32_bf16 v[68:71], v[112:115], a[88:91], v[68:71]
    s_waitcnt lgkmcnt(0)
    v_mfma_f32_16x16x32_bf16 v[72:75], v[112:115], a[92:95], v[72:75]
    s_barrier
    ds_read_b128 v[108:111], v76 offset:39040
    ds_read_b128 v[112:115], v77 offset:39040
    ds_read_b64_tr_b16 a[0:1], v20 offset:39040
    ds_read_b64_tr_b16 a[2:3], v20 offset:39552
    ds_read_b64_tr_b16 a[4:5], v21 offset:39040
    ds_read_b64_tr_b16 a[6:7], v21 offset:39552
    ds_read_b64_tr_b16 a[8:9], v22 offset:39040
    ds_read_b64_tr_b16 a[10:11], v22 offset:39552
    ds_read_b64_tr_b16 a[12:13], v23 offset:39040
    ds_read_b64_tr_b16 a[14:15], v23 offset:39552
    ds_read_b64_tr_b16 a[16:17], v20 offset:47232
    ds_read_b64_tr_b16 a[18:19], v20 offset:47744
    ds_read_b64_tr_b16 a[20:21], v21 offset:47232
    ds_read_b64_tr_b16 a[22:23], v21 offset:47744
    ds_read_b64_tr_b16 a[24:25], v22 offset:47232
    ds_read_b64_tr_b16 a[26:27], v22 offset:47744
    s_waitcnt lgkmcnt(12)
    v_mfma_f32_16x16x32_bf16 v[28:31], a[0:3], v[116:119], v[28:31]
    ds_read_b64_tr_b16 a[28:29], v23 offset:47232
    ds_read_b64_tr_b16 a[30:31], v23 offset:47744
    s_waitcnt lgkmcnt(12)
    v_mfma_f32_16x16x32_bf16 v[32:35], a[4:7], v[116:119], v[32:35]
    ds_read_b64_tr_b16 a[32:33], v20 offset:55424
    ds_read_b64_tr_b16 a[34:35], v20 offset:55936
    s_waitcnt lgkmcnt(12)
    v_mfma_f32_16x16x32_bf16 v[36:39], a[8:11], v[116:119], v[36:39]
    ds_read_b64_tr_b16 a[36:37], v21 offset:55424
    ds_read_b64_tr_b16 a[38:39], v21 offset:55936
    s_waitcnt lgkmcnt(12)
    v_mfma_f32_16x16x32_bf16 v[40:43], a[12:15], v[116:119], v[40:43]
    ds_read_b64_tr_b16 a[40:41], v22 offset:55424
    ds_read_b64_tr_b16 a[42:43], v22 offset:55936
    s_waitcnt lgkmcnt(12)
    v_mfma_f32_16x16x32_bf16 v[44:47], a[16:19], v[108:111], v[44:47]
    ds_read_b64_tr_b16 a[44:45], v23 offset:55424
    ds_read_b64_tr_b16 a[46:47], v23 offset:55936
    s_waitcnt lgkmcnt(12)
    v_mfma_f32_16x16x32_bf16 v[48:51], a[20:23], v[108:111], v[48:51]
    ds_read_b64_tr_b16 a[48:49], v20 offset:43136
    ds_read_b64_tr_b16 a[50:51], v20 offset:43648
    s_waitcnt lgkmcnt(12)
    v_mfma_f32_16x16x32_bf16 v[52:55], a[24:27], v[108:111], v[52:55]
    ds_read_b64_tr_b16 a[52:53], v21 offset:43136
    ds_read_b64_tr_b16 a[54:55], v21 offset:43648
    s_waitcnt lgkmcnt(12)
    v_mfma_f32_16x16x32_bf16 v[56:59], a[28:31], v[108:111], v[56:59]
    ds_read_b64_tr_b16 a[56:57], v22 offset:43136
    ds_read_b64_tr_b16 a[58:59], v22 offset:43648
    s_waitcnt lgkmcnt(12)
    v_mfma_f32_16x16x32_bf16 v[60:63], v[108:111], a[32:35], v[60:63]
    ds_read_b64_tr_b16 a[60:61], v23 offset:43136
    ds_read_b64_tr_b16 a[62:63], v23 offset:43648
    s_waitcnt lgkmcnt(12)
    v_mfma_f32_16x16x32_bf16 v[64:67], v[108:111], a[36:39], v[64:67]
    ds_read_b64_tr_b16 a[64:65], v20 offset:51328
    ds_read_b64_tr_b16 a[66:67], v20 offset:51840
    s_waitcnt lgkmcnt(12)
    v_mfma_f32_16x16x32_bf16 v[68:71], v[108:111], a[40:43], v[68:71]
    ds_read_b64_tr_b16 a[68:69], v21 offset:51328
    ds_read_b64_tr_b16 a[70:71], v21 offset:51840
    s_waitcnt lgkmcnt(12)
    v_mfma_f32_16x16x32_bf16 v[72:75], v[108:111], a[44:47], v[72:75]
    ds_read_b64_tr_b16 a[72:73], v22 offset:51328
    ds_read_b64_tr_b16 a[74:75], v22 offset:51840
    s_waitcnt lgkmcnt(12)
    v_mfma_f32_16x16x32_bf16 v[28:31], a[48:51], v[116:119], v[28:31]
    ds_read_b64_tr_b16 a[76:77], v23 offset:51328
    ds_read_b64_tr_b16 a[78:79], v23 offset:51840
    s_waitcnt lgkmcnt(12)
    v_mfma_f32_16x16x32_bf16 v[32:35], a[52:55], v[116:119], v[32:35]
    ds_read_b64_tr_b16 a[80:81], v20 offset:59520
    ds_read_b64_tr_b16 a[82:83], v20 offset:60032
    s_waitcnt lgkmcnt(12)
    v_mfma_f32_16x16x32_bf16 v[36:39], a[56:59], v[116:119], v[36:39]
    ds_read_b64_tr_b16 a[84:85], v21 offset:59520
    ds_read_b64_tr_b16 a[86:87], v21 offset:60032
    s_waitcnt lgkmcnt(12)
    v_mfma_f32_16x16x32_bf16 v[40:43], a[60:63], v[116:119], v[40:43]
    ds_read_b64_tr_b16 a[88:89], v22 offset:59520
    ds_read_b64_tr_b16 a[90:91], v22 offset:60032
    s_waitcnt lgkmcnt(12)
    v_mfma_f32_16x16x32_bf16 v[44:47], a[64:67], v[112:115], v[44:47]
    ds_read_b64_tr_b16 a[92:93], v23 offset:59520
    ds_read_b64_tr_b16 a[94:95], v23 offset:60032
    s_waitcnt lgkmcnt(12)
    v_mfma_f32_16x16x32_bf16 v[48:51], a[68:71], v[112:115], v[48:51]
    s_waitcnt lgkmcnt(10)
    v_mfma_f32_16x16x32_bf16 v[52:55], a[72:75], v[112:115], v[52:55]
    s_waitcnt lgkmcnt(8)
    v_mfma_f32_16x16x32_bf16 v[56:59], a[76:79], v[112:115], v[56:59]
    s_waitcnt lgkmcnt(6)
    v_mfma_f32_16x16x32_bf16 v[60:63], v[112:115], a[80:83], v[60:63]
    s_waitcnt lgkmcnt(4)
    v_mfma_f32_16x16x32_bf16 v[64:67], v[112:115], a[84:87], v[64:67]
    s_waitcnt lgkmcnt(2)
    v_mfma_f32_16x16x32_bf16 v[68:71], v[112:115], a[88:91], v[68:71]
    s_waitcnt lgkmcnt(0)
    v_mfma_f32_16x16x32_bf16 v[72:75], v[112:115], a[92:95], v[72:75]
    s_barrier
    ds_read_b128 a[96:99], v80 offset:0
    ds_read_b128 a[100:103], v81 offset:0
    ds_read_b64_tr_b16 a[0:1], v24 offset:0
    ds_read_b64_tr_b16 a[2:3], v24 offset:512
    ds_read_b64_tr_b16 a[4:5], v25 offset:0
    ds_read_b64_tr_b16 a[6:7], v25 offset:512
    ds_read_b64_tr_b16 a[8:9], v26 offset:0
    ds_read_b64_tr_b16 a[10:11], v26 offset:512
    ds_read_b64_tr_b16 a[12:13], v27 offset:0
    ds_read_b64_tr_b16 a[14:15], v27 offset:512
    ds_read_b64_tr_b16 a[16:17], v24 offset:8192
    ds_read_b64_tr_b16 a[18:19], v24 offset:8704
    ds_read_b64_tr_b16 a[20:21], v25 offset:8192
    ds_read_b64_tr_b16 a[22:23], v25 offset:8704
    ds_read_b64_tr_b16 a[24:25], v26 offset:8192
    ds_read_b64_tr_b16 a[26:27], v26 offset:8704
    s_waitcnt lgkmcnt(12)
    v_mfma_f32_16x16x32_bf16 v[28:31], a[0:3], v[116:119], v[28:31]
    ds_read_b64_tr_b16 a[28:29], v27 offset:8192
    ds_read_b64_tr_b16 a[30:31], v27 offset:8704
    s_waitcnt lgkmcnt(12)
    v_mfma_f32_16x16x32_bf16 v[32:35], a[4:7], v[116:119], v[32:35]
    ds_read_b64_tr_b16 a[48:49], v24 offset:4096
    ds_read_b64_tr_b16 a[50:51], v24 offset:4608
    s_waitcnt lgkmcnt(12)
    v_mfma_f32_16x16x32_bf16 v[36:39], a[8:11], v[116:119], v[36:39]
    ds_read_b64_tr_b16 a[52:53], v25 offset:4096
    ds_read_b64_tr_b16 a[54:55], v25 offset:4608
    s_waitcnt lgkmcnt(12)
    v_mfma_f32_16x16x32_bf16 v[40:43], a[12:15], v[116:119], v[40:43]
    ds_read_b64_tr_b16 a[56:57], v26 offset:4096
    ds_read_b64_tr_b16 a[58:59], v26 offset:4608
    s_waitcnt lgkmcnt(12)
    v_mfma_f32_16x16x32_bf16 v[44:47], a[16:19], a[96:99], v[44:47]
    ds_read_b64_tr_b16 a[60:61], v27 offset:4096
    ds_read_b64_tr_b16 a[62:63], v27 offset:4608
    s_waitcnt lgkmcnt(12)
    v_mfma_f32_16x16x32_bf16 v[48:51], a[20:23], a[96:99], v[48:51]
    ds_read_b64_tr_b16 a[64:65], v24 offset:12288
    ds_read_b64_tr_b16 a[66:67], v24 offset:12800
    s_waitcnt lgkmcnt(12)
    v_mfma_f32_16x16x32_bf16 v[52:55], a[24:27], a[96:99], v[52:55]
    ds_read_b64_tr_b16 a[68:69], v25 offset:12288
    ds_read_b64_tr_b16 a[70:71], v25 offset:12800
    s_waitcnt lgkmcnt(12)
    v_mfma_f32_16x16x32_bf16 v[56:59], a[28:31], a[96:99], v[56:59]
    ds_read_b64_tr_b16 a[72:73], v26 offset:12288
    ds_read_b64_tr_b16 a[74:75], v26 offset:12800
    s_waitcnt lgkmcnt(12)
    v_mfma_f32_16x16x32_bf16 v[28:31], a[48:51], v[116:119], v[28:31]
    ds_read_b64_tr_b16 a[76:77], v27 offset:12288
    ds_read_b64_tr_b16 a[78:79], v27 offset:12800
    s_waitcnt lgkmcnt(12)
    v_mfma_f32_16x16x32_bf16 v[32:35], a[52:55], v[116:119], v[32:35]
    s_waitcnt lgkmcnt(10)
    v_mfma_f32_16x16x32_bf16 v[36:39], a[56:59], v[116:119], v[36:39]
    s_waitcnt lgkmcnt(8)
    v_mfma_f32_16x16x32_bf16 v[40:43], a[60:63], v[116:119], v[40:43]
    s_waitcnt lgkmcnt(6)
    v_mfma_f32_16x16x32_bf16 v[44:47], a[64:67], a[100:103], v[44:47]
    s_waitcnt lgkmcnt(4)
    v_mfma_f32_16x16x32_bf16 v[48:51], a[68:71], a[100:103], v[48:51]
    s_waitcnt lgkmcnt(2)
    v_mfma_f32_16x16x32_bf16 v[52:55], a[72:75], a[100:103], v[52:55]
    s_waitcnt lgkmcnt(0)
    v_mfma_f32_16x16x32_bf16 v[56:59], a[76:79], a[100:103], v[56:59]
    s_barrier
    ds_read_b128 a[104:107], v80 offset:39040
    ds_read_b128 a[108:111], v81 offset:39040
    ds_read_b64_tr_b16 a[0:1], v24 offset:39040
    ds_read_b64_tr_b16 a[2:3], v24 offset:39552
    ds_read_b64_tr_b16 a[4:5], v25 offset:39040
    ds_read_b64_tr_b16 a[6:7], v25 offset:39552
    ds_read_b64_tr_b16 a[8:9], v26 offset:39040
    ds_read_b64_tr_b16 a[10:11], v26 offset:39552
    ds_read_b64_tr_b16 a[12:13], v27 offset:39040
    ds_read_b64_tr_b16 a[14:15], v27 offset:39552
    ds_read_b64_tr_b16 a[16:17], v24 offset:47232
    ds_read_b64_tr_b16 a[18:19], v24 offset:47744
    ds_read_b64_tr_b16 a[20:21], v25 offset:47232
    ds_read_b64_tr_b16 a[22:23], v25 offset:47744
    ds_read_b64_tr_b16 a[24:25], v26 offset:47232
    ds_read_b64_tr_b16 a[26:27], v26 offset:47744
    s_waitcnt lgkmcnt(12)
    v_mfma_f32_16x16x32_bf16 v[28:31], a[0:3], v[116:119], v[28:31]
    ds_read_b64_tr_b16 a[28:29], v27 offset:47232
    ds_read_b64_tr_b16 a[30:31], v27 offset:47744
    s_waitcnt lgkmcnt(12)
    v_mfma_f32_16x16x32_bf16 v[32:35], a[4:7], v[116:119], v[32:35]
    ds_read_b64_tr_b16 a[48:49], v24 offset:43136
    ds_read_b64_tr_b16 a[50:51], v24 offset:43648
    s_waitcnt lgkmcnt(12)
    v_mfma_f32_16x16x32_bf16 v[36:39], a[8:11], v[116:119], v[36:39]
    ds_read_b64_tr_b16 a[52:53], v25 offset:43136
    ds_read_b64_tr_b16 a[54:55], v25 offset:43648
    s_waitcnt lgkmcnt(12)
    v_mfma_f32_16x16x32_bf16 v[40:43], a[12:15], v[116:119], v[40:43]
    ds_read_b64_tr_b16 a[56:57], v26 offset:43136
    ds_read_b64_tr_b16 a[58:59], v26 offset:43648
    s_waitcnt lgkmcnt(12)
    v_mfma_f32_16x16x32_bf16 v[44:47], a[16:19], a[104:107], v[44:47]
    ds_read_b64_tr_b16 a[60:61], v27 offset:43136
    ds_read_b64_tr_b16 a[62:63], v27 offset:43648
    s_waitcnt lgkmcnt(12)
    v_mfma_f32_16x16x32_bf16 v[48:51], a[20:23], a[104:107], v[48:51]
    ds_read_b64_tr_b16 a[64:65], v24 offset:51328
    ds_read_b64_tr_b16 a[66:67], v24 offset:51840
    s_waitcnt lgkmcnt(12)
    v_mfma_f32_16x16x32_bf16 v[52:55], a[24:27], a[104:107], v[52:55]
    ds_read_b64_tr_b16 a[68:69], v25 offset:51328
    ds_read_b64_tr_b16 a[70:71], v25 offset:51840
    s_waitcnt lgkmcnt(12)
    v_mfma_f32_16x16x32_bf16 v[56:59], a[28:31], a[104:107], v[56:59]
    ds_read_b64_tr_b16 a[72:73], v26 offset:51328
    ds_read_b64_tr_b16 a[74:75], v26 offset:51840
    s_waitcnt lgkmcnt(12)
    v_mfma_f32_16x16x32_bf16 v[28:31], a[48:51], v[116:119], v[28:31]
    ds_read_b64_tr_b16 a[76:77], v27 offset:51328
    ds_read_b64_tr_b16 a[78:79], v27 offset:51840
    s_waitcnt lgkmcnt(12)
    v_mfma_f32_16x16x32_bf16 v[32:35], a[52:55], v[116:119], v[32:35]
    s_waitcnt lgkmcnt(10)
    v_mfma_f32_16x16x32_bf16 v[36:39], a[56:59], v[116:119], v[36:39]
    s_waitcnt lgkmcnt(8)
    v_mfma_f32_16x16x32_bf16 v[40:43], a[60:63], v[116:119], v[40:43]
    s_waitcnt lgkmcnt(6)
    v_mfma_f32_16x16x32_bf16 v[44:47], a[64:67], a[108:111], v[44:47]
    s_waitcnt lgkmcnt(4)
    v_mfma_f32_16x16x32_bf16 v[48:51], a[68:71], a[108:111], v[48:51]
    s_waitcnt lgkmcnt(2)
    v_mfma_f32_16x16x32_bf16 v[52:55], a[72:75], a[108:111], v[52:55]
    s_waitcnt lgkmcnt(0)
    v_mfma_f32_16x16x32_bf16 v[56:59], a[76:79], a[108:111], v[56:59]
    buffer_load_dwordx2 v[92:93], v96, s[28:31], s46 offen sc1
    buffer_load_dwordx2 v[94:95], v97, s[28:31], s46 offen sc1
    s_barrier
    ds_read_b128 a[112:115], v76 offset:0
    ds_read_b128 a[116:119], v77 offset:0
    ds_read_b64_tr_b16 a[0:1], v20 offset:0
    ds_read_b64_tr_b16 a[2:3], v20 offset:512
    ds_read_b64_tr_b16 a[4:5], v21 offset:0
    ds_read_b64_tr_b16 a[6:7], v21 offset:512
    ds_read_b64_tr_b16 a[8:9], v22 offset:0
    ds_read_b64_tr_b16 a[10:11], v22 offset:512
    ds_read_b64_tr_b16 a[12:13], v23 offset:0
    ds_read_b64_tr_b16 a[14:15], v23 offset:512
    ds_read_b64_tr_b16 a[16:17], v20 offset:8192
    ds_read_b64_tr_b16 a[18:19], v20 offset:8704
    ds_read_b64_tr_b16 a[20:21], v21 offset:8192
    ds_read_b64_tr_b16 a[22:23], v21 offset:8704
    ds_read_b64_tr_b16 a[24:25], v22 offset:8192
    ds_read_b64_tr_b16 a[26:27], v22 offset:8704
    s_waitcnt lgkmcnt(12)
    v_mfma_f32_16x16x32_bf16 v[28:31], a[0:3], v[116:119], v[28:31]
    ds_read_b64_tr_b16 a[28:29], v23 offset:8192
    ds_read_b64_tr_b16 a[30:31], v23 offset:8704
    s_waitcnt lgkmcnt(12)
    v_mfma_f32_16x16x32_bf16 v[32:35], a[4:7], v[116:119], v[32:35]
    ds_read_b64_tr_b16 a[48:49], v20 offset:4096
    ds_read_b64_tr_b16 a[50:51], v20 offset:4608
    s_waitcnt lgkmcnt(12)
    v_mfma_f32_16x16x32_bf16 v[36:39], a[8:11], v[116:119], v[36:39]
    ds_read_b64_tr_b16 a[52:53], v21 offset:4096
    ds_read_b64_tr_b16 a[54:55], v21 offset:4608
    s_waitcnt lgkmcnt(12)
    v_mfma_f32_16x16x32_bf16 v[40:43], a[12:15], v[116:119], v[40:43]
    ds_read_b64_tr_b16 a[56:57], v22 offset:4096
    ds_read_b64_tr_b16 a[58:59], v22 offset:4608
    s_waitcnt lgkmcnt(12)
    v_mfma_f32_16x16x32_bf16 v[44:47], a[16:19], a[112:115], v[44:47]
    ds_read_b64_tr_b16 a[60:61], v23 offset:4096
    ds_read_b64_tr_b16 a[62:63], v23 offset:4608
    s_waitcnt lgkmcnt(12)
    v_mfma_f32_16x16x32_bf16 v[48:51], a[20:23], a[112:115], v[48:51]
    ds_read_b64_tr_b16 a[64:65], v20 offset:12288
    ds_read_b64_tr_b16 a[66:67], v20 offset:12800
    s_waitcnt lgkmcnt(12)
    v_mfma_f32_16x16x32_bf16 v[52:55], a[24:27], a[112:115], v[52:55]
    ds_read_b64_tr_b16 a[68:69], v21 offset:12288
    ds_read_b64_tr_b16 a[70:71], v21 offset:12800
    s_waitcnt lgkmcnt(12)
    v_mfma_f32_16x16x32_bf16 v[56:59], a[28:31], a[112:115], v[56:59]
    ds_read_b64_tr_b16 a[72:73], v22 offset:12288
    ds_read_b64_tr_b16 a[74:75], v22 offset:12800
    s_waitcnt lgkmcnt(12)
    v_mfma_f32_16x16x32_bf16 v[28:31], a[48:51], v[116:119], v[28:31]
    ds_read_b64_tr_b16 a[76:77], v23 offset:12288
    ds_read_b64_tr_b16 a[78:79], v23 offset:12800
    s_waitcnt lgkmcnt(12)
    v_mfma_f32_16x16x32_bf16 v[32:35], a[52:55], v[116:119], v[32:35]
    s_waitcnt lgkmcnt(10)
    v_mfma_f32_16x16x32_bf16 v[36:39], a[56:59], v[116:119], v[36:39]
    s_waitcnt vmcnt(0)
Lst_chk:
    v_cmp_ne_u32 vcc, s34, v93
    v_cmp_ne_u32 s[36:37], s34, v95
    s_nop 0
    s_or_b64 s[36:37], s[36:37], vcc
    s_cbranch_scc1 Lst_re
    v_lshlrev_b32 v93, 16, v92
    s_waitcnt lgkmcnt(8)
    v_mfma_f32_16x16x32_bf16 v[40:43], a[60:63], v[116:119], v[40:43]
    v_and_b32 v92, 0xffff0000, v92
    v_rcp_f32 v93, v93
    s_waitcnt lgkmcnt(6)
    v_mfma_f32_16x16x32_bf16 v[44:47], a[64:67], a[116:119], v[44:47]
    v_lshlrev_b32 v95, 16, v94
    v_and_b32 v94, 0xffff0000, v94
    s_waitcnt lgkmcnt(4)
    v_mfma_f32_16x16x32_bf16 v[48:51], a[68:71], a[116:119], v[48:51]
    v_rcp_f32 v95, v95
    ds_write2st64_b32 v4, v92, v93 offset0:0 offset1:2
    s_waitcnt lgkmcnt(3)
    v_mfma_f32_16x16x32_bf16 v[52:55], a[72:75], a[116:119], v[52:55]
    ds_write2st64_b32 v5, v94, v95 offset0:0 offset1:2
    ds_read_b32 v120, v11
    s_waitcnt lgkmcnt(3)
    v_mfma_f32_16x16x32_bf16 v[56:59], a[76:79], a[116:119], v[56:59]
    s_waitcnt lgkmcnt(0)
    s_barrier
    ds_read_b128 a[120:123], v76 offset:39040
    ds_read_b128 a[124:127], v77 offset:39040
    ds_read_b64_tr_b16 a[0:1], v20 offset:39040
    ds_read_b64_tr_b16 a[2:3], v20 offset:39552
    ds_read_b64_tr_b16 a[4:5], v21 offset:39040
    ds_read_b64_tr_b16 a[6:7], v21 offset:39552
    ds_read_b64_tr_b16 a[8:9], v22 offset:39040
    ds_read_b64_tr_b16 a[10:11], v22 offset:39552
    ds_read_b64_tr_b16 a[12:13], v23 offset:39040
    ds_read_b64_tr_b16 a[14:15], v23 offset:39552
    ds_read_b64_tr_b16 a[16:17], v20 offset:47232
    ds_read_b64_tr_b16 a[18:19], v20 offset:47744
    ds_read_b64_tr_b16 a[20:21], v21 offset:47232
    ds_read_b64_tr_b16 a[22:23], v21 offset:47744
    ds_read_b64_tr_b16 a[24:25], v22 offset:47232
    ds_read_b64_tr_b16 a[26:27], v22 offset:47744
    s_waitcnt lgkmcnt(12)
    v_mfma_f32_16x16x32_bf16 v[28:31], a[0:3], v[116:119], v[28:31]
    ds_read_b64_tr_b16 a[28:29], v23 offset:47232
    ds_read_b64_tr_b16 a[30:31], v23 offset:47744
    s_waitcnt lgkmcnt(12)
    v_mfma_f32_16x16x32_bf16 v[32:35], a[4:7], v[116:119], v[32:35]
    ds_read_b64_tr_b16 a[48:49], v20 offset:43136
    ds_read_b64_tr_b16 a[50:51], v20 offset:43648
    s_waitcnt lgkmcnt(12)
    v_mfma_f32_16x16x32_bf16 v[36:39], a[8:11], v[116:119], v[36:39]
    ds_read_b64_tr_b16 a[52:53], v21 offset:43136
    ds_read_b64_tr_b16 a[54:55], v21 offset:43648
    s_waitcnt lgkmcnt(12)
    v_mfma_f32_16x16x32_bf16 v[40:43], a[12:15], v[116:119], v[40:43]
    ds_read_b64_tr_b16 a[56:57], v22 offset:43136
    ds_read_b64_tr_b16 a[58:59], v22 offset:43648
    s_waitcnt lgkmcnt(12)
    v_mfma_f32_16x16x32_bf16 v[44:47], a[16:19], a[120:123], v[44:47]
    ds_read_b64_tr_b16 a[60:61], v23 offset:43136
    ds_read_b64_tr_b16 a[62:63], v23 offset:43648
    s_waitcnt lgkmcnt(12)
    v_mfma_f32_16x16x32_bf16 v[48:51], a[20:23], a[120:123], v[48:51]
    ds_read_b64_tr_b16 a[64:65], v20 offset:51328
    ds_read_b64_tr_b16 a[66:67], v20 offset:51840
    s_waitcnt lgkmcnt(12)
    v_mfma_f32_16x16x32_bf16 v[52:55], a[24:27], a[120:123], v[52:55]
    ds_read_b64_tr_b16 a[68:69], v21 offset:51328
    ds_read_b64_tr_b16 a[70:71], v21 offset:51840
    s_waitcnt lgkmcnt(12)
    v_mfma_f32_16x16x32_bf16 v[56:59], a[28:31], a[120:123], v[56:59]
    ds_read_b64_tr_b16 a[72:73], v22 offset:51328
    ds_read_b64_tr_b16 a[74:75], v22 offset:51840
    s_waitcnt lgkmcnt(12)
    v_mfma_f32_16x16x32_bf16 v[28:31], a[48:51], v[116:119], v[28:31]
    ds_read_b64_tr_b16 a[76:77], v23 offset:51328
    ds_read_b64_tr_b16 a[78:79], v23 offset:51840
    s_waitcnt lgkmcnt(12)
    v_mfma_f32_16x16x32_bf16 v[32:35], a[52:55], v[116:119], v[32:35]
    s_waitcnt lgkmcnt(10)
    v_mfma_f32_16x16x32_bf16 v[36:39], a[56:59], v[116:119], v[36:39]
    s_waitcnt lgkmcnt(8)
    v_mfma_f32_16x16x32_bf16 v[40:43], a[60:63], v[116:119], v[40:43]
    s_waitcnt lgkmcnt(6)
    v_mfma_f32_16x16x32_bf16 v[44:47], a[64:67], a[124:127], v[44:47]
    s_waitcnt lgkmcnt(4)
    v_mfma_f32_16x16x32_bf16 v[48:51], a[68:71], a[124:127], v[48:51]
    s_waitcnt lgkmcnt(2)
    v_mfma_f32_16x16x32_bf16 v[52:55], a[72:75], a[124:127], v[52:55]
    s_waitcnt lgkmcnt(0)
    v_mfma_f32_16x16x32_bf16 v[56:59], a[76:79], a[124:127], v[56:59]
    s_mov_b32 exec_lo, 0x00010001
    s_mov_b32 exec_hi, 0x00010001
    ds_write_b128 v6, v[28:31] offset:0
    ds_write_b128 v6, v[32:35] offset:64
    ds_write_b128 v6, v[36:39] offset:128
    ds_write_b128 v6, v[40:43] offset:192
    ds_write_b128 v6, v[44:47] offset:256
    ds_write_b128 v6, v[48:51] offset:320
    ds_write_b128 v6, v[52:55] offset:384
    ds_write_b128 v6, v[56:59] offset:448
    ds_write_b32 v7, v7
    s_mov_b64 exec, -1
    ds_read_b128 v[76:79], v6 offset:256
    ds_read_b128 v[80:83], v6 offset:320
    ds_read_b128 v[84:87], v6 offset:384
    ds_read_b128 v[88:91], v6 offset:448
    s_waitcnt lgkmcnt(0)
    v_fmac_f32 v44, v76, v120
    v_fmac_f32 v45, v77, v120
    v_fmac_f32 v46, v78, v120
    v_fmac_f32 v47, v79, v120
    v_cvt_pk_bf16_f32 v44, v44, v45
    v_cvt_pk_bf16_f32 v45, v46, v47
    v_fmac_f32 v48, v80, v120
    v_fmac_f32 v49, v81, v120
    v_fmac_f32 v50, v82, v120
    v_fmac_f32 v51, v83, v120
    v_cvt_pk_bf16_f32 v46, v48, v49
    v_cvt_pk_bf16_f32 v47, v50, v51
    v_fmac_f32 v52, v84, v120
    v_fmac_f32 v53, v85, v120
    v_fmac_f32 v54, v86, v120
    v_fmac_f32 v55, v87, v120
    v_cvt_pk_bf16_f32 v48, v52, v53
    v_cvt_pk_bf16_f32 v49, v54, v55
    v_fmac_f32 v56, v88, v120
    v_fmac_f32 v57, v89, v120
    v_fmac_f32 v58, v90, v120
    v_fmac_f32 v59, v91, v120
    v_cvt_pk_bf16_f32 v50, v56, v57
    v_cvt_pk_bf16_f32 v51, v58, v59
    ds_write_b128 v125, v[44:47] offset:4096
    ds_write_b128 v125, v[48:51] offset:5120
    v_mov_b32 v5, 157972
    v_mov_b32 v6, 1
    s_mov_b64 exec, 1
    ds_add_u32 v5, v6
    s_mov_b64 exec, -1
    v_mov_b32 v5, 157980
Lcw_6:
    s_sub_u32 s35, s35, 1
    s_cbranch_scc1 Lend
    ds_read_b32 v6, v5
    s_waitcnt lgkmcnt(0)
    v_readfirstlane_b32 s38, v6
    s_nop 0
    s_cmp_lt_u32 s38, 1
    s_cbranch_scc1 Lcw_6
    ds_read_b64_tr_b16 a[0:1], v24 offset:16384
    ds_read_b64_tr_b16 a[2:3], v24 offset:16896
    ds_read_b64_tr_b16 a[4:5], v25 offset:16384
    ds_read_b64_tr_b16 a[6:7], v25 offset:16896
    ds_read_b64_tr_b16 a[8:9], v26 offset:16384
    ds_read_b64_tr_b16 a[10:11], v26 offset:16896
    ds_read_b64_tr_b16 a[12:13], v27 offset:16384
    ds_read_b64_tr_b16 a[14:15], v27 offset:16896
    ds_read_b64_tr_b16 a[16:17], v24 offset:20480
    ds_read_b64_tr_b16 a[18:19], v24 offset:20992
    ds_read_b64_tr_b16 a[20:21], v25 offset:20480
    ds_read_b64_tr_b16 a[22:23], v25 offset:20992
    ds_read_b64_tr_b16 a[24:25], v26 offset:20480
    ds_read_b64_tr_b16 a[26:27], v26 offset:20992
    ds_read_b64_tr_b16 a[28:29], v27 offset:20480
    ds_read_b64_tr_b16 a[30:31], v27 offset:20992
    ds_read_b64_tr_b16 a[32:33], v24 offset:55424
    ds_read_b64_tr_b16 a[34:35], v24 offset:55936
    ds_read_b64_tr_b16 a[36:37], v25 offset:55424
    ds_read_b64_tr_b16 a[38:39], v25 offset:55936
    ds_read_b64_tr_b16 a[40:41], v26 offset:55424
    ds_read_b64_tr_b16 a[42:43], v26 offset:55936
    ds_read_b64_tr_b16 a[44:45], v27 offset:55424
    ds_read_b64_tr_b16 a[46:47], v27 offset:55936
    ds_read_b64_tr_b16 a[48:49], v24 offset:59520
    ds_read_b64_tr_b16 a[50:51], v24 offset:60032
    ds_read_b64_tr_b16 a[52:53], v25 offset:59520
    ds_read_b64_tr_b16 a[54:55], v25 offset:60032
    ds_read_b64_tr_b16 a[56:57], v26 offset:59520
    ds_read_b64_tr_b16 a[58:59], v26 offset:60032
    ds_read_b64_tr_b16 a[60:61], v27 offset:59520
    ds_read_b64_tr_b16 a[62:63], v27 offset:60032
    ds_read_b64_tr_b16 a[64:65], v20 offset:16384
    ds_read_b64_tr_b16 a[66:67], v20 offset:16896
    ds_read_b64_tr_b16 a[68:69], v21 offset:16384
    ds_read_b64_tr_b16 a[70:71], v21 offset:16896
    ds_read_b64_tr_b16 a[72:73], v22 offset:16384
    ds_read_b64_tr_b16 a[74:75], v22 offset:16896
    ds_read_b64_tr_b16 a[76:77], v23 offset:16384
    ds_read_b64_tr_b16 a[78:79], v23 offset:16896
    ds_read_b64_tr_b16 a[80:81], v20 offset:20480
    ds_read_b64_tr_b16 a[82:83], v20 offset:20992
    ds_read_b64_tr_b16 a[84:85], v21 offset:20480
    ds_read_b64_tr_b16 a[86:87], v21 offset:20992
    ds_read_b64_tr_b16 a[88:89], v22 offset:20480
    ds_read_b64_tr_b16 a[90:91], v22 offset:20992
    ds_read_b64_tr_b16 a[92:93], v23 offset:20480
    ds_read_b64_tr_b16 a[94:95], v23 offset:20992
    s_waitcnt lgkmcnt(15)
    v_mfma_f32_16x16x32_bf16 v[60:63], a[96:99], a[0:3], v[60:63]
    v_mfma_f32_16x16x32_bf16 v[64:67], a[96:99], a[4:7], v[64:67]
    v_mfma_f32_16x16x32_bf16 v[68:71], a[96:99], a[8:11], v[68:71]
    v_mfma_f32_16x16x32_bf16 v[72:75], a[96:99], a[12:15], v[72:75]
    ds_read_b64_tr_b16 a[0:1], v20 offset:55424
    ds_read_b64_tr_b16 a[2:3], v20 offset:55936
    ds_read_b64_tr_b16 a[4:5], v21 offset:55424
    ds_read_b64_tr_b16 a[6:7], v21 offset:55936
    ds_read_b64_tr_b16 a[8:9], v22 offset:55424
    ds_read_b64_tr_b16 a[10:11], v22 offset:55936
    ds_read_b64_tr_b16 a[12:13], v23 offset:55424
    ds_read_b64_tr_b16 a[14:15], v23 offset:55936
    v_mfma_f32_16x16x32_bf16 v[60:63], a[100:103], a[16:19], v[60:63]
    v_mfma_f32_16x16x32_bf16 v[64:67], a[100:103], a[20:23], v[64:67]
    v_mfma_f32_16x16x32_bf16 v[68:71], a[100:103], a[24:27], v[68:71]
    v_mfma_f32_16x16x32_bf16 v[72:75], a[100:103], a[28:31], v[72:75]
    ds_read_b64_tr_b16 a[16:17], v20 offset:59520
    ds_read_b64_tr_b16 a[18:19], v20 offset:60032
    ds_read_b64_tr_b16 a[20:21], v21 offset:59520
    ds_read_b64_tr_b16 a[22:23], v21 offset:60032
    ds_read_b64_tr_b16 a[24:25], v22 offset:59520
    ds_read_b64_tr_b16 a[26:27], v22 offset:60032
    ds_read_b64_tr_b16 a[28:29], v23 offset:59520
    ds_read_b64_tr_b16 a[30:31], v23 offset:60032
    v_mfma_f32_16x16x32_bf16 v[60:63], a[104:107], a[32:35], v[60:63]
    v_mfma_f32_16x16x32_bf16 v[64:67], a[104:107], a[36:39], v[64:67]
    v_mfma_f32_16x16x32_bf16 v[68:71], a[104:107], a[40:43], v[68:71]
    v_mfma_f32_16x16x32_bf16 v[72:75], a[104:107], a[44:47], v[72:75]
    v_mfma_f32_16x16x32_bf16 v[60:63], a[108:111], a[48:51], v[60:63]
    v_mfma_f32_16x16x32_bf16 v[64:67], a[108:111], a[52:55], v[64:67]
    v_mfma_f32_16x16x32_bf16 v[68:71], a[108:111], a[56:59], v[68:71]
    v_mfma_f32_16x16x32_bf16 v[72:75], a[108:111], a[60:63], v[72:75]
    s_waitcnt lgkmcnt(15)
    v_mfma_f32_16x16x32_bf16 v[60:63], a[112:115], a[64:67], v[60:63]
    v_mfma_f32_16x16x32_bf16 v[64:67], a[112:115], a[68:71], v[64:67]
    v_mfma_f32_16x16x32_bf16 v[68:71], a[112:115], a[72:75], v[68:71]
    v_mfma_f32_16x16x32_bf16 v[72:75], a[112:115], a[76:79], v[72:75]
    v_mfma_f32_16x16x32_bf16 v[60:63], a[116:119], a[80:83], v[60:63]
    v_mfma_f32_16x16x32_bf16 v[64:67], a[116:119], a[84:87], v[64:67]
    v_mfma_f32_16x16x32_bf16 v[68:71], a[116:119], a[88:91], v[68:71]
    v_mfma_f32_16x16x32_bf16 v[72:75], a[116:119], a[92:95], v[72:75]
    s_waitcnt lgkmcnt(8)
    v_mfma_f32_16x16x32_bf16 v[60:63], a[120:123], a[0:3], v[60:63]
    v_mfma_f32_16x16x32_bf16 v[64:67], a[120:123], a[4:7], v[64:67]
    v_mfma_f32_16x16x32_bf16 v[68:71], a[120:123], a[8:11], v[68:71]
    v_mfma_f32_16x16x32_bf16 v[72:75], a[120:123], a[12:15], v[72:75]
    s_waitcnt lgkmcnt(0)
    v_mfma_f32_16x16x32_bf16 v[60:63], a[124:127], a[16:19], v[60:63]
    v_mfma_f32_16x16x32_bf16 v[64:67], a[124:127], a[20:23], v[64:67]
    v_mfma_f32_16x16x32_bf16 v[68:71], a[124:127], a[24:27], v[68:71]
    v_mfma_f32_16x16x32_bf16 v[72:75], a[124:127], a[28:31], v[72:75]
    v_lshlrev_b32 v5, 4, v3
    v_add_u32 v5, 157696, v5
    v_mov_b32 v6, 157952
    v_lshlrev_b32 v4, 4, v2
    v_add_u32 v4, 156224, v4
    v_lshl_add_u32 v125, v1, 3, s45
    s_mov_b64 exec, 0xffff
    ds_write_b32 v5, v60 offset:0
    ds_write_b32 v5, v64 offset:4
    ds_write_b32 v5, v68 offset:8
    ds_write_b32 v5, v72 offset:12
    ds_write_b32 v6, v6
    s_mov_b64 exec, -1
    ds_read_b128 v[36:39], v5
    ds_read_b128 v[28:31], v4
    ds_read_b128 v[32:35], v4 offset:512
    s_waitcnt lgkmcnt(0)
    v_fmac_f32 v60, v28, v36
    v_fmac_f32 v61, v29, v36
    v_fmac_f32 v62, v30, v36
    v_fmac_f32 v63, v31, v36
    v_mul_f32 v60, v60, v32
    v_mul_f32 v61, v61, v33
    v_mul_f32 v62, v62, v34
    v_mul_f32 v63, v63, v35
    v_cvt_pk_bf16_f32 v60, v60, v61
    v_cvt_pk_bf16_f32 v61, v62, v63
    ds_write_b64 v125, v[60:61] offset:0
    v_fmac_f32 v64, v28, v37
    v_fmac_f32 v65, v29, v37
    v_fmac_f32 v66, v30, v37
    v_fmac_f32 v67, v31, v37
    v_mul_f32 v64, v64, v32
    v_mul_f32 v65, v65, v33
    v_mul_f32 v66, v66, v34
    v_mul_f32 v67, v67, v35
    v_cvt_pk_bf16_f32 v64, v64, v65
    v_cvt_pk_bf16_f32 v65, v66, v67
    ds_write_b64 v125, v[64:65] offset:512
    v_fmac_f32 v68, v28, v38
    v_fmac_f32 v69, v29, v38
    v_fmac_f32 v70, v30, v38
    v_fmac_f32 v71, v31, v38
    v_mul_f32 v68, v68, v32
    v_mul_f32 v69, v69, v33
    v_mul_f32 v70, v70, v34
    v_mul_f32 v71, v71, v35
    v_cvt_pk_bf16_f32 v68, v68, v69
    v_cvt_pk_bf16_f32 v69, v70, v71
    ds_write_b64 v125, v[68:69] offset:1024
    v_fmac_f32 v72, v28, v39
    v_fmac_f32 v73, v29, v39
    v_fmac_f32 v74, v30, v39
    v_fmac_f32 v75, v31, v39
    v_mul_f32 v72, v72, v32
    v_mul_f32 v73, v73, v33
    v_mul_f32 v74, v74, v34
    v_mul_f32 v75, v75, v35
    v_cvt_pk_bf16_f32 v72, v72, v73
    v_cvt_pk_bf16_f32 v73, v74, v75
    ds_write_b64 v125, v[72:73] offset:1536
    v_mov_b32 v8, 157976
    v_mov_b32 v9, 1
    s_mov_b64 exec, 1
    ds_add_u32 v8, v9
    s_mov_b64 exec, -1
    s_branch Lagent
Lst_re:
    s_sub_u32 s35, s35, 1
    s_cbranch_scc1 Lend
    buffer_load_dwordx2 v[92:93], v96, s[28:31], s46 offen sc1
    buffer_load_dwordx2 v[94:95], v97, s[28:31], s46 offen sc1
    s_waitcnt vmcnt(0)
    s_branch Lst_chk
Laux:
    s_lshl_b32 s32, s37, 3
    s_lshl_b32 s39, s38, 2
    s_add_u32 s32, s32, s36
    s_cmp_lt_u32 s37, 4
    s_cselect_b32 s39, s39, 0
    s_add_u32 s32, s32, s39
    s_and_b32 s33, s2, 3
    s_lshl_b32 s33, s33, 3
    s_and_b32 s39, s2, 4
    s_add_u32 s33, s33, s39
    s_add_u32 s33, s33, s37
    s_cmp_ge_u32 s32, 32
    s_cbranch_scc1 Lmst
    v_lshrrev_b32 v5, 3, v1
    v_and_b32 v6, 7, v1
    s_lshl_b32 s40, s3, 14
    s_cmp_eq_u32 s27, 0
    s_cbranch_scc0 Laux_u
    s_lshl_b32 s36, s33, 6
    s_lshl_b32 s37, s26, 4
    s_add_u32 s36, s36, s37
    v_add_u32 v7, s36, v5
    v_mul_u32_u24 v7, 1280, v7
    v_xor_b32 v8, v6, v2
    v_lshl_add_u32 v92, v8, 4, v7
    v_add_u32 v92, 4096, v92
    v_xor_b32 v93, 64, v92
    v_add_u32 v93, 9216, v93
    v_subrev_u32 v94, 1920, v92
    v_subrev_u32 v95, 1920, v93
    s_waitcnt lgkmcnt(0)
    s_sub_u32 s52, s4, 4096
    s_subb_u32 s53, s5, 0
    s_mov_b32 s54, 2625536
    s_mov_b32 s55, 0x20000
    s_mov_b64 s[60:61], s[12:13]
    s_mov_b32 s62, 1280
    s_mov_b32 s63, 0x20000
    s_mov_b32 m0, 131072
    s_nop 0
    buffer_load_dwordx4 v13, s[60:63], 0 offen lds
    s_mov_b64 exec, 0xffff
    buffer_load_dwordx4 v13, s[60:63], 0 offen offset:1024 lds
    s_mov_b64 exec, -1
    s_add_u32 m0, s40, 0
    s_mov_b32 s41, 0
    buffer_load_dwordx4 v92, s[52:55], s41 offen lds
    buffer_load_dwordx4 v93, s[52:55], s41 offen offset:1024 lds
    buffer_load_dwordx4 v94, s[52:55], s41 offen offset:2048 lds
    buffer_load_dwordx4 v95, s[52:55], s41 offen offset:3072 lds
    s_add_u32 m0, s40, 4096
    s_mov_b32 s41, 256
    buffer_load_dwordx4 v92, s[52:55], s41 offen lds
    buffer_load_dwordx4 v93, s[52:55], s41 offen offset:1024 lds
    buffer_load_dwordx4 v94, s[52:55], s41 offen offset:2048 lds
    buffer_load_dwordx4 v95, s[52:55], s41 offen offset:3072 lds
    s_add_u32 m0, s40, 8192
    s_mov_b32 s41, 512
    buffer_load_dwordx4 v92, s[52:55], s41 offen lds
    buffer_load_dwordx4 v93, s[52:55], s41 offen offset:1024 lds
    buffer_load_dwordx4 v94, s[52:55], s41 offen offset:2048 lds
    buffer_load_dwordx4 v95, s[52:55], s41 offen offset:3072 lds
    s_add_u32 m0, s40, 12288
    s_mov_b32 s41, 768
    buffer_load_dwordx4 v92, s[52:55], s41 offen lds
    buffer_load_dwordx4 v93, s[52:55], s41 offen offset:1024 lds
    buffer_load_dwordx4 v94, s[52:55], s41 offen offset:2048 lds
    buffer_load_dwordx4 v95, s[52:55], s41 offen offset:3072 lds
    s_mov_b64 s[28:29], s[24:25]
    s_mov_b32 s30, 268435456
    s_mov_b32 s31, 0x20000
    s_load_dword s34, s[28:29], 0
    s_mov_b64 s[44:45], s[14:15]
    s_mov_b32 s46, 2211840
    s_mov_b32 s47, 0x20000
    s_mov_b64 s[48:49], s[18:19]
    s_mov_b32 s50, 2211840
    s_mov_b32 s51, 0x20000
    v_and_b32 v8, 1, v2
    v_lshlrev_b32 v8, 1, v8
    v_xor_b32 v8, v8, v6
    v_lshlrev_b32 v8, 4, v8
    v_mul_u32_u24 v9, 3456, v5
    s_lshl_b32 s38, s32, 7
    v_add3_u32 v18, v9, v8, s38
    v_xor_b32 v19, 64, v18
    v_add_u32 v19, 26624, v19
    v_add_u32 v20, 53248, v18
    v_add_u32 v21, 53248, v19
    s_mul_i32 s42, s26, 110592
    v_mul_u32_u24 v9, 1280, v5
    v_add_u32 v22, v9, v8
    v_xor_b32 v23, 64, v22
    v_add_u32 v23, 9216, v23
    v_add_u32 v24, 18432, v22
    v_add_u32 v25, 18432, v23
    s_mul_i32 s43, s32, 81920
    s_lshl_b32 s38, s3, 7
    s_add_u32 s43, s43, s38
    v_mov_b32 v96, 0x3f803f80
    v_mov_b32 v97, 0x3f803f80
    v_mov_b32 v98, 0x3f803f80
    v_mov_b32 v99, 0x3f803f80
    v_lshlrev_b32 v100, 4, v2
    v_add_u32 v100, 131072, v100
    v_lshrrev_b32 v10, 1, v3
    v_xor_b32 v10, v10, v2
    v_lshlrev_b32 v10, 4, v10
    v_lshl_add_u32 v10, v3, 7, v10
    v_add_u32 v102, s40, v10
    v_xor_b32 v103, 64, v102
    s_mov_b32 s58, 0xaaaaaaaa
    s_mov_b32 s59, 0xaaaaaaaa
    s_mov_b32 s64, 0xcccccccc
    s_mov_b32 s65, 0xcccccccc
    v_lshrrev_b32 v101, 2, v3
    v_lshl_add_u32 v101, v101, 4, v3
    v_lshlrev_b32 v101, 2, v101
    s_lshl_b32 s36, s26, 4
    v_add_u32 v10, s36, v3
    s_lshl_b32 s37, s33, 6
    s_sub_u32 s37, 2047, s37
    v_sub_u32 v106, s37, v10
    v_lshlrev_b32 v107, 2, v10
    v_add_u32 v107, 132608, v107
    s_lshl_b32 s36, s33, 9
    s_add_u32 s36, s36, 8192000
    v_lshl_add_u32 v108, v10, 3, s36
    v_bfe_u32 v10, v1, 2, 2
    v_and_b32 v8, 3, v1
    v_lshl_add_u32 v14, v2, 3, v10
    v_lshlrev_b32 v14, 7, v14
    v_lshlrev_b32 v9, 2, v1
    v_and_b32 v9, 0x60, v9
    v_add3_u32 v14, v14, v9, s40
    v_lshl_add_u32 v14, v8, 3, v14
    v_xor_b32 v15, 32, v14
    v_xor_b32 v16, 64, v14
    v_xor_b32 v17, 96, v14
    s_lshl_b32 s36, s26, 6
    s_add_u32 s36, s36, 141312
    v_lshl_add_u32 v26, v2, 4, s36
    v_min_u32 v8, 2, v3
    v_mul_u32_u24 v8, 1536, v8
    v_add_u32 v26, v26, v8
    v_add_u32 v4, 132864, v12
    v_mov_b32 v5, 0
    ds_write_b32 v4, v5
    s_waitcnt lgkmcnt(0)
    s_add_u32 s34, s34, 0x9e3779b8
    s_or_b32 s34, s34, 1
    s_waitcnt vmcnt(12)
    ds_read_b128 a[80:83], v102 offset:0
    ds_read_b128 a[84:87], v100 offset:0
    ds_read_b128 a[88:91], v103 offset:0
    ds_read_b128 a[92:95], v100 offset:64
    ds_read_b128 a[96:99], v102 offset:2048
    ds_read_b128 a[100:103], v100 offset:128
    ds_read_b128 a[104:107], v103 offset:2048
    ds_read_b128 a[108:111], v100 offset:192
    s_waitcnt lgkmcnt(0)
    s_add_u32 m0, s40, 0
    s_mov_b32 s41, 1024
    buffer_load_dwordx4 v92, s[52:55], s41 offen lds
    buffer_load_dwordx4 v93, s[52:55], s41 offen offset:1024 lds
    buffer_load_dwordx4 v94, s[52:55], s41 offen offset:2048 lds
    buffer_load_dwordx4 v95, s[52:55], s41 offen offset:3072 lds
    s_barrier
    v_mfma_f32_16x16x32_bf16 v[116:119], a[80:83], a[80:83], 0
    v_mfma_f32_16x16x32_bf16 v[112:115], v[96:99], a[80:83], 0
    v_mfma_f32_16x16x32_bf16 v[120:123], a[84:87], a[80:83], 0
    v_mfma_f32_16x16x32_bf16 v[124:127], a[84:87], v[96:99], 0
    v_mfma_f32_16x16x32_bf16 v[116:119], a[88:91], a[88:91], v[116:119]
    v_mfma_f32_16x16x32_bf16 v[112:115], v[96:99], a[88:91], v[112:115]
    v_mfma_f32_16x16x32_bf16 v[120:123], a[92:95], a[88:91], v[120:123]
    v_mfma_f32_16x16x32_bf16 v[124:127], a[92:95], v[96:99], v[124:127]
    v_mfma_f32_16x16x32_bf16 v[116:119], a[96:99], a[96:99], v[116:119]
    v_mfma_f32_16x16x32_bf16 v[112:115], v[96:99], a[96:99], v[112:115]
    v_mfma_f32_16x16x32_bf16 v[120:123], a[100:103], a[96:99], v[120:123]
    v_mfma_f32_16x16x32_bf16 v[124:127], a[100:103], v[96:99], v[124:127]
    v_mfma_f32_16x16x32_bf16 v[116:119], a[104:107], a[104:107], v[116:119]
    v_mfma_f32_16x16x32_bf16 v[112:115], v[96:99], a[104:107], v[112:115]
    v_mfma_f32_16x16x32_bf16 v[120:123], a[108:111], a[104:107], v[120:123]
    v_mfma_f32_16x16x32_bf16 v[124:127], a[108:111], v[96:99], v[124:127]
    s_waitcnt vmcnt(12)
    ds_read_b128 a[80:83], v102 offset:4096
    ds_read_b128 a[84:87], v100 offset:256
    ds_read_b128 a[88:91], v103 offset:4096
    ds_read_b128 a[92:95], v100 offset:320
    ds_read_b128 a[96:99], v102 offset:6144
    ds_read_b128 a[100:103], v100 offset:384
    ds_read_b128 a[104:107], v103 offset:6144
    ds_read_b128 a[108:111], v100 offset:448
    s_waitcnt lgkmcnt(0)
    v_mfma_f32_16x16x32_bf16 v[116:119], a[80:83], a[80:83], v[116:119]
    v_mfma_f32_16x16x32_bf16 v[112:115], v[96:99], a[80:83], v[112:115]
    v_mfma_f32_16x16x32_bf16 v[120:123], a[84:87], a[80:83], v[120:123]
    v_mfma_f32_16x16x32_bf16 v[124:127], a[84:87], v[96:99], v[124:127]
    v_mfma_f32_16x16x32_bf16 v[116:119], a[88:91], a[88:91], v[116:119]
    v_mfma_f32_16x16x32_bf16 v[112:115], v[96:99], a[88:91], v[112:115]
    v_mfma_f32_16x16x32_bf16 v[120:123], a[92:95], a[88:91], v[120:123]
    v_mfma_f32_16x16x32_bf16 v[124:127], a[92:95], v[96:99], v[124:127]
    v_mfma_f32_16x16x32_bf16 v[116:119], a[96:99], a[96:99], v[116:119]
    v_mfma_f32_16x16x32_bf16 v[112:115], v[96:99], a[96:99], v[112:115]
    v_mfma_f32_16x16x32_bf16 v[120:123], a[100:103], a[96:99], v[120:123]
    v_mfma_f32_16x16x32_bf16 v[124:127], a[100:103], v[96:99], v[124:127]
    v_mfma_f32_16x16x32_bf16 v[116:119], a[104:107], a[104:107], v[116:119]
    v_mfma_f32_16x16x32_bf16 v[112:115], v[96:99], a[104:107], v[112:115]
    v_mfma_f32_16x16x32_bf16 v[120:123], a[108:111], a[104:107], v[120:123]
    v_mfma_f32_16x16x32_bf16 v[124:127], a[108:111], v[96:99], v[124:127]
    s_waitcnt vmcnt(8)
    ds_read_b128 a[80:83], v102 offset:8192
    ds_read_b128 a[84:87], v100 offset:512
    ds_read_b128 a[88:91], v103 offset:8192
    ds_read_b128 a[92:95], v100 offset:576
    ds_read_b128 a[96:99], v102 offset:10240
    ds_read_b128 a[100:103], v100 offset:640
    ds_read_b128 a[104:107], v103 offset:10240
    ds_read_b128 a[108:111], v100 offset:704
    s_waitcnt lgkmcnt(0)
    v_mfma_f32_16x16x32_bf16 v[116:119], a[80:83], a[80:83], v[116:119]
    v_mfma_f32_16x16x32_bf16 v[112:115], v[96:99], a[80:83], v[112:115]
    v_mfma_f32_16x16x32_bf16 v[120:123], a[84:87], a[80:83], v[120:123]
    v_mfma_f32_16x16x32_bf16 v[124:127], a[84:87], v[96:99], v[124:127]
    v_mfma_f32_16x16x32_bf16 v[116:119], a[88:91], a[88:91], v[116:119]
    v_mfma_f32_16x16x32_bf16 v[112:115], v[96:99], a[88:91], v[112:115]
    v_mfma_f32_16x16x32_bf16 v[120:123], a[92:95], a[88:91], v[120:123]
    v_mfma_f32_16x16x32_bf16 v[124:127], a[92:95], v[96:99], v[124:127]
    v_mfma_f32_16x16x32_bf16 v[116:119], a[96:99], a[96:99], v[116:119]
    v_mfma_f32_16x16x32_bf16 v[112:115], v[96:99], a[96:99], v[112:115]
    v_mfma_f32_16x16x32_bf16 v[120:123], a[100:103], a[96:99], v[120:123]
    v_mfma_f32_16x16x32_bf16 v[124:127], a[100:103], v[96:99], v[124:127]
    v_mfma_f32_16x16x32_bf16 v[116:119], a[104:107], a[104:107], v[116:119]
    v_mfma_f32_16x16x32_bf16 v[112:115], v[96:99], a[104:107], v[112:115]
    v_mfma_f32_16x16x32_bf16 v[120:123], a[108:111], a[104:107], v[120:123]
    v_mfma_f32_16x16x32_bf16 v[124:127], a[108:111], v[96:99], v[124:127]
    s_waitcnt vmcnt(4)
    ds_read_b128 a[80:83], v102 offset:12288
    ds_read_b128 a[84:87], v100 offset:768
    ds_read_b128 a[88:91], v103 offset:12288
    ds_read_b128 a[92:95], v100 offset:832
    ds_read_b128 a[96:99], v102 offset:14336
    ds_read_b128 a[100:103], v100 offset:896
    ds_read_b128 a[104:107], v103 offset:14336
    ds_read_b128 a[108:111], v100 offset:960
    s_waitcnt lgkmcnt(0)
    v_mfma_f32_16x16x32_bf16 v[116:119], a[80:83], a[80:83], v[116:119]
    v_mfma_f32_16x16x32_bf16 v[112:115], v[96:99], a[80:83], v[112:115]
    v_mfma_f32_16x16x32_bf16 v[120:123], a[84:87], a[80:83], v[120:123]
    v_mfma_f32_16x16x32_bf16 v[124:127], a[84:87], v[96:99], v[124:127]
    v_mfma_f32_16x16x32_bf16 v[116:119], a[88:91], a[88:91], v[116:119]
    v_mfma_f32_16x16x32_bf16 v[112:115], v[96:99], a[88:91], v[112:115]
    v_mfma_f32_16x16x32_bf16 v[120:123], a[92:95], a[88:91], v[120:123]
    v_mfma_f32_16x16x32_bf16 v[124:127], a[92:95], v[96:99], v[124:127]
    v_mfma_f32_16x16x32_bf16 v[116:119], a[96:99], a[96:99], v[116:119]
    v_mfma_f32_16x16x32_bf16 v[112:115], v[96:99], a[96:99], v[112:115]
    v_mfma_f32_16x16x32_bf16 v[120:123], a[100:103], a[96:99], v[120:123]
    v_mfma_f32_16x16x32_bf16 v[124:127], a[100:103], v[96:99], v[124:127]
    v_mfma_f32_16x16x32_bf16 v[116:119], a[104:107], a[104:107], v[116:119]
    v_mfma_f32_16x16x32_bf16 v[112:115], v[96:99], a[104:107], v[112:115]
    v_mfma_f32_16x16x32_bf16 v[120:123], a[108:111], a[104:107], v[120:123]
    v_mfma_f32_16x16x32_bf16 v[124:127], a[108:111], v[96:99], v[124:127]
    s_waitcnt vmcnt(0)
    ds_read_b128 a[80:83], v102 offset:0
    ds_read_b128 a[84:87], v100 offset:1024
    ds_read_b128 a[88:91], v103 offset:0
    ds_read_b128 a[92:95], v100 offset:1088
    ds_read_b128 a[96:99], v102 offset:2048
    ds_read_b128 a[100:103], v100 offset:1152
    ds_read_b128 a[104:107], v103 offset:2048
    ds_read_b128 a[108:111], v100 offset:1216
    s_waitcnt lgkmcnt(0)
    v_mfma_f32_16x16x32_bf16 v[116:119], a[80:83], a[80:83], v[116:119]
    v_mfma_f32_16x16x32_bf16 v[112:115], v[96:99], a[80:83], v[112:115]
    v_mfma_f32_16x16x32_bf16 v[120:123], a[84:87], a[80:83], v[120:123]
    v_mfma_f32_16x16x32_bf16 v[124:127], a[84:87], v[96:99], v[124:127]
    v_mfma_f32_16x16x32_bf16 v[116:119], a[88:91], a[88:91], v[116:119]
    v_mfma_f32_16x16x32_bf16 v[112:115], v[96:99], a[88:91], v[112:115]
    v_mfma_f32_16x16x32_bf16 v[120:123], a[92:95], a[88:91], v[120:123]
    v_mfma_f32_16x16x32_bf16 v[124:127], a[92:95], v[96:99], v[124:127]
    v_mfma_f32_16x16x32_bf16 v[116:119], a[96:99], a[96:99], v[116:119]
    v_mfma_f32_16x16x32_bf16 v[112:115], v[96:99], a[96:99], v[112:115]
    v_mfma_f32_16x16x32_bf16 v[120:123], a[100:103], a[96:99], v[120:123]
    v_mfma_f32_16x16x32_bf16 v[124:127], a[100:103], v[96:99], v[124:127]
    v_mfma_f32_16x16x32_bf16 v[116:119], a[104:107], a[104:107], v[116:119]
    v_mfma_f32_16x16x32_bf16 v[112:115], v[96:99], a[104:107], v[112:115]
    v_mfma_f32_16x16x32_bf16 v[120:123], a[108:111], a[104:107], v[120:123]
    v_mfma_f32_16x16x32_bf16 v[124:127], a[108:111], v[96:99], v[124:127]
    s_nop 4
    v_cndmask_b32 v4, v116, v117, s[58:59]
    v_cndmask_b32 v5, v118, v119, s[58:59]
    v_cndmask_b32 v4, v4, v5, s[64:65]
    ds_bpermute_b32 v4, v101, v4
    v_mul_f32 v5, 0xbacccccd, v112
    v_cvt_pk_bf16_f32 v104, v5, v5
    v_lshlrev_b32 v104, 16, v104
    v_mul_f32 v5, v5, v5
    v_mov_b32 v6, 0x3acccccd
    s_waitcnt lgkmcnt(0)
    v_fma_f32 v4, v4, v6, -v5
    v_max_f32 v4, 0, v4
    v_cvt_pk_bf16_f32 v4, v4, v4
    v_lshlrev_b32 v4, 16, v4
    v_add_f32 v4, 0x3727c5ac, v4
    v_cvt_pk_bf16_f32 v4, v4, v4
    v_lshlrev_b32 v4, 16, v4
    v_sqrt_f32 v4, v4
    s_nop 0
    v_cvt_pk_bf16_f32 v4, v4, v4
    v_lshlrev_b32 v4, 16, v4
    v_rcp_f32 v105, v4
    v_lshrrev_b32 v8, 16, v4
    v_fma_f32 v4, v104, v124, v120
    v_mul_f32 v4, v4, v105
    v_cvt_pk_bf16_f32 v4, v4, v4
    v_ashrrev_i32 v5, 31, v4
    v_or_b32 v5, 0x80000000, v5
    v_xor_b32 v4, v4, v5
    v_and_b32 v4, 0xffff0000, v4
    v_or_b32 v4, v4, v106
    ds_write_b32 v107, v4
    v_mov_b32 v11, 132864
    v_mov_b32 v7, 1
    s_mov_b64 exec, 1
    ds_add_u32 v11, v7
    s_mov_b64 exec, -1
    v_or_b32 v8, v8, v104
    v_mov_b32 v9, s34
    s_mov_b64 exec, 0xffff
    buffer_store_dwordx2 v[8:9], v108, s[28:31], 0 offen sc1
    s_mov_b64 exec, -1
    s_cmp_lg_u32 s26, 0
    s_cbranch_scc1 Lpub_done
    s_setprio 3
Lcw_9:
    s_sub_u32 s35, s35, 1
    s_cbranch_scc1 Lend
    ds_read_b32 v7, v11
    s_waitcnt lgkmcnt(0)
    v_readfirstlane_b32 s38, v7
    s_nop 0
    s_cmp_lt_u32 s38, 4
    s_cbranch_scc1 Lcw_9
    v_add_u32 v5, 132608, v12
    ds_read_b32 v6, v5
    s_waitcnt lgkmcnt(0)
    v_mov_b32 v4, v6
    s_nop 1
    v_max_u32_dpp v4, v4, v4 row_ror:8 row_mask:0xf bank_mask:0xf
    s_nop 1
    v_max_u32_dpp v4, v4, v4 row_ror:4 row_mask:0xf bank_mask:0xf
    s_nop 1
    v_max_u32_dpp v4, v4, v4 row_ror:2 row_mask:0xf bank_mask:0xf
    s_nop 1
    v_max_u32_dpp v4, v4, v4 row_ror:1 row_mask:0xf bank_mask:0xf
    s_nop 0
    v_readlane_b32 s66, v4, 0
    v_readlane_b32 s36, v4, 16
    v_readlane_b32 s37, v4, 32
    v_readlane_b32 s38, v4, 48
    s_max_u32 s66, s66, s36
    s_max_u32 s37, s37, s38
    s_max_u32 s66, s66, s37
    v_cmp_eq_u32 vcc, s66, v6
    s_nop 1
    v_cndmask_b32 v4, v6, 0, vcc
    s_nop 1
    v_max_u32_dpp v4, v4, v4 row_ror:8 row_mask:0xf bank_mask:0xf
    s_nop 1
    v_max_u32_dpp v4, v4, v4 row_ror:4 row_mask:0xf bank_mask:0xf
    s_nop 1
    v_max_u32_dpp v4, v4, v4 row_ror:2 row_mask:0xf bank_mask:0xf
    s_nop 1
    v_max_u32_dpp v4, v4, v4 row_ror:1 row_mask:0xf bank_mask:0xf
    s_nop 0
    v_readlane_b32 s67, v4, 0
    v_readlane_b32 s36, v4, 16
    v_readlane_b32 s37, v4, 32
    v_readlane_b32 s38, v4, 48
    s_max_u32 s67, s67, s36
    s_max_u32 s37, s37, s38
    s_max_u32 s67, s67, s37
    v_mov_b32 v112, s66
    v_mov_b32 v113, s34
    v_mov_b32 v114, s67
    v_mov_b32 v115, s34
    s_lshl_b32 s36, s32, 7
    s_add_u32 s36, s36, 8126464
    s_mov_b64 exec, 0xff
    buffer_store_dwordx4 v[112:115], v13, s[28:31], s36 offen sc1
    s_mov_b64 exec, -1
    v_mov_b32 v11, 132864
    v_mov_b32 v7, 1
    s_mov_b64 exec, 1
    ds_add_u32 v11, v7
    s_mov_b64 exec, -1
    s_mov_b64 exec, 1
    s_lshl_b32 s36, s2, 2
    s_add_u32 s36, s36, 8323072
    v_mov_b32 v4, s34
    v_mov_b32 v5, s36
    buffer_store_dword v4, v5, s[28:31], 0 offen sc1
    s_mov_b64 exec, -1
    s_setprio 0
Lpub_done:
Lcw_10:
    s_sub_u32 s35, s35, 1
    s_cbranch_scc1 Lend
    ds_read_b32 v7, v11
    s_waitcnt lgkmcnt(0)
    v_readfirstlane_b32 s38, v7
    s_nop 0
    s_cmp_lt_u32 s38, 5
    s_cbranch_scc1 Lcw_10
    s_cmp_ge_u32 s32, 27
    s_cbranch_scc1 Lhelp_r
    s_add_u32 m0, s40, 0
    s_add_u32 s41, s42, 0
    buffer_load_dwordx4 v18, s[44:47], s41 offen nt lds
    buffer_load_dwordx4 v19, s[44:47], s41 offen offset:1024 nt lds
    buffer_load_dwordx4 v20, s[44:47], s41 offen offset:2048 nt lds
    buffer_load_dwordx4 v21, s[44:47], s41 offen offset:3072 nt lds
    s_add_u32 m0, s40, 4096
    s_add_u32 s41, s42, 442368
    buffer_load_dwordx4 v18, s[44:47], s41 offen nt lds
    buffer_load_dwordx4 v19, s[44:47], s41 offen offset:1024 nt lds
    buffer_load_dwordx4 v20, s[44:47], s41 offen offset:2048 nt lds
    buffer_load_dwordx4 v21, s[44:47], s41 offen offset:3072 nt lds
    s_add_u32 m0, s40, 8192
    s_add_u32 s41, s42, 884736
    buffer_load_dwordx4 v18, s[44:47], s41 offen nt lds
    buffer_load_dwordx4 v19, s[44:47], s41 offen offset:1024 nt lds
    buffer_load_dwordx4 v20, s[44:47], s41 offen offset:2048 nt lds
    buffer_load_dwordx4 v21, s[44:47], s41 offen offset:3072 nt lds
    s_add_u32 m0, s40, 12288
    s_add_u32 s41, s42, 1327104
    buffer_load_dwordx4 v18, s[44:47], s41 offen nt lds
    buffer_load_dwordx4 v19, s[44:47], s41 offen offset:1024 nt lds
    buffer_load_dwordx4 v20, s[44:47], s41 offen offset:2048 nt lds
    buffer_load_dwordx4 v21, s[44:47], s41 offen offset:3072 nt lds
    s_waitcnt vmcnt(12)
    ds_read_b64_tr_b16 a[0:1], v14 offset:0
    ds_read_b64_tr_b16 a[2:3], v14 offset:512
    ds_read_b64_tr_b16 a[4:5], v15 offset:0
    ds_read_b64_tr_b16 a[6:7], v15 offset:512
    ds_read_b64_tr_b16 a[8:9], v16 offset:0
    ds_read_b64_tr_b16 a[10:11], v16 offset:512
    ds_read_b64_tr_b16 a[12:13], v17 offset:0
    ds_read_b64_tr_b16 a[14:15], v17 offset:512
    s_waitcnt lgkmcnt(0)
    s_add_u32 m0, s40, 0
    s_add_u32 s41, s42, 1769472
    buffer_load_dwordx4 v18, s[44:47], s41 offen nt lds
    buffer_load_dwordx4 v19, s[44:47], s41 offen offset:1024 nt lds
    buffer_load_dwordx4 v20, s[44:47], s41 offen offset:2048 nt lds
    buffer_load_dwordx4 v21, s[44:47], s41 offen offset:3072 nt lds
    v_mov_b32 v11, 132864
    v_mov_b32 v7, 1
    s_mov_b64 exec, 1
    ds_add_u32 v11, v7
    s_mov_b64 exec, -1
    s_waitcnt vmcnt(12)
    ds_read_b64_tr_b16 a[16:17], v14 offset:4096
    ds_read_b64_tr_b16 a[18:19], v14 offset:4608
    ds_read_b64_tr_b16 a[20:21], v15 offset:4096
    ds_read_b64_tr_b16 a[22:23], v15 offset:4608
    ds_read_b64_tr_b16 a[24:25], v16 offset:4096
    ds_read_b64_tr_b16 a[26:27], v16 offset:4608
    ds_read_b64_tr_b16 a[28:29], v17 offset:4096
    ds_read_b64_tr_b16 a[30:31], v17 offset:4608
    s_waitcnt lgkmcnt(0)
    s_add_u32 m0, s40, 4096
    s_add_u32 s41, s43, 0
    buffer_load_dwordx4 v22, s[48:51], s41 offen nt lds
    buffer_load_dwordx4 v23, s[48:51], s41 offen offset:1024 nt lds
    buffer_load_dwordx4 v24, s[48:51], s41 offen offset:2048 nt lds
    buffer_load_dwordx4 v25, s[48:51], s41 offen offset:3072 nt lds
    s_waitcnt vmcnt(12)
    ds_read_b64_tr_b16 a[32:33], v14 offset:8192
    ds_read_b64_tr_b16 a[34:35], v14 offset:8704
    ds_read_b64_tr_b16 a[36:37], v15 offset:8192
    ds_read_b64_tr_b16 a[38:39], v15 offset:8704
    ds_read_b64_tr_b16 a[40:41], v16 offset:8192
    ds_read_b64_tr_b16 a[42:43], v16 offset:8704
    ds_read_b64_tr_b16 a[44:45], v17 offset:8192
    ds_read_b64_tr_b16 a[46:47], v17 offset:8704
    s_waitcnt lgkmcnt(0)
    s_add_u32 m0, s40, 8192
    s_add_u32 s41, s43, 40960
    buffer_load_dwordx4 v22, s[48:51], s41 offen nt lds
    buffer_load_dwordx4 v23, s[48:51], s41 offen offset:1024 nt lds
    buffer_load_dwordx4 v24, s[48:51], s41 offen offset:2048 nt lds
    buffer_load_dwordx4 v25, s[48:51], s41 offen offset:3072 nt lds
    s_waitcnt vmcnt(12)
    ds_read_b64_tr_b16 a[48:49], v14 offset:12288
    ds_read_b64_tr_b16 a[50:51], v14 offset:12800
    ds_read_b64_tr_b16 a[52:53], v15 offset:12288
    ds_read_b64_tr_b16 a[54:55], v15 offset:12800
    ds_read_b64_tr_b16 a[56:57], v16 offset:12288
    ds_read_b64_tr_b16 a[58:59], v16 offset:12800
    ds_read_b64_tr_b16 a[60:61], v17 offset:12288
    ds_read_b64_tr_b16 a[62:63], v17 offset:12800
    s_waitcnt vmcnt(8)
    ds_read_b64_tr_b16 a[64:65], v14 offset:0
    ds_read_b64_tr_b16 a[66:67], v14 offset:512
    ds_read_b64_tr_b16 a[68:69], v15 offset:0
    ds_read_b64_tr_b16 a[70:71], v15 offset:512
    ds_read_b64_tr_b16 a[72:73], v16 offset:0
    ds_read_b64_tr_b16 a[74:75], v16 offset:512
    ds_read_b64_tr_b16 a[76:77], v17 offset:0
    ds_read_b64_tr_b16 a[78:79], v17 offset:512
    s_branch Laux_mm
Laux_u:
    s_cmp_ge_u32 s32, 27
    s_cbranch_scc1 Lend
    v_and_b32 v8, 1, v2
    v_lshlrev_b32 v8, 1, v8
    v_xor_b32 v8, v8, v6
    v_lshlrev_b32 v8, 4, v8
    v_mul_u32_u24 v9, 3456, v5
    s_lshl_b32 s38, s32, 7
    v_add3_u32 v18, v9, v8, s38
    v_xor_b32 v19, 64, v18
    v_add_u32 v19, 26624, v19
    v_add_u32 v20, 53248, v18
    v_add_u32 v21, 53248, v19
    s_mul_i32 s42, s26, 110592
    v_mul_u32_u24 v9, 1280, v5
    v_add_u32 v22, v9, v8
    v_xor_b32 v23, 64, v22
    v_add_u32 v23, 9216, v23
    v_add_u32 v24, 18432, v22
    v_add_u32 v25, 18432, v23
    s_mul_i32 s43, s32, 81920
    s_lshl_b32 s38, s3, 7
    s_add_u32 s43, s43, s38
    s_waitcnt lgkmcnt(0)
    s_mov_b64 s[44:45], s[16:17]
    s_mov_b32 s46, 2211840
    s_mov_b32 s47, 0x20000
    s_mov_b64 s[28:29], s[24:25]
    s_mov_b32 s30, 268435456
    s_mov_b32 s31, 0x20000
    s_load_dword s34, s[28:29], 0
    s_mov_b64 s[52:53], s[4:5]
    s_mov_b32 s54, 2621440
    s_mov_b32 s55, 0x20000
    s_mov_b64 s[48:49], s[18:19]
    s_mov_b32 s50, 2211840
    s_mov_b32 s51, 0x20000
    s_mov_b64 s[68:69], s[18:19]
    s_mov_b32 s70, 2211840
    s_mov_b32 s71, 0x20000
    s_cmp_ge_u32 s26, 2
    s_cselect_b32 s70, 0, s70
    v_bfe_u32 v10, v1, 2, 2
    v_and_b32 v8, 3, v1
    v_lshl_add_u32 v14, v2, 3, v10
    v_lshlrev_b32 v14, 7, v14
    v_lshlrev_b32 v9, 2, v1
    v_and_b32 v9, 0x60, v9
    v_add3_u32 v14, v14, v9, s40
    v_lshl_add_u32 v14, v8, 3, v14
    v_xor_b32 v15, 32, v14
    v_xor_b32 v16, 64, v14
    v_xor_b32 v17, 96, v14
    s_lshl_b32 s36, s26, 6
    s_add_u32 s36, s36, 141312
    v_lshl_add_u32 v26, v2, 4, s36
    v_min_u32 v8, 2, v3
    v_mul_u32_u24 v8, 1536, v8
    v_add_u32 v26, v26, v8
    s_waitcnt lgkmcnt(0)
    s_add_u32 s34, s34, 0x9e3779b8
    s_or_b32 s34, s34, 1
    s_cmp_lg_u32 s3, 7
    s_cbranch_scc1 Lnop7
    s_setprio 3
Lnop7:
    s_barrier
    s_add_u32 m0, s40, 0
    s_add_u32 s41, s42, 0
    buffer_load_dwordx4 v18, s[44:47], s41 offen nt lds
    buffer_load_dwordx4 v19, s[44:47], s41 offen offset:1024 nt lds
    buffer_load_dwordx4 v20, s[44:47], s41 offen offset:2048 nt lds
    buffer_load_dwordx4 v21, s[44:47], s41 offen offset:3072 nt lds
    s_add_u32 m0, s40, 4096
    s_add_u32 s41, s42, 442368
    buffer_load_dwordx4 v18, s[44:47], s41 offen nt lds
    buffer_load_dwordx4 v19, s[44:47], s41 offen offset:1024 nt lds
    buffer_load_dwordx4 v20, s[44:47], s41 offen offset:2048 nt lds
    buffer_load_dwordx4 v21, s[44:47], s41 offen offset:3072 nt lds
    s_add_u32 m0, s40, 8192
    s_add_u32 s41, s42, 884736
    buffer_load_dwordx4 v18, s[44:47], s41 offen nt lds
    buffer_load_dwordx4 v19, s[44:47], s41 offen offset:1024 nt lds
    buffer_load_dwordx4 v20, s[44:47], s41 offen offset:2048 nt lds
    buffer_load_dwordx4 v21, s[44:47], s41 offen offset:3072 nt lds
    s_add_u32 m0, s40, 12288
    s_add_u32 s41, s42, 1327104
    buffer_load_dwordx4 v18, s[44:47], s41 offen nt lds
    buffer_load_dwordx4 v19, s[44:47], s41 offen offset:1024 nt lds
    buffer_load_dwordx4 v20, s[44:47], s41 offen offset:2048 nt lds
    buffer_load_dwordx4 v21, s[44:47], s41 offen offset:3072 nt lds
    v_mov_b32 v11, 132864
Lcw_11:
    s_sub_u32 s35, s35, 1
    s_cbranch_scc1 Lend
    s_sleep 4
    ds_read_b32 v7, v11
    s_waitcnt lgkmcnt(0)
    v_readfirstlane_b32 s38, v7
    s_nop 0
    s_cmp_lt_u32 s38, 5
    s_cbranch_scc1 Lcw_11
    s_waitcnt vmcnt(12)
    ds_read_b64_tr_b16 a[0:1], v14 offset:0
    ds_read_b64_tr_b16 a[2:3], v14 offset:512
    ds_read_b64_tr_b16 a[4:5], v15 offset:0
    ds_read_b64_tr_b16 a[6:7], v15 offset:512
    ds_read_b64_tr_b16 a[8:9], v16 offset:0
    ds_read_b64_tr_b16 a[10:11], v16 offset:512
    ds_read_b64_tr_b16 a[12:13], v17 offset:0
    ds_read_b64_tr_b16 a[14:15], v17 offset:512
    s_waitcnt lgkmcnt(0)
    s_add_u32 m0, s40, 0
    s_add_u32 s41, s42, 1769472
    buffer_load_dwordx4 v18, s[44:47], s41 offen nt lds
    buffer_load_dwordx4 v19, s[44:47], s41 offen offset:1024 nt lds
    buffer_load_dwordx4 v20, s[44:47], s41 offen offset:2048 nt lds
    buffer_load_dwordx4 v21, s[44:47], s41 offen offset:3072 nt lds
    s_waitcnt vmcnt(12)
    ds_read_b64_tr_b16 a[16:17], v14 offset:4096
    ds_read_b64_tr_b16 a[18:19], v14 offset:4608
    ds_read_b64_tr_b16 a[20:21], v15 offset:4096
    ds_read_b64_tr_b16 a[22:23], v15 offset:4608
    ds_read_b64_tr_b16 a[24:25], v16 offset:4096
    ds_read_b64_tr_b16 a[26:27], v16 offset:4608
    ds_read_b64_tr_b16 a[28:29], v17 offset:4096
    ds_read_b64_tr_b16 a[30:31], v17 offset:4608
    s_waitcnt vmcnt(8)
    ds_read_b64_tr_b16 a[32:33], v14 offset:8192
    ds_read_b64_tr_b16 a[34:35], v14 offset:8704
    ds_read_b64_tr_b16 a[36:37], v15 offset:8192
    ds_read_b64_tr_b16 a[38:39], v15 offset:8704
    ds_read_b64_tr_b16 a[40:41], v16 offset:8192
    ds_read_b64_tr_b16 a[42:43], v16 offset:8704
    ds_read_b64_tr_b16 a[44:45], v17 offset:8192
    ds_read_b64_tr_b16 a[46:47], v17 offset:8704
    s_waitcnt vmcnt(4)
    ds_read_b64_tr_b16 a[48:49], v14 offset:12288
    ds_read_b64_tr_b16 a[50:51], v14 offset:12800
    ds_read_b64_tr_b16 a[52:53], v15 offset:12288
    ds_read_b64_tr_b16 a[54:55], v15 offset:12800
    ds_read_b64_tr_b16 a[56:57], v16 offset:12288
    ds_read_b64_tr_b16 a[58:59], v16 offset:12800
    ds_read_b64_tr_b16 a[60:61], v17 offset:12288
    ds_read_b64_tr_b16 a[62:63], v17 offset:12800
    s_waitcnt vmcnt(0)
    ds_read_b64_tr_b16 a[64:65], v14 offset:0
    ds_read_b64_tr_b16 a[66:67], v14 offset:512
    ds_read_b64_tr_b16 a[68:69], v15 offset:0
    ds_read_b64_tr_b16 a[70:71], v15 offset:512
    ds_read_b64_tr_b16 a[72:73], v16 offset:0
    ds_read_b64_tr_b16 a[74:75], v16 offset:512
    ds_read_b64_tr_b16 a[76:77], v17 offset:0
    ds_read_b64_tr_b16 a[78:79], v17 offset:512
    s_cmp_lg_u32 s3, 7
    s_cbranch_scc1 Lnofx
    v_mov_b32 v92, 0x3f803f80
    v_mov_b32 v93, 0x3f803f80
    v_mov_b32 v94, 0x3f803f80
    v_mov_b32 v95, 0x3f803f80
    v_add_u32 v4, 144384, v13
    ds_write_b128 v4, v[92:95]
    ds_write_b128 v4, v[92:95] offset:1024
    v_and_b32 v120, 31, v1
    v_lshlrev_b32 v120, 7, v120
    v_add_u32 v120, 8126464, v120
Lpt_12:
    s_sub_u32 s35, s35, 1
    s_cbranch_scc1 Lend
    s_sleep 2
    buffer_load_dwordx4 v[124:127], v120, s[28:31], 0 offen sc1
    s_waitcnt vmcnt(0)
    v_cmp_ne_u32 vcc, s34, v125
    v_cmp_ne_u32 s[36:37], s34, v127
    s_nop 0
    s_or_b64 s[36:37], s[36:37], vcc
    s_cbranch_scc1 Lpt_12
    v_mov_b32 v120, v124
    s_nop 1
    v_max_u32_dpp v120, v120, v120 row_ror:8 row_mask:0xf bank_mask:0xf
    s_nop 1
    v_max_u32_dpp v120, v120, v120 row_ror:4 row_mask:0xf bank_mask:0xf
    s_nop 1
    v_max_u32_dpp v120, v120, v120 row_ror:2 row_mask:0xf bank_mask:0xf
    s_nop 1
    v_max_u32_dpp v120, v120, v120 row_ror:1 row_mask:0xf bank_mask:0xf
    s_nop 0
    v_readlane_b32 s56, v120, 0
    v_readlane_b32 s36, v120, 16
    v_readlane_b32 s37, v120, 32
    v_readlane_b32 s38, v120, 48
    s_max_u32 s56, s56, s36
    s_max_u32 s37, s37, s38
    s_max_u32 s56, s56, s37
    v_cmp_eq_u32 vcc, s56, v124
    s_nop 1
    v_cndmask_b32 v120, v124, v126, vcc
    s_nop 1
    v_max_u32_dpp v120, v120, v120 row_ror:8 row_mask:0xf bank_mask:0xf
    s_nop 1
    v_max_u32_dpp v120, v120, v120 row_ror:4 row_mask:0xf bank_mask:0xf
    s_nop 1
    v_max_u32_dpp v120, v120, v120 row_ror:2 row_mask:0xf bank_mask:0xf
    s_nop 1
    v_max_u32_dpp v120, v120, v120 row_ror:1 row_mask:0xf bank_mask:0xf
    s_nop 0
    v_readlane_b32 s57, v120, 0
    v_readlane_b32 s36, v120, 16
    v_readlane_b32 s37, v120, 32
    v_readlane_b32 s38, v120, 48
    s_max_u32 s57, s57, s36
    s_max_u32 s37, s37, s38
    s_max_u32 s57, s57, s37
    s_and_b32 s36, s56, 0x7ff
    s_sub_u32 s36, 2047, s36
    s_and_b32 s37, s57, 0x7ff
    s_sub_u32 s37, 2047, s37
    s_mul_i32 s38, s36, 1280
    s_mul_i32 s39, s37, 1280
    s_mov_b32 m0, 141312
    v_mov_b32 v4, s36
    buffer_load_dwordx4 v13, s[52:55], s38 offen lds
    s_mov_b32 m0, 142848
    v_mov_b32 v5, s37
    buffer_load_dwordx4 v13, s[52:55], s39 offen lds
    s_mov_b64 exec, 0xffff
    buffer_load_dwordx4 v13, s[52:55], s39 offen offset:1024 lds
    s_mov_b32 m0, 141312
    s_mov_b32 vcc_lo, 0xaaaaaaaa
    buffer_load_dwordx4 v13, s[52:55], s38 offen offset:1024 lds
    s_mov_b64 exec, 3
    v_cndmask_b32 v4, v4, v5, vcc
    v_lshlrev_b32 v118, 3, v4
    v_add_u32 v118, 8192000, v118
    v_add_u32 v9, 132872, v12
Lxs_chk:
    s_sub_u32 s35, s35, 1
    s_cbranch_scc1 Lend
    buffer_load_dwordx2 v[116:117], v118, s[28:31], 0 offen sc1
    s_waitcnt vmcnt(0)
    v_cmp_ne_u32 vcc, s34, v117
    s_nop 0
    s_cbranch_vccnz Lxs_chk
    ds_write_b32 v9, v116
    s_mov_b64 exec, -1
    v_mov_b32 v10, 132868
    v_mov_b32 v7, 1
    s_mov_b64 exec, 1
    ds_add_u32 v10, v7
    s_mov_b64 exec, -1
Lnofx:
Lcw_13:
    s_sub_u32 s35, s35, 1
    s_cbranch_scc1 Lend
    s_sleep 2
    ds_read_b32 v7, v11
    s_waitcnt lgkmcnt(0)
    v_readfirstlane_b32 s38, v7
    s_nop 0
    s_cmp_lt_u32 s38, 9
    s_cbranch_scc1 Lcw_13
    s_add_u32 m0, s40, 4096
    s_add_u32 s41, s43, 0
    buffer_load_dwordx4 v22, s[48:51], s41 offen nt lds
    buffer_load_dwordx4 v23, s[48:51], s41 offen offset:1024 nt lds
    buffer_load_dwordx4 v24, s[48:51], s41 offen offset:2048 nt lds
    buffer_load_dwordx4 v25, s[48:51], s41 offen offset:3072 nt lds
    s_add_u32 m0, s40, 8192
    s_add_u32 s41, s43, 40960
    buffer_load_dwordx4 v22, s[48:51], s41 offen nt lds
    buffer_load_dwordx4 v23, s[48:51], s41 offen offset:1024 nt lds
    buffer_load_dwordx4 v24, s[48:51], s41 offen offset:2048 nt lds
    buffer_load_dwordx4 v25, s[48:51], s41 offen offset:3072 nt lds
    s_add_u32 m0, s40, 12288
    s_add_u32 s41, s43, 512
    buffer_load_dwordx4 v22, s[68:71], s41 offen nt lds
    buffer_load_dwordx4 v23, s[68:71], s41 offen offset:1024 nt lds
    buffer_load_dwordx4 v24, s[68:71], s41 offen offset:2048 nt lds
    buffer_load_dwordx4 v25, s[68:71], s41 offen offset:3072 nt lds
    s_add_u32 m0, s40, 0
    s_add_u32 s41, s43, 41472
    buffer_load_dwordx4 v22, s[68:71], s41 offen nt lds
    buffer_load_dwordx4 v23, s[68:71], s41 offen offset:1024 nt lds
    buffer_load_dwordx4 v24, s[68:71], s41 offen offset:2048 nt lds
    buffer_load_dwordx4 v25, s[68:71], s41 offen offset:3072 nt lds
Laux_mm:
    v_mov_b32 v10, 132868
Lcw_14:
    s_sub_u32 s35, s35, 1
    s_cbranch_scc1 Lend
    s_sleep 1
    ds_read_b32 v7, v10
    s_waitcnt lgkmcnt(0)
    v_readfirstlane_b32 s38, v7
    s_nop 0
    s_cmp_lt_u32 s38, 1
    s_cbranch_scc1 Lcw_14
    ds_read_b128 v[92:95], v26 offset:0
    ds_read_b128 v[96:99], v26 offset:256
    ds_read_b128 v[100:103], v26 offset:512
    ds_read_b128 v[104:107], v26 offset:768
    ds_read_b128 v[108:111], v26 offset:1024
    ds_read_b64 v[116:117], v10 offset:4
    s_waitcnt lgkmcnt(0)
    v_readfirstlane_b32 s56, v116
    v_readfirstlane_b32 s57, v117
    v_mfma_f32_16x16x32_bf16 v[112:115], a[0:3], v[92:95], 0
    v_mfma_f32_16x16x32_bf16 v[116:119], a[4:7], v[92:95], 0
    v_mfma_f32_16x16x32_bf16 v[120:123], a[8:11], v[92:95], 0
    v_mfma_f32_16x16x32_bf16 v[124:127], a[12:15], v[92:95], 0
    v_mfma_f32_16x16x32_bf16 v[112:115], a[16:19], v[96:99], v[112:115]
    v_mfma_f32_16x16x32_bf16 v[116:119], a[20:23], v[96:99], v[116:119]
    v_mfma_f32_16x16x32_bf16 v[120:123], a[24:27], v[96:99], v[120:123]
    v_mfma_f32_16x16x32_bf16 v[124:127], a[28:31], v[96:99], v[124:127]
    v_mfma_f32_16x16x32_bf16 v[112:115], a[32:35], v[100:103], v[112:115]
    v_mfma_f32_16x16x32_bf16 v[116:119], a[36:39], v[100:103], v[116:119]
    v_mfma_f32_16x16x32_bf16 v[120:123], a[40:43], v[100:103], v[120:123]
    v_mfma_f32_16x16x32_bf16 v[124:127], a[44:47], v[100:103], v[124:127]
    v_mfma_f32_16x16x32_bf16 v[112:115], a[48:51], v[104:107], v[112:115]
    v_mfma_f32_16x16x32_bf16 v[116:119], a[52:55], v[104:107], v[116:119]
    v_mfma_f32_16x16x32_bf16 v[120:123], a[56:59], v[104:107], v[120:123]
    v_mfma_f32_16x16x32_bf16 v[124:127], a[60:63], v[104:107], v[124:127]
    v_mfma_f32_16x16x32_bf16 v[112:115], a[64:67], v[108:111], v[112:115]
    v_mfma_f32_16x16x32_bf16 v[116:119], a[68:71], v[108:111], v[116:119]
    v_mfma_f32_16x16x32_bf16 v[120:123], a[72:75], v[108:111], v[120:123]
    v_mfma_f32_16x16x32_bf16 v[124:127], a[76:79], v[108:111], v[124:127]
    s_mul_i32 s36, s3, 768
    s_add_u32 s36, s36, 133120
    v_lshlrev_b32 v4, 8, v3
    v_lshl_add_u32 v4, v2, 4, v4
    v_add_u32 v4, s36, v4
    v_add_u32 v5, 133120, v12
    s_lshl_b32 s37, s3, 8
    s_add_u32 s37, s37, 139264
    v_lshl_add_u32 v6, v1, 1, s37
    v_and_b32 v7, 1, v1
    v_lshlrev_b32 v7, 7, v7
    v_lshl_add_u32 v7, v2, 4, v7
    v_add_u32 v7, s37, v7
    s_lshl_b32 s38, s56, 16
    s_lshl_b32 s39, s57, 16
    v_rcp_f32 v8, s38
    v_rcp_f32 v9, s39
    s_and_b32 s56, s56, 0xffff0000
    s_and_b32 s57, s57, 0xffff0000
    s_mov_b32 exec_lo, 0x00070007
    s_mov_b32 exec_hi, 0x00070007
    ds_write_b128 v4, v[112:115] offset:0
    ds_write_b128 v4, v[116:119] offset:64
    ds_write_b128 v4, v[120:123] offset:128
    ds_write_b128 v4, v[124:127] offset:192
    s_mov_b64 exec, -1
    s_waitcnt lgkmcnt(0)
    s_barrier
    ds_read2st64_b32 v[92:93], v5 offset0:0 offset1:1
    ds_read2st64_b32 v[94:95], v5 offset0:2 offset1:3
    ds_read2st64_b32 v[96:97], v5 offset0:4 offset1:5
    ds_read2st64_b32 v[98:99], v5 offset0:6 offset1:7
    ds_read2st64_b32 v[100:101], v5 offset0:8 offset1:9
    ds_read2st64_b32 v[102:103], v5 offset0:10 offset1:11
    ds_read2st64_b32 v[116:117], v5 offset0:12 offset1:13
    ds_read2st64_b32 v[118:119], v5 offset0:14 offset1:15
    ds_read2st64_b32 v[120:121], v5 offset0:16 offset1:17
    ds_read2st64_b32 v[122:123], v5 offset0:18 offset1:19
    ds_read2st64_b32 v[124:125], v5 offset0:20 offset1:21
    ds_read2st64_b32 v[126:127], v5 offset0:22 offset1:23
    v_cmp_eq_u32 s[72:73], 1, v2
    v_cmp_eq_u32 s[74:75], 2, v2
    v_cmp_eq_u32 s[76:77], 3, v2
    s_mul_i32 s37, s32, 10
    s_add_u32 s37, s37, s3
    s_lshl_b32 s37, s37, 10
    s_add_u32 s37, s37, 7405568
    s_waitcnt lgkmcnt(0)
    v_add_f32 v92, v92, v95
    v_add_f32 v98, v98, v101
    v_add_f32 v92, v92, v98
    v_add_f32 v93, v93, v96
    v_add_f32 v99, v99, v102
    v_add_f32 v93, v93, v99
    v_add_f32 v94, v94, v97
    v_add_f32 v100, v100, v103
    v_add_f32 v94, v94, v100
    v_add_f32 v116, v116, v119
    v_add_f32 v122, v122, v125
    v_add_f32 v116, v116, v122
    v_add_f32 v117, v117, v120
    v_add_f32 v123, v123, v126
    v_add_f32 v117, v117, v123
    v_add_f32 v118, v118, v121
    v_add_f32 v124, v124, v127
    v_add_f32 v118, v118, v124
    v_fmac_f32 v92, s56, v94
    v_mul_f32 v112, v92, v8
    v_fmac_f32 v93, s57, v94
    v_mul_f32 v113, v93, v9
    v_fmac_f32 v116, s56, v118
    v_mul_f32 v120, v116, v8
    v_fmac_f32 v117, s57, v118
    v_mul_f32 v121, v117, v9
    v_cvt_pk_bf16_f32 v113, v112, v113
    v_lshlrev_b32 v112, 16, v113
    v_and_b32 v113, 0xffff0000, v113
    v_cvt_pk_bf16_f32 v121, v120, v121
    v_lshlrev_b32 v120, 16, v121
    v_and_b32 v121, 0xffff0000, v121
    v_mul_f32 v114, 0xbfb8aa3b, v112
    v_mul_f32 v115, 0xbfb8aa3b, v113
    v_exp_f32 v114, v114
    v_exp_f32 v115, v115
    v_add_f32 v114, 1.0, v114
    v_add_f32 v115, 1.0, v115
    v_rcp_f32 v114, v114
    v_rcp_f32 v115, v115
    v_mul_f32 v114, v114, v112
    v_mul_f32 v115, v115, v113
    v_cvt_pk_bf16_f32 v115, v114, v115
    v_lshlrev_b32 v114, 16, v115
    v_and_b32 v115, 0xffff0000, v115
    v_mul_f32 v114, v114, v120
    v_mul_f32 v115, v115, v121
    v_cvt_pk_bf16_f32 v114, v114, v115
    ds_write_b16 v6, v114
    ds_write_b16_d16_hi v6, v114 offset:128
    ds_read_b128 v[92:95], v7 offset:0
    ds_read_b128 v[96:99], v7 offset:64
    v_mov_b32 v101, s34
    v_mov_b32 v103, s34
    s_waitcnt vmcnt(0)
    ds_read_b64_tr_b16 v[28:29], v14 offset:4096
    ds_read_b64_tr_b16 v[30:31], v14 offset:4608
    ds_read_b64_tr_b16 v[32:33], v15 offset:4096
    ds_read_b64_tr_b16 v[34:35], v15 offset:4608
    ds_read_b64_tr_b16 v[36:37], v16 offset:4096
    ds_read_b64_tr_b16 v[38:39], v16 offset:4608
    ds_read_b64_tr_b16 v[40:41], v17 offset:4096
    ds_read_b64_tr_b16 v[42:43], v17 offset:4608
    ds_read_b64_tr_b16 v[44:45], v14 offset:8192
    ds_read_b64_tr_b16 v[46:47], v14 offset:8704
    ds_read_b64_tr_b16 v[48:49], v15 offset:8192
    ds_read_b64_tr_b16 v[50:51], v15 offset:8704
    ds_read_b64_tr_b16 v[52:53], v16 offset:8192
    ds_read_b64_tr_b16 v[54:55], v16 offset:8704
    ds_read_b64_tr_b16 v[56:57], v17 offset:8192
    ds_read_b64_tr_b16 v[58:59], v17 offset:8704
    s_waitcnt lgkmcnt(0)
    v_mfma_f32_16x16x32_bf16 v[112:115], v[92:95], v[28:31], 0
    v_mfma_f32_16x16x32_bf16 v[116:119], v[92:95], v[32:35], 0
    v_mfma_f32_16x16x32_bf16 v[120:123], v[92:95], v[36:39], 0
    v_mfma_f32_16x16x32_bf16 v[124:127], v[92:95], v[40:43], 0
    v_mfma_f32_16x16x32_bf16 v[112:115], v[96:99], v[44:47], v[112:115]
    v_mfma_f32_16x16x32_bf16 v[116:119], v[96:99], v[48:51], v[116:119]
    v_mfma_f32_16x16x32_bf16 v[120:123], v[96:99], v[52:55], v[120:123]
    v_mfma_f32_16x16x32_bf16 v[124:127], v[96:99], v[56:59], v[124:127]
    s_nop 5
    v_cndmask_b32 v100, v112, v116, s[72:73]
    v_cndmask_b32 v100, v100, v120, s[74:75]
    v_cndmask_b32 v100, v100, v124, s[76:77]
    v_cndmask_b32 v102, v113, v117, s[72:73]
    v_cndmask_b32 v102, v102, v121, s[74:75]
    v_cndmask_b32 v102, v102, v125, s[76:77]
    buffer_store_dwordx4 v[100:103], v13, s[28:31], s37 offen sc1
    s_sub_u32 s36, s3, 4
    s_cmp_ge_u32 s36, 2
    s_cbranch_scc1 Laux_end
    s_add_u32 s37, s37, 4096
    ds_read_b64_tr_b16 v[60:61], v14 offset:12288
    ds_read_b64_tr_b16 v[62:63], v14 offset:12800
    ds_read_b64_tr_b16 v[64:65], v15 offset:12288
    ds_read_b64_tr_b16 v[66:67], v15 offset:12800
    ds_read_b64_tr_b16 v[68:69], v16 offset:12288
    ds_read_b64_tr_b16 v[70:71], v16 offset:12800
    ds_read_b64_tr_b16 v[72:73], v17 offset:12288
    ds_read_b64_tr_b16 v[74:75], v17 offset:12800
    ds_read_b64_tr_b16 v[76:77], v14 offset:0
    ds_read_b64_tr_b16 v[78:79], v14 offset:512
    ds_read_b64_tr_b16 v[80:81], v15 offset:0
    ds_read_b64_tr_b16 v[82:83], v15 offset:512
    ds_read_b64_tr_b16 v[84:85], v16 offset:0
    ds_read_b64_tr_b16 v[86:87], v16 offset:512
    ds_read_b64_tr_b16 v[88:89], v17 offset:0
    ds_read_b64_tr_b16 v[90:91], v17 offset:512
    s_waitcnt lgkmcnt(0)
    v_mfma_f32_16x16x32_bf16 v[112:115], v[92:95], v[60:63], 0
    v_mfma_f32_16x16x32_bf16 v[116:119], v[92:95], v[64:67], 0
    v_mfma_f32_16x16x32_bf16 v[120:123], v[92:95], v[68:71], 0
    v_mfma_f32_16x16x32_bf16 v[124:127], v[92:95], v[72:75], 0
    v_mfma_f32_16x16x32_bf16 v[112:115], v[96:99], v[76:79], v[112:115]
    v_mfma_f32_16x16x32_bf16 v[116:119], v[96:99], v[80:83], v[116:119]
    v_mfma_f32_16x16x32_bf16 v[120:123], v[96:99], v[84:87], v[120:123]
    v_mfma_f32_16x16x32_bf16 v[124:127], v[96:99], v[88:91], v[124:127]
    s_nop 5
    v_cndmask_b32 v100, v112, v116, s[72:73]
    v_cndmask_b32 v100, v100, v120, s[74:75]
    v_cndmask_b32 v100, v100, v124, s[76:77]
    v_cndmask_b32 v102, v113, v117, s[72:73]
    v_cndmask_b32 v102, v102, v121, s[74:75]
    v_cndmask_b32 v102, v102, v125, s[76:77]
    buffer_store_dwordx4 v[100:103], v13, s[28:31], s37 offen sc1
Laux_end:
    s_endpgm
Lmst:
    s_cmp_lg_u32 s3, 0
    s_cbranch_scc1 Lhelp_i
    s_waitcnt lgkmcnt(0)
    s_mov_b64 s[28:29], s[24:25]
    s_mov_b32 s30, 268435456
    s_mov_b32 s31, 0x20000
    s_load_dword s34, s[28:29], 0
    s_waitcnt lgkmcnt(0)
    s_add_u32 s34, s34, 0x9e3779b8
    s_or_b32 s34, s34, 1
    s_mov_b64 exec, 1
    s_lshl_b32 s36, s2, 2
    s_add_u32 s36, s36, 8323072
    v_mov_b32 v4, s34
    v_mov_b32 v5, s36
    buffer_store_dword v4, v5, s[28:31], 0 offen sc1
    s_mov_b64 exec, -1
    s_cmp_lg_u32 s32, 32
    s_cbranch_scc1 Lend
Lmst_bc:
    v_and_b32 v4, 31, v1
    v_lshlrev_b32 v4, 7, v4
    v_add_u32 v4, 8126464, v4
Lpt_15:
    s_sub_u32 s35, s35, 1
    s_cbranch_scc1 Lend
    s_sleep 8
    buffer_load_dwordx4 v[8:11], v4, s[28:31], 0 offen sc1
    s_waitcnt vmcnt(0)
    v_cmp_ne_u32 vcc, s34, v9
    v_cmp_ne_u32 s[36:37], s34, v11
    s_nop 0
    s_or_b64 s[36:37], s[36:37], vcc
    s_cbranch_scc1 Lpt_15
    v_mov_b32 v4, v8
    s_nop 1
    v_max_u32_dpp v4, v4, v4 row_ror:8 row_mask:0xf bank_mask:0xf
    s_nop 1
    v_max_u32_dpp v4, v4, v4 row_ror:4 row_mask:0xf bank_mask:0xf
    s_nop 1
    v_max_u32_dpp v4, v4, v4 row_ror:2 row_mask:0xf bank_mask:0xf
    s_nop 1
    v_max_u32_dpp v4, v4, v4 row_ror:1 row_mask:0xf bank_mask:0xf
    s_nop 0
    v_readlane_b32 s40, v4, 0
    v_readlane_b32 s36, v4, 16
    v_readlane_b32 s37, v4, 32
    v_readlane_b32 s38, v4, 48
    s_max_u32 s40, s40, s36
    s_max_u32 s37, s37, s38
    s_max_u32 s40, s40, s37
    v_cmp_eq_u32 vcc, s40, v8
    s_nop 1
    v_cndmask_b32 v4, v8, v10, vcc
    s_nop 1
    v_max_u32_dpp v4, v4, v4 row_ror:8 row_mask:0xf bank_mask:0xf
    s_nop 1
    v_max_u32_dpp v4, v4, v4 row_ror:4 row_mask:0xf bank_mask:0xf
    s_nop 1
    v_max_u32_dpp v4, v4, v4 row_ror:2 row_mask:0xf bank_mask:0xf
    s_nop 1
    v_max_u32_dpp v4, v4, v4 row_ror:1 row_mask:0xf bank_mask:0xf
    s_nop 0
    v_readlane_b32 s41, v4, 0
    v_readlane_b32 s36, v4, 16
    v_readlane_b32 s37, v4, 32
    v_readlane_b32 s38, v4, 48
    s_max_u32 s41, s41, s36
    s_max_u32 s37, s37, s38
    s_max_u32 s41, s41, s37
    v_mov_b32 v8, s40
    v_mov_b32 v9, s34
    v_mov_b32 v10, s41
    v_mov_b32 v11, s34
    s_mov_b32 s36, 8257536
    buffer_store_dwordx4 v[8:11], v13, s[28:31], s36 offen offset:0 sc1
    buffer_store_dwordx4 v[8:11], v13, s[28:31], s36 offen offset:1024 sc1
    buffer_store_dwordx4 v[8:11], v13, s[28:31], s36 offen offset:2048 sc1
    s_mov_b32 s36, 8323072
Lmaster:
    s_sub_u32 s35, s35, 1
    s_cbranch_scc1 Lend
    s_sleep 16
    buffer_load_dwordx4 v[4:7], v13, s[28:31], s36 offen sc1
    s_waitcnt vmcnt(0)
    v_xor_b32 v4, s34, v4
    v_xor_b32 v5, s34, v5
    v_xor_b32 v6, s34, v6
    v_xor_b32 v7, s34, v7
    v_or3_b32 v4, v4, v5, v6
    v_or_b32 v4, v4, v7
    v_cmp_ne_u32 vcc, 0, v4
    s_nop 0
    s_cbranch_vccnz Lmaster
    s_mov_b64 exec, 1
    buffer_store_dword v9, v4, s[28:31], 0 offen sc1
    s_endpgm
Lhelp_r:
    s_sub_u32 s72, s32, 27
    s_add_u32 s72, s72, 27
    s_mov_b32 s73, 5
    s_mov_b32 s37, 4
    s_branch Lhelp
Lhelp_i:
    s_cmp_eq_u32 s32, 32
    s_cbranch_scc1 Lend
    s_cmp_eq_u32 s27, 0
    s_cbranch_scc1 Lend
    s_sub_u32 s72, s32, 33
    s_mov_b32 s73, 3
    s_mov_b32 s37, 9
Lhelp:
    s_lshl_b32 s38, s26, 6
    v_add_u32 v4, s38, v1
    v_mul_u32_u24 v4, 1280, v4
    s_waitcnt lgkmcnt(0)
    s_mov_b64 s[68:69], s[18:19]
    s_mov_b32 s70, 2211840
    s_mov_b32 s71, 0x20000
Lhelp2:
    s_mul_i32 s38, s72, 9363
    s_lshr_b32 s38, s38, 16
    s_mul_i32 s39, s38, 7
    s_sub_u32 s39, s72, s39
    s_mul_i32 s39, s39, 327680
    s_lshl_b32 s38, s38, 7
    s_sub_u32 s39, s39, s38
    s_add_u32 s39, s39, 1152
    v_add_u32 v6, s39, v4
    buffer_load_dword v5, v6, s[68:71], 0 offen
    s_add_u32 s72, s72, s73
    s_sub_u32 s37, s37, 1
    s_cmp_lg_u32 s37, 0
    s_cbranch_scc1 Lhelp2
Lend:
    s_endpgm
.section .rodata,"a"
.p2align 6
.amdhsa_kernel recurrent_scan__sliding_local_dilated__moe_arch_mod__prompt_kernel
  .amdhsa_next_free_vgpr 256
  .amdhsa_next_free_sgpr 102
  .amdhsa_accum_offset 128
  .amdhsa_group_segment_fixed_size 0
  .amdhsa_kernarg_size 88
  .amdhsa_user_sgpr_count 2
  .amdhsa_user_sgpr_kernarg_segment_ptr 1
  .amdhsa_system_sgpr_workgroup_id_x 1
  .amdhsa_float_denorm_mode_32 3
.end_amdhsa_kernel
```

```asm
; @launch grid=(256,1,1) block=(512,1,1) lds=163840
.amdgcn_target "amdgcn-amd-amdhsa--gfx950"
.text
.globl recurrent_scan__sliding_local_dilated__moe_arch_mod__prompt_kernel
.p2align 8
.type recurrent_scan__sliding_local_dilated__moe_arch_mod__prompt_kernel,@function
recurrent_scan__sliding_local_dilated__moe_arch_mod__prompt_kernel:
    s_load_dwordx16 s[4:19], s[0:1], 0
    s_load_dwordx4 s[20:23], s[0:1], 64
    s_load_dwordx2 s[24:25], s[0:1], 80
    v_lshrrev_b32 v4, 6, v0
    v_and_b32 v1, 63, v0
    s_cmp_ge_u32 s2, 256
    s_cbranch_scc1 Lend
    v_readfirstlane_b32 s3, v4
    s_getpc_b64 s[36:37]
Lpc:
    s_and_b32 s38, s2, 0xf8
    v_add_u32 v5, s38, v4
    v_and_b32 v6, 1, v0
    v_lshl_add_u32 v5, v5, 1, v6
    v_lshlrev_b32 v5, 7, v5
    v_min_u32 v5, Lend-Lpc, v5
    v_mov_b32 v7, s37
    v_add_co_u32 v6, vcc, s36, v5
    s_nop 1
    v_addc_co_u32 v7, vcc, 0, v7, vcc
    global_load_dword v0, v[6:7], off
    v_lshrrev_b32 v2, 4, v1
    v_and_b32 v3, 15, v1
    v_lshlrev_b32 v12, 2, v1
    v_lshlrev_b32 v13, 4, v1
    s_mov_b32 s35, 2000000
    s_and_b32 s36, s2, 7
    s_lshr_b32 s37, s2, 3
    s_and_b32 s38, s36, 1
    s_lshr_b32 s36, s36, 1
    s_add_u32 s39, s38, 4
    s_and_b32 s26, s3, 3
    s_lshr_b32 s27, s3, 2
    s_cmp_lt_u32 s37, s39
    s_cbranch_scc1 Laux
    s_lshr_b32 s33, s36, 1
    s_and_b32 s36, s36, 1
    s_mul_i32 s36, s36, 55
    s_mul_i32 s38, s38, 28
    s_add_u32 s36, s36, s38
    s_add_u32 s36, s36, s37
    s_sub_u32 s36, s36, s39
    s_mul_i32 s32, s36, 13108
    s_lshr_b32 s32, s32, 16
    s_mul_i32 s37, s32, 5
    s_sub_u32 s36, s36, s37
    s_mul_i32 s33, s33, 5
    s_add_u32 s33, s33, s36
    s_add_u32 s42, s33, s32
    s_mul_i32 s36, s42, 13108
    s_lshr_b32 s36, s36, 16
    s_mul_i32 s36, s36, 5
    s_sub_u32 s42, s42, s36
    s_and_b32 s43, s2, 7
    s_lshl_b32 s43, s43, 2
    s_lshr_b32 s43, 0x30858530, s43
    s_and_b32 s43, s43, 15
    s_cmp_lg_u32 s3, 0
    s_cbranch_scc1 Lcomp
Lloader:
    s_setprio 3
    v_lshrrev_b32 v5, 3, v1
    v_and_b32 v6, 7, v1
    v_and_b32 v8, 1, v2
    v_lshlrev_b32 v8, 1, v8
    v_xor_b32 v8, v8, v6
    s_lshl_b32 s39, s33, 7
    v_lshl_add_u32 v50, v8, 4, s39
    v_mov_b32 v7, 3840
    v_mad_u32_u24 v28, v5, v7, v50
    v_xor_b32 v29, 64, v28
    v_add_u32 v29, 29696, v29
    v_add_u32 v30, 59392, v28
    v_add_u32 v31, 59392, v29
    v_add_u32 v32, 122880, v28
    v_add_u32 v33, 122880, v29
    v_add_u32 v34, 182272, v28
    v_add_u32 v35, 182272, v29
    s_lshl_b32 s79, s42, 2
    s_lshr_b32 s79, 0x11000, s79
    s_and_b32 s79, s79, 15
    s_add_u32 s79, s79, s43
    s_sub_u32 s38, s79, 10
    s_cmp_ge_u32 s79, 10
    s_cselect_b32 s79, s38, s79
    s_mul_i32 s68, s79, 245760
    s_lshl_b32 s78, s79, 7
    s_waitcnt lgkmcnt(0)
    s_mov_b64 s[48:49], s[6:7]
    s_mov_b32 s50, 2457600
    s_mov_b32 s51, 0x20000
    s_add_u32 s52, s6, 1280
    s_addc_u32 s53, s7, 0
    s_mov_b32 s54, 2456320
    s_mov_b32 s55, 0x20000
    s_add_u32 s56, s6, 2560
    s_addc_u32 s57, s7, 0
    s_mov_b32 s58, 2455040
    s_mov_b32 s59, 0x20000
    s_lshr_b32 s69, 10, s42
    s_and_b32 s69, s69, 1
    s_mul_i32 s70, s69, 122880
    s_sub_u32 s71, 122880, s70
    s_add_u32 s70, s70, s68
    s_add_u32 s71, s71, s68
    s_lshl_b32 s72, s69, 12
    s_xor_b32 s73, s72, 4096
    s_add_u32 m0, s72, 0
    s_mul_i32 s38, s32, 96
    s_sub_u32 s38, s38, 16
    v_add_u32 v7, s38, v5
    v_xor_b32 v9, v6, v2
    v_lshlrev_b32 v9, 4, v9
    buffer_load_dwordx4 v28, s[48:51], s70 offen lds
    v_xor_b32 v10, 64, v9
    v_mov_b32 v11, 2052
    v_mov_b32 v8, 1280
    v_add_u32 v36, 0, v7
    buffer_load_dwordx4 v29, s[48:51], s70 offen offset:1024 lds
    v_med3_i32 v36, v36, 0, v11
    v_mad_u32_u24 v36, v36, v8, v9
    v_add_u32 v36, 4096, v36
    v_add_u32 v37, 8, v7
    buffer_load_dwordx4 v30, s[48:51], s70 offen offset:2048 lds
    v_med3_i32 v37, v37, 0, v11
    v_mad_u32_u24 v37, v37, v8, v10
    v_add_u32 v37, 3072, v37
    v_add_u32 v38, 16, v7
    v_med3_i32 v38, v38, 0, v11
    buffer_load_dwordx4 v31, s[48:51], s70 offen offset:3072 lds
    v_mad_u32_u24 v38, v38, v8, v9
    v_add_u32 v38, 2048, v38
    v_add_u32 v39, 24, v7
    v_med3_i32 v39, v39, 0, v11
    s_add_u32 m0, s72, 8192
    v_mad_u32_u24 v39, v39, v8, v10
    v_add_u32 v39, 1024, v39
    v_add_u32 v40, 32, v7
    v_med3_i32 v40, v40, 0, v11
    buffer_load_dwordx4 v28, s[52:55], s70 offen lds
    v_mad_u32_u24 v40, v40, v8, v9
    v_add_u32 v40, 4096, v40
    v_add_u32 v41, 40, v7
    v_med3_i32 v41, v41, 0, v11
    v_mad_u32_u24 v41, v41, v8, v10
    buffer_load_dwordx4 v29, s[52:55], s70 offen offset:1024 lds
    v_add_u32 v41, 3072, v41
    v_add_u32 v42, 48, v7
    v_med3_i32 v42, v42, 0, v11
    v_mad_u32_u24 v42, v42, v8, v9
    buffer_load_dwordx4 v30, s[52:55], s70 offen offset:2048 lds
    v_add_u32 v42, 2048, v42
    v_add_u32 v43, 56, v7
    v_med3_i32 v43, v43, 0, v11
    v_mad_u32_u24 v43, v43, v8, v10
    buffer_load_dwordx4 v31, s[52:55], s70 offen offset:3072 lds
    v_add_u32 v43, 1024, v43
    v_add_u32 v44, 64, v7
    v_med3_i32 v44, v44, 0, v11
    v_mad_u32_u24 v44, v44, v8, v9
    v_add_u32 v44, 4096, v44
    s_add_u32 m0, s72, 16384
    v_add_u32 v45, 72, v7
    v_med3_i32 v45, v45, 0, v11
    v_mad_u32_u24 v45, v45, v8, v10
    v_add_u32 v45, 3072, v45
    buffer_load_dwordx4 v28, s[56:59], s70 offen lds
    v_add_u32 v46, 80, v7
    v_med3_i32 v46, v46, 0, v11
    v_mad_u32_u24 v46, v46, v8, v9
    v_add_u32 v46, 2048, v46
    buffer_load_dwordx4 v29, s[56:59], s70 offen offset:1024 lds
    v_add_u32 v47, 88, v7
    v_med3_i32 v47, v47, 0, v11
    v_mad_u32_u24 v47, v47, v8, v10
    v_add_u32 v47, 1024, v47
    v_add_u32 v48, 96, v7
    buffer_load_dwordx4 v30, s[56:59], s70 offen offset:2048 lds
    v_med3_i32 v48, v48, 0, v11
    v_mad_u32_u24 v48, v48, v8, v9
    v_add_u32 v48, 4096, v48
    v_add_u32 v49, 104, v7
    buffer_load_dwordx4 v31, s[56:59], s70 offen offset:3072 lds
    v_med3_i32 v49, v49, 0, v11
    v_mad_u32_u24 v49, v49, v8, v10
    v_add_u32 v49, 3072, v49
    s_sub_u32 s44, s4, 4096
    s_subb_u32 s45, s5, 0
    s_mov_b32 s46, 2625536
    s_mov_b32 s47, 0x20000
    s_mov_b32 m0, 24576
    s_nop 0
    buffer_load_dwordx4 v36, s[44:47], s78 offen lds
    buffer_load_dwordx4 v37, s[44:47], s78 offen offset:1024 lds
    buffer_load_dwordx4 v38, s[44:47], s78 offen offset:2048 lds
    buffer_load_dwordx4 v39, s[44:47], s78 offen offset:3072 lds
    s_mov_b32 m0, 28672
    s_nop 0
    buffer_load_dwordx4 v40, s[44:47], s78 offen lds
    buffer_load_dwordx4 v41, s[44:47], s78 offen offset:1024 lds
    buffer_load_dwordx4 v42, s[44:47], s78 offen offset:2048 lds
    buffer_load_dwordx4 v43, s[44:47], s78 offen offset:3072 lds
    s_mov_b32 m0, 32768
    s_nop 0
    buffer_load_dwordx4 v44, s[44:47], s78 offen lds
    buffer_load_dwordx4 v45, s[44:47], s78 offen offset:1024 lds
    buffer_load_dwordx4 v46, s[44:47], s78 offen offset:2048 lds
    buffer_load_dwordx4 v47, s[44:47], s78 offen offset:3072 lds
    s_mov_b32 m0, 36864
    s_nop 0
    buffer_load_dwordx4 v48, s[44:47], s78 offen lds
    buffer_load_dwordx4 v49, s[44:47], s78 offen offset:1024 lds
    s_add_u32 m0, s73, 0
    s_nop 0
    buffer_load_dwordx4 v28, s[48:51], s71 offen lds
    buffer_load_dwordx4 v29, s[48:51], s71 offen offset:1024 lds
    buffer_load_dwordx4 v30, s[48:51], s71 offen offset:2048 lds
    buffer_load_dwordx4 v31, s[48:51], s71 offen offset:3072 lds
    s_add_u32 m0, s73, 8192
    s_nop 0
    buffer_load_dwordx4 v28, s[52:55], s71 offen lds
    buffer_load_dwordx4 v29, s[52:55], s71 offen offset:1024 lds
    buffer_load_dwordx4 v30, s[52:55], s71 offen offset:2048 lds
    buffer_load_dwordx4 v31, s[52:55], s71 offen offset:3072 lds
    s_add_u32 m0, s73, 16384
    s_nop 0
    buffer_load_dwordx4 v28, s[56:59], s71 offen lds
    buffer_load_dwordx4 v29, s[56:59], s71 offen offset:1024 lds
    buffer_load_dwordx4 v30, s[56:59], s71 offen offset:2048 lds
    buffer_load_dwordx4 v31, s[56:59], s71 offen offset:3072 lds
    s_mov_b32 s80, 0x86542310
    s_mov_b32 s81, 0x97
    s_cmp_eq_u32 s42, 1
    s_cselect_b32 s80, 0x76453210, s80
    s_cselect_b32 s81, 0x98, s81
    s_cmp_eq_u32 s42, 2
    s_cselect_b32 s80, 0x67543120, s80
    s_cselect_b32 s81, 0x98, s81
    s_cmp_eq_u32 s42, 3
    s_cselect_b32 s80, 0x76534201, s80
    s_cselect_b32 s81, 0x89, s81
    s_cmp_eq_u32 s42, 4
    s_cselect_b32 s80, 0x75643201, s80
    s_cselect_b32 s81, 0x98, s81
    s_lshr_b64 s[80:81], s[80:81], 4
    s_and_b32 s79, s80, 15
    s_add_u32 s79, s79, s43
    s_sub_u32 s38, s79, 10
    s_cmp_ge_u32 s79, 10
    s_cselect_b32 s79, s38, s79
    s_mov_b64 s[28:29], s[24:25]
    s_mov_b32 s30, 268435456
    s_mov_b32 s31, 0x20000
    s_load_dword s34, s[28:29], 0
    s_mov_b64 s[60:61], s[8:9]
    s_mov_b32 s62, 819200
    s_mov_b32 s63, 0x20000
    v_mov_b32 v51, 157984
    v_and_b32 v66, 7, v1
    v_max_u32 v66, 1, v66
    v_lshlrev_b32 v66, 2, v66
    v_add_u32 v66, 158016, v66
    s_mul_i32 s69, s79, 245760
    s_lshl_b32 s78, s79, 7
    s_mov_b32 m0, 63616
    s_nop 0
    buffer_load_dwordx4 v36, s[44:47], s78 offen lds
    buffer_load_dwordx4 v37, s[44:47], s78 offen offset:1024 lds
    buffer_load_dwordx4 v38, s[44:47], s78 offen offset:2048 lds
    buffer_load_dwordx4 v39, s[44:47], s78 offen offset:3072 lds
    s_mov_b32 m0, 39040
    s_nop 0
    buffer_load_dwordx4 v28, s[48:51], s69 offen lds
    buffer_load_dwordx4 v29, s[48:51], s69 offen offset:1024 lds
    buffer_load_dwordx4 v30, s[48:51], s69 offen offset:2048 lds
    buffer_load_dwordx4 v31, s[48:51], s69 offen offset:3072 lds
    s_mov_b32 m0, 67712
    s_nop 0
    buffer_load_dwordx4 v40, s[44:47], s78 offen lds
    buffer_load_dwordx4 v41, s[44:47], s78 offen offset:1024 lds
    buffer_load_dwordx4 v42, s[44:47], s78 offen offset:2048 lds
    buffer_load_dwordx4 v43, s[44:47], s78 offen offset:3072 lds
    s_mov_b32 m0, 47232
    s_nop 0
    buffer_load_dwordx4 v28, s[52:55], s69 offen lds
    buffer_load_dwordx4 v29, s[52:55], s69 offen offset:1024 lds
    buffer_load_dwordx4 v30, s[52:55], s69 offen offset:2048 lds
    buffer_load_dwordx4 v31, s[52:55], s69 offen offset:3072 lds
    s_mov_b32 m0, 71808
    s_nop 0
    buffer_load_dwordx4 v44, s[44:47], s78 offen lds
    buffer_load_dwordx4 v45, s[44:47], s78 offen offset:1024 lds
    buffer_load_dwordx4 v46, s[44:47], s78 offen offset:2048 lds
    buffer_load_dwordx4 v47, s[44:47], s78 offen offset:3072 lds
    s_mov_b32 m0, 55424
    s_nop 0
    buffer_load_dwordx4 v28, s[56:59], s69 offen lds
    buffer_load_dwordx4 v29, s[56:59], s69 offen offset:1024 lds
    buffer_load_dwordx4 v30, s[56:59], s69 offen offset:2048 lds
    buffer_load_dwordx4 v31, s[56:59], s69 offen offset:3072 lds
    s_mov_b32 m0, 75904
    s_nop 0
    buffer_load_dwordx4 v48, s[44:47], s78 offen lds
    s_waitcnt vmcnt(55)
    buffer_load_dwordx4 v49, s[44:47], s78 offen offset:1024 lds
    s_mov_b32 m0, 43136
    s_nop 0
    buffer_load_dwordx4 v32, s[48:51], s69 offen lds
    buffer_load_dwordx4 v33, s[48:51], s69 offen offset:1024 lds
    buffer_load_dwordx4 v34, s[48:51], s69 offen offset:2048 lds
    buffer_load_dwordx4 v35, s[48:51], s69 offen offset:3072 lds
    s_mov_b32 m0, 51328
    s_nop 0
    buffer_load_dwordx4 v32, s[52:55], s69 offen lds
    buffer_load_dwordx4 v33, s[52:55], s69 offen offset:1024 lds
    buffer_load_dwordx4 v34, s[52:55], s69 offen offset:2048 lds
    s_waitcnt vmcnt(55)
    buffer_load_dwordx4 v35, s[52:55], s69 offen offset:3072 lds
    s_mov_b32 m0, 59520
    s_nop 0
    buffer_load_dwordx4 v32, s[56:59], s69 offen lds
    buffer_load_dwordx4 v33, s[56:59], s69 offen offset:1024 lds
    buffer_load_dwordx4 v34, s[56:59], s69 offen offset:2048 lds
    buffer_load_dwordx4 v35, s[56:59], s69 offen offset:3072 lds
    s_waitcnt vmcnt(38) lgkmcnt(0)
    s_barrier
    s_add_u32 s34, s34, 0x9e3779b8
    s_or_b32 s34, s34, 1
    s_lshr_b64 s[80:81], s[80:81], 4
    s_and_b32 s79, s80, 15
    s_add_u32 s79, s79, s43
    s_sub_u32 s38, s79, 10
    s_cmp_ge_u32 s79, 10
    s_cselect_b32 s79, s38, s79
    s_mul_i32 s70, s79, 245760
    s_lshl_b32 s78, s79, 7
    s_mov_b32 m0, 102656
    s_nop 0
    buffer_load_dwordx4 v36, s[44:47], s78 offen lds
    buffer_load_dwordx4 v37, s[44:47], s78 offen offset:1024 lds
    buffer_load_dwordx4 v38, s[44:47], s78 offen offset:2048 lds
    buffer_load_dwordx4 v39, s[44:47], s78 offen offset:3072 lds
    s_mov_b32 m0, 78080
    s_nop 0
    buffer_load_dwordx4 v28, s[48:51], s70 offen lds
    buffer_load_dwordx4 v29, s[48:51], s70 offen offset:1024 lds
    buffer_load_dwordx4 v30, s[48:51], s70 offen offset:2048 lds
    buffer_load_dwordx4 v31, s[48:51], s70 offen offset:3072 lds
    s_mov_b32 m0, 106752
    s_nop 0
    buffer_load_dwordx4 v40, s[44:47], s78 offen lds
    buffer_load_dwordx4 v41, s[44:47], s78 offen offset:1024 lds
    buffer_load_dwordx4 v42, s[44:47], s78 offen offset:2048 lds
    buffer_load_dwordx4 v43, s[44:47], s78 offen offset:3072 lds
    s_mov_b32 m0, 86272
    s_nop 0
    buffer_load_dwordx4 v28, s[52:55], s70 offen lds
    buffer_load_dwordx4 v29, s[52:55], s70 offen offset:1024 lds
    buffer_load_dwordx4 v30, s[52:55], s70 offen offset:2048 lds
    buffer_load_dwordx4 v31, s[52:55], s70 offen offset:3072 lds
    s_mov_b32 m0, 110848
    s_nop 0
    buffer_load_dwordx4 v44, s[44:47], s78 offen lds
    buffer_load_dwordx4 v45, s[44:47], s78 offen offset:1024 lds
    buffer_load_dwordx4 v46, s[44:47], s78 offen offset:2048 lds
    buffer_load_dwordx4 v47, s[44:47], s78 offen offset:3072 lds
    s_mov_b32 m0, 94464
    s_nop 0
    buffer_load_dwordx4 v28, s[56:59], s70 offen lds
    buffer_load_dwordx4 v29, s[56:59], s70 offen offset:1024 lds
    buffer_load_dwordx4 v30, s[56:59], s70 offen offset:2048 lds
    buffer_load_dwordx4 v31, s[56:59], s70 offen offset:3072 lds
    s_mov_b32 m0, 114944
    s_nop 0
    buffer_load_dwordx4 v48, s[44:47], s78 offen lds
    s_waitcnt vmcnt(55)
    buffer_load_dwordx4 v49, s[44:47], s78 offen offset:1024 lds
    s_mov_b32 m0, 82176
    s_nop 0
    buffer_load_dwordx4 v32, s[48:51], s70 offen lds
    buffer_load_dwordx4 v33, s[48:51], s70 offen offset:1024 lds
    buffer_load_dwordx4 v34, s[48:51], s70 offen offset:2048 lds
    buffer_load_dwordx4 v35, s[48:51], s70 offen offset:3072 lds
    s_mov_b32 m0, 90368
    s_nop 0
    buffer_load_dwordx4 v32, s[52:55], s70 offen lds
    buffer_load_dwordx4 v33, s[52:55], s70 offen offset:1024 lds
    buffer_load_dwordx4 v34, s[52:55], s70 offen offset:2048 lds
    s_waitcnt vmcnt(55)
    buffer_load_dwordx4 v35, s[52:55], s70 offen offset:3072 lds
    s_mov_b32 m0, 98560
    s_nop 0
    buffer_load_dwordx4 v32, s[56:59], s70 offen lds
    buffer_load_dwordx4 v33, s[56:59], s70 offen offset:1024 lds
    buffer_load_dwordx4 v34, s[56:59], s70 offen offset:2048 lds
    buffer_load_dwordx4 v35, s[56:59], s70 offen offset:3072 lds
    s_waitcnt vmcnt(38) lgkmcnt(0)
    s_barrier
    s_lshr_b64 s[80:81], s[80:81], 4
    s_and_b32 s79, s80, 15
    s_add_u32 s79, s79, s43
    s_sub_u32 s38, s79, 10
    s_cmp_ge_u32 s79, 10
    s_cselect_b32 s79, s38, s79
    s_mul_i32 s71, s79, 245760
    s_lshl_b32 s78, s79, 7
    s_mov_b32 m0, 141696
    s_nop 0
    buffer_load_dwordx4 v36, s[44:47], s78 offen lds
    buffer_load_dwordx4 v37, s[44:47], s78 offen offset:1024 lds
    buffer_load_dwordx4 v38, s[44:47], s78 offen offset:2048 lds
    buffer_load_dwordx4 v39, s[44:47], s78 offen offset:3072 lds
    s_mov_b32 m0, 117120
    s_nop 0
    buffer_load_dwordx4 v28, s[48:51], s71 offen lds
    buffer_load_dwordx4 v29, s[48:51], s71 offen offset:1024 lds
    buffer_load_dwordx4 v30, s[48:51], s71 offen offset:2048 lds
    buffer_load_dwordx4 v31, s[48:51], s71 offen offset:3072 lds
    s_mov_b32 m0, 145792
    s_nop 0
    buffer_load_dwordx4 v40, s[44:47], s78 offen lds
    buffer_load_dwordx4 v41, s[44:47], s78 offen offset:1024 lds
    buffer_load_dwordx4 v42, s[44:47], s78 offen offset:2048 lds
    buffer_load_dwordx4 v43, s[44:47], s78 offen offset:3072 lds
    s_mov_b32 m0, 125312
    s_nop 0
    buffer_load_dwordx4 v28, s[52:55], s71 offen lds
    buffer_load_dwordx4 v29, s[52:55], s71 offen offset:1024 lds
    buffer_load_dwordx4 v30, s[52:55], s71 offen offset:2048 lds
    buffer_load_dwordx4 v31, s[52:55], s71 offen offset:3072 lds
    s_mov_b32 m0, 149888
    s_nop 0
    buffer_load_dwordx4 v44, s[44:47], s78 offen lds
    buffer_load_dwordx4 v45, s[44:47], s78 offen offset:1024 lds
    buffer_load_dwordx4 v46, s[44:47], s78 offen offset:2048 lds
    buffer_load_dwordx4 v47, s[44:47], s78 offen offset:3072 lds
    s_mov_b32 m0, 133504
    s_nop 0
    buffer_load_dwordx4 v28, s[56:59], s71 offen lds
    buffer_load_dwordx4 v29, s[56:59], s71 offen offset:1024 lds
    buffer_load_dwordx4 v30, s[56:59], s71 offen offset:2048 lds
    buffer_load_dwordx4 v31, s[56:59], s71 offen offset:3072 lds
    s_mov_b32 m0, 153984
    s_nop 0
    buffer_load_dwordx4 v48, s[44:47], s78 offen lds
    s_waitcnt vmcnt(55)
    buffer_load_dwordx4 v49, s[44:47], s78 offen offset:1024 lds
    s_mov_b32 m0, 121216
    s_nop 0
    buffer_load_dwordx4 v32, s[48:51], s71 offen lds
    buffer_load_dwordx4 v33, s[48:51], s71 offen offset:1024 lds
    buffer_load_dwordx4 v34, s[48:51], s71 offen offset:2048 lds
    buffer_load_dwordx4 v35, s[48:51], s71 offen offset:3072 lds
    s_mov_b32 m0, 129408
    s_nop 0
    buffer_load_dwordx4 v32, s[52:55], s71 offen lds
    buffer_load_dwordx4 v33, s[52:55], s71 offen offset:1024 lds
    buffer_load_dwordx4 v34, s[52:55], s71 offen offset:2048 lds
    s_waitcnt vmcnt(55)
    buffer_load_dwordx4 v35, s[52:55], s71 offen offset:3072 lds
    s_mov_b32 m0, 137600
    s_nop 0
    buffer_load_dwordx4 v32, s[56:59], s71 offen lds
    buffer_load_dwordx4 v33, s[56:59], s71 offen offset:1024 lds
    buffer_load_dwordx4 v34, s[56:59], s71 offen offset:2048 lds
    buffer_load_dwordx4 v35, s[56:59], s71 offen offset:3072 lds
    s_waitcnt vmcnt(38) lgkmcnt(0)
    s_barrier
    s_lshr_b64 s[80:81], s[80:81], 4
    s_and_b32 s79, s80, 15
    s_add_u32 s79, s79, s43
    s_sub_u32 s38, s79, 10
    s_cmp_ge_u32 s79, 10
    s_cselect_b32 s79, s38, s79
    s_mul_i32 s72, s79, 245760
    s_lshl_b32 s78, s79, 7
    s_mov_b32 m0, 24576
    s_nop 0
    buffer_load_dwordx4 v36, s[44:47], s78 offen lds
    buffer_load_dwordx4 v37, s[44:47], s78 offen offset:1024 lds
    buffer_load_dwordx4 v38, s[44:47], s78 offen offset:2048 lds
    buffer_load_dwordx4 v39, s[44:47], s78 offen offset:3072 lds
    s_mov_b32 m0, 0
    s_nop 0
    buffer_load_dwordx4 v28, s[48:51], s72 offen lds
    buffer_load_dwordx4 v29, s[48:51], s72 offen offset:1024 lds
    buffer_load_dwordx4 v30, s[48:51], s72 offen offset:2048 lds
    buffer_load_dwordx4 v31, s[48:51], s72 offen offset:3072 lds
    s_mov_b32 m0, 28672
    s_nop 0
    buffer_load_dwordx4 v40, s[44:47], s78 offen lds
    buffer_load_dwordx4 v41, s[44:47], s78 offen offset:1024 lds
    buffer_load_dwordx4 v42, s[44:47], s78 offen offset:2048 lds
    buffer_load_dwordx4 v43, s[44:47], s78 offen offset:3072 lds
    s_mov_b32 m0, 8192
    s_nop 0
    buffer_load_dwordx4 v28, s[52:55], s72 offen lds
    buffer_load_dwordx4 v29, s[52:55], s72 offen offset:1024 lds
    buffer_load_dwordx4 v30, s[52:55], s72 offen offset:2048 lds
    buffer_load_dwordx4 v31, s[52:55], s72 offen offset:3072 lds
    s_mov_b32 m0, 32768
    s_nop 0
    buffer_load_dwordx4 v44, s[44:47], s78 offen lds
    buffer_load_dwordx4 v45, s[44:47], s78 offen offset:1024 lds
    buffer_load_dwordx4 v46, s[44:47], s78 offen offset:2048 lds
    buffer_load_dwordx4 v47, s[44:47], s78 offen offset:3072 lds
    s_mov_b32 m0, 16384
    s_nop 0
    buffer_load_dwordx4 v28, s[56:59], s72 offen lds
    buffer_load_dwordx4 v29, s[56:59], s72 offen offset:1024 lds
    buffer_load_dwordx4 v30, s[56:59], s72 offen offset:2048 lds
    buffer_load_dwordx4 v31, s[56:59], s72 offen offset:3072 lds
    s_mov_b32 m0, 36864
    s_nop 0
    buffer_load_dwordx4 v48, s[44:47], s78 offen lds
    s_waitcnt vmcnt(55)
    buffer_load_dwordx4 v49, s[44:47], s78 offen offset:1024 lds
    s_mov_b32 m0, 4096
    s_nop 0
    buffer_load_dwordx4 v32, s[48:51], s72 offen lds
    buffer_load_dwordx4 v33, s[48:51], s72 offen offset:1024 lds
    buffer_load_dwordx4 v34, s[48:51], s72 offen offset:2048 lds
    buffer_load_dwordx4 v35, s[48:51], s72 offen offset:3072 lds
    s_mov_b32 m0, 12288
    s_nop 0
    buffer_load_dwordx4 v32, s[52:55], s72 offen lds
    buffer_load_dwordx4 v33, s[52:55], s72 offen offset:1024 lds
    buffer_load_dwordx4 v34, s[52:55], s72 offen offset:2048 lds
    s_waitcnt vmcnt(55)
    buffer_load_dwordx4 v35, s[52:55], s72 offen offset:3072 lds
    s_mov_b32 m0, 20480
    s_nop 0
    buffer_load_dwordx4 v32, s[56:59], s72 offen lds
    buffer_load_dwordx4 v33, s[56:59], s72 offen offset:1024 lds
    buffer_load_dwordx4 v34, s[56:59], s72 offen offset:2048 lds
    buffer_load_dwordx4 v35, s[56:59], s72 offen offset:3072 lds
    s_waitcnt vmcnt(38) lgkmcnt(0)
    s_barrier
    s_lshr_b64 s[80:81], s[80:81], 4
    s_and_b32 s79, s80, 15
    s_add_u32 s79, s79, s43
    s_sub_u32 s38, s79, 10
    s_cmp_ge_u32 s79, 10
    s_cselect_b32 s79, s38, s79
    s_mul_i32 s73, s79, 245760
    s_lshl_b32 s78, s79, 7
    s_mov_b32 m0, 63616
    s_nop 0
    buffer_load_dwordx4 v36, s[44:47], s78 offen lds
    buffer_load_dwordx4 v37, s[44:47], s78 offen offset:1024 lds
    buffer_load_dwordx4 v38, s[44:47], s78 offen offset:2048 lds
    buffer_load_dwordx4 v39, s[44:47], s78 offen offset:3072 lds
    s_mov_b32 m0, 39040
    s_nop 0
    buffer_load_dwordx4 v28, s[48:51], s73 offen lds
    buffer_load_dwordx4 v29, s[48:51], s73 offen offset:1024 lds
    buffer_load_dwordx4 v30, s[48:51], s73 offen offset:2048 lds
    buffer_load_dwordx4 v31, s[48:51], s73 offen offset:3072 lds
    s_mov_b32 m0, 67712
    s_nop 0
    buffer_load_dwordx4 v40, s[44:47], s78 offen lds
    buffer_load_dwordx4 v41, s[44:47], s78 offen offset:1024 lds
    buffer_load_dwordx4 v42, s[44:47], s78 offen offset:2048 lds
    buffer_load_dwordx4 v43, s[44:47], s78 offen offset:3072 lds
    s_mov_b32 m0, 47232
    s_nop 0
    buffer_load_dwordx4 v28, s[52:55], s73 offen lds
    buffer_load_dwordx4 v29, s[52:55], s73 offen offset:1024 lds
    buffer_load_dwordx4 v30, s[52:55], s73 offen offset:2048 lds
    buffer_load_dwordx4 v31, s[52:55], s73 offen offset:3072 lds
    s_mov_b32 m0, 71808
    s_nop 0
    buffer_load_dwordx4 v44, s[44:47], s78 offen lds
    buffer_load_dwordx4 v45, s[44:47], s78 offen offset:1024 lds
    buffer_load_dwordx4 v46, s[44:47], s78 offen offset:2048 lds
    buffer_load_dwordx4 v47, s[44:47], s78 offen offset:3072 lds
    s_mov_b32 m0, 55424
    s_nop 0
    buffer_load_dwordx4 v28, s[56:59], s73 offen lds
    buffer_load_dwordx4 v29, s[56:59], s73 offen offset:1024 lds
    buffer_load_dwordx4 v30, s[56:59], s73 offen offset:2048 lds
    buffer_load_dwordx4 v31, s[56:59], s73 offen offset:3072 lds
    s_mov_b32 m0, 75904
    s_nop 0
    buffer_load_dwordx4 v48, s[44:47], s78 offen lds
    s_waitcnt vmcnt(55)
    buffer_load_dwordx4 v49, s[44:47], s78 offen offset:1024 lds
    s_mov_b32 m0, 43136
    s_nop 0
    buffer_load_dwordx4 v32, s[48:51], s73 offen lds
    buffer_load_dwordx4 v33, s[48:51], s73 offen offset:1024 lds
    buffer_load_dwordx4 v34, s[48:51], s73 offen offset:2048 lds
    buffer_load_dwordx4 v35, s[48:51], s73 offen offset:3072 lds
    s_mov_b32 m0, 51328
    s_nop 0
    buffer_load_dwordx4 v32, s[52:55], s73 offen lds
    buffer_load_dwordx4 v33, s[52:55], s73 offen offset:1024 lds
    buffer_load_dwordx4 v34, s[52:55], s73 offen offset:2048 lds
    s_waitcnt vmcnt(55)
    buffer_load_dwordx4 v35, s[52:55], s73 offen offset:3072 lds
    s_mov_b32 m0, 59520
    s_nop 0
    buffer_load_dwordx4 v32, s[56:59], s73 offen lds
    buffer_load_dwordx4 v33, s[56:59], s73 offen offset:1024 lds
    buffer_load_dwordx4 v34, s[56:59], s73 offen offset:2048 lds
    buffer_load_dwordx4 v35, s[56:59], s73 offen offset:3072 lds
    s_waitcnt vmcnt(38) lgkmcnt(0)
    s_barrier
    s_lshr_b64 s[80:81], s[80:81], 4
    s_and_b32 s79, s80, 15
    s_add_u32 s79, s79, s43
    s_sub_u32 s38, s79, 10
    s_cmp_ge_u32 s79, 10
    s_cselect_b32 s79, s38, s79
    s_mul_i32 s74, s79, 245760
    s_lshl_b32 s78, s79, 7
    s_mov_b32 m0, 102656
    s_nop 0
    buffer_load_dwordx4 v36, s[44:47], s78 offen lds
    buffer_load_dwordx4 v37, s[44:47], s78 offen offset:1024 lds
    buffer_load_dwordx4 v38, s[44:47], s78 offen offset:2048 lds
    buffer_load_dwordx4 v39, s[44:47], s78 offen offset:3072 lds
    s_mov_b32 m0, 78080
    s_nop 0
    buffer_load_dwordx4 v28, s[48:51], s74 offen lds
    buffer_load_dwordx4 v29, s[48:51], s74 offen offset:1024 lds
    buffer_load_dwordx4 v30, s[48:51], s74 offen offset:2048 lds
    buffer_load_dwordx4 v31, s[48:51], s74 offen offset:3072 lds
    s_mov_b32 m0, 106752
    s_nop 0
    buffer_load_dwordx4 v40, s[44:47], s78 offen lds
    buffer_load_dwordx4 v41, s[44:47], s78 offen offset:1024 lds
    buffer_load_dwordx4 v42, s[44:47], s78 offen offset:2048 lds
    buffer_load_dwordx4 v43, s[44:47], s78 offen offset:3072 lds
    s_mov_b32 m0, 86272
    s_nop 0
    buffer_load_dwordx4 v28, s[52:55], s74 offen lds
    buffer_load_dwordx4 v29, s[52:55], s74 offen offset:1024 lds
    buffer_load_dwordx4 v30, s[52:55], s74 offen offset:2048 lds
    buffer_load_dwordx4 v31, s[52:55], s74 offen offset:3072 lds
    s_mov_b32 m0, 110848
    s_nop 0
    buffer_load_dwordx4 v44, s[44:47], s78 offen lds
    buffer_load_dwordx4 v45, s[44:47], s78 offen offset:1024 lds
    buffer_load_dwordx4 v46, s[44:47], s78 offen offset:2048 lds
    buffer_load_dwordx4 v47, s[44:47], s78 offen offset:3072 lds
    s_mov_b32 m0, 82176
    s_nop 0
    buffer_load_dwordx4 v32, s[48:51], s74 offen lds
    buffer_load_dwordx4 v33, s[48:51], s74 offen offset:1024 lds
    buffer_load_dwordx4 v34, s[48:51], s74 offen offset:2048 lds
    buffer_load_dwordx4 v35, s[48:51], s74 offen offset:3072 lds
    s_mov_b32 m0, 114944
    s_nop 0
    buffer_load_dwordx4 v48, s[44:47], s78 offen lds
    s_waitcnt vmcnt(55)
    buffer_load_dwordx4 v49, s[44:47], s78 offen offset:1024 lds
    s_mov_b32 m0, 90368
    s_nop 0
    buffer_load_dwordx4 v32, s[52:55], s74 offen lds
    buffer_load_dwordx4 v33, s[52:55], s74 offen offset:1024 lds
    buffer_load_dwordx4 v34, s[52:55], s74 offen offset:2048 lds
    buffer_load_dwordx4 v35, s[52:55], s74 offen offset:3072 lds
    s_waitcnt vmcnt(30) lgkmcnt(0)
    s_barrier
    s_lshr_b64 s[80:81], s[80:81], 4
    s_and_b32 s79, s80, 15
    s_add_u32 s79, s79, s43
    s_sub_u32 s38, s79, 10
    s_cmp_ge_u32 s79, 10
    s_cselect_b32 s79, s38, s79
    s_mul_i32 s75, s79, 245760
    s_lshl_b32 s78, s79, 7
    s_mov_b32 m0, 141696
    s_nop 0
    buffer_load_dwordx4 v36, s[44:47], s78 offen lds
    buffer_load_dwordx4 v37, s[44:47], s78 offen offset:1024 lds
    buffer_load_dwordx4 v38, s[44:47], s78 offen offset:2048 lds
    buffer_load_dwordx4 v39, s[44:47], s78 offen offset:3072 lds
    s_mov_b32 m0, 117120
    s_nop 0
    buffer_load_dwordx4 v28, s[48:51], s75 offen lds
    buffer_load_dwordx4 v29, s[48:51], s75 offen offset:1024 lds
    buffer_load_dwordx4 v30, s[48:51], s75 offen offset:2048 lds
    buffer_load_dwordx4 v31, s[48:51], s75 offen offset:3072 lds
    s_mov_b32 m0, 145792
    s_nop 0
    buffer_load_dwordx4 v40, s[44:47], s78 offen lds
    buffer_load_dwordx4 v41, s[44:47], s78 offen offset:1024 lds
    buffer_load_dwordx4 v42, s[44:47], s78 offen offset:2048 lds
    buffer_load_dwordx4 v43, s[44:47], s78 offen offset:3072 lds
    s_mov_b32 m0, 125312
    s_nop 0
    buffer_load_dwordx4 v28, s[52:55], s75 offen lds
    buffer_load_dwordx4 v29, s[52:55], s75 offen offset:1024 lds
    buffer_load_dwordx4 v30, s[52:55], s75 offen offset:2048 lds
    buffer_load_dwordx4 v31, s[52:55], s75 offen offset:3072 lds
    s_mov_b32 m0, 149888
    s_nop 0
    buffer_load_dwordx4 v44, s[44:47], s78 offen lds
    buffer_load_dwordx4 v45, s[44:47], s78 offen offset:1024 lds
    buffer_load_dwordx4 v46, s[44:47], s78 offen offset:2048 lds
    buffer_load_dwordx4 v47, s[44:47], s78 offen offset:3072 lds
    s_mov_b32 m0, 121216
    s_nop 0
    buffer_load_dwordx4 v32, s[48:51], s75 offen lds
    buffer_load_dwordx4 v33, s[48:51], s75 offen offset:1024 lds
    buffer_load_dwordx4 v34, s[48:51], s75 offen offset:2048 lds
    buffer_load_dwordx4 v35, s[48:51], s75 offen offset:3072 lds
    s_mov_b32 m0, 153984
    s_nop 0
    buffer_load_dwordx4 v48, s[44:47], s78 offen lds
    buffer_load_dwordx4 v49, s[44:47], s78 offen offset:1024 lds
    s_mov_b32 m0, 129408
    s_nop 0
    buffer_load_dwordx4 v32, s[52:55], s75 offen lds
    buffer_load_dwordx4 v33, s[52:55], s75 offen offset:1024 lds
    buffer_load_dwordx4 v34, s[52:55], s75 offen offset:2048 lds
    buffer_load_dwordx4 v35, s[52:55], s75 offen offset:3072 lds
    s_waitcnt vmcnt(30) lgkmcnt(0)
    s_barrier
    s_lshr_b64 s[80:81], s[80:81], 4
    s_and_b32 s79, s80, 15
    s_add_u32 s79, s79, s43
    s_sub_u32 s38, s79, 10
    s_cmp_ge_u32 s79, 10
    s_cselect_b32 s79, s38, s79
    s_mul_i32 s76, s79, 245760
    s_lshl_b32 s78, s79, 7
    s_mov_b32 m0, 24576
    s_nop 0
    buffer_load_dwordx4 v36, s[44:47], s78 offen lds
    buffer_load_dwordx4 v37, s[44:47], s78 offen offset:1024 lds
    buffer_load_dwordx4 v38, s[44:47], s78 offen offset:2048 lds
    buffer_load_dwordx4 v39, s[44:47], s78 offen offset:3072 lds
    s_mov_b32 m0, 0
    s_nop 0
    buffer_load_dwordx4 v28, s[48:51], s76 offen lds
    buffer_load_dwordx4 v29, s[48:51], s76 offen offset:1024 lds
    buffer_load_dwordx4 v30, s[48:51], s76 offen offset:2048 lds
    buffer_load_dwordx4 v31, s[48:51], s76 offen offset:3072 lds
    s_mov_b32 m0, 28672
    s_nop 0
    buffer_load_dwordx4 v40, s[44:47], s78 offen lds
    buffer_load_dwordx4 v41, s[44:47], s78 offen offset:1024 lds
    buffer_load_dwordx4 v42, s[44:47], s78 offen offset:2048 lds
    buffer_load_dwordx4 v43, s[44:47], s78 offen offset:3072 lds
    s_mov_b32 m0, 8192
    s_nop 0
    buffer_load_dwordx4 v28, s[52:55], s76 offen lds
    buffer_load_dwordx4 v29, s[52:55], s76 offen offset:1024 lds
    buffer_load_dwordx4 v30, s[52:55], s76 offen offset:2048 lds
    buffer_load_dwordx4 v31, s[52:55], s76 offen offset:3072 lds
    s_mov_b32 m0, 32768
    s_nop 0
    buffer_load_dwordx4 v44, s[44:47], s78 offen lds
    buffer_load_dwordx4 v45, s[44:47], s78 offen offset:1024 lds
    buffer_load_dwordx4 v46, s[44:47], s78 offen offset:2048 lds
    buffer_load_dwordx4 v47, s[44:47], s78 offen offset:3072 lds
    s_mov_b32 m0, 4096
    s_nop 0
    buffer_load_dwordx4 v32, s[48:51], s76 offen lds
    buffer_load_dwordx4 v33, s[48:51], s76 offen offset:1024 lds
    buffer_load_dwordx4 v34, s[48:51], s76 offen offset:2048 lds
    buffer_load_dwordx4 v35, s[48:51], s76 offen offset:3072 lds
    s_mov_b32 m0, 36864
    s_nop 0
    buffer_load_dwordx4 v48, s[44:47], s78 offen lds
    buffer_load_dwordx4 v49, s[44:47], s78 offen offset:1024 lds
    s_mov_b32 m0, 12288
    s_nop 0
    buffer_load_dwordx4 v32, s[52:55], s76 offen lds
    buffer_load_dwordx4 v33, s[52:55], s76 offen offset:1024 lds
    buffer_load_dwordx4 v34, s[52:55], s76 offen offset:2048 lds
    buffer_load_dwordx4 v35, s[52:55], s76 offen offset:3072 lds
    s_waitcnt vmcnt(30) lgkmcnt(0)
    s_barrier
    s_lshr_b64 s[80:81], s[80:81], 4
    s_and_b32 s79, s80, 15
    s_add_u32 s79, s79, s43
    s_sub_u32 s38, s79, 10
    s_cmp_ge_u32 s79, 10
    s_cselect_b32 s79, s38, s79
    s_mul_i32 s77, s79, 245760
    s_lshl_b32 s78, s79, 7
    s_mov_b32 m0, 63616
    s_nop 0
    buffer_load_dwordx4 v36, s[44:47], s78 offen lds
    buffer_load_dwordx4 v37, s[44:47], s78 offen offset:1024 lds
    buffer_load_dwordx4 v38, s[44:47], s78 offen offset:2048 lds
    buffer_load_dwordx4 v39, s[44:47], s78 offen offset:3072 lds
    s_mov_b32 m0, 39040
    s_nop 0
    buffer_load_dwordx4 v28, s[48:51], s77 offen lds
    buffer_load_dwordx4 v29, s[48:51], s77 offen offset:1024 lds
    buffer_load_dwordx4 v30, s[48:51], s77 offen offset:2048 lds
    buffer_load_dwordx4 v31, s[48:51], s77 offen offset:3072 lds
    s_mov_b32 m0, 67712
    s_nop 0
    buffer_load_dwordx4 v40, s[44:47], s78 offen lds
    buffer_load_dwordx4 v41, s[44:47], s78 offen offset:1024 lds
    buffer_load_dwordx4 v42, s[44:47], s78 offen offset:2048 lds
    buffer_load_dwordx4 v43, s[44:47], s78 offen offset:3072 lds
    s_mov_b32 m0, 47232
    s_nop 0
    buffer_load_dwordx4 v28, s[52:55], s77 offen lds
    buffer_load_dwordx4 v29, s[52:55], s77 offen offset:1024 lds
    buffer_load_dwordx4 v30, s[52:55], s77 offen offset:2048 lds
    buffer_load_dwordx4 v31, s[52:55], s77 offen offset:3072 lds
    s_mov_b32 m0, 71808
    s_nop 0
    buffer_load_dwordx4 v44, s[44:47], s78 offen lds
    buffer_load_dwordx4 v45, s[44:47], s78 offen offset:1024 lds
    buffer_load_dwordx4 v46, s[44:47], s78 offen offset:2048 lds
    buffer_load_dwordx4 v47, s[44:47], s78 offen offset:3072 lds
    s_mov_b32 m0, 43136
    s_nop 0
    buffer_load_dwordx4 v32, s[48:51], s77 offen lds
    buffer_load_dwordx4 v33, s[48:51], s77 offen offset:1024 lds
    buffer_load_dwordx4 v34, s[48:51], s77 offen offset:2048 lds
    buffer_load_dwordx4 v35, s[48:51], s77 offen offset:3072 lds
    s_mov_b32 m0, 75904
    s_nop 0
    buffer_load_dwordx4 v48, s[44:47], s78 offen lds
    buffer_load_dwordx4 v49, s[44:47], s78 offen offset:1024 lds
    s_mov_b32 m0, 51328
    s_nop 0
    buffer_load_dwordx4 v32, s[52:55], s77 offen lds
    buffer_load_dwordx4 v33, s[52:55], s77 offen offset:1024 lds
    buffer_load_dwordx4 v34, s[52:55], s77 offen offset:2048 lds
    buffer_load_dwordx4 v35, s[52:55], s77 offen offset:3072 lds
    s_waitcnt vmcnt(30) lgkmcnt(0)
    s_barrier
    s_lshr_b64 s[80:81], s[80:81], 4
    s_and_b32 s79, s80, 15
    s_add_u32 s79, s79, s43
    s_sub_u32 s38, s79, 10
    s_cmp_ge_u32 s79, 10
    s_cselect_b32 s79, s38, s79
    s_mov_b32 m0, 94464
    s_nop 0
    buffer_load_dwordx4 v28, s[56:59], s74 offen lds
    buffer_load_dwordx4 v29, s[56:59], s74 offen offset:1024 lds
    buffer_load_dwordx4 v30, s[56:59], s74 offen offset:2048 lds
    buffer_load_dwordx4 v31, s[56:59], s74 offen offset:3072 lds
    s_mov_b32 m0, 98560
    s_nop 0
    buffer_load_dwordx4 v32, s[56:59], s74 offen lds
    buffer_load_dwordx4 v33, s[56:59], s74 offen offset:1024 lds
    buffer_load_dwordx4 v34, s[56:59], s74 offen offset:2048 lds
    buffer_load_dwordx4 v35, s[56:59], s74 offen offset:3072 lds
    s_mov_b32 m0, 133504
    s_nop 0
    buffer_load_dwordx4 v28, s[56:59], s75 offen lds
    buffer_load_dwordx4 v29, s[56:59], s75 offen offset:1024 lds
    buffer_load_dwordx4 v30, s[56:59], s75 offen offset:2048 lds
    buffer_load_dwordx4 v31, s[56:59], s75 offen offset:3072 lds
    s_waitcnt vmcnt(12) lgkmcnt(0)
    s_barrier
    s_mov_b32 m0, 137600
    s_nop 0
    buffer_load_dwordx4 v32, s[56:59], s75 offen lds
    buffer_load_dwordx4 v33, s[56:59], s75 offen offset:1024 lds
    buffer_load_dwordx4 v34, s[56:59], s75 offen offset:2048 lds
    buffer_load_dwordx4 v35, s[56:59], s75 offen offset:3072 lds
    s_mov_b32 m0, 16384
    s_nop 0
    buffer_load_dwordx4 v28, s[56:59], s76 offen lds
    buffer_load_dwordx4 v29, s[56:59], s76 offen offset:1024 lds
    buffer_load_dwordx4 v30, s[56:59], s76 offen offset:2048 lds
    buffer_load_dwordx4 v31, s[56:59], s76 offen offset:3072 lds
    s_mov_b32 m0, 20480
    s_nop 0
    buffer_load_dwordx4 v32, s[56:59], s76 offen lds
    buffer_load_dwordx4 v33, s[56:59], s76 offen offset:1024 lds
    buffer_load_dwordx4 v34, s[56:59], s76 offen offset:2048 lds
    buffer_load_dwordx4 v35, s[56:59], s76 offen offset:3072 lds
    s_mov_b32 m0, 55424
    s_nop 0
    buffer_load_dwordx4 v28, s[56:59], s77 offen lds
    buffer_load_dwordx4 v29, s[56:59], s77 offen offset:1024 lds
    buffer_load_dwordx4 v30, s[56:59], s77 offen offset:2048 lds
    buffer_load_dwordx4 v31, s[56:59], s77 offen offset:3072 lds
    s_mov_b32 m0, 59520
    s_nop 0
    buffer_load_dwordx4 v32, s[56:59], s77 offen lds
    buffer_load_dwordx4 v33, s[56:59], s77 offen offset:1024 lds
    buffer_load_dwordx4 v34, s[56:59], s77 offen offset:2048 lds
    buffer_load_dwordx4 v35, s[56:59], s77 offen offset:3072 lds
    s_mov_b32 s10, 20480
    v_lshrrev_b32 v52, 5, v1
    v_lshlrev_b32 v52, 3, v52
    v_add_u32 v56, 8, v52
    v_mul_u32_u24 v52, 3, v52
    v_add_u32 v53, 2, v52
    v_add_u32 v54, 4, v52
    v_add_u32 v55, 6, v52
    v_add_u32 v57, 2, v56
    v_add_u32 v58, 4, v56
    v_add_u32 v59, 6, v56
    v_and_b32 v7, 3, v5
    v_mul_u32_u24 v7, 1280, v7
    v_add_u32 v60, v7, v50
    v_xor_b32 v61, 64, v60
    v_add_u32 v61, 4096, v61
    v_add_u32 v62, 8192, v60
    v_add_u32 v63, 8192, v61
    s_mov_b32 s42, 0
    s_mov_b32 s5, 0xbfe10856
    s_mov_b32 s6, 0xaff80255
    s_mov_b32 s7, 0xabfe4015
    s_mov_b32 s8, 0xaa7fd005
    s_mov_b32 s9, 0x6adfb401
    s_cmp_eq_u32 s42, 1
    s_cselect_b32 s5, 0xabfe4015, s5
    s_cselect_b32 s6, 0xaa7fd005, s6
    s_cselect_b32 s7, 0x6adfb401, s7
    s_cselect_b32 s8, 0xbfe10856, s8
    s_cselect_b32 s9, 0xaff80255, s9
    s_cmp_eq_u32 s42, 2
    s_cselect_b32 s5, 0x6adfb401, s5
    s_cselect_b32 s6, 0xbfe10856, s6
    s_cselect_b32 s7, 0xaff80255, s7
    s_cselect_b32 s8, 0xabfe4015, s8
    s_cselect_b32 s9, 0xaa7fd005, s9
    s_cmp_eq_u32 s42, 3
    s_cselect_b32 s5, 0xaff80255, s5
    s_cselect_b32 s6, 0xabfe4015, s6
    s_cselect_b32 s7, 0xaa7fd005, s7
    s_cselect_b32 s8, 0x6adfb401, s8
    s_cselect_b32 s9, 0xbfe10856, s9
    s_cmp_eq_u32 s42, 4
    s_cselect_b32 s5, 0xaa7fd005, s5
    s_cselect_b32 s6, 0x6adfb401, s6
    s_cselect_b32 s7, 0xbfe10856, s7
    s_cselect_b32 s8, 0xaff80255, s8
    s_cselect_b32 s9, 0xabfe4015, s9
    s_mul_i32 s4, s42, 163840
    s_mov_b32 m0, 0
    s_mov_b32 s4, 0
    v_bfe_u32 v64, s5, v52, 2
    v_mad_u32_u24 v64, v64, s10, v60
    buffer_load_dwordx4 v64, s[60:63], s4 offen lds
    v_bfe_u32 v65, s5, v53, 2
    v_mad_u32_u24 v65, v65, s10, v61
    buffer_load_dwordx4 v65, s[60:63], s4 offen offset:1024 lds
    v_bfe_u32 v64, s5, v54, 2
    v_mad_u32_u24 v64, v64, s10, v62
    buffer_load_dwordx4 v64, s[60:63], s4 offen offset:2048 lds
    v_bfe_u32 v65, s5, v55, 2
    v_mad_u32_u24 v65, v65, s10, v63
    buffer_load_dwordx4 v65, s[60:63], s4 offen offset:3072 lds
    s_mov_b32 m0, 4096
    s_mov_b32 s4, 81920
    v_bfe_u32 v64, s6, v52, 2
    v_mad_u32_u24 v64, v64, s10, v60
    buffer_load_dwordx4 v64, s[60:63], s4 offen lds
    v_bfe_u32 v65, s6, v53, 2
    v_mad_u32_u24 v65, v65, s10, v61
    buffer_load_dwordx4 v65, s[60:63], s4 offen offset:1024 lds
    v_bfe_u32 v64, s6, v54, 2
    v_mad_u32_u24 v64, v64, s10, v62
    buffer_load_dwordx4 v64, s[60:63], s4 offen offset:2048 lds
    v_bfe_u32 v65, s6, v55, 2
    v_mad_u32_u24 v65, v65, s10, v63
    buffer_load_dwordx4 v65, s[60:63], s4 offen offset:3072 lds
    s_mov_b32 m0, 8192
    s_mov_b32 s4, 163840
    v_bfe_u32 v64, s7, v52, 2
    v_mad_u32_u24 v64, v64, s10, v60
    buffer_load_dwordx4 v64, s[60:63], s4 offen lds
    v_bfe_u32 v65, s7, v53, 2
    v_mad_u32_u24 v65, v65, s10, v61
    buffer_load_dwordx4 v65, s[60:63], s4 offen offset:1024 lds
    v_bfe_u32 v64, s7, v54, 2
    v_mad_u32_u24 v64, v64, s10, v62
    buffer_load_dwordx4 v64, s[60:63], s4 offen offset:2048 lds
    v_bfe_u32 v65, s7, v55, 2
    v_mad_u32_u24 v65, v65, s10, v63
    buffer_load_dwordx4 v65, s[60:63], s4 offen offset:3072 lds
    s_mov_b32 m0, 12288
    s_mov_b32 s4, 245760
    v_bfe_u32 v64, s8, v52, 2
    v_mad_u32_u24 v64, v64, s10, v60
    buffer_load_dwordx4 v64, s[60:63], s4 offen lds
    v_bfe_u32 v65, s8, v53, 2
    v_mad_u32_u24 v65, v65, s10, v61
    buffer_load_dwordx4 v65, s[60:63], s4 offen offset:1024 lds
    v_bfe_u32 v64, s8, v54, 2
    v_mad_u32_u24 v64, v64, s10, v62
    buffer_load_dwordx4 v64, s[60:63], s4 offen offset:2048 lds
    v_bfe_u32 v65, s8, v55, 2
    v_mad_u32_u24 v65, v65, s10, v63
    buffer_load_dwordx4 v65, s[60:63], s4 offen offset:3072 lds
    s_waitcnt vmcnt(16)
    v_mov_b32 v5, 157980
    v_mov_b32 v6, 1
    s_mov_b64 exec, 1
    ds_add_u32 v5, v6
    s_mov_b64 exec, -1
    v_mov_b32 v5, 157972
    v_mov_b32 v6, 1
    s_mov_b64 exec, 1
    ds_add_u32 v5, v6
    s_mov_b64 exec, -1
    s_mov_b32 m0, 24576
    s_mov_b32 s4, 327680
    v_bfe_u32 v64, s9, v52, 2
    v_mad_u32_u24 v64, v64, s10, v60
    buffer_load_dwordx4 v64, s[60:63], s4 offen lds
    v_bfe_u32 v65, s9, v53, 2
    v_mad_u32_u24 v65, v65, s10, v61
    buffer_load_dwordx4 v65, s[60:63], s4 offen offset:1024 lds
    v_bfe_u32 v64, s9, v54, 2
    v_mad_u32_u24 v64, v64, s10, v62
    buffer_load_dwordx4 v64, s[60:63], s4 offen offset:2048 lds
    v_bfe_u32 v65, s9, v55, 2
    v_mad_u32_u24 v65, v65, s10, v63
    buffer_load_dwordx4 v65, s[60:63], s4 offen offset:3072 lds
    s_mov_b32 m0, 28672
    s_mov_b32 s4, 409600
    v_bfe_u32 v64, s5, v52, 2
    v_mad_u32_u24 v64, v64, s10, v60
    buffer_load_dwordx4 v64, s[60:63], s4 offen lds
    v_bfe_u32 v65, s5, v53, 2
    v_mad_u32_u24 v65, v65, s10, v61
    buffer_load_dwordx4 v65, s[60:63], s4 offen offset:1024 lds
    v_bfe_u32 v64, s5, v54, 2
    v_mad_u32_u24 v64, v64, s10, v62
    buffer_load_dwordx4 v64, s[60:63], s4 offen offset:2048 lds
    v_bfe_u32 v65, s5, v55, 2
    v_mad_u32_u24 v65, v65, s10, v63
    buffer_load_dwordx4 v65, s[60:63], s4 offen offset:3072 lds
    s_mov_b32 m0, 123136
    s_mov_b32 s4, 491520
    v_bfe_u32 v64, s6, v52, 2
    v_mad_u32_u24 v64, v64, s10, v60
    buffer_load_dwordx4 v64, s[60:63], s4 offen lds
    v_bfe_u32 v65, s6, v53, 2
    v_mad_u32_u24 v65, v65, s10, v61
    buffer_load_dwordx4 v65, s[60:63], s4 offen offset:1024 lds
    v_bfe_u32 v64, s6, v54, 2
    v_mad_u32_u24 v64, v64, s10, v62
    buffer_load_dwordx4 v64, s[60:63], s4 offen offset:2048 lds
    v_bfe_u32 v65, s6, v55, 2
    v_mad_u32_u24 v65, v65, s10, v63
    buffer_load_dwordx4 v65, s[60:63], s4 offen offset:3072 lds
    s_mov_b32 m0, 127232
    s_mov_b32 s4, 573440
    v_bfe_u32 v64, s7, v52, 2
    v_mad_u32_u24 v64, v64, s10, v60
    buffer_load_dwordx4 v64, s[60:63], s4 offen lds
    v_bfe_u32 v65, s7, v53, 2
    v_mad_u32_u24 v65, v65, s10, v61
    buffer_load_dwordx4 v65, s[60:63], s4 offen offset:1024 lds
    v_bfe_u32 v64, s7, v54, 2
    v_mad_u32_u24 v64, v64, s10, v62
    buffer_load_dwordx4 v64, s[60:63], s4 offen offset:2048 lds
    v_bfe_u32 v65, s7, v55, 2
    v_mad_u32_u24 v65, v65, s10, v63
    buffer_load_dwordx4 v65, s[60:63], s4 offen offset:3072 lds
    s_mov_b32 m0, 80000
    s_mov_b32 s4, 655360
    v_bfe_u32 v64, s8, v52, 2
    v_mad_u32_u24 v64, v64, s10, v60
    buffer_load_dwordx4 v64, s[60:63], s4 offen lds
    v_bfe_u32 v65, s8, v53, 2
    v_mad_u32_u24 v65, v65, s10, v61
    buffer_load_dwordx4 v65, s[60:63], s4 offen offset:1024 lds
    v_bfe_u32 v64, s8, v54, 2
    v_mad_u32_u24 v64, v64, s10, v62
    buffer_load_dwordx4 v64, s[60:63], s4 offen offset:2048 lds
    v_bfe_u32 v65, s8, v55, 2
    v_mad_u32_u24 v65, v65, s10, v63
    buffer_load_dwordx4 v65, s[60:63], s4 offen offset:3072 lds
    s_mov_b32 m0, 84096
    s_mov_b32 s4, 737280
    v_bfe_u32 v64, s9, v52, 2
    v_mad_u32_u24 v64, v64, s10, v60
    buffer_load_dwordx4 v64, s[60:63], s4 offen lds
    v_bfe_u32 v65, s9, v53, 2
    v_mad_u32_u24 v65, v65, s10, v61
    buffer_load_dwordx4 v65, s[60:63], s4 offen offset:1024 lds
    v_bfe_u32 v64, s9, v54, 2
    v_mad_u32_u24 v64, v64, s10, v62
    buffer_load_dwordx4 v64, s[60:63], s4 offen offset:2048 lds
    v_bfe_u32 v65, s9, v55, 2
    v_mad_u32_u24 v65, v65, s10, v63
    buffer_load_dwordx4 v65, s[60:63], s4 offen offset:3072 lds
    s_waitcnt vmcnt(0)
    v_mov_b32 v7, 157980
    v_mov_b32 v6, 1
    s_mov_b64 exec, 1
    ds_add_u32 v7, v6
    s_mov_b64 exec, -1
Lcw_7:
    s_sub_u32 s35, s35, 1
    s_cbranch_scc1 Lend
    s_sleep 2
    ds_read_b32 v6, v5
    s_waitcnt lgkmcnt(0)
    v_readfirstlane_b32 s38, v6
    s_nop 0
    s_cmp_lt_u32 s38, 8
    s_cbranch_scc1 Lcw_7
    s_lshl_b32 s36, s32, 7
    s_add_u32 s36, s36, 8257536
    v_mov_b32 v69, s36
    buffer_load_dwordx4 v[70:73], v69, s[28:31], 0 offen sc1
    v_mov_b32 v5, 157976
Lcw_8:
    s_sub_u32 s35, s35, 1
    s_cbranch_scc1 Lend
    s_sleep 2
    ds_read_b32 v6, v5
    s_waitcnt lgkmcnt(0)
    v_readfirstlane_b32 s38, v6
    s_nop 0
    s_cmp_lt_u32 s38, 7
    s_cbranch_scc1 Lcw_8
    s_mov_b32 m0, 32768
    s_mov_b32 s4, 0
    v_bfe_u32 v64, s5, v56, 2
    v_mad_u32_u24 v64, v64, s10, v60
    buffer_load_dwordx4 v64, s[60:63], s4 offen lds
    v_bfe_u32 v65, s5, v57, 2
    v_mad_u32_u24 v65, v65, s10, v61
    buffer_load_dwordx4 v65, s[60:63], s4 offen offset:1024 lds
    v_bfe_u32 v64, s5, v58, 2
    v_mad_u32_u24 v64, v64, s10, v62
    buffer_load_dwordx4 v64, s[60:63], s4 offen offset:2048 lds
    v_bfe_u32 v65, s5, v59, 2
    v_mad_u32_u24 v65, v65, s10, v63
    buffer_load_dwordx4 v65, s[60:63], s4 offen offset:3072 lds
    s_mov_b32 m0, 36864
    s_mov_b32 s4, 81920
    v_bfe_u32 v64, s6, v56, 2
    v_mad_u32_u24 v64, v64, s10, v60
    buffer_load_dwordx4 v64, s[60:63], s4 offen lds
    v_bfe_u32 v65, s6, v57, 2
    v_mad_u32_u24 v65, v65, s10, v61
    buffer_load_dwordx4 v65, s[60:63], s4 offen offset:1024 lds
    v_bfe_u32 v64, s6, v58, 2
    v_mad_u32_u24 v64, v64, s10, v62
    buffer_load_dwordx4 v64, s[60:63], s4 offen offset:2048 lds
    v_bfe_u32 v65, s6, v59, 2
    v_mad_u32_u24 v65, v65, s10, v63
    buffer_load_dwordx4 v65, s[60:63], s4 offen offset:3072 lds
    s_mov_b32 m0, 40960
    s_mov_b32 s4, 163840
    v_bfe_u32 v64, s7, v56, 2
    v_mad_u32_u24 v64, v64, s10, v60
    buffer_load_dwordx4 v64, s[60:63], s4 offen lds
    v_bfe_u32 v65, s7, v57, 2
    v_mad_u32_u24 v65, v65, s10, v61
    buffer_load_dwordx4 v65, s[60:63], s4 offen offset:1024 lds
    v_bfe_u32 v64, s7, v58, 2
    v_mad_u32_u24 v64, v64, s10, v62
    buffer_load_dwordx4 v64, s[60:63], s4 offen offset:2048 lds
    v_bfe_u32 v65, s7, v59, 2
    v_mad_u32_u24 v65, v65, s10, v63
    buffer_load_dwordx4 v65, s[60:63], s4 offen offset:3072 lds
    s_mov_b32 m0, 45056
    s_mov_b32 s4, 245760
    v_bfe_u32 v64, s8, v56, 2
    v_mad_u32_u24 v64, v64, s10, v60
    buffer_load_dwordx4 v64, s[60:63], s4 offen lds
    v_bfe_u32 v65, s8, v57, 2
    v_mad_u32_u24 v65, v65, s10, v61
    buffer_load_dwordx4 v65, s[60:63], s4 offen offset:1024 lds
    v_bfe_u32 v64, s8, v58, 2
    v_mad_u32_u24 v64, v64, s10, v62
    buffer_load_dwordx4 v64, s[60:63], s4 offen offset:2048 lds
    v_bfe_u32 v65, s8, v59, 2
    v_mad_u32_u24 v65, v65, s10, v63
    buffer_load_dwordx4 v65, s[60:63], s4 offen offset:3072 lds
    s_mov_b32 m0, 63616
    s_mov_b32 s4, 327680
    v_bfe_u32 v64, s9, v56, 2
    v_mad_u32_u24 v64, v64, s10, v60
    buffer_load_dwordx4 v64, s[60:63], s4 offen lds
    v_bfe_u32 v65, s9, v57, 2
    v_mad_u32_u24 v65, v65, s10, v61
    buffer_load_dwordx4 v65, s[60:63], s4 offen offset:1024 lds
    v_bfe_u32 v64, s9, v58, 2
    v_mad_u32_u24 v64, v64, s10, v62
    buffer_load_dwordx4 v64, s[60:63], s4 offen offset:2048 lds
    v_bfe_u32 v65, s9, v59, 2
    v_mad_u32_u24 v65, v65, s10, v63
    buffer_load_dwordx4 v65, s[60:63], s4 offen offset:3072 lds
    s_mov_b32 m0, 67712
    s_mov_b32 s4, 409600
    v_bfe_u32 v64, s5, v56, 2
    v_mad_u32_u24 v64, v64, s10, v60
    buffer_load_dwordx4 v64, s[60:63], s4 offen lds
    v_bfe_u32 v65, s5, v57, 2
    v_mad_u32_u24 v65, v65, s10, v61
    buffer_load_dwordx4 v65, s[60:63], s4 offen offset:1024 lds
    v_bfe_u32 v64, s5, v58, 2
    v_mad_u32_u24 v64, v64, s10, v62
    buffer_load_dwordx4 v64, s[60:63], s4 offen offset:2048 lds
    v_bfe_u32 v65, s5, v59, 2
    v_mad_u32_u24 v65, v65, s10, v63
    buffer_load_dwordx4 v65, s[60:63], s4 offen offset:3072 lds
    s_mov_b32 m0, 71808
    s_mov_b32 s4, 491520
    v_bfe_u32 v64, s6, v56, 2
    v_mad_u32_u24 v64, v64, s10, v60
    buffer_load_dwordx4 v64, s[60:63], s4 offen lds
    v_bfe_u32 v65, s6, v57, 2
    v_mad_u32_u24 v65, v65, s10, v61
    buffer_load_dwordx4 v65, s[60:63], s4 offen offset:1024 lds
    v_bfe_u32 v64, s6, v58, 2
    v_mad_u32_u24 v64, v64, s10, v62
    buffer_load_dwordx4 v64, s[60:63], s4 offen offset:2048 lds
    v_bfe_u32 v65, s6, v59, 2
    v_mad_u32_u24 v65, v65, s10, v63
    buffer_load_dwordx4 v65, s[60:63], s4 offen offset:3072 lds
    s_mov_b32 m0, 75904
    s_mov_b32 s4, 573440
    v_bfe_u32 v64, s7, v56, 2
    v_mad_u32_u24 v64, v64, s10, v60
    buffer_load_dwordx4 v64, s[60:63], s4 offen lds
    v_bfe_u32 v65, s7, v57, 2
    v_mad_u32_u24 v65, v65, s10, v61
    buffer_load_dwordx4 v65, s[60:63], s4 offen offset:1024 lds
    v_bfe_u32 v64, s7, v58, 2
    v_mad_u32_u24 v64, v64, s10, v62
    buffer_load_dwordx4 v64, s[60:63], s4 offen offset:2048 lds
    v_bfe_u32 v65, s7, v59, 2
    v_mad_u32_u24 v65, v65, s10, v63
    buffer_load_dwordx4 v65, s[60:63], s4 offen offset:3072 lds
    s_mov_b32 m0, 49152
    s_mov_b32 s4, 655360
    v_bfe_u32 v64, s8, v56, 2
    v_mad_u32_u24 v64, v64, s10, v60
    buffer_load_dwordx4 v64, s[60:63], s4 offen lds
    v_bfe_u32 v65, s8, v57, 2
    v_mad_u32_u24 v65, v65, s10, v61
    buffer_load_dwordx4 v65, s[60:63], s4 offen offset:1024 lds
    v_bfe_u32 v64, s8, v58, 2
    v_mad_u32_u24 v64, v64, s10, v62
    buffer_load_dwordx4 v64, s[60:63], s4 offen offset:2048 lds
    v_bfe_u32 v65, s8, v59, 2
    v_mad_u32_u24 v65, v65, s10, v63
    buffer_load_dwordx4 v65, s[60:63], s4 offen offset:3072 lds
    s_mov_b32 m0, 88192
    s_mov_b32 s4, 737280
    v_bfe_u32 v64, s9, v56, 2
    v_mad_u32_u24 v64, v64, s10, v60
    buffer_load_dwordx4 v64, s[60:63], s4 offen lds
    v_bfe_u32 v65, s9, v57, 2
    v_mad_u32_u24 v65, v65, s10, v61
    buffer_load_dwordx4 v65, s[60:63], s4 offen offset:1024 lds
    v_bfe_u32 v64, s9, v58, 2
    v_mad_u32_u24 v64, v64, s10, v62
    buffer_load_dwordx4 v64, s[60:63], s4 offen offset:2048 lds
    v_bfe_u32 v65, s9, v59, 2
    v_mad_u32_u24 v65, v65, s10, v63
    buffer_load_dwordx4 v65, s[60:63], s4 offen offset:3072 lds
    s_waitcnt vmcnt(0)
Lbc:
    v_readfirstlane_b32 s11, v70
    v_readfirstlane_b32 s36, v71
    v_readfirstlane_b32 s12, v72
    v_readfirstlane_b32 s37, v73
    s_cmp_eq_u32 s36, s34
    s_cselect_b32 s37, s37, s36
    s_cmp_eq_u32 s37, s34
    s_cbranch_scc1 Lbc_ok
Lbc_re:
    s_sub_u32 s35, s35, 1
    s_cbranch_scc1 Lend
    buffer_load_dwordx4 v[70:73], v69, s[28:31], 0 offen sc1
    s_waitcnt vmcnt(0)
    s_branch Lbc
Lbc_ok:
    s_mul_i32 s36, s32, 96
    s_and_b32 s13, s11, 0x7ff
    s_sub_u32 s13, 2047, s13
    s_sub_u32 s37, s13, s36
    s_cmp_lt_u32 s37, 96
    s_cselect_b32 s13, s13, -1
    s_and_b32 s14, s12, 0x7ff
    s_sub_u32 s14, 2047, s14
    s_sub_u32 s37, s14, s36
    s_cmp_lt_u32 s37, 96
    s_cselect_b32 s14, s14, -1
    v_mov_b32 v4, s13
    v_mov_b32 v5, s14
    v_mov_b32 v6, 157960
    s_cmp_lg_u32 s3, 0
    s_cbranch_scc1 Lag2
    ds_write_b64 v6, v[4:5]
    s_branch Lw0_done
Lag2:
    s_and_b32 s37, s13, s14
    s_cmp_eq_u32 s37, -1
    s_cbranch_scc1 Lw0_done
    s_max_i32 s36, s13, 0
    s_mul_i32 s36, s36, 1280
    s_lshl_b32 s37, s33, 7
    s_add_u32 s36, s36, s37
    s_add_u32 s36, s36, 4096
    v_lshlrev_b32 v8, 1, v1
    buffer_load_ushort v124, v8, s[44:47], s36 offen
    s_max_i32 s36, s14, 0
    s_mul_i32 s36, s36, 1280
    s_lshl_b32 s37, s33, 7
    s_add_u32 s36, s36, s37
    s_add_u32 s36, s36, 4096
    v_lshlrev_b32 v8, 1, v1
    buffer_load_ushort v125, v8, s[44:47], s36 offen
    v_min_u32 v7, 26, v1
    v_mul_u32_u24 v7, 10240, v7
Ly_poll:
    s_sub_u32 s35, s35, 1
    s_cbranch_scc1 Lend
    s_sleep 4
    s_lshl_b32 s36, s33, 10
    s_add_u32 s36, s36, 7405568
    buffer_load_dword v4, v7, s[28:31], s36 offen offset:1020 sc1
    s_waitcnt vmcnt(0)
    v_cmp_ne_u32 vcc, s34, v4
    s_nop 0
    s_cbranch_vccnz Ly_poll
    buffer_load_dwordx4 v[16:19], v13, s[28:31], s36 offen sc1
    s_add_u32 s36, s36, 10240
    buffer_load_dwordx4 v[20:23], v13, s[28:31], s36 offen sc1
    s_add_u32 s36, s36, 10240
    buffer_load_dwordx4 v[24:27], v13, s[28:31], s36 offen sc1
    s_add_u32 s36, s36, 10240
    buffer_load_dwordx4 v[28:31], v13, s[28:31], s36 offen sc1
    s_add_u32 s36, s36, 10240
    buffer_load_dwordx4 v[32:35], v13, s[28:31], s36 offen sc1
    s_add_u32 s36, s36, 10240
    buffer_load_dwordx4 v[36:39], v13, s[28:31], s36 offen sc1
    s_add_u32 s36, s36, 10240
    buffer_load_dwordx4 v[40:43], v13, s[28:31], s36 offen sc1
    s_add_u32 s36, s36, 10240
    buffer_load_dwordx4 v[44:47], v13, s[28:31], s36 offen sc1
    s_add_u32 s36, s36, 10240
    buffer_load_dwordx4 v[48:51], v13, s[28:31], s36 offen sc1
    s_add_u32 s36, s36, 10240
    buffer_load_dwordx4 v[52:55], v13, s[28:31], s36 offen sc1
    s_add_u32 s36, s36, 10240
    buffer_load_dwordx4 v[56:59], v13, s[28:31], s36 offen sc1
    s_add_u32 s36, s36, 10240
    buffer_load_dwordx4 v[60:63], v13, s[28:31], s36 offen sc1
    s_add_u32 s36, s36, 10240
    buffer_load_dwordx4 v[64:67], v13, s[28:31], s36 offen sc1
    s_add_u32 s36, s36, 10240
    buffer_load_dwordx4 v[68:71], v13, s[28:31], s36 offen sc1
    s_add_u32 s36, s36, 10240
    buffer_load_dwordx4 v[72:75], v13, s[28:31], s36 offen sc1
    s_add_u32 s36, s36, 10240
    buffer_load_dwordx4 v[76:79], v13, s[28:31], s36 offen sc1
    s_add_u32 s36, s36, 10240
    buffer_load_dwordx4 v[80:83], v13, s[28:31], s36 offen sc1
    s_add_u32 s36, s36, 10240
    buffer_load_dwordx4 v[84:87], v13, s[28:31], s36 offen sc1
    s_add_u32 s36, s36, 10240
    buffer_load_dwordx4 v[88:91], v13, s[28:31], s36 offen sc1
    s_add_u32 s36, s36, 10240
    buffer_load_dwordx4 v[92:95], v13, s[28:31], s36 offen sc1
    s_add_u32 s36, s36, 10240
    buffer_load_dwordx4 v[96:99], v13, s[28:31], s36 offen sc1
    s_add_u32 s36, s36, 10240
    buffer_load_dwordx4 v[100:103], v13, s[28:31], s36 offen sc1
    s_add_u32 s36, s36, 10240
    buffer_load_dwordx4 v[104:107], v13, s[28:31], s36 offen sc1
    s_add_u32 s36, s36, 10240
    buffer_load_dwordx4 v[108:111], v13, s[28:31], s36 offen sc1
    s_add_u32 s36, s36, 10240
    buffer_load_dwordx4 v[112:115], v13, s[28:31], s36 offen sc1
    s_add_u32 s36, s36, 10240
    buffer_load_dwordx4 v[116:119], v13, s[28:31], s36 offen sc1
    s_add_u32 s36, s36, 10240
    buffer_load_dwordx4 v[120:123], v13, s[28:31], s36 offen sc1
    s_add_u32 s36, s36, 10240
    s_waitcnt vmcnt(0)
    v_xor_b32 v4, s34, v17
    v_xor_b32 v5, s34, v19
    v_or_b32 v4, v4, v5
    v_xor_b32 v5, s34, v21
    v_or_b32 v4, v4, v5
    v_xor_b32 v5, s34, v23
    v_or_b32 v4, v4, v5
    v_xor_b32 v5, s34, v25
    v_or_b32 v4, v4, v5
    v_xor_b32 v5, s34, v27
    v_or_b32 v4, v4, v5
    v_xor_b32 v5, s34, v29
    v_or_b32 v4, v4, v5
    v_xor_b32 v5, s34, v31
    v_or_b32 v4, v4, v5
    v_xor_b32 v5, s34, v33
    v_or_b32 v4, v4, v5
    v_xor_b32 v5, s34, v35
    v_or_b32 v4, v4, v5
    v_xor_b32 v5, s34, v37
    v_or_b32 v4, v4, v5
    v_xor_b32 v5, s34, v39
    v_or_b32 v4, v4, v5
    v_xor_b32 v5, s34, v41
    v_or_b32 v4, v4, v5
    v_xor_b32 v5, s34, v43
    v_or_b32 v4, v4, v5
    v_xor_b32 v5, s34, v45
    v_or_b32 v4, v4, v5
    v_xor_b32 v5, s34, v47
    v_or_b32 v4, v4, v5
    v_xor_b32 v5, s34, v49
    v_or_b32 v4, v4, v5
    v_xor_b32 v5, s34, v51
    v_or_b32 v4, v4, v5
    v_xor_b32 v5, s34, v53
    v_or_b32 v4, v4, v5
    v_xor_b32 v5, s34, v55
    v_or_b32 v4, v4, v5
    v_xor_b32 v5, s34, v57
    v_or_b32 v4, v4, v5
    v_xor_b32 v5, s34, v59
    v_or_b32 v4, v4, v5
    v_xor_b32 v5, s34, v61
    v_or_b32 v4, v4, v5
    v_xor_b32 v5, s34, v63
    v_or_b32 v4, v4, v5
    v_xor_b32 v5, s34, v65
    v_or_b32 v4, v4, v5
    v_xor_b32 v5, s34, v67
    v_or_b32 v4, v4, v5
    v_xor_b32 v5, s34, v69
    v_or_b32 v4, v4, v5
    v_xor_b32 v5, s34, v71
    v_or_b32 v4, v4, v5
    v_xor_b32 v5, s34, v73
    v_or_b32 v4, v4, v5
    v_xor_b32 v5, s34, v75
    v_or_b32 v4, v4, v5
    v_xor_b32 v5, s34, v77
    v_or_b32 v4, v4, v5
    v_xor_b32 v5, s34, v79
    v_or_b32 v4, v4, v5
    v_xor_b32 v5, s34, v81
    v_or_b32 v4, v4, v5
    v_xor_b32 v5, s34, v83
    v_or_b32 v4, v4, v5
    v_xor_b32 v5, s34, v85
    v_or_b32 v4, v4, v5
    v_xor_b32 v5, s34, v87
    v_or_b32 v4, v4, v5
    v_xor_b32 v5, s34, v89
    v_or_b32 v4, v4, v5
    v_xor_b32 v5, s34, v91
    v_or_b32 v4, v4, v5
    v_xor_b32 v5, s34, v93
    v_or_b32 v4, v4, v5
    v_xor_b32 v5, s34, v95
    v_or_b32 v4, v4, v5
    v_xor_b32 v5, s34, v97
    v_or_b32 v4, v4, v5
    v_xor_b32 v5, s34, v99
    v_or_b32 v4, v4, v5
    v_xor_b32 v5, s34, v101
    v_or_b32 v4, v4, v5
    v_xor_b32 v5, s34, v103
    v_or_b32 v4, v4, v5
    v_xor_b32 v5, s34, v105
    v_or_b32 v4, v4, v5
    v_xor_b32 v5, s34, v107
    v_or_b32 v4, v4, v5
    v_xor_b32 v5, s34, v109
    v_or_b32 v4, v4, v5
    v_xor_b32 v5, s34, v111
    v_or_b32 v4, v4, v5
    v_xor_b32 v5, s34, v113
    v_or_b32 v4, v4, v5
    v_xor_b32 v5, s34, v115
    v_or_b32 v4, v4, v5
    v_xor_b32 v5, s34, v117
    v_or_b32 v4, v4, v5
    v_xor_b32 v5, s34, v119
    v_or_b32 v4, v4, v5
    v_xor_b32 v5, s34, v121
    v_or_b32 v4, v4, v5
    v_xor_b32 v5, s34, v123
    v_or_b32 v4, v4, v5
    v_cmp_ne_u32 vcc, 0, v4
    s_nop 0
    s_cmp_lg_u64 vcc, 0
    s_cbranch_scc1 Ly_poll
    v_add_f32 v16, v16, v20
    v_add_f32 v18, v18, v22
    v_add_f32 v16, v16, v24
    v_add_f32 v18, v18, v26
    v_add_f32 v16, v16, v28
    v_add_f32 v18, v18, v30
    v_add_f32 v16, v16, v32
    v_add_f32 v18, v18, v34
    v_add_f32 v16, v16, v36
    v_add_f32 v18, v18, v38
    v_add_f32 v16, v16, v40
    v_add_f32 v18, v18, v42
    v_add_f32 v16, v16, v44
    v_add_f32 v18, v18, v46
    v_add_f32 v16, v16, v48
    v_add_f32 v18, v18, v50
    v_add_f32 v16, v16, v52
    v_add_f32 v18, v18, v54
    v_add_f32 v16, v16, v56
    v_add_f32 v18, v18, v58
    v_add_f32 v16, v16, v60
    v_add_f32 v18, v18, v62
    v_add_f32 v16, v16, v64
    v_add_f32 v18, v18, v66
    v_add_f32 v16, v16, v68
    v_add_f32 v18, v18, v70
    v_add_f32 v16, v16, v72
    v_add_f32 v18, v18, v74
    v_add_f32 v16, v16, v76
    v_add_f32 v18, v18, v78
    v_add_f32 v16, v16, v80
    v_add_f32 v18, v18, v82
    v_add_f32 v16, v16, v84
    v_add_f32 v18, v18, v86
    v_add_f32 v16, v16, v88
    v_add_f32 v18, v18, v90
    v_add_f32 v16, v16, v92
    v_add_f32 v18, v18, v94
    v_add_f32 v16, v16, v96
    v_add_f32 v18, v18, v98
    v_add_f32 v16, v16, v100
    v_add_f32 v18, v18, v102
    v_add_f32 v16, v16, v104
    v_add_f32 v18, v18, v106
    v_add_f32 v16, v16, v108
    v_add_f32 v18, v18, v110
    v_add_f32 v16, v16, v112
    v_add_f32 v18, v18, v114
    v_add_f32 v16, v16, v116
    v_add_f32 v18, v18, v118
    v_add_f32 v16, v16, v120
    v_add_f32 v18, v18, v122
    s_lshr_b32 s36, s11, 16
    s_cmp_ge_u32 s36, 0x8000
    s_cselect_b32 s37, 0x8000, -1
    s_xor_b32 s36, s36, s37
    s_lshl_b32 s36, s36, 16
    v_mov_b32 v4, s36
    v_mul_f32 v4, 0xbfb8aa3b, v4
    v_exp_f32 v4, v4
    s_nop 0
    v_add_f32 v4, 1.0, v4
    v_rcp_f32 v4, v4
    s_nop 0
    v_cvt_pk_bf16_f32 v4, v4, v4
    v_lshlrev_b32 v4, 16, v4
    v_cvt_pk_bf16_f32 v16, v16, v16
    v_lshlrev_b32 v16, 16, v16
    v_mul_f32 v16, v16, v4
    v_cvt_pk_bf16_f32 v16, v16, v16
    v_lshlrev_b32 v16, 16, v16
    s_lshr_b32 s36, s12, 16
    s_cmp_ge_u32 s36, 0x8000
    s_cselect_b32 s37, 0x8000, -1
    s_xor_b32 s36, s36, s37
    s_lshl_b32 s36, s36, 16
    v_mov_b32 v4, s36
    v_mul_f32 v4, 0xbfb8aa3b, v4
    v_exp_f32 v4, v4
    s_nop 0
    v_add_f32 v4, 1.0, v4
    v_rcp_f32 v4, v4
    s_nop 0
    v_cvt_pk_bf16_f32 v4, v4, v4
    v_lshlrev_b32 v4, 16, v4
    v_cvt_pk_bf16_f32 v18, v18, v18
    v_lshlrev_b32 v18, 16, v18
    v_mul_f32 v18, v18, v4
    v_cvt_pk_bf16_f32 v18, v18, v18
    v_lshlrev_b32 v18, 16, v18
    s_mul_i32 s36, s32, 96
    s_sub_u32 s36, s13, s36
    s_max_i32 s36, s36, 0
    s_lshl_b32 s36, s36, 2
    s_add_u32 s36, s36, 156288
    v_mov_b32 v4, s36
    ds_read2st64_b32 v[4:5], v4 offset0:0 offset1:2
    v_lshlrev_b32 v124, 16, v124
    s_waitcnt lgkmcnt(0)
    v_add_f32 v20, v124, v4
    v_cvt_pk_bf16_f32 v20, v20, v20
    v_lshlrev_b32 v20, 16, v20
    v_mul_f32 v20, v20, v5
    v_cvt_pk_bf16_f32 v20, v20, v20
    v_lshlrev_b32 v20, 16, v20
    v_add_f32 v20, v20, v16
    v_cvt_pk_bf16_f32 v20, v20, v20
    v_lshlrev_b32 v20, 16, v20
    v_mul_f32 v16, 0xbfb8aa3b, v20
    v_exp_f32 v16, v16
    s_nop 0
    v_add_f32 v16, 1.0, v16
    v_rcp_f32 v16, v16
    s_nop 0
    v_mul_f32 v16, v16, v20
    v_cvt_pk_bf16_f32 v16, v16, v16
    v_lshlrev_b32 v16, 16, v16
    s_mul_i32 s36, s32, 96
    s_sub_u32 s36, s14, s36
    s_max_i32 s36, s36, 0
    s_lshl_b32 s36, s36, 2
    s_add_u32 s36, s36, 156288
    v_mov_b32 v4, s36
    ds_read2st64_b32 v[4:5], v4 offset0:0 offset1:2
    v_lshlrev_b32 v125, 16, v125
    s_waitcnt lgkmcnt(0)
    v_add_f32 v22, v125, v4
    v_cvt_pk_bf16_f32 v22, v22, v22
    v_lshlrev_b32 v22, 16, v22
    v_mul_f32 v22, v22, v5
    v_cvt_pk_bf16_f32 v22, v22, v22
    v_lshlrev_b32 v22, 16, v22
    v_add_f32 v22, v22, v18
    v_cvt_pk_bf16_f32 v22, v22, v22
    v_lshlrev_b32 v22, 16, v22
    v_mul_f32 v18, 0xbfb8aa3b, v22
    v_exp_f32 v18, v18
    s_nop 0
    v_add_f32 v18, 1.0, v18
    v_rcp_f32 v18, v18
    s_nop 0
    v_mul_f32 v18, v18, v22
    v_cvt_pk_bf16_f32 v18, v18, v18
    v_lshlrev_b32 v18, 16, v18
    v_add_u32 v5, 158208, v12
    ds_write2st64_b32 v5, v16, v18 offset0:0 offset1:1
    v_mov_b32 v6, 157956
    v_mov_b32 v7, 1
    s_mov_b64 exec, 1
    ds_add_u32 v6, v7
    s_mov_b64 exec, -1
Lw0_done:
    s_endpgm
Lagent:
    s_sub_u32 s44, s4, 4096
    s_subb_u32 s45, s5, 0
    s_mov_b32 s46, 2625536
    s_mov_b32 s47, 0x20000
    s_lshl_b32 s36, s32, 7
    s_add_u32 s36, s36, 8257536
    v_mov_b32 v69, s36
    s_branch Lbc_re
Lcomp:
    s_lshl_b32 s44, s26, 1
    s_add_u32 s44, s44, s27
    s_sub_u32 s36, s33, 5
    s_cmp_ge_u32 s33, 5
    s_cselect_b32 s40, s36, s33
    s_mov_b32 s41, 0xbfe10856
    s_cmp_eq_u32 s40, 1
    s_cselect_b32 s41, 0xaff80255, s41
    s_cmp_eq_u32 s40, 2
    s_cselect_b32 s41, 0xabfe4015, s41
    s_cmp_eq_u32 s40, 3
    s_cselect_b32 s41, 0xaa7fd005, s41
    s_cmp_eq_u32 s40, 4
    s_cselect_b32 s41, 0x6adfb401, s41
    s_lshl_b32 s37, s27, 13
    s_cmp_eq_u32 s44, 1
    s_cselect_b32 s37, 0, s37
    v_bfe_u32 v7, v1, 2, 2
    v_and_b32 v8, 3, v1
    v_lshl_add_u32 v18, v2, 3, v7
    v_lshlrev_b32 v18, 7, v18
    v_lshlrev_b32 v19, 2, v1
    v_and_b32 v19, 0x60, v19
    v_lshlrev_b32 v10, 1, v8
    v_add_u32 v9, s37, v18
    v_add_u32 v11, 0, v10
    v_bfe_u32 v11, s41, v11, 2
    v_lshl_add_u32 v11, v11, 2, v8
    v_lshlrev_b32 v11, 3, v11
    v_xad_u32 v20, v11, v19, v9
    v_add_u32 v11, 8, v10
    v_bfe_u32 v11, s41, v11, 2
    v_lshl_add_u32 v11, v11, 2, v8
    v_lshlrev_b32 v11, 3, v11
    v_xad_u32 v21, v11, v19, v9
    v_add_u32 v11, 16, v10
    v_bfe_u32 v11, s41, v11, 2
    v_lshl_add_u32 v11, v11, 2, v8
    v_lshlrev_b32 v11, 3, v11
    v_xad_u32 v22, v11, v19, v9
    v_add_u32 v11, 24, v10
    v_bfe_u32 v11, s41, v11, 2
    v_lshl_add_u32 v11, v11, 2, v8
    v_lshlrev_b32 v11, 3, v11
    v_xad_u32 v23, v11, v19, v9
    v_add_u32 v24, 78080, v20
    v_add_u32 v25, 78080, v21
    v_add_u32 v26, 78080, v22
    v_add_u32 v27, 78080, v23
    v_lshrrev_b32 v10, 1, v3
    v_xor_b32 v9, v10, v2
    v_lshlrev_b32 v9, 4, v9
    v_lshl_add_u32 v9, v3, 7, v9
    s_lshl_b32 s36, s44, 11
    s_xor_b32 s38, s36, 2048
    s_add_u32 s36, s36, 22528
    s_add_u32 s38, s38, 22528
    v_add_u32 v76, s36, v9
    v_add_u32 v78, s38, v9
    s_mul_i32 s39, s26, 6144
    s_add_u32 s39, s39, 98560
    v_add_u32 v125, s39, v13
    s_lshl_b32 s45, s44, 11
    s_add_u32 s45, s45, 139648
    s_waitcnt lgkmcnt(0)
    s_mov_b64 s[28:29], s[24:25]
    s_mov_b32 s30, 268435456
    s_mov_b32 s31, 0x20000
    s_load_dword s34, s[28:29], 0
    s_cmp_eq_u32 s44, 1
    s_cbranch_scc1 Lhalo
    v_xor_b32 v77, 64, v76
    v_xor_b32 v79, 64, v78
    v_add_u32 v80, 78080, v76
    v_add_u32 v81, 78080, v77
    v_add_u32 v82, 78080, v78
    v_add_u32 v83, 78080, v79
    s_cmp_eq_u32 s27, 0
    s_cselect_b64 vcc, 0, -1
    s_sub_u32 s37, 16384, s37
    v_cndmask_b32 v84, v20, v22, vcc
    v_cndmask_b32 v85, v21, v23, vcc
    v_add_u32 v84, s37, v84
    v_add_u32 v85, s37, v85
    v_add_u32 v86, 78080, v84
    v_add_u32 v87, 78080, v85
    v_lshrrev_b32 v8, 1, v2
    v_xor_b32 v8, v8, v10
    v_lshlrev_b32 v8, 4, v8
    v_lshl_add_u32 v8, v3, 7, v8
    v_and_b32 v7, 1, v2
    v_lshl_add_u32 v124, v7, 3, v8
    s_mov_b32 s46, 0
    s_mov_b32 s38, 0x86542310
    s_mov_b32 s39, 0x97
    s_cmp_eq_u32 s42, 1
    s_cselect_b32 s38, 0x76453210, s38
    s_cselect_b32 s39, 0x98, s39
    s_cmp_eq_u32 s42, 2
    s_cselect_b32 s38, 0x67543120, s38
    s_cselect_b32 s39, 0x98, s39
    s_cmp_eq_u32 s42, 3
    s_cselect_b32 s38, 0x76534201, s38
    s_cselect_b32 s39, 0x89, s39
    s_cmp_eq_u32 s42, 4
    s_cselect_b32 s38, 0x75643201, s38
    s_cselect_b32 s39, 0x98, s39
    s_sub_u32 s42, s33, s43
    s_cselect_b32 s43, 10, 0
    s_add_u32 s42, s42, s43
    s_lshl_b32 s42, s42, 2
    s_lshr_b64 s[38:39], s[38:39], s42
    s_and_b32 s42, s38, 15
    s_and_b32 s38, s42, 3
    s_mul_i32 s38, s38, 39040
    s_add_u32 s38, s38, s36
    v_add_u32 v4, s38, v124
    v_xor_b32 v5, 32, v4
    v_xor_b32 v6, 64, v4
    v_xor_b32 v7, 0x60, v4
    s_mov_b64 s[48:49], s[20:21]
    s_mov_b32 s50, 2621440
    s_mov_b32 s51, 0x20000
    v_mov_b32 v14, 0x3f803f80
    v_mov_b32 v15, 0x3f803f80
    v_mov_b32 v16, 0x3f803f80
    v_mov_b32 v17, 0x3f803f80
    s_mov_b32 s4, 0xaae00455
    s_cmp_eq_u32 s40, 1
    s_cselect_b32 s4, 0xaaf80155, s4
    s_cmp_eq_u32 s40, 2
    s_cselect_b32 s4, 0xaafe4055, s4
    s_cmp_eq_u32 s40, 3
    s_cselect_b32 s4, 0xaabfd055, s4
    s_cmp_eq_u32 s40, 4
    s_cselect_b32 s4, 0xaaeff455, s4
    v_lshlrev_b32 v10, 1, v2
    v_add_u32 v10, 8, v10
    v_bfe_u32 v10, s4, v10, 2
    v_cmp_eq_u32 s[6:7], 0, v10
    v_cmp_eq_u32 s[8:9], 3, v10
    v_cmp_eq_u32 s[10:11], 1, v10
    v_lshlrev_b32 v10, 1, v2
    v_add_u32 v10, 16, v10
    v_bfe_u32 v10, s4, v10, 2
    v_cmp_eq_u32 s[12:13], 0, v10
    v_cmp_eq_u32 s[14:15], 3, v10
    v_cmp_eq_u32 s[16:17], 2, v10
    s_mov_b32 s4, 0xaaaaaaaa
    s_mov_b32 s5, 0xaaaaaaaa
    s_mov_b32 s18, 0xfff0ffff
    s_mov_b32 s19, 0xf000ff00
    s_mov_b32 s20, 0xffc0fffc
    s_mov_b32 s21, 0xc000fc00
    v_mov_b32 v8, 0xffff
    v_not_b32 v9, v8
    v_cndmask_b32 v8, v8, v9, s[4:5]
    v_cndmask_b32 v118, 0, v8, s[18:19]
    v_cndmask_b32 v119, 0, v8, s[20:21]
    v_xor_b32 v116, v118, v8
    v_xor_b32 v117, v119, v8
    s_cmp_eq_u32 s32, 0
    s_cselect_b32 s36, s44, 0
    s_cmp_eq_u32 s36, 2
    s_cselect_b32 s22, 0xff800000, 0
    s_mul_i32 s36, s32, 6
    s_add_u32 s36, s36, s44
    s_sub_u32 s36, s36, 2
    s_lshl_b32 s24, s36, 7
    s_add_u32 s24, s24, 7340032
    s_mul_i32 s52, s36, 20480
    s_add_u32 s52, s52, 4194304
    s_lshl_b32 s36, s33, 11
    s_add_u32 s23, s36, s52
    s_add_u32 s53, s52, s46
    s_add_u32 s46, s46, 4096
    s_cmp_eq_u32 s46, 20480
    s_cselect_b32 s46, 0, s46
    s_add_u32 s54, s52, s46
    s_add_u32 s46, s46, 4096
    s_cmp_eq_u32 s46, 20480
    s_cselect_b32 s46, 0, s46
    s_add_u32 s55, s52, s46
    s_add_u32 s46, s46, 4096
    s_cmp_eq_u32 s46, 20480
    s_cselect_b32 s46, 0, s46
    s_add_u32 s56, s52, s46
    s_add_u32 s46, s46, 4096
    s_cmp_eq_u32 s46, 20480
    s_cselect_b32 s46, 0, s46
    s_add_u32 s57, s52, s46
    s_add_u32 s46, s46, 4096
    s_cmp_eq_u32 s46, 20480
    s_cselect_b32 s46, 0, s46
    s_mul_i32 s36, s32, 10
    s_add_u32 s36, s36, s33
    s_mul_i32 s58, s36, 6144
    s_lshl_b32 s36, s44, 10
    s_add_u32 s58, s58, s36
    s_add_u32 s58, s58, 1046528
    s_sub_u32 s59, s58, 6144
    s_add_u32 s60, s58, 6144
    s_cmp_eq_u32 s40, 0
    s_cselect_b32 s61, 0, -1
    s_cmp_eq_u32 s40, 4
    s_cselect_b32 s62, 0, -1
    s_lshl_b32 s36, s33, 2
    v_mov_b32 v97, s36
    s_mov_b32 s25, 0x3ea52b5c
    s_lshl_b32 s36, s44, 6
    s_add_u32 s36, s36, 156160
    v_lshl_add_u32 v94, v3, 2, s36
    v_and_b32 v8, 1, v1
    v_lshl_add_u32 v8, v2, 2, v8
    v_lshl_add_u32 v8, v8, 2, s36
    v_subrev_u32 v9, 64, v8
    v_cndmask_b32 v92, v9, v8, s[18:19]
    v_cndmask_b32 v93, v9, v8, s[20:21]
    v_lshlrev_b32 v95, 4, v2
    s_lshl_b32 s36, s27, 8
    s_add_u32 s36, s36, 157184
    v_add_u32 v95, s36, v95
    v_mov_b32 v96, 157968
    s_lshl_b32 s36, s27, 11
    v_add_u32 v99, s36, v125
    v_mov_b32 v100, -1
    v_mov_b32 v101, -1
    v_mov_b32 v102, -1
    v_mov_b32 v103, -1
    v_mov_b32 v127, 157984
    s_lshl_b32 s36, s3, 2
    s_add_u32 s36, s36, 158016
    v_mov_b32 v10, s36
    v_xor_b32 v11, 16, v10
    v_cndmask_b32 v127, v127, v11, s[4:5]
    s_waitcnt vmcnt(0)
    s_waitcnt lgkmcnt(0)
    s_barrier
    ds_read_b128 a[64:67], v76 offset:0
    ds_read_b128 a[68:71], v78 offset:0
    ds_read_b64_tr_b16 a[80:81], v20 offset:0
    ds_read_b64_tr_b16 a[82:83], v20 offset:512
    ds_read_b64_tr_b16 a[84:85], v21 offset:0
    ds_read_b64_tr_b16 a[86:87], v21 offset:512
    ds_read_b64_tr_b16 a[88:89], v22 offset:0
    ds_read_b64_tr_b16 a[90:91], v22 offset:512
    ds_read_b64_tr_b16 a[92:93], v23 offset:0
    ds_read_b64_tr_b16 a[94:95], v23 offset:512
    ds_read_b64_tr_b16 a[96:97], v84 offset:0
    ds_read_b64_tr_b16 a[98:99], v84 offset:512
    ds_read_b64_tr_b16 a[100:101], v85 offset:0
    ds_read_b64_tr_b16 a[102:103], v85 offset:512
    s_add_u32 s34, s34, 0x9e3779b8
    s_or_b32 s34, s34, 1
    s_cmp_eq_u32 s42, 0
    s_cbranch_scc1 Lxe0
Lxe0_b:
    s_setprio 1
    s_waitcnt lgkmcnt(10)
    v_mfma_f32_16x16x32_bf16 v[28:31], a[80:83], a[64:67], 0
    ds_read_b128 a[72:75], v77 offset:0
    ds_read_b128 a[76:79], v79 offset:0
    v_mfma_f32_16x16x32_bf16 v[44:47], a[80:83], a[68:71], 0
    ds_read_b64_tr_b16 a[104:105], v20 offset:4096
    s_waitcnt lgkmcnt(11)
    v_mfma_f32_16x16x32_bf16 v[48:51], a[84:87], a[68:71], 0
    ds_read_b64_tr_b16 a[106:107], v20 offset:4608
    v_mfma_f32_16x16x32_bf16 v[32:35], a[84:87], a[64:67], 0
    ds_read_b64_tr_b16 a[108:109], v21 offset:4096
    s_waitcnt lgkmcnt(11)
    v_mfma_f32_16x16x32_bf16 v[36:39], a[88:91], a[64:67], 0
    ds_read_b64_tr_b16 a[110:111], v21 offset:4608
    ds_read_b64_tr_b16 a[112:113], v22 offset:4096
    v_mfma_f32_16x16x32_bf16 v[52:55], a[88:91], a[68:71], 0
    ds_read_b64_tr_b16 a[114:115], v22 offset:4608
    s_setprio 0
    s_waitcnt lgkmcnt(12)
    v_mfma_f32_16x16x32_bf16 v[56:59], a[92:95], a[68:71], 0
    ds_read_b64_tr_b16 a[116:117], v23 offset:4096
    v_mfma_f32_16x16x32_bf16 v[40:43], a[92:95], a[64:67], 0
    ds_read_b64_tr_b16 a[118:119], v23 offset:4608
    s_waitcnt lgkmcnt(12)
    v_mfma_f32_16x16x32_bf16 v[60:63], a[64:67], a[96:99], 0
    ds_read_b64_tr_b16 a[120:121], v84 offset:4096
    v_mfma_f32_16x16x32_bf16 v[68:71], a[68:71], a[96:99], 0
    ds_read_b64_tr_b16 a[122:123], v84 offset:4608
    s_waitcnt lgkmcnt(12)
    v_mfma_f32_16x16x32_bf16 v[72:75], a[68:71], a[100:103], 0
    ds_read_b64_tr_b16 a[124:125], v85 offset:4096
    v_mfma_f32_16x16x32_bf16 v[64:67], a[64:67], a[100:103], 0
    ds_read_b64_tr_b16 a[126:127], v85 offset:4608
    s_barrier
    s_setprio 3
    s_waitcnt lgkmcnt(10)
    v_mfma_f32_16x16x32_bf16 v[28:31], a[104:107], a[72:75], v[28:31]
    ds_read_b128 a[64:67], v76 offset:39040
    ds_read_b128 a[68:71], v78 offset:39040
    v_mfma_f32_16x16x32_bf16 v[44:47], a[104:107], a[76:79], v[44:47]
    ds_read_b64_tr_b16 a[80:81], v20 offset:39040
    s_waitcnt lgkmcnt(11)
    v_mfma_f32_16x16x32_bf16 v[48:51], a[108:111], a[76:79], v[48:51]
    ds_read_b64_tr_b16 a[82:83], v20 offset:39552
    v_mfma_f32_16x16x32_bf16 v[32:35], a[108:111], a[72:75], v[32:35]
    ds_read_b64_tr_b16 a[84:85], v21 offset:39040
    s_waitcnt lgkmcnt(11)
    v_mfma_f32_16x16x32_bf16 v[36:39], a[112:115], a[72:75], v[36:39]
    ds_read_b64_tr_b16 a[86:87], v21 offset:39552
    v_mfma_f32_16x16x32_bf16 v[52:55], a[112:115], a[76:79], v[52:55]
    ds_read_b64_tr_b16 a[88:89], v22 offset:39040
    s_setprio 2
    s_waitcnt lgkmcnt(11)
    v_mfma_f32_16x16x32_bf16 v[56:59], a[116:119], a[76:79], v[56:59]
    ds_read_b64_tr_b16 a[90:91], v22 offset:39552
    ds_read_b64_tr_b16 a[92:93], v23 offset:39040
    v_mfma_f32_16x16x32_bf16 v[40:43], a[116:119], a[72:75], v[40:43]
    ds_read_b64_tr_b16 a[94:95], v23 offset:39552
    s_waitcnt lgkmcnt(12)
    v_mfma_f32_16x16x32_bf16 v[60:63], a[72:75], a[120:123], v[60:63]
    ds_read_b64_tr_b16 a[96:97], v84 offset:39040
    v_mfma_f32_16x16x32_bf16 v[68:71], a[76:79], a[120:123], v[68:71]
    ds_read_b64_tr_b16 a[98:99], v84 offset:39552
    s_waitcnt lgkmcnt(12)
    v_mfma_f32_16x16x32_bf16 v[72:75], a[76:79], a[124:127], v[72:75]
    ds_read_b64_tr_b16 a[100:101], v85 offset:39040
    v_mfma_f32_16x16x32_bf16 v[64:67], a[72:75], a[124:127], v[64:67]
    ds_read_b64_tr_b16 a[102:103], v85 offset:39552
    s_cmp_eq_u32 s42, 1
    s_cbranch_scc1 Lxe1
Lxe1_b:
    s_setprio 1
    s_waitcnt lgkmcnt(10)
    v_mfma_f32_16x16x32_bf16 v[28:31], a[80:83], a[64:67], v[28:31]
    ds_read_b128 a[72:75], v77 offset:39040
    ds_read_b128 a[76:79], v79 offset:39040
    v_mfma_f32_16x16x32_bf16 v[44:47], a[80:83], a[68:71], v[44:47]
    ds_read_b64_tr_b16 a[104:105], v20 offset:43136
    s_waitcnt lgkmcnt(11)
    v_mfma_f32_16x16x32_bf16 v[48:51], a[84:87], a[68:71], v[48:51]
    ds_read_b64_tr_b16 a[106:107], v20 offset:43648
    v_mfma_f32_16x16x32_bf16 v[32:35], a[84:87], a[64:67], v[32:35]
    ds_read_b64_tr_b16 a[108:109], v21 offset:43136
    s_waitcnt lgkmcnt(11)
    v_mfma_f32_16x16x32_bf16 v[36:39], a[88:91], a[64:67], v[36:39]
    ds_read_b64_tr_b16 a[110:111], v21 offset:43648
    ds_read_b64_tr_b16 a[112:113], v22 offset:43136
    v_mfma_f32_16x16x32_bf16 v[52:55], a[88:91], a[68:71], v[52:55]
    ds_read_b64_tr_b16 a[114:115], v22 offset:43648
    s_setprio 0
    s_waitcnt lgkmcnt(12)
    v_mfma_f32_16x16x32_bf16 v[56:59], a[92:95], a[68:71], v[56:59]
    ds_read_b64_tr_b16 a[116:117], v23 offset:43136
    v_mfma_f32_16x16x32_bf16 v[40:43], a[92:95], a[64:67], v[40:43]
    ds_read_b64_tr_b16 a[118:119], v23 offset:43648
    s_waitcnt lgkmcnt(12)
    v_mfma_f32_16x16x32_bf16 v[60:63], a[64:67], a[96:99], v[60:63]
    ds_read_b64_tr_b16 a[120:121], v84 offset:43136
    v_mfma_f32_16x16x32_bf16 v[68:71], a[68:71], a[96:99], v[68:71]
    ds_read_b64_tr_b16 a[122:123], v84 offset:43648
    s_waitcnt lgkmcnt(12)
    v_mfma_f32_16x16x32_bf16 v[72:75], a[68:71], a[100:103], v[72:75]
    ds_read_b64_tr_b16 a[124:125], v85 offset:43136
    v_mfma_f32_16x16x32_bf16 v[64:67], a[64:67], a[100:103], v[64:67]
    ds_read_b64_tr_b16 a[126:127], v85 offset:43648
    s_barrier
    s_setprio 3
    s_waitcnt lgkmcnt(10)
    v_mfma_f32_16x16x32_bf16 v[28:31], a[104:107], a[72:75], v[28:31]
    ds_read_b128 a[64:67], v80 offset:0
    ds_read_b128 a[68:71], v82 offset:0
    v_mfma_f32_16x16x32_bf16 v[44:47], a[104:107], a[76:79], v[44:47]
    ds_read_b64_tr_b16 a[80:81], v24 offset:0
    s_waitcnt lgkmcnt(11)
    v_mfma_f32_16x16x32_bf16 v[48:51], a[108:111], a[76:79], v[48:51]
    ds_read_b64_tr_b16 a[82:83], v24 offset:512
    v_mfma_f32_16x16x32_bf16 v[32:35], a[108:111], a[72:75], v[32:35]
    ds_read_b64_tr_b16 a[84:85], v25 offset:0
    s_waitcnt lgkmcnt(11)
    v_mfma_f32_16x16x32_bf16 v[36:39], a[112:115], a[72:75], v[36:39]
    ds_read_b64_tr_b16 a[86:87], v25 offset:512
    v_mfma_f32_16x16x32_bf16 v[52:55], a[112:115], a[76:79], v[52:55]
    ds_read_b64_tr_b16 a[88:89], v26 offset:0
    s_setprio 2
    s_waitcnt lgkmcnt(11)
    v_mfma_f32_16x16x32_bf16 v[56:59], a[116:119], a[76:79], v[56:59]
    ds_read_b64_tr_b16 a[90:91], v26 offset:512
    ds_read_b64_tr_b16 a[92:93], v27 offset:0
    v_mfma_f32_16x16x32_bf16 v[40:43], a[116:119], a[72:75], v[40:43]
    ds_read_b64_tr_b16 a[94:95], v27 offset:512
    s_waitcnt lgkmcnt(12)
    v_mfma_f32_16x16x32_bf16 v[60:63], a[72:75], a[120:123], v[60:63]
    ds_read_b64_tr_b16 a[96:97], v86 offset:0
    v_mfma_f32_16x16x32_bf16 v[68:71], a[76:79], a[120:123], v[68:71]
    ds_read_b64_tr_b16 a[98:99], v86 offset:512
    s_waitcnt lgkmcnt(12)
    v_mfma_f32_16x16x32_bf16 v[72:75], a[76:79], a[124:127], v[72:75]
    ds_read_b64_tr_b16 a[100:101], v87 offset:0
    v_mfma_f32_16x16x32_bf16 v[64:67], a[72:75], a[124:127], v[64:67]
    ds_read_b64_tr_b16 a[102:103], v87 offset:512
    buffer_store_dwordx4 v[100:103], v13, s[28:31], s58 offen sc1
    s_cmp_eq_u32 s42, 2
    s_cbranch_scc1 Lxe2
Lxe2_b:
    s_setprio 1
    s_waitcnt lgkmcnt(10)
    v_mfma_f32_16x16x32_bf16 v[28:31], a[80:83], a[64:67], v[28:31]
    ds_read_b128 a[72:75], v81 offset:0
    ds_read_b128 a[76:79], v83 offset:0
    v_mfma_f32_16x16x32_bf16 v[44:47], a[80:83], a[68:71], v[44:47]
    ds_read_b64_tr_b16 a[104:105], v24 offset:4096
    s_waitcnt lgkmcnt(11)
    v_mfma_f32_16x16x32_bf16 v[48:51], a[84:87], a[68:71], v[48:51]
    ds_read_b64_tr_b16 a[106:107], v24 offset:4608
    v_mfma_f32_16x16x32_bf16 v[32:35], a[84:87], a[64:67], v[32:35]
    ds_read_b64_tr_b16 a[108:109], v25 offset:4096
    s_waitcnt lgkmcnt(11)
    v_mfma_f32_16x16x32_bf16 v[36:39], a[88:91], a[64:67], v[36:39]
    ds_read_b64_tr_b16 a[110:111], v25 offset:4608
    ds_read_b64_tr_b16 a[112:113], v26 offset:4096
    v_mfma_f32_16x16x32_bf16 v[52:55], a[88:91], a[68:71], v[52:55]
    ds_read_b64_tr_b16 a[114:115], v26 offset:4608
    s_setprio 0
    s_waitcnt lgkmcnt(12)
    v_mfma_f32_16x16x32_bf16 v[56:59], a[92:95], a[68:71], v[56:59]
    ds_read_b64_tr_b16 a[116:117], v27 offset:4096
    v_mfma_f32_16x16x32_bf16 v[40:43], a[92:95], a[64:67], v[40:43]
    ds_read_b64_tr_b16 a[118:119], v27 offset:4608
    s_waitcnt lgkmcnt(12)
    v_mfma_f32_16x16x32_bf16 v[60:63], a[64:67], a[96:99], v[60:63]
    ds_read_b64_tr_b16 a[120:121], v86 offset:4096
    v_mfma_f32_16x16x32_bf16 v[68:71], a[68:71], a[96:99], v[68:71]
    ds_read_b64_tr_b16 a[122:123], v86 offset:4608
    s_waitcnt lgkmcnt(12)
    v_mfma_f32_16x16x32_bf16 v[72:75], a[68:71], a[100:103], v[72:75]
    ds_read_b64_tr_b16 a[124:125], v87 offset:4096
    v_mfma_f32_16x16x32_bf16 v[64:67], a[64:67], a[100:103], v[64:67]
    ds_read_b64_tr_b16 a[126:127], v87 offset:4608
    s_barrier
    s_setprio 3
    s_waitcnt lgkmcnt(10)
    v_mfma_f32_16x16x32_bf16 v[28:31], a[104:107], a[72:75], v[28:31]
    ds_read_b128 a[64:67], v80 offset:39040
    ds_read_b128 a[68:71], v82 offset:39040
    v_mfma_f32_16x16x32_bf16 v[44:47], a[104:107], a[76:79], v[44:47]
    ds_read_b64_tr_b16 a[80:81], v24 offset:39040
    s_waitcnt lgkmcnt(11)
    v_mfma_f32_16x16x32_bf16 v[48:51], a[108:111], a[76:79], v[48:51]
    ds_read_b64_tr_b16 a[82:83], v24 offset:39552
    v_mfma_f32_16x16x32_bf16 v[32:35], a[108:111], a[72:75], v[32:35]
    ds_read_b64_tr_b16 a[84:85], v25 offset:39040
    s_waitcnt lgkmcnt(11)
    v_mfma_f32_16x16x32_bf16 v[36:39], a[112:115], a[72:75], v[36:39]
    ds_read_b64_tr_b16 a[86:87], v25 offset:39552
    v_mfma_f32_16x16x32_bf16 v[52:55], a[112:115], a[76:79], v[52:55]
    ds_read_b64_tr_b16 a[88:89], v26 offset:39040
    s_setprio 2
    s_waitcnt lgkmcnt(11)
    v_mfma_f32_16x16x32_bf16 v[56:59], a[116:119], a[76:79], v[56:59]
    ds_read_b64_tr_b16 a[90:91], v26 offset:39552
    ds_read_b64_tr_b16 a[92:93], v27 offset:39040
    v_mfma_f32_16x16x32_bf16 v[40:43], a[116:119], a[72:75], v[40:43]
    ds_read_b64_tr_b16 a[94:95], v27 offset:39552
    s_waitcnt lgkmcnt(12)
    v_mfma_f32_16x16x32_bf16 v[60:63], a[72:75], a[120:123], v[60:63]
    ds_read_b64_tr_b16 a[96:97], v86 offset:39040
    v_mfma_f32_16x16x32_bf16 v[68:71], a[76:79], a[120:123], v[68:71]
    ds_read_b64_tr_b16 a[98:99], v86 offset:39552
    s_waitcnt lgkmcnt(12)
    v_mfma_f32_16x16x32_bf16 v[72:75], a[76:79], a[124:127], v[72:75]
    ds_read_b64_tr_b16 a[100:101], v87 offset:39040
    v_mfma_f32_16x16x32_bf16 v[64:67], a[72:75], a[124:127], v[64:67]
    ds_read_b64_tr_b16 a[102:103], v87 offset:39552
    s_cmp_eq_u32 s42, 3
    s_cbranch_scc1 Lxe3
Lxe3_b:
    s_setprio 1
    s_waitcnt lgkmcnt(10)
    v_mfma_f32_16x16x32_bf16 v[28:31], a[80:83], a[64:67], v[28:31]
    ds_read_b128 a[72:75], v81 offset:39040
    ds_read_b128 a[76:79], v83 offset:39040
    v_mfma_f32_16x16x32_bf16 v[44:47], a[80:83], a[68:71], v[44:47]
    ds_read_b64_tr_b16 a[104:105], v24 offset:43136
    s_waitcnt lgkmcnt(11)
    v_mfma_f32_16x16x32_bf16 v[48:51], a[84:87], a[68:71], v[48:51]
    ds_read_b64_tr_b16 a[106:107], v24 offset:43648
    v_mfma_f32_16x16x32_bf16 v[32:35], a[84:87], a[64:67], v[32:35]
    ds_read_b64_tr_b16 a[108:109], v25 offset:43136
    s_waitcnt lgkmcnt(11)
    v_mfma_f32_16x16x32_bf16 v[36:39], a[88:91], a[64:67], v[36:39]
    ds_read_b64_tr_b16 a[110:111], v25 offset:43648
    ds_read_b64_tr_b16 a[112:113], v26 offset:43136
    v_mfma_f32_16x16x32_bf16 v[52:55], a[88:91], a[68:71], v[52:55]
    ds_read_b64_tr_b16 a[114:115], v26 offset:43648
    s_setprio 0
    s_waitcnt lgkmcnt(12)
    v_mfma_f32_16x16x32_bf16 v[56:59], a[92:95], a[68:71], v[56:59]
    ds_read_b64_tr_b16 a[116:117], v27 offset:43136
    v_mfma_f32_16x16x32_bf16 v[40:43], a[92:95], a[64:67], v[40:43]
    ds_read_b64_tr_b16 a[118:119], v27 offset:43648
    s_waitcnt lgkmcnt(12)
    v_mfma_f32_16x16x32_bf16 v[60:63], a[64:67], a[96:99], v[60:63]
    ds_read_b64_tr_b16 a[120:121], v86 offset:43136
    v_mfma_f32_16x16x32_bf16 v[68:71], a[68:71], a[96:99], v[68:71]
    ds_read_b64_tr_b16 a[122:123], v86 offset:43648
    s_waitcnt lgkmcnt(12)
    v_mfma_f32_16x16x32_bf16 v[72:75], a[68:71], a[100:103], v[72:75]
    ds_read_b64_tr_b16 a[124:125], v87 offset:43136
    v_mfma_f32_16x16x32_bf16 v[64:67], a[64:67], a[100:103], v[64:67]
    ds_read_b64_tr_b16 a[126:127], v87 offset:43648
    s_barrier
    s_setprio 3
    s_waitcnt lgkmcnt(10)
    v_mfma_f32_16x16x32_bf16 v[28:31], a[104:107], a[72:75], v[28:31]
    ds_read_b128 a[64:67], v76 offset:0
    ds_read_b128 a[68:71], v78 offset:0
    v_mfma_f32_16x16x32_bf16 v[44:47], a[104:107], a[76:79], v[44:47]
    ds_read_b64_tr_b16 a[80:81], v20 offset:0
    s_waitcnt lgkmcnt(11)
    v_mfma_f32_16x16x32_bf16 v[48:51], a[108:111], a[76:79], v[48:51]
    ds_read_b64_tr_b16 a[82:83], v20 offset:512
    v_mfma_f32_16x16x32_bf16 v[32:35], a[108:111], a[72:75], v[32:35]
    ds_read_b64_tr_b16 a[84:85], v21 offset:0
    s_waitcnt lgkmcnt(11)
    v_mfma_f32_16x16x32_bf16 v[36:39], a[112:115], a[72:75], v[36:39]
    ds_read_b64_tr_b16 a[86:87], v21 offset:512
    v_mfma_f32_16x16x32_bf16 v[52:55], a[112:115], a[76:79], v[52:55]
    ds_read_b64_tr_b16 a[88:89], v22 offset:0
    s_setprio 2
    s_waitcnt lgkmcnt(11)
    v_mfma_f32_16x16x32_bf16 v[56:59], a[116:119], a[76:79], v[56:59]
    ds_read_b64_tr_b16 a[90:91], v22 offset:512
    ds_read_b64_tr_b16 a[92:93], v23 offset:0
    v_mfma_f32_16x16x32_bf16 v[40:43], a[116:119], a[72:75], v[40:43]
    ds_read_b64_tr_b16 a[94:95], v23 offset:512
    s_waitcnt lgkmcnt(12)
    v_mfma_f32_16x16x32_bf16 v[60:63], a[72:75], a[120:123], v[60:63]
    ds_read_b64_tr_b16 a[96:97], v84 offset:0
    v_mfma_f32_16x16x32_bf16 v[68:71], a[76:79], a[120:123], v[68:71]
    ds_read_b64_tr_b16 a[98:99], v84 offset:512
    s_waitcnt lgkmcnt(12)
    v_mfma_f32_16x16x32_bf16 v[72:75], a[76:79], a[124:127], v[72:75]
    ds_read_b64_tr_b16 a[100:101], v85 offset:0
    v_mfma_f32_16x16x32_bf16 v[64:67], a[72:75], a[124:127], v[64:67]
    ds_read_b64_tr_b16 a[102:103], v85 offset:512
    buffer_store_dwordx4 v[100:103], v13, s[28:31], s23 offen offset:0 sc1
    s_cmp_eq_u32 s42, 4
    s_cbranch_scc1 Lxe4
Lxe4_b:
    s_setprio 1
    s_waitcnt lgkmcnt(10)
    v_mfma_f32_16x16x32_bf16 v[28:31], a[80:83], a[64:67], v[28:31]
    ds_read_b128 a[72:75], v77 offset:0
    ds_read_b128 a[76:79], v79 offset:0
    v_mfma_f32_16x16x32_bf16 v[44:47], a[80:83], a[68:71], v[44:47]
    ds_read_b64_tr_b16 a[104:105], v20 offset:4096
    s_waitcnt lgkmcnt(11)
    v_mfma_f32_16x16x32_bf16 v[48:51], a[84:87], a[68:71], v[48:51]
    ds_read_b64_tr_b16 a[106:107], v20 offset:4608
    v_mfma_f32_16x16x32_bf16 v[32:35], a[84:87], a[64:67], v[32:35]
    ds_read_b64_tr_b16 a[108:109], v21 offset:4096
    s_waitcnt lgkmcnt(11)
    v_mfma_f32_16x16x32_bf16 v[36:39], a[88:91], a[64:67], v[36:39]
    ds_read_b64_tr_b16 a[110:111], v21 offset:4608
    ds_read_b64_tr_b16 a[112:113], v22 offset:4096
    v_mfma_f32_16x16x32_bf16 v[52:55], a[88:91], a[68:71], v[52:55]
    ds_read_b64_tr_b16 a[114:115], v22 offset:4608
    s_setprio 0
    s_waitcnt lgkmcnt(12)
    v_mfma_f32_16x16x32_bf16 v[56:59], a[92:95], a[68:71], v[56:59]
    ds_read_b64_tr_b16 a[116:117], v23 offset:4096
    v_mfma_f32_16x16x32_bf16 v[40:43], a[92:95], a[64:67], v[40:43]
    ds_read_b64_tr_b16 a[118:119], v23 offset:4608
    s_waitcnt lgkmcnt(12)
    v_mfma_f32_16x16x32_bf16 v[60:63], a[64:67], a[96:99], v[60:63]
    ds_read_b64_tr_b16 a[120:121], v84 offset:4096
    v_mfma_f32_16x16x32_bf16 v[68:71], a[68:71], a[96:99], v[68:71]
    ds_read_b64_tr_b16 a[122:123], v84 offset:4608
    s_waitcnt lgkmcnt(12)
    v_mfma_f32_16x16x32_bf16 v[72:75], a[68:71], a[100:103], v[72:75]
    ds_read_b64_tr_b16 a[124:125], v85 offset:4096
    v_mfma_f32_16x16x32_bf16 v[64:67], a[64:67], a[100:103], v[64:67]
    ds_read_b64_tr_b16 a[126:127], v85 offset:4608
    s_barrier
    s_setprio 3
    s_waitcnt lgkmcnt(10)
    v_mfma_f32_16x16x32_bf16 v[28:31], a[104:107], a[72:75], v[28:31]
    ds_read_b128 a[64:67], v76 offset:39040
    ds_read_b128 a[68:71], v78 offset:39040
    v_mfma_f32_16x16x32_bf16 v[44:47], a[104:107], a[76:79], v[44:47]
    ds_read_b64_tr_b16 a[80:81], v20 offset:39040
    s_waitcnt lgkmcnt(11)
    v_mfma_f32_16x16x32_bf16 v[48:51], a[108:111], a[76:79], v[48:51]
    ds_read_b64_tr_b16 a[82:83], v20 offset:39552
    v_mfma_f32_16x16x32_bf16 v[32:35], a[108:111], a[72:75], v[32:35]
    ds_read_b64_tr_b16 a[84:85], v21 offset:39040
    s_waitcnt lgkmcnt(11)
    v_mfma_f32_16x16x32_bf16 v[36:39], a[112:115], a[72:75], v[36:39]
    ds_read_b64_tr_b16 a[86:87], v21 offset:39552
    v_mfma_f32_16x16x32_bf16 v[52:55], a[112:115], a[76:79], v[52:55]
    ds_read_b64_tr_b16 a[88:89], v22 offset:39040
    s_setprio 2
    s_waitcnt lgkmcnt(11)
    v_mfma_f32_16x16x32_bf16 v[56:59], a[116:119], a[76:79], v[56:59]
    ds_read_b64_tr_b16 a[90:91], v22 offset:39552
    ds_read_b64_tr_b16 a[92:93], v23 offset:39040
    v_mfma_f32_16x16x32_bf16 v[40:43], a[116:119], a[72:75], v[40:43]
    ds_read_b64_tr_b16 a[94:95], v23 offset:39552
    s_waitcnt lgkmcnt(12)
    v_mfma_f32_16x16x32_bf16 v[60:63], a[72:75], a[120:123], v[60:63]
    ds_read_b64_tr_b16 a[96:97], v84 offset:39040
    v_mfma_f32_16x16x32_bf16 v[68:71], a[76:79], a[120:123], v[68:71]
    ds_read_b64_tr_b16 a[98:99], v84 offset:39552
    s_waitcnt lgkmcnt(12)
    v_mfma_f32_16x16x32_bf16 v[72:75], a[76:79], a[124:127], v[72:75]
    ds_read_b64_tr_b16 a[100:101], v85 offset:39040
    v_mfma_f32_16x16x32_bf16 v[64:67], a[72:75], a[124:127], v[64:67]
    ds_read_b64_tr_b16 a[102:103], v85 offset:39552
    s_cmp_eq_u32 s42, 5
    s_cbranch_scc1 Lxe5
Lxe5_b:
    s_setprio 1
    s_waitcnt lgkmcnt(10)
    v_mfma_f32_16x16x32_bf16 v[28:31], a[80:83], a[64:67], v[28:31]
    ds_read_b128 a[72:75], v77 offset:39040
    ds_read_b128 a[76:79], v79 offset:39040
    v_mfma_f32_16x16x32_bf16 v[44:47], a[80:83], a[68:71], v[44:47]
    ds_read_b64_tr_b16 a[104:105], v20 offset:43136
    s_waitcnt lgkmcnt(11)
    v_mfma_f32_16x16x32_bf16 v[48:51], a[84:87], a[68:71], v[48:51]
    ds_read_b64_tr_b16 a[106:107], v20 offset:43648
    v_mfma_f32_16x16x32_bf16 v[32:35], a[84:87], a[64:67], v[32:35]
    ds_read_b64_tr_b16 a[108:109], v21 offset:43136
    s_waitcnt lgkmcnt(11)
    v_mfma_f32_16x16x32_bf16 v[36:39], a[88:91], a[64:67], v[36:39]
    ds_read_b64_tr_b16 a[110:111], v21 offset:43648
    ds_read_b64_tr_b16 a[112:113], v22 offset:43136
    v_mfma_f32_16x16x32_bf16 v[52:55], a[88:91], a[68:71], v[52:55]
    ds_read_b64_tr_b16 a[114:115], v22 offset:43648
    s_setprio 0
    s_waitcnt lgkmcnt(12)
    v_mfma_f32_16x16x32_bf16 v[56:59], a[92:95], a[68:71], v[56:59]
    ds_read_b64_tr_b16 a[116:117], v23 offset:43136
    v_mfma_f32_16x16x32_bf16 v[40:43], a[92:95], a[64:67], v[40:43]
    ds_read_b64_tr_b16 a[118:119], v23 offset:43648
    s_waitcnt lgkmcnt(12)
    v_mfma_f32_16x16x32_bf16 v[60:63], a[64:67], a[96:99], v[60:63]
    ds_read_b64_tr_b16 a[120:121], v84 offset:43136
    v_mfma_f32_16x16x32_bf16 v[68:71], a[68:71], a[96:99], v[68:71]
    ds_read_b64_tr_b16 a[122:123], v84 offset:43648
    s_waitcnt lgkmcnt(12)
    v_mfma_f32_16x16x32_bf16 v[72:75], a[68:71], a[100:103], v[72:75]
    ds_read_b64_tr_b16 a[124:125], v85 offset:43136
    v_mfma_f32_16x16x32_bf16 v[64:67], a[64:67], a[100:103], v[64:67]
    ds_read_b64_tr_b16 a[126:127], v85 offset:43648
    s_barrier
    s_setprio 3
    s_waitcnt lgkmcnt(10)
    v_mfma_f32_16x16x32_bf16 v[28:31], a[104:107], a[72:75], v[28:31]
    ds_read_b128 a[0:3], v80 offset:0
    v_mfma_f32_16x16x32_bf16 v[44:47], a[104:107], a[76:79], v[44:47]
    ds_read_b128 a[4:7], v82 offset:0
    s_waitcnt lgkmcnt(10)
    v_mfma_f32_16x16x32_bf16 v[48:51], a[108:111], a[76:79], v[48:51]
    ds_read_b64_tr_b16 a[80:81], v24 offset:0
    v_mfma_f32_16x16x32_bf16 v[32:35], a[108:111], a[72:75], v[32:35]
    ds_read_b64_tr_b16 a[82:83], v24 offset:512
    s_waitcnt lgkmcnt(10)
    v_mfma_f32_16x16x32_bf16 v[36:39], a[112:115], a[72:75], v[36:39]
    ds_read_b64_tr_b16 a[84:85], v25 offset:0
    v_mfma_f32_16x16x32_bf16 v[52:55], a[112:115], a[76:79], v[52:55]
    s_setprio 2
    s_waitcnt lgkmcnt(9)
    v_mfma_f32_16x16x32_bf16 v[56:59], a[116:119], a[76:79], v[56:59]
    ds_read_b64_tr_b16 a[86:87], v25 offset:512
    v_mfma_f32_16x16x32_bf16 v[40:43], a[116:119], a[72:75], v[40:43]
    ds_read_b64_tr_b16 a[88:89], v26 offset:0
    s_waitcnt lgkmcnt(9)
    v_mfma_f32_16x16x32_bf16 v[60:63], a[72:75], a[120:123], v[60:63]
    ds_read_b64_tr_b16 a[90:91], v26 offset:512
    v_mfma_f32_16x16x32_bf16 v[68:71], a[76:79], a[120:123], v[68:71]
    ds_read_b64_tr_b16 a[92:93], v27 offset:0
    s_waitcnt lgkmcnt(9)
    v_mfma_f32_16x16x32_bf16 v[72:75], a[76:79], a[124:127], v[72:75]
    ds_read_b64_tr_b16 a[94:95], v27 offset:512
    v_mfma_f32_16x16x32_bf16 v[64:67], a[72:75], a[124:127], v[64:67]
    buffer_store_dwordx4 v[100:103], v13, s[28:31], s23 offen offset:1024 sc1
    s_cmp_eq_u32 s42, 6
    s_cbranch_scc1 Lxe6
Lxe6_b:
    s_setprio 1
    s_waitcnt lgkmcnt(6)
    v_mfma_f32_16x16x32_bf16 v[28:31], a[80:83], a[0:3], v[28:31]
    ds_read_b128 a[8:11], v81 offset:0
    ds_read_b128 a[12:15], v83 offset:0
    v_mfma_f32_16x16x32_bf16 v[44:47], a[80:83], a[4:7], v[44:47]
    ds_read_b64_tr_b16 a[104:105], v24 offset:4096
    s_waitcnt lgkmcnt(7)
    v_mfma_f32_16x16x32_bf16 v[48:51], a[84:87], a[4:7], v[48:51]
    ds_read_b64_tr_b16 a[106:107], v24 offset:4608
    ds_read_b64_tr_b16 a[108:109], v25 offset:4096
    v_mfma_f32_16x16x32_bf16 v[32:35], a[84:87], a[0:3], v[32:35]
    ds_read_b64_tr_b16 a[110:111], v25 offset:4608
    s_setprio 0
    s_waitcnt lgkmcnt(8)
    v_mfma_f32_16x16x32_bf16 v[36:39], a[88:91], a[0:3], v[36:39]
    v_mfma_f32_16x16x32_bf16 v[52:55], a[88:91], a[4:7], v[52:55]
    ds_read_b64_tr_b16 a[112:113], v26 offset:4096
    ds_read_b64_tr_b16 a[114:115], v26 offset:4608
    s_waitcnt lgkmcnt(8)
    v_mfma_f32_16x16x32_bf16 v[56:59], a[92:95], a[4:7], v[56:59]
    ds_read_b64_tr_b16 a[116:117], v27 offset:4096
    v_mfma_f32_16x16x32_bf16 v[40:43], a[92:95], a[0:3], v[40:43]
    ds_read_b64_tr_b16 a[118:119], v27 offset:4608
    s_barrier
    s_setprio 3
    s_waitcnt lgkmcnt(6)
    v_mfma_f32_16x16x32_bf16 v[28:31], a[104:107], a[8:11], v[28:31]
    ds_read_b128 a[16:19], v80 offset:39040
    ds_read_b128 a[20:23], v82 offset:39040
    v_mfma_f32_16x16x32_bf16 v[44:47], a[104:107], a[12:15], v[44:47]
    ds_read_b64_tr_b16 a[80:81], v24 offset:39040
    s_waitcnt lgkmcnt(7)
    v_mfma_f32_16x16x32_bf16 v[48:51], a[108:111], a[12:15], v[48:51]
    ds_read_b64_tr_b16 a[82:83], v24 offset:39552
    v_mfma_f32_16x16x32_bf16 v[32:35], a[108:111], a[8:11], v[32:35]
    ds_read_b64_tr_b16 a[84:85], v25 offset:39040
    s_setprio 2
    s_waitcnt lgkmcnt(7)
    v_mfma_f32_16x16x32_bf16 v[36:39], a[112:115], a[8:11], v[36:39]
    ds_read_b64_tr_b16 a[86:87], v25 offset:39552
    ds_read_b64_tr_b16 a[88:89], v26 offset:39040
    v_mfma_f32_16x16x32_bf16 v[52:55], a[112:115], a[12:15], v[52:55]
    ds_read_b64_tr_b16 a[90:91], v26 offset:39552
    s_waitcnt lgkmcnt(8)
    v_mfma_f32_16x16x32_bf16 v[56:59], a[116:119], a[12:15], v[56:59]
    ds_read_b64_tr_b16 a[92:93], v27 offset:39040
    v_mfma_f32_16x16x32_bf16 v[40:43], a[116:119], a[8:11], v[40:43]
    ds_read_b64_tr_b16 a[94:95], v27 offset:39552
    s_cmp_eq_u32 s42, 7
    s_cbranch_scc1 Lxe7
Lxe7_b:
    s_setprio 1
    s_waitcnt lgkmcnt(6)
    v_mfma_f32_16x16x32_bf16 v[28:31], a[80:83], a[16:19], v[28:31]
    ds_read_b128 a[24:27], v81 offset:39040
    ds_read_b128 a[28:31], v83 offset:39040
    v_mfma_f32_16x16x32_bf16 v[44:47], a[80:83], a[20:23], v[44:47]
    ds_read_b64_tr_b16 a[104:105], v24 offset:43136
    s_waitcnt lgkmcnt(7)
    v_mfma_f32_16x16x32_bf16 v[48:51], a[84:87], a[20:23], v[48:51]
    ds_read_b64_tr_b16 a[106:107], v24 offset:43648
    ds_read_b64_tr_b16 a[108:109], v25 offset:43136
    v_mfma_f32_16x16x32_bf16 v[32:35], a[84:87], a[16:19], v[32:35]
    ds_read_b64_tr_b16 a[110:111], v25 offset:43648
    s_setprio 0
    s_waitcnt lgkmcnt(8)
    v_mfma_f32_16x16x32_bf16 v[36:39], a[88:91], a[16:19], v[36:39]
    v_mfma_f32_16x16x32_bf16 v[52:55], a[88:91], a[20:23], v[52:55]
    ds_read_b64_tr_b16 a[112:113], v26 offset:43136
    ds_read_b64_tr_b16 a[114:115], v26 offset:43648
    s_waitcnt lgkmcnt(8)
    v_mfma_f32_16x16x32_bf16 v[56:59], a[92:95], a[20:23], v[56:59]
    ds_read_b64_tr_b16 a[116:117], v27 offset:43136
    v_mfma_f32_16x16x32_bf16 v[40:43], a[92:95], a[16:19], v[40:43]
    ds_read_b64_tr_b16 a[118:119], v27 offset:43648
    s_barrier
    s_setprio 3
    s_waitcnt lgkmcnt(6)
    v_mfma_f32_16x16x32_bf16 v[28:31], a[104:107], a[24:27], v[28:31]
    ds_read_b128 a[32:35], v76 offset:0
    ds_read_b128 a[36:39], v78 offset:0
    v_mfma_f32_16x16x32_bf16 v[44:47], a[104:107], a[28:31], v[44:47]
    ds_read_b64_tr_b16 a[80:81], v20 offset:0
    s_waitcnt lgkmcnt(7)
    v_mfma_f32_16x16x32_bf16 v[48:51], a[108:111], a[28:31], v[48:51]
    ds_read_b64_tr_b16 a[82:83], v20 offset:512
    v_mfma_f32_16x16x32_bf16 v[32:35], a[108:111], a[24:27], v[32:35]
    ds_read_b64_tr_b16 a[84:85], v21 offset:0
    s_setprio 2
    s_waitcnt lgkmcnt(7)
    v_mfma_f32_16x16x32_bf16 v[36:39], a[112:115], a[24:27], v[36:39]
    ds_read_b64_tr_b16 a[86:87], v21 offset:512
    ds_read_b64_tr_b16 a[88:89], v22 offset:0
    v_mfma_f32_16x16x32_bf16 v[52:55], a[112:115], a[28:31], v[52:55]
    ds_read_b64_tr_b16 a[90:91], v22 offset:512
    s_waitcnt lgkmcnt(8)
    v_mfma_f32_16x16x32_bf16 v[56:59], a[116:119], a[28:31], v[56:59]
    ds_read_b64_tr_b16 a[92:93], v23 offset:0
    v_mfma_f32_16x16x32_bf16 v[40:43], a[116:119], a[24:27], v[40:43]
    ds_read_b64_tr_b16 a[94:95], v23 offset:512
    s_cmp_eq_u32 s42, 8
    s_cbranch_scc1 Lxe8
Lxe8_b:
    s_setprio 1
    s_waitcnt lgkmcnt(6)
    v_mfma_f32_16x16x32_bf16 v[28:31], a[80:83], a[32:35], v[28:31]
    ds_read_b128 a[40:43], v77 offset:0
    ds_read_b128 a[44:47], v79 offset:0
    v_mfma_f32_16x16x32_bf16 v[44:47], a[80:83], a[36:39], v[44:47]
    ds_read_b64_tr_b16 a[104:105], v20 offset:4096
    s_waitcnt lgkmcnt(7)
    v_mfma_f32_16x16x32_bf16 v[48:51], a[84:87], a[36:39], v[48:51]
    ds_read_b64_tr_b16 a[106:107], v20 offset:4608
    v_mfma_f32_16x16x32_bf16 v[32:35], a[84:87], a[32:35], v[32:35]
    ds_read_b64_tr_b16 a[108:109], v21 offset:4096
    s_setprio 0
    s_waitcnt lgkmcnt(7)
    v_mfma_f32_16x16x32_bf16 v[36:39], a[88:91], a[32:35], v[36:39]
    ds_read_b64_tr_b16 a[110:111], v21 offset:4608
    ds_read_b64_tr_b16 a[112:113], v22 offset:4096
    v_mfma_f32_16x16x32_bf16 v[52:55], a[88:91], a[36:39], v[52:55]
    ds_read_b64_tr_b16 a[114:115], v22 offset:4608
    s_waitcnt lgkmcnt(8)
    v_mfma_f32_16x16x32_bf16 v[56:59], a[92:95], a[36:39], v[56:59]
    ds_read_b64_tr_b16 a[116:117], v23 offset:4096
    v_mfma_f32_16x16x32_bf16 v[40:43], a[92:95], a[32:35], v[40:43]
    ds_read_b64_tr_b16 a[118:119], v23 offset:4608
    s_waitcnt lgkmcnt(0)
    s_barrier
    s_setprio 3
    v_mfma_f32_16x16x32_bf16 v[28:31], a[104:107], a[40:43], v[28:31]
    ds_read_b128 a[48:51], v76 offset:39040
    ds_read_b128 a[52:55], v78 offset:39040
    v_mfma_f32_16x16x32_bf16 v[44:47], a[104:107], a[44:47], v[44:47]
    ds_read_b64_tr_b16 a[80:81], v20 offset:39040
    v_mfma_f32_16x16x32_bf16 v[48:51], a[108:111], a[44:47], v[48:51]
    ds_read_b64_tr_b16 a[82:83], v20 offset:39552
    v_mfma_f32_16x16x32_bf16 v[32:35], a[108:111], a[40:43], v[32:35]
    ds_read_b64_tr_b16 a[84:85], v21 offset:39040
    s_setprio 2
    v_mfma_f32_16x16x32_bf16 v[36:39], a[112:115], a[40:43], v[36:39]
    ds_read_b64_tr_b16 a[86:87], v21 offset:39552
    ds_read_b64_tr_b16 a[88:89], v22 offset:39040
    v_mfma_f32_16x16x32_bf16 v[52:55], a[112:115], a[44:47], v[52:55]
    ds_read_b64_tr_b16 a[90:91], v22 offset:39552
    v_mfma_f32_16x16x32_bf16 v[56:59], a[116:119], a[44:47], v[56:59]
    ds_read_b64_tr_b16 a[92:93], v23 offset:39040
    v_mfma_f32_16x16x32_bf16 v[40:43], a[116:119], a[40:43], v[40:43]
    ds_read_b64_tr_b16 a[94:95], v23 offset:39552
    v_mov_b32 v98, s34
    s_waitcnt vmcnt(0)
    s_mov_b64 exec, 1
    buffer_store_dword v98, v97, s[28:31], s24 offen sc1
    s_mov_b64 exec, -1
    s_cmp_eq_u32 s42, 9
    s_cbranch_scc1 Lxe9
Lxe9_b:
    s_setprio 1
    s_waitcnt lgkmcnt(6)
    v_mfma_f32_16x16x32_bf16 v[28:31], a[80:83], a[48:51], v[28:31]
    ds_read_b128 a[56:59], v77 offset:39040
    ds_read_b128 a[60:63], v79 offset:39040
    ds_read_b64_tr_b16 a[104:105], v20 offset:43136
    v_mfma_f32_16x16x32_bf16 v[44:47], a[80:83], a[52:55], v[44:47]
    ds_read_b64_tr_b16 a[106:107], v20 offset:43648
    ds_read_b64_tr_b16 a[108:109], v21 offset:43136
    s_waitcnt lgkmcnt(9)
    v_mfma_f32_16x16x32_bf16 v[48:51], a[84:87], a[52:55], v[48:51]
    ds_read_b64_tr_b16 a[110:111], v21 offset:43648
    ds_read_b64_tr_b16 a[112:113], v22 offset:43136
    ds_read_b64_tr_b16 a[114:115], v22 offset:43648
    v_mfma_f32_16x16x32_bf16 v[32:35], a[84:87], a[48:51], v[32:35]
    ds_read_b64_tr_b16 a[116:117], v23 offset:43136
    ds_read_b64_tr_b16 a[118:119], v23 offset:43648
    s_setprio 0
    s_waitcnt lgkmcnt(12)
    v_mfma_f32_16x16x32_bf16 v[36:39], a[88:91], a[48:51], v[36:39]
    ds_read_b32 v120, v94
    ds_read_b32 v121, v94 offset:512
    v_xor_b32 v94, 64, v94
    v_mfma_f32_16x16x32_bf16 v[52:55], a[88:91], a[52:55], v[52:55]
    ds_read_b32 v122, v94
    ds_read_b32 v123, v92 offset:512
    s_waitcnt lgkmcnt(14)
    v_mfma_f32_16x16x32_bf16 v[56:59], a[92:95], a[52:55], v[56:59]
    ds_read_b32 v126, v93 offset:520
    v_mov_b32 v24, v84
    v_mov_b32 v25, v85
    v_mfma_f32_16x16x32_bf16 v[40:43], a[92:95], a[48:51], v[40:43]
    v_mov_b32 v26, v86
    v_mov_b32 v27, v87
    s_waitcnt lgkmcnt(5)
    v_mfma_f32_16x16x32_bf16 v[44:47], a[104:107], a[60:63], v[44:47]
    v_mfma_f32_16x16x32_bf16 v[48:51], a[108:111], a[60:63], v[48:51]
    v_mfma_f32_16x16x32_bf16 v[52:55], a[112:115], a[60:63], v[52:55]
    v_mfma_f32_16x16x32_bf16 v[56:59], a[116:119], a[60:63], v[56:59]
    v_mfma_f32_16x16x32_bf16 v[28:31], a[104:107], a[56:59], v[28:31]
    v_mfma_f32_16x16x32_bf16 v[32:35], a[108:111], a[56:59], v[32:35]
    ds_read_b32 v7, v96
    ds_read_b128 v[76:79], v95 offset:0
    ds_read_b128 v[80:83], v95 offset:64
    ds_read_b128 v[84:87], v95 offset:128
    ds_read_b128 v[88:91], v95 offset:192
    v_mfma_f32_16x16x32_bf16 v[36:39], a[112:115], a[56:59], v[36:39]
    v_mfma_f32_16x16x32_bf16 v[40:43], a[116:119], a[56:59], v[40:43]
    s_waitcnt lgkmcnt(0)
Lqf:
    v_readfirstlane_b32 s38, v7
    s_nop 0
    s_cmp_eq_u32 s38, 0
    s_cbranch_scc1 Lqf_re
    s_cmp_eq_u32 s27, 0
    v_fmac_f32 v44, v76, v122
    v_fmac_f32 v45, v77, v122
    v_fmac_f32 v46, v78, v122
    v_fmac_f32 v47, v79, v122
    v_cvt_pk_bf16_f32 v44, v44, v45
    v_cvt_pk_bf16_f32 v45, v46, v47
    v_fmac_f32 v48, v80, v122
    v_fmac_f32 v49, v81, v122
    v_fmac_f32 v50, v82, v122
    v_fmac_f32 v51, v83, v122
    v_cvt_pk_bf16_f32 v46, v48, v49
    v_cvt_pk_bf16_f32 v47, v50, v51
    v_fmac_f32 v52, v84, v122
    v_fmac_f32 v53, v85, v122
    v_fmac_f32 v54, v86, v122
    v_fmac_f32 v55, v87, v122
    v_cvt_pk_bf16_f32 v48, v52, v53
    v_cvt_pk_bf16_f32 v49, v54, v55
    v_fmac_f32 v56, v88, v122
    v_fmac_f32 v57, v89, v122
    v_fmac_f32 v58, v90, v122
    v_fmac_f32 v59, v91, v122
    v_cvt_pk_bf16_f32 v50, v56, v57
    v_cvt_pk_bf16_f32 v51, v58, v59
    s_cbranch_scc1 Lh1
    s_setprio 3
    ds_write_b128 v125, v[44:47] offset:2048
    ds_write_b128 v125, v[48:51] offset:3072
    v_fmac_f32 v28, v76, v120
    v_fmac_f32 v29, v77, v120
    v_fmac_f32 v30, v78, v120
    v_fmac_f32 v31, v79, v120
    v_cvt_pk_bf16_f32 v52, v28, v29
    v_cvt_pk_bf16_f32 v53, v30, v31
    v_fmac_f32 v32, v80, v120
    v_fmac_f32 v33, v81, v120
    v_fmac_f32 v34, v82, v120
    v_fmac_f32 v35, v83, v120
    v_cvt_pk_bf16_f32 v54, v32, v33
    v_cvt_pk_bf16_f32 v55, v34, v35
    v_fmac_f32 v36, v84, v120
    v_fmac_f32 v37, v85, v120
    v_fmac_f32 v38, v86, v120
    v_fmac_f32 v39, v87, v120
    v_cvt_pk_bf16_f32 v56, v36, v37
    v_cvt_pk_bf16_f32 v57, v38, v39
    v_fmac_f32 v40, v88, v120
    v_fmac_f32 v41, v89, v120
    v_fmac_f32 v42, v90, v120
    v_fmac_f32 v43, v91, v120
    v_cvt_pk_bf16_f32 v58, v40, v41
    v_cvt_pk_bf16_f32 v59, v42, v43
    ds_write_b128 v125, v[52:55] offset:4096
    ds_write_b128 v125, v[56:59] offset:5120
    v_mov_b32 v5, 157972
    v_mov_b32 v6, 1
    s_mov_b64 exec, 1
    ds_add_u32 v5, v6
    s_mov_b64 exec, -1
    v_mov_b32 v8, s22
    v_mov_b32 v9, s22
    v_mov_b32 v10, s22
    v_mov_b32 v11, s22
Lcw_1:
    s_sub_u32 s35, s35, 1
    s_cbranch_scc1 Lend
    ds_read_b32 v6, v5
    s_waitcnt lgkmcnt(0)
    v_readfirstlane_b32 s38, v6
    s_nop 0
    s_cmp_lt_u32 s38, 8
    s_cbranch_scc1 Lcw_1
    ds_read_b128 v[28:31], v125 offset:0
    ds_read_b128 v[32:35], v125 offset:1024
Lh_join:
    buffer_load_dword v20, v12, s[28:31], s24 offen sc1
    ds_read_b64_tr_b16 a[64:65], v26 offset:0
    ds_read_b64_tr_b16 a[66:67], v26 offset:512
    ds_read_b64_tr_b16 a[68:69], v27 offset:0
    ds_read_b64_tr_b16 a[70:71], v27 offset:512
    ds_read_b64_tr_b16 a[72:73], v26 offset:4096
    ds_read_b64_tr_b16 a[74:75], v26 offset:4608
    ds_read_b64_tr_b16 a[76:77], v27 offset:4096
    ds_read_b64_tr_b16 a[78:79], v27 offset:4608
    s_waitcnt lgkmcnt(8)
    s_setprio 3
    v_cndmask_b32 v92, 0, v30, s[6:7]
    v_cndmask_b32 v93, 0, v31, s[6:7]
    v_cndmask_b32 v94, 0, v32, s[12:13]
    v_cndmask_b32 v95, 0, v33, s[12:13]
    v_cndmask_b32 v104, 0, v30, s[8:9]
    v_cndmask_b32 v105, 0, v31, s[8:9]
    v_mfma_f32_16x16x32_bf16 v[76:79], v[46:49], v[92:95], v[8:11]
    v_mfma_f32_16x16x32_bf16 v[80:83], v[54:57], v[92:95], 0
    v_cndmask_b32 v106, 0, v32, s[14:15]
    v_cndmask_b32 v107, 0, v33, s[14:15]
    v_mov_b32 v96, v28
    v_mov_b32 v97, v29
    v_mfma_f32_16x16x32_bf16 v[84:87], v[46:49], v[104:107], v[8:11]
    v_mfma_f32_16x16x32_bf16 v[88:91], v[54:57], v[104:107], 0
    v_cndmask_b32 v98, 0, v30, s[10:11]
    v_cndmask_b32 v99, 0, v31, s[10:11]
    v_cndmask_b32 v100, 0, v32, s[16:17]
    v_cndmask_b32 v101, 0, v33, s[16:17]
    v_mfma_f32_16x16x32_bf16 v[36:39], v[44:47], v[96:99], v[8:11]
    v_mfma_f32_16x16x32_bf16 v[40:43], v[52:55], v[96:99], 0
    v_cndmask_b32 v76, v76, v77, s[4:5]
    v_cndmask_b32 v80, v80, v81, s[4:5]
    v_cndmask_b32 v78, v78, v79, s[4:5]
    v_cndmask_b32 v82, v82, v83, s[4:5]
    v_cndmask_b32 v92, v76, v80, s[18:19]
    v_cndmask_b32 v94, v78, v82, s[20:21]
    v_min_u32 v4, -2, v92
    v_min_u32 v5, -2, v94
    v_cndmask_b32 v84, v84, v85, s[4:5]
    v_cndmask_b32 v88, v88, v89, s[4:5]
    v_cndmask_b32 v86, v86, v87, s[4:5]
    v_cndmask_b32 v90, v90, v91, s[4:5]
    v_cndmask_b32 v104, v84, v88, s[18:19]
    v_cndmask_b32 v106, v86, v90, s[20:21]
    v_min_u32 v6, -2, v104
    v_min_u32 v7, -2, v106
    buffer_store_dwordx4 v[4:7], v13, s[28:31], s58 offen sc0 sc1
    s_setprio 2
    ds_read_b64_tr_b16 a[80:81], v26 offset:39040
    ds_read_b64_tr_b16 a[82:83], v26 offset:39552
    ds_read_b64_tr_b16 a[84:85], v27 offset:39040
    ds_read_b64_tr_b16 a[86:87], v27 offset:39552
    ds_read_b64_tr_b16 a[88:89], v26 offset:43136
    ds_read_b64_tr_b16 a[90:91], v26 offset:43648
    ds_read_b64_tr_b16 a[92:93], v27 offset:43136
    ds_read_b64_tr_b16 a[94:95], v27 offset:43648
    ds_read_b64_tr_b16 a[96:97], v24 offset:0
    ds_read_b64_tr_b16 a[98:99], v24 offset:512
    ds_read_b64_tr_b16 a[100:101], v25 offset:0
    ds_read_b64_tr_b16 a[102:103], v25 offset:512
    ds_read_b64_tr_b16 a[104:105], v24 offset:4096
    ds_read_b64_tr_b16 a[106:107], v24 offset:4608
    ds_read_b64_tr_b16 a[108:109], v25 offset:4096
    ds_read_b64_tr_b16 a[110:111], v25 offset:4608
    ds_read_b64_tr_b16 a[112:113], v24 offset:39040
    ds_read_b64_tr_b16 a[114:115], v24 offset:39552
    ds_read_b64_tr_b16 a[116:117], v25 offset:39040
    ds_read_b64_tr_b16 a[118:119], v25 offset:39552
    ds_read_b64_tr_b16 a[120:121], v24 offset:43136
    ds_read_b64_tr_b16 a[122:123], v24 offset:43648
    ds_read_b64_tr_b16 a[124:125], v25 offset:43136
    ds_read_b64_tr_b16 a[126:127], v25 offset:43648
    s_waitcnt lgkmcnt(15)
    v_mfma_f32_16x16x32_bf16 v[60:63], a[0:3], a[64:67], v[60:63]
    v_mov_b32 v102, v34
    v_mov_b32 v103, v35
    v_mul_f32 v4, s25, v121
    v_mfma_f32_16x16x32_bf16 v[68:71], a[4:7], a[64:67], v[68:71]
    v_mfma_f32_16x16x32_bf16 v[76:79], v[48:51], v[100:103], v[8:11]
    v_mfma_f32_16x16x32_bf16 v[80:83], v[56:59], v[100:103], 0
    v_mul_f32 v123, v123, v4
    v_mfma_f32_16x16x32_bf16 v[64:67], a[0:3], a[68:71], v[64:67]
    v_mul_f32 v126, v126, v4
    v_cndmask_b32 v36, v36, v37, s[4:5]
    v_cndmask_b32 v40, v40, v41, s[4:5]
    v_mfma_f32_16x16x32_bf16 v[72:75], a[4:7], a[68:71], v[72:75]
    v_cndmask_b32 v38, v38, v39, s[4:5]
    v_cndmask_b32 v42, v42, v43, s[4:5]
    v_cndmask_b32 v96, v36, v40, s[18:19]
    v_mfma_f32_16x16x32_bf16 v[60:63], a[8:11], a[72:75], v[60:63]
    v_cndmask_b32 v98, v38, v42, s[20:21]
    v_cndmask_b32 v76, v76, v77, s[4:5]
    v_cndmask_b32 v80, v80, v81, s[4:5]
    v_mfma_f32_16x16x32_bf16 v[68:71], a[12:15], a[72:75], v[68:71]
    v_cndmask_b32 v78, v78, v79, s[4:5]
    v_cndmask_b32 v82, v82, v83, s[4:5]
    v_cndmask_b32 v100, v76, v80, s[18:19]
    v_mfma_f32_16x16x32_bf16 v[64:67], a[8:11], a[76:79], v[64:67]
    v_cndmask_b32 v102, v78, v82, s[20:21]
    v_mul_f32 v96, v96, v123
    v_mul_f32 v98, v98, v126
    v_mfma_f32_16x16x32_bf16 v[72:75], a[12:15], a[76:79], v[72:75]
    v_mul_f32 v100, v100, v123
    v_mul_f32 v102, v102, v126
    v_max_f32 v4, v96, v98
    v_mfma_f32_16x16x32_bf16 v[60:63], a[16:19], a[80:83], v[60:63]
    v_max_f32 v5, v100, v102
    v_mov_b32 v6, v4
    v_mov_b32 v7, v5
    v_mfma_f32_16x16x32_bf16 v[68:71], a[20:23], a[80:83], v[68:71]
    v_permlane32_swap_b32 v4, v6
    v_permlane32_swap_b32 v5, v7
    v_max_f32 v4, v4, v6
    v_mfma_f32_16x16x32_bf16 v[64:67], a[16:19], a[84:87], v[64:67]
    v_max_f32 v5, v5, v7
    v_mov_b32 v6, v4
    v_mov_b32 v7, v5
    v_mfma_f32_16x16x32_bf16 v[72:75], a[20:23], a[84:87], v[72:75]
    v_permlane16_swap_b32 v4, v6
    v_permlane16_swap_b32 v5, v7
    s_setprio 1
    v_mfma_f32_16x16x32_bf16 v[60:63], a[24:27], a[88:91], v[60:63]
    v_max_f32 v4, v4, v6
    v_max_f32 v5, v5, v7
    v_sub_f32 v96, v96, v4
    v_mfma_f32_16x16x32_bf16 v[68:71], a[28:31], a[88:91], v[68:71]
    v_sub_f32 v98, v98, v4
    v_sub_f32 v100, v100, v5
    v_sub_f32 v102, v102, v5
    v_mfma_f32_16x16x32_bf16 v[64:67], a[24:27], a[92:95], v[64:67]
    v_exp_f32 v96, v96
    v_exp_f32 v98, v98
    v_exp_f32 v100, v100
    v_mfma_f32_16x16x32_bf16 v[72:75], a[28:31], a[92:95], v[72:75]
    v_exp_f32 v102, v102
    v_cvt_pk_bf16_f32 v96, v96, v96
    s_waitcnt lgkmcnt(12)
    v_mfma_f32_16x16x32_bf16 v[60:63], a[32:35], a[96:99], v[60:63]
    v_cvt_pk_bf16_f32 v97, v98, v98
    v_cvt_pk_bf16_f32 v100, v100, v100
    v_cvt_pk_bf16_f32 v101, v102, v102
    v_mfma_f32_16x16x32_bf16 v[68:71], a[36:39], a[96:99], v[68:71]
    v_and_b32 v98, v96, v118
    v_and_b32 v99, v97, v119
    v_and_b32 v96, v96, v116
    v_mfma_f32_16x16x32_bf16 v[64:67], a[32:35], a[100:103], v[64:67]
    v_and_b32 v97, v97, v117
    v_and_b32 v102, v100, v118
    v_and_b32 v103, v101, v119
    v_mfma_f32_16x16x32_bf16 v[72:75], a[36:39], a[100:103], v[72:75]
    v_and_b32 v100, v100, v116
    v_and_b32 v101, v101, v117
    s_waitcnt lgkmcnt(8)
    v_mfma_f32_16x16x32_bf16 v[60:63], a[40:43], a[104:107], v[60:63]
    s_lshl_b32 s36, s44, 6
    s_add_u32 s36, s36, 156160
    v_lshl_add_u32 v48, v2, 4, s36
    v_xor_b32 v49, 64, v48
    ds_read_b128 v[28:31], v48 offset:0
    v_mfma_f32_16x16x32_bf16 v[68:71], a[44:47], a[104:107], v[68:71]
    ds_read_b128 v[32:35], v48 offset:512
    ds_read_b128 v[36:39], v49 offset:0
    ds_read_b128 v[40:43], v49 offset:512
    s_lshl_b32 s36, s27, 3
    s_add_u32 s36, s36, 157696
    v_mfma_f32_16x16x32_bf16 v[64:67], a[40:43], a[108:111], v[64:67]
    v_lshl_add_u32 v48, v3, 4, s36
    v_mov_b32 v49, 157952
    v_lshl_add_u32 v125, v1, 3, s45
    s_lshl_b32 s36, s27, 10
    v_add_u32 v50, s36, v125
    v_mfma_f32_16x16x32_bf16 v[72:75], a[44:47], a[108:111], v[72:75]
    s_lshl_b32 s37, s27, 12
    s_sub_u32 s37, 2048, s37
    v_add_u32 v51, s37, v50
    v_subrev_u32 v125, 2048, v125
    s_setprio 0
    s_waitcnt lgkmcnt(8)
    v_mfma_f32_16x16x32_bf16 v[60:63], a[48:51], a[112:115], v[60:63]
    v_mfma_f32_16x16x32_bf16 v[68:71], a[52:55], a[112:115], v[68:71]
    v_mfma_f32_16x16x32_bf16 v[64:67], a[48:51], a[116:119], v[64:67]
    v_mfma_f32_16x16x32_bf16 v[72:75], a[52:55], a[116:119], v[72:75]
    s_waitcnt vmcnt(1)
Lfl_chk:
    v_cmp_eq_u32 vcc, s34, v20
    s_nop 0
    s_and_b32 s36, vcc_lo, 0x3ff
    s_cmp_lg_u32 s36, 0x3ff
    s_cbranch_scc1 Lfl_re
    buffer_load_dwordx2 v[52:53], v13, s[28:31], s59 offen offset:8 sc1
    buffer_load_dwordx2 v[54:55], v13, s[28:31], s60 offen offset:0 sc1
    s_waitcnt lgkmcnt(4)
    v_mfma_f32_16x16x32_bf16 v[60:63], a[56:59], a[120:123], v[60:63]
    v_mfma_f32_16x16x32_bf16 v[68:71], a[60:63], a[120:123], v[68:71]
    v_mfma_f32_16x16x32_bf16 v[64:67], a[56:59], a[124:127], v[64:67]
    v_mfma_f32_16x16x32_bf16 v[72:75], a[60:63], a[124:127], v[72:75]
    ds_read_b32 v46, v49
    ds_read_b64 v[44:45], v48
    s_waitcnt lgkmcnt(0)
Lcsv:
    v_readfirstlane_b32 s38, v46
    s_nop 0
    s_cmp_eq_u32 s38, 0
    s_cbranch_scc1 Lcsv_re
    v_fmac_f32 v60, v28, v44
    v_fmac_f32 v61, v29, v44
    v_fmac_f32 v62, v30, v44
    v_fmac_f32 v63, v31, v44
    v_mul_f32 v60, v60, v32
    v_mul_f32 v61, v61, v33
    v_mul_f32 v62, v62, v34
    v_mul_f32 v63, v63, v35
    v_cvt_pk_bf16_f32 v60, v60, v61
    v_cvt_pk_bf16_f32 v61, v62, v63
    ds_write_b64 v50, v[60:61] offset:0
    v_fmac_f32 v64, v28, v45
    v_fmac_f32 v65, v29, v45
    v_fmac_f32 v66, v30, v45
    v_fmac_f32 v67, v31, v45
    v_mul_f32 v64, v64, v32
    v_mul_f32 v65, v65, v33
    v_mul_f32 v66, v66, v34
    v_mul_f32 v67, v67, v35
    v_cvt_pk_bf16_f32 v64, v64, v65
    v_cvt_pk_bf16_f32 v65, v66, v67
    ds_write_b64 v50, v[64:65] offset:512
    v_fmac_f32 v68, v36, v44
    v_fmac_f32 v69, v37, v44
    v_fmac_f32 v70, v38, v44
    v_fmac_f32 v71, v39, v44
    v_mul_f32 v68, v68, v40
    v_mul_f32 v69, v69, v41
    v_mul_f32 v70, v70, v42
    v_mul_f32 v71, v71, v43
    v_cvt_pk_bf16_f32 v68, v68, v69
    v_cvt_pk_bf16_f32 v69, v70, v71
    ds_write_b64 v51, v[68:69] offset:0
    v_fmac_f32 v72, v36, v45
    v_fmac_f32 v73, v37, v45
    v_fmac_f32 v74, v38, v45
    v_fmac_f32 v75, v39, v45
    v_mul_f32 v72, v72, v40
    v_mul_f32 v73, v73, v41
    v_mul_f32 v74, v74, v42
    v_mul_f32 v75, v75, v43
    v_cvt_pk_bf16_f32 v72, v72, v73
    v_cvt_pk_bf16_f32 v73, v74, v75
    ds_write_b64 v51, v[72:73] offset:512
    v_mov_b32 v8, 157976
    v_mov_b32 v9, 1
    s_mov_b64 exec, 1
    ds_add_u32 v8, v9
    s_mov_b64 exec, -1
    s_waitcnt vmcnt(0)
Lrx_chk:
    v_and_b32 v52, s61, v52
    v_and_b32 v53, s61, v53
    v_and_b32 v54, s62, v54
    v_and_b32 v55, s62, v55
    v_max3_u32 v4, v52, v53, v54
    v_max_u32 v4, v4, v55
    v_cmp_eq_u32 vcc, -1, v4
    s_nop 0
    s_cbranch_vccnz Lrx_re
    v_add_f32 v92, v92, v52
    v_add_f32 v94, v94, v53
    v_add_f32 v104, v104, v54
    v_add_f32 v106, v106, v55
Lcw_4:
    s_sub_u32 s35, s35, 1
    s_cbranch_scc1 Lend
    ds_read_b32 v9, v8
    s_waitcnt lgkmcnt(0)
    v_readfirstlane_b32 s38, v9
    s_nop 0
    s_cmp_lt_u32 s38, 7
    s_cbranch_scc1 Lcw_4
    s_setprio 2
    ds_read2st64_b64 v[60:63], v125 offset0:0 offset1:4
    ds_read2st64_b64 v[64:67], v125 offset0:1 offset1:5
    ds_read2st64_b64 v[68:71], v125 offset0:2 offset1:6
    ds_read2st64_b64 v[72:75], v125 offset0:3 offset1:7
    v_mfma_f32_16x16x32_bf16 v[80:83], v[14:17], v[96:99], 0
    v_mfma_f32_16x16x32_bf16 v[84:87], v[14:17], v[100:103], 0
    v_mul_f32 v92, v92, v123
    v_mul_f32 v94, v94, v126
    v_mul_f32 v104, v104, v123
    v_mul_f32 v106, v106, v126
    v_max_f32 v4, v92, v94
    v_max_f32 v5, v104, v106
    v_mov_b32 v6, v4
    v_mov_b32 v7, v5
    s_waitcnt lgkmcnt(0)
    v_mfma_f32_16x16x32_bf16 v[28:31], v[60:63], v[96:99], 0
    v_permlane32_swap_b32 v4, v6
    v_permlane32_swap_b32 v5, v7
    v_max_f32 v4, v4, v6
    v_mfma_f32_16x16x32_bf16 v[40:43], v[72:75], v[100:103], 0
    v_max_f32 v5, v5, v7
    v_mov_b32 v6, v4
    v_mov_b32 v7, v5
    v_mfma_f32_16x16x32_bf16 v[32:35], v[64:67], v[96:99], 0
    v_permlane16_swap_b32 v4, v6
    v_permlane16_swap_b32 v5, v7
    v_max_f32 v4, v4, v6
    v_mfma_f32_16x16x32_bf16 v[36:39], v[68:71], v[100:103], 0
    v_max_f32 v5, v5, v7
    v_sub_f32 v92, v92, v4
    v_sub_f32 v94, v94, v4
    v_rcp_f32 v80, v80
    v_rcp_f32 v84, v84
    v_mul_f32 v28, v28, v80
    v_mul_f32 v29, v29, v80
    v_mul_f32 v30, v30, v80
    v_mul_f32 v31, v31, v80
    v_cvt_pk_bf16_f32 v8, v28, v29
    v_cvt_pk_bf16_f32 v9, v30, v31
    v_min_u32 v8, -2, v8
    v_min_u32 v9, -2, v9
    v_mul_f32 v40, v40, v84
    v_mul_f32 v41, v41, v84
    v_mul_f32 v42, v42, v84
    v_mul_f32 v43, v43, v84
    v_cvt_pk_bf16_f32 v10, v40, v41
    v_cvt_pk_bf16_f32 v11, v42, v43
    v_min_u32 v10, -2, v10
    v_min_u32 v11, -2, v11
    buffer_store_dwordx4 v[8:11], v13, s[28:31], s23 offen sc0 sc1
    v_sub_f32 v104, v104, v5
    v_sub_f32 v106, v106, v5
    v_exp_f32 v92, v92
    v_exp_f32 v94, v94
    v_exp_f32 v104, v104
    v_exp_f32 v106, v106
    v_cvt_pk_bf16_f32 v92, v92, v92
    v_cvt_pk_bf16_f32 v93, v94, v94
    v_cvt_pk_bf16_f32 v104, v104, v104
    v_cvt_pk_bf16_f32 v105, v106, v106
    v_and_b32 v94, v92, v118
    v_and_b32 v95, v93, v119
    v_and_b32 v92, v92, v116
    v_and_b32 v93, v93, v117
    v_and_b32 v106, v104, v118
    v_and_b32 v107, v105, v119
    v_and_b32 v104, v104, v116
    v_and_b32 v105, v105, v117
    v_mfma_f32_16x16x32_bf16 v[76:79], v[14:17], v[92:95], 0
    s_nop 0
    v_mfma_f32_16x16x32_bf16 v[88:91], v[14:17], v[104:107], 0
    v_mfma_f32_16x16x32_bf16 v[44:47], v[64:67], v[92:95], 0
    v_mfma_f32_16x16x32_bf16 v[48:51], v[68:71], v[92:95], 0
    v_mfma_f32_16x16x32_bf16 v[52:55], v[64:67], v[104:107], 0
    v_mfma_f32_16x16x32_bf16 v[56:59], v[68:71], v[104:107], 0
    s_nop 1
    v_rcp_f32 v76, v76
    s_nop 0
    v_rcp_f32 v88, v88
    v_cndmask_b32 v82, v80, v76, s[6:7]
    v_cndmask_b32 v82, v82, v88, s[8:9]
    v_cndmask_b32 v32, v32, v44, s[6:7]
    v_cndmask_b32 v33, v33, v45, s[6:7]
    v_cndmask_b32 v34, v34, v46, s[6:7]
    v_cndmask_b32 v35, v35, v47, s[6:7]
    v_cndmask_b32 v32, v32, v52, s[8:9]
    v_cndmask_b32 v33, v33, v53, s[8:9]
    v_cndmask_b32 v34, v34, v54, s[8:9]
    v_cndmask_b32 v35, v35, v55, s[8:9]
    v_mul_f32 v32, v32, v82
    v_mul_f32 v33, v33, v82
    v_mul_f32 v34, v34, v82
    v_mul_f32 v35, v35, v82
    v_cvt_pk_bf16_f32 v4, v32, v33
    v_cvt_pk_bf16_f32 v5, v34, v35
    v_min_u32 v4, -2, v4
    v_min_u32 v5, -2, v5
    v_cndmask_b32 v86, v84, v76, s[12:13]
    v_cndmask_b32 v86, v86, v88, s[14:15]
    v_cndmask_b32 v36, v36, v48, s[12:13]
    v_cndmask_b32 v37, v37, v49, s[12:13]
    v_cndmask_b32 v38, v38, v50, s[12:13]
    v_cndmask_b32 v39, v39, v51, s[12:13]
    v_cndmask_b32 v36, v36, v56, s[14:15]
    v_cndmask_b32 v37, v37, v57, s[14:15]
    v_cndmask_b32 v38, v38, v58, s[14:15]
    v_cndmask_b32 v39, v39, v59, s[14:15]
    v_mul_f32 v36, v36, v86
    v_mul_f32 v37, v37, v86
    v_mul_f32 v38, v38, v86
    v_mul_f32 v39, v39, v86
    v_cvt_pk_bf16_f32 v6, v36, v37
    v_cvt_pk_bf16_f32 v7, v38, v39
    v_min_u32 v6, -2, v6
    v_min_u32 v7, -2, v7
    buffer_store_dwordx4 v[4:7], v13, s[28:31], s23 offen offset:1024 sc0 sc1
    s_setprio 1
    v_mov_b32 v10, 157980
    v_and_b32 v6, 3, v1
    v_lshl_add_u32 v6, v6, 3, v19
    v_add_u32 v20, v6, v18
    v_xor_b32 v21, 32, v20
    v_xor_b32 v22, 64, v20
    v_xor_b32 v23, 96, v20
    v_add_u32 v24, 63616, v20
    v_add_u32 v25, 63616, v21
    v_add_u32 v26, 63616, v22
    v_add_u32 v27, 63616, v23
Lcw_3:
    s_sub_u32 s35, s35, 1
    s_cbranch_scc1 Lend
    ds_read_b32 v11, v10
    s_waitcnt lgkmcnt(0)
    v_readfirstlane_b32 s38, v11
    s_nop 0
    s_cmp_lt_u32 s38, 2
    s_cbranch_scc1 Lcw_3
    s_mul_i32 s36, s32, 96
    s_lshl_b32 s37, s44, 4
    s_add_u32 s36, s36, s37
    s_sub_u32 s36, s36, 32
    v_add_u32 v126, s36, v3
    v_lshrrev_b32 v6, 3, v1
    v_add_u32 v6, s36, v6
    v_mul_u32_u24 v6, 1280, v6
    v_and_b32 v7, 7, v1
    v_xor_b32 v7, v7, v2
    v_lshl_add_u32 v122, v7, 4, v6
    v_xor_b32 v123, 64, v122
    v_add_u32 v123, 10240, v123
    s_lshl_b32 s36, s44, 11
    s_add_u32 s36, s36, 102656
    v_add_u32 v124, s36, v124
    v_add_u32 v125, s36, v13
    s_lshl_b32 s24, s33, 7
    v_mov_b32 v10, 157960
    s_mov_b32 s41, 0
    s_mov_b32 s47, 3
    v_lshlrev_b32 v28, 16, v108
    ds_read_b64_tr_b16 a[0:1], v20 offset:0
    ds_read_b64_tr_b16 a[2:3], v20 offset:512
    ds_read_b64_tr_b16 a[4:5], v21 offset:0
    ds_read_b64_tr_b16 a[6:7], v21 offset:512
    ds_read_b64_tr_b16 a[8:9], v22 offset:0
    ds_read_b64_tr_b16 a[10:11], v22 offset:512
    ds_read_b64_tr_b16 a[12:13], v23 offset:0
    ds_read_b64_tr_b16 a[14:15], v23 offset:512
    v_and_b32 v29, 0xffff0000, v108
    v_lshlrev_b32 v30, 16, v109
    v_and_b32 v31, 0xffff0000, v109
    v_lshlrev_b32 v32, 16, v110
    v_and_b32 v33, 0xffff0000, v110
    v_lshlrev_b32 v34, 16, v111
    v_and_b32 v35, 0xffff0000, v111
    v_lshlrev_b32 v36, 16, v112
    v_and_b32 v37, 0xffff0000, v112
    v_lshlrev_b32 v38, 16, v113
    v_and_b32 v39, 0xffff0000, v113
    v_lshlrev_b32 v40, 16, v114
    v_and_b32 v41, 0xffff0000, v114
    v_lshlrev_b32 v42, 16, v115
    ds_read_b64_tr_b16 a[16:17], v20 offset:4096
    ds_read_b64_tr_b16 a[18:19], v20 offset:4608
    ds_read_b64_tr_b16 a[20:21], v21 offset:4096
    ds_read_b64_tr_b16 a[22:23], v21 offset:4608
    ds_read_b64_tr_b16 a[24:25], v22 offset:4096
    ds_read_b64_tr_b16 a[26:27], v22 offset:4608
    ds_read_b64_tr_b16 a[28:29], v23 offset:4096
    ds_read_b64_tr_b16 a[30:31], v23 offset:4608
    v_and_b32 v43, 0xffff0000, v115
    v_mul_f32 v4, v120, v121
    v_mul_f32 v5, 0xbfb8aa3b, v121
    v_mul_f32 v6, 0xbfb8aa3b, v4
    v_fma_f32 v44, v28, v5, v6
    v_fma_f32 v45, v29, v5, v6
    v_fma_f32 v46, v30, v5, v6
    v_fma_f32 v47, v31, v5, v6
    v_fma_f32 v48, v32, v5, v6
    v_fma_f32 v49, v33, v5, v6
    v_fma_f32 v50, v34, v5, v6
    v_fma_f32 v51, v35, v5, v6
    v_fma_f32 v52, v36, v5, v6
    v_fma_f32 v53, v37, v5, v6
    ds_read_b64_tr_b16 a[32:33], v20 offset:8192
    ds_read_b64_tr_b16 a[34:35], v20 offset:8704
    ds_read_b64_tr_b16 a[36:37], v21 offset:8192
    ds_read_b64_tr_b16 a[38:39], v21 offset:8704
    ds_read_b64_tr_b16 a[40:41], v22 offset:8192
    ds_read_b64_tr_b16 a[42:43], v22 offset:8704
    ds_read_b64_tr_b16 a[44:45], v23 offset:8192
    ds_read_b64_tr_b16 a[46:47], v23 offset:8704
    v_fma_f32 v54, v38, v5, v6
    v_fma_f32 v55, v39, v5, v6
    v_fma_f32 v56, v40, v5, v6
    v_fma_f32 v57, v41, v5, v6
    v_fma_f32 v58, v42, v5, v6
    v_fma_f32 v59, v43, v5, v6
    v_exp_f32 v44, v44
    v_exp_f32 v45, v45
    v_exp_f32 v46, v46
    v_exp_f32 v47, v47
    v_exp_f32 v48, v48
    v_exp_f32 v49, v49
    v_exp_f32 v50, v50
    v_exp_f32 v51, v51
    v_exp_f32 v52, v52
    ds_read_b64_tr_b16 a[48:49], v20 offset:12288
    ds_read_b64_tr_b16 a[50:51], v20 offset:12800
    ds_read_b64_tr_b16 a[52:53], v21 offset:12288
    ds_read_b64_tr_b16 a[54:55], v21 offset:12800
    ds_read_b64_tr_b16 a[56:57], v22 offset:12288
    ds_read_b64_tr_b16 a[58:59], v22 offset:12800
    ds_read_b64_tr_b16 a[60:61], v23 offset:12288
    ds_read_b64_tr_b16 a[62:63], v23 offset:12800
    v_exp_f32 v53, v53
    v_exp_f32 v54, v54
    v_exp_f32 v55, v55
    v_exp_f32 v56, v56
    v_exp_f32 v57, v57
    v_exp_f32 v58, v58
    v_exp_f32 v59, v59
    v_add_f32 v44, 1.0, v44
    v_add_f32 v45, 1.0, v45
    v_add_f32 v46, 1.0, v46
    v_add_f32 v47, 1.0, v47
    v_add_f32 v48, 1.0, v48
    v_add_f32 v49, 1.0, v49
    v_add_f32 v50, 1.0, v50
    ds_read_b64_tr_b16 a[64:65], v20 offset:24576
    ds_read_b64_tr_b16 a[66:67], v20 offset:25088
    ds_read_b64_tr_b16 a[68:69], v21 offset:24576
    ds_read_b64_tr_b16 a[70:71], v21 offset:25088
    ds_read_b64_tr_b16 a[72:73], v22 offset:24576
    ds_read_b64_tr_b16 a[74:75], v22 offset:25088
    ds_read_b64_tr_b16 a[76:77], v23 offset:24576
    ds_read_b64_tr_b16 a[78:79], v23 offset:25088
    v_add_f32 v51, 1.0, v51
    v_add_f32 v52, 1.0, v52
    v_add_f32 v53, 1.0, v53
    v_add_f32 v54, 1.0, v54
    v_add_f32 v55, 1.0, v55
    v_add_f32 v56, 1.0, v56
    v_add_f32 v57, 1.0, v57
    v_add_f32 v58, 1.0, v58
    v_add_f32 v59, 1.0, v59
    v_rcp_f32 v44, v44
    v_rcp_f32 v45, v45
    v_rcp_f32 v46, v46
    v_rcp_f32 v47, v47
    v_rcp_f32 v48, v48
    ds_read_b64_tr_b16 a[80:81], v20 offset:28672
    ds_read_b64_tr_b16 a[82:83], v20 offset:29184
    ds_read_b64_tr_b16 a[84:85], v21 offset:28672
    ds_read_b64_tr_b16 a[86:87], v21 offset:29184
    ds_read_b64_tr_b16 a[88:89], v22 offset:28672
    ds_read_b64_tr_b16 a[90:91], v22 offset:29184
    ds_read_b64_tr_b16 a[92:93], v23 offset:28672
    ds_read_b64_tr_b16 a[94:95], v23 offset:29184
    v_rcp_f32 v49, v49
    v_rcp_f32 v50, v50
    v_rcp_f32 v51, v51
    v_rcp_f32 v52, v52
    v_rcp_f32 v53, v53
    v_rcp_f32 v54, v54
    v_rcp_f32 v55, v55
    v_rcp_f32 v56, v56
    v_rcp_f32 v57, v57
    v_rcp_f32 v58, v58
    v_rcp_f32 v59, v59
    v_fma_f32 v7, v28, v121, v4
    v_mul_f32 v44, v44, v7
    buffer_load_dwordx4 v[60:63], v13, s[28:31], s53 offen offset:0 sc1
    buffer_load_dwordx4 v[64:67], v13, s[28:31], s53 offen offset:2048 sc1
    buffer_load_dwordx4 v[68:71], v13, s[28:31], s54 offen offset:0 sc1
    buffer_load_dwordx4 v[72:75], v13, s[28:31], s54 offen offset:2048 sc1
    buffer_load_dwordx4 v[76:79], v13, s[28:31], s55 offen offset:0 sc1
    buffer_load_dwordx4 v[80:83], v13, s[28:31], s55 offen offset:2048 sc1
    buffer_load_dwordx4 v[84:87], v13, s[28:31], s56 offen offset:0 sc1
    buffer_load_dwordx4 v[88:91], v13, s[28:31], s56 offen offset:2048 sc1
    s_setprio 0
    v_fma_f32 v11, v29, v121, v4
    v_mul_f32 v45, v45, v11
    ds_read_b64_tr_b16 a[96:97], v24 offset:59520
    ds_read_b64_tr_b16 a[98:99], v24 offset:60032
    ds_read_b64_tr_b16 a[100:101], v25 offset:59520
    ds_read_b64_tr_b16 a[102:103], v25 offset:60032
    ds_read_b64_tr_b16 a[104:105], v26 offset:59520
    ds_read_b64_tr_b16 a[106:107], v26 offset:60032
    ds_read_b64_tr_b16 a[108:109], v27 offset:59520
    ds_read_b64_tr_b16 a[110:111], v27 offset:60032
    v_fma_f32 v7, v30, v121, v4
    v_mul_f32 v46, v46, v7
    v_fma_f32 v11, v31, v121, v4
    v_mul_f32 v47, v47, v11
    v_fma_f32 v7, v32, v121, v4
    v_mul_f32 v48, v48, v7
    v_fma_f32 v11, v33, v121, v4
    v_mul_f32 v49, v49, v11
    v_fma_f32 v7, v34, v121, v4
    v_mul_f32 v50, v50, v7
    v_fma_f32 v11, v35, v121, v4
    v_mul_f32 v51, v51, v11
    v_fma_f32 v7, v36, v121, v4
    v_mul_f32 v52, v52, v7
    ds_read_b64_tr_b16 a[112:113], v24 offset:63616
    ds_read_b64_tr_b16 a[114:115], v24 offset:64128
    ds_read_b64_tr_b16 a[116:117], v25 offset:63616
    ds_read_b64_tr_b16 a[118:119], v25 offset:64128
    ds_read_b64_tr_b16 a[120:121], v26 offset:63616
    ds_read_b64_tr_b16 a[122:123], v26 offset:64128
    ds_read_b64_tr_b16 a[124:125], v27 offset:63616
    ds_read_b64_tr_b16 a[126:127], v27 offset:64128
    v_fma_f32 v11, v37, v121, v4
    v_mul_f32 v53, v53, v11
    v_fma_f32 v7, v38, v121, v4
    v_mul_f32 v54, v54, v7
    v_fma_f32 v11, v39, v121, v4
    v_mul_f32 v55, v55, v11
    v_fma_f32 v7, v40, v121, v4
    v_mul_f32 v56, v56, v7
    v_fma_f32 v11, v41, v121, v4
    v_mul_f32 v57, v57, v11
    v_fma_f32 v7, v42, v121, v4
    v_mul_f32 v58, v58, v7
    v_fma_f32 v11, v43, v121, v4
    v_mul_f32 v59, v59, v11
Lwo_go:
    s_setprio 3
    ds_read_b64 v[8:9], v10
    s_waitcnt vmcnt(6)
    v_max3_u32 v18, v60, v61, v62
    v_max3_u32 v19, v64, v65, v66
    v_max3_u32 v18, v18, v63, v67
    v_max_u32 v18, v18, v19
    v_cmp_eq_u32 vcc, -1, v18
    s_nop 0
    s_cbranch_vccnz Lre_0
Lck_0:
    s_waitcnt lgkmcnt(15)
    v_mfma_f32_16x16x32_bf16 v[108:111], a[0:3], v[60:63], 0
    ds_read_b64_tr_b16 a[0:1], v24 offset:16384
    ds_read_b64_tr_b16 a[2:3], v24 offset:16896
    buffer_load_dwordx4 v[92:95], v13, s[28:31], s57 offen offset:0 sc1
    v_mfma_f32_16x16x32_bf16 v[112:115], a[4:7], v[60:63], 0
    ds_read_b64_tr_b16 a[4:5], v25 offset:16384
    ds_read_b64_tr_b16 a[6:7], v25 offset:16896
    v_mfma_f32_16x16x32_bf16 v[116:119], a[8:11], v[60:63], 0
    ds_read_b64_tr_b16 a[8:9], v26 offset:16384
    buffer_load_dwordx4 v[96:99], v13, s[28:31], s57 offen offset:2048 sc1
    v_mfma_f32_16x16x32_bf16 v[14:17], a[12:15], v[60:63], 0
    ds_read_b64_tr_b16 a[10:11], v26 offset:16896
    ds_read_b64_tr_b16 a[12:13], v27 offset:16384
    v_mfma_f32_16x16x32_bf16 v[108:111], a[16:19], v[64:67], v[108:111]
    ds_read_b64_tr_b16 a[14:15], v27 offset:16896
    s_waitcnt vmcnt(6)
    v_max3_u32 v18, v68, v69, v70
    v_mfma_f32_16x16x32_bf16 v[112:115], a[20:23], v[64:67], v[112:115]
    ds_read_b64_tr_b16 a[16:17], v24 offset:20480
    ds_read_b64_tr_b16 a[18:19], v24 offset:20992
    v_max3_u32 v19, v72, v73, v74
    v_max3_u32 v18, v18, v71, v75
    v_mfma_f32_16x16x32_bf16 v[116:119], a[24:27], v[64:67], v[116:119]
    ds_read_b64_tr_b16 a[20:21], v25 offset:20480
    ds_read_b64_tr_b16 a[22:23], v25 offset:20992
    v_max_u32 v18, v18, v19
    v_cmp_eq_u32 vcc, -1, v18
    v_mfma_f32_16x16x32_bf16 v[14:17], a[28:31], v[64:67], v[14:17]
    ds_read_b64_tr_b16 a[24:25], v26 offset:20480
    s_cbranch_vccnz Lre_1
Lck_1:
    s_waitcnt lgkmcnt(13)
Linfo:
    v_readfirstlane_b32 s39, v8
    s_nop 0
    s_cmp_eq_u32 s39, -2
    s_cbranch_scc1 Linfo_re
    v_mfma_f32_16x16x32_bf16 v[108:111], a[32:35], v[68:71], v[108:111]
    ds_read_b64_tr_b16 a[26:27], v26 offset:20992
    ds_read_b64_tr_b16 a[28:29], v27 offset:20480
    buffer_load_dwordx4 v[100:103], v13, s[28:31], s53 offen offset:1024 sc1
    v_mfma_f32_16x16x32_bf16 v[112:115], a[36:39], v[68:71], v[112:115]
    ds_read_b64_tr_b16 a[30:31], v27 offset:20992
    v_mfma_f32_16x16x32_bf16 v[116:119], a[40:43], v[68:71], v[116:119]
    ds_read_b64_tr_b16 a[32:33], v20 offset:32768
    ds_read_b64_tr_b16 a[34:35], v20 offset:33280
    buffer_load_dwordx4 v[104:107], v13, s[28:31], s53 offen offset:3072 sc1
    v_mfma_f32_16x16x32_bf16 v[14:17], a[44:47], v[68:71], v[14:17]
    ds_read_b64_tr_b16 a[36:37], v21 offset:32768
    ds_read_b64_tr_b16 a[38:39], v21 offset:33280
    v_mfma_f32_16x16x32_bf16 v[108:111], a[48:51], v[72:75], v[108:111]
    ds_read_b64_tr_b16 a[40:41], v22 offset:32768
    s_waitcnt vmcnt(6)
    v_max3_u32 v18, v76, v77, v78
    v_mfma_f32_16x16x32_bf16 v[112:115], a[52:55], v[72:75], v[112:115]
    ds_read_b64_tr_b16 a[42:43], v22 offset:33280
    ds_read_b64_tr_b16 a[44:45], v23 offset:32768
    v_max3_u32 v19, v80, v81, v82
    v_max3_u32 v18, v18, v79, v83
    v_mfma_f32_16x16x32_bf16 v[116:119], a[56:59], v[72:75], v[116:119]
    ds_read_b64_tr_b16 a[46:47], v23 offset:33280
    v_max_u32 v18, v18, v19
    v_cmp_eq_u32 vcc, -1, v18
    v_mfma_f32_16x16x32_bf16 v[14:17], a[60:63], v[72:75], v[14:17]
    ds_read_b64_tr_b16 a[48:49], v20 offset:36864
    ds_read_b64_tr_b16 a[50:51], v20 offset:37376
    s_cbranch_vccnz Lre_2
Lck_2:
    v_mfma_f32_16x16x32_bf16 v[108:111], a[64:67], v[76:79], v[108:111]
    ds_read_b64_tr_b16 a[52:53], v21 offset:36864
    ds_read_b64_tr_b16 a[54:55], v21 offset:37376
    buffer_load_dwordx4 v[60:63], v13, s[28:31], s54 offen offset:1024 sc1
    v_mfma_f32_16x16x32_bf16 v[112:115], a[68:71], v[76:79], v[112:115]
    ds_read_b64_tr_b16 a[56:57], v22 offset:36864
    v_mfma_f32_16x16x32_bf16 v[116:119], a[72:75], v[76:79], v[116:119]
    ds_read_b64_tr_b16 a[58:59], v22 offset:37376
    ds_read_b64_tr_b16 a[60:61], v23 offset:36864
    buffer_load_dwordx4 v[64:67], v13, s[28:31], s54 offen offset:3072 sc1
    v_mfma_f32_16x16x32_bf16 v[14:17], a[76:79], v[76:79], v[14:17]
    ds_read_b64_tr_b16 a[62:63], v23 offset:37376
    v_mfma_f32_16x16x32_bf16 v[108:111], a[80:83], v[80:83], v[108:111]
    ds_read_b64_tr_b16 a[64:65], v20 offset:40960
    ds_read_b64_tr_b16 a[66:67], v20 offset:41472
    s_waitcnt vmcnt(6)
    v_max3_u32 v18, v84, v85, v86
    v_mfma_f32_16x16x32_bf16 v[112:115], a[84:87], v[80:83], v[112:115]
    ds_read_b64_tr_b16 a[68:69], v21 offset:40960
    ds_read_b64_tr_b16 a[70:71], v21 offset:41472
    v_max3_u32 v19, v88, v89, v90
    v_max3_u32 v18, v18, v87, v91
    v_mfma_f32_16x16x32_bf16 v[116:119], a[88:91], v[80:83], v[116:119]
    ds_read_b64_tr_b16 a[72:73], v22 offset:40960
    v_max_u32 v18, v18, v19
    v_cmp_eq_u32 vcc, -1, v18
    v_mfma_f32_16x16x32_bf16 v[14:17], a[92:95], v[80:83], v[14:17]
    ds_read_b64_tr_b16 a[74:75], v22 offset:41472
    ds_read_b64_tr_b16 a[76:77], v23 offset:40960
    s_cbranch_vccnz Lre_3
Lck_3:
    s_setprio 2
    v_mfma_f32_16x16x32_bf16 v[108:111], a[96:99], v[84:87], v[108:111]
    ds_read_b64_tr_b16 a[78:79], v23 offset:41472
    buffer_load_dwordx4 v[68:71], v13, s[28:31], s55 offen offset:1024 sc1
    v_mfma_f32_16x16x32_bf16 v[112:115], a[100:103], v[84:87], v[112:115]
    ds_read_b64_tr_b16 a[80:81], v20 offset:45056
    ds_read_b64_tr_b16 a[82:83], v20 offset:45568
    v_mfma_f32_16x16x32_bf16 v[116:119], a[104:107], v[84:87], v[116:119]
    ds_read_b64_tr_b16 a[84:85], v21 offset:45056
    ds_read_b64_tr_b16 a[86:87], v21 offset:45568
    buffer_load_dwordx4 v[72:75], v13, s[28:31], s55 offen offset:3072 sc1
    v_mfma_f32_16x16x32_bf16 v[14:17], a[108:111], v[84:87], v[14:17]
    ds_read_b64_tr_b16 a[88:89], v22 offset:45056
    v_mfma_f32_16x16x32_bf16 v[108:111], a[112:115], v[88:91], v[108:111]
    ds_read_b64_tr_b16 a[90:91], v22 offset:45568
    ds_read_b64_tr_b16 a[92:93], v23 offset:45056
    s_waitcnt vmcnt(6)
    v_max3_u32 v18, v92, v93, v94
    v_mfma_f32_16x16x32_bf16 v[112:115], a[116:119], v[88:91], v[112:115]
    ds_read_b64_tr_b16 a[94:95], v23 offset:45568
    v_max3_u32 v19, v96, v97, v98
    v_max3_u32 v18, v18, v95, v99
    v_mfma_f32_16x16x32_bf16 v[116:119], a[120:123], v[88:91], v[116:119]
    ds_read_b64_tr_b16 a[96:97], v24 offset:0
    ds_read_b64_tr_b16 a[98:99], v24 offset:512
    v_max_u32 v18, v18, v19
    v_cmp_eq_u32 vcc, -1, v18
    v_mfma_f32_16x16x32_bf16 v[14:17], a[124:127], v[88:91], v[14:17]
    ds_read_b64_tr_b16 a[100:101], v25 offset:0
    ds_read_b64_tr_b16 a[102:103], v25 offset:512
    s_cbranch_vccnz Lre_4
Lck_4:
    s_waitcnt lgkmcnt(15)
    v_mfma_f32_16x16x32_bf16 v[108:111], a[0:3], v[92:95], v[108:111]
    ds_read_b64_tr_b16 a[104:105], v26 offset:0
    buffer_load_dwordx4 v[76:79], v13, s[28:31], s56 offen offset:1024 sc1
    v_mfma_f32_16x16x32_bf16 v[112:115], a[4:7], v[92:95], v[112:115]
    ds_read_b64_tr_b16 a[106:107], v26 offset:512
    ds_read_b64_tr_b16 a[108:109], v27 offset:0
    v_mfma_f32_16x16x32_bf16 v[116:119], a[8:11], v[92:95], v[116:119]
    ds_read_b64_tr_b16 a[110:111], v27 offset:512
    buffer_load_dwordx4 v[80:83], v13, s[28:31], s56 offen offset:3072 sc1
    v_mfma_f32_16x16x32_bf16 v[14:17], a[12:15], v[92:95], v[14:17]
    ds_read_b64_tr_b16 a[112:113], v24 offset:4096
    ds_read_b64_tr_b16 a[114:115], v24 offset:4608
    v_mfma_f32_16x16x32_bf16 v[108:111], a[16:19], v[96:99], v[108:111]
    ds_read_b64_tr_b16 a[116:117], v25 offset:4096
    ds_read_b64_tr_b16 a[118:119], v25 offset:4608
    s_waitcnt vmcnt(6)
    v_max3_u32 v18, v100, v101, v102
    v_mfma_f32_16x16x32_bf16 v[112:115], a[20:23], v[96:99], v[112:115]
    ds_read_b64_tr_b16 a[120:121], v26 offset:4096
    v_max3_u32 v19, v104, v105, v106
    v_max3_u32 v18, v18, v103, v107
    v_mfma_f32_16x16x32_bf16 v[116:119], a[24:27], v[96:99], v[116:119]
    ds_read_b64_tr_b16 a[122:123], v26 offset:4608
    ds_read_b64_tr_b16 a[124:125], v27 offset:4096
    v_max_u32 v18, v18, v19
    v_cmp_eq_u32 vcc, -1, v18
    v_mfma_f32_16x16x32_bf16 v[14:17], a[28:31], v[96:99], v[14:17]
    ds_read_b64_tr_b16 a[126:127], v27 offset:4608
    s_cbranch_vccnz Lre_5
Lck_5:
    v_mfma_f32_16x16x32_bf16 v[108:111], a[32:35], v[100:103], v[108:111]
    ds_read_b64_tr_b16 a[0:1], v24 offset:8192
    ds_read_b64_tr_b16 a[2:3], v24 offset:8704
    buffer_load_dwordx4 v[84:87], v13, s[28:31], s57 offen offset:1024 sc1
    v_mfma_f32_16x16x32_bf16 v[112:115], a[36:39], v[100:103], v[112:115]
    ds_read_b64_tr_b16 a[4:5], v25 offset:8192
    ds_read_b64_tr_b16 a[6:7], v25 offset:8704
    v_mfma_f32_16x16x32_bf16 v[116:119], a[40:43], v[100:103], v[116:119]
    ds_read_b64_tr_b16 a[8:9], v26 offset:8192
    buffer_load_dwordx4 v[88:91], v13, s[28:31], s57 offen offset:3072 sc1
    v_mfma_f32_16x16x32_bf16 v[14:17], a[44:47], v[100:103], v[14:17]
    ds_read_b64_tr_b16 a[10:11], v26 offset:8704
    ds_read_b64_tr_b16 a[12:13], v27 offset:8192
    v_mfma_f32_16x16x32_bf16 v[108:111], a[48:51], v[104:107], v[108:111]
    ds_read_b64_tr_b16 a[14:15], v27 offset:8704
    s_waitcnt vmcnt(6)
    v_max3_u32 v18, v60, v61, v62
    v_mfma_f32_16x16x32_bf16 v[112:115], a[52:55], v[104:107], v[112:115]
    ds_read_b64_tr_b16 a[16:17], v24 offset:12288
    ds_read_b64_tr_b16 a[18:19], v24 offset:12800
    v_max3_u32 v19, v64, v65, v66
    v_max3_u32 v18, v18, v63, v67
    v_mfma_f32_16x16x32_bf16 v[116:119], a[56:59], v[104:107], v[116:119]
    ds_read_b64_tr_b16 a[20:21], v25 offset:12288
    ds_read_b64_tr_b16 a[22:23], v25 offset:12800
    v_max_u32 v18, v18, v19
    v_cmp_eq_u32 vcc, -1, v18
    v_mfma_f32_16x16x32_bf16 v[14:17], a[60:63], v[104:107], v[14:17]
    ds_read_b64_tr_b16 a[24:25], v26 offset:12288
    s_cbranch_vccnz Lre_6
Lck_6:
    s_setprio 1
    s_waitcnt lgkmcnt(15)
    v_mfma_f32_16x16x32_bf16 v[108:111], a[64:67], v[60:63], v[108:111]
    ds_read_b64_tr_b16 a[26:27], v26 offset:12800
    ds_read_b64_tr_b16 a[28:29], v27 offset:12288
    v_mfma_f32_16x16x32_bf16 v[112:115], a[68:71], v[60:63], v[112:115]
    ds_read_b64_tr_b16 a[30:31], v27 offset:12800
    v_mfma_f32_16x16x32_bf16 v[116:119], a[72:75], v[60:63], v[116:119]
    ds_read_b64_tr_b16 a[32:33], v20 offset:49152
    ds_read_b64_tr_b16 a[34:35], v20 offset:49664
    v_mfma_f32_16x16x32_bf16 v[14:17], a[76:79], v[60:63], v[14:17]
    ds_read_b64_tr_b16 a[36:37], v21 offset:49152
    ds_read_b64_tr_b16 a[38:39], v21 offset:49664
    v_mfma_f32_16x16x32_bf16 v[108:111], a[80:83], v[64:67], v[108:111]
    ds_read_b64_tr_b16 a[40:41], v22 offset:49152
    s_waitcnt vmcnt(4)
    v_max3_u32 v18, v68, v69, v70
    v_mfma_f32_16x16x32_bf16 v[112:115], a[84:87], v[64:67], v[112:115]
    ds_read_b64_tr_b16 a[42:43], v22 offset:49664
    ds_read_b64_tr_b16 a[44:45], v23 offset:49152
    v_max3_u32 v19, v72, v73, v74
    v_max3_u32 v18, v18, v71, v75
    v_mfma_f32_16x16x32_bf16 v[116:119], a[88:91], v[64:67], v[116:119]
    ds_read_b64_tr_b16 a[46:47], v23 offset:49664
    v_max_u32 v18, v18, v19
    v_cmp_eq_u32 vcc, -1, v18
    v_mfma_f32_16x16x32_bf16 v[14:17], a[92:95], v[64:67], v[14:17]
    ds_read_b64_tr_b16 a[48:49], v24 offset:24576
    ds_read_b64_tr_b16 a[50:51], v24 offset:25088
    s_cbranch_vccnz Lre_7
Lck_7:
    v_mfma_f32_16x16x32_bf16 v[108:111], a[96:99], v[68:71], v[108:111]
    ds_read_b64_tr_b16 a[52:53], v25 offset:24576
    ds_read_b64_tr_b16 a[54:55], v25 offset:25088
    v_mfma_f32_16x16x32_bf16 v[112:115], a[100:103], v[68:71], v[112:115]
    ds_read_b64_tr_b16 a[56:57], v26 offset:24576
    v_mfma_f32_16x16x32_bf16 v[116:119], a[104:107], v[68:71], v[116:119]
    ds_read_b64_tr_b16 a[58:59], v26 offset:25088
    ds_read_b64_tr_b16 a[60:61], v27 offset:24576
    v_mfma_f32_16x16x32_bf16 v[14:17], a[108:111], v[68:71], v[14:17]
    ds_read_b64_tr_b16 a[62:63], v27 offset:25088
    s_waitcnt lgkmcnt(15)
    v_mfma_f32_16x16x32_bf16 v[108:111], a[112:115], v[72:75], v[108:111]
    s_waitcnt vmcnt(2)
    v_max3_u32 v18, v76, v77, v78
    v_mfma_f32_16x16x32_bf16 v[112:115], a[116:119], v[72:75], v[112:115]
    v_max3_u32 v19, v80, v81, v82
    v_max3_u32 v18, v18, v79, v83
    v_mfma_f32_16x16x32_bf16 v[116:119], a[120:123], v[72:75], v[116:119]
    v_max_u32 v18, v18, v19
    v_cmp_eq_u32 vcc, -1, v18
    v_mfma_f32_16x16x32_bf16 v[14:17], a[124:127], v[72:75], v[14:17]
    s_cbranch_vccnz Lre_8
Lck_8:
    s_setprio 0
    v_mfma_f32_16x16x32_bf16 v[108:111], a[0:3], v[76:79], v[108:111]
    v_mfma_f32_16x16x32_bf16 v[112:115], a[4:7], v[76:79], v[112:115]
    v_mfma_f32_16x16x32_bf16 v[116:119], a[8:11], v[76:79], v[116:119]
    v_mfma_f32_16x16x32_bf16 v[14:17], a[12:15], v[76:79], v[14:17]
    v_mfma_f32_16x16x32_bf16 v[108:111], a[16:19], v[80:83], v[108:111]
    s_waitcnt vmcnt(0)
    v_max3_u32 v18, v84, v85, v86
    v_mfma_f32_16x16x32_bf16 v[112:115], a[20:23], v[80:83], v[112:115]
    v_max3_u32 v19, v88, v89, v90
    v_max3_u32 v18, v18, v87, v91
    v_mfma_f32_16x16x32_bf16 v[116:119], a[24:27], v[80:83], v[116:119]
    v_max_u32 v18, v18, v19
    v_cmp_eq_u32 vcc, -1, v18
    v_mfma_f32_16x16x32_bf16 v[14:17], a[28:31], v[80:83], v[14:17]
    s_cbranch_vccnz Lre_9
Lck_9:
    s_waitcnt lgkmcnt(8)
    v_mfma_f32_16x16x32_bf16 v[108:111], a[32:35], v[84:87], v[108:111]
    v_mfma_f32_16x16x32_bf16 v[112:115], a[36:39], v[84:87], v[112:115]
    v_mfma_f32_16x16x32_bf16 v[116:119], a[40:43], v[84:87], v[116:119]
    v_mfma_f32_16x16x32_bf16 v[14:17], a[44:47], v[84:87], v[14:17]
    s_waitcnt lgkmcnt(0)
    v_mfma_f32_16x16x32_bf16 v[108:111], a[48:51], v[88:91], v[108:111]
    v_mfma_f32_16x16x32_bf16 v[112:115], a[52:55], v[88:91], v[112:115]
    v_mfma_f32_16x16x32_bf16 v[116:119], a[56:59], v[88:91], v[116:119]
    v_mfma_f32_16x16x32_bf16 v[14:17], a[60:63], v[88:91], v[14:17]
    v_xor_b32 v60, 32, v124
    v_xor_b32 v61, 64, v124
    v_xor_b32 v62, 96, v124
    v_cmp_eq_u32 s[36:37], v8, v126
    v_cmp_eq_u32 s[38:39], v9, v126
    s_nop 0
    s_or_b64 vcc, s[36:37], s[38:39]
    s_cbranch_scc1 Lfix
Lnofix:
    v_fma_f32 v108, v108, v44, v28
    v_fma_f32 v109, v109, v45, v29
    v_fma_f32 v110, v110, v46, v30
    v_fma_f32 v111, v111, v47, v31
    v_cvt_pk_bf16_f32 v68, v108, v109
    v_cvt_pk_bf16_f32 v69, v110, v111
    ds_write_b64 v124, v[68:69]
    v_fma_f32 v112, v112, v48, v32
    v_fma_f32 v113, v113, v49, v33
    v_fma_f32 v114, v114, v50, v34
    v_fma_f32 v115, v115, v51, v35
    v_cvt_pk_bf16_f32 v70, v112, v113
    v_cvt_pk_bf16_f32 v71, v114, v115
    ds_write_b64 v60, v[70:71]
    v_fma_f32 v116, v116, v52, v36
    v_fma_f32 v117, v117, v53, v37
    v_fma_f32 v118, v118, v54, v38
    v_fma_f32 v119, v119, v55, v39
    v_cvt_pk_bf16_f32 v72, v116, v117
    v_cvt_pk_bf16_f32 v73, v118, v119
    ds_write_b64 v61, v[72:73]
    v_fma_f32 v14, v14, v56, v40
    v_fma_f32 v15, v15, v57, v41
    v_fma_f32 v16, v16, v58, v42
    v_fma_f32 v17, v17, v59, v43
    v_cvt_pk_bf16_f32 v74, v14, v15
    v_cvt_pk_bf16_f32 v75, v16, v17
    ds_write_b64 v62, v[74:75]
    ds_read_b128 v[76:79], v125 offset:0
    ds_read_b128 v[80:83], v125 offset:1024
    s_waitcnt lgkmcnt(1)
    buffer_store_dwordx4 v[76:79], v122, s[48:51], s24 offen sc0 sc1
    s_waitcnt lgkmcnt(0)
    buffer_store_dwordx4 v[80:83], v123, s[48:51], s24 offen sc0 sc1
    s_endpgm
Lh1:
    ds_write_b128 v125, v[44:47] offset:0
    ds_write_b128 v125, v[48:51] offset:1024
    v_mov_b32 v5, 157972
    v_mov_b32 v6, 1
    s_mov_b64 exec, 1
    ds_add_u32 v5, v6
    s_mov_b64 exec, -1
    v_fmac_f32 v28, v76, v120
    v_fmac_f32 v29, v77, v120
    v_fmac_f32 v30, v78, v120
    v_fmac_f32 v31, v79, v120
    v_cvt_pk_bf16_f32 v28, v28, v29
    v_cvt_pk_bf16_f32 v29, v30, v31
    v_fmac_f32 v32, v80, v120
    v_fmac_f32 v33, v81, v120
    v_fmac_f32 v34, v82, v120
    v_fmac_f32 v35, v83, v120
    v_cvt_pk_bf16_f32 v30, v32, v33
    v_cvt_pk_bf16_f32 v31, v34, v35
    v_fmac_f32 v36, v84, v120
    v_fmac_f32 v37, v85, v120
    v_fmac_f32 v38, v86, v120
    v_fmac_f32 v39, v87, v120
    v_cvt_pk_bf16_f32 v32, v36, v37
    v_cvt_pk_bf16_f32 v33, v38, v39
    v_fmac_f32 v40, v88, v120
    v_fmac_f32 v41, v89, v120
    v_fmac_f32 v42, v90, v120
    v_fmac_f32 v43, v91, v120
    v_cvt_pk_bf16_f32 v34, v40, v41
    v_cvt_pk_bf16_f32 v35, v42, v43
    v_subrev_u32 v4, 6144, v125
    v_mov_b32 v8, s22
    v_mov_b32 v9, s22
    v_mov_b32 v10, s22
    v_mov_b32 v11, s22
Lcw_2:
    s_sub_u32 s35, s35, 1
    s_cbranch_scc1 Lend
    ds_read_b32 v6, v5
    s_waitcnt lgkmcnt(0)
    v_readfirstlane_b32 s38, v6
    s_nop 0
    s_cmp_lt_u32 s38, 8
    s_cbranch_scc1 Lcw_2
    ds_read_b128 v[52:55], v125 offset:2048
    ds_read_b128 v[56:59], v125 offset:3072
    ds_read_b128 v[44:47], v4 offset:4096
    ds_read_b128 v[48:51], v4 offset:5120
    s_branch Lh_join
Lqf_re:
    s_sub_u32 s35, s35, 1
    s_cbranch_scc1 Lend
    ds_read_b32 v7, v96
    ds_read_b128 v[76:79], v95 offset:0
    ds_read_b128 v[80:83], v95 offset:64
    ds_read_b128 v[84:87], v95 offset:128
    ds_read_b128 v[88:91], v95 offset:192
    s_waitcnt lgkmcnt(0)
    s_branch Lqf
Lcsv_re:
    s_sub_u32 s35, s35, 1
    s_cbranch_scc1 Lend
    ds_read_b32 v46, v49
    ds_read_b64 v[44:45], v48
    s_waitcnt lgkmcnt(0)
    s_branch Lcsv
Lrx_re:
    s_sub_u32 s35, s35, 1
    s_cbranch_scc1 Lend
    buffer_load_dwordx2 v[52:53], v13, s[28:31], s59 offen offset:8 sc1
    buffer_load_dwordx2 v[54:55], v13, s[28:31], s60 offen offset:0 sc1
    s_waitcnt vmcnt(0)
    s_branch Lrx_chk
Linfo_re:
    s_sub_u32 s35, s35, 1
    s_cbranch_scc1 Lend
    ds_read_b64 v[8:9], v10
    s_waitcnt lgkmcnt(0)
    s_branch Linfo
Lfl_re:
    s_sub_u32 s35, s35, 1
    s_cbranch_scc1 Lend
    buffer_load_dword v20, v12, s[28:31], s24 offen sc1
    s_waitcnt vmcnt(0)
    s_branch Lfl_chk
Lxe0:
    ds_read_b64 v[108:109], v4
    ds_read_b64 v[110:111], v5
    ds_read_b64 v[112:113], v6
    ds_read_b64 v[114:115], v7
    s_branch Lxe0_b
Lxe1:
    ds_read_b64 v[108:109], v4
    ds_read_b64 v[110:111], v5
    ds_read_b64 v[112:113], v6
    ds_read_b64 v[114:115], v7
    s_branch Lxe1_b
Lxe2:
    ds_read_b64 v[108:109], v4
    ds_read_b64 v[110:111], v5
    ds_read_b64 v[112:113], v6
    ds_read_b64 v[114:115], v7
    s_branch Lxe2_b
Lxe3:
    ds_read_b64 v[108:109], v4
    ds_read_b64 v[110:111], v5
    ds_read_b64 v[112:113], v6
    ds_read_b64 v[114:115], v7
    s_branch Lxe3_b
Lxe4:
    ds_read_b64 v[108:109], v4
    ds_read_b64 v[110:111], v5
    ds_read_b64 v[112:113], v6
    ds_read_b64 v[114:115], v7
    s_branch Lxe4_b
Lxe5:
    ds_read_b64 v[108:109], v4
    ds_read_b64 v[110:111], v5
    ds_read_b64 v[112:113], v6
    ds_read_b64 v[114:115], v7
    s_branch Lxe5_b
Lxe6:
    ds_read_b64 v[108:109], v4
    ds_read_b64 v[110:111], v5
    ds_read_b64 v[112:113], v6
    ds_read_b64 v[114:115], v7
    s_branch Lxe6_b
Lxe7:
    ds_read_b64 v[108:109], v4
    ds_read_b64 v[110:111], v5
    ds_read_b64 v[112:113], v6
    ds_read_b64 v[114:115], v7
    s_branch Lxe7_b
Lxe8:
    ds_read_b64 v[108:109], v4
    ds_read_b64 v[110:111], v5
    ds_read_b64 v[112:113], v6
    ds_read_b64 v[114:115], v7
    s_branch Lxe8_b
Lxe9:
    ds_read_b64 v[108:109], v4
    ds_read_b64 v[110:111], v5
    ds_read_b64 v[112:113], v6
    ds_read_b64 v[114:115], v7
    s_branch Lxe9_b
Lre_0:
    s_mov_b32 s41, 1
    s_sub_u32 s35, s35, 1
    s_cbranch_scc1 Lend
    s_sleep 2
    buffer_load_dwordx4 v[60:63], v13, s[28:31], s53 offen offset:0 sc1
    buffer_load_dwordx4 v[64:67], v13, s[28:31], s53 offen offset:2048 sc1
    s_waitcnt vmcnt(0)
    v_max3_u32 v18, v60, v61, v62
    v_max3_u32 v19, v64, v65, v66
    v_max3_u32 v18, v18, v63, v67
    v_max_u32 v18, v18, v19
    v_cmp_eq_u32 vcc, -1, v18
    s_nop 0
    s_cbranch_vccnz Lre_0
    buffer_load_dwordx4 v[68:71], v13, s[28:31], s54 offen offset:0 sc1
    buffer_load_dwordx4 v[72:75], v13, s[28:31], s54 offen offset:2048 sc1
    buffer_load_dwordx4 v[76:79], v13, s[28:31], s55 offen offset:0 sc1
    buffer_load_dwordx4 v[80:83], v13, s[28:31], s55 offen offset:2048 sc1
    buffer_load_dwordx4 v[84:87], v13, s[28:31], s56 offen offset:0 sc1
    buffer_load_dwordx4 v[88:91], v13, s[28:31], s56 offen offset:2048 sc1
    s_branch Lck_0
Lre_1:
    s_mov_b32 s41, 1
    s_sub_u32 s35, s35, 1
    s_cbranch_scc1 Lend
    s_sleep 2
    buffer_load_dwordx4 v[68:71], v13, s[28:31], s54 offen offset:0 sc1
    buffer_load_dwordx4 v[72:75], v13, s[28:31], s54 offen offset:2048 sc1
    s_waitcnt vmcnt(0)
    v_max3_u32 v18, v68, v69, v70
    v_max3_u32 v19, v72, v73, v74
    v_max3_u32 v18, v18, v71, v75
    v_max_u32 v18, v18, v19
    v_cmp_eq_u32 vcc, -1, v18
    s_nop 0
    s_cbranch_vccnz Lre_1
    buffer_load_dwordx4 v[76:79], v13, s[28:31], s55 offen offset:0 sc1
    buffer_load_dwordx4 v[80:83], v13, s[28:31], s55 offen offset:2048 sc1
    buffer_load_dwordx4 v[84:87], v13, s[28:31], s56 offen offset:0 sc1
    buffer_load_dwordx4 v[88:91], v13, s[28:31], s56 offen offset:2048 sc1
    buffer_load_dwordx4 v[92:95], v13, s[28:31], s57 offen offset:0 sc1
    buffer_load_dwordx4 v[96:99], v13, s[28:31], s57 offen offset:2048 sc1
    s_branch Lck_1
Lre_2:
    s_mov_b32 s41, 1
    s_sub_u32 s35, s35, 1
    s_cbranch_scc1 Lend
    s_sleep 2
    buffer_load_dwordx4 v[76:79], v13, s[28:31], s55 offen offset:0 sc1
    buffer_load_dwordx4 v[80:83], v13, s[28:31], s55 offen offset:2048 sc1
    s_waitcnt vmcnt(0)
    v_max3_u32 v18, v76, v77, v78
    v_max3_u32 v19, v80, v81, v82
    v_max3_u32 v18, v18, v79, v83
    v_max_u32 v18, v18, v19
    v_cmp_eq_u32 vcc, -1, v18
    s_nop 0
    s_cbranch_vccnz Lre_2
    buffer_load_dwordx4 v[84:87], v13, s[28:31], s56 offen offset:0 sc1
    buffer_load_dwordx4 v[88:91], v13, s[28:31], s56 offen offset:2048 sc1
    buffer_load_dwordx4 v[92:95], v13, s[28:31], s57 offen offset:0 sc1
    buffer_load_dwordx4 v[96:99], v13, s[28:31], s57 offen offset:2048 sc1
    buffer_load_dwordx4 v[100:103], v13, s[28:31], s53 offen offset:1024 sc1
    buffer_load_dwordx4 v[104:107], v13, s[28:31], s53 offen offset:3072 sc1
    s_branch Lck_2
Lre_3:
    s_mov_b32 s41, 1
    s_sub_u32 s35, s35, 1
    s_cbranch_scc1 Lend
    s_sleep 2
    buffer_load_dwordx4 v[84:87], v13, s[28:31], s56 offen offset:0 sc1
    buffer_load_dwordx4 v[88:91], v13, s[28:31], s56 offen offset:2048 sc1
    s_waitcnt vmcnt(0)
    v_max3_u32 v18, v84, v85, v86
    v_max3_u32 v19, v88, v89, v90
    v_max3_u32 v18, v18, v87, v91
    v_max_u32 v18, v18, v19
    v_cmp_eq_u32 vcc, -1, v18
    s_nop 0
    s_cbranch_vccnz Lre_3
    buffer_load_dwordx4 v[92:95], v13, s[28:31], s57 offen offset:0 sc1
    buffer_load_dwordx4 v[96:99], v13, s[28:31], s57 offen offset:2048 sc1
    buffer_load_dwordx4 v[100:103], v13, s[28:31], s53 offen offset:1024 sc1
    buffer_load_dwordx4 v[104:107], v13, s[28:31], s53 offen offset:3072 sc1
    buffer_load_dwordx4 v[60:63], v13, s[28:31], s54 offen offset:1024 sc1
    buffer_load_dwordx4 v[64:67], v13, s[28:31], s54 offen offset:3072 sc1
    s_branch Lck_3
Lre_4:
    s_mov_b32 s41, 1
    s_sub_u32 s35, s35, 1
    s_cbranch_scc1 Lend
    s_sleep 2
    buffer_load_dwordx4 v[92:95], v13, s[28:31], s57 offen offset:0 sc1
    buffer_load_dwordx4 v[96:99], v13, s[28:31], s57 offen offset:2048 sc1
    s_waitcnt vmcnt(0)
    v_max3_u32 v18, v92, v93, v94
    v_max3_u32 v19, v96, v97, v98
    v_max3_u32 v18, v18, v95, v99
    v_max_u32 v18, v18, v19
    v_cmp_eq_u32 vcc, -1, v18
    s_nop 0
    s_cbranch_vccnz Lre_4
    buffer_load_dwordx4 v[100:103], v13, s[28:31], s53 offen offset:1024 sc1
    buffer_load_dwordx4 v[104:107], v13, s[28:31], s53 offen offset:3072 sc1
    buffer_load_dwordx4 v[60:63], v13, s[28:31], s54 offen offset:1024 sc1
    buffer_load_dwordx4 v[64:67], v13, s[28:31], s54 offen offset:3072 sc1
    buffer_load_dwordx4 v[68:71], v13, s[28:31], s55 offen offset:1024 sc1
    buffer_load_dwordx4 v[72:75], v13, s[28:31], s55 offen offset:3072 sc1
    s_branch Lck_4
Lre_5:
    s_mov_b32 s41, 1
    s_sub_u32 s35, s35, 1
    s_cbranch_scc1 Lend
    s_sleep 2
    buffer_load_dwordx4 v[100:103], v13, s[28:31], s53 offen offset:1024 sc1
    buffer_load_dwordx4 v[104:107], v13, s[28:31], s53 offen offset:3072 sc1
    s_waitcnt vmcnt(0)
    v_max3_u32 v18, v100, v101, v102
    v_max3_u32 v19, v104, v105, v106
    v_max3_u32 v18, v18, v103, v107
    v_max_u32 v18, v18, v19
    v_cmp_eq_u32 vcc, -1, v18
    s_nop 0
    s_cbranch_vccnz Lre_5
    buffer_load_dwordx4 v[60:63], v13, s[28:31], s54 offen offset:1024 sc1
    buffer_load_dwordx4 v[64:67], v13, s[28:31], s54 offen offset:3072 sc1
    buffer_load_dwordx4 v[68:71], v13, s[28:31], s55 offen offset:1024 sc1
    buffer_load_dwordx4 v[72:75], v13, s[28:31], s55 offen offset:3072 sc1
    buffer_load_dwordx4 v[76:79], v13, s[28:31], s56 offen offset:1024 sc1
    buffer_load_dwordx4 v[80:83], v13, s[28:31], s56 offen offset:3072 sc1
    s_branch Lck_5
Lre_6:
    s_mov_b32 s41, 1
    s_sub_u32 s35, s35, 1
    s_cbranch_scc1 Lend
    s_sleep 2
    buffer_load_dwordx4 v[60:63], v13, s[28:31], s54 offen offset:1024 sc1
    buffer_load_dwordx4 v[64:67], v13, s[28:31], s54 offen offset:3072 sc1
    s_waitcnt vmcnt(0)
    v_max3_u32 v18, v60, v61, v62
    v_max3_u32 v19, v64, v65, v66
    v_max3_u32 v18, v18, v63, v67
    v_max_u32 v18, v18, v19
    v_cmp_eq_u32 vcc, -1, v18
    s_nop 0
    s_cbranch_vccnz Lre_6
    buffer_load_dwordx4 v[68:71], v13, s[28:31], s55 offen offset:1024 sc1
    buffer_load_dwordx4 v[72:75], v13, s[28:31], s55 offen offset:3072 sc1
    buffer_load_dwordx4 v[76:79], v13, s[28:31], s56 offen offset:1024 sc1
    buffer_load_dwordx4 v[80:83], v13, s[28:31], s56 offen offset:3072 sc1
    buffer_load_dwordx4 v[84:87], v13, s[28:31], s57 offen offset:1024 sc1
    buffer_load_dwordx4 v[88:91], v13, s[28:31], s57 offen offset:3072 sc1
    s_branch Lck_6
Lre_7:
    s_mov_b32 s41, 1
    s_sub_u32 s35, s35, 1
    s_cbranch_scc1 Lend
    s_sleep 2
    buffer_load_dwordx4 v[68:71], v13, s[28:31], s55 offen offset:1024 sc1
    buffer_load_dwordx4 v[72:75], v13, s[28:31], s55 offen offset:3072 sc1
    s_waitcnt vmcnt(0)
    v_max3_u32 v18, v68, v69, v70
    v_max3_u32 v19, v72, v73, v74
    v_max3_u32 v18, v18, v71, v75
    v_max_u32 v18, v18, v19
    v_cmp_eq_u32 vcc, -1, v18
    s_nop 0
    s_cbranch_vccnz Lre_7
    buffer_load_dwordx4 v[76:79], v13, s[28:31], s56 offen offset:1024 sc1
    buffer_load_dwordx4 v[80:83], v13, s[28:31], s56 offen offset:3072 sc1
    buffer_load_dwordx4 v[84:87], v13, s[28:31], s57 offen offset:1024 sc1
    buffer_load_dwordx4 v[88:91], v13, s[28:31], s57 offen offset:3072 sc1
    s_branch Lck_7
Lre_8:
    s_mov_b32 s41, 1
    s_sub_u32 s35, s35, 1
    s_cbranch_scc1 Lend
    s_sleep 2
    buffer_load_dwordx4 v[76:79], v13, s[28:31], s56 offen offset:1024 sc1
    buffer_load_dwordx4 v[80:83], v13, s[28:31], s56 offen offset:3072 sc1
    s_waitcnt vmcnt(0)
    v_max3_u32 v18, v76, v77, v78
    v_max3_u32 v19, v80, v81, v82
    v_max3_u32 v18, v18, v79, v83
    v_max_u32 v18, v18, v19
    v_cmp_eq_u32 vcc, -1, v18
    s_nop 0
    s_cbranch_vccnz Lre_8
    buffer_load_dwordx4 v[84:87], v13, s[28:31], s57 offen offset:1024 sc1
    buffer_load_dwordx4 v[88:91], v13, s[28:31], s57 offen offset:3072 sc1
    s_branch Lck_8
Lre_9:
    s_mov_b32 s41, 1
    s_sub_u32 s35, s35, 1
    s_cbranch_scc1 Lend
    s_sleep 2
    buffer_load_dwordx4 v[84:87], v13, s[28:31], s57 offen offset:1024 sc1
    buffer_load_dwordx4 v[88:91], v13, s[28:31], s57 offen offset:3072 sc1
    s_waitcnt vmcnt(0)
    v_max3_u32 v18, v84, v85, v86
    v_max3_u32 v19, v88, v89, v90
    v_max3_u32 v18, v18, v87, v91
    v_max_u32 v18, v18, v19
    v_cmp_eq_u32 vcc, -1, v18
    s_nop 0
    s_cbranch_vccnz Lre_9
    s_branch Lck_9
Lfix:
    s_mov_b64 vcc, s[38:39]
    v_lshlrev_b32 v6, 4, v2
    v_add_u32 v6, 158208, v6
    v_mov_b32 v10, 157956
Lcw_5:
    s_sub_u32 s35, s35, 1
    s_cbranch_scc1 Lend
    ds_read_b32 v11, v10
    s_waitcnt lgkmcnt(0)
    v_readfirstlane_b32 s38, v11
    s_nop 0
    s_cmp_lt_u32 s38, 1
    s_cbranch_scc1 Lcw_5
    s_mov_b64 exec, s[36:37]
    ds_read_b128 v[44:47], v6 offset:0
    ds_read_b128 v[48:51], v6 offset:64
    ds_read_b128 v[52:55], v6 offset:128
    ds_read_b128 v[56:59], v6 offset:192
    s_mov_b64 exec, vcc
    ds_read_b128 v[44:47], v6 offset:256
    ds_read_b128 v[48:51], v6 offset:320
    ds_read_b128 v[52:55], v6 offset:384
    ds_read_b128 v[56:59], v6 offset:448
    s_mov_b64 exec, -1
    s_waitcnt lgkmcnt(0)
    s_branch Lnofix
Lhalo:
    s_mov_b32 vcc_lo, 0x00010001
    s_mov_b32 vcc_hi, 0x00010001
    v_mov_b32 v11, 38912
    v_cndmask_b32 v76, v76, v11, vcc
    v_xor_b32 v77, 64, v76
    v_add_u32 v80, 78080, v76
    v_add_u32 v81, 78080, v77
    v_mov_b32 v14, 0x3f803f80
    v_mov_b32 v15, 0x3f803f80
    v_mov_b32 v16, 0x3f803f80
    v_mov_b32 v17, 0x3f803f80
    v_and_b32 v4, 7, v1
    v_lshlrev_b32 v4, 4, v4
    v_mul_u32_u24 v5, 39040, v2
    v_add_u32 v4, v4, v5
    ds_write_b128 v4, v[14:17] offset:38912
    v_mov_b32 v4, 157952
    v_mov_b32 v8, 0
    v_mov_b32 v9, 0
    v_mov_b32 v10, -2
    v_mov_b32 v11, -2
    ds_write_b128 v4, v[8:11]
    v_min_u32 v5, 23, v1
    v_lshl_add_u32 v5, v5, 2, v4
    ds_write_b32 v5, v8 offset:16
    s_mul_i32 s36, s32, 96
    s_sub_u32 s36, s36, 16
    v_add_u32 v96, s36, v1
    v_min_u32 v5, 47, v1
    v_add3_u32 v97, s36, v5, 64
    v_mov_b32 v6, 2047
    v_med3_i32 v96, v96, 0, v6
    v_med3_i32 v97, v97, 0, v6
    v_lshlrev_b32 v96, 3, v96
    v_lshlrev_b32 v97, 3, v97
    s_mov_b32 s46, 8192000
    v_mov_b32 v127, 157984
    s_lshl_b32 s36, s3, 2
    s_add_u32 s36, s36, 158016
    v_mov_b32 v10, s36
    s_mov_b32 vcc_lo, 0x00010001
    s_mov_b32 vcc_hi, 0x00010001
    v_cndmask_b32 v116, 0, v14, vcc
    v_cndmask_b32 v117, 0, v15, vcc
    v_cndmask_b32 v118, 0, v16, vcc
    v_cndmask_b32 v119, 0, v17, vcc
    s_waitcnt vmcnt(0)
    s_waitcnt lgkmcnt(0)
    s_barrier
    s_add_u32 s34, s34, 0x9e3779b8
    s_or_b32 s34, s34, 1
    ds_read_b128 v[108:111], v76 offset:0
    ds_read_b128 v[112:115], v77 offset:0
    ds_read_b64_tr_b16 a[0:1], v20 offset:0
    ds_read_b64_tr_b16 a[2:3], v20 offset:512
    ds_read_b64_tr_b16 a[4:5], v21 offset:0
    ds_read_b64_tr_b16 a[6:7], v21 offset:512
    ds_read_b64_tr_b16 a[8:9], v22 offset:0
    ds_read_b64_tr_b16 a[10:11], v22 offset:512
    ds_read_b64_tr_b16 a[12:13], v23 offset:0
    ds_read_b64_tr_b16 a[14:15], v23 offset:512
    ds_read_b64_tr_b16 a[16:17], v20 offset:8192
    ds_read_b64_tr_b16 a[18:19], v20 offset:8704
    ds_read_b64_tr_b16 a[20:21], v21 offset:8192
    ds_read_b64_tr_b16 a[22:23], v21 offset:8704
    ds_read_b64_tr_b16 a[24:25], v22 offset:8192
    ds_read_b64_tr_b16 a[26:27], v22 offset:8704
    s_waitcnt lgkmcnt(12)
    v_mfma_f32_16x16x32_bf16 v[28:31], a[0:3], v[116:119], 0
    ds_read_b64_tr_b16 a[28:29], v23 offset:8192
    ds_read_b64_tr_b16 a[30:31], v23 offset:8704
    s_waitcnt lgkmcnt(12)
    v_mfma_f32_16x16x32_bf16 v[32:35], a[4:7], v[116:119], 0
    ds_read_b64_tr_b16 a[32:33], v20 offset:16384
    ds_read_b64_tr_b16 a[34:35], v20 offset:16896
    s_waitcnt lgkmcnt(12)
    v_mfma_f32_16x16x32_bf16 v[36:39], a[8:11], v[116:119], 0
    ds_read_b64_tr_b16 a[36:37], v21 offset:16384
    ds_read_b64_tr_b16 a[38:39], v21 offset:16896
    s_waitcnt lgkmcnt(12)
    v_mfma_f32_16x16x32_bf16 v[40:43], a[12:15], v[116:119], 0
    ds_read_b64_tr_b16 a[40:41], v22 offset:16384
    ds_read_b64_tr_b16 a[42:43], v22 offset:16896
    s_waitcnt lgkmcnt(12)
    v_mfma_f32_16x16x32_bf16 v[44:47], a[16:19], v[108:111], 0
    ds_read_b64_tr_b16 a[44:45], v23 offset:16384
    ds_read_b64_tr_b16 a[46:47], v23 offset:16896
    s_waitcnt lgkmcnt(12)
    v_mfma_f32_16x16x32_bf16 v[48:51], a[20:23], v[108:111], 0
    ds_read_b64_tr_b16 a[48:49], v20 offset:4096
    ds_read_b64_tr_b16 a[50:51], v20 offset:4608
    s_waitcnt lgkmcnt(12)
    v_mfma_f32_16x16x32_bf16 v[52:55], a[24:27], v[108:111], 0
    ds_read_b64_tr_b16 a[52:53], v21 offset:4096
    ds_read_b64_tr_b16 a[54:55], v21 offset:4608
    s_waitcnt lgkmcnt(12)
    v_mfma_f32_16x16x32_bf16 v[56:59], a[28:31], v[108:111], 0
    ds_read_b64_tr_b16 a[56:57], v22 offset:4096
    ds_read_b64_tr_b16 a[58:59], v22 offset:4608
    s_waitcnt lgkmcnt(12)
    v_mfma_f32_16x16x32_bf16 v[60:63], v[108:111], a[32:35], 0
    ds_read_b64_tr_b16 a[60:61], v23 offset:4096
    ds_read_b64_tr_b16 a[62:63], v23 offset:4608
    s_waitcnt lgkmcnt(12)
    v_mfma_f32_16x16x32_bf16 v[64:67], v[108:111], a[36:39], 0
    ds_read_b64_tr_b16 a[64:65], v20 offset:12288
    ds_read_b64_tr_b16 a[66:67], v20 offset:12800
    s_waitcnt lgkmcnt(12)
    v_mfma_f32_16x16x32_bf16 v[68:71], v[108:111], a[40:43], 0
    ds_read_b64_tr_b16 a[68:69], v21 offset:12288
    ds_read_b64_tr_b16 a[70:71], v21 offset:12800
    s_waitcnt lgkmcnt(12)
    v_mfma_f32_16x16x32_bf16 v[72:75], v[108:111], a[44:47], 0
    ds_read_b64_tr_b16 a[72:73], v22 offset:12288
    ds_read_b64_tr_b16 a[74:75], v22 offset:12800
    s_waitcnt lgkmcnt(12)
    v_mfma_f32_16x16x32_bf16 v[28:31], a[48:51], v[116:119], v[28:31]
    ds_read_b64_tr_b16 a[76:77], v23 offset:12288
    ds_read_b64_tr_b16 a[78:79], v23 offset:12800
    s_waitcnt lgkmcnt(12)
    v_mfma_f32_16x16x32_bf16 v[32:35], a[52:55], v[116:119], v[32:35]
    ds_read_b64_tr_b16 a[80:81], v20 offset:20480
    ds_read_b64_tr_b16 a[82:83], v20 offset:20992
    s_waitcnt lgkmcnt(12)
    v_mfma_f32_16x16x32_bf16 v[36:39], a[56:59], v[116:119], v[36:39]
    ds_read_b64_tr_b16 a[84:85], v21 offset:20480
    ds_read_b64_tr_b16 a[86:87], v21 offset:20992
    s_waitcnt lgkmcnt(12)
    v_mfma_f32_16x16x32_bf16 v[40:43], a[60:63], v[116:119], v[40:43]
    ds_read_b64_tr_b16 a[88:89], v22 offset:20480
    ds_read_b64_tr_b16 a[90:91], v22 offset:20992
    s_waitcnt lgkmcnt(12)
    v_mfma_f32_16x16x32_bf16 v[44:47], a[64:67], v[112:115], v[44:47]
    ds_read_b64_tr_b16 a[92:93], v23 offset:20480
    ds_read_b64_tr_b16 a[94:95], v23 offset:20992
    s_waitcnt lgkmcnt(12)
    v_mfma_f32_16x16x32_bf16 v[48:51], a[68:71], v[112:115], v[48:51]
    s_waitcnt lgkmcnt(10)
    v_mfma_f32_16x16x32_bf16 v[52:55], a[72:75], v[112:115], v[52:55]
    s_waitcnt lgkmcnt(8)
    v_mfma_f32_16x16x32_bf16 v[56:59], a[76:79], v[112:115], v[56:59]
    s_waitcnt lgkmcnt(6)
    v_mfma_f32_16x16x32_bf16 v[60:63], v[112:115], a[80:83], v[60:63]
    s_waitcnt lgkmcnt(4)
    v_mfma_f32_16x16x32_bf16 v[64:67], v[112:115], a[84:87], v[64:67]
    s_waitcnt lgkmcnt(2)
    v_mfma_f32_16x16x32_bf16 v[68:71], v[112:115], a[88:91], v[68:71]
    s_waitcnt lgkmcnt(0)
    v_mfma_f32_16x16x32_bf16 v[72:75], v[112:115], a[92:95], v[72:75]
    s_barrier
    ds_read_b128 v[108:111], v76 offset:39040
    ds_read_b128 v[112:115], v77 offset:39040
    ds_read_b64_tr_b16 a[0:1], v20 offset:39040
    ds_read_b64_tr_b16 a[2:3], v20 offset:39552
    ds_read_b64_tr_b16 a[4:5], v21 offset:39040
    ds_read_b64_tr_b16 a[6:7], v21 offset:39552
    ds_read_b64_tr_b16 a[8:9], v22 offset:39040
    ds_read_b64_tr_b16 a[10:11], v22 offset:39552
    ds_read_b64_tr_b16 a[12:13], v23 offset:39040
    ds_read_b64_tr_b16 a[14:15], v23 offset:39552
    ds_read_b64_tr_b16 a[16:17], v20 offset:47232
    ds_read_b64_tr_b16 a[18:19], v20 offset:47744
    ds_read_b64_tr_b16 a[20:21], v21 offset:47232
    ds_read_b64_tr_b16 a[22:23], v21 offset:47744
    ds_read_b64_tr_b16 a[24:25], v22 offset:47232
    ds_read_b64_tr_b16 a[26:27], v22 offset:47744
    s_waitcnt lgkmcnt(12)
    v_mfma_f32_16x16x32_bf16 v[28:31], a[0:3], v[116:119], v[28:31]
    ds_read_b64_tr_b16 a[28:29], v23 offset:47232
    ds_read_b64_tr_b16 a[30:31], v23 offset:47744
    s_waitcnt lgkmcnt(12)
    v_mfma_f32_16x16x32_bf16 v[32:35], a[4:7], v[116:119], v[32:35]
    ds_read_b64_tr_b16 a[32:33], v20 offset:55424
    ds_read_b64_tr_b16 a[34:35], v20 offset:55936
    s_waitcnt lgkmcnt(12)
    v_mfma_f32_16x16x32_bf16 v[36:39], a[8:11], v[116:119], v[36:39]
    ds_read_b64_tr_b16 a[36:37], v21 offset:55424
    ds_read_b64_tr_b16 a[38:39], v21 offset:55936
    s_waitcnt lgkmcnt(12)
    v_mfma_f32_16x16x32_bf16 v[40:43], a[12:15], v[116:119], v[40:43]
    ds_read_b64_tr_b16 a[40:41], v22 offset:55424
    ds_read_b64_tr_b16 a[42:43], v22 offset:55936
    s_waitcnt lgkmcnt(12)
    v_mfma_f32_16x16x32_bf16 v[44:47], a[16:19], v[108:111], v[44:47]
    ds_read_b64_tr_b16 a[44:45], v23 offset:55424
    ds_read_b64_tr_b16 a[46:47], v23 offset:55936
    s_waitcnt lgkmcnt(12)
    v_mfma_f32_16x16x32_bf16 v[48:51], a[20:23], v[108:111], v[48:51]
    ds_read_b64_tr_b16 a[48:49], v20 offset:43136
    ds_read_b64_tr_b16 a[50:51], v20 offset:43648
    s_waitcnt lgkmcnt(12)
    v_mfma_f32_16x16x32_bf16 v[52:55], a[24:27], v[108:111], v[52:55]
    ds_read_b64_tr_b16 a[52:53], v21 offset:43136
    ds_read_b64_tr_b16 a[54:55], v21 offset:43648
    s_waitcnt lgkmcnt(12)
    v_mfma_f32_16x16x32_bf16 v[56:59], a[28:31], v[108:111], v[56:59]
    ds_read_b64_tr_b16 a[56:57], v22 offset:43136
    ds_read_b64_tr_b16 a[58:59], v22 offset:43648
    s_waitcnt lgkmcnt(12)
    v_mfma_f32_16x16x32_bf16 v[60:63], v[108:111], a[32:35], v[60:63]
    ds_read_b64_tr_b16 a[60:61], v23 offset:43136
    ds_read_b64_tr_b16 a[62:63], v23 offset:43648
    s_waitcnt lgkmcnt(12)
    v_mfma_f32_16x16x32_bf16 v[64:67], v[108:111], a[36:39], v[64:67]
    ds_read_b64_tr_b16 a[64:65], v20 offset:51328
    ds_read_b64_tr_b16 a[66:67], v20 offset:51840
    s_waitcnt lgkmcnt(12)
    v_mfma_f32_16x16x32_bf16 v[68:71], v[108:111], a[40:43], v[68:71]
    ds_read_b64_tr_b16 a[68:69], v21 offset:51328
    ds_read_b64_tr_b16 a[70:71], v21 offset:51840
    s_waitcnt lgkmcnt(12)
    v_mfma_f32_16x16x32_bf16 v[72:75], v[108:111], a[44:47], v[72:75]
    ds_read_b64_tr_b16 a[72:73], v22 offset:51328
    ds_read_b64_tr_b16 a[74:75], v22 offset:51840
    s_waitcnt lgkmcnt(12)
    v_mfma_f32_16x16x32_bf16 v[28:31], a[48:51], v[116:119], v[28:31]
    ds_read_b64_tr_b16 a[76:77], v23 offset:51328
    ds_read_b64_tr_b16 a[78:79], v23 offset:51840
    s_waitcnt lgkmcnt(12)
    v_mfma_f32_16x16x32_bf16 v[32:35], a[52:55], v[116:119], v[32:35]
    ds_read_b64_tr_b16 a[80:81], v20 offset:59520
    ds_read_b64_tr_b16 a[82:83], v20 offset:60032
    s_waitcnt lgkmcnt(12)
    v_mfma_f32_16x16x32_bf16 v[36:39], a[56:59], v[116:119], v[36:39]
    ds_read_b64_tr_b16 a[84:85], v21 offset:59520
    ds_read_b64_tr_b16 a[86:87], v21 offset:60032
    s_waitcnt lgkmcnt(12)
    v_mfma_f32_16x16x32_bf16 v[40:43], a[60:63], v[116:119], v[40:43]
    ds_read_b64_tr_b16 a[88:89], v22 offset:59520
    ds_read_b64_tr_b16 a[90:91], v22 offset:60032
    s_waitcnt lgkmcnt(12)
    v_mfma_f32_16x16x32_bf16 v[44:47], a[64:67], v[112:115], v[44:47]
    ds_read_b64_tr_b16 a[92:93], v23 offset:59520
    ds_read_b64_tr_b16 a[94:95], v23 offset:60032
    s_waitcnt lgkmcnt(12)
    v_mfma_f32_16x16x32_bf16 v[48:51], a[68:71], v[112:115], v[48:51]
    s_waitcnt lgkmcnt(10)
    v_mfma_f32_16x16x32_bf16 v[52:55], a[72:75], v[112:115], v[52:55]
    s_waitcnt lgkmcnt(8)
    v_mfma_f32_16x16x32_bf16 v[56:59], a[76:79], v[112:115], v[56:59]
    s_waitcnt lgkmcnt(6)
    v_mfma_f32_16x16x32_bf16 v[60:63], v[112:115], a[80:83], v[60:63]
    s_waitcnt lgkmcnt(4)
    v_mfma_f32_16x16x32_bf16 v[64:67], v[112:115], a[84:87], v[64:67]
    s_waitcnt lgkmcnt(2)
    v_mfma_f32_16x16x32_bf16 v[68:71], v[112:115], a[88:91], v[68:71]
    s_waitcnt lgkmcnt(0)
    v_mfma_f32_16x16x32_bf16 v[72:75], v[112:115], a[92:95], v[72:75]
    s_mov_b64 exec, 1
    s_lshl_b32 s36, s2, 2
    s_add_u32 s36, s36, 8323072
    v_mov_b32 v4, s34
    v_mov_b32 v5, s36
    buffer_store_dword v4, v5, s[28:31], 0 offen sc1
    s_mov_b64 exec, -1
    s_barrier
    ds_read_b128 v[108:111], v80 offset:0
    ds_read_b128 v[112:115], v81 offset:0
    ds_read_b64_tr_b16 a[0:1], v24 offset:0
    ds_read_b64_tr_b16 a[2:3], v24 offset:512
    ds_read_b64_tr_b16 a[4:5], v25 offset:0
    ds_read_b64_tr_b16 a[6:7], v25 offset:512
    ds_read_b64_tr_b16 a[8:9], v26 offset:0
    ds_read_b64_tr_b16 a[10:11], v26 offset:512
    ds_read_b64_tr_b16 a[12:13], v27 offset:0
    ds_read_b64_tr_b16 a[14:15], v27 offset:512
    ds_read_b64_tr_b16 a[16:17], v24 offset:8192
    ds_read_b64_tr_b16 a[18:19], v24 offset:8704
    ds_read_b64_tr_b16 a[20:21], v25 offset:8192
    ds_read_b64_tr_b16 a[22:23], v25 offset:8704
    ds_read_b64_tr_b16 a[24:25], v26 offset:8192
    ds_read_b64_tr_b16 a[26:27], v26 offset:8704
    s_waitcnt lgkmcnt(12)
    v_mfma_f32_16x16x32_bf16 v[28:31], a[0:3], v[116:119], v[28:31]
    ds_read_b64_tr_b16 a[28:29], v27 offset:8192
    ds_read_b64_tr_b16 a[30:31], v27 offset:8704
    s_waitcnt lgkmcnt(12)
    v_mfma_f32_16x16x32_bf16 v[32:35], a[4:7], v[116:119], v[32:35]
    ds_read_b64_tr_b16 a[32:33], v24 offset:16384
    ds_read_b64_tr_b16 a[34:35], v24 offset:16896
    s_waitcnt lgkmcnt(12)
    v_mfma_f32_16x16x32_bf16 v[36:39], a[8:11], v[116:119], v[36:39]
    ds_read_b64_tr_b16 a[36:37], v25 offset:16384
    ds_read_b64_tr_b16 a[38:39], v25 offset:16896
    s_waitcnt lgkmcnt(12)
    v_mfma_f32_16x16x32_bf16 v[40:43], a[12:15], v[116:119], v[40:43]
    ds_read_b64_tr_b16 a[40:41], v26 offset:16384
    ds_read_b64_tr_b16 a[42:43], v26 offset:16896
    s_waitcnt lgkmcnt(12)
    v_mfma_f32_16x16x32_bf16 v[44:47], a[16:19], v[108:111], v[44:47]
    ds_read_b64_tr_b16 a[44:45], v27 offset:16384
    ds_read_b64_tr_b16 a[46:47], v27 offset:16896
    s_waitcnt lgkmcnt(12)
    v_mfma_f32_16x16x32_bf16 v[48:51], a[20:23], v[108:111], v[48:51]
    ds_read_b64_tr_b16 a[48:49], v24 offset:4096
    ds_read_b64_tr_b16 a[50:51], v24 offset:4608
    s_waitcnt lgkmcnt(12)
    v_mfma_f32_16x16x32_bf16 v[52:55], a[24:27], v[108:111], v[52:55]
    ds_read_b64_tr_b16 a[52:53], v25 offset:4096
    ds_read_b64_tr_b16 a[54:55], v25 offset:4608
    s_waitcnt lgkmcnt(12)
    v_mfma_f32_16x16x32_bf16 v[56:59], a[28:31], v[108:111], v[56:59]
    ds_read_b64_tr_b16 a[56:57], v26 offset:4096
    ds_read_b64_tr_b16 a[58:59], v26 offset:4608
    s_waitcnt lgkmcnt(12)
    v_mfma_f32_16x16x32_bf16 v[60:63], v[108:111], a[32:35], v[60:63]
    ds_read_b64_tr_b16 a[60:61], v27 offset:4096
    ds_read_b64_tr_b16 a[62:63], v27 offset:4608
    s_waitcnt lgkmcnt(12)
    v_mfma_f32_16x16x32_bf16 v[64:67], v[108:111], a[36:39], v[64:67]
    ds_read_b64_tr_b16 a[64:65], v24 offset:12288
    ds_read_b64_tr_b16 a[66:67], v24 offset:12800
    s_waitcnt lgkmcnt(12)
    v_mfma_f32_16x16x32_bf16 v[68:71], v[108:111], a[40:43], v[68:71]
    ds_read_b64_tr_b16 a[68:69], v25 offset:12288
    ds_read_b64_tr_b16 a[70:71], v25 offset:12800
    s_waitcnt lgkmcnt(12)
    v_mfma_f32_16x16x32_bf16 v[72:75], v[108:111], a[44:47], v[72:75]
    ds_read_b64_tr_b16 a[72:73], v26 offset:12288
    ds_read_b64_tr_b16 a[74:75], v26 offset:12800
    s_waitcnt lgkmcnt(12)
    v_mfma_f32_16x16x32_bf16 v[28:31], a[48:51], v[116:119], v[28:31]
    ds_read_b64_tr_b16 a[76:77], v27 offset:12288
    ds_read_b64_tr_b16 a[78:79], v27 offset:12800
    s_waitcnt lgkmcnt(12)
    v_mfma_f32_16x16x32_bf16 v[32:35], a[52:55], v[116:119], v[32:35]
    ds_read_b64_tr_b16 a[80:81], v24 offset:20480
    ds_read_b64_tr_b16 a[82:83], v24 offset:20992
    s_waitcnt lgkmcnt(12)
    v_mfma_f32_16x16x32_bf16 v[36:39], a[56:59], v[116:119], v[36:39]
    ds_read_b64_tr_b16 a[84:85], v25 offset:20480
    ds_read_b64_tr_b16 a[86:87], v25 offset:20992
    s_waitcnt lgkmcnt(12)
    v_mfma_f32_16x16x32_bf16 v[40:43], a[60:63], v[116:119], v[40:43]
    ds_read_b64_tr_b16 a[88:89], v26 offset:20480
    ds_read_b64_tr_b16 a[90:91], v26 offset:20992
    s_waitcnt lgkmcnt(12)
    v_mfma_f32_16x16x32_bf16 v[44:47], a[64:67], v[112:115], v[44:47]
    ds_read_b64_tr_b16 a[92:93], v27 offset:20480
    ds_read_b64_tr_b16 a[94:95], v27 offset:20992
    s_waitcnt lgkmcnt(12)
    v_mfma_f32_16x16x32_bf16 v[48:51], a[68:71], v[112:115], v[48:51]
    s_waitcnt lgkmcnt(10)
    v_mfma_f32_16x16x32_bf16 v[52:55], a[72:75], v[112:115], v[52:55]
    s_waitcnt lgkmcnt(8)
    v_mfma_f32_16x16x32_bf16 v[56:59], a[76:79], v[112:115], v[56:59]
    s_waitcnt lgkmcnt(6)
    v_mfma_f32_16x16x32_bf16 v[60:63], v[112:115], a[80:83], v[60:63]
    s_waitcnt lgkmcnt(4)
    v_mfma_f32_16x16x32_bf16 v[64:67], v[112:115], a[84:87], v[64:67]
    s_waitcnt lgkmcnt(2)
    v_mfma_f32_16x16x32_bf16 v[68:71], v[112:115], a[88:91], v[68:71]
    s_waitcnt lgkmcnt(0)
    v_mfma_f32_16x16x32_bf16 v[72:75], v[112:115], a[92:95], v[72:75]
    s_barrier
    ds_read_b128 v[108:111], v80 offset:39040
    ds_read_b128 v[112:115], v81 offset:39040
    ds_read_b64_tr_b16 a[0:1], v24 offset:39040
    ds_read_b64_tr_b16 a[2:3], v24 offset:39552
    ds_read_b64_tr_b16 a[4:5], v25 offset:39040
    ds_read_b64_tr_b16 a[6:7], v25 offset:39552
    ds_read_b64_tr_b16 a[8:9], v26 offset:39040
    ds_read_b64_tr_b16 a[10:11], v26 offset:39552
    ds_read_b64_tr_b16 a[12:13], v27 offset:39040
    ds_read_b64_tr_b16 a[14:15], v27 offset:39552
    ds_read_b64_tr_b16 a[16:17], v24 offset:47232
    ds_read_b64_tr_b16 a[18:19], v24 offset:47744
    ds_read_b64_tr_b16 a[20:21], v25 offset:47232
    ds_read_b64_tr_b16 a[22:23], v25 offset:47744
    ds_read_b64_tr_b16 a[24:25], v26 offset:47232
    ds_read_b64_tr_b16 a[26:27], v26 offset:47744
    s_waitcnt lgkmcnt(12)
    v_mfma_f32_16x16x32_bf16 v[28:31], a[0:3], v[116:119], v[28:31]
    ds_read_b64_tr_b16 a[28:29], v27 offset:47232
    ds_read_b64_tr_b16 a[30:31], v27 offset:47744
    s_waitcnt lgkmcnt(12)
    v_mfma_f32_16x16x32_bf16 v[32:35], a[4:7], v[116:119], v[32:35]
    ds_read_b64_tr_b16 a[32:33], v24 offset:55424
    ds_read_b64_tr_b16 a[34:35], v24 offset:55936
    s_waitcnt lgkmcnt(12)
    v_mfma_f32_16x16x32_bf16 v[36:39], a[8:11], v[116:119], v[36:39]
    ds_read_b64_tr_b16 a[36:37], v25 offset:55424
    ds_read_b64_tr_b16 a[38:39], v25 offset:55936
    s_waitcnt lgkmcnt(12)
    v_mfma_f32_16x16x32_bf16 v[40:43], a[12:15], v[116:119], v[40:43]
    ds_read_b64_tr_b16 a[40:41], v26 offset:55424
    ds_read_b64_tr_b16 a[42:43], v26 offset:55936
    s_waitcnt lgkmcnt(12)
    v_mfma_f32_16x16x32_bf16 v[44:47], a[16:19], v[108:111], v[44:47]
    ds_read_b64_tr_b16 a[44:45], v27 offset:55424
    ds_read_b64_tr_b16 a[46:47], v27 offset:55936
    s_waitcnt lgkmcnt(12)
    v_mfma_f32_16x16x32_bf16 v[48:51], a[20:23], v[108:111], v[48:51]
    ds_read_b64_tr_b16 a[48:49], v24 offset:43136
    ds_read_b64_tr_b16 a[50:51], v24 offset:43648
    s_waitcnt lgkmcnt(12)
    v_mfma_f32_16x16x32_bf16 v[52:55], a[24:27], v[108:111], v[52:55]
    ds_read_b64_tr_b16 a[52:53], v25 offset:43136
    ds_read_b64_tr_b16 a[54:55], v25 offset:43648
    s_waitcnt lgkmcnt(12)
    v_mfma_f32_16x16x32_bf16 v[56:59], a[28:31], v[108:111], v[56:59]
    ds_read_b64_tr_b16 a[56:57], v26 offset:43136
    ds_read_b64_tr_b16 a[58:59], v26 offset:43648
    s_waitcnt lgkmcnt(12)
    v_mfma_f32_16x16x32_bf16 v[60:63], v[108:111], a[32:35], v[60:63]
    ds_read_b64_tr_b16 a[60:61], v27 offset:43136
    ds_read_b64_tr_b16 a[62:63], v27 offset:43648
    s_waitcnt lgkmcnt(12)
    v_mfma_f32_16x16x32_bf16 v[64:67], v[108:111], a[36:39], v[64:67]
    ds_read_b64_tr_b16 a[64:65], v24 offset:51328
    ds_read_b64_tr_b16 a[66:67], v24 offset:51840
    s_waitcnt lgkmcnt(12)
    v_mfma_f32_16x16x32_bf16 v[68:71], v[108:111], a[40:43], v[68:71]
    ds_read_b64_tr_b16 a[68:69], v25 offset:51328
    ds_read_b64_tr_b16 a[70:71], v25 offset:51840
    s_waitcnt lgkmcnt(12)
    v_mfma_f32_16x16x32_bf16 v[72:75], v[108:111], a[44:47], v[72:75]
    ds_read_b64_tr_b16 a[72:73], v26 offset:51328
    ds_read_b64_tr_b16 a[74:75], v26 offset:51840
    s_waitcnt lgkmcnt(12)
    v_mfma_f32_16x16x32_bf16 v[28:31], a[48:51], v[116:119], v[28:31]
    ds_read_b64_tr_b16 a[76:77], v27 offset:51328
    ds_read_b64_tr_b16 a[78:79], v27 offset:51840
    s_waitcnt lgkmcnt(12)
    v_mfma_f32_16x16x32_bf16 v[32:35], a[52:55], v[116:119], v[32:35]
    ds_read_b64_tr_b16 a[80:81], v24 offset:59520
    ds_read_b64_tr_b16 a[82:83], v24 offset:60032
    s_waitcnt lgkmcnt(12)
    v_mfma_f32_16x16x32_bf16 v[36:39], a[56:59], v[116:119], v[36:39]
    ds_read_b64_tr_b16 a[84:85], v25 offset:59520
    ds_read_b64_tr_b16 a[86:87], v25 offset:60032
    s_waitcnt lgkmcnt(12)
    v_mfma_f32_16x16x32_bf16 v[40:43], a[60:63], v[116:119], v[40:43]
    ds_read_b64_tr_b16 a[88:89], v26 offset:59520
    ds_read_b64_tr_b16 a[90:91], v26 offset:60032
    s_waitcnt lgkmcnt(12)
    v_mfma_f32_16x16x32_bf16 v[44:47], a[64:67], v[112:115], v[44:47]
    ds_read_b64_tr_b16 a[92:93], v27 offset:59520
    ds_read_b64_tr_b16 a[94:95], v27 offset:60032
    s_waitcnt lgkmcnt(12)
    v_mfma_f32_16x16x32_bf16 v[48:51], a[68:71], v[112:115], v[48:51]
    s_waitcnt lgkmcnt(10)
    v_mfma_f32_16x16x32_bf16 v[52:55], a[72:75], v[112:115], v[52:55]
    s_waitcnt lgkmcnt(8)
    v_mfma_f32_16x16x32_bf16 v[56:59], a[76:79], v[112:115], v[56:59]
    s_waitcnt lgkmcnt(6)
    v_mfma_f32_16x16x32_bf16 v[60:63], v[112:115], a[80:83], v[60:63]
    s_waitcnt lgkmcnt(4)
    v_mfma_f32_16x16x32_bf16 v[64:67], v[112:115], a[84:87], v[64:67]
    s_waitcnt lgkmcnt(2)
    v_mfma_f32_16x16x32_bf16 v[68:71], v[112:115], a[88:91], v[68:71]
    s_waitcnt lgkmcnt(0)
    v_mfma_f32_16x16x32_bf16 v[72:75], v[112:115], a[92:95], v[72:75]
    v_add_u32 v4, 156224, v12
    v_min_u32 v5, 47, v1
    v_lshlrev_b32 v5, 2, v5
    v_add_u32 v5, 156480, v5
    v_lshlrev_b32 v6, 4, v2
    v_add_u32 v6, 157184, v6
    v_mov_b32 v7, 157968
    v_lshlrev_b32 v11, 2, v3
    v_add_u32 v11, 156224, v11
    s_barrier
    ds_read_b128 v[108:111], v76 offset:0
    ds_read_b128 v[112:115], v77 offset:0
    ds_read_b64_tr_b16 a[0:1], v20 offset:0
    ds_read_b64_tr_b16 a[2:3], v20 offset:512
    ds_read_b64_tr_b16 a[4:5], v21 offset:0
    ds_read_b64_tr_b16 a[6:7], v21 offset:512
    ds_read_b64_tr_b16 a[8:9], v22 offset:0
    ds_read_b64_tr_b16 a[10:11], v22 offset:512
    ds_read_b64_tr_b16 a[12:13], v23 offset:0
    ds_read_b64_tr_b16 a[14:15], v23 offset:512
    ds_read_b64_tr_b16 a[16:17], v20 offset:8192
    ds_read_b64_tr_b16 a[18:19], v20 offset:8704
    ds_read_b64_tr_b16 a[20:21], v21 offset:8192
    ds_read_b64_tr_b16 a[22:23], v21 offset:8704
    ds_read_b64_tr_b16 a[24:25], v22 offset:8192
    ds_read_b64_tr_b16 a[26:27], v22 offset:8704
    s_waitcnt lgkmcnt(12)
    v_mfma_f32_16x16x32_bf16 v[28:31], a[0:3], v[116:119], v[28:31]
    ds_read_b64_tr_b16 a[28:29], v23 offset:8192
    ds_read_b64_tr_b16 a[30:31], v23 offset:8704
    s_waitcnt lgkmcnt(12)
    v_mfma_f32_16x16x32_bf16 v[32:35], a[4:7], v[116:119], v[32:35]
    ds_read_b64_tr_b16 a[32:33], v20 offset:16384
    ds_read_b64_tr_b16 a[34:35], v20 offset:16896
    s_waitcnt lgkmcnt(12)
    v_mfma_f32_16x16x32_bf16 v[36:39], a[8:11], v[116:119], v[36:39]
    ds_read_b64_tr_b16 a[36:37], v21 offset:16384
    ds_read_b64_tr_b16 a[38:39], v21 offset:16896
    s_waitcnt lgkmcnt(12)
    v_mfma_f32_16x16x32_bf16 v[40:43], a[12:15], v[116:119], v[40:43]
    ds_read_b64_tr_b16 a[40:41], v22 offset:16384
    ds_read_b64_tr_b16 a[42:43], v22 offset:16896
    s_waitcnt lgkmcnt(12)
    v_mfma_f32_16x16x32_bf16 v[44:47], a[16:19], v[108:111], v[44:47]
    ds_read_b64_tr_b16 a[44:45], v23 offset:16384
    ds_read_b64_tr_b16 a[46:47], v23 offset:16896
    s_waitcnt lgkmcnt(12)
    v_mfma_f32_16x16x32_bf16 v[48:51], a[20:23], v[108:111], v[48:51]
    ds_read_b64_tr_b16 a[48:49], v20 offset:4096
    ds_read_b64_tr_b16 a[50:51], v20 offset:4608
    s_waitcnt lgkmcnt(12)
    v_mfma_f32_16x16x32_bf16 v[52:55], a[24:27], v[108:111], v[52:55]
    ds_read_b64_tr_b16 a[52:53], v21 offset:4096
    ds_read_b64_tr_b16 a[54:55], v21 offset:4608
    s_waitcnt lgkmcnt(12)
    v_mfma_f32_16x16x32_bf16 v[56:59], a[28:31], v[108:111], v[56:59]
    ds_read_b64_tr_b16 a[56:57], v22 offset:4096
    ds_read_b64_tr_b16 a[58:59], v22 offset:4608
    s_waitcnt lgkmcnt(12)
    v_mfma_f32_16x16x32_bf16 v[60:63], v[108:111], a[32:35], v[60:63]
    ds_read_b64_tr_b16 a[60:61], v23 offset:4096
    ds_read_b64_tr_b16 a[62:63], v23 offset:4608
    s_waitcnt lgkmcnt(12)
    v_mfma_f32_16x16x32_bf16 v[64:67], v[108:111], a[36:39], v[64:67]
    ds_read_b64_tr_b16 a[64:65], v20 offset:12288
    ds_read_b64_tr_b16 a[66:67], v20 offset:12800
    s_waitcnt lgkmcnt(12)
    v_mfma_f32_16x16x32_bf16 v[68:71], v[108:111], a[40:43], v[68:71]
    ds_read_b64_tr_b16 a[68:69], v21 offset:12288
    ds_read_b64_tr_b16 a[70:71], v21 offset:12800
    s_waitcnt lgkmcnt(12)
    v_mfma_f32_16x16x32_bf16 v[72:75], v[108:111], a[44:47], v[72:75]
    ds_read_b64_tr_b16 a[72:73], v22 offset:12288
    ds_read_b64_tr_b16 a[74:75], v22 offset:12800
    s_waitcnt lgkmcnt(12)
    v_mfma_f32_16x16x32_bf16 v[28:31], a[48:51], v[116:119], v[28:31]
    ds_read_b64_tr_b16 a[76:77], v23 offset:12288
    ds_read_b64_tr_b16 a[78:79], v23 offset:12800
    s_waitcnt lgkmcnt(12)
    v_mfma_f32_16x16x32_bf16 v[32:35], a[52:55], v[116:119], v[32:35]
    ds_read_b64_tr_b16 a[80:81], v20 offset:20480
    ds_read_b64_tr_b16 a[82:83], v20 offset:20992
    s_waitcnt lgkmcnt(12)
    v_mfma_f32_16x16x32_bf16 v[36:39], a[56:59], v[116:119], v[36:39]
    ds_read_b64_tr_b16 a[84:85], v21 offset:20480
    ds_read_b64_tr_b16 a[86:87], v21 offset:20992
    s_waitcnt lgkmcnt(12)
    v_mfma_f32_16x16x32_bf16 v[40:43], a[60:63], v[116:119], v[40:43]
    ds_read_b64_tr_b16 a[88:89], v22 offset:20480
    ds_read_b64_tr_b16 a[90:91], v22 offset:20992
    s_waitcnt lgkmcnt(12)
    v_mfma_f32_16x16x32_bf16 v[44:47], a[64:67], v[112:115], v[44:47]
    ds_read_b64_tr_b16 a[92:93], v23 offset:20480
    ds_read_b64_tr_b16 a[94:95], v23 offset:20992
    s_waitcnt lgkmcnt(12)
    v_mfma_f32_16x16x32_bf16 v[48:51], a[68:71], v[112:115], v[48:51]
    s_waitcnt lgkmcnt(10)
    v_mfma_f32_16x16x32_bf16 v[52:55], a[72:75], v[112:115], v[52:55]
    s_waitcnt lgkmcnt(8)
    v_mfma_f32_16x16x32_bf16 v[56:59], a[76:79], v[112:115], v[56:59]
    s_waitcnt lgkmcnt(6)
    v_mfma_f32_16x16x32_bf16 v[60:63], v[112:115], a[80:83], v[60:63]
    s_waitcnt lgkmcnt(4)
    v_mfma_f32_16x16x32_bf16 v[64:67], v[112:115], a[84:87], v[64:67]
    s_waitcnt lgkmcnt(2)
    v_mfma_f32_16x16x32_bf16 v[68:71], v[112:115], a[88:91], v[68:71]
    s_waitcnt lgkmcnt(0)
    v_mfma_f32_16x16x32_bf16 v[72:75], v[112:115], a[92:95], v[72:75]
    s_barrier
    ds_read_b128 v[108:111], v76 offset:39040
    ds_read_b128 v[112:115], v77 offset:39040
    ds_read_b64_tr_b16 a[0:1], v20 offset:39040
    ds_read_b64_tr_b16 a[2:3], v20 offset:39552
    ds_read_b64_tr_b16 a[4:5], v21 offset:39040
    ds_read_b64_tr_b16 a[6:7], v21 offset:39552
    ds_read_b64_tr_b16 a[8:9], v22 offset:39040
    ds_read_b64_tr_b16 a[10:11], v22 offset:39552
    ds_read_b64_tr_b16 a[12:13], v23 offset:39040
    ds_read_b64_tr_b16 a[14:15], v23 offset:39552
    ds_read_b64_tr_b16 a[16:17], v20 offset:47232
    ds_read_b64_tr_b16 a[18:19], v20 offset:47744
    ds_read_b64_tr_b16 a[20:21], v21 offset:47232
    ds_read_b64_tr_b16 a[22:23], v21 offset:47744
    ds_read_b64_tr_b16 a[24:25], v22 offset:47232
    ds_read_b64_tr_b16 a[26:27], v22 offset:47744
    s_waitcnt lgkmcnt(12)
    v_mfma_f32_16x16x32_bf16 v[28:31], a[0:3], v[116:119], v[28:31]
    ds_read_b64_tr_b16 a[28:29], v23 offset:47232
    ds_read_b64_tr_b16 a[30:31], v23 offset:47744
    s_waitcnt lgkmcnt(12)
    v_mfma_f32_16x16x32_bf16 v[32:35], a[4:7], v[116:119], v[32:35]
    ds_read_b64_tr_b16 a[32:33], v20 offset:55424
    ds_read_b64_tr_b16 a[34:35], v20 offset:55936
    s_waitcnt lgkmcnt(12)
    v_mfma_f32_16x16x32_bf16 v[36:39], a[8:11], v[116:119], v[36:39]
    ds_read_b64_tr_b16 a[36:37], v21 offset:55424
    ds_read_b64_tr_b16 a[38:39], v21 offset:55936
    s_waitcnt lgkmcnt(12)
    v_mfma_f32_16x16x32_bf16 v[40:43], a[12:15], v[116:119], v[40:43]
    ds_read_b64_tr_b16 a[40:41], v22 offset:55424
    ds_read_b64_tr_b16 a[42:43], v22 offset:55936
    s_waitcnt lgkmcnt(12)
    v_mfma_f32_16x16x32_bf16 v[44:47], a[16:19], v[108:111], v[44:47]
    ds_read_b64_tr_b16 a[44:45], v23 offset:55424
    ds_read_b64_tr_b16 a[46:47], v23 offset:55936
    s_waitcnt lgkmcnt(12)
    v_mfma_f32_16x16x32_bf16 v[48:51], a[20:23], v[108:111], v[48:51]
    ds_read_b64_tr_b16 a[48:49], v20 offset:43136
    ds_read_b64_tr_b16 a[50:51], v20 offset:43648
    s_waitcnt lgkmcnt(12)
    v_mfma_f32_16x16x32_bf16 v[52:55], a[24:27], v[108:111], v[52:55]
    ds_read_b64_tr_b16 a[52:53], v21 offset:43136
    ds_read_b64_tr_b16 a[54:55], v21 offset:43648
    s_waitcnt lgkmcnt(12)
    v_mfma_f32_16x16x32_bf16 v[56:59], a[28:31], v[108:111], v[56:59]
    ds_read_b64_tr_b16 a[56:57], v22 offset:43136
    ds_read_b64_tr_b16 a[58:59], v22 offset:43648
    s_waitcnt lgkmcnt(12)
    v_mfma_f32_16x16x32_bf16 v[60:63], v[108:111], a[32:35], v[60:63]
    ds_read_b64_tr_b16 a[60:61], v23 offset:43136
    ds_read_b64_tr_b16 a[62:63], v23 offset:43648
    s_waitcnt lgkmcnt(12)
    v_mfma_f32_16x16x32_bf16 v[64:67], v[108:111], a[36:39], v[64:67]
    ds_read_b64_tr_b16 a[64:65], v20 offset:51328
    ds_read_b64_tr_b16 a[66:67], v20 offset:51840
    s_waitcnt lgkmcnt(12)
    v_mfma_f32_16x16x32_bf16 v[68:71], v[108:111], a[40:43], v[68:71]
    ds_read_b64_tr_b16 a[68:69], v21 offset:51328
    ds_read_b64_tr_b16 a[70:71], v21 offset:51840
    s_waitcnt lgkmcnt(12)
    v_mfma_f32_16x16x32_bf16 v[72:75], v[108:111], a[44:47], v[72:75]
    ds_read_b64_tr_b16 a[72:73], v22 offset:51328
    ds_read_b64_tr_b16 a[74:75], v22 offset:51840
    s_waitcnt lgkmcnt(12)
    v_mfma_f32_16x16x32_bf16 v[28:31], a[48:51], v[116:119], v[28:31]
    ds_read_b64_tr_b16 a[76:77], v23 offset:51328
    ds_read_b64_tr_b16 a[78:79], v23 offset:51840
    s_waitcnt lgkmcnt(12)
    v_mfma_f32_16x16x32_bf16 v[32:35], a[52:55], v[116:119], v[32:35]
    ds_read_b64_tr_b16 a[80:81], v20 offset:59520
    ds_read_b64_tr_b16 a[82:83], v20 offset:60032
    s_waitcnt lgkmcnt(12)
    v_mfma_f32_16x16x32_bf16 v[36:39], a[56:59], v[116:119], v[36:39]
    ds_read_b64_tr_b16 a[84:85], v21 offset:59520
    ds_read_b64_tr_b16 a[86:87], v21 offset:60032
    s_waitcnt lgkmcnt(12)
    v_mfma_f32_16x16x32_bf16 v[40:43], a[60:63], v[116:119], v[40:43]
    ds_read_b64_tr_b16 a[88:89], v22 offset:59520
    ds_read_b64_tr_b16 a[90:91], v22 offset:60032
    s_waitcnt lgkmcnt(12)
    v_mfma_f32_16x16x32_bf16 v[44:47], a[64:67], v[112:115], v[44:47]
    ds_read_b64_tr_b16 a[92:93], v23 offset:59520
    ds_read_b64_tr_b16 a[94:95], v23 offset:60032
    s_waitcnt lgkmcnt(12)
    v_mfma_f32_16x16x32_bf16 v[48:51], a[68:71], v[112:115], v[48:51]
    s_waitcnt lgkmcnt(10)
    v_mfma_f32_16x16x32_bf16 v[52:55], a[72:75], v[112:115], v[52:55]
    s_waitcnt lgkmcnt(8)
    v_mfma_f32_16x16x32_bf16 v[56:59], a[76:79], v[112:115], v[56:59]
    s_waitcnt lgkmcnt(6)
    v_mfma_f32_16x16x32_bf16 v[60:63], v[112:115], a[80:83], v[60:63]
    s_waitcnt lgkmcnt(4)
    v_mfma_f32_16x16x32_bf16 v[64:67], v[112:115], a[84:87], v[64:67]
    s_waitcnt lgkmcnt(2)
    v_mfma_f32_16x16x32_bf16 v[68:71], v[112:115], a[88:91], v[68:71]
    s_waitcnt lgkmcnt(0)
    v_mfma_f32_16x16x32_bf16 v[72:75], v[112:115], a[92:95], v[72:75]
    s_barrier
    ds_read_b128 a[96:99], v80 offset:0
    ds_read_b128 a[100:103], v81 offset:0
    ds_read_b64_tr_b16 a[0:1], v24 offset:0
    ds_read_b64_tr_b16 a[2:3], v24 offset:512
    ds_read_b64_tr_b16 a[4:5], v25 offset:0
    ds_read_b64_tr_b16 a[6:7], v25 offset:512
    ds_read_b64_tr_b16 a[8:9], v26 offset:0
    ds_read_b64_tr_b16 a[10:11], v26 offset:512
    ds_read_b64_tr_b16 a[12:13], v27 offset:0
    ds_read_b64_tr_b16 a[14:15], v27 offset:512
    ds_read_b64_tr_b16 a[16:17], v24 offset:8192
    ds_read_b64_tr_b16 a[18:19], v24 offset:8704
    ds_read_b64_tr_b16 a[20:21], v25 offset:8192
    ds_read_b64_tr_b16 a[22:23], v25 offset:8704
    ds_read_b64_tr_b16 a[24:25], v26 offset:8192
    ds_read_b64_tr_b16 a[26:27], v26 offset:8704
    s_waitcnt lgkmcnt(12)
    v_mfma_f32_16x16x32_bf16 v[28:31], a[0:3], v[116:119], v[28:31]
    ds_read_b64_tr_b16 a[28:29], v27 offset:8192
    ds_read_b64_tr_b16 a[30:31], v27 offset:8704
    s_waitcnt lgkmcnt(12)
    v_mfma_f32_16x16x32_bf16 v[32:35], a[4:7], v[116:119], v[32:35]
    ds_read_b64_tr_b16 a[48:49], v24 offset:4096
    ds_read_b64_tr_b16 a[50:51], v24 offset:4608
    s_waitcnt lgkmcnt(12)
    v_mfma_f32_16x16x32_bf16 v[36:39], a[8:11], v[116:119], v[36:39]
    ds_read_b64_tr_b16 a[52:53], v25 offset:4096
    ds_read_b64_tr_b16 a[54:55], v25 offset:4608
    s_waitcnt lgkmcnt(12)
    v_mfma_f32_16x16x32_bf16 v[40:43], a[12:15], v[116:119], v[40:43]
    ds_read_b64_tr_b16 a[56:57], v26 offset:4096
    ds_read_b64_tr_b16 a[58:59], v26 offset:4608
    s_waitcnt lgkmcnt(12)
    v_mfma_f32_16x16x32_bf16 v[44:47], a[16:19], a[96:99], v[44:47]
    ds_read_b64_tr_b16 a[60:61], v27 offset:4096
    ds_read_b64_tr_b16 a[62:63], v27 offset:4608
    s_waitcnt lgkmcnt(12)
    v_mfma_f32_16x16x32_bf16 v[48:51], a[20:23], a[96:99], v[48:51]
    ds_read_b64_tr_b16 a[64:65], v24 offset:12288
    ds_read_b64_tr_b16 a[66:67], v24 offset:12800
    s_waitcnt lgkmcnt(12)
    v_mfma_f32_16x16x32_bf16 v[52:55], a[24:27], a[96:99], v[52:55]
    ds_read_b64_tr_b16 a[68:69], v25 offset:12288
    ds_read_b64_tr_b16 a[70:71], v25 offset:12800
    s_waitcnt lgkmcnt(12)
    v_mfma_f32_16x16x32_bf16 v[56:59], a[28:31], a[96:99], v[56:59]
    ds_read_b64_tr_b16 a[72:73], v26 offset:12288
    ds_read_b64_tr_b16 a[74:75], v26 offset:12800
    s_waitcnt lgkmcnt(12)
    v_mfma_f32_16x16x32_bf16 v[28:31], a[48:51], v[116:119], v[28:31]
    ds_read_b64_tr_b16 a[76:77], v27 offset:12288
    ds_read_b64_tr_b16 a[78:79], v27 offset:12800
    s_waitcnt lgkmcnt(12)
    v_mfma_f32_16x16x32_bf16 v[32:35], a[52:55], v[116:119], v[32:35]
    s_waitcnt lgkmcnt(10)
    v_mfma_f32_16x16x32_bf16 v[36:39], a[56:59], v[116:119], v[36:39]
    s_waitcnt lgkmcnt(8)
    v_mfma_f32_16x16x32_bf16 v[40:43], a[60:63], v[116:119], v[40:43]
    s_waitcnt lgkmcnt(6)
    v_mfma_f32_16x16x32_bf16 v[44:47], a[64:67], a[100:103], v[44:47]
    s_waitcnt lgkmcnt(4)
    v_mfma_f32_16x16x32_bf16 v[48:51], a[68:71], a[100:103], v[48:51]
    s_waitcnt lgkmcnt(2)
    v_mfma_f32_16x16x32_bf16 v[52:55], a[72:75], a[100:103], v[52:55]
    s_waitcnt lgkmcnt(0)
    v_mfma_f32_16x16x32_bf16 v[56:59], a[76:79], a[100:103], v[56:59]
    s_barrier
    ds_read_b128 a[104:107], v80 offset:39040
    ds_read_b128 a[108:111], v81 offset:39040
    ds_read_b64_tr_b16 a[0:1], v24 offset:39040
    ds_read_b64_tr_b16 a[2:3], v24 offset:39552
    ds_read_b64_tr_b16 a[4:5], v25 offset:39040
    ds_read_b64_tr_b16 a[6:7], v25 offset:39552
    ds_read_b64_tr_b16 a[8:9], v26 offset:39040
    ds_read_b64_tr_b16 a[10:11], v26 offset:39552
    ds_read_b64_tr_b16 a[12:13], v27 offset:39040
    ds_read_b64_tr_b16 a[14:15], v27 offset:39552
    ds_read_b64_tr_b16 a[16:17], v24 offset:47232
    ds_read_b64_tr_b16 a[18:19], v24 offset:47744
    ds_read_b64_tr_b16 a[20:21], v25 offset:47232
    ds_read_b64_tr_b16 a[22:23], v25 offset:47744
    ds_read_b64_tr_b16 a[24:25], v26 offset:47232
    ds_read_b64_tr_b16 a[26:27], v26 offset:47744
    s_waitcnt lgkmcnt(12)
    v_mfma_f32_16x16x32_bf16 v[28:31], a[0:3], v[116:119], v[28:31]
    ds_read_b64_tr_b16 a[28:29], v27 offset:47232
    ds_read_b64_tr_b16 a[30:31], v27 offset:47744
    s_waitcnt lgkmcnt(12)
    v_mfma_f32_16x16x32_bf16 v[32:35], a[4:7], v[116:119], v[32:35]
    ds_read_b64_tr_b16 a[48:49], v24 offset:43136
    ds_read_b64_tr_b16 a[50:51], v24 offset:43648
    s_waitcnt lgkmcnt(12)
    v_mfma_f32_16x16x32_bf16 v[36:39], a[8:11], v[116:119], v[36:39]
    ds_read_b64_tr_b16 a[52:53], v25 offset:43136
    ds_read_b64_tr_b16 a[54:55], v25 offset:43648
    s_waitcnt lgkmcnt(12)
    v_mfma_f32_16x16x32_bf16 v[40:43], a[12:15], v[116:119], v[40:43]
    ds_read_b64_tr_b16 a[56:57], v26 offset:43136
    ds_read_b64_tr_b16 a[58:59], v26 offset:43648
    s_waitcnt lgkmcnt(12)
    v_mfma_f32_16x16x32_bf16 v[44:47], a[16:19], a[104:107], v[44:47]
    ds_read_b64_tr_b16 a[60:61], v27 offset:43136
    ds_read_b64_tr_b16 a[62:63], v27 offset:43648
    s_waitcnt lgkmcnt(12)
    v_mfma_f32_16x16x32_bf16 v[48:51], a[20:23], a[104:107], v[48:51]
    ds_read_b64_tr_b16 a[64:65], v24 offset:51328
    ds_read_b64_tr_b16 a[66:67], v24 offset:51840
    s_waitcnt lgkmcnt(12)
    v_mfma_f32_16x16x32_bf16 v[52:55], a[24:27], a[104:107], v[52:55]
    ds_read_b64_tr_b16 a[68:69], v25 offset:51328
    ds_read_b64_tr_b16 a[70:71], v25 offset:51840
    s_waitcnt lgkmcnt(12)
    v_mfma_f32_16x16x32_bf16 v[56:59], a[28:31], a[104:107], v[56:59]
    ds_read_b64_tr_b16 a[72:73], v26 offset:51328
    ds_read_b64_tr_b16 a[74:75], v26 offset:51840
    s_waitcnt lgkmcnt(12)
    v_mfma_f32_16x16x32_bf16 v[28:31], a[48:51], v[116:119], v[28:31]
    ds_read_b64_tr_b16 a[76:77], v27 offset:51328
    ds_read_b64_tr_b16 a[78:79], v27 offset:51840
    s_waitcnt lgkmcnt(12)
    v_mfma_f32_16x16x32_bf16 v[32:35], a[52:55], v[116:119], v[32:35]
    s_waitcnt lgkmcnt(10)
    v_mfma_f32_16x16x32_bf16 v[36:39], a[56:59], v[116:119], v[36:39]
    s_waitcnt lgkmcnt(8)
    v_mfma_f32_16x16x32_bf16 v[40:43], a[60:63], v[116:119], v[40:43]
    s_waitcnt lgkmcnt(6)
    v_mfma_f32_16x16x32_bf16 v[44:47], a[64:67], a[108:111], v[44:47]
    s_waitcnt lgkmcnt(4)
    v_mfma_f32_16x16x32_bf16 v[48:51], a[68:71], a[108:111], v[48:51]
    s_waitcnt lgkmcnt(2)
    v_mfma_f32_16x16x32_bf16 v[52:55], a[72:75], a[108:111], v[52:55]
    s_waitcnt lgkmcnt(0)
    v_mfma_f32_16x16x32_bf16 v[56:59], a[76:79], a[108:111], v[56:59]
    buffer_load_dwordx2 v[92:93], v96, s[28:31], s46 offen sc1
    buffer_load_dwordx2 v[94:95], v97, s[28:31], s46 offen sc1
    s_barrier
    ds_read_b128 a[112:115], v76 offset:0
    ds_read_b128 a[116:119], v77 offset:0
    ds_read_b64_tr_b16 a[0:1], v20 offset:0
    ds_read_b64_tr_b16 a[2:3], v20 offset:512
    ds_read_b64_tr_b16 a[4:5], v21 offset:0
    ds_read_b64_tr_b16 a[6:7], v21 offset:512
    ds_read_b64_tr_b16 a[8:9], v22 offset:0
    ds_read_b64_tr_b16 a[10:11], v22 offset:512
    ds_read_b64_tr_b16 a[12:13], v23 offset:0
    ds_read_b64_tr_b16 a[14:15], v23 offset:512
    ds_read_b64_tr_b16 a[16:17], v20 offset:8192
    ds_read_b64_tr_b16 a[18:19], v20 offset:8704
    ds_read_b64_tr_b16 a[20:21], v21 offset:8192
    ds_read_b64_tr_b16 a[22:23], v21 offset:8704
    ds_read_b64_tr_b16 a[24:25], v22 offset:8192
    ds_read_b64_tr_b16 a[26:27], v22 offset:8704
    s_waitcnt lgkmcnt(12)
    v_mfma_f32_16x16x32_bf16 v[28:31], a[0:3], v[116:119], v[28:31]
    ds_read_b64_tr_b16 a[28:29], v23 offset:8192
    ds_read_b64_tr_b16 a[30:31], v23 offset:8704
    s_waitcnt lgkmcnt(12)
    v_mfma_f32_16x16x32_bf16 v[32:35], a[4:7], v[116:119], v[32:35]
    ds_read_b64_tr_b16 a[48:49], v20 offset:4096
    ds_read_b64_tr_b16 a[50:51], v20 offset:4608
    s_waitcnt lgkmcnt(12)
    v_mfma_f32_16x16x32_bf16 v[36:39], a[8:11], v[116:119], v[36:39]
    ds_read_b64_tr_b16 a[52:53], v21 offset:4096
    ds_read_b64_tr_b16 a[54:55], v21 offset:4608
    s_waitcnt lgkmcnt(12)
    v_mfma_f32_16x16x32_bf16 v[40:43], a[12:15], v[116:119], v[40:43]
    ds_read_b64_tr_b16 a[56:57], v22 offset:4096
    ds_read_b64_tr_b16 a[58:59], v22 offset:4608
    s_waitcnt lgkmcnt(12)
    v_mfma_f32_16x16x32_bf16 v[44:47], a[16:19], a[112:115], v[44:47]
    ds_read_b64_tr_b16 a[60:61], v23 offset:4096
    ds_read_b64_tr_b16 a[62:63], v23 offset:4608
    s_waitcnt lgkmcnt(12)
    v_mfma_f32_16x16x32_bf16 v[48:51], a[20:23], a[112:115], v[48:51]
    ds_read_b64_tr_b16 a[64:65], v20 offset:12288
    ds_read_b64_tr_b16 a[66:67], v20 offset:12800
    s_waitcnt lgkmcnt(12)
    v_mfma_f32_16x16x32_bf16 v[52:55], a[24:27], a[112:115], v[52:55]
    ds_read_b64_tr_b16 a[68:69], v21 offset:12288
    ds_read_b64_tr_b16 a[70:71], v21 offset:12800
    s_waitcnt lgkmcnt(12)
    v_mfma_f32_16x16x32_bf16 v[56:59], a[28:31], a[112:115], v[56:59]
    ds_read_b64_tr_b16 a[72:73], v22 offset:12288
    ds_read_b64_tr_b16 a[74:75], v22 offset:12800
    s_waitcnt lgkmcnt(12)
    v_mfma_f32_16x16x32_bf16 v[28:31], a[48:51], v[116:119], v[28:31]
    ds_read_b64_tr_b16 a[76:77], v23 offset:12288
    ds_read_b64_tr_b16 a[78:79], v23 offset:12800
    s_waitcnt lgkmcnt(12)
    v_mfma_f32_16x16x32_bf16 v[32:35], a[52:55], v[116:119], v[32:35]
    s_waitcnt lgkmcnt(10)
    v_mfma_f32_16x16x32_bf16 v[36:39], a[56:59], v[116:119], v[36:39]
    s_waitcnt vmcnt(0)
Lst_chk:
    v_cmp_ne_u32 vcc, s34, v93
    v_cmp_ne_u32 s[36:37], s34, v95
    s_nop 0
    s_or_b64 s[36:37], s[36:37], vcc
    s_cbranch_scc1 Lst_re
    v_lshlrev_b32 v93, 16, v92
    s_waitcnt lgkmcnt(8)
    v_mfma_f32_16x16x32_bf16 v[40:43], a[60:63], v[116:119], v[40:43]
    v_and_b32 v92, 0xffff0000, v92
    v_rcp_f32 v93, v93
    s_waitcnt lgkmcnt(6)
    v_mfma_f32_16x16x32_bf16 v[44:47], a[64:67], a[116:119], v[44:47]
    v_lshlrev_b32 v95, 16, v94
    v_and_b32 v94, 0xffff0000, v94
    s_waitcnt lgkmcnt(4)
    v_mfma_f32_16x16x32_bf16 v[48:51], a[68:71], a[116:119], v[48:51]
    v_rcp_f32 v95, v95
    ds_write2st64_b32 v4, v92, v93 offset0:0 offset1:2
    s_waitcnt lgkmcnt(3)
    v_mfma_f32_16x16x32_bf16 v[52:55], a[72:75], a[116:119], v[52:55]
    ds_write2st64_b32 v5, v94, v95 offset0:0 offset1:2
    ds_read_b32 v120, v11
    s_waitcnt lgkmcnt(3)
    v_mfma_f32_16x16x32_bf16 v[56:59], a[76:79], a[116:119], v[56:59]
    s_waitcnt lgkmcnt(0)
    s_barrier
    ds_read_b128 a[120:123], v76 offset:39040
    ds_read_b128 a[124:127], v77 offset:39040
    ds_read_b64_tr_b16 a[0:1], v20 offset:39040
    ds_read_b64_tr_b16 a[2:3], v20 offset:39552
    ds_read_b64_tr_b16 a[4:5], v21 offset:39040
    ds_read_b64_tr_b16 a[6:7], v21 offset:39552
    ds_read_b64_tr_b16 a[8:9], v22 offset:39040
    ds_read_b64_tr_b16 a[10:11], v22 offset:39552
    ds_read_b64_tr_b16 a[12:13], v23 offset:39040
    ds_read_b64_tr_b16 a[14:15], v23 offset:39552
    ds_read_b64_tr_b16 a[16:17], v20 offset:47232
    ds_read_b64_tr_b16 a[18:19], v20 offset:47744
    ds_read_b64_tr_b16 a[20:21], v21 offset:47232
    ds_read_b64_tr_b16 a[22:23], v21 offset:47744
    ds_read_b64_tr_b16 a[24:25], v22 offset:47232
    ds_read_b64_tr_b16 a[26:27], v22 offset:47744
    s_waitcnt lgkmcnt(12)
    v_mfma_f32_16x16x32_bf16 v[28:31], a[0:3], v[116:119], v[28:31]
    ds_read_b64_tr_b16 a[28:29], v23 offset:47232
    ds_read_b64_tr_b16 a[30:31], v23 offset:47744
    s_waitcnt lgkmcnt(12)
    v_mfma_f32_16x16x32_bf16 v[32:35], a[4:7], v[116:119], v[32:35]
    ds_read_b64_tr_b16 a[48:49], v20 offset:43136
    ds_read_b64_tr_b16 a[50:51], v20 offset:43648
    s_waitcnt lgkmcnt(12)
    v_mfma_f32_16x16x32_bf16 v[36:39], a[8:11], v[116:119], v[36:39]
    ds_read_b64_tr_b16 a[52:53], v21 offset:43136
    ds_read_b64_tr_b16 a[54:55], v21 offset:43648
    s_waitcnt lgkmcnt(12)
    v_mfma_f32_16x16x32_bf16 v[40:43], a[12:15], v[116:119], v[40:43]
    ds_read_b64_tr_b16 a[56:57], v22 offset:43136
    ds_read_b64_tr_b16 a[58:59], v22 offset:43648
    s_waitcnt lgkmcnt(12)
    v_mfma_f32_16x16x32_bf16 v[44:47], a[16:19], a[120:123], v[44:47]
    ds_read_b64_tr_b16 a[60:61], v23 offset:43136
    ds_read_b64_tr_b16 a[62:63], v23 offset:43648
    s_waitcnt lgkmcnt(12)
    v_mfma_f32_16x16x32_bf16 v[48:51], a[20:23], a[120:123], v[48:51]
    ds_read_b64_tr_b16 a[64:65], v20 offset:51328
    ds_read_b64_tr_b16 a[66:67], v20 offset:51840
    s_waitcnt lgkmcnt(12)
    v_mfma_f32_16x16x32_bf16 v[52:55], a[24:27], a[120:123], v[52:55]
    ds_read_b64_tr_b16 a[68:69], v21 offset:51328
    ds_read_b64_tr_b16 a[70:71], v21 offset:51840
    s_waitcnt lgkmcnt(12)
    v_mfma_f32_16x16x32_bf16 v[56:59], a[28:31], a[120:123], v[56:59]
    ds_read_b64_tr_b16 a[72:73], v22 offset:51328
    ds_read_b64_tr_b16 a[74:75], v22 offset:51840
    s_waitcnt lgkmcnt(12)
    v_mfma_f32_16x16x32_bf16 v[28:31], a[48:51], v[116:119], v[28:31]
    ds_read_b64_tr_b16 a[76:77], v23 offset:51328
    ds_read_b64_tr_b16 a[78:79], v23 offset:51840
    s_waitcnt lgkmcnt(12)
    v_mfma_f32_16x16x32_bf16 v[32:35], a[52:55], v[116:119], v[32:35]
    s_waitcnt lgkmcnt(10)
    v_mfma_f32_16x16x32_bf16 v[36:39], a[56:59], v[116:119], v[36:39]
    s_waitcnt lgkmcnt(8)
    v_mfma_f32_16x16x32_bf16 v[40:43], a[60:63], v[116:119], v[40:43]
    s_waitcnt lgkmcnt(6)
    v_mfma_f32_16x16x32_bf16 v[44:47], a[64:67], a[124:127], v[44:47]
    s_waitcnt lgkmcnt(4)
    v_mfma_f32_16x16x32_bf16 v[48:51], a[68:71], a[124:127], v[48:51]
    s_waitcnt lgkmcnt(2)
    v_mfma_f32_16x16x32_bf16 v[52:55], a[72:75], a[124:127], v[52:55]
    s_waitcnt lgkmcnt(0)
    v_mfma_f32_16x16x32_bf16 v[56:59], a[76:79], a[124:127], v[56:59]
    s_mov_b32 exec_lo, 0x00010001
    s_mov_b32 exec_hi, 0x00010001
    ds_write_b128 v6, v[28:31] offset:0
    ds_write_b128 v6, v[32:35] offset:64
    ds_write_b128 v6, v[36:39] offset:128
    ds_write_b128 v6, v[40:43] offset:192
    ds_write_b128 v6, v[44:47] offset:256
    ds_write_b128 v6, v[48:51] offset:320
    ds_write_b128 v6, v[52:55] offset:384
    ds_write_b128 v6, v[56:59] offset:448
    ds_write_b32 v7, v7
    s_mov_b64 exec, -1
    ds_read_b128 v[76:79], v6 offset:256
    ds_read_b128 v[80:83], v6 offset:320
    ds_read_b128 v[84:87], v6 offset:384
    ds_read_b128 v[88:91], v6 offset:448
    s_waitcnt lgkmcnt(0)
    v_fmac_f32 v44, v76, v120
    v_fmac_f32 v45, v77, v120
    v_fmac_f32 v46, v78, v120
    v_fmac_f32 v47, v79, v120
    v_cvt_pk_bf16_f32 v44, v44, v45
    v_cvt_pk_bf16_f32 v45, v46, v47
    v_fmac_f32 v48, v80, v120
    v_fmac_f32 v49, v81, v120
    v_fmac_f32 v50, v82, v120
    v_fmac_f32 v51, v83, v120
    v_cvt_pk_bf16_f32 v46, v48, v49
    v_cvt_pk_bf16_f32 v47, v50, v51
    v_fmac_f32 v52, v84, v120
    v_fmac_f32 v53, v85, v120
    v_fmac_f32 v54, v86, v120
    v_fmac_f32 v55, v87, v120
    v_cvt_pk_bf16_f32 v48, v52, v53
    v_cvt_pk_bf16_f32 v49, v54, v55
    v_fmac_f32 v56, v88, v120
    v_fmac_f32 v57, v89, v120
    v_fmac_f32 v58, v90, v120
    v_fmac_f32 v59, v91, v120
    v_cvt_pk_bf16_f32 v50, v56, v57
    v_cvt_pk_bf16_f32 v51, v58, v59
    ds_write_b128 v125, v[44:47] offset:4096
    ds_write_b128 v125, v[48:51] offset:5120
    v_mov_b32 v5, 157972
    v_mov_b32 v6, 1
    s_mov_b64 exec, 1
    ds_add_u32 v5, v6
    s_mov_b64 exec, -1
    v_mov_b32 v5, 157980
Lcw_6:
    s_sub_u32 s35, s35, 1
    s_cbranch_scc1 Lend
    ds_read_b32 v6, v5
    s_waitcnt lgkmcnt(0)
    v_readfirstlane_b32 s38, v6
    s_nop 0
    s_cmp_lt_u32 s38, 1
    s_cbranch_scc1 Lcw_6
    ds_read_b64_tr_b16 a[0:1], v24 offset:16384
    ds_read_b64_tr_b16 a[2:3], v24 offset:16896
    ds_read_b64_tr_b16 a[4:5], v25 offset:16384
    ds_read_b64_tr_b16 a[6:7], v25 offset:16896
    ds_read_b64_tr_b16 a[8:9], v26 offset:16384
    ds_read_b64_tr_b16 a[10:11], v26 offset:16896
    ds_read_b64_tr_b16 a[12:13], v27 offset:16384
    ds_read_b64_tr_b16 a[14:15], v27 offset:16896
    ds_read_b64_tr_b16 a[16:17], v24 offset:20480
    ds_read_b64_tr_b16 a[18:19], v24 offset:20992
    ds_read_b64_tr_b16 a[20:21], v25 offset:20480
    ds_read_b64_tr_b16 a[22:23], v25 offset:20992
    ds_read_b64_tr_b16 a[24:25], v26 offset:20480
    ds_read_b64_tr_b16 a[26:27], v26 offset:20992
    ds_read_b64_tr_b16 a[28:29], v27 offset:20480
    ds_read_b64_tr_b16 a[30:31], v27 offset:20992
    ds_read_b64_tr_b16 a[32:33], v24 offset:55424
    ds_read_b64_tr_b16 a[34:35], v24 offset:55936
    ds_read_b64_tr_b16 a[36:37], v25 offset:55424
    ds_read_b64_tr_b16 a[38:39], v25 offset:55936
    ds_read_b64_tr_b16 a[40:41], v26 offset:55424
    ds_read_b64_tr_b16 a[42:43], v26 offset:55936
    ds_read_b64_tr_b16 a[44:45], v27 offset:55424
    ds_read_b64_tr_b16 a[46:47], v27 offset:55936
    ds_read_b64_tr_b16 a[48:49], v24 offset:59520
    ds_read_b64_tr_b16 a[50:51], v24 offset:60032
    ds_read_b64_tr_b16 a[52:53], v25 offset:59520
    ds_read_b64_tr_b16 a[54:55], v25 offset:60032
    ds_read_b64_tr_b16 a[56:57], v26 offset:59520
    ds_read_b64_tr_b16 a[58:59], v26 offset:60032
    ds_read_b64_tr_b16 a[60:61], v27 offset:59520
    ds_read_b64_tr_b16 a[62:63], v27 offset:60032
    ds_read_b64_tr_b16 a[64:65], v20 offset:16384
    ds_read_b64_tr_b16 a[66:67], v20 offset:16896
    ds_read_b64_tr_b16 a[68:69], v21 offset:16384
    ds_read_b64_tr_b16 a[70:71], v21 offset:16896
    ds_read_b64_tr_b16 a[72:73], v22 offset:16384
    ds_read_b64_tr_b16 a[74:75], v22 offset:16896
    ds_read_b64_tr_b16 a[76:77], v23 offset:16384
    ds_read_b64_tr_b16 a[78:79], v23 offset:16896
    ds_read_b64_tr_b16 a[80:81], v20 offset:20480
    ds_read_b64_tr_b16 a[82:83], v20 offset:20992
    ds_read_b64_tr_b16 a[84:85], v21 offset:20480
    ds_read_b64_tr_b16 a[86:87], v21 offset:20992
    ds_read_b64_tr_b16 a[88:89], v22 offset:20480
    ds_read_b64_tr_b16 a[90:91], v22 offset:20992
    ds_read_b64_tr_b16 a[92:93], v23 offset:20480
    ds_read_b64_tr_b16 a[94:95], v23 offset:20992
    s_waitcnt lgkmcnt(15)
    v_mfma_f32_16x16x32_bf16 v[60:63], a[96:99], a[0:3], v[60:63]
    v_mfma_f32_16x16x32_bf16 v[64:67], a[96:99], a[4:7], v[64:67]
    v_mfma_f32_16x16x32_bf16 v[68:71], a[96:99], a[8:11], v[68:71]
    v_mfma_f32_16x16x32_bf16 v[72:75], a[96:99], a[12:15], v[72:75]
    ds_read_b64_tr_b16 a[0:1], v20 offset:55424
    ds_read_b64_tr_b16 a[2:3], v20 offset:55936
    ds_read_b64_tr_b16 a[4:5], v21 offset:55424
    ds_read_b64_tr_b16 a[6:7], v21 offset:55936
    ds_read_b64_tr_b16 a[8:9], v22 offset:55424
    ds_read_b64_tr_b16 a[10:11], v22 offset:55936
    ds_read_b64_tr_b16 a[12:13], v23 offset:55424
    ds_read_b64_tr_b16 a[14:15], v23 offset:55936
    v_mfma_f32_16x16x32_bf16 v[60:63], a[100:103], a[16:19], v[60:63]
    v_mfma_f32_16x16x32_bf16 v[64:67], a[100:103], a[20:23], v[64:67]
    v_mfma_f32_16x16x32_bf16 v[68:71], a[100:103], a[24:27], v[68:71]
    v_mfma_f32_16x16x32_bf16 v[72:75], a[100:103], a[28:31], v[72:75]
    ds_read_b64_tr_b16 a[16:17], v20 offset:59520
    ds_read_b64_tr_b16 a[18:19], v20 offset:60032
    ds_read_b64_tr_b16 a[20:21], v21 offset:59520
    ds_read_b64_tr_b16 a[22:23], v21 offset:60032
    ds_read_b64_tr_b16 a[24:25], v22 offset:59520
    ds_read_b64_tr_b16 a[26:27], v22 offset:60032
    ds_read_b64_tr_b16 a[28:29], v23 offset:59520
    ds_read_b64_tr_b16 a[30:31], v23 offset:60032
    v_mfma_f32_16x16x32_bf16 v[60:63], a[104:107], a[32:35], v[60:63]
    v_mfma_f32_16x16x32_bf16 v[64:67], a[104:107], a[36:39], v[64:67]
    v_mfma_f32_16x16x32_bf16 v[68:71], a[104:107], a[40:43], v[68:71]
    v_mfma_f32_16x16x32_bf16 v[72:75], a[104:107], a[44:47], v[72:75]
    v_mfma_f32_16x16x32_bf16 v[60:63], a[108:111], a[48:51], v[60:63]
    v_mfma_f32_16x16x32_bf16 v[64:67], a[108:111], a[52:55], v[64:67]
    v_mfma_f32_16x16x32_bf16 v[68:71], a[108:111], a[56:59], v[68:71]
    v_mfma_f32_16x16x32_bf16 v[72:75], a[108:111], a[60:63], v[72:75]
    s_waitcnt lgkmcnt(15)
    v_mfma_f32_16x16x32_bf16 v[60:63], a[112:115], a[64:67], v[60:63]
    v_mfma_f32_16x16x32_bf16 v[64:67], a[112:115], a[68:71], v[64:67]
    v_mfma_f32_16x16x32_bf16 v[68:71], a[112:115], a[72:75], v[68:71]
    v_mfma_f32_16x16x32_bf16 v[72:75], a[112:115], a[76:79], v[72:75]
    v_mfma_f32_16x16x32_bf16 v[60:63], a[116:119], a[80:83], v[60:63]
    v_mfma_f32_16x16x32_bf16 v[64:67], a[116:119], a[84:87], v[64:67]
    v_mfma_f32_16x16x32_bf16 v[68:71], a[116:119], a[88:91], v[68:71]
    v_mfma_f32_16x16x32_bf16 v[72:75], a[116:119], a[92:95], v[72:75]
    s_waitcnt lgkmcnt(8)
    v_mfma_f32_16x16x32_bf16 v[60:63], a[120:123], a[0:3], v[60:63]
    v_mfma_f32_16x16x32_bf16 v[64:67], a[120:123], a[4:7], v[64:67]
    v_mfma_f32_16x16x32_bf16 v[68:71], a[120:123], a[8:11], v[68:71]
    v_mfma_f32_16x16x32_bf16 v[72:75], a[120:123], a[12:15], v[72:75]
    s_waitcnt lgkmcnt(0)
    v_mfma_f32_16x16x32_bf16 v[60:63], a[124:127], a[16:19], v[60:63]
    v_mfma_f32_16x16x32_bf16 v[64:67], a[124:127], a[20:23], v[64:67]
    v_mfma_f32_16x16x32_bf16 v[68:71], a[124:127], a[24:27], v[68:71]
    v_mfma_f32_16x16x32_bf16 v[72:75], a[124:127], a[28:31], v[72:75]
    v_lshlrev_b32 v5, 4, v3
    v_add_u32 v5, 157696, v5
    v_mov_b32 v6, 157952
    v_lshlrev_b32 v4, 4, v2
    v_add_u32 v4, 156224, v4
    v_lshl_add_u32 v125, v1, 3, s45
    s_mov_b64 exec, 0xffff
    ds_write_b32 v5, v60 offset:0
    ds_write_b32 v5, v64 offset:4
    ds_write_b32 v5, v68 offset:8
    ds_write_b32 v5, v72 offset:12
    ds_write_b32 v6, v6
    s_mov_b64 exec, -1
    ds_read_b128 v[36:39], v5
    ds_read_b128 v[28:31], v4
    ds_read_b128 v[32:35], v4 offset:512
    s_waitcnt lgkmcnt(0)
    v_fmac_f32 v60, v28, v36
    v_fmac_f32 v61, v29, v36
    v_fmac_f32 v62, v30, v36
    v_fmac_f32 v63, v31, v36
    v_mul_f32 v60, v60, v32
    v_mul_f32 v61, v61, v33
    v_mul_f32 v62, v62, v34
    v_mul_f32 v63, v63, v35
    v_cvt_pk_bf16_f32 v60, v60, v61
    v_cvt_pk_bf16_f32 v61, v62, v63
    ds_write_b64 v125, v[60:61] offset:0
    v_fmac_f32 v64, v28, v37
    v_fmac_f32 v65, v29, v37
    v_fmac_f32 v66, v30, v37
    v_fmac_f32 v67, v31, v37
    v_mul_f32 v64, v64, v32
    v_mul_f32 v65, v65, v33
    v_mul_f32 v66, v66, v34
    v_mul_f32 v67, v67, v35
    v_cvt_pk_bf16_f32 v64, v64, v65
    v_cvt_pk_bf16_f32 v65, v66, v67
    ds_write_b64 v125, v[64:65] offset:512
    v_fmac_f32 v68, v28, v38
    v_fmac_f32 v69, v29, v38
    v_fmac_f32 v70, v30, v38
    v_fmac_f32 v71, v31, v38
    v_mul_f32 v68, v68, v32
    v_mul_f32 v69, v69, v33
    v_mul_f32 v70, v70, v34
    v_mul_f32 v71, v71, v35
    v_cvt_pk_bf16_f32 v68, v68, v69
    v_cvt_pk_bf16_f32 v69, v70, v71
    ds_write_b64 v125, v[68:69] offset:1024
    v_fmac_f32 v72, v28, v39
    v_fmac_f32 v73, v29, v39
    v_fmac_f32 v74, v30, v39
    v_fmac_f32 v75, v31, v39
    v_mul_f32 v72, v72, v32
    v_mul_f32 v73, v73, v33
    v_mul_f32 v74, v74, v34
    v_mul_f32 v75, v75, v35
    v_cvt_pk_bf16_f32 v72, v72, v73
    v_cvt_pk_bf16_f32 v73, v74, v75
    ds_write_b64 v125, v[72:73] offset:1536
    v_mov_b32 v8, 157976
    v_mov_b32 v9, 1
    s_mov_b64 exec, 1
    ds_add_u32 v8, v9
    s_mov_b64 exec, -1
    s_branch Lagent
Lst_re:
    s_sub_u32 s35, s35, 1
    s_cbranch_scc1 Lend
    buffer_load_dwordx2 v[92:93], v96, s[28:31], s46 offen sc1
    buffer_load_dwordx2 v[94:95], v97, s[28:31], s46 offen sc1
    s_waitcnt vmcnt(0)
    s_branch Lst_chk
Laux:
    s_lshl_b32 s32, s37, 3
    s_lshl_b32 s39, s38, 2
    s_add_u32 s32, s32, s36
    s_cmp_lt_u32 s37, 4
    s_cselect_b32 s39, s39, 0
    s_add_u32 s32, s32, s39
    s_and_b32 s33, s2, 3
    s_lshl_b32 s33, s33, 3
    s_and_b32 s39, s2, 4
    s_add_u32 s33, s33, s39
    s_add_u32 s33, s33, s37
    s_cmp_ge_u32 s32, 32
    s_cbranch_scc1 Lmst
    v_lshrrev_b32 v5, 3, v1
    v_and_b32 v6, 7, v1
    s_lshl_b32 s40, s3, 14
    s_cmp_eq_u32 s27, 0
    s_cbranch_scc0 Laux_u
    s_lshl_b32 s36, s33, 6
    s_lshl_b32 s37, s26, 4
    s_add_u32 s36, s36, s37
    v_add_u32 v7, s36, v5
    v_mul_u32_u24 v7, 1280, v7
    v_xor_b32 v8, v6, v2
    v_lshl_add_u32 v92, v8, 4, v7
    v_add_u32 v92, 4096, v92
    v_xor_b32 v93, 64, v92
    v_add_u32 v93, 9216, v93
    v_subrev_u32 v94, 1920, v92
    v_subrev_u32 v95, 1920, v93
    s_waitcnt lgkmcnt(0)
    s_sub_u32 s52, s4, 4096
    s_subb_u32 s53, s5, 0
    s_mov_b32 s54, 2625536
    s_mov_b32 s55, 0x20000
    s_mov_b64 s[60:61], s[12:13]
    s_mov_b32 s62, 1280
    s_mov_b32 s63, 0x20000
    s_mov_b32 m0, 131072
    s_nop 0
    buffer_load_dwordx4 v13, s[60:63], 0 offen lds
    s_mov_b64 exec, 0xffff
    buffer_load_dwordx4 v13, s[60:63], 0 offen offset:1024 lds
    s_mov_b64 exec, -1
    s_add_u32 m0, s40, 0
    s_mov_b32 s41, 0
    buffer_load_dwordx4 v92, s[52:55], s41 offen lds
    buffer_load_dwordx4 v93, s[52:55], s41 offen offset:1024 lds
    buffer_load_dwordx4 v94, s[52:55], s41 offen offset:2048 lds
    buffer_load_dwordx4 v95, s[52:55], s41 offen offset:3072 lds
    s_add_u32 m0, s40, 4096
    s_mov_b32 s41, 256
    buffer_load_dwordx4 v92, s[52:55], s41 offen lds
    buffer_load_dwordx4 v93, s[52:55], s41 offen offset:1024 lds
    buffer_load_dwordx4 v94, s[52:55], s41 offen offset:2048 lds
    buffer_load_dwordx4 v95, s[52:55], s41 offen offset:3072 lds
    s_add_u32 m0, s40, 8192
    s_mov_b32 s41, 512
    buffer_load_dwordx4 v92, s[52:55], s41 offen lds
    buffer_load_dwordx4 v93, s[52:55], s41 offen offset:1024 lds
    buffer_load_dwordx4 v94, s[52:55], s41 offen offset:2048 lds
    buffer_load_dwordx4 v95, s[52:55], s41 offen offset:3072 lds
    s_add_u32 m0, s40, 12288
    s_mov_b32 s41, 768
    buffer_load_dwordx4 v92, s[52:55], s41 offen lds
    buffer_load_dwordx4 v93, s[52:55], s41 offen offset:1024 lds
    buffer_load_dwordx4 v94, s[52:55], s41 offen offset:2048 lds
    buffer_load_dwordx4 v95, s[52:55], s41 offen offset:3072 lds
    s_mov_b64 s[28:29], s[24:25]
    s_mov_b32 s30, 268435456
    s_mov_b32 s31, 0x20000
    s_load_dword s34, s[28:29], 0
    s_mov_b64 s[44:45], s[14:15]
    s_mov_b32 s46, 2211840
    s_mov_b32 s47, 0x20000
    s_mov_b64 s[48:49], s[18:19]
    s_mov_b32 s50, 2211840
    s_mov_b32 s51, 0x20000
    v_and_b32 v8, 1, v2
    v_lshlrev_b32 v8, 1, v8
    v_xor_b32 v8, v8, v6
    v_lshlrev_b32 v8, 4, v8
    v_mul_u32_u24 v9, 3456, v5
    s_lshl_b32 s38, s32, 7
    v_add3_u32 v18, v9, v8, s38
    v_xor_b32 v19, 64, v18
    v_add_u32 v19, 26624, v19
    v_add_u32 v20, 53248, v18
    v_add_u32 v21, 53248, v19
    s_mul_i32 s42, s26, 110592
    v_mul_u32_u24 v9, 1280, v5
    v_add_u32 v22, v9, v8
    v_xor_b32 v23, 64, v22
    v_add_u32 v23, 9216, v23
    v_add_u32 v24, 18432, v22
    v_add_u32 v25, 18432, v23
    s_mul_i32 s43, s32, 81920
    s_lshl_b32 s38, s3, 7
    s_add_u32 s43, s43, s38
    v_mov_b32 v96, 0x3f803f80
    v_mov_b32 v97, 0x3f803f80
    v_mov_b32 v98, 0x3f803f80
    v_mov_b32 v99, 0x3f803f80
    v_lshlrev_b32 v100, 4, v2
    v_add_u32 v100, 131072, v100
    v_lshrrev_b32 v10, 1, v3
    v_xor_b32 v10, v10, v2
    v_lshlrev_b32 v10, 4, v10
    v_lshl_add_u32 v10, v3, 7, v10
    v_add_u32 v102, s40, v10
    v_xor_b32 v103, 64, v102
    s_mov_b32 s58, 0xaaaaaaaa
    s_mov_b32 s59, 0xaaaaaaaa
    s_mov_b32 s64, 0xcccccccc
    s_mov_b32 s65, 0xcccccccc
    v_lshrrev_b32 v101, 2, v3
    v_lshl_add_u32 v101, v101, 4, v3
    v_lshlrev_b32 v101, 2, v101
    s_lshl_b32 s36, s26, 4
    v_add_u32 v10, s36, v3
    s_lshl_b32 s37, s33, 6
    s_sub_u32 s37, 2047, s37
    v_sub_u32 v106, s37, v10
    v_lshlrev_b32 v107, 2, v10
    v_add_u32 v107, 132608, v107
    s_lshl_b32 s36, s33, 9
    s_add_u32 s36, s36, 8192000
    v_lshl_add_u32 v108, v10, 3, s36
    v_bfe_u32 v10, v1, 2, 2
    v_and_b32 v8, 3, v1
    v_lshl_add_u32 v14, v2, 3, v10
    v_lshlrev_b32 v14, 7, v14
    v_lshlrev_b32 v9, 2, v1
    v_and_b32 v9, 0x60, v9
    v_add3_u32 v14, v14, v9, s40
    v_lshl_add_u32 v14, v8, 3, v14
    v_xor_b32 v15, 32, v14
    v_xor_b32 v16, 64, v14
    v_xor_b32 v17, 96, v14
    s_lshl_b32 s36, s26, 6
    s_add_u32 s36, s36, 141312
    v_lshl_add_u32 v26, v2, 4, s36
    v_min_u32 v8, 2, v3
    v_mul_u32_u24 v8, 1536, v8
    v_add_u32 v26, v26, v8
    v_add_u32 v4, 132864, v12
    v_mov_b32 v5, 0
    ds_write_b32 v4, v5
    s_waitcnt lgkmcnt(0)
    s_add_u32 s34, s34, 0x9e3779b8
    s_or_b32 s34, s34, 1
    s_waitcnt vmcnt(12)
    ds_read_b128 a[80:83], v102 offset:0
    ds_read_b128 a[84:87], v100 offset:0
    ds_read_b128 a[88:91], v103 offset:0
    ds_read_b128 a[92:95], v100 offset:64
    ds_read_b128 a[96:99], v102 offset:2048
    ds_read_b128 a[100:103], v100 offset:128
    ds_read_b128 a[104:107], v103 offset:2048
    ds_read_b128 a[108:111], v100 offset:192
    s_waitcnt lgkmcnt(0)
    s_add_u32 m0, s40, 0
    s_mov_b32 s41, 1024
    buffer_load_dwordx4 v92, s[52:55], s41 offen lds
    buffer_load_dwordx4 v93, s[52:55], s41 offen offset:1024 lds
    buffer_load_dwordx4 v94, s[52:55], s41 offen offset:2048 lds
    buffer_load_dwordx4 v95, s[52:55], s41 offen offset:3072 lds
    s_barrier
    v_mfma_f32_16x16x32_bf16 v[116:119], a[80:83], a[80:83], 0
    v_mfma_f32_16x16x32_bf16 v[112:115], v[96:99], a[80:83], 0
    v_mfma_f32_16x16x32_bf16 v[120:123], a[84:87], a[80:83], 0
    v_mfma_f32_16x16x32_bf16 v[124:127], a[84:87], v[96:99], 0
    v_mfma_f32_16x16x32_bf16 v[116:119], a[88:91], a[88:91], v[116:119]
    v_mfma_f32_16x16x32_bf16 v[112:115], v[96:99], a[88:91], v[112:115]
    v_mfma_f32_16x16x32_bf16 v[120:123], a[92:95], a[88:91], v[120:123]
    v_mfma_f32_16x16x32_bf16 v[124:127], a[92:95], v[96:99], v[124:127]
    v_mfma_f32_16x16x32_bf16 v[116:119], a[96:99], a[96:99], v[116:119]
    v_mfma_f32_16x16x32_bf16 v[112:115], v[96:99], a[96:99], v[112:115]
    v_mfma_f32_16x16x32_bf16 v[120:123], a[100:103], a[96:99], v[120:123]
    v_mfma_f32_16x16x32_bf16 v[124:127], a[100:103], v[96:99], v[124:127]
    v_mfma_f32_16x16x32_bf16 v[116:119], a[104:107], a[104:107], v[116:119]
    v_mfma_f32_16x16x32_bf16 v[112:115], v[96:99], a[104:107], v[112:115]
    v_mfma_f32_16x16x32_bf16 v[120:123], a[108:111], a[104:107], v[120:123]
    v_mfma_f32_16x16x32_bf16 v[124:127], a[108:111], v[96:99], v[124:127]
    s_waitcnt vmcnt(12)
    ds_read_b128 a[80:83], v102 offset:4096
    ds_read_b128 a[84:87], v100 offset:256
    ds_read_b128 a[88:91], v103 offset:4096
    ds_read_b128 a[92:95], v100 offset:320
    ds_read_b128 a[96:99], v102 offset:6144
    ds_read_b128 a[100:103], v100 offset:384
    ds_read_b128 a[104:107], v103 offset:6144
    ds_read_b128 a[108:111], v100 offset:448
    s_waitcnt lgkmcnt(0)
    v_mfma_f32_16x16x32_bf16 v[116:119], a[80:83], a[80:83], v[116:119]
    v_mfma_f32_16x16x32_bf16 v[112:115], v[96:99], a[80:83], v[112:115]
    v_mfma_f32_16x16x32_bf16 v[120:123], a[84:87], a[80:83], v[120:123]
    v_mfma_f32_16x16x32_bf16 v[124:127], a[84:87], v[96:99], v[124:127]
    v_mfma_f32_16x16x32_bf16 v[116:119], a[88:91], a[88:91], v[116:119]
    v_mfma_f32_16x16x32_bf16 v[112:115], v[96:99], a[88:91], v[112:115]
    v_mfma_f32_16x16x32_bf16 v[120:123], a[92:95], a[88:91], v[120:123]
    v_mfma_f32_16x16x32_bf16 v[124:127], a[92:95], v[96:99], v[124:127]
    v_mfma_f32_16x16x32_bf16 v[116:119], a[96:99], a[96:99], v[116:119]
    v_mfma_f32_16x16x32_bf16 v[112:115], v[96:99], a[96:99], v[112:115]
    v_mfma_f32_16x16x32_bf16 v[120:123], a[100:103], a[96:99], v[120:123]
    v_mfma_f32_16x16x32_bf16 v[124:127], a[100:103], v[96:99], v[124:127]
    v_mfma_f32_16x16x32_bf16 v[116:119], a[104:107], a[104:107], v[116:119]
    v_mfma_f32_16x16x32_bf16 v[112:115], v[96:99], a[104:107], v[112:115]
    v_mfma_f32_16x16x32_bf16 v[120:123], a[108:111], a[104:107], v[120:123]
    v_mfma_f32_16x16x32_bf16 v[124:127], a[108:111], v[96:99], v[124:127]
    s_waitcnt vmcnt(8)
    ds_read_b128 a[80:83], v102 offset:8192
    ds_read_b128 a[84:87], v100 offset:512
    ds_read_b128 a[88:91], v103 offset:8192
    ds_read_b128 a[92:95], v100 offset:576
    ds_read_b128 a[96:99], v102 offset:10240
    ds_read_b128 a[100:103], v100 offset:640
    ds_read_b128 a[104:107], v103 offset:10240
    ds_read_b128 a[108:111], v100 offset:704
    s_waitcnt lgkmcnt(0)
    v_mfma_f32_16x16x32_bf16 v[116:119], a[80:83], a[80:83], v[116:119]
    v_mfma_f32_16x16x32_bf16 v[112:115], v[96:99], a[80:83], v[112:115]
    v_mfma_f32_16x16x32_bf16 v[120:123], a[84:87], a[80:83], v[120:123]
    v_mfma_f32_16x16x32_bf16 v[124:127], a[84:87], v[96:99], v[124:127]
    v_mfma_f32_16x16x32_bf16 v[116:119], a[88:91], a[88:91], v[116:119]
    v_mfma_f32_16x16x32_bf16 v[112:115], v[96:99], a[88:91], v[112:115]
    v_mfma_f32_16x16x32_bf16 v[120:123], a[92:95], a[88:91], v[120:123]
    v_mfma_f32_16x16x32_bf16 v[124:127], a[92:95], v[96:99], v[124:127]
    v_mfma_f32_16x16x32_bf16 v[116:119], a[96:99], a[96:99], v[116:119]
    v_mfma_f32_16x16x32_bf16 v[112:115], v[96:99], a[96:99], v[112:115]
    v_mfma_f32_16x16x32_bf16 v[120:123], a[100:103], a[96:99], v[120:123]
    v_mfma_f32_16x16x32_bf16 v[124:127], a[100:103], v[96:99], v[124:127]
    v_mfma_f32_16x16x32_bf16 v[116:119], a[104:107], a[104:107], v[116:119]
    v_mfma_f32_16x16x32_bf16 v[112:115], v[96:99], a[104:107], v[112:115]
    v_mfma_f32_16x16x32_bf16 v[120:123], a[108:111], a[104:107], v[120:123]
    v_mfma_f32_16x16x32_bf16 v[124:127], a[108:111], v[96:99], v[124:127]
    s_waitcnt vmcnt(4)
    ds_read_b128 a[80:83], v102 offset:12288
    ds_read_b128 a[84:87], v100 offset:768
    ds_read_b128 a[88:91], v103 offset:12288
    ds_read_b128 a[92:95], v100 offset:832
    ds_read_b128 a[96:99], v102 offset:14336
    ds_read_b128 a[100:103], v100 offset:896
    ds_read_b128 a[104:107], v103 offset:14336
    ds_read_b128 a[108:111], v100 offset:960
    s_waitcnt lgkmcnt(0)
    v_mfma_f32_16x16x32_bf16 v[116:119], a[80:83], a[80:83], v[116:119]
    v_mfma_f32_16x16x32_bf16 v[112:115], v[96:99], a[80:83], v[112:115]
    v_mfma_f32_16x16x32_bf16 v[120:123], a[84:87], a[80:83], v[120:123]
    v_mfma_f32_16x16x32_bf16 v[124:127], a[84:87], v[96:99], v[124:127]
    v_mfma_f32_16x16x32_bf16 v[116:119], a[88:91], a[88:91], v[116:119]
    v_mfma_f32_16x16x32_bf16 v[112:115], v[96:99], a[88:91], v[112:115]
    v_mfma_f32_16x16x32_bf16 v[120:123], a[92:95], a[88:91], v[120:123]
    v_mfma_f32_16x16x32_bf16 v[124:127], a[92:95], v[96:99], v[124:127]
    v_mfma_f32_16x16x32_bf16 v[116:119], a[96:99], a[96:99], v[116:119]
    v_mfma_f32_16x16x32_bf16 v[112:115], v[96:99], a[96:99], v[112:115]
    v_mfma_f32_16x16x32_bf16 v[120:123], a[100:103], a[96:99], v[120:123]
    v_mfma_f32_16x16x32_bf16 v[124:127], a[100:103], v[96:99], v[124:127]
    v_mfma_f32_16x16x32_bf16 v[116:119], a[104:107], a[104:107], v[116:119]
    v_mfma_f32_16x16x32_bf16 v[112:115], v[96:99], a[104:107], v[112:115]
    v_mfma_f32_16x16x32_bf16 v[120:123], a[108:111], a[104:107], v[120:123]
    v_mfma_f32_16x16x32_bf16 v[124:127], a[108:111], v[96:99], v[124:127]
    s_waitcnt vmcnt(0)
    ds_read_b128 a[80:83], v102 offset:0
    ds_read_b128 a[84:87], v100 offset:1024
    ds_read_b128 a[88:91], v103 offset:0
    ds_read_b128 a[92:95], v100 offset:1088
    ds_read_b128 a[96:99], v102 offset:2048
    ds_read_b128 a[100:103], v100 offset:1152
    ds_read_b128 a[104:107], v103 offset:2048
    ds_read_b128 a[108:111], v100 offset:1216
    s_waitcnt lgkmcnt(0)
    v_mfma_f32_16x16x32_bf16 v[116:119], a[80:83], a[80:83], v[116:119]
    v_mfma_f32_16x16x32_bf16 v[112:115], v[96:99], a[80:83], v[112:115]
    v_mfma_f32_16x16x32_bf16 v[120:123], a[84:87], a[80:83], v[120:123]
    v_mfma_f32_16x16x32_bf16 v[124:127], a[84:87], v[96:99], v[124:127]
    v_mfma_f32_16x16x32_bf16 v[116:119], a[88:91], a[88:91], v[116:119]
    v_mfma_f32_16x16x32_bf16 v[112:115], v[96:99], a[88:91], v[112:115]
    v_mfma_f32_16x16x32_bf16 v[120:123], a[92:95], a[88:91], v[120:123]
    v_mfma_f32_16x16x32_bf16 v[124:127], a[92:95], v[96:99], v[124:127]
    v_mfma_f32_16x16x32_bf16 v[116:119], a[96:99], a[96:99], v[116:119]
    v_mfma_f32_16x16x32_bf16 v[112:115], v[96:99], a[96:99], v[112:115]
    v_mfma_f32_16x16x32_bf16 v[120:123], a[100:103], a[96:99], v[120:123]
    v_mfma_f32_16x16x32_bf16 v[124:127], a[100:103], v[96:99], v[124:127]
    v_mfma_f32_16x16x32_bf16 v[116:119], a[104:107], a[104:107], v[116:119]
    v_mfma_f32_16x16x32_bf16 v[112:115], v[96:99], a[104:107], v[112:115]
    v_mfma_f32_16x16x32_bf16 v[120:123], a[108:111], a[104:107], v[120:123]
    v_mfma_f32_16x16x32_bf16 v[124:127], a[108:111], v[96:99], v[124:127]
    s_nop 4
    v_cndmask_b32 v4, v116, v117, s[58:59]
    v_cndmask_b32 v5, v118, v119, s[58:59]
    v_cndmask_b32 v4, v4, v5, s[64:65]
    ds_bpermute_b32 v4, v101, v4
    v_mul_f32 v5, 0xbacccccd, v112
    v_cvt_pk_bf16_f32 v104, v5, v5
    v_lshlrev_b32 v104, 16, v104
    v_mul_f32 v5, v5, v5
    v_mov_b32 v6, 0x3acccccd
    s_waitcnt lgkmcnt(0)
    v_fma_f32 v4, v4, v6, -v5
    v_max_f32 v4, 0, v4
    v_cvt_pk_bf16_f32 v4, v4, v4
    v_lshlrev_b32 v4, 16, v4
    v_add_f32 v4, 0x3727c5ac, v4
    v_cvt_pk_bf16_f32 v4, v4, v4
    v_lshlrev_b32 v4, 16, v4
    v_sqrt_f32 v4, v4
    s_nop 0
    v_cvt_pk_bf16_f32 v4, v4, v4
    v_lshlrev_b32 v4, 16, v4
    v_rcp_f32 v105, v4
    v_lshrrev_b32 v8, 16, v4
    v_fma_f32 v4, v104, v124, v120
    v_mul_f32 v4, v4, v105
    v_cvt_pk_bf16_f32 v4, v4, v4
    v_ashrrev_i32 v5, 31, v4
    v_or_b32 v5, 0x80000000, v5
    v_xor_b32 v4, v4, v5
    v_and_b32 v4, 0xffff0000, v4
    v_or_b32 v4, v4, v106
    ds_write_b32 v107, v4
    v_mov_b32 v11, 132864
    v_mov_b32 v7, 1
    s_mov_b64 exec, 1
    ds_add_u32 v11, v7
    s_mov_b64 exec, -1
    v_or_b32 v8, v8, v104
    v_mov_b32 v9, s34
    s_mov_b64 exec, 0xffff
    buffer_store_dwordx2 v[8:9], v108, s[28:31], 0 offen sc1
    s_mov_b64 exec, -1
    s_cmp_lg_u32 s26, 0
    s_cbranch_scc1 Lpub_done
    s_setprio 3
Lcw_9:
    s_sub_u32 s35, s35, 1
    s_cbranch_scc1 Lend
    ds_read_b32 v7, v11
    s_waitcnt lgkmcnt(0)
    v_readfirstlane_b32 s38, v7
    s_nop 0
    s_cmp_lt_u32 s38, 4
    s_cbranch_scc1 Lcw_9
    v_add_u32 v5, 132608, v12
    ds_read_b32 v6, v5
    s_waitcnt lgkmcnt(0)
    v_mov_b32 v4, v6
    s_nop 1
    v_max_u32_dpp v4, v4, v4 row_ror:8 row_mask:0xf bank_mask:0xf
    s_nop 1
    v_max_u32_dpp v4, v4, v4 row_ror:4 row_mask:0xf bank_mask:0xf
    s_nop 1
    v_max_u32_dpp v4, v4, v4 row_ror:2 row_mask:0xf bank_mask:0xf
    s_nop 1
    v_max_u32_dpp v4, v4, v4 row_ror:1 row_mask:0xf bank_mask:0xf
    s_nop 0
    v_readlane_b32 s66, v4, 0
    v_readlane_b32 s36, v4, 16
    v_readlane_b32 s37, v4, 32
    v_readlane_b32 s38, v4, 48
    s_max_u32 s66, s66, s36
    s_max_u32 s37, s37, s38
    s_max_u32 s66, s66, s37
    v_cmp_eq_u32 vcc, s66, v6
    s_nop 1
    v_cndmask_b32 v4, v6, 0, vcc
    s_nop 1
    v_max_u32_dpp v4, v4, v4 row_ror:8 row_mask:0xf bank_mask:0xf
    s_nop 1
    v_max_u32_dpp v4, v4, v4 row_ror:4 row_mask:0xf bank_mask:0xf
    s_nop 1
    v_max_u32_dpp v4, v4, v4 row_ror:2 row_mask:0xf bank_mask:0xf
    s_nop 1
    v_max_u32_dpp v4, v4, v4 row_ror:1 row_mask:0xf bank_mask:0xf
    s_nop 0
    v_readlane_b32 s67, v4, 0
    v_readlane_b32 s36, v4, 16
    v_readlane_b32 s37, v4, 32
    v_readlane_b32 s38, v4, 48
    s_max_u32 s67, s67, s36
    s_max_u32 s37, s37, s38
    s_max_u32 s67, s67, s37
    v_mov_b32 v112, s66
    v_mov_b32 v113, s34
    v_mov_b32 v114, s67
    v_mov_b32 v115, s34
    s_lshl_b32 s36, s32, 7
    s_add_u32 s36, s36, 8126464
    s_mov_b64 exec, 0xff
    buffer_store_dwordx4 v[112:115], v13, s[28:31], s36 offen sc1
    s_mov_b64 exec, -1
    v_mov_b32 v11, 132864
    v_mov_b32 v7, 1
    s_mov_b64 exec, 1
    ds_add_u32 v11, v7
    s_mov_b64 exec, -1
    s_mov_b64 exec, 1
    s_lshl_b32 s36, s2, 2
    s_add_u32 s36, s36, 8323072
    v_mov_b32 v4, s34
    v_mov_b32 v5, s36
    buffer_store_dword v4, v5, s[28:31], 0 offen sc1
    s_mov_b64 exec, -1
    s_setprio 0
Lpub_done:
Lcw_10:
    s_sub_u32 s35, s35, 1
    s_cbranch_scc1 Lend
    ds_read_b32 v7, v11
    s_waitcnt lgkmcnt(0)
    v_readfirstlane_b32 s38, v7
    s_nop 0
    s_cmp_lt_u32 s38, 5
    s_cbranch_scc1 Lcw_10
    s_cmp_ge_u32 s32, 27
    s_cbranch_scc1 Lhelp_r
    s_add_u32 m0, s40, 0
    s_add_u32 s41, s42, 0
    buffer_load_dwordx4 v18, s[44:47], s41 offen nt lds
    buffer_load_dwordx4 v19, s[44:47], s41 offen offset:1024 nt lds
    buffer_load_dwordx4 v20, s[44:47], s41 offen offset:2048 nt lds
    buffer_load_dwordx4 v21, s[44:47], s41 offen offset:3072 nt lds
    s_add_u32 m0, s40, 4096
    s_add_u32 s41, s42, 442368
    buffer_load_dwordx4 v18, s[44:47], s41 offen nt lds
    buffer_load_dwordx4 v19, s[44:47], s41 offen offset:1024 nt lds
    buffer_load_dwordx4 v20, s[44:47], s41 offen offset:2048 nt lds
    buffer_load_dwordx4 v21, s[44:47], s41 offen offset:3072 nt lds
    s_add_u32 m0, s40, 8192
    s_add_u32 s41, s42, 884736
    buffer_load_dwordx4 v18, s[44:47], s41 offen nt lds
    buffer_load_dwordx4 v19, s[44:47], s41 offen offset:1024 nt lds
    buffer_load_dwordx4 v20, s[44:47], s41 offen offset:2048 nt lds
    buffer_load_dwordx4 v21, s[44:47], s41 offen offset:3072 nt lds
    s_add_u32 m0, s40, 12288
    s_add_u32 s41, s42, 1327104
    buffer_load_dwordx4 v18, s[44:47], s41 offen nt lds
    buffer_load_dwordx4 v19, s[44:47], s41 offen offset:1024 nt lds
    buffer_load_dwordx4 v20, s[44:47], s41 offen offset:2048 nt lds
    buffer_load_dwordx4 v21, s[44:47], s41 offen offset:3072 nt lds
    s_waitcnt vmcnt(12)
    ds_read_b64_tr_b16 a[0:1], v14 offset:0
    ds_read_b64_tr_b16 a[2:3], v14 offset:512
    ds_read_b64_tr_b16 a[4:5], v15 offset:0
    ds_read_b64_tr_b16 a[6:7], v15 offset:512
    ds_read_b64_tr_b16 a[8:9], v16 offset:0
    ds_read_b64_tr_b16 a[10:11], v16 offset:512
    ds_read_b64_tr_b16 a[12:13], v17 offset:0
    ds_read_b64_tr_b16 a[14:15], v17 offset:512
    s_waitcnt lgkmcnt(0)
    s_add_u32 m0, s40, 0
    s_add_u32 s41, s42, 1769472
    buffer_load_dwordx4 v18, s[44:47], s41 offen nt lds
    buffer_load_dwordx4 v19, s[44:47], s41 offen offset:1024 nt lds
    buffer_load_dwordx4 v20, s[44:47], s41 offen offset:2048 nt lds
    buffer_load_dwordx4 v21, s[44:47], s41 offen offset:3072 nt lds
    v_mov_b32 v11, 132864
    v_mov_b32 v7, 1
    s_mov_b64 exec, 1
    ds_add_u32 v11, v7
    s_mov_b64 exec, -1
    s_waitcnt vmcnt(12)
    ds_read_b64_tr_b16 a[16:17], v14 offset:4096
    ds_read_b64_tr_b16 a[18:19], v14 offset:4608
    ds_read_b64_tr_b16 a[20:21], v15 offset:4096
    ds_read_b64_tr_b16 a[22:23], v15 offset:4608
    ds_read_b64_tr_b16 a[24:25], v16 offset:4096
    ds_read_b64_tr_b16 a[26:27], v16 offset:4608
    ds_read_b64_tr_b16 a[28:29], v17 offset:4096
    ds_read_b64_tr_b16 a[30:31], v17 offset:4608
    s_waitcnt lgkmcnt(0)
    s_add_u32 m0, s40, 4096
    s_add_u32 s41, s43, 0
    buffer_load_dwordx4 v22, s[48:51], s41 offen nt lds
    buffer_load_dwordx4 v23, s[48:51], s41 offen offset:1024 nt lds
    buffer_load_dwordx4 v24, s[48:51], s41 offen offset:2048 nt lds
    buffer_load_dwordx4 v25, s[48:51], s41 offen offset:3072 nt lds
    s_waitcnt vmcnt(12)
    ds_read_b64_tr_b16 a[32:33], v14 offset:8192
    ds_read_b64_tr_b16 a[34:35], v14 offset:8704
    ds_read_b64_tr_b16 a[36:37], v15 offset:8192
    ds_read_b64_tr_b16 a[38:39], v15 offset:8704
    ds_read_b64_tr_b16 a[40:41], v16 offset:8192
    ds_read_b64_tr_b16 a[42:43], v16 offset:8704
    ds_read_b64_tr_b16 a[44:45], v17 offset:8192
    ds_read_b64_tr_b16 a[46:47], v17 offset:8704
    s_waitcnt lgkmcnt(0)
    s_add_u32 m0, s40, 8192
    s_add_u32 s41, s43, 40960
    buffer_load_dwordx4 v22, s[48:51], s41 offen nt lds
    buffer_load_dwordx4 v23, s[48:51], s41 offen offset:1024 nt lds
    buffer_load_dwordx4 v24, s[48:51], s41 offen offset:2048 nt lds
    buffer_load_dwordx4 v25, s[48:51], s41 offen offset:3072 nt lds
    s_waitcnt vmcnt(12)
    ds_read_b64_tr_b16 a[48:49], v14 offset:12288
    ds_read_b64_tr_b16 a[50:51], v14 offset:12800
    ds_read_b64_tr_b16 a[52:53], v15 offset:12288
    ds_read_b64_tr_b16 a[54:55], v15 offset:12800
    ds_read_b64_tr_b16 a[56:57], v16 offset:12288
    ds_read_b64_tr_b16 a[58:59], v16 offset:12800
    ds_read_b64_tr_b16 a[60:61], v17 offset:12288
    ds_read_b64_tr_b16 a[62:63], v17 offset:12800
    s_waitcnt vmcnt(8)
    ds_read_b64_tr_b16 a[64:65], v14 offset:0
    ds_read_b64_tr_b16 a[66:67], v14 offset:512
    ds_read_b64_tr_b16 a[68:69], v15 offset:0
    ds_read_b64_tr_b16 a[70:71], v15 offset:512
    ds_read_b64_tr_b16 a[72:73], v16 offset:0
    ds_read_b64_tr_b16 a[74:75], v16 offset:512
    ds_read_b64_tr_b16 a[76:77], v17 offset:0
    ds_read_b64_tr_b16 a[78:79], v17 offset:512
    s_branch Laux_mm
Laux_u:
    s_cmp_ge_u32 s32, 27
    s_cbranch_scc1 Lend
    v_and_b32 v8, 1, v2
    v_lshlrev_b32 v8, 1, v8
    v_xor_b32 v8, v8, v6
    v_lshlrev_b32 v8, 4, v8
    v_mul_u32_u24 v9, 3456, v5
    s_lshl_b32 s38, s32, 7
    v_add3_u32 v18, v9, v8, s38
    v_xor_b32 v19, 64, v18
    v_add_u32 v19, 26624, v19
    v_add_u32 v20, 53248, v18
    v_add_u32 v21, 53248, v19
    s_mul_i32 s42, s26, 110592
    v_mul_u32_u24 v9, 1280, v5
    v_add_u32 v22, v9, v8
    v_xor_b32 v23, 64, v22
    v_add_u32 v23, 9216, v23
    v_add_u32 v24, 18432, v22
    v_add_u32 v25, 18432, v23
    s_mul_i32 s43, s32, 81920
    s_lshl_b32 s38, s3, 7
    s_add_u32 s43, s43, s38
    s_waitcnt lgkmcnt(0)
    s_mov_b64 s[44:45], s[16:17]
    s_mov_b32 s46, 2211840
    s_mov_b32 s47, 0x20000
    s_mov_b64 s[28:29], s[24:25]
    s_mov_b32 s30, 268435456
    s_mov_b32 s31, 0x20000
    s_load_dword s34, s[28:29], 0
    s_mov_b64 s[52:53], s[4:5]
    s_mov_b32 s54, 2621440
    s_mov_b32 s55, 0x20000
    s_mov_b64 s[48:49], s[18:19]
    s_mov_b32 s50, 2211840
    s_mov_b32 s51, 0x20000
    s_mov_b64 s[68:69], s[18:19]
    s_mov_b32 s70, 2211840
    s_mov_b32 s71, 0x20000
    s_cmp_ge_u32 s26, 2
    s_cselect_b32 s70, 0, s70
    v_bfe_u32 v10, v1, 2, 2
    v_and_b32 v8, 3, v1
    v_lshl_add_u32 v14, v2, 3, v10
    v_lshlrev_b32 v14, 7, v14
    v_lshlrev_b32 v9, 2, v1
    v_and_b32 v9, 0x60, v9
    v_add3_u32 v14, v14, v9, s40
    v_lshl_add_u32 v14, v8, 3, v14
    v_xor_b32 v15, 32, v14
    v_xor_b32 v16, 64, v14
    v_xor_b32 v17, 96, v14
    s_lshl_b32 s36, s26, 6
    s_add_u32 s36, s36, 141312
    v_lshl_add_u32 v26, v2, 4, s36
    v_min_u32 v8, 2, v3
    v_mul_u32_u24 v8, 1536, v8
    v_add_u32 v26, v26, v8
    s_waitcnt lgkmcnt(0)
    s_add_u32 s34, s34, 0x9e3779b8
    s_or_b32 s34, s34, 1
    s_cmp_lg_u32 s3, 7
    s_cbranch_scc1 Lnop7
    s_setprio 3
Lnop7:
    s_barrier
    s_add_u32 m0, s40, 0
    s_add_u32 s41, s42, 0
    buffer_load_dwordx4 v18, s[44:47], s41 offen nt lds
    buffer_load_dwordx4 v19, s[44:47], s41 offen offset:1024 nt lds
    buffer_load_dwordx4 v20, s[44:47], s41 offen offset:2048 nt lds
    buffer_load_dwordx4 v21, s[44:47], s41 offen offset:3072 nt lds
    s_add_u32 m0, s40, 4096
    s_add_u32 s41, s42, 442368
    buffer_load_dwordx4 v18, s[44:47], s41 offen nt lds
    buffer_load_dwordx4 v19, s[44:47], s41 offen offset:1024 nt lds
    buffer_load_dwordx4 v20, s[44:47], s41 offen offset:2048 nt lds
    buffer_load_dwordx4 v21, s[44:47], s41 offen offset:3072 nt lds
    s_add_u32 m0, s40, 8192
    s_add_u32 s41, s42, 884736
    buffer_load_dwordx4 v18, s[44:47], s41 offen nt lds
    buffer_load_dwordx4 v19, s[44:47], s41 offen offset:1024 nt lds
    buffer_load_dwordx4 v20, s[44:47], s41 offen offset:2048 nt lds
    buffer_load_dwordx4 v21, s[44:47], s41 offen offset:3072 nt lds
    s_add_u32 m0, s40, 12288
    s_add_u32 s41, s42, 1327104
    buffer_load_dwordx4 v18, s[44:47], s41 offen nt lds
    buffer_load_dwordx4 v19, s[44:47], s41 offen offset:1024 nt lds
    buffer_load_dwordx4 v20, s[44:47], s41 offen offset:2048 nt lds
    buffer_load_dwordx4 v21, s[44:47], s41 offen offset:3072 nt lds
    v_mov_b32 v11, 132864
Lcw_11:
    s_sub_u32 s35, s35, 1
    s_cbranch_scc1 Lend
    s_sleep 4
    ds_read_b32 v7, v11
    s_waitcnt lgkmcnt(0)
    v_readfirstlane_b32 s38, v7
    s_nop 0
    s_cmp_lt_u32 s38, 5
    s_cbranch_scc1 Lcw_11
    s_waitcnt vmcnt(12)
    ds_read_b64_tr_b16 a[0:1], v14 offset:0
    ds_read_b64_tr_b16 a[2:3], v14 offset:512
    ds_read_b64_tr_b16 a[4:5], v15 offset:0
    ds_read_b64_tr_b16 a[6:7], v15 offset:512
    ds_read_b64_tr_b16 a[8:9], v16 offset:0
    ds_read_b64_tr_b16 a[10:11], v16 offset:512
    ds_read_b64_tr_b16 a[12:13], v17 offset:0
    ds_read_b64_tr_b16 a[14:15], v17 offset:512
    s_waitcnt lgkmcnt(0)
    s_add_u32 m0, s40, 0
    s_add_u32 s41, s42, 1769472
    buffer_load_dwordx4 v18, s[44:47], s41 offen nt lds
    buffer_load_dwordx4 v19, s[44:47], s41 offen offset:1024 nt lds
    buffer_load_dwordx4 v20, s[44:47], s41 offen offset:2048 nt lds
    buffer_load_dwordx4 v21, s[44:47], s41 offen offset:3072 nt lds
    s_waitcnt vmcnt(12)
    ds_read_b64_tr_b16 a[16:17], v14 offset:4096
    ds_read_b64_tr_b16 a[18:19], v14 offset:4608
    ds_read_b64_tr_b16 a[20:21], v15 offset:4096
    ds_read_b64_tr_b16 a[22:23], v15 offset:4608
    ds_read_b64_tr_b16 a[24:25], v16 offset:4096
    ds_read_b64_tr_b16 a[26:27], v16 offset:4608
    ds_read_b64_tr_b16 a[28:29], v17 offset:4096
    ds_read_b64_tr_b16 a[30:31], v17 offset:4608
    s_waitcnt vmcnt(8)
    ds_read_b64_tr_b16 a[32:33], v14 offset:8192
    ds_read_b64_tr_b16 a[34:35], v14 offset:8704
    ds_read_b64_tr_b16 a[36:37], v15 offset:8192
    ds_read_b64_tr_b16 a[38:39], v15 offset:8704
    ds_read_b64_tr_b16 a[40:41], v16 offset:8192
    ds_read_b64_tr_b16 a[42:43], v16 offset:8704
    ds_read_b64_tr_b16 a[44:45], v17 offset:8192
    ds_read_b64_tr_b16 a[46:47], v17 offset:8704
    s_waitcnt vmcnt(4)
    ds_read_b64_tr_b16 a[48:49], v14 offset:12288
    ds_read_b64_tr_b16 a[50:51], v14 offset:12800
    ds_read_b64_tr_b16 a[52:53], v15 offset:12288
    ds_read_b64_tr_b16 a[54:55], v15 offset:12800
    ds_read_b64_tr_b16 a[56:57], v16 offset:12288
    ds_read_b64_tr_b16 a[58:59], v16 offset:12800
    ds_read_b64_tr_b16 a[60:61], v17 offset:12288
    ds_read_b64_tr_b16 a[62:63], v17 offset:12800
    s_waitcnt vmcnt(0)
    ds_read_b64_tr_b16 a[64:65], v14 offset:0
    ds_read_b64_tr_b16 a[66:67], v14 offset:512
    ds_read_b64_tr_b16 a[68:69], v15 offset:0
    ds_read_b64_tr_b16 a[70:71], v15 offset:512
    ds_read_b64_tr_b16 a[72:73], v16 offset:0
    ds_read_b64_tr_b16 a[74:75], v16 offset:512
    ds_read_b64_tr_b16 a[76:77], v17 offset:0
    ds_read_b64_tr_b16 a[78:79], v17 offset:512
    s_cmp_lg_u32 s3, 7
    s_cbranch_scc1 Lnofx
    v_mov_b32 v92, 0x3f803f80
    v_mov_b32 v93, 0x3f803f80
    v_mov_b32 v94, 0x3f803f80
    v_mov_b32 v95, 0x3f803f80
    v_add_u32 v4, 144384, v13
    ds_write_b128 v4, v[92:95]
    ds_write_b128 v4, v[92:95] offset:1024
    v_and_b32 v120, 31, v1
    v_lshlrev_b32 v120, 7, v120
    v_add_u32 v120, 8126464, v120
Lpt_12:
    s_sub_u32 s35, s35, 1
    s_cbranch_scc1 Lend
    s_sleep 2
    buffer_load_dwordx4 v[124:127], v120, s[28:31], 0 offen sc1
    s_waitcnt vmcnt(0)
    v_cmp_ne_u32 vcc, s34, v125
    v_cmp_ne_u32 s[36:37], s34, v127
    s_nop 0
    s_or_b64 s[36:37], s[36:37], vcc
    s_cbranch_scc1 Lpt_12
    v_mov_b32 v120, v124
    s_nop 1
    v_max_u32_dpp v120, v120, v120 row_ror:8 row_mask:0xf bank_mask:0xf
    s_nop 1
    v_max_u32_dpp v120, v120, v120 row_ror:4 row_mask:0xf bank_mask:0xf
    s_nop 1
    v_max_u32_dpp v120, v120, v120 row_ror:2 row_mask:0xf bank_mask:0xf
    s_nop 1
    v_max_u32_dpp v120, v120, v120 row_ror:1 row_mask:0xf bank_mask:0xf
    s_nop 0
    v_readlane_b32 s56, v120, 0
    v_readlane_b32 s36, v120, 16
    v_readlane_b32 s37, v120, 32
    v_readlane_b32 s38, v120, 48
    s_max_u32 s56, s56, s36
    s_max_u32 s37, s37, s38
    s_max_u32 s56, s56, s37
    v_cmp_eq_u32 vcc, s56, v124
    s_nop 1
    v_cndmask_b32 v120, v124, v126, vcc
    s_nop 1
    v_max_u32_dpp v120, v120, v120 row_ror:8 row_mask:0xf bank_mask:0xf
    s_nop 1
    v_max_u32_dpp v120, v120, v120 row_ror:4 row_mask:0xf bank_mask:0xf
    s_nop 1
    v_max_u32_dpp v120, v120, v120 row_ror:2 row_mask:0xf bank_mask:0xf
    s_nop 1
    v_max_u32_dpp v120, v120, v120 row_ror:1 row_mask:0xf bank_mask:0xf
    s_nop 0
    v_readlane_b32 s57, v120, 0
    v_readlane_b32 s36, v120, 16
    v_readlane_b32 s37, v120, 32
    v_readlane_b32 s38, v120, 48
    s_max_u32 s57, s57, s36
    s_max_u32 s37, s37, s38
    s_max_u32 s57, s57, s37
    s_and_b32 s36, s56, 0x7ff
    s_sub_u32 s36, 2047, s36
    s_and_b32 s37, s57, 0x7ff
    s_sub_u32 s37, 2047, s37
    s_mul_i32 s38, s36, 1280
    s_mul_i32 s39, s37, 1280
    s_mov_b32 m0, 141312
    v_mov_b32 v4, s36
    buffer_load_dwordx4 v13, s[52:55], s38 offen lds
    s_mov_b32 m0, 142848
    v_mov_b32 v5, s37
    buffer_load_dwordx4 v13, s[52:55], s39 offen lds
    s_mov_b64 exec, 0xffff
    buffer_load_dwordx4 v13, s[52:55], s39 offen offset:1024 lds
    s_mov_b32 m0, 141312
    s_mov_b32 vcc_lo, 0xaaaaaaaa
    buffer_load_dwordx4 v13, s[52:55], s38 offen offset:1024 lds
    s_mov_b64 exec, 3
    v_cndmask_b32 v4, v4, v5, vcc
    v_lshlrev_b32 v118, 3, v4
    v_add_u32 v118, 8192000, v118
    v_add_u32 v9, 132872, v12
Lxs_chk:
    s_sub_u32 s35, s35, 1
    s_cbranch_scc1 Lend
    buffer_load_dwordx2 v[116:117], v118, s[28:31], 0 offen sc1
    s_waitcnt vmcnt(0)
    v_cmp_ne_u32 vcc, s34, v117
    s_nop 0
    s_cbranch_vccnz Lxs_chk
    ds_write_b32 v9, v116
    s_mov_b64 exec, -1
    v_mov_b32 v10, 132868
    v_mov_b32 v7, 1
    s_mov_b64 exec, 1
    ds_add_u32 v10, v7
    s_mov_b64 exec, -1
Lnofx:
Lcw_13:
    s_sub_u32 s35, s35, 1
    s_cbranch_scc1 Lend
    s_sleep 2
    ds_read_b32 v7, v11
    s_waitcnt lgkmcnt(0)
    v_readfirstlane_b32 s38, v7
    s_nop 0
    s_cmp_lt_u32 s38, 9
    s_cbranch_scc1 Lcw_13
    s_add_u32 m0, s40, 4096
    s_add_u32 s41, s43, 0
    buffer_load_dwordx4 v22, s[48:51], s41 offen nt lds
    buffer_load_dwordx4 v23, s[48:51], s41 offen offset:1024 nt lds
    buffer_load_dwordx4 v24, s[48:51], s41 offen offset:2048 nt lds
    buffer_load_dwordx4 v25, s[48:51], s41 offen offset:3072 nt lds
    s_add_u32 m0, s40, 8192
    s_add_u32 s41, s43, 40960
    buffer_load_dwordx4 v22, s[48:51], s41 offen nt lds
    buffer_load_dwordx4 v23, s[48:51], s41 offen offset:1024 nt lds
    buffer_load_dwordx4 v24, s[48:51], s41 offen offset:2048 nt lds
    buffer_load_dwordx4 v25, s[48:51], s41 offen offset:3072 nt lds
    s_add_u32 m0, s40, 12288
    s_add_u32 s41, s43, 512
    buffer_load_dwordx4 v22, s[68:71], s41 offen nt lds
    buffer_load_dwordx4 v23, s[68:71], s41 offen offset:1024 nt lds
    buffer_load_dwordx4 v24, s[68:71], s41 offen offset:2048 nt lds
    buffer_load_dwordx4 v25, s[68:71], s41 offen offset:3072 nt lds
    s_add_u32 m0, s40, 0
    s_add_u32 s41, s43, 41472
    buffer_load_dwordx4 v22, s[68:71], s41 offen nt lds
    buffer_load_dwordx4 v23, s[68:71], s41 offen offset:1024 nt lds
    buffer_load_dwordx4 v24, s[68:71], s41 offen offset:2048 nt lds
    buffer_load_dwordx4 v25, s[68:71], s41 offen offset:3072 nt lds
Laux_mm:
    v_mov_b32 v10, 132868
Lcw_14:
    s_sub_u32 s35, s35, 1
    s_cbranch_scc1 Lend
    s_sleep 1
    ds_read_b32 v7, v10
    s_waitcnt lgkmcnt(0)
    v_readfirstlane_b32 s38, v7
    s_nop 0
    s_cmp_lt_u32 s38, 1
    s_cbranch_scc1 Lcw_14
    ds_read_b128 v[92:95], v26 offset:0
    ds_read_b128 v[96:99], v26 offset:256
    ds_read_b128 v[100:103], v26 offset:512
    ds_read_b128 v[104:107], v26 offset:768
    ds_read_b128 v[108:111], v26 offset:1024
    ds_read_b64 v[116:117], v10 offset:4
    s_waitcnt lgkmcnt(0)
    v_readfirstlane_b32 s56, v116
    v_readfirstlane_b32 s57, v117
    v_mfma_f32_16x16x32_bf16 v[112:115], a[0:3], v[92:95], 0
    v_mfma_f32_16x16x32_bf16 v[116:119], a[4:7], v[92:95], 0
    v_mfma_f32_16x16x32_bf16 v[120:123], a[8:11], v[92:95], 0
    v_mfma_f32_16x16x32_bf16 v[124:127], a[12:15], v[92:95], 0
    v_mfma_f32_16x16x32_bf16 v[112:115], a[16:19], v[96:99], v[112:115]
    v_mfma_f32_16x16x32_bf16 v[116:119], a[20:23], v[96:99], v[116:119]
    v_mfma_f32_16x16x32_bf16 v[120:123], a[24:27], v[96:99], v[120:123]
    v_mfma_f32_16x16x32_bf16 v[124:127], a[28:31], v[96:99], v[124:127]
    v_mfma_f32_16x16x32_bf16 v[112:115], a[32:35], v[100:103], v[112:115]
    v_mfma_f32_16x16x32_bf16 v[116:119], a[36:39], v[100:103], v[116:119]
    v_mfma_f32_16x16x32_bf16 v[120:123], a[40:43], v[100:103], v[120:123]
    v_mfma_f32_16x16x32_bf16 v[124:127], a[44:47], v[100:103], v[124:127]
    v_mfma_f32_16x16x32_bf16 v[112:115], a[48:51], v[104:107], v[112:115]
    v_mfma_f32_16x16x32_bf16 v[116:119], a[52:55], v[104:107], v[116:119]
    v_mfma_f32_16x16x32_bf16 v[120:123], a[56:59], v[104:107], v[120:123]
    v_mfma_f32_16x16x32_bf16 v[124:127], a[60:63], v[104:107], v[124:127]
    v_mfma_f32_16x16x32_bf16 v[112:115], a[64:67], v[108:111], v[112:115]
    v_mfma_f32_16x16x32_bf16 v[116:119], a[68:71], v[108:111], v[116:119]
    v_mfma_f32_16x16x32_bf16 v[120:123], a[72:75], v[108:111], v[120:123]
    v_mfma_f32_16x16x32_bf16 v[124:127], a[76:79], v[108:111], v[124:127]
    s_mul_i32 s36, s3, 768
    s_add_u32 s36, s36, 133120
    v_lshlrev_b32 v4, 8, v3
    v_lshl_add_u32 v4, v2, 4, v4
    v_add_u32 v4, s36, v4
    v_add_u32 v5, 133120, v12
    s_lshl_b32 s37, s3, 8
    s_add_u32 s37, s37, 139264
    v_lshl_add_u32 v6, v1, 1, s37
    v_and_b32 v7, 1, v1
    v_lshlrev_b32 v7, 7, v7
    v_lshl_add_u32 v7, v2, 4, v7
    v_add_u32 v7, s37, v7
    s_lshl_b32 s38, s56, 16
    s_lshl_b32 s39, s57, 16
    v_rcp_f32 v8, s38
    v_rcp_f32 v9, s39
    s_and_b32 s56, s56, 0xffff0000
    s_and_b32 s57, s57, 0xffff0000
    s_mov_b32 exec_lo, 0x00070007
    s_mov_b32 exec_hi, 0x00070007
    ds_write_b128 v4, v[112:115] offset:0
    ds_write_b128 v4, v[116:119] offset:64
    ds_write_b128 v4, v[120:123] offset:128
    ds_write_b128 v4, v[124:127] offset:192
    s_mov_b64 exec, -1
    s_waitcnt lgkmcnt(0)
    s_barrier
    ds_read2st64_b32 v[92:93], v5 offset0:0 offset1:1
    ds_read2st64_b32 v[94:95], v5 offset0:2 offset1:3
    ds_read2st64_b32 v[96:97], v5 offset0:4 offset1:5
    ds_read2st64_b32 v[98:99], v5 offset0:6 offset1:7
    ds_read2st64_b32 v[100:101], v5 offset0:8 offset1:9
    ds_read2st64_b32 v[102:103], v5 offset0:10 offset1:11
    ds_read2st64_b32 v[116:117], v5 offset0:12 offset1:13
    ds_read2st64_b32 v[118:119], v5 offset0:14 offset1:15
    ds_read2st64_b32 v[120:121], v5 offset0:16 offset1:17
    ds_read2st64_b32 v[122:123], v5 offset0:18 offset1:19
    ds_read2st64_b32 v[124:125], v5 offset0:20 offset1:21
    ds_read2st64_b32 v[126:127], v5 offset0:22 offset1:23
    v_cmp_eq_u32 s[72:73], 1, v2
    v_cmp_eq_u32 s[74:75], 2, v2
    v_cmp_eq_u32 s[76:77], 3, v2
    s_mul_i32 s37, s32, 10
    s_add_u32 s37, s37, s3
    s_lshl_b32 s37, s37, 10
    s_add_u32 s37, s37, 7405568
    s_waitcnt lgkmcnt(0)
    v_add_f32 v92, v92, v95
    v_add_f32 v98, v98, v101
    v_add_f32 v92, v92, v98
    v_add_f32 v93, v93, v96
    v_add_f32 v99, v99, v102
    v_add_f32 v93, v93, v99
    v_add_f32 v94, v94, v97
    v_add_f32 v100, v100, v103
    v_add_f32 v94, v94, v100
    v_add_f32 v116, v116, v119
    v_add_f32 v122, v122, v125
    v_add_f32 v116, v116, v122
    v_add_f32 v117, v117, v120
    v_add_f32 v123, v123, v126
    v_add_f32 v117, v117, v123
    v_add_f32 v118, v118, v121
    v_add_f32 v124, v124, v127
    v_add_f32 v118, v118, v124
    v_fmac_f32 v92, s56, v94
    v_mul_f32 v112, v92, v8
    v_fmac_f32 v93, s57, v94
    v_mul_f32 v113, v93, v9
    v_fmac_f32 v116, s56, v118
    v_mul_f32 v120, v116, v8
    v_fmac_f32 v117, s57, v118
    v_mul_f32 v121, v117, v9
    v_cvt_pk_bf16_f32 v113, v112, v113
    v_lshlrev_b32 v112, 16, v113
    v_and_b32 v113, 0xffff0000, v113
    v_cvt_pk_bf16_f32 v121, v120, v121
    v_lshlrev_b32 v120, 16, v121
    v_and_b32 v121, 0xffff0000, v121
    v_mul_f32 v114, 0xbfb8aa3b, v112
    v_mul_f32 v115, 0xbfb8aa3b, v113
    v_exp_f32 v114, v114
    v_exp_f32 v115, v115
    v_add_f32 v114, 1.0, v114
    v_add_f32 v115, 1.0, v115
    v_rcp_f32 v114, v114
    v_rcp_f32 v115, v115
    v_mul_f32 v114, v114, v112
    v_mul_f32 v115, v115, v113
    v_cvt_pk_bf16_f32 v115, v114, v115
    v_lshlrev_b32 v114, 16, v115
    v_and_b32 v115, 0xffff0000, v115
    v_mul_f32 v114, v114, v120
    v_mul_f32 v115, v115, v121
    v_cvt_pk_bf16_f32 v114, v114, v115
    ds_write_b16 v6, v114
    ds_write_b16_d16_hi v6, v114 offset:128
    ds_read_b128 v[92:95], v7 offset:0
    ds_read_b128 v[96:99], v7 offset:64
    v_mov_b32 v101, s34
    v_mov_b32 v103, s34
    s_waitcnt vmcnt(0)
    ds_read_b64_tr_b16 v[28:29], v14 offset:4096
    ds_read_b64_tr_b16 v[30:31], v14 offset:4608
    ds_read_b64_tr_b16 v[32:33], v15 offset:4096
    ds_read_b64_tr_b16 v[34:35], v15 offset:4608
    ds_read_b64_tr_b16 v[36:37], v16 offset:4096
    ds_read_b64_tr_b16 v[38:39], v16 offset:4608
    ds_read_b64_tr_b16 v[40:41], v17 offset:4096
    ds_read_b64_tr_b16 v[42:43], v17 offset:4608
    ds_read_b64_tr_b16 v[44:45], v14 offset:8192
    ds_read_b64_tr_b16 v[46:47], v14 offset:8704
    ds_read_b64_tr_b16 v[48:49], v15 offset:8192
    ds_read_b64_tr_b16 v[50:51], v15 offset:8704
    ds_read_b64_tr_b16 v[52:53], v16 offset:8192
    ds_read_b64_tr_b16 v[54:55], v16 offset:8704
    ds_read_b64_tr_b16 v[56:57], v17 offset:8192
    ds_read_b64_tr_b16 v[58:59], v17 offset:8704
    s_waitcnt lgkmcnt(0)
    v_mfma_f32_16x16x32_bf16 v[112:115], v[92:95], v[28:31], 0
    v_mfma_f32_16x16x32_bf16 v[116:119], v[92:95], v[32:35], 0
    v_mfma_f32_16x16x32_bf16 v[120:123], v[92:95], v[36:39], 0
    v_mfma_f32_16x16x32_bf16 v[124:127], v[92:95], v[40:43], 0
    v_mfma_f32_16x16x32_bf16 v[112:115], v[96:99], v[44:47], v[112:115]
    v_mfma_f32_16x16x32_bf16 v[116:119], v[96:99], v[48:51], v[116:119]
    v_mfma_f32_16x16x32_bf16 v[120:123], v[96:99], v[52:55], v[120:123]
    v_mfma_f32_16x16x32_bf16 v[124:127], v[96:99], v[56:59], v[124:127]
    s_nop 5
    v_cndmask_b32 v100, v112, v116, s[72:73]
    v_cndmask_b32 v100, v100, v120, s[74:75]
    v_cndmask_b32 v100, v100, v124, s[76:77]
    v_cndmask_b32 v102, v113, v117, s[72:73]
    v_cndmask_b32 v102, v102, v121, s[74:75]
    v_cndmask_b32 v102, v102, v125, s[76:77]
    buffer_store_dwordx4 v[100:103], v13, s[28:31], s37 offen sc1
    s_sub_u32 s36, s3, 4
    s_cmp_ge_u32 s36, 2
    s_cbranch_scc1 Laux_end
    s_add_u32 s37, s37, 4096
    ds_read_b64_tr_b16 v[60:61], v14 offset:12288
    ds_read_b64_tr_b16 v[62:63], v14 offset:12800
    ds_read_b64_tr_b16 v[64:65], v15 offset:12288
    ds_read_b64_tr_b16 v[66:67], v15 offset:12800
    ds_read_b64_tr_b16 v[68:69], v16 offset:12288
    ds_read_b64_tr_b16 v[70:71], v16 offset:12800
    ds_read_b64_tr_b16 v[72:73], v17 offset:12288
    ds_read_b64_tr_b16 v[74:75], v17 offset:12800
    ds_read_b64_tr_b16 v[76:77], v14 offset:0
    ds_read_b64_tr_b16 v[78:79], v14 offset:512
    ds_read_b64_tr_b16 v[80:81], v15 offset:0
    ds_read_b64_tr_b16 v[82:83], v15 offset:512
    ds_read_b64_tr_b16 v[84:85], v16 offset:0
    ds_read_b64_tr_b16 v[86:87], v16 offset:512
    ds_read_b64_tr_b16 v[88:89], v17 offset:0
    ds_read_b64_tr_b16 v[90:91], v17 offset:512
    s_waitcnt lgkmcnt(0)
    v_mfma_f32_16x16x32_bf16 v[112:115], v[92:95], v[60:63], 0
    v_mfma_f32_16x16x32_bf16 v[116:119], v[92:95], v[64:67], 0
    v_mfma_f32_16x16x32_bf16 v[120:123], v[92:95], v[68:71], 0
    v_mfma_f32_16x16x32_bf16 v[124:127], v[92:95], v[72:75], 0
    v_mfma_f32_16x16x32_bf16 v[112:115], v[96:99], v[76:79], v[112:115]
    v_mfma_f32_16x16x32_bf16 v[116:119], v[96:99], v[80:83], v[116:119]
    v_mfma_f32_16x16x32_bf16 v[120:123], v[96:99], v[84:87], v[120:123]
    v_mfma_f32_16x16x32_bf16 v[124:127], v[96:99], v[88:91], v[124:127]
    s_nop 5
    v_cndmask_b32 v100, v112, v116, s[72:73]
    v_cndmask_b32 v100, v100, v120, s[74:75]
    v_cndmask_b32 v100, v100, v124, s[76:77]
    v_cndmask_b32 v102, v113, v117, s[72:73]
    v_cndmask_b32 v102, v102, v121, s[74:75]
    v_cndmask_b32 v102, v102, v125, s[76:77]
    buffer_store_dwordx4 v[100:103], v13, s[28:31], s37 offen sc1
Laux_end:
    s_endpgm
Lmst:
    s_cmp_lg_u32 s3, 0
    s_cbranch_scc1 Lhelp_i
    s_waitcnt lgkmcnt(0)
    s_mov_b64 s[28:29], s[24:25]
    s_mov_b32 s30, 268435456
    s_mov_b32 s31, 0x20000
    s_load_dword s34, s[28:29], 0
    s_waitcnt lgkmcnt(0)
    s_add_u32 s34, s34, 0x9e3779b8
    s_or_b32 s34, s34, 1
    s_mov_b64 exec, 1
    s_lshl_b32 s36, s2, 2
    s_add_u32 s36, s36, 8323072
    v_mov_b32 v4, s34
    v_mov_b32 v5, s36
    buffer_store_dword v4, v5, s[28:31], 0 offen sc1
    s_mov_b64 exec, -1
    s_cmp_lg_u32 s32, 32
    s_cbranch_scc1 Lend
Lmst_bc:
    v_and_b32 v4, 31, v1
    v_lshlrev_b32 v4, 7, v4
    v_add_u32 v4, 8126464, v4
Lpt_15:
    s_sub_u32 s35, s35, 1
    s_cbranch_scc1 Lend
    s_sleep 8
    buffer_load_dwordx4 v[8:11], v4, s[28:31], 0 offen sc1
    s_waitcnt vmcnt(0)
    v_cmp_ne_u32 vcc, s34, v9
    v_cmp_ne_u32 s[36:37], s34, v11
    s_nop 0
    s_or_b64 s[36:37], s[36:37], vcc
    s_cbranch_scc1 Lpt_15
    v_mov_b32 v4, v8
    s_nop 1
    v_max_u32_dpp v4, v4, v4 row_ror:8 row_mask:0xf bank_mask:0xf
    s_nop 1
    v_max_u32_dpp v4, v4, v4 row_ror:4 row_mask:0xf bank_mask:0xf
    s_nop 1
    v_max_u32_dpp v4, v4, v4 row_ror:2 row_mask:0xf bank_mask:0xf
    s_nop 1
    v_max_u32_dpp v4, v4, v4 row_ror:1 row_mask:0xf bank_mask:0xf
    s_nop 0
    v_readlane_b32 s40, v4, 0
    v_readlane_b32 s36, v4, 16
    v_readlane_b32 s37, v4, 32
    v_readlane_b32 s38, v4, 48
    s_max_u32 s40, s40, s36
    s_max_u32 s37, s37, s38
    s_max_u32 s40, s40, s37
    v_cmp_eq_u32 vcc, s40, v8
    s_nop 1
    v_cndmask_b32 v4, v8, v10, vcc
    s_nop 1
    v_max_u32_dpp v4, v4, v4 row_ror:8 row_mask:0xf bank_mask:0xf
    s_nop 1
    v_max_u32_dpp v4, v4, v4 row_ror:4 row_mask:0xf bank_mask:0xf
    s_nop 1
    v_max_u32_dpp v4, v4, v4 row_ror:2 row_mask:0xf bank_mask:0xf
    s_nop 1
    v_max_u32_dpp v4, v4, v4 row_ror:1 row_mask:0xf bank_mask:0xf
    s_nop 0
    v_readlane_b32 s41, v4, 0
    v_readlane_b32 s36, v4, 16
    v_readlane_b32 s37, v4, 32
    v_readlane_b32 s38, v4, 48
    s_max_u32 s41, s41, s36
    s_max_u32 s37, s37, s38
    s_max_u32 s41, s41, s37
    v_mov_b32 v8, s40
    v_mov_b32 v9, s34
    v_mov_b32 v10, s41
    v_mov_b32 v11, s34
    s_mov_b32 s36, 8257536
    buffer_store_dwordx4 v[8:11], v13, s[28:31], s36 offen offset:0 sc1
    buffer_store_dwordx4 v[8:11], v13, s[28:31], s36 offen offset:1024 sc1
    buffer_store_dwordx4 v[8:11], v13, s[28:31], s36 offen offset:2048 sc1
    s_mov_b32 s36, 8323072
Lmaster:
    s_sub_u32 s35, s35, 1
    s_cbranch_scc1 Lend
    s_sleep 16
    buffer_load_dwordx4 v[4:7], v13, s[28:31], s36 offen sc1
    s_waitcnt vmcnt(0)
    v_xor_b32 v4, s34, v4
    v_xor_b32 v5, s34, v5
    v_xor_b32 v6, s34, v6
    v_xor_b32 v7, s34, v7
    v_or3_b32 v4, v4, v5, v6
    v_or_b32 v4, v4, v7
    v_cmp_ne_u32 vcc, 0, v4
    s_nop 0
    s_cbranch_vccnz Lmaster
    s_mov_b64 exec, 1
    buffer_store_dword v9, v4, s[28:31], 0 offen sc1
    s_endpgm
Lhelp_r:
    s_sub_u32 s72, s32, 27
    s_add_u32 s72, s72, 27
    s_mov_b32 s73, 5
    s_mov_b32 s37, 4
    s_branch Lhelp
Lhelp_i:
    s_cmp_eq_u32 s32, 32
    s_cbranch_scc1 Lend
    s_cmp_eq_u32 s27, 0
    s_cbranch_scc1 Lend
    s_sub_u32 s72, s32, 33
    s_mov_b32 s73, 3
    s_mov_b32 s37, 9
Lhelp:
    s_lshl_b32 s38, s26, 6
    v_add_u32 v4, s38, v1
    v_mul_u32_u24 v4, 1280, v4
    s_waitcnt lgkmcnt(0)
    s_mov_b64 s[68:69], s[18:19]
    s_mov_b32 s70, 2211840
    s_mov_b32 s71, 0x20000
Lhelp2:
    s_mul_i32 s38, s72, 9363
    s_lshr_b32 s38, s38, 16
    s_mul_i32 s39, s38, 7
    s_sub_u32 s39, s72, s39
    s_mul_i32 s39, s39, 327680
    s_lshl_b32 s38, s38, 7
    s_sub_u32 s39, s39, s38
    s_add_u32 s39, s39, 1152
    v_add_u32 v6, s39, v4
    buffer_load_dword v5, v6, s[68:71], 0 offen
    s_add_u32 s72, s72, s73
    s_sub_u32 s37, s37, 1
    s_cmp_lg_u32 s37, 0
    s_cbranch_scc1 Lhelp2
Lend:
    s_endpgm
.section .rodata,"a"
.p2align 6
.amdhsa_kernel recurrent_scan__sliding_local_dilated__moe_arch_mod__prompt_kernel
  .amdhsa_next_free_vgpr 256
  .amdhsa_next_free_sgpr 102
  .amdhsa_accum_offset 128
  .amdhsa_group_segment_fixed_size 0
  .amdhsa_kernarg_size 88
  .amdhsa_user_sgpr_count 2
  .amdhsa_user_sgpr_kernarg_segment_ptr 1
  .amdhsa_system_sgpr_workgroup_id_x 1
  .amdhsa_float_denorm_mode_32 3
.end_amdhsa_kernel
```

```asm
; @launch grid=(256,1,1) block=(512,1,1) lds=163840
.amdgcn_target "amdgcn-amd-amdhsa--gfx950"
.text
.globl recurrent_scan__sliding_local_dilated__moe_arch_mod__prompt_kernel
.p2align 8
.type recurrent_scan__sliding_local_dilated__moe_arch_mod__prompt_kernel,@function
recurrent_scan__sliding_local_dilated__moe_arch_mod__prompt_kernel:
    s_load_dwordx16 s[4:19], s[0:1], 0
    s_load_dwordx4 s[20:23], s[0:1], 64
    s_load_dwordx2 s[24:25], s[0:1], 80
    v_lshrrev_b32 v4, 6, v0
    v_and_b32 v1, 63, v0
    s_cmp_ge_u32 s2, 256
    s_cbranch_scc1 Lend
    v_readfirstlane_b32 s3, v4
    s_getpc_b64 s[36:37]
Lpc:
    s_and_b32 s38, s2, 0xf8
    v_add_u32 v5, s38, v4
    v_and_b32 v6, 1, v0
    v_lshl_add_u32 v5, v5, 1, v6
    v_lshlrev_b32 v5, 7, v5
    v_min_u32 v5, Lend-Lpc, v5
    v_mov_b32 v7, s37
    v_add_co_u32 v6, vcc, s36, v5
    s_nop 1
    v_addc_co_u32 v7, vcc, 0, v7, vcc
    global_load_dword v0, v[6:7], off
    v_lshrrev_b32 v2, 4, v1
    v_and_b32 v3, 15, v1
    v_lshlrev_b32 v12, 2, v1
    v_lshlrev_b32 v13, 4, v1
    s_mov_b32 s35, 2000000
    s_and_b32 s36, s2, 7
    s_lshr_b32 s37, s2, 3
    s_and_b32 s38, s36, 1
    s_lshr_b32 s36, s36, 1
    s_add_u32 s39, s38, 4
    s_and_b32 s26, s3, 3
    s_lshr_b32 s27, s3, 2
    s_cmp_lt_u32 s37, s39
    s_cbranch_scc1 Laux
    s_lshr_b32 s33, s36, 1
    s_and_b32 s36, s36, 1
    s_mul_i32 s36, s36, 55
    s_mul_i32 s38, s38, 28
    s_add_u32 s36, s36, s38
    s_add_u32 s36, s36, s37
    s_sub_u32 s36, s36, s39
    s_mul_i32 s32, s36, 13108
    s_lshr_b32 s32, s32, 16
    s_mul_i32 s37, s32, 5
    s_sub_u32 s36, s36, s37
    s_mul_i32 s33, s33, 5
    s_add_u32 s33, s33, s36
    s_add_u32 s42, s33, s32
    s_mul_i32 s36, s42, 13108
    s_lshr_b32 s36, s36, 16
    s_mul_i32 s36, s36, 5
    s_sub_u32 s42, s42, s36
    s_and_b32 s43, s2, 7
    s_lshl_b32 s43, s43, 2
    s_lshr_b32 s43, 0x30858530, s43
    s_and_b32 s43, s43, 15
    s_cmp_lg_u32 s3, 0
    s_cbranch_scc1 Lcomp
Lloader:
    s_setprio 3
    v_lshrrev_b32 v5, 3, v1
    v_and_b32 v6, 7, v1
    v_and_b32 v8, 1, v2
    v_lshlrev_b32 v8, 1, v8
    v_xor_b32 v8, v8, v6
    s_lshl_b32 s39, s33, 7
    v_lshl_add_u32 v50, v8, 4, s39
    v_mov_b32 v7, 3840
    v_mad_u32_u24 v28, v5, v7, v50
    v_xor_b32 v29, 64, v28
    v_add_u32 v29, 29696, v29
    v_add_u32 v30, 59392, v28
    v_add_u32 v31, 59392, v29
    v_add_u32 v32, 122880, v28
    v_add_u32 v33, 122880, v29
    v_add_u32 v34, 182272, v28
    v_add_u32 v35, 182272, v29
    s_lshl_b32 s79, s42, 2
    s_lshr_b32 s79, 0x11000, s79
    s_and_b32 s79, s79, 15
    s_add_u32 s79, s79, s43
    s_sub_u32 s38, s79, 10
    s_cmp_ge_u32 s79, 10
    s_cselect_b32 s79, s38, s79
    s_mul_i32 s68, s79, 245760
    s_lshl_b32 s78, s79, 7
    s_waitcnt lgkmcnt(0)
    s_mov_b64 s[48:49], s[6:7]
    s_mov_b32 s50, 2457600
    s_mov_b32 s51, 0x20000
    s_add_u32 s52, s6, 1280
    s_addc_u32 s53, s7, 0
    s_mov_b32 s54, 2456320
    s_mov_b32 s55, 0x20000
    s_add_u32 s56, s6, 2560
    s_addc_u32 s57, s7, 0
    s_mov_b32 s58, 2455040
    s_mov_b32 s59, 0x20000
    s_lshr_b32 s69, 10, s42
    s_and_b32 s69, s69, 1
    s_mul_i32 s70, s69, 122880
    s_sub_u32 s71, 122880, s70
    s_add_u32 s70, s70, s68
    s_add_u32 s71, s71, s68
    s_lshl_b32 s72, s69, 12
    s_xor_b32 s73, s72, 4096
    s_add_u32 m0, s72, 0
    s_mul_i32 s38, s32, 96
    s_sub_u32 s38, s38, 16
    v_add_u32 v7, s38, v5
    v_xor_b32 v9, v6, v2
    v_lshlrev_b32 v9, 4, v9
    buffer_load_dwordx4 v28, s[48:51], s70 offen lds
    v_xor_b32 v10, 64, v9
    v_mov_b32 v11, 2052
    v_mov_b32 v8, 1280
    v_add_u32 v36, 0, v7
    buffer_load_dwordx4 v29, s[48:51], s70 offen offset:1024 lds
    v_med3_i32 v36, v36, 0, v11
    v_mad_u32_u24 v36, v36, v8, v9
    v_add_u32 v36, 4096, v36
    v_add_u32 v37, 8, v7
    buffer_load_dwordx4 v30, s[48:51], s70 offen offset:2048 lds
    v_med3_i32 v37, v37, 0, v11
    v_mad_u32_u24 v37, v37, v8, v10
    v_add_u32 v37, 3072, v37
    v_add_u32 v38, 16, v7
    v_med3_i32 v38, v38, 0, v11
    buffer_load_dwordx4 v31, s[48:51], s70 offen offset:3072 lds
    v_mad_u32_u24 v38, v38, v8, v9
    v_add_u32 v38, 2048, v38
    v_add_u32 v39, 24, v7
    v_med3_i32 v39, v39, 0, v11
    s_add_u32 m0, s72, 8192
    v_mad_u32_u24 v39, v39, v8, v10
    v_add_u32 v39, 1024, v39
    v_add_u32 v40, 32, v7
    v_med3_i32 v40, v40, 0, v11
    buffer_load_dwordx4 v28, s[52:55], s70 offen lds
    v_mad_u32_u24 v40, v40, v8, v9
    v_add_u32 v40, 4096, v40
    v_add_u32 v41, 40, v7
    v_med3_i32 v41, v41, 0, v11
    v_mad_u32_u24 v41, v41, v8, v10
    buffer_load_dwordx4 v29, s[52:55], s70 offen offset:1024 lds
    v_add_u32 v41, 3072, v41
    v_add_u32 v42, 48, v7
    v_med3_i32 v42, v42, 0, v11
    v_mad_u32_u24 v42, v42, v8, v9
    buffer_load_dwordx4 v30, s[52:55], s70 offen offset:2048 lds
    v_add_u32 v42, 2048, v42
    v_add_u32 v43, 56, v7
    v_med3_i32 v43, v43, 0, v11
    v_mad_u32_u24 v43, v43, v8, v10
    buffer_load_dwordx4 v31, s[52:55], s70 offen offset:3072 lds
    v_add_u32 v43, 1024, v43
    v_add_u32 v44, 64, v7
    v_med3_i32 v44, v44, 0, v11
    v_mad_u32_u24 v44, v44, v8, v9
    v_add_u32 v44, 4096, v44
    s_add_u32 m0, s72, 16384
    v_add_u32 v45, 72, v7
    v_med3_i32 v45, v45, 0, v11
    v_mad_u32_u24 v45, v45, v8, v10
    v_add_u32 v45, 3072, v45
    buffer_load_dwordx4 v28, s[56:59], s70 offen lds
    v_add_u32 v46, 80, v7
    v_med3_i32 v46, v46, 0, v11
    v_mad_u32_u24 v46, v46, v8, v9
    v_add_u32 v46, 2048, v46
    buffer_load_dwordx4 v29, s[56:59], s70 offen offset:1024 lds
    v_add_u32 v47, 88, v7
    v_med3_i32 v47, v47, 0, v11
    v_mad_u32_u24 v47, v47, v8, v10
    v_add_u32 v47, 1024, v47
    v_add_u32 v48, 96, v7
    buffer_load_dwordx4 v30, s[56:59], s70 offen offset:2048 lds
    v_med3_i32 v48, v48, 0, v11
    v_mad_u32_u24 v48, v48, v8, v9
    v_add_u32 v48, 4096, v48
    v_add_u32 v49, 104, v7
    buffer_load_dwordx4 v31, s[56:59], s70 offen offset:3072 lds
    v_med3_i32 v49, v49, 0, v11
    v_mad_u32_u24 v49, v49, v8, v10
    v_add_u32 v49, 3072, v49
    s_sub_u32 s44, s4, 4096
    s_subb_u32 s45, s5, 0
    s_mov_b32 s46, 2625536
    s_mov_b32 s47, 0x20000
    s_mov_b32 m0, 24576
    s_nop 0
    buffer_load_dwordx4 v36, s[44:47], s78 offen lds
    buffer_load_dwordx4 v37, s[44:47], s78 offen offset:1024 lds
    buffer_load_dwordx4 v38, s[44:47], s78 offen offset:2048 lds
    buffer_load_dwordx4 v39, s[44:47], s78 offen offset:3072 lds
    s_mov_b32 m0, 28672
    s_nop 0
    buffer_load_dwordx4 v40, s[44:47], s78 offen lds
    buffer_load_dwordx4 v41, s[44:47], s78 offen offset:1024 lds
    buffer_load_dwordx4 v42, s[44:47], s78 offen offset:2048 lds
    buffer_load_dwordx4 v43, s[44:47], s78 offen offset:3072 lds
    s_mov_b32 m0, 32768
    s_nop 0
    buffer_load_dwordx4 v44, s[44:47], s78 offen lds
    buffer_load_dwordx4 v45, s[44:47], s78 offen offset:1024 lds
    buffer_load_dwordx4 v46, s[44:47], s78 offen offset:2048 lds
    buffer_load_dwordx4 v47, s[44:47], s78 offen offset:3072 lds
    s_mov_b32 m0, 36864
    s_nop 0
    buffer_load_dwordx4 v48, s[44:47], s78 offen lds
    buffer_load_dwordx4 v49, s[44:47], s78 offen offset:1024 lds
    s_add_u32 m0, s73, 0
    s_nop 0
    buffer_load_dwordx4 v28, s[48:51], s71 offen lds
    buffer_load_dwordx4 v29, s[48:51], s71 offen offset:1024 lds
    buffer_load_dwordx4 v30, s[48:51], s71 offen offset:2048 lds
    buffer_load_dwordx4 v31, s[48:51], s71 offen offset:3072 lds
    s_add_u32 m0, s73, 8192
    s_nop 0
    buffer_load_dwordx4 v28, s[52:55], s71 offen lds
    buffer_load_dwordx4 v29, s[52:55], s71 offen offset:1024 lds
    buffer_load_dwordx4 v30, s[52:55], s71 offen offset:2048 lds
    buffer_load_dwordx4 v31, s[52:55], s71 offen offset:3072 lds
    s_add_u32 m0, s73, 16384
    s_nop 0
    buffer_load_dwordx4 v28, s[56:59], s71 offen lds
    buffer_load_dwordx4 v29, s[56:59], s71 offen offset:1024 lds
    buffer_load_dwordx4 v30, s[56:59], s71 offen offset:2048 lds
    buffer_load_dwordx4 v31, s[56:59], s71 offen offset:3072 lds
    s_mov_b32 s80, 0x86542310
    s_mov_b32 s81, 0x97
    s_cmp_eq_u32 s42, 1
    s_cselect_b32 s80, 0x76453210, s80
    s_cselect_b32 s81, 0x98, s81
    s_cmp_eq_u32 s42, 2
    s_cselect_b32 s80, 0x67543120, s80
    s_cselect_b32 s81, 0x98, s81
    s_cmp_eq_u32 s42, 3
    s_cselect_b32 s80, 0x76534201, s80
    s_cselect_b32 s81, 0x89, s81
    s_cmp_eq_u32 s42, 4
    s_cselect_b32 s80, 0x75643201, s80
    s_cselect_b32 s81, 0x98, s81
    s_lshr_b64 s[80:81], s[80:81], 4
    s_and_b32 s79, s80, 15
    s_add_u32 s79, s79, s43
    s_sub_u32 s38, s79, 10
    s_cmp_ge_u32 s79, 10
    s_cselect_b32 s79, s38, s79
    s_mov_b64 s[28:29], s[24:25]
    s_mov_b32 s30, 268435456
    s_mov_b32 s31, 0x20000
    s_load_dword s34, s[28:29], 0
    s_mov_b64 s[60:61], s[8:9]
    s_mov_b32 s62, 819200
    s_mov_b32 s63, 0x20000
    v_mov_b32 v51, 157984
    v_and_b32 v66, 7, v1
    v_max_u32 v66, 1, v66
    v_lshlrev_b32 v66, 2, v66
    v_add_u32 v66, 158016, v66
    s_mul_i32 s69, s79, 245760
    s_lshl_b32 s78, s79, 7
    s_mov_b32 m0, 63616
    s_nop 0
    buffer_load_dwordx4 v36, s[44:47], s78 offen lds
    buffer_load_dwordx4 v37, s[44:47], s78 offen offset:1024 lds
    buffer_load_dwordx4 v38, s[44:47], s78 offen offset:2048 lds
    buffer_load_dwordx4 v39, s[44:47], s78 offen offset:3072 lds
    s_mov_b32 m0, 39040
    s_nop 0
    buffer_load_dwordx4 v28, s[48:51], s69 offen lds
    buffer_load_dwordx4 v29, s[48:51], s69 offen offset:1024 lds
    buffer_load_dwordx4 v30, s[48:51], s69 offen offset:2048 lds
    buffer_load_dwordx4 v31, s[48:51], s69 offen offset:3072 lds
    s_mov_b32 m0, 67712
    s_nop 0
    buffer_load_dwordx4 v40, s[44:47], s78 offen lds
    buffer_load_dwordx4 v41, s[44:47], s78 offen offset:1024 lds
    buffer_load_dwordx4 v42, s[44:47], s78 offen offset:2048 lds
    buffer_load_dwordx4 v43, s[44:47], s78 offen offset:3072 lds
    s_mov_b32 m0, 47232
    s_nop 0
    buffer_load_dwordx4 v28, s[52:55], s69 offen lds
    buffer_load_dwordx4 v29, s[52:55], s69 offen offset:1024 lds
    buffer_load_dwordx4 v30, s[52:55], s69 offen offset:2048 lds
    buffer_load_dwordx4 v31, s[52:55], s69 offen offset:3072 lds
    s_mov_b32 m0, 71808
    s_nop 0
    buffer_load_dwordx4 v44, s[44:47], s78 offen lds
    buffer_load_dwordx4 v45, s[44:47], s78 offen offset:1024 lds
    buffer_load_dwordx4 v46, s[44:47], s78 offen offset:2048 lds
    buffer_load_dwordx4 v47, s[44:47], s78 offen offset:3072 lds
    s_mov_b32 m0, 55424
    s_nop 0
    buffer_load_dwordx4 v28, s[56:59], s69 offen lds
    buffer_load_dwordx4 v29, s[56:59], s69 offen offset:1024 lds
    buffer_load_dwordx4 v30, s[56:59], s69 offen offset:2048 lds
    buffer_load_dwordx4 v31, s[56:59], s69 offen offset:3072 lds
    s_mov_b32 m0, 75904
    s_nop 0
    buffer_load_dwordx4 v48, s[44:47], s78 offen lds
    s_waitcnt vmcnt(55)
    buffer_load_dwordx4 v49, s[44:47], s78 offen offset:1024 lds
    s_mov_b32 m0, 43136
    s_nop 0
    buffer_load_dwordx4 v32, s[48:51], s69 offen lds
    buffer_load_dwordx4 v33, s[48:51], s69 offen offset:1024 lds
    buffer_load_dwordx4 v34, s[48:51], s69 offen offset:2048 lds
    buffer_load_dwordx4 v35, s[48:51], s69 offen offset:3072 lds
    s_mov_b32 m0, 51328
    s_nop 0
    buffer_load_dwordx4 v32, s[52:55], s69 offen lds
    buffer_load_dwordx4 v33, s[52:55], s69 offen offset:1024 lds
    buffer_load_dwordx4 v34, s[52:55], s69 offen offset:2048 lds
    s_waitcnt vmcnt(55)
    buffer_load_dwordx4 v35, s[52:55], s69 offen offset:3072 lds
    s_mov_b32 m0, 59520
    s_nop 0
    buffer_load_dwordx4 v32, s[56:59], s69 offen lds
    buffer_load_dwordx4 v33, s[56:59], s69 offen offset:1024 lds
    buffer_load_dwordx4 v34, s[56:59], s69 offen offset:2048 lds
    buffer_load_dwordx4 v35, s[56:59], s69 offen offset:3072 lds
    s_waitcnt vmcnt(38) lgkmcnt(0)
    s_barrier
    s_add_u32 s34, s34, 0x9e3779b8
    s_or_b32 s34, s34, 1
    s_lshr_b64 s[80:81], s[80:81], 4
    s_and_b32 s79, s80, 15
    s_add_u32 s79, s79, s43
    s_sub_u32 s38, s79, 10
    s_cmp_ge_u32 s79, 10
    s_cselect_b32 s79, s38, s79
    s_mul_i32 s70, s79, 245760
    s_lshl_b32 s78, s79, 7
    s_mov_b32 m0, 102656
    s_nop 0
    buffer_load_dwordx4 v36, s[44:47], s78 offen lds
    buffer_load_dwordx4 v37, s[44:47], s78 offen offset:1024 lds
    buffer_load_dwordx4 v38, s[44:47], s78 offen offset:2048 lds
    buffer_load_dwordx4 v39, s[44:47], s78 offen offset:3072 lds
    s_mov_b32 m0, 78080
    s_nop 0
    buffer_load_dwordx4 v28, s[48:51], s70 offen lds
    buffer_load_dwordx4 v29, s[48:51], s70 offen offset:1024 lds
    buffer_load_dwordx4 v30, s[48:51], s70 offen offset:2048 lds
    buffer_load_dwordx4 v31, s[48:51], s70 offen offset:3072 lds
    s_mov_b32 m0, 106752
    s_nop 0
    buffer_load_dwordx4 v40, s[44:47], s78 offen lds
    buffer_load_dwordx4 v41, s[44:47], s78 offen offset:1024 lds
    buffer_load_dwordx4 v42, s[44:47], s78 offen offset:2048 lds
    buffer_load_dwordx4 v43, s[44:47], s78 offen offset:3072 lds
    s_mov_b32 m0, 86272
    s_nop 0
    buffer_load_dwordx4 v28, s[52:55], s70 offen lds
    buffer_load_dwordx4 v29, s[52:55], s70 offen offset:1024 lds
    buffer_load_dwordx4 v30, s[52:55], s70 offen offset:2048 lds
    buffer_load_dwordx4 v31, s[52:55], s70 offen offset:3072 lds
    s_mov_b32 m0, 110848
    s_nop 0
    buffer_load_dwordx4 v44, s[44:47], s78 offen lds
    buffer_load_dwordx4 v45, s[44:47], s78 offen offset:1024 lds
    buffer_load_dwordx4 v46, s[44:47], s78 offen offset:2048 lds
    buffer_load_dwordx4 v47, s[44:47], s78 offen offset:3072 lds
    s_mov_b32 m0, 94464
    s_nop 0
    buffer_load_dwordx4 v28, s[56:59], s70 offen lds
    buffer_load_dwordx4 v29, s[56:59], s70 offen offset:1024 lds
    buffer_load_dwordx4 v30, s[56:59], s70 offen offset:2048 lds
    buffer_load_dwordx4 v31, s[56:59], s70 offen offset:3072 lds
    s_mov_b32 m0, 114944
    s_nop 0
    buffer_load_dwordx4 v48, s[44:47], s78 offen lds
    s_waitcnt vmcnt(55)
    buffer_load_dwordx4 v49, s[44:47], s78 offen offset:1024 lds
    s_mov_b32 m0, 82176
    s_nop 0
    buffer_load_dwordx4 v32, s[48:51], s70 offen lds
    buffer_load_dwordx4 v33, s[48:51], s70 offen offset:1024 lds
    buffer_load_dwordx4 v34, s[48:51], s70 offen offset:2048 lds
    buffer_load_dwordx4 v35, s[48:51], s70 offen offset:3072 lds
    s_mov_b32 m0, 90368
    s_nop 0
    buffer_load_dwordx4 v32, s[52:55], s70 offen lds
    buffer_load_dwordx4 v33, s[52:55], s70 offen offset:1024 lds
    buffer_load_dwordx4 v34, s[52:55], s70 offen offset:2048 lds
    s_waitcnt vmcnt(55)
    buffer_load_dwordx4 v35, s[52:55], s70 offen offset:3072 lds
    s_mov_b32 m0, 98560
    s_nop 0
    buffer_load_dwordx4 v32, s[56:59], s70 offen lds
    buffer_load_dwordx4 v33, s[56:59], s70 offen offset:1024 lds
    buffer_load_dwordx4 v34, s[56:59], s70 offen offset:2048 lds
    buffer_load_dwordx4 v35, s[56:59], s70 offen offset:3072 lds
    s_waitcnt vmcnt(38) lgkmcnt(0)
    s_barrier
    s_lshr_b64 s[80:81], s[80:81], 4
    s_and_b32 s79, s80, 15
    s_add_u32 s79, s79, s43
    s_sub_u32 s38, s79, 10
    s_cmp_ge_u32 s79, 10
    s_cselect_b32 s79, s38, s79
    s_mul_i32 s71, s79, 245760
    s_lshl_b32 s78, s79, 7
    s_mov_b32 m0, 141696
    s_nop 0
    buffer_load_dwordx4 v36, s[44:47], s78 offen lds
    buffer_load_dwordx4 v37, s[44:47], s78 offen offset:1024 lds
    buffer_load_dwordx4 v38, s[44:47], s78 offen offset:2048 lds
    buffer_load_dwordx4 v39, s[44:47], s78 offen offset:3072 lds
    s_mov_b32 m0, 117120
    s_nop 0
    buffer_load_dwordx4 v28, s[48:51], s71 offen lds
    buffer_load_dwordx4 v29, s[48:51], s71 offen offset:1024 lds
    buffer_load_dwordx4 v30, s[48:51], s71 offen offset:2048 lds
    buffer_load_dwordx4 v31, s[48:51], s71 offen offset:3072 lds
    s_mov_b32 m0, 145792
    s_nop 0
    buffer_load_dwordx4 v40, s[44:47], s78 offen lds
    buffer_load_dwordx4 v41, s[44:47], s78 offen offset:1024 lds
    buffer_load_dwordx4 v42, s[44:47], s78 offen offset:2048 lds
    buffer_load_dwordx4 v43, s[44:47], s78 offen offset:3072 lds
    s_mov_b32 m0, 125312
    s_nop 0
    buffer_load_dwordx4 v28, s[52:55], s71 offen lds
    buffer_load_dwordx4 v29, s[52:55], s71 offen offset:1024 lds
    buffer_load_dwordx4 v30, s[52:55], s71 offen offset:2048 lds
    buffer_load_dwordx4 v31, s[52:55], s71 offen offset:3072 lds
    s_mov_b32 m0, 149888
    s_nop 0
    buffer_load_dwordx4 v44, s[44:47], s78 offen lds
    buffer_load_dwordx4 v45, s[44:47], s78 offen offset:1024 lds
    buffer_load_dwordx4 v46, s[44:47], s78 offen offset:2048 lds
    buffer_load_dwordx4 v47, s[44:47], s78 offen offset:3072 lds
    s_mov_b32 m0, 133504
    s_nop 0
    buffer_load_dwordx4 v28, s[56:59], s71 offen lds
    buffer_load_dwordx4 v29, s[56:59], s71 offen offset:1024 lds
    buffer_load_dwordx4 v30, s[56:59], s71 offen offset:2048 lds
    buffer_load_dwordx4 v31, s[56:59], s71 offen offset:3072 lds
    s_mov_b32 m0, 153984
    s_nop 0
    buffer_load_dwordx4 v48, s[44:47], s78 offen lds
    s_waitcnt vmcnt(55)
    buffer_load_dwordx4 v49, s[44:47], s78 offen offset:1024 lds
    s_mov_b32 m0, 121216
    s_nop 0
    buffer_load_dwordx4 v32, s[48:51], s71 offen lds
    buffer_load_dwordx4 v33, s[48:51], s71 offen offset:1024 lds
    buffer_load_dwordx4 v34, s[48:51], s71 offen offset:2048 lds
    buffer_load_dwordx4 v35, s[48:51], s71 offen offset:3072 lds
    s_mov_b32 m0, 129408
    s_nop 0
    buffer_load_dwordx4 v32, s[52:55], s71 offen lds
    buffer_load_dwordx4 v33, s[52:55], s71 offen offset:1024 lds
    buffer_load_dwordx4 v34, s[52:55], s71 offen offset:2048 lds
    s_waitcnt vmcnt(55)
    buffer_load_dwordx4 v35, s[52:55], s71 offen offset:3072 lds
    s_mov_b32 m0, 137600
    s_nop 0
    buffer_load_dwordx4 v32, s[56:59], s71 offen lds
    buffer_load_dwordx4 v33, s[56:59], s71 offen offset:1024 lds
    buffer_load_dwordx4 v34, s[56:59], s71 offen offset:2048 lds
    buffer_load_dwordx4 v35, s[56:59], s71 offen offset:3072 lds
    s_waitcnt vmcnt(38) lgkmcnt(0)
    s_barrier
    s_lshr_b64 s[80:81], s[80:81], 4
    s_and_b32 s79, s80, 15
    s_add_u32 s79, s79, s43
    s_sub_u32 s38, s79, 10
    s_cmp_ge_u32 s79, 10
    s_cselect_b32 s79, s38, s79
    s_mul_i32 s72, s79, 245760
    s_lshl_b32 s78, s79, 7
    s_mov_b32 m0, 24576
    s_nop 0
    buffer_load_dwordx4 v36, s[44:47], s78 offen lds
    buffer_load_dwordx4 v37, s[44:47], s78 offen offset:1024 lds
    buffer_load_dwordx4 v38, s[44:47], s78 offen offset:2048 lds
    buffer_load_dwordx4 v39, s[44:47], s78 offen offset:3072 lds
    s_mov_b32 m0, 0
    s_nop 0
    buffer_load_dwordx4 v28, s[48:51], s72 offen lds
    buffer_load_dwordx4 v29, s[48:51], s72 offen offset:1024 lds
    buffer_load_dwordx4 v30, s[48:51], s72 offen offset:2048 lds
    buffer_load_dwordx4 v31, s[48:51], s72 offen offset:3072 lds
    s_mov_b32 m0, 28672
    s_nop 0
    buffer_load_dwordx4 v40, s[44:47], s78 offen lds
    buffer_load_dwordx4 v41, s[44:47], s78 offen offset:1024 lds
    buffer_load_dwordx4 v42, s[44:47], s78 offen offset:2048 lds
    buffer_load_dwordx4 v43, s[44:47], s78 offen offset:3072 lds
    s_mov_b32 m0, 8192
    s_nop 0
    buffer_load_dwordx4 v28, s[52:55], s72 offen lds
    buffer_load_dwordx4 v29, s[52:55], s72 offen offset:1024 lds
    buffer_load_dwordx4 v30, s[52:55], s72 offen offset:2048 lds
    buffer_load_dwordx4 v31, s[52:55], s72 offen offset:3072 lds
    s_mov_b32 m0, 32768
    s_nop 0
    buffer_load_dwordx4 v44, s[44:47], s78 offen lds
    buffer_load_dwordx4 v45, s[44:47], s78 offen offset:1024 lds
    buffer_load_dwordx4 v46, s[44:47], s78 offen offset:2048 lds
    buffer_load_dwordx4 v47, s[44:47], s78 offen offset:3072 lds
    s_mov_b32 m0, 16384
    s_nop 0
    buffer_load_dwordx4 v28, s[56:59], s72 offen lds
    buffer_load_dwordx4 v29, s[56:59], s72 offen offset:1024 lds
    buffer_load_dwordx4 v30, s[56:59], s72 offen offset:2048 lds
    buffer_load_dwordx4 v31, s[56:59], s72 offen offset:3072 lds
    s_mov_b32 m0, 36864
    s_nop 0
    buffer_load_dwordx4 v48, s[44:47], s78 offen lds
    s_waitcnt vmcnt(55)
    buffer_load_dwordx4 v49, s[44:47], s78 offen offset:1024 lds
    s_mov_b32 m0, 4096
    s_nop 0
    buffer_load_dwordx4 v32, s[48:51], s72 offen lds
    buffer_load_dwordx4 v33, s[48:51], s72 offen offset:1024 lds
    buffer_load_dwordx4 v34, s[48:51], s72 offen offset:2048 lds
    buffer_load_dwordx4 v35, s[48:51], s72 offen offset:3072 lds
    s_mov_b32 m0, 12288
    s_nop 0
    buffer_load_dwordx4 v32, s[52:55], s72 offen lds
    buffer_load_dwordx4 v33, s[52:55], s72 offen offset:1024 lds
    buffer_load_dwordx4 v34, s[52:55], s72 offen offset:2048 lds
    s_waitcnt vmcnt(55)
    buffer_load_dwordx4 v35, s[52:55], s72 offen offset:3072 lds
    s_mov_b32 m0, 20480
    s_nop 0
    buffer_load_dwordx4 v32, s[56:59], s72 offen lds
    buffer_load_dwordx4 v33, s[56:59], s72 offen offset:1024 lds
    buffer_load_dwordx4 v34, s[56:59], s72 offen offset:2048 lds
    buffer_load_dwordx4 v35, s[56:59], s72 offen offset:3072 lds
    s_waitcnt vmcnt(38) lgkmcnt(0)
    s_barrier
    s_lshr_b64 s[80:81], s[80:81], 4
    s_and_b32 s79, s80, 15
    s_add_u32 s79, s79, s43
    s_sub_u32 s38, s79, 10
    s_cmp_ge_u32 s79, 10
    s_cselect_b32 s79, s38, s79
    s_mul_i32 s73, s79, 245760
    s_lshl_b32 s78, s79, 7
    s_mov_b32 m0, 63616
    s_nop 0
    buffer_load_dwordx4 v36, s[44:47], s78 offen lds
    buffer_load_dwordx4 v37, s[44:47], s78 offen offset:1024 lds
    buffer_load_dwordx4 v38, s[44:47], s78 offen offset:2048 lds
    buffer_load_dwordx4 v39, s[44:47], s78 offen offset:3072 lds
    s_mov_b32 m0, 39040
    s_nop 0
    buffer_load_dwordx4 v28, s[48:51], s73 offen lds
    buffer_load_dwordx4 v29, s[48:51], s73 offen offset:1024 lds
    buffer_load_dwordx4 v30, s[48:51], s73 offen offset:2048 lds
    buffer_load_dwordx4 v31, s[48:51], s73 offen offset:3072 lds
    s_mov_b32 m0, 67712
    s_nop 0
    buffer_load_dwordx4 v40, s[44:47], s78 offen lds
    buffer_load_dwordx4 v41, s[44:47], s78 offen offset:1024 lds
    buffer_load_dwordx4 v42, s[44:47], s78 offen offset:2048 lds
    buffer_load_dwordx4 v43, s[44:47], s78 offen offset:3072 lds
    s_mov_b32 m0, 47232
    s_nop 0
    buffer_load_dwordx4 v28, s[52:55], s73 offen lds
    buffer_load_dwordx4 v29, s[52:55], s73 offen offset:1024 lds
    buffer_load_dwordx4 v30, s[52:55], s73 offen offset:2048 lds
    buffer_load_dwordx4 v31, s[52:55], s73 offen offset:3072 lds
    s_mov_b32 m0, 71808
    s_nop 0
    buffer_load_dwordx4 v44, s[44:47], s78 offen lds
    buffer_load_dwordx4 v45, s[44:47], s78 offen offset:1024 lds
    buffer_load_dwordx4 v46, s[44:47], s78 offen offset:2048 lds
    buffer_load_dwordx4 v47, s[44:47], s78 offen offset:3072 lds
    s_mov_b32 m0, 55424
    s_nop 0
    buffer_load_dwordx4 v28, s[56:59], s73 offen lds
    buffer_load_dwordx4 v29, s[56:59], s73 offen offset:1024 lds
    buffer_load_dwordx4 v30, s[56:59], s73 offen offset:2048 lds
    buffer_load_dwordx4 v31, s[56:59], s73 offen offset:3072 lds
    s_mov_b32 m0, 75904
    s_nop 0
    buffer_load_dwordx4 v48, s[44:47], s78 offen lds
    s_waitcnt vmcnt(55)
    buffer_load_dwordx4 v49, s[44:47], s78 offen offset:1024 lds
    s_mov_b32 m0, 43136
    s_nop 0
    buffer_load_dwordx4 v32, s[48:51], s73 offen lds
    buffer_load_dwordx4 v33, s[48:51], s73 offen offset:1024 lds
    buffer_load_dwordx4 v34, s[48:51], s73 offen offset:2048 lds
    buffer_load_dwordx4 v35, s[48:51], s73 offen offset:3072 lds
    s_mov_b32 m0, 51328
    s_nop 0
    buffer_load_dwordx4 v32, s[52:55], s73 offen lds
    buffer_load_dwordx4 v33, s[52:55], s73 offen offset:1024 lds
    buffer_load_dwordx4 v34, s[52:55], s73 offen offset:2048 lds
    s_waitcnt vmcnt(55)
    buffer_load_dwordx4 v35, s[52:55], s73 offen offset:3072 lds
    s_mov_b32 m0, 59520
    s_nop 0
    buffer_load_dwordx4 v32, s[56:59], s73 offen lds
    buffer_load_dwordx4 v33, s[56:59], s73 offen offset:1024 lds
    buffer_load_dwordx4 v34, s[56:59], s73 offen offset:2048 lds
    buffer_load_dwordx4 v35, s[56:59], s73 offen offset:3072 lds
    s_waitcnt vmcnt(38) lgkmcnt(0)
    s_barrier
    s_lshr_b64 s[80:81], s[80:81], 4
    s_and_b32 s79, s80, 15
    s_add_u32 s79, s79, s43
    s_sub_u32 s38, s79, 10
    s_cmp_ge_u32 s79, 10
    s_cselect_b32 s79, s38, s79
    s_mul_i32 s74, s79, 245760
    s_lshl_b32 s78, s79, 7
    s_mov_b32 m0, 102656
    s_nop 0
    buffer_load_dwordx4 v36, s[44:47], s78 offen lds
    buffer_load_dwordx4 v37, s[44:47], s78 offen offset:1024 lds
    buffer_load_dwordx4 v38, s[44:47], s78 offen offset:2048 lds
    buffer_load_dwordx4 v39, s[44:47], s78 offen offset:3072 lds
    s_mov_b32 m0, 78080
    s_nop 0
    buffer_load_dwordx4 v28, s[48:51], s74 offen lds
    buffer_load_dwordx4 v29, s[48:51], s74 offen offset:1024 lds
    buffer_load_dwordx4 v30, s[48:51], s74 offen offset:2048 lds
    buffer_load_dwordx4 v31, s[48:51], s74 offen offset:3072 lds
    s_mov_b32 m0, 106752
    s_nop 0
    buffer_load_dwordx4 v40, s[44:47], s78 offen lds
    buffer_load_dwordx4 v41, s[44:47], s78 offen offset:1024 lds
    buffer_load_dwordx4 v42, s[44:47], s78 offen offset:2048 lds
    buffer_load_dwordx4 v43, s[44:47], s78 offen offset:3072 lds
    s_mov_b32 m0, 86272
    s_nop 0
    buffer_load_dwordx4 v28, s[52:55], s74 offen lds
    buffer_load_dwordx4 v29, s[52:55], s74 offen offset:1024 lds
    buffer_load_dwordx4 v30, s[52:55], s74 offen offset:2048 lds
    buffer_load_dwordx4 v31, s[52:55], s74 offen offset:3072 lds
    s_mov_b32 m0, 110848
    s_nop 0
    buffer_load_dwordx4 v44, s[44:47], s78 offen lds
    buffer_load_dwordx4 v45, s[44:47], s78 offen offset:1024 lds
    buffer_load_dwordx4 v46, s[44:47], s78 offen offset:2048 lds
    buffer_load_dwordx4 v47, s[44:47], s78 offen offset:3072 lds
    s_mov_b32 m0, 82176
    s_nop 0
    buffer_load_dwordx4 v32, s[48:51], s74 offen lds
    buffer_load_dwordx4 v33, s[48:51], s74 offen offset:1024 lds
    buffer_load_dwordx4 v34, s[48:51], s74 offen offset:2048 lds
    buffer_load_dwordx4 v35, s[48:51], s74 offen offset:3072 lds
    s_mov_b32 m0, 114944
    s_nop 0
    buffer_load_dwordx4 v48, s[44:47], s78 offen lds
    s_waitcnt vmcnt(55)
    buffer_load_dwordx4 v49, s[44:47], s78 offen offset:1024 lds
    s_mov_b32 m0, 90368
    s_nop 0
    buffer_load_dwordx4 v32, s[52:55], s74 offen lds
    buffer_load_dwordx4 v33, s[52:55], s74 offen offset:1024 lds
    buffer_load_dwordx4 v34, s[52:55], s74 offen offset:2048 lds
    buffer_load_dwordx4 v35, s[52:55], s74 offen offset:3072 lds
    s_waitcnt vmcnt(30) lgkmcnt(0)
    s_barrier
    s_lshr_b64 s[80:81], s[80:81], 4
    s_and_b32 s79, s80, 15
    s_add_u32 s79, s79, s43
    s_sub_u32 s38, s79, 10
    s_cmp_ge_u32 s79, 10
    s_cselect_b32 s79, s38, s79
    s_mul_i32 s75, s79, 245760
    s_lshl_b32 s78, s79, 7
    s_mov_b32 m0, 141696
    s_nop 0
    buffer_load_dwordx4 v36, s[44:47], s78 offen lds
    buffer_load_dwordx4 v37, s[44:47], s78 offen offset:1024 lds
    buffer_load_dwordx4 v38, s[44:47], s78 offen offset:2048 lds
    buffer_load_dwordx4 v39, s[44:47], s78 offen offset:3072 lds
    s_mov_b32 m0, 117120
    s_nop 0
    buffer_load_dwordx4 v28, s[48:51], s75 offen lds
    buffer_load_dwordx4 v29, s[48:51], s75 offen offset:1024 lds
    buffer_load_dwordx4 v30, s[48:51], s75 offen offset:2048 lds
    buffer_load_dwordx4 v31, s[48:51], s75 offen offset:3072 lds
    s_mov_b32 m0, 145792
    s_nop 0
    buffer_load_dwordx4 v40, s[44:47], s78 offen lds
    buffer_load_dwordx4 v41, s[44:47], s78 offen offset:1024 lds
    buffer_load_dwordx4 v42, s[44:47], s78 offen offset:2048 lds
    buffer_load_dwordx4 v43, s[44:47], s78 offen offset:3072 lds
    s_mov_b32 m0, 125312
    s_nop 0
    buffer_load_dwordx4 v28, s[52:55], s75 offen lds
    buffer_load_dwordx4 v29, s[52:55], s75 offen offset:1024 lds
    buffer_load_dwordx4 v30, s[52:55], s75 offen offset:2048 lds
    buffer_load_dwordx4 v31, s[52:55], s75 offen offset:3072 lds
    s_mov_b32 m0, 149888
    s_nop 0
    buffer_load_dwordx4 v44, s[44:47], s78 offen lds
    buffer_load_dwordx4 v45, s[44:47], s78 offen offset:1024 lds
    buffer_load_dwordx4 v46, s[44:47], s78 offen offset:2048 lds
    buffer_load_dwordx4 v47, s[44:47], s78 offen offset:3072 lds
    s_mov_b32 m0, 121216
    s_nop 0
    buffer_load_dwordx4 v32, s[48:51], s75 offen lds
    buffer_load_dwordx4 v33, s[48:51], s75 offen offset:1024 lds
    buffer_load_dwordx4 v34, s[48:51], s75 offen offset:2048 lds
    buffer_load_dwordx4 v35, s[48:51], s75 offen offset:3072 lds
    s_mov_b32 m0, 153984
    s_nop 0
    buffer_load_dwordx4 v48, s[44:47], s78 offen lds
    buffer_load_dwordx4 v49, s[44:47], s78 offen offset:1024 lds
    s_mov_b32 m0, 129408
    s_nop 0
    buffer_load_dwordx4 v32, s[52:55], s75 offen lds
    buffer_load_dwordx4 v33, s[52:55], s75 offen offset:1024 lds
    buffer_load_dwordx4 v34, s[52:55], s75 offen offset:2048 lds
    buffer_load_dwordx4 v35, s[52:55], s75 offen offset:3072 lds
    s_waitcnt vmcnt(30) lgkmcnt(0)
    s_barrier
    s_lshr_b64 s[80:81], s[80:81], 4
    s_and_b32 s79, s80, 15
    s_add_u32 s79, s79, s43
    s_sub_u32 s38, s79, 10
    s_cmp_ge_u32 s79, 10
    s_cselect_b32 s79, s38, s79
    s_mul_i32 s76, s79, 245760
    s_lshl_b32 s78, s79, 7
    s_mov_b32 m0, 24576
    s_nop 0
    buffer_load_dwordx4 v36, s[44:47], s78 offen lds
    buffer_load_dwordx4 v37, s[44:47], s78 offen offset:1024 lds
    buffer_load_dwordx4 v38, s[44:47], s78 offen offset:2048 lds
    buffer_load_dwordx4 v39, s[44:47], s78 offen offset:3072 lds
    s_mov_b32 m0, 0
    s_nop 0
    buffer_load_dwordx4 v28, s[48:51], s76 offen lds
    buffer_load_dwordx4 v29, s[48:51], s76 offen offset:1024 lds
    buffer_load_dwordx4 v30, s[48:51], s76 offen offset:2048 lds
    buffer_load_dwordx4 v31, s[48:51], s76 offen offset:3072 lds
    s_mov_b32 m0, 28672
    s_nop 0
    buffer_load_dwordx4 v40, s[44:47], s78 offen lds
    buffer_load_dwordx4 v41, s[44:47], s78 offen offset:1024 lds
    buffer_load_dwordx4 v42, s[44:47], s78 offen offset:2048 lds
    buffer_load_dwordx4 v43, s[44:47], s78 offen offset:3072 lds
    s_mov_b32 m0, 8192
    s_nop 0
    buffer_load_dwordx4 v28, s[52:55], s76 offen lds
    buffer_load_dwordx4 v29, s[52:55], s76 offen offset:1024 lds
    buffer_load_dwordx4 v30, s[52:55], s76 offen offset:2048 lds
    buffer_load_dwordx4 v31, s[52:55], s76 offen offset:3072 lds
    s_mov_b32 m0, 32768
    s_nop 0
    buffer_load_dwordx4 v44, s[44:47], s78 offen lds
    buffer_load_dwordx4 v45, s[44:47], s78 offen offset:1024 lds
    buffer_load_dwordx4 v46, s[44:47], s78 offen offset:2048 lds
    buffer_load_dwordx4 v47, s[44:47], s78 offen offset:3072 lds
    s_mov_b32 m0, 4096
    s_nop 0
    buffer_load_dwordx4 v32, s[48:51], s76 offen lds
    buffer_load_dwordx4 v33, s[48:51], s76 offen offset:1024 lds
    buffer_load_dwordx4 v34, s[48:51], s76 offen offset:2048 lds
    buffer_load_dwordx4 v35, s[48:51], s76 offen offset:3072 lds
    s_mov_b32 m0, 36864
    s_nop 0
    buffer_load_dwordx4 v48, s[44:47], s78 offen lds
    buffer_load_dwordx4 v49, s[44:47], s78 offen offset:1024 lds
    s_mov_b32 m0, 12288
    s_nop 0
    buffer_load_dwordx4 v32, s[52:55], s76 offen lds
    buffer_load_dwordx4 v33, s[52:55], s76 offen offset:1024 lds
    buffer_load_dwordx4 v34, s[52:55], s76 offen offset:2048 lds
    buffer_load_dwordx4 v35, s[52:55], s76 offen offset:3072 lds
    s_waitcnt vmcnt(30) lgkmcnt(0)
    s_barrier
    s_lshr_b64 s[80:81], s[80:81], 4
    s_and_b32 s79, s80, 15
    s_add_u32 s79, s79, s43
    s_sub_u32 s38, s79, 10
    s_cmp_ge_u32 s79, 10
    s_cselect_b32 s79, s38, s79
    s_mul_i32 s77, s79, 245760
    s_lshl_b32 s78, s79, 7
    s_mov_b32 m0, 63616
    s_nop 0
    buffer_load_dwordx4 v36, s[44:47], s78 offen lds
    buffer_load_dwordx4 v37, s[44:47], s78 offen offset:1024 lds
    buffer_load_dwordx4 v38, s[44:47], s78 offen offset:2048 lds
    buffer_load_dwordx4 v39, s[44:47], s78 offen offset:3072 lds
    s_mov_b32 m0, 39040
    s_nop 0
    buffer_load_dwordx4 v28, s[48:51], s77 offen lds
    buffer_load_dwordx4 v29, s[48:51], s77 offen offset:1024 lds
    buffer_load_dwordx4 v30, s[48:51], s77 offen offset:2048 lds
    buffer_load_dwordx4 v31, s[48:51], s77 offen offset:3072 lds
    s_mov_b32 m0, 67712
    s_nop 0
    buffer_load_dwordx4 v40, s[44:47], s78 offen lds
    buffer_load_dwordx4 v41, s[44:47], s78 offen offset:1024 lds
    buffer_load_dwordx4 v42, s[44:47], s78 offen offset:2048 lds
    buffer_load_dwordx4 v43, s[44:47], s78 offen offset:3072 lds
    s_mov_b32 m0, 47232
    s_nop 0
    buffer_load_dwordx4 v28, s[52:55], s77 offen lds
    buffer_load_dwordx4 v29, s[52:55], s77 offen offset:1024 lds
    buffer_load_dwordx4 v30, s[52:55], s77 offen offset:2048 lds
    buffer_load_dwordx4 v31, s[52:55], s77 offen offset:3072 lds
    s_mov_b32 m0, 71808
    s_nop 0
    buffer_load_dwordx4 v44, s[44:47], s78 offen lds
    buffer_load_dwordx4 v45, s[44:47], s78 offen offset:1024 lds
    buffer_load_dwordx4 v46, s[44:47], s78 offen offset:2048 lds
    buffer_load_dwordx4 v47, s[44:47], s78 offen offset:3072 lds
    s_mov_b32 m0, 43136
    s_nop 0
    buffer_load_dwordx4 v32, s[48:51], s77 offen lds
    buffer_load_dwordx4 v33, s[48:51], s77 offen offset:1024 lds
    buffer_load_dwordx4 v34, s[48:51], s77 offen offset:2048 lds
    buffer_load_dwordx4 v35, s[48:51], s77 offen offset:3072 lds
    s_mov_b32 m0, 75904
    s_nop 0
    buffer_load_dwordx4 v48, s[44:47], s78 offen lds
    buffer_load_dwordx4 v49, s[44:47], s78 offen offset:1024 lds
    s_mov_b32 m0, 51328
    s_nop 0
    buffer_load_dwordx4 v32, s[52:55], s77 offen lds
    buffer_load_dwordx4 v33, s[52:55], s77 offen offset:1024 lds
    buffer_load_dwordx4 v34, s[52:55], s77 offen offset:2048 lds
    buffer_load_dwordx4 v35, s[52:55], s77 offen offset:3072 lds
    s_waitcnt vmcnt(30) lgkmcnt(0)
    s_barrier
    s_lshr_b64 s[80:81], s[80:81], 4
    s_and_b32 s79, s80, 15
    s_add_u32 s79, s79, s43
    s_sub_u32 s38, s79, 10
    s_cmp_ge_u32 s79, 10
    s_cselect_b32 s79, s38, s79
    s_mov_b32 m0, 94464
    s_nop 0
    buffer_load_dwordx4 v28, s[56:59], s74 offen lds
    buffer_load_dwordx4 v29, s[56:59], s74 offen offset:1024 lds
    buffer_load_dwordx4 v30, s[56:59], s74 offen offset:2048 lds
    buffer_load_dwordx4 v31, s[56:59], s74 offen offset:3072 lds
    s_mov_b32 m0, 98560
    s_nop 0
    buffer_load_dwordx4 v32, s[56:59], s74 offen lds
    buffer_load_dwordx4 v33, s[56:59], s74 offen offset:1024 lds
    buffer_load_dwordx4 v34, s[56:59], s74 offen offset:2048 lds
    buffer_load_dwordx4 v35, s[56:59], s74 offen offset:3072 lds
    s_mov_b32 m0, 133504
    s_nop 0
    buffer_load_dwordx4 v28, s[56:59], s75 offen lds
    buffer_load_dwordx4 v29, s[56:59], s75 offen offset:1024 lds
    buffer_load_dwordx4 v30, s[56:59], s75 offen offset:2048 lds
    buffer_load_dwordx4 v31, s[56:59], s75 offen offset:3072 lds
    s_waitcnt vmcnt(12) lgkmcnt(0)
    s_barrier
    s_mov_b32 m0, 137600
    s_nop 0
    buffer_load_dwordx4 v32, s[56:59], s75 offen lds
    buffer_load_dwordx4 v33, s[56:59], s75 offen offset:1024 lds
    buffer_load_dwordx4 v34, s[56:59], s75 offen offset:2048 lds
    buffer_load_dwordx4 v35, s[56:59], s75 offen offset:3072 lds
    s_mov_b32 m0, 16384
    s_nop 0
    buffer_load_dwordx4 v28, s[56:59], s76 offen lds
    buffer_load_dwordx4 v29, s[56:59], s76 offen offset:1024 lds
    buffer_load_dwordx4 v30, s[56:59], s76 offen offset:2048 lds
    buffer_load_dwordx4 v31, s[56:59], s76 offen offset:3072 lds
    s_mov_b32 m0, 20480
    s_nop 0
    buffer_load_dwordx4 v32, s[56:59], s76 offen lds
    buffer_load_dwordx4 v33, s[56:59], s76 offen offset:1024 lds
    buffer_load_dwordx4 v34, s[56:59], s76 offen offset:2048 lds
    buffer_load_dwordx4 v35, s[56:59], s76 offen offset:3072 lds
    s_mov_b32 m0, 55424
    s_nop 0
    buffer_load_dwordx4 v28, s[56:59], s77 offen lds
    buffer_load_dwordx4 v29, s[56:59], s77 offen offset:1024 lds
    buffer_load_dwordx4 v30, s[56:59], s77 offen offset:2048 lds
    buffer_load_dwordx4 v31, s[56:59], s77 offen offset:3072 lds
    s_mov_b32 m0, 59520
    s_nop 0
    buffer_load_dwordx4 v32, s[56:59], s77 offen lds
    buffer_load_dwordx4 v33, s[56:59], s77 offen offset:1024 lds
    buffer_load_dwordx4 v34, s[56:59], s77 offen offset:2048 lds
    buffer_load_dwordx4 v35, s[56:59], s77 offen offset:3072 lds
    s_mov_b32 s10, 20480
    v_lshrrev_b32 v52, 5, v1
    v_lshlrev_b32 v52, 3, v52
    v_add_u32 v56, 8, v52
    v_mul_u32_u24 v52, 3, v52
    v_add_u32 v53, 2, v52
    v_add_u32 v54, 4, v52
    v_add_u32 v55, 6, v52
    v_add_u32 v57, 2, v56
    v_add_u32 v58, 4, v56
    v_add_u32 v59, 6, v56
    v_and_b32 v7, 3, v5
    v_mul_u32_u24 v7, 1280, v7
    v_add_u32 v60, v7, v50
    v_xor_b32 v61, 64, v60
    v_add_u32 v61, 4096, v61
    v_add_u32 v62, 8192, v60
    v_add_u32 v63, 8192, v61
    s_mov_b32 s42, 0
    s_mov_b32 s5, 0xbfe10856
    s_mov_b32 s6, 0xaff80255
    s_mov_b32 s7, 0xabfe4015
    s_mov_b32 s8, 0xaa7fd005
    s_mov_b32 s9, 0x6adfb401
    s_cmp_eq_u32 s42, 1
    s_cselect_b32 s5, 0xabfe4015, s5
    s_cselect_b32 s6, 0xaa7fd005, s6
    s_cselect_b32 s7, 0x6adfb401, s7
    s_cselect_b32 s8, 0xbfe10856, s8
    s_cselect_b32 s9, 0xaff80255, s9
    s_cmp_eq_u32 s42, 2
    s_cselect_b32 s5, 0x6adfb401, s5
    s_cselect_b32 s6, 0xbfe10856, s6
    s_cselect_b32 s7, 0xaff80255, s7
    s_cselect_b32 s8, 0xabfe4015, s8
    s_cselect_b32 s9, 0xaa7fd005, s9
    s_cmp_eq_u32 s42, 3
    s_cselect_b32 s5, 0xaff80255, s5
    s_cselect_b32 s6, 0xabfe4015, s6
    s_cselect_b32 s7, 0xaa7fd005, s7
    s_cselect_b32 s8, 0x6adfb401, s8
    s_cselect_b32 s9, 0xbfe10856, s9
    s_cmp_eq_u32 s42, 4
    s_cselect_b32 s5, 0xaa7fd005, s5
    s_cselect_b32 s6, 0x6adfb401, s6
    s_cselect_b32 s7, 0xbfe10856, s7
    s_cselect_b32 s8, 0xaff80255, s8
    s_cselect_b32 s9, 0xabfe4015, s9
    s_mul_i32 s4, s42, 163840
    s_mov_b32 m0, 0
    s_mov_b32 s4, 0
    v_bfe_u32 v64, s5, v52, 2
    v_mad_u32_u24 v64, v64, s10, v60
    buffer_load_dwordx4 v64, s[60:63], s4 offen lds
    v_bfe_u32 v65, s5, v53, 2
    v_mad_u32_u24 v65, v65, s10, v61
    buffer_load_dwordx4 v65, s[60:63], s4 offen offset:1024 lds
    v_bfe_u32 v64, s5, v54, 2
    v_mad_u32_u24 v64, v64, s10, v62
    buffer_load_dwordx4 v64, s[60:63], s4 offen offset:2048 lds
    v_bfe_u32 v65, s5, v55, 2
    v_mad_u32_u24 v65, v65, s10, v63
    buffer_load_dwordx4 v65, s[60:63], s4 offen offset:3072 lds
    s_mov_b32 m0, 4096
    s_mov_b32 s4, 81920
    v_bfe_u32 v64, s6, v52, 2
    v_mad_u32_u24 v64, v64, s10, v60
    buffer_load_dwordx4 v64, s[60:63], s4 offen lds
    v_bfe_u32 v65, s6, v53, 2
    v_mad_u32_u24 v65, v65, s10, v61
    buffer_load_dwordx4 v65, s[60:63], s4 offen offset:1024 lds
    v_bfe_u32 v64, s6, v54, 2
    v_mad_u32_u24 v64, v64, s10, v62
    buffer_load_dwordx4 v64, s[60:63], s4 offen offset:2048 lds
    v_bfe_u32 v65, s6, v55, 2
    v_mad_u32_u24 v65, v65, s10, v63
    buffer_load_dwordx4 v65, s[60:63], s4 offen offset:3072 lds
    s_mov_b32 m0, 8192
    s_mov_b32 s4, 163840
    v_bfe_u32 v64, s7, v52, 2
    v_mad_u32_u24 v64, v64, s10, v60
    buffer_load_dwordx4 v64, s[60:63], s4 offen lds
    v_bfe_u32 v65, s7, v53, 2
    v_mad_u32_u24 v65, v65, s10, v61
    buffer_load_dwordx4 v65, s[60:63], s4 offen offset:1024 lds
    v_bfe_u32 v64, s7, v54, 2
    v_mad_u32_u24 v64, v64, s10, v62
    buffer_load_dwordx4 v64, s[60:63], s4 offen offset:2048 lds
    v_bfe_u32 v65, s7, v55, 2
    v_mad_u32_u24 v65, v65, s10, v63
    buffer_load_dwordx4 v65, s[60:63], s4 offen offset:3072 lds
    s_mov_b32 m0, 12288
    s_mov_b32 s4, 245760
    v_bfe_u32 v64, s8, v52, 2
    v_mad_u32_u24 v64, v64, s10, v60
    buffer_load_dwordx4 v64, s[60:63], s4 offen lds
    v_bfe_u32 v65, s8, v53, 2
    v_mad_u32_u24 v65, v65, s10, v61
    buffer_load_dwordx4 v65, s[60:63], s4 offen offset:1024 lds
    v_bfe_u32 v64, s8, v54, 2
    v_mad_u32_u24 v64, v64, s10, v62
    buffer_load_dwordx4 v64, s[60:63], s4 offen offset:2048 lds
    v_bfe_u32 v65, s8, v55, 2
    v_mad_u32_u24 v65, v65, s10, v63
    buffer_load_dwordx4 v65, s[60:63], s4 offen offset:3072 lds
    s_waitcnt vmcnt(16)
    v_mov_b32 v5, 157980
    v_mov_b32 v6, 1
    s_mov_b64 exec, 1
    ds_add_u32 v5, v6
    s_mov_b64 exec, -1
    v_mov_b32 v5, 157972
    v_mov_b32 v6, 1
    s_mov_b64 exec, 1
    ds_add_u32 v5, v6
    s_mov_b64 exec, -1
    s_mov_b32 m0, 24576
    s_mov_b32 s4, 327680
    v_bfe_u32 v64, s9, v52, 2
    v_mad_u32_u24 v64, v64, s10, v60
    buffer_load_dwordx4 v64, s[60:63], s4 offen lds
    v_bfe_u32 v65, s9, v53, 2
    v_mad_u32_u24 v65, v65, s10, v61
    buffer_load_dwordx4 v65, s[60:63], s4 offen offset:1024 lds
    v_bfe_u32 v64, s9, v54, 2
    v_mad_u32_u24 v64, v64, s10, v62
    buffer_load_dwordx4 v64, s[60:63], s4 offen offset:2048 lds
    v_bfe_u32 v65, s9, v55, 2
    v_mad_u32_u24 v65, v65, s10, v63
    buffer_load_dwordx4 v65, s[60:63], s4 offen offset:3072 lds
    s_mov_b32 m0, 28672
    s_mov_b32 s4, 409600
    v_bfe_u32 v64, s5, v52, 2
    v_mad_u32_u24 v64, v64, s10, v60
    buffer_load_dwordx4 v64, s[60:63], s4 offen lds
    v_bfe_u32 v65, s5, v53, 2
    v_mad_u32_u24 v65, v65, s10, v61
    buffer_load_dwordx4 v65, s[60:63], s4 offen offset:1024 lds
    v_bfe_u32 v64, s5, v54, 2
    v_mad_u32_u24 v64, v64, s10, v62
    buffer_load_dwordx4 v64, s[60:63], s4 offen offset:2048 lds
    v_bfe_u32 v65, s5, v55, 2
    v_mad_u32_u24 v65, v65, s10, v63
    buffer_load_dwordx4 v65, s[60:63], s4 offen offset:3072 lds
    s_mov_b32 m0, 123136
    s_mov_b32 s4, 491520
    v_bfe_u32 v64, s6, v52, 2
    v_mad_u32_u24 v64, v64, s10, v60
    buffer_load_dwordx4 v64, s[60:63], s4 offen lds
    v_bfe_u32 v65, s6, v53, 2
    v_mad_u32_u24 v65, v65, s10, v61
    buffer_load_dwordx4 v65, s[60:63], s4 offen offset:1024 lds
    v_bfe_u32 v64, s6, v54, 2
    v_mad_u32_u24 v64, v64, s10, v62
    buffer_load_dwordx4 v64, s[60:63], s4 offen offset:2048 lds
    v_bfe_u32 v65, s6, v55, 2
    v_mad_u32_u24 v65, v65, s10, v63
    buffer_load_dwordx4 v65, s[60:63], s4 offen offset:3072 lds
    s_mov_b32 m0, 127232
    s_mov_b32 s4, 573440
    v_bfe_u32 v64, s7, v52, 2
    v_mad_u32_u24 v64, v64, s10, v60
    buffer_load_dwordx4 v64, s[60:63], s4 offen lds
    v_bfe_u32 v65, s7, v53, 2
    v_mad_u32_u24 v65, v65, s10, v61
    buffer_load_dwordx4 v65, s[60:63], s4 offen offset:1024 lds
    v_bfe_u32 v64, s7, v54, 2
    v_mad_u32_u24 v64, v64, s10, v62
    buffer_load_dwordx4 v64, s[60:63], s4 offen offset:2048 lds
    v_bfe_u32 v65, s7, v55, 2
    v_mad_u32_u24 v65, v65, s10, v63
    buffer_load_dwordx4 v65, s[60:63], s4 offen offset:3072 lds
    s_mov_b32 m0, 80000
    s_mov_b32 s4, 655360
    v_bfe_u32 v64, s8, v52, 2
    v_mad_u32_u24 v64, v64, s10, v60
    buffer_load_dwordx4 v64, s[60:63], s4 offen lds
    v_bfe_u32 v65, s8, v53, 2
    v_mad_u32_u24 v65, v65, s10, v61
    buffer_load_dwordx4 v65, s[60:63], s4 offen offset:1024 lds
    v_bfe_u32 v64, s8, v54, 2
    v_mad_u32_u24 v64, v64, s10, v62
    buffer_load_dwordx4 v64, s[60:63], s4 offen offset:2048 lds
    v_bfe_u32 v65, s8, v55, 2
    v_mad_u32_u24 v65, v65, s10, v63
    buffer_load_dwordx4 v65, s[60:63], s4 offen offset:3072 lds
    s_mov_b32 m0, 84096
    s_mov_b32 s4, 737280
    v_bfe_u32 v64, s9, v52, 2
    v_mad_u32_u24 v64, v64, s10, v60
    buffer_load_dwordx4 v64, s[60:63], s4 offen lds
    v_bfe_u32 v65, s9, v53, 2
    v_mad_u32_u24 v65, v65, s10, v61
    buffer_load_dwordx4 v65, s[60:63], s4 offen offset:1024 lds
    v_bfe_u32 v64, s9, v54, 2
    v_mad_u32_u24 v64, v64, s10, v62
    buffer_load_dwordx4 v64, s[60:63], s4 offen offset:2048 lds
    v_bfe_u32 v65, s9, v55, 2
    v_mad_u32_u24 v65, v65, s10, v63
    buffer_load_dwordx4 v65, s[60:63], s4 offen offset:3072 lds
    s_waitcnt vmcnt(0)
    v_mov_b32 v7, 157980
    v_mov_b32 v6, 1
    s_mov_b64 exec, 1
    ds_add_u32 v7, v6
    s_mov_b64 exec, -1
Lcw_7:
    s_sub_u32 s35, s35, 1
    s_cbranch_scc1 Lend
    s_sleep 2
    ds_read_b32 v6, v5
    s_waitcnt lgkmcnt(0)
    v_readfirstlane_b32 s38, v6
    s_nop 0
    s_cmp_lt_u32 s38, 8
    s_cbranch_scc1 Lcw_7
    s_lshl_b32 s36, s32, 7
    s_add_u32 s36, s36, 8257536
    v_mov_b32 v69, s36
    buffer_load_dwordx4 v[70:73], v69, s[28:31], 0 offen sc1
    s_mov_b32 m0, 32768
    s_mov_b32 s4, 0
    v_bfe_u32 v64, s5, v56, 2
    v_mad_u32_u24 v64, v64, s10, v60
    buffer_load_dwordx4 v64, s[60:63], s4 offen lds
    v_bfe_u32 v65, s5, v57, 2
    v_mad_u32_u24 v65, v65, s10, v61
    buffer_load_dwordx4 v65, s[60:63], s4 offen offset:1024 lds
    v_bfe_u32 v64, s5, v58, 2
    v_mad_u32_u24 v64, v64, s10, v62
    buffer_load_dwordx4 v64, s[60:63], s4 offen offset:2048 lds
    v_bfe_u32 v65, s5, v59, 2
    v_mad_u32_u24 v65, v65, s10, v63
    buffer_load_dwordx4 v65, s[60:63], s4 offen offset:3072 lds
    s_mov_b32 m0, 36864
    s_mov_b32 s4, 81920
    v_bfe_u32 v64, s6, v56, 2
    v_mad_u32_u24 v64, v64, s10, v60
    buffer_load_dwordx4 v64, s[60:63], s4 offen lds
    v_bfe_u32 v65, s6, v57, 2
    v_mad_u32_u24 v65, v65, s10, v61
    buffer_load_dwordx4 v65, s[60:63], s4 offen offset:1024 lds
    v_bfe_u32 v64, s6, v58, 2
    v_mad_u32_u24 v64, v64, s10, v62
    buffer_load_dwordx4 v64, s[60:63], s4 offen offset:2048 lds
    v_bfe_u32 v65, s6, v59, 2
    v_mad_u32_u24 v65, v65, s10, v63
    buffer_load_dwordx4 v65, s[60:63], s4 offen offset:3072 lds
    s_mov_b32 m0, 40960
    s_mov_b32 s4, 163840
    v_bfe_u32 v64, s7, v56, 2
    v_mad_u32_u24 v64, v64, s10, v60
    buffer_load_dwordx4 v64, s[60:63], s4 offen lds
    v_bfe_u32 v65, s7, v57, 2
    v_mad_u32_u24 v65, v65, s10, v61
    buffer_load_dwordx4 v65, s[60:63], s4 offen offset:1024 lds
    v_bfe_u32 v64, s7, v58, 2
    v_mad_u32_u24 v64, v64, s10, v62
    buffer_load_dwordx4 v64, s[60:63], s4 offen offset:2048 lds
    v_bfe_u32 v65, s7, v59, 2
    v_mad_u32_u24 v65, v65, s10, v63
    buffer_load_dwordx4 v65, s[60:63], s4 offen offset:3072 lds
    s_mov_b32 m0, 45056
    s_mov_b32 s4, 245760
    v_bfe_u32 v64, s8, v56, 2
    v_mad_u32_u24 v64, v64, s10, v60
    buffer_load_dwordx4 v64, s[60:63], s4 offen lds
    v_bfe_u32 v65, s8, v57, 2
    v_mad_u32_u24 v65, v65, s10, v61
    buffer_load_dwordx4 v65, s[60:63], s4 offen offset:1024 lds
    v_bfe_u32 v64, s8, v58, 2
    v_mad_u32_u24 v64, v64, s10, v62
    buffer_load_dwordx4 v64, s[60:63], s4 offen offset:2048 lds
    v_bfe_u32 v65, s8, v59, 2
    v_mad_u32_u24 v65, v65, s10, v63
    buffer_load_dwordx4 v65, s[60:63], s4 offen offset:3072 lds
    s_mov_b32 m0, 63616
    s_mov_b32 s4, 327680
    v_bfe_u32 v64, s9, v56, 2
    v_mad_u32_u24 v64, v64, s10, v60
    buffer_load_dwordx4 v64, s[60:63], s4 offen lds
    v_bfe_u32 v65, s9, v57, 2
    v_mad_u32_u24 v65, v65, s10, v61
    buffer_load_dwordx4 v65, s[60:63], s4 offen offset:1024 lds
    v_bfe_u32 v64, s9, v58, 2
    v_mad_u32_u24 v64, v64, s10, v62
    buffer_load_dwordx4 v64, s[60:63], s4 offen offset:2048 lds
    v_bfe_u32 v65, s9, v59, 2
    v_mad_u32_u24 v65, v65, s10, v63
    buffer_load_dwordx4 v65, s[60:63], s4 offen offset:3072 lds
    s_mov_b32 m0, 67712
    s_mov_b32 s4, 409600
    v_bfe_u32 v64, s5, v56, 2
    v_mad_u32_u24 v64, v64, s10, v60
    buffer_load_dwordx4 v64, s[60:63], s4 offen lds
    v_bfe_u32 v65, s5, v57, 2
    v_mad_u32_u24 v65, v65, s10, v61
    buffer_load_dwordx4 v65, s[60:63], s4 offen offset:1024 lds
    v_bfe_u32 v64, s5, v58, 2
    v_mad_u32_u24 v64, v64, s10, v62
    buffer_load_dwordx4 v64, s[60:63], s4 offen offset:2048 lds
    v_bfe_u32 v65, s5, v59, 2
    v_mad_u32_u24 v65, v65, s10, v63
    buffer_load_dwordx4 v65, s[60:63], s4 offen offset:3072 lds
    s_mov_b32 m0, 71808
    s_mov_b32 s4, 491520
    v_bfe_u32 v64, s6, v56, 2
    v_mad_u32_u24 v64, v64, s10, v60
    buffer_load_dwordx4 v64, s[60:63], s4 offen lds
    v_bfe_u32 v65, s6, v57, 2
    v_mad_u32_u24 v65, v65, s10, v61
    buffer_load_dwordx4 v65, s[60:63], s4 offen offset:1024 lds
    v_bfe_u32 v64, s6, v58, 2
    v_mad_u32_u24 v64, v64, s10, v62
    buffer_load_dwordx4 v64, s[60:63], s4 offen offset:2048 lds
    v_bfe_u32 v65, s6, v59, 2
    v_mad_u32_u24 v65, v65, s10, v63
    buffer_load_dwordx4 v65, s[60:63], s4 offen offset:3072 lds
    s_mov_b32 m0, 75904
    s_mov_b32 s4, 573440
    v_bfe_u32 v64, s7, v56, 2
    v_mad_u32_u24 v64, v64, s10, v60
    buffer_load_dwordx4 v64, s[60:63], s4 offen lds
    v_bfe_u32 v65, s7, v57, 2
    v_mad_u32_u24 v65, v65, s10, v61
    buffer_load_dwordx4 v65, s[60:63], s4 offen offset:1024 lds
    v_bfe_u32 v64, s7, v58, 2
    v_mad_u32_u24 v64, v64, s10, v62
    buffer_load_dwordx4 v64, s[60:63], s4 offen offset:2048 lds
    v_bfe_u32 v65, s7, v59, 2
    v_mad_u32_u24 v65, v65, s10, v63
    buffer_load_dwordx4 v65, s[60:63], s4 offen offset:3072 lds
    s_mov_b32 m0, 49152
    s_mov_b32 s4, 655360
    v_bfe_u32 v64, s8, v56, 2
    v_mad_u32_u24 v64, v64, s10, v60
    buffer_load_dwordx4 v64, s[60:63], s4 offen lds
    v_bfe_u32 v65, s8, v57, 2
    v_mad_u32_u24 v65, v65, s10, v61
    buffer_load_dwordx4 v65, s[60:63], s4 offen offset:1024 lds
    v_bfe_u32 v64, s8, v58, 2
    v_mad_u32_u24 v64, v64, s10, v62
    buffer_load_dwordx4 v64, s[60:63], s4 offen offset:2048 lds
    v_bfe_u32 v65, s8, v59, 2
    v_mad_u32_u24 v65, v65, s10, v63
    buffer_load_dwordx4 v65, s[60:63], s4 offen offset:3072 lds
    s_mov_b32 m0, 88192
    s_mov_b32 s4, 737280
    v_bfe_u32 v64, s9, v56, 2
    v_mad_u32_u24 v64, v64, s10, v60
    buffer_load_dwordx4 v64, s[60:63], s4 offen lds
    v_bfe_u32 v65, s9, v57, 2
    v_mad_u32_u24 v65, v65, s10, v61
    buffer_load_dwordx4 v65, s[60:63], s4 offen offset:1024 lds
    v_bfe_u32 v64, s9, v58, 2
    v_mad_u32_u24 v64, v64, s10, v62
    buffer_load_dwordx4 v64, s[60:63], s4 offen offset:2048 lds
    v_bfe_u32 v65, s9, v59, 2
    v_mad_u32_u24 v65, v65, s10, v63
    buffer_load_dwordx4 v65, s[60:63], s4 offen offset:3072 lds
    s_waitcnt vmcnt(0)
Lbc:
    v_readfirstlane_b32 s11, v70
    v_readfirstlane_b32 s36, v71
    v_readfirstlane_b32 s12, v72
    v_readfirstlane_b32 s37, v73
    s_cmp_eq_u32 s36, s34
    s_cselect_b32 s37, s37, s36
    s_cmp_eq_u32 s37, s34
    s_cbranch_scc1 Lbc_ok
Lbc_re:
    s_sub_u32 s35, s35, 1
    s_cbranch_scc1 Lend
    buffer_load_dwordx4 v[70:73], v69, s[28:31], 0 offen sc1
    s_waitcnt vmcnt(0)
    s_branch Lbc
Lbc_ok:
    s_mul_i32 s36, s32, 96
    s_and_b32 s13, s11, 0x7ff
    s_sub_u32 s13, 2047, s13
    s_sub_u32 s37, s13, s36
    s_cmp_lt_u32 s37, 96
    s_cselect_b32 s13, s13, -1
    s_and_b32 s14, s12, 0x7ff
    s_sub_u32 s14, 2047, s14
    s_sub_u32 s37, s14, s36
    s_cmp_lt_u32 s37, 96
    s_cselect_b32 s14, s14, -1
    v_mov_b32 v4, s13
    v_mov_b32 v5, s14
    v_mov_b32 v6, 157960
    s_cmp_lg_u32 s3, 0
    s_cbranch_scc1 Lag2
    ds_write_b64 v6, v[4:5]
    s_branch Lw0_done
Lag2:
    s_and_b32 s37, s13, s14
    s_cmp_eq_u32 s37, -1
    s_cbranch_scc1 Lw0_done
    s_max_i32 s36, s13, 0
    s_mul_i32 s36, s36, 1280
    s_lshl_b32 s37, s33, 7
    s_add_u32 s36, s36, s37
    s_add_u32 s36, s36, 4096
    v_lshlrev_b32 v8, 1, v1
    buffer_load_ushort v124, v8, s[44:47], s36 offen
    s_max_i32 s36, s14, 0
    s_mul_i32 s36, s36, 1280
    s_lshl_b32 s37, s33, 7
    s_add_u32 s36, s36, s37
    s_add_u32 s36, s36, 4096
    v_lshlrev_b32 v8, 1, v1
    buffer_load_ushort v125, v8, s[44:47], s36 offen
    v_min_u32 v7, 26, v1
    v_mul_u32_u24 v7, 10240, v7
Ly_poll:
    s_sub_u32 s35, s35, 1
    s_cbranch_scc1 Lend
    s_sleep 4
    s_lshl_b32 s36, s33, 10
    s_add_u32 s36, s36, 7405568
    buffer_load_dword v4, v7, s[28:31], s36 offen offset:1020 sc1
    s_waitcnt vmcnt(0)
    v_cmp_ne_u32 vcc, s34, v4
    s_nop 0
    s_cbranch_vccnz Ly_poll
    buffer_load_dwordx4 v[16:19], v13, s[28:31], s36 offen sc1
    s_add_u32 s36, s36, 10240
    buffer_load_dwordx4 v[20:23], v13, s[28:31], s36 offen sc1
    s_add_u32 s36, s36, 10240
    buffer_load_dwordx4 v[24:27], v13, s[28:31], s36 offen sc1
    s_add_u32 s36, s36, 10240
    buffer_load_dwordx4 v[28:31], v13, s[28:31], s36 offen sc1
    s_add_u32 s36, s36, 10240
    buffer_load_dwordx4 v[32:35], v13, s[28:31], s36 offen sc1
    s_add_u32 s36, s36, 10240
    buffer_load_dwordx4 v[36:39], v13, s[28:31], s36 offen sc1
    s_add_u32 s36, s36, 10240
    buffer_load_dwordx4 v[40:43], v13, s[28:31], s36 offen sc1
    s_add_u32 s36, s36, 10240
    buffer_load_dwordx4 v[44:47], v13, s[28:31], s36 offen sc1
    s_add_u32 s36, s36, 10240
    buffer_load_dwordx4 v[48:51], v13, s[28:31], s36 offen sc1
    s_add_u32 s36, s36, 10240
    buffer_load_dwordx4 v[52:55], v13, s[28:31], s36 offen sc1
    s_add_u32 s36, s36, 10240
    buffer_load_dwordx4 v[56:59], v13, s[28:31], s36 offen sc1
    s_add_u32 s36, s36, 10240
    buffer_load_dwordx4 v[60:63], v13, s[28:31], s36 offen sc1
    s_add_u32 s36, s36, 10240
    buffer_load_dwordx4 v[64:67], v13, s[28:31], s36 offen sc1
    s_add_u32 s36, s36, 10240
    buffer_load_dwordx4 v[68:71], v13, s[28:31], s36 offen sc1
    s_add_u32 s36, s36, 10240
    buffer_load_dwordx4 v[72:75], v13, s[28:31], s36 offen sc1
    s_add_u32 s36, s36, 10240
    buffer_load_dwordx4 v[76:79], v13, s[28:31], s36 offen sc1
    s_add_u32 s36, s36, 10240
    buffer_load_dwordx4 v[80:83], v13, s[28:31], s36 offen sc1
    s_add_u32 s36, s36, 10240
    buffer_load_dwordx4 v[84:87], v13, s[28:31], s36 offen sc1
    s_add_u32 s36, s36, 10240
    buffer_load_dwordx4 v[88:91], v13, s[28:31], s36 offen sc1
    s_add_u32 s36, s36, 10240
    buffer_load_dwordx4 v[92:95], v13, s[28:31], s36 offen sc1
    s_add_u32 s36, s36, 10240
    buffer_load_dwordx4 v[96:99], v13, s[28:31], s36 offen sc1
    s_add_u32 s36, s36, 10240
    buffer_load_dwordx4 v[100:103], v13, s[28:31], s36 offen sc1
    s_add_u32 s36, s36, 10240
    buffer_load_dwordx4 v[104:107], v13, s[28:31], s36 offen sc1
    s_add_u32 s36, s36, 10240
    buffer_load_dwordx4 v[108:111], v13, s[28:31], s36 offen sc1
    s_add_u32 s36, s36, 10240
    buffer_load_dwordx4 v[112:115], v13, s[28:31], s36 offen sc1
    s_add_u32 s36, s36, 10240
    buffer_load_dwordx4 v[116:119], v13, s[28:31], s36 offen sc1
    s_add_u32 s36, s36, 10240
    buffer_load_dwordx4 v[120:123], v13, s[28:31], s36 offen sc1
    s_add_u32 s36, s36, 10240
    s_waitcnt vmcnt(0)
    v_xor_b32 v4, s34, v17
    v_xor_b32 v5, s34, v19
    v_or_b32 v4, v4, v5
    v_xor_b32 v5, s34, v21
    v_or_b32 v4, v4, v5
    v_xor_b32 v5, s34, v23
    v_or_b32 v4, v4, v5
    v_xor_b32 v5, s34, v25
    v_or_b32 v4, v4, v5
    v_xor_b32 v5, s34, v27
    v_or_b32 v4, v4, v5
    v_xor_b32 v5, s34, v29
    v_or_b32 v4, v4, v5
    v_xor_b32 v5, s34, v31
    v_or_b32 v4, v4, v5
    v_xor_b32 v5, s34, v33
    v_or_b32 v4, v4, v5
    v_xor_b32 v5, s34, v35
    v_or_b32 v4, v4, v5
    v_xor_b32 v5, s34, v37
    v_or_b32 v4, v4, v5
    v_xor_b32 v5, s34, v39
    v_or_b32 v4, v4, v5
    v_xor_b32 v5, s34, v41
    v_or_b32 v4, v4, v5
    v_xor_b32 v5, s34, v43
    v_or_b32 v4, v4, v5
    v_xor_b32 v5, s34, v45
    v_or_b32 v4, v4, v5
    v_xor_b32 v5, s34, v47
    v_or_b32 v4, v4, v5
    v_xor_b32 v5, s34, v49
    v_or_b32 v4, v4, v5
    v_xor_b32 v5, s34, v51
    v_or_b32 v4, v4, v5
    v_xor_b32 v5, s34, v53
    v_or_b32 v4, v4, v5
    v_xor_b32 v5, s34, v55
    v_or_b32 v4, v4, v5
    v_xor_b32 v5, s34, v57
    v_or_b32 v4, v4, v5
    v_xor_b32 v5, s34, v59
    v_or_b32 v4, v4, v5
    v_xor_b32 v5, s34, v61
    v_or_b32 v4, v4, v5
    v_xor_b32 v5, s34, v63
    v_or_b32 v4, v4, v5
    v_xor_b32 v5, s34, v65
    v_or_b32 v4, v4, v5
    v_xor_b32 v5, s34, v67
    v_or_b32 v4, v4, v5
    v_xor_b32 v5, s34, v69
    v_or_b32 v4, v4, v5
    v_xor_b32 v5, s34, v71
    v_or_b32 v4, v4, v5
    v_xor_b32 v5, s34, v73
    v_or_b32 v4, v4, v5
    v_xor_b32 v5, s34, v75
    v_or_b32 v4, v4, v5
    v_xor_b32 v5, s34, v77
    v_or_b32 v4, v4, v5
    v_xor_b32 v5, s34, v79
    v_or_b32 v4, v4, v5
    v_xor_b32 v5, s34, v81
    v_or_b32 v4, v4, v5
    v_xor_b32 v5, s34, v83
    v_or_b32 v4, v4, v5
    v_xor_b32 v5, s34, v85
    v_or_b32 v4, v4, v5
    v_xor_b32 v5, s34, v87
    v_or_b32 v4, v4, v5
    v_xor_b32 v5, s34, v89
    v_or_b32 v4, v4, v5
    v_xor_b32 v5, s34, v91
    v_or_b32 v4, v4, v5
    v_xor_b32 v5, s34, v93
    v_or_b32 v4, v4, v5
    v_xor_b32 v5, s34, v95
    v_or_b32 v4, v4, v5
    v_xor_b32 v5, s34, v97
    v_or_b32 v4, v4, v5
    v_xor_b32 v5, s34, v99
    v_or_b32 v4, v4, v5
    v_xor_b32 v5, s34, v101
    v_or_b32 v4, v4, v5
    v_xor_b32 v5, s34, v103
    v_or_b32 v4, v4, v5
    v_xor_b32 v5, s34, v105
    v_or_b32 v4, v4, v5
    v_xor_b32 v5, s34, v107
    v_or_b32 v4, v4, v5
    v_xor_b32 v5, s34, v109
    v_or_b32 v4, v4, v5
    v_xor_b32 v5, s34, v111
    v_or_b32 v4, v4, v5
    v_xor_b32 v5, s34, v113
    v_or_b32 v4, v4, v5
    v_xor_b32 v5, s34, v115
    v_or_b32 v4, v4, v5
    v_xor_b32 v5, s34, v117
    v_or_b32 v4, v4, v5
    v_xor_b32 v5, s34, v119
    v_or_b32 v4, v4, v5
    v_xor_b32 v5, s34, v121
    v_or_b32 v4, v4, v5
    v_xor_b32 v5, s34, v123
    v_or_b32 v4, v4, v5
    v_cmp_ne_u32 vcc, 0, v4
    s_nop 0
    s_cmp_lg_u64 vcc, 0
    s_cbranch_scc1 Ly_poll
    v_add_f32 v16, v16, v20
    v_add_f32 v18, v18, v22
    v_add_f32 v16, v16, v24
    v_add_f32 v18, v18, v26
    v_add_f32 v16, v16, v28
    v_add_f32 v18, v18, v30
    v_add_f32 v16, v16, v32
    v_add_f32 v18, v18, v34
    v_add_f32 v16, v16, v36
    v_add_f32 v18, v18, v38
    v_add_f32 v16, v16, v40
    v_add_f32 v18, v18, v42
    v_add_f32 v16, v16, v44
    v_add_f32 v18, v18, v46
    v_add_f32 v16, v16, v48
    v_add_f32 v18, v18, v50
    v_add_f32 v16, v16, v52
    v_add_f32 v18, v18, v54
    v_add_f32 v16, v16, v56
    v_add_f32 v18, v18, v58
    v_add_f32 v16, v16, v60
    v_add_f32 v18, v18, v62
    v_add_f32 v16, v16, v64
    v_add_f32 v18, v18, v66
    v_add_f32 v16, v16, v68
    v_add_f32 v18, v18, v70
    v_add_f32 v16, v16, v72
    v_add_f32 v18, v18, v74
    v_add_f32 v16, v16, v76
    v_add_f32 v18, v18, v78
    v_add_f32 v16, v16, v80
    v_add_f32 v18, v18, v82
    v_add_f32 v16, v16, v84
    v_add_f32 v18, v18, v86
    v_add_f32 v16, v16, v88
    v_add_f32 v18, v18, v90
    v_add_f32 v16, v16, v92
    v_add_f32 v18, v18, v94
    v_add_f32 v16, v16, v96
    v_add_f32 v18, v18, v98
    v_add_f32 v16, v16, v100
    v_add_f32 v18, v18, v102
    v_add_f32 v16, v16, v104
    v_add_f32 v18, v18, v106
    v_add_f32 v16, v16, v108
    v_add_f32 v18, v18, v110
    v_add_f32 v16, v16, v112
    v_add_f32 v18, v18, v114
    v_add_f32 v16, v16, v116
    v_add_f32 v18, v18, v118
    v_add_f32 v16, v16, v120
    v_add_f32 v18, v18, v122
    s_lshr_b32 s36, s11, 16
    s_cmp_ge_u32 s36, 0x8000
    s_cselect_b32 s37, 0x8000, -1
    s_xor_b32 s36, s36, s37
    s_lshl_b32 s36, s36, 16
    v_mov_b32 v4, s36
    v_mul_f32 v4, 0xbfb8aa3b, v4
    v_exp_f32 v4, v4
    s_nop 0
    v_add_f32 v4, 1.0, v4
    v_rcp_f32 v4, v4
    s_nop 0
    v_cvt_pk_bf16_f32 v4, v4, v4
    v_lshlrev_b32 v4, 16, v4
    v_cvt_pk_bf16_f32 v16, v16, v16
    v_lshlrev_b32 v16, 16, v16
    v_mul_f32 v16, v16, v4
    v_cvt_pk_bf16_f32 v16, v16, v16
    v_lshlrev_b32 v16, 16, v16
    s_lshr_b32 s36, s12, 16
    s_cmp_ge_u32 s36, 0x8000
    s_cselect_b32 s37, 0x8000, -1
    s_xor_b32 s36, s36, s37
    s_lshl_b32 s36, s36, 16
    v_mov_b32 v4, s36
    v_mul_f32 v4, 0xbfb8aa3b, v4
    v_exp_f32 v4, v4
    s_nop 0
    v_add_f32 v4, 1.0, v4
    v_rcp_f32 v4, v4
    s_nop 0
    v_cvt_pk_bf16_f32 v4, v4, v4
    v_lshlrev_b32 v4, 16, v4
    v_cvt_pk_bf16_f32 v18, v18, v18
    v_lshlrev_b32 v18, 16, v18
    v_mul_f32 v18, v18, v4
    v_cvt_pk_bf16_f32 v18, v18, v18
    v_lshlrev_b32 v18, 16, v18
    s_mul_i32 s36, s32, 96
    s_sub_u32 s36, s13, s36
    s_max_i32 s36, s36, 0
    s_lshl_b32 s36, s36, 2
    s_add_u32 s36, s36, 156288
    v_mov_b32 v4, s36
    ds_read2st64_b32 v[4:5], v4 offset0:0 offset1:2
    v_lshlrev_b32 v124, 16, v124
    s_waitcnt lgkmcnt(0)
    v_add_f32 v20, v124, v4
    v_cvt_pk_bf16_f32 v20, v20, v20
    v_lshlrev_b32 v20, 16, v20
    v_mul_f32 v20, v20, v5
    v_cvt_pk_bf16_f32 v20, v20, v20
    v_lshlrev_b32 v20, 16, v20
    v_add_f32 v20, v20, v16
    v_cvt_pk_bf16_f32 v20, v20, v20
    v_lshlrev_b32 v20, 16, v20
    v_mul_f32 v16, 0xbfb8aa3b, v20
    v_exp_f32 v16, v16
    s_nop 0
    v_add_f32 v16, 1.0, v16
    v_rcp_f32 v16, v16
    s_nop 0
    v_mul_f32 v16, v16, v20
    v_cvt_pk_bf16_f32 v16, v16, v16
    v_lshlrev_b32 v16, 16, v16
    s_mul_i32 s36, s32, 96
    s_sub_u32 s36, s14, s36
    s_max_i32 s36, s36, 0
    s_lshl_b32 s36, s36, 2
    s_add_u32 s36, s36, 156288
    v_mov_b32 v4, s36
    ds_read2st64_b32 v[4:5], v4 offset0:0 offset1:2
    v_lshlrev_b32 v125, 16, v125
    s_waitcnt lgkmcnt(0)
    v_add_f32 v22, v125, v4
    v_cvt_pk_bf16_f32 v22, v22, v22
    v_lshlrev_b32 v22, 16, v22
    v_mul_f32 v22, v22, v5
    v_cvt_pk_bf16_f32 v22, v22, v22
    v_lshlrev_b32 v22, 16, v22
    v_add_f32 v22, v22, v18
    v_cvt_pk_bf16_f32 v22, v22, v22
    v_lshlrev_b32 v22, 16, v22
    v_mul_f32 v18, 0xbfb8aa3b, v22
    v_exp_f32 v18, v18
    s_nop 0
    v_add_f32 v18, 1.0, v18
    v_rcp_f32 v18, v18
    s_nop 0
    v_mul_f32 v18, v18, v22
    v_cvt_pk_bf16_f32 v18, v18, v18
    v_lshlrev_b32 v18, 16, v18
    v_add_u32 v5, 158208, v12
    ds_write2st64_b32 v5, v16, v18 offset0:0 offset1:1
    v_mov_b32 v6, 157956
    v_mov_b32 v7, 1
    s_mov_b64 exec, 1
    ds_add_u32 v6, v7
    s_mov_b64 exec, -1
Lw0_done:
    s_endpgm
Lagent:
    s_sub_u32 s44, s4, 4096
    s_subb_u32 s45, s5, 0
    s_mov_b32 s46, 2625536
    s_mov_b32 s47, 0x20000
    s_lshl_b32 s36, s32, 7
    s_add_u32 s36, s36, 8257536
    v_mov_b32 v69, s36
    s_branch Lbc_re
Lcomp:
    s_lshl_b32 s44, s26, 1
    s_add_u32 s44, s44, s27
    s_sub_u32 s36, s33, 5
    s_cmp_ge_u32 s33, 5
    s_cselect_b32 s40, s36, s33
    s_mov_b32 s41, 0xbfe10856
    s_cmp_eq_u32 s40, 1
    s_cselect_b32 s41, 0xaff80255, s41
    s_cmp_eq_u32 s40, 2
    s_cselect_b32 s41, 0xabfe4015, s41
    s_cmp_eq_u32 s40, 3
    s_cselect_b32 s41, 0xaa7fd005, s41
    s_cmp_eq_u32 s40, 4
    s_cselect_b32 s41, 0x6adfb401, s41
    s_lshl_b32 s37, s27, 13
    s_cmp_eq_u32 s44, 1
    s_cselect_b32 s37, 0, s37
    v_bfe_u32 v7, v1, 2, 2
    v_and_b32 v8, 3, v1
    v_lshl_add_u32 v18, v2, 3, v7
    v_lshlrev_b32 v18, 7, v18
    v_lshlrev_b32 v19, 2, v1
    v_and_b32 v19, 0x60, v19
    v_lshlrev_b32 v10, 1, v8
    v_add_u32 v9, s37, v18
    v_add_u32 v11, 0, v10
    v_bfe_u32 v11, s41, v11, 2
    v_lshl_add_u32 v11, v11, 2, v8
    v_lshlrev_b32 v11, 3, v11
    v_xad_u32 v20, v11, v19, v9
    v_add_u32 v11, 8, v10
    v_bfe_u32 v11, s41, v11, 2
    v_lshl_add_u32 v11, v11, 2, v8
    v_lshlrev_b32 v11, 3, v11
    v_xad_u32 v21, v11, v19, v9
    v_add_u32 v11, 16, v10
    v_bfe_u32 v11, s41, v11, 2
    v_lshl_add_u32 v11, v11, 2, v8
    v_lshlrev_b32 v11, 3, v11
    v_xad_u32 v22, v11, v19, v9
    v_add_u32 v11, 24, v10
    v_bfe_u32 v11, s41, v11, 2
    v_lshl_add_u32 v11, v11, 2, v8
    v_lshlrev_b32 v11, 3, v11
    v_xad_u32 v23, v11, v19, v9
    v_add_u32 v24, 78080, v20
    v_add_u32 v25, 78080, v21
    v_add_u32 v26, 78080, v22
    v_add_u32 v27, 78080, v23
    v_lshrrev_b32 v10, 1, v3
    v_xor_b32 v9, v10, v2
    v_lshlrev_b32 v9, 4, v9
    v_lshl_add_u32 v9, v3, 7, v9
    s_lshl_b32 s36, s44, 11
    s_xor_b32 s38, s36, 2048
    s_add_u32 s36, s36, 22528
    s_add_u32 s38, s38, 22528
    v_add_u32 v76, s36, v9
    v_add_u32 v78, s38, v9
    s_mul_i32 s39, s26, 6144
    s_add_u32 s39, s39, 98560
    v_add_u32 v125, s39, v13
    s_lshl_b32 s45, s44, 11
    s_add_u32 s45, s45, 139648
    s_waitcnt lgkmcnt(0)
    s_mov_b64 s[28:29], s[24:25]
    s_mov_b32 s30, 268435456
    s_mov_b32 s31, 0x20000
    s_load_dword s34, s[28:29], 0
    s_cmp_eq_u32 s44, 1
    s_cbranch_scc1 Lhalo
    v_xor_b32 v77, 64, v76
    v_xor_b32 v79, 64, v78
    v_add_u32 v80, 78080, v76
    v_add_u32 v81, 78080, v77
    v_add_u32 v82, 78080, v78
    v_add_u32 v83, 78080, v79
    s_cmp_eq_u32 s27, 0
    s_cselect_b64 vcc, 0, -1
    s_sub_u32 s37, 16384, s37
    v_cndmask_b32 v84, v20, v22, vcc
    v_cndmask_b32 v85, v21, v23, vcc
    v_add_u32 v84, s37, v84
    v_add_u32 v85, s37, v85
    v_add_u32 v86, 78080, v84
    v_add_u32 v87, 78080, v85
    v_lshrrev_b32 v8, 1, v2
    v_xor_b32 v8, v8, v10
    v_lshlrev_b32 v8, 4, v8
    v_lshl_add_u32 v8, v3, 7, v8
    v_and_b32 v7, 1, v2
    v_lshl_add_u32 v124, v7, 3, v8
    s_mov_b32 s46, 0
    s_mov_b32 s38, 0x86542310
    s_mov_b32 s39, 0x97
    s_cmp_eq_u32 s42, 1
    s_cselect_b32 s38, 0x76453210, s38
    s_cselect_b32 s39, 0x98, s39
    s_cmp_eq_u32 s42, 2
    s_cselect_b32 s38, 0x67543120, s38
    s_cselect_b32 s39, 0x98, s39
    s_cmp_eq_u32 s42, 3
    s_cselect_b32 s38, 0x76534201, s38
    s_cselect_b32 s39, 0x89, s39
    s_cmp_eq_u32 s42, 4
    s_cselect_b32 s38, 0x75643201, s38
    s_cselect_b32 s39, 0x98, s39
    s_sub_u32 s42, s33, s43
    s_cselect_b32 s43, 10, 0
    s_add_u32 s42, s42, s43
    s_lshl_b32 s42, s42, 2
    s_lshr_b64 s[38:39], s[38:39], s42
    s_and_b32 s42, s38, 15
    s_and_b32 s38, s42, 3
    s_mul_i32 s38, s38, 39040
    s_add_u32 s38, s38, s36
    v_add_u32 v4, s38, v124
    v_xor_b32 v5, 32, v4
    v_xor_b32 v6, 64, v4
    v_xor_b32 v7, 0x60, v4
    s_mov_b64 s[48:49], s[20:21]
    s_mov_b32 s50, 2621440
    s_mov_b32 s51, 0x20000
    v_mov_b32 v14, 0x3f803f80
    v_mov_b32 v15, 0x3f803f80
    v_mov_b32 v16, 0x3f803f80
    v_mov_b32 v17, 0x3f803f80
    s_mov_b32 s4, 0xaae00455
    s_cmp_eq_u32 s40, 1
    s_cselect_b32 s4, 0xaaf80155, s4
    s_cmp_eq_u32 s40, 2
    s_cselect_b32 s4, 0xaafe4055, s4
    s_cmp_eq_u32 s40, 3
    s_cselect_b32 s4, 0xaabfd055, s4
    s_cmp_eq_u32 s40, 4
    s_cselect_b32 s4, 0xaaeff455, s4
    v_lshlrev_b32 v10, 1, v2
    v_add_u32 v10, 8, v10
    v_bfe_u32 v10, s4, v10, 2
    v_cmp_eq_u32 s[6:7], 0, v10
    v_cmp_eq_u32 s[8:9], 3, v10
    v_cmp_eq_u32 s[10:11], 1, v10
    v_lshlrev_b32 v10, 1, v2
    v_add_u32 v10, 16, v10
    v_bfe_u32 v10, s4, v10, 2
    v_cmp_eq_u32 s[12:13], 0, v10
    v_cmp_eq_u32 s[14:15], 3, v10
    v_cmp_eq_u32 s[16:17], 2, v10
    s_mov_b32 s4, 0xaaaaaaaa
    s_mov_b32 s5, 0xaaaaaaaa
    s_mov_b32 s18, 0xfff0ffff
    s_mov_b32 s19, 0xf000ff00
    s_mov_b32 s20, 0xffc0fffc
    s_mov_b32 s21, 0xc000fc00
    v_mov_b32 v8, 0xffff
    v_not_b32 v9, v8
    v_cndmask_b32 v8, v8, v9, s[4:5]
    v_cndmask_b32 v118, 0, v8, s[18:19]
    v_cndmask_b32 v119, 0, v8, s[20:21]
    v_xor_b32 v116, v118, v8
    v_xor_b32 v117, v119, v8
    s_cmp_eq_u32 s32, 0
    s_cselect_b32 s36, s44, 0
    s_cmp_eq_u32 s36, 2
    s_cselect_b32 s22, 0xff800000, 0
    s_mul_i32 s36, s32, 6
    s_add_u32 s36, s36, s44
    s_sub_u32 s36, s36, 2
    s_lshl_b32 s24, s36, 7
    s_add_u32 s24, s24, 7340032
    s_mul_i32 s52, s36, 20480
    s_add_u32 s52, s52, 4194304
    s_lshl_b32 s36, s33, 11
    s_add_u32 s23, s36, s52
    s_add_u32 s53, s52, s46
    s_add_u32 s46, s46, 4096
    s_cmp_eq_u32 s46, 20480
    s_cselect_b32 s46, 0, s46
    s_add_u32 s54, s52, s46
    s_add_u32 s46, s46, 4096
    s_cmp_eq_u32 s46, 20480
    s_cselect_b32 s46, 0, s46
    s_add_u32 s55, s52, s46
    s_add_u32 s46, s46, 4096
    s_cmp_eq_u32 s46, 20480
    s_cselect_b32 s46, 0, s46
    s_add_u32 s56, s52, s46
    s_add_u32 s46, s46, 4096
    s_cmp_eq_u32 s46, 20480
    s_cselect_b32 s46, 0, s46
    s_add_u32 s57, s52, s46
    s_add_u32 s46, s46, 4096
    s_cmp_eq_u32 s46, 20480
    s_cselect_b32 s46, 0, s46
    s_mul_i32 s36, s32, 10
    s_add_u32 s36, s36, s33
    s_mul_i32 s58, s36, 6144
    s_lshl_b32 s36, s44, 10
    s_add_u32 s58, s58, s36
    s_add_u32 s58, s58, 1046528
    s_sub_u32 s59, s58, 6144
    s_add_u32 s60, s58, 6144
    s_cmp_eq_u32 s40, 0
    s_cselect_b32 s61, 0, -1
    s_cmp_eq_u32 s40, 4
    s_cselect_b32 s62, 0, -1
    s_lshl_b32 s36, s33, 2
    v_mov_b32 v97, s36
    s_mov_b32 s25, 0x3ea52b5c
    s_lshl_b32 s36, s44, 6
    s_add_u32 s36, s36, 156160
    v_lshl_add_u32 v94, v3, 2, s36
    v_and_b32 v8, 1, v1
    v_lshl_add_u32 v8, v2, 2, v8
    v_lshl_add_u32 v8, v8, 2, s36
    v_subrev_u32 v9, 64, v8
    v_cndmask_b32 v92, v9, v8, s[18:19]
    v_cndmask_b32 v93, v9, v8, s[20:21]
    v_lshlrev_b32 v95, 4, v2
    s_lshl_b32 s36, s27, 8
    s_add_u32 s36, s36, 157184
    v_add_u32 v95, s36, v95
    v_mov_b32 v96, 157968
    s_lshl_b32 s36, s27, 11
    v_add_u32 v99, s36, v125
    v_mov_b32 v100, -1
    v_mov_b32 v101, -1
    v_mov_b32 v102, -1
    v_mov_b32 v103, -1
    v_mov_b32 v127, 157984
    s_lshl_b32 s36, s3, 2
    s_add_u32 s36, s36, 158016
    v_mov_b32 v10, s36
    v_xor_b32 v11, 16, v10
    v_cndmask_b32 v127, v127, v11, s[4:5]
    s_waitcnt vmcnt(0)
    s_waitcnt lgkmcnt(0)
    s_barrier
    ds_read_b128 a[64:67], v76 offset:0
    ds_read_b128 a[68:71], v78 offset:0
    ds_read_b64_tr_b16 a[80:81], v20 offset:0
    ds_read_b64_tr_b16 a[82:83], v20 offset:512
    ds_read_b64_tr_b16 a[84:85], v21 offset:0
    ds_read_b64_tr_b16 a[86:87], v21 offset:512
    ds_read_b64_tr_b16 a[88:89], v22 offset:0
    ds_read_b64_tr_b16 a[90:91], v22 offset:512
    ds_read_b64_tr_b16 a[92:93], v23 offset:0
    ds_read_b64_tr_b16 a[94:95], v23 offset:512
    ds_read_b64_tr_b16 a[96:97], v84 offset:0
    ds_read_b64_tr_b16 a[98:99], v84 offset:512
    ds_read_b64_tr_b16 a[100:101], v85 offset:0
    ds_read_b64_tr_b16 a[102:103], v85 offset:512
    s_add_u32 s34, s34, 0x9e3779b8
    s_or_b32 s34, s34, 1
    s_cmp_eq_u32 s42, 0
    s_cbranch_scc1 Lxe0
Lxe0_b:
    s_setprio 1
    s_waitcnt lgkmcnt(10)
    v_mfma_f32_16x16x32_bf16 v[28:31], a[80:83], a[64:67], 0
    ds_read_b128 a[72:75], v77 offset:0
    ds_read_b128 a[76:79], v79 offset:0
    v_mfma_f32_16x16x32_bf16 v[44:47], a[80:83], a[68:71], 0
    ds_read_b64_tr_b16 a[104:105], v20 offset:4096
    s_waitcnt lgkmcnt(11)
    v_mfma_f32_16x16x32_bf16 v[48:51], a[84:87], a[68:71], 0
    ds_read_b64_tr_b16 a[106:107], v20 offset:4608
    v_mfma_f32_16x16x32_bf16 v[32:35], a[84:87], a[64:67], 0
    ds_read_b64_tr_b16 a[108:109], v21 offset:4096
    s_waitcnt lgkmcnt(11)
    v_mfma_f32_16x16x32_bf16 v[36:39], a[88:91], a[64:67], 0
    ds_read_b64_tr_b16 a[110:111], v21 offset:4608
    ds_read_b64_tr_b16 a[112:113], v22 offset:4096
    v_mfma_f32_16x16x32_bf16 v[52:55], a[88:91], a[68:71], 0
    ds_read_b64_tr_b16 a[114:115], v22 offset:4608
    s_setprio 0
    s_waitcnt lgkmcnt(12)
    v_mfma_f32_16x16x32_bf16 v[56:59], a[92:95], a[68:71], 0
    ds_read_b64_tr_b16 a[116:117], v23 offset:4096
    v_mfma_f32_16x16x32_bf16 v[40:43], a[92:95], a[64:67], 0
    ds_read_b64_tr_b16 a[118:119], v23 offset:4608
    s_waitcnt lgkmcnt(12)
    v_mfma_f32_16x16x32_bf16 v[60:63], a[64:67], a[96:99], 0
    ds_read_b64_tr_b16 a[120:121], v84 offset:4096
    v_mfma_f32_16x16x32_bf16 v[68:71], a[68:71], a[96:99], 0
    ds_read_b64_tr_b16 a[122:123], v84 offset:4608
    s_waitcnt lgkmcnt(12)
    v_mfma_f32_16x16x32_bf16 v[72:75], a[68:71], a[100:103], 0
    ds_read_b64_tr_b16 a[124:125], v85 offset:4096
    v_mfma_f32_16x16x32_bf16 v[64:67], a[64:67], a[100:103], 0
    ds_read_b64_tr_b16 a[126:127], v85 offset:4608
    s_barrier
    s_setprio 3
    s_waitcnt lgkmcnt(10)
    v_mfma_f32_16x16x32_bf16 v[28:31], a[104:107], a[72:75], v[28:31]
    ds_read_b128 a[64:67], v76 offset:39040
    ds_read_b128 a[68:71], v78 offset:39040
    v_mfma_f32_16x16x32_bf16 v[44:47], a[104:107], a[76:79], v[44:47]
    ds_read_b64_tr_b16 a[80:81], v20 offset:39040
    s_waitcnt lgkmcnt(11)
    v_mfma_f32_16x16x32_bf16 v[48:51], a[108:111], a[76:79], v[48:51]
    ds_read_b64_tr_b16 a[82:83], v20 offset:39552
    v_mfma_f32_16x16x32_bf16 v[32:35], a[108:111], a[72:75], v[32:35]
    ds_read_b64_tr_b16 a[84:85], v21 offset:39040
    s_waitcnt lgkmcnt(11)
    v_mfma_f32_16x16x32_bf16 v[36:39], a[112:115], a[72:75], v[36:39]
    ds_read_b64_tr_b16 a[86:87], v21 offset:39552
    v_mfma_f32_16x16x32_bf16 v[52:55], a[112:115], a[76:79], v[52:55]
    ds_read_b64_tr_b16 a[88:89], v22 offset:39040
    s_setprio 2
    s_waitcnt lgkmcnt(11)
    v_mfma_f32_16x16x32_bf16 v[56:59], a[116:119], a[76:79], v[56:59]
    ds_read_b64_tr_b16 a[90:91], v22 offset:39552
    ds_read_b64_tr_b16 a[92:93], v23 offset:39040
    v_mfma_f32_16x16x32_bf16 v[40:43], a[116:119], a[72:75], v[40:43]
    ds_read_b64_tr_b16 a[94:95], v23 offset:39552
    s_waitcnt lgkmcnt(12)
    v_mfma_f32_16x16x32_bf16 v[60:63], a[72:75], a[120:123], v[60:63]
    ds_read_b64_tr_b16 a[96:97], v84 offset:39040
    v_mfma_f32_16x16x32_bf16 v[68:71], a[76:79], a[120:123], v[68:71]
    ds_read_b64_tr_b16 a[98:99], v84 offset:39552
    s_waitcnt lgkmcnt(12)
    v_mfma_f32_16x16x32_bf16 v[72:75], a[76:79], a[124:127], v[72:75]
    ds_read_b64_tr_b16 a[100:101], v85 offset:39040
    v_mfma_f32_16x16x32_bf16 v[64:67], a[72:75], a[124:127], v[64:67]
    ds_read_b64_tr_b16 a[102:103], v85 offset:39552
    s_cmp_eq_u32 s42, 1
    s_cbranch_scc1 Lxe1
Lxe1_b:
    s_setprio 1
    s_waitcnt lgkmcnt(10)
    v_mfma_f32_16x16x32_bf16 v[28:31], a[80:83], a[64:67], v[28:31]
    ds_read_b128 a[72:75], v77 offset:39040
    ds_read_b128 a[76:79], v79 offset:39040
    v_mfma_f32_16x16x32_bf16 v[44:47], a[80:83], a[68:71], v[44:47]
    ds_read_b64_tr_b16 a[104:105], v20 offset:43136
    s_waitcnt lgkmcnt(11)
    v_mfma_f32_16x16x32_bf16 v[48:51], a[84:87], a[68:71], v[48:51]
    ds_read_b64_tr_b16 a[106:107], v20 offset:43648
    v_mfma_f32_16x16x32_bf16 v[32:35], a[84:87], a[64:67], v[32:35]
    ds_read_b64_tr_b16 a[108:109], v21 offset:43136
    s_waitcnt lgkmcnt(11)
    v_mfma_f32_16x16x32_bf16 v[36:39], a[88:91], a[64:67], v[36:39]
    ds_read_b64_tr_b16 a[110:111], v21 offset:43648
    ds_read_b64_tr_b16 a[112:113], v22 offset:43136
    v_mfma_f32_16x16x32_bf16 v[52:55], a[88:91], a[68:71], v[52:55]
    ds_read_b64_tr_b16 a[114:115], v22 offset:43648
    s_setprio 0
    s_waitcnt lgkmcnt(12)
    v_mfma_f32_16x16x32_bf16 v[56:59], a[92:95], a[68:71], v[56:59]
    ds_read_b64_tr_b16 a[116:117], v23 offset:43136
    v_mfma_f32_16x16x32_bf16 v[40:43], a[92:95], a[64:67], v[40:43]
    ds_read_b64_tr_b16 a[118:119], v23 offset:43648
    s_waitcnt lgkmcnt(12)
    v_mfma_f32_16x16x32_bf16 v[60:63], a[64:67], a[96:99], v[60:63]
    ds_read_b64_tr_b16 a[120:121], v84 offset:43136
    v_mfma_f32_16x16x32_bf16 v[68:71], a[68:71], a[96:99], v[68:71]
    ds_read_b64_tr_b16 a[122:123], v84 offset:43648
    s_waitcnt lgkmcnt(12)
    v_mfma_f32_16x16x32_bf16 v[72:75], a[68:71], a[100:103], v[72:75]
    ds_read_b64_tr_b16 a[124:125], v85 offset:43136
    v_mfma_f32_16x16x32_bf16 v[64:67], a[64:67], a[100:103], v[64:67]
    ds_read_b64_tr_b16 a[126:127], v85 offset:43648
    s_barrier
    s_setprio 3
    s_waitcnt lgkmcnt(10)
    v_mfma_f32_16x16x32_bf16 v[28:31], a[104:107], a[72:75], v[28:31]
    ds_read_b128 a[64:67], v80 offset:0
    ds_read_b128 a[68:71], v82 offset:0
    v_mfma_f32_16x16x32_bf16 v[44:47], a[104:107], a[76:79], v[44:47]
    ds_read_b64_tr_b16 a[80:81], v24 offset:0
    s_waitcnt lgkmcnt(11)
    v_mfma_f32_16x16x32_bf16 v[48:51], a[108:111], a[76:79], v[48:51]
    ds_read_b64_tr_b16 a[82:83], v24 offset:512
    v_mfma_f32_16x16x32_bf16 v[32:35], a[108:111], a[72:75], v[32:35]
    ds_read_b64_tr_b16 a[84:85], v25 offset:0
    s_waitcnt lgkmcnt(11)
    v_mfma_f32_16x16x32_bf16 v[36:39], a[112:115], a[72:75], v[36:39]
    ds_read_b64_tr_b16 a[86:87], v25 offset:512
    v_mfma_f32_16x16x32_bf16 v[52:55], a[112:115], a[76:79], v[52:55]
    ds_read_b64_tr_b16 a[88:89], v26 offset:0
    s_setprio 2
    s_waitcnt lgkmcnt(11)
    v_mfma_f32_16x16x32_bf16 v[56:59], a[116:119], a[76:79], v[56:59]
    ds_read_b64_tr_b16 a[90:91], v26 offset:512
    ds_read_b64_tr_b16 a[92:93], v27 offset:0
    v_mfma_f32_16x16x32_bf16 v[40:43], a[116:119], a[72:75], v[40:43]
    ds_read_b64_tr_b16 a[94:95], v27 offset:512
    s_waitcnt lgkmcnt(12)
    v_mfma_f32_16x16x32_bf16 v[60:63], a[72:75], a[120:123], v[60:63]
    ds_read_b64_tr_b16 a[96:97], v86 offset:0
    v_mfma_f32_16x16x32_bf16 v[68:71], a[76:79], a[120:123], v[68:71]
    ds_read_b64_tr_b16 a[98:99], v86 offset:512
    s_waitcnt lgkmcnt(12)
    v_mfma_f32_16x16x32_bf16 v[72:75], a[76:79], a[124:127], v[72:75]
    ds_read_b64_tr_b16 a[100:101], v87 offset:0
    v_mfma_f32_16x16x32_bf16 v[64:67], a[72:75], a[124:127], v[64:67]
    ds_read_b64_tr_b16 a[102:103], v87 offset:512
    buffer_store_dwordx4 v[100:103], v13, s[28:31], s58 offen sc1
    s_cmp_eq_u32 s42, 2
    s_cbranch_scc1 Lxe2
Lxe2_b:
    s_setprio 1
    s_waitcnt lgkmcnt(10)
    v_mfma_f32_16x16x32_bf16 v[28:31], a[80:83], a[64:67], v[28:31]
    ds_read_b128 a[72:75], v81 offset:0
    ds_read_b128 a[76:79], v83 offset:0
    v_mfma_f32_16x16x32_bf16 v[44:47], a[80:83], a[68:71], v[44:47]
    ds_read_b64_tr_b16 a[104:105], v24 offset:4096
    s_waitcnt lgkmcnt(11)
    v_mfma_f32_16x16x32_bf16 v[48:51], a[84:87], a[68:71], v[48:51]
    ds_read_b64_tr_b16 a[106:107], v24 offset:4608
    v_mfma_f32_16x16x32_bf16 v[32:35], a[84:87], a[64:67], v[32:35]
    ds_read_b64_tr_b16 a[108:109], v25 offset:4096
    s_waitcnt lgkmcnt(11)
    v_mfma_f32_16x16x32_bf16 v[36:39], a[88:91], a[64:67], v[36:39]
    ds_read_b64_tr_b16 a[110:111], v25 offset:4608
    ds_read_b64_tr_b16 a[112:113], v26 offset:4096
    v_mfma_f32_16x16x32_bf16 v[52:55], a[88:91], a[68:71], v[52:55]
    ds_read_b64_tr_b16 a[114:115], v26 offset:4608
    s_setprio 0
    s_waitcnt lgkmcnt(12)
    v_mfma_f32_16x16x32_bf16 v[56:59], a[92:95], a[68:71], v[56:59]
    ds_read_b64_tr_b16 a[116:117], v27 offset:4096
    v_mfma_f32_16x16x32_bf16 v[40:43], a[92:95], a[64:67], v[40:43]
    ds_read_b64_tr_b16 a[118:119], v27 offset:4608
    s_waitcnt lgkmcnt(12)
    v_mfma_f32_16x16x32_bf16 v[60:63], a[64:67], a[96:99], v[60:63]
    ds_read_b64_tr_b16 a[120:121], v86 offset:4096
    v_mfma_f32_16x16x32_bf16 v[68:71], a[68:71], a[96:99], v[68:71]
    ds_read_b64_tr_b16 a[122:123], v86 offset:4608
    s_waitcnt lgkmcnt(12)
    v_mfma_f32_16x16x32_bf16 v[72:75], a[68:71], a[100:103], v[72:75]
    ds_read_b64_tr_b16 a[124:125], v87 offset:4096
    v_mfma_f32_16x16x32_bf16 v[64:67], a[64:67], a[100:103], v[64:67]
    ds_read_b64_tr_b16 a[126:127], v87 offset:4608
    s_barrier
    s_setprio 3
    s_waitcnt lgkmcnt(10)
    v_mfma_f32_16x16x32_bf16 v[28:31], a[104:107], a[72:75], v[28:31]
    ds_read_b128 a[64:67], v80 offset:39040
    ds_read_b128 a[68:71], v82 offset:39040
    v_mfma_f32_16x16x32_bf16 v[44:47], a[104:107], a[76:79], v[44:47]
    ds_read_b64_tr_b16 a[80:81], v24 offset:39040
    s_waitcnt lgkmcnt(11)
    v_mfma_f32_16x16x32_bf16 v[48:51], a[108:111], a[76:79], v[48:51]
    ds_read_b64_tr_b16 a[82:83], v24 offset:39552
    v_mfma_f32_16x16x32_bf16 v[32:35], a[108:111], a[72:75], v[32:35]
    ds_read_b64_tr_b16 a[84:85], v25 offset:39040
    s_waitcnt lgkmcnt(11)
    v_mfma_f32_16x16x32_bf16 v[36:39], a[112:115], a[72:75], v[36:39]
    ds_read_b64_tr_b16 a[86:87], v25 offset:39552
    v_mfma_f32_16x16x32_bf16 v[52:55], a[112:115], a[76:79], v[52:55]
    ds_read_b64_tr_b16 a[88:89], v26 offset:39040
    s_setprio 2
    s_waitcnt lgkmcnt(11)
    v_mfma_f32_16x16x32_bf16 v[56:59], a[116:119], a[76:79], v[56:59]
    ds_read_b64_tr_b16 a[90:91], v26 offset:39552
    ds_read_b64_tr_b16 a[92:93], v27 offset:39040
    v_mfma_f32_16x16x32_bf16 v[40:43], a[116:119], a[72:75], v[40:43]
    ds_read_b64_tr_b16 a[94:95], v27 offset:39552
    s_waitcnt lgkmcnt(12)
    v_mfma_f32_16x16x32_bf16 v[60:63], a[72:75], a[120:123], v[60:63]
    ds_read_b64_tr_b16 a[96:97], v86 offset:39040
    v_mfma_f32_16x16x32_bf16 v[68:71], a[76:79], a[120:123], v[68:71]
    ds_read_b64_tr_b16 a[98:99], v86 offset:39552
    s_waitcnt lgkmcnt(12)
    v_mfma_f32_16x16x32_bf16 v[72:75], a[76:79], a[124:127], v[72:75]
    ds_read_b64_tr_b16 a[100:101], v87 offset:39040
    v_mfma_f32_16x16x32_bf16 v[64:67], a[72:75], a[124:127], v[64:67]
    ds_read_b64_tr_b16 a[102:103], v87 offset:39552
    s_cmp_eq_u32 s42, 3
    s_cbranch_scc1 Lxe3
Lxe3_b:
    s_setprio 1
    s_waitcnt lgkmcnt(10)
    v_mfma_f32_16x16x32_bf16 v[28:31], a[80:83], a[64:67], v[28:31]
    ds_read_b128 a[72:75], v81 offset:39040
    ds_read_b128 a[76:79], v83 offset:39040
    v_mfma_f32_16x16x32_bf16 v[44:47], a[80:83], a[68:71], v[44:47]
    ds_read_b64_tr_b16 a[104:105], v24 offset:43136
    s_waitcnt lgkmcnt(11)
    v_mfma_f32_16x16x32_bf16 v[48:51], a[84:87], a[68:71], v[48:51]
    ds_read_b64_tr_b16 a[106:107], v24 offset:43648
    v_mfma_f32_16x16x32_bf16 v[32:35], a[84:87], a[64:67], v[32:35]
    ds_read_b64_tr_b16 a[108:109], v25 offset:43136
    s_waitcnt lgkmcnt(11)
    v_mfma_f32_16x16x32_bf16 v[36:39], a[88:91], a[64:67], v[36:39]
    ds_read_b64_tr_b16 a[110:111], v25 offset:43648
    ds_read_b64_tr_b16 a[112:113], v26 offset:43136
    v_mfma_f32_16x16x32_bf16 v[52:55], a[88:91], a[68:71], v[52:55]
    ds_read_b64_tr_b16 a[114:115], v26 offset:43648
    s_setprio 0
    s_waitcnt lgkmcnt(12)
    v_mfma_f32_16x16x32_bf16 v[56:59], a[92:95], a[68:71], v[56:59]
    ds_read_b64_tr_b16 a[116:117], v27 offset:43136
    v_mfma_f32_16x16x32_bf16 v[40:43], a[92:95], a[64:67], v[40:43]
    ds_read_b64_tr_b16 a[118:119], v27 offset:43648
    s_waitcnt lgkmcnt(12)
    v_mfma_f32_16x16x32_bf16 v[60:63], a[64:67], a[96:99], v[60:63]
    ds_read_b64_tr_b16 a[120:121], v86 offset:43136
    v_mfma_f32_16x16x32_bf16 v[68:71], a[68:71], a[96:99], v[68:71]
    ds_read_b64_tr_b16 a[122:123], v86 offset:43648
    s_waitcnt lgkmcnt(12)
    v_mfma_f32_16x16x32_bf16 v[72:75], a[68:71], a[100:103], v[72:75]
    ds_read_b64_tr_b16 a[124:125], v87 offset:43136
    v_mfma_f32_16x16x32_bf16 v[64:67], a[64:67], a[100:103], v[64:67]
    ds_read_b64_tr_b16 a[126:127], v87 offset:43648
    s_barrier
    s_setprio 3
    s_waitcnt lgkmcnt(10)
    v_mfma_f32_16x16x32_bf16 v[28:31], a[104:107], a[72:75], v[28:31]
    ds_read_b128 a[64:67], v76 offset:0
    ds_read_b128 a[68:71], v78 offset:0
    v_mfma_f32_16x16x32_bf16 v[44:47], a[104:107], a[76:79], v[44:47]
    ds_read_b64_tr_b16 a[80:81], v20 offset:0
    s_waitcnt lgkmcnt(11)
    v_mfma_f32_16x16x32_bf16 v[48:51], a[108:111], a[76:79], v[48:51]
    ds_read_b64_tr_b16 a[82:83], v20 offset:512
    v_mfma_f32_16x16x32_bf16 v[32:35], a[108:111], a[72:75], v[32:35]
    ds_read_b64_tr_b16 a[84:85], v21 offset:0
    s_waitcnt lgkmcnt(11)
    v_mfma_f32_16x16x32_bf16 v[36:39], a[112:115], a[72:75], v[36:39]
    ds_read_b64_tr_b16 a[86:87], v21 offset:512
    v_mfma_f32_16x16x32_bf16 v[52:55], a[112:115], a[76:79], v[52:55]
    ds_read_b64_tr_b16 a[88:89], v22 offset:0
    s_setprio 2
    s_waitcnt lgkmcnt(11)
    v_mfma_f32_16x16x32_bf16 v[56:59], a[116:119], a[76:79], v[56:59]
    ds_read_b64_tr_b16 a[90:91], v22 offset:512
    ds_read_b64_tr_b16 a[92:93], v23 offset:0
    v_mfma_f32_16x16x32_bf16 v[40:43], a[116:119], a[72:75], v[40:43]
    ds_read_b64_tr_b16 a[94:95], v23 offset:512
    s_waitcnt lgkmcnt(12)
    v_mfma_f32_16x16x32_bf16 v[60:63], a[72:75], a[120:123], v[60:63]
    ds_read_b64_tr_b16 a[96:97], v84 offset:0
    v_mfma_f32_16x16x32_bf16 v[68:71], a[76:79], a[120:123], v[68:71]
    ds_read_b64_tr_b16 a[98:99], v84 offset:512
    s_waitcnt lgkmcnt(12)
    v_mfma_f32_16x16x32_bf16 v[72:75], a[76:79], a[124:127], v[72:75]
    ds_read_b64_tr_b16 a[100:101], v85 offset:0
    v_mfma_f32_16x16x32_bf16 v[64:67], a[72:75], a[124:127], v[64:67]
    ds_read_b64_tr_b16 a[102:103], v85 offset:512
    buffer_store_dwordx4 v[100:103], v13, s[28:31], s23 offen offset:0 sc1
    s_cmp_eq_u32 s42, 4
    s_cbranch_scc1 Lxe4
Lxe4_b:
    s_setprio 1
    s_waitcnt lgkmcnt(10)
    v_mfma_f32_16x16x32_bf16 v[28:31], a[80:83], a[64:67], v[28:31]
    ds_read_b128 a[72:75], v77 offset:0
    ds_read_b128 a[76:79], v79 offset:0
    v_mfma_f32_16x16x32_bf16 v[44:47], a[80:83], a[68:71], v[44:47]
    ds_read_b64_tr_b16 a[104:105], v20 offset:4096
    s_waitcnt lgkmcnt(11)
    v_mfma_f32_16x16x32_bf16 v[48:51], a[84:87], a[68:71], v[48:51]
    ds_read_b64_tr_b16 a[106:107], v20 offset:4608
    v_mfma_f32_16x16x32_bf16 v[32:35], a[84:87], a[64:67], v[32:35]
    ds_read_b64_tr_b16 a[108:109], v21 offset:4096
    s_waitcnt lgkmcnt(11)
    v_mfma_f32_16x16x32_bf16 v[36:39], a[88:91], a[64:67], v[36:39]
    ds_read_b64_tr_b16 a[110:111], v21 offset:4608
    ds_read_b64_tr_b16 a[112:113], v22 offset:4096
    v_mfma_f32_16x16x32_bf16 v[52:55], a[88:91], a[68:71], v[52:55]
    ds_read_b64_tr_b16 a[114:115], v22 offset:4608
    s_setprio 0
    s_waitcnt lgkmcnt(12)
    v_mfma_f32_16x16x32_bf16 v[56:59], a[92:95], a[68:71], v[56:59]
    ds_read_b64_tr_b16 a[116:117], v23 offset:4096
    v_mfma_f32_16x16x32_bf16 v[40:43], a[92:95], a[64:67], v[40:43]
    ds_read_b64_tr_b16 a[118:119], v23 offset:4608
    s_waitcnt lgkmcnt(12)
    v_mfma_f32_16x16x32_bf16 v[60:63], a[64:67], a[96:99], v[60:63]
    ds_read_b64_tr_b16 a[120:121], v84 offset:4096
    v_mfma_f32_16x16x32_bf16 v[68:71], a[68:71], a[96:99], v[68:71]
    ds_read_b64_tr_b16 a[122:123], v84 offset:4608
    s_waitcnt lgkmcnt(12)
    v_mfma_f32_16x16x32_bf16 v[72:75], a[68:71], a[100:103], v[72:75]
    ds_read_b64_tr_b16 a[124:125], v85 offset:4096
    v_mfma_f32_16x16x32_bf16 v[64:67], a[64:67], a[100:103], v[64:67]
    ds_read_b64_tr_b16 a[126:127], v85 offset:4608
    s_barrier
    s_setprio 3
    s_waitcnt lgkmcnt(10)
    v_mfma_f32_16x16x32_bf16 v[28:31], a[104:107], a[72:75], v[28:31]
    ds_read_b128 a[64:67], v76 offset:39040
    ds_read_b128 a[68:71], v78 offset:39040
    v_mfma_f32_16x16x32_bf16 v[44:47], a[104:107], a[76:79], v[44:47]
    ds_read_b64_tr_b16 a[80:81], v20 offset:39040
    s_waitcnt lgkmcnt(11)
    v_mfma_f32_16x16x32_bf16 v[48:51], a[108:111], a[76:79], v[48:51]
    ds_read_b64_tr_b16 a[82:83], v20 offset:39552
    v_mfma_f32_16x16x32_bf16 v[32:35], a[108:111], a[72:75], v[32:35]
    ds_read_b64_tr_b16 a[84:85], v21 offset:39040
    s_waitcnt lgkmcnt(11)
    v_mfma_f32_16x16x32_bf16 v[36:39], a[112:115], a[72:75], v[36:39]
    ds_read_b64_tr_b16 a[86:87], v21 offset:39552
    v_mfma_f32_16x16x32_bf16 v[52:55], a[112:115], a[76:79], v[52:55]
    ds_read_b64_tr_b16 a[88:89], v22 offset:39040
    s_setprio 2
    s_waitcnt lgkmcnt(11)
    v_mfma_f32_16x16x32_bf16 v[56:59], a[116:119], a[76:79], v[56:59]
    ds_read_b64_tr_b16 a[90:91], v22 offset:39552
    ds_read_b64_tr_b16 a[92:93], v23 offset:39040
    v_mfma_f32_16x16x32_bf16 v[40:43], a[116:119], a[72:75], v[40:43]
    ds_read_b64_tr_b16 a[94:95], v23 offset:39552
    s_waitcnt lgkmcnt(12)
    v_mfma_f32_16x16x32_bf16 v[60:63], a[72:75], a[120:123], v[60:63]
    ds_read_b64_tr_b16 a[96:97], v84 offset:39040
    v_mfma_f32_16x16x32_bf16 v[68:71], a[76:79], a[120:123], v[68:71]
    ds_read_b64_tr_b16 a[98:99], v84 offset:39552
    s_waitcnt lgkmcnt(12)
    v_mfma_f32_16x16x32_bf16 v[72:75], a[76:79], a[124:127], v[72:75]
    ds_read_b64_tr_b16 a[100:101], v85 offset:39040
    v_mfma_f32_16x16x32_bf16 v[64:67], a[72:75], a[124:127], v[64:67]
    ds_read_b64_tr_b16 a[102:103], v85 offset:39552
    s_cmp_eq_u32 s42, 5
    s_cbranch_scc1 Lxe5
Lxe5_b:
    s_setprio 1
    s_waitcnt lgkmcnt(10)
    v_mfma_f32_16x16x32_bf16 v[28:31], a[80:83], a[64:67], v[28:31]
    ds_read_b128 a[72:75], v77 offset:39040
    ds_read_b128 a[76:79], v79 offset:39040
    v_mfma_f32_16x16x32_bf16 v[44:47], a[80:83], a[68:71], v[44:47]
    ds_read_b64_tr_b16 a[104:105], v20 offset:43136
    s_waitcnt lgkmcnt(11)
    v_mfma_f32_16x16x32_bf16 v[48:51], a[84:87], a[68:71], v[48:51]
    ds_read_b64_tr_b16 a[106:107], v20 offset:43648
    v_mfma_f32_16x16x32_bf16 v[32:35], a[84:87], a[64:67], v[32:35]
    ds_read_b64_tr_b16 a[108:109], v21 offset:43136
    s_waitcnt lgkmcnt(11)
    v_mfma_f32_16x16x32_bf16 v[36:39], a[88:91], a[64:67], v[36:39]
    ds_read_b64_tr_b16 a[110:111], v21 offset:43648
    ds_read_b64_tr_b16 a[112:113], v22 offset:43136
    v_mfma_f32_16x16x32_bf16 v[52:55], a[88:91], a[68:71], v[52:55]
    ds_read_b64_tr_b16 a[114:115], v22 offset:43648
    s_setprio 0
    s_waitcnt lgkmcnt(12)
    v_mfma_f32_16x16x32_bf16 v[56:59], a[92:95], a[68:71], v[56:59]
    ds_read_b64_tr_b16 a[116:117], v23 offset:43136
    v_mfma_f32_16x16x32_bf16 v[40:43], a[92:95], a[64:67], v[40:43]
    ds_read_b64_tr_b16 a[118:119], v23 offset:43648
    s_waitcnt lgkmcnt(12)
    v_mfma_f32_16x16x32_bf16 v[60:63], a[64:67], a[96:99], v[60:63]
    ds_read_b64_tr_b16 a[120:121], v84 offset:43136
    v_mfma_f32_16x16x32_bf16 v[68:71], a[68:71], a[96:99], v[68:71]
    ds_read_b64_tr_b16 a[122:123], v84 offset:43648
    s_waitcnt lgkmcnt(12)
    v_mfma_f32_16x16x32_bf16 v[72:75], a[68:71], a[100:103], v[72:75]
    ds_read_b64_tr_b16 a[124:125], v85 offset:43136
    v_mfma_f32_16x16x32_bf16 v[64:67], a[64:67], a[100:103], v[64:67]
    ds_read_b64_tr_b16 a[126:127], v85 offset:43648
    s_barrier
    s_setprio 3
    s_waitcnt lgkmcnt(10)
    v_mfma_f32_16x16x32_bf16 v[28:31], a[104:107], a[72:75], v[28:31]
    ds_read_b128 a[0:3], v80 offset:0
    v_mfma_f32_16x16x32_bf16 v[44:47], a[104:107], a[76:79], v[44:47]
    ds_read_b128 a[4:7], v82 offset:0
    s_waitcnt lgkmcnt(10)
    v_mfma_f32_16x16x32_bf16 v[48:51], a[108:111], a[76:79], v[48:51]
    ds_read_b64_tr_b16 a[80:81], v24 offset:0
    v_mfma_f32_16x16x32_bf16 v[32:35], a[108:111], a[72:75], v[32:35]
    ds_read_b64_tr_b16 a[82:83], v24 offset:512
    s_waitcnt lgkmcnt(10)
    v_mfma_f32_16x16x32_bf16 v[36:39], a[112:115], a[72:75], v[36:39]
    ds_read_b64_tr_b16 a[84:85], v25 offset:0
    v_mfma_f32_16x16x32_bf16 v[52:55], a[112:115], a[76:79], v[52:55]
    s_setprio 2
    s_waitcnt lgkmcnt(9)
    v_mfma_f32_16x16x32_bf16 v[56:59], a[116:119], a[76:79], v[56:59]
    ds_read_b64_tr_b16 a[86:87], v25 offset:512
    v_mfma_f32_16x16x32_bf16 v[40:43], a[116:119], a[72:75], v[40:43]
    ds_read_b64_tr_b16 a[88:89], v26 offset:0
    s_waitcnt lgkmcnt(9)
    v_mfma_f32_16x16x32_bf16 v[60:63], a[72:75], a[120:123], v[60:63]
    ds_read_b64_tr_b16 a[90:91], v26 offset:512
    v_mfma_f32_16x16x32_bf16 v[68:71], a[76:79], a[120:123], v[68:71]
    ds_read_b64_tr_b16 a[92:93], v27 offset:0
    s_waitcnt lgkmcnt(9)
    v_mfma_f32_16x16x32_bf16 v[72:75], a[76:79], a[124:127], v[72:75]
    ds_read_b64_tr_b16 a[94:95], v27 offset:512
    v_mfma_f32_16x16x32_bf16 v[64:67], a[72:75], a[124:127], v[64:67]
    buffer_store_dwordx4 v[100:103], v13, s[28:31], s23 offen offset:1024 sc1
    s_cmp_eq_u32 s42, 6
    s_cbranch_scc1 Lxe6
Lxe6_b:
    s_setprio 1
    s_waitcnt lgkmcnt(6)
    v_mfma_f32_16x16x32_bf16 v[28:31], a[80:83], a[0:3], v[28:31]
    ds_read_b128 a[8:11], v81 offset:0
    ds_read_b128 a[12:15], v83 offset:0
    v_mfma_f32_16x16x32_bf16 v[44:47], a[80:83], a[4:7], v[44:47]
    ds_read_b64_tr_b16 a[104:105], v24 offset:4096
    s_waitcnt lgkmcnt(7)
    v_mfma_f32_16x16x32_bf16 v[48:51], a[84:87], a[4:7], v[48:51]
    ds_read_b64_tr_b16 a[106:107], v24 offset:4608
    ds_read_b64_tr_b16 a[108:109], v25 offset:4096
    v_mfma_f32_16x16x32_bf16 v[32:35], a[84:87], a[0:3], v[32:35]
    ds_read_b64_tr_b16 a[110:111], v25 offset:4608
    s_setprio 0
    s_waitcnt lgkmcnt(8)
    v_mfma_f32_16x16x32_bf16 v[36:39], a[88:91], a[0:3], v[36:39]
    v_mfma_f32_16x16x32_bf16 v[52:55], a[88:91], a[4:7], v[52:55]
    ds_read_b64_tr_b16 a[112:113], v26 offset:4096
    ds_read_b64_tr_b16 a[114:115], v26 offset:4608
    s_waitcnt lgkmcnt(8)
    v_mfma_f32_16x16x32_bf16 v[56:59], a[92:95], a[4:7], v[56:59]
    ds_read_b64_tr_b16 a[116:117], v27 offset:4096
    v_mfma_f32_16x16x32_bf16 v[40:43], a[92:95], a[0:3], v[40:43]
    ds_read_b64_tr_b16 a[118:119], v27 offset:4608
    s_barrier
    s_setprio 3
    s_waitcnt lgkmcnt(6)
    v_mfma_f32_16x16x32_bf16 v[28:31], a[104:107], a[8:11], v[28:31]
    ds_read_b128 a[16:19], v80 offset:39040
    ds_read_b128 a[20:23], v82 offset:39040
    v_mfma_f32_16x16x32_bf16 v[44:47], a[104:107], a[12:15], v[44:47]
    ds_read_b64_tr_b16 a[80:81], v24 offset:39040
    s_waitcnt lgkmcnt(7)
    v_mfma_f32_16x16x32_bf16 v[48:51], a[108:111], a[12:15], v[48:51]
    ds_read_b64_tr_b16 a[82:83], v24 offset:39552
    v_mfma_f32_16x16x32_bf16 v[32:35], a[108:111], a[8:11], v[32:35]
    ds_read_b64_tr_b16 a[84:85], v25 offset:39040
    s_setprio 2
    s_waitcnt lgkmcnt(7)
    v_mfma_f32_16x16x32_bf16 v[36:39], a[112:115], a[8:11], v[36:39]
    ds_read_b64_tr_b16 a[86:87], v25 offset:39552
    ds_read_b64_tr_b16 a[88:89], v26 offset:39040
    v_mfma_f32_16x16x32_bf16 v[52:55], a[112:115], a[12:15], v[52:55]
    ds_read_b64_tr_b16 a[90:91], v26 offset:39552
    s_waitcnt lgkmcnt(8)
    v_mfma_f32_16x16x32_bf16 v[56:59], a[116:119], a[12:15], v[56:59]
    ds_read_b64_tr_b16 a[92:93], v27 offset:39040
    v_mfma_f32_16x16x32_bf16 v[40:43], a[116:119], a[8:11], v[40:43]
    ds_read_b64_tr_b16 a[94:95], v27 offset:39552
    s_cmp_eq_u32 s42, 7
    s_cbranch_scc1 Lxe7
Lxe7_b:
    s_setprio 1
    s_waitcnt lgkmcnt(6)
    v_mfma_f32_16x16x32_bf16 v[28:31], a[80:83], a[16:19], v[28:31]
    ds_read_b128 a[24:27], v81 offset:39040
    ds_read_b128 a[28:31], v83 offset:39040
    v_mfma_f32_16x16x32_bf16 v[44:47], a[80:83], a[20:23], v[44:47]
    ds_read_b64_tr_b16 a[104:105], v24 offset:43136
    s_waitcnt lgkmcnt(7)
    v_mfma_f32_16x16x32_bf16 v[48:51], a[84:87], a[20:23], v[48:51]
    ds_read_b64_tr_b16 a[106:107], v24 offset:43648
    ds_read_b64_tr_b16 a[108:109], v25 offset:43136
    v_mfma_f32_16x16x32_bf16 v[32:35], a[84:87], a[16:19], v[32:35]
    ds_read_b64_tr_b16 a[110:111], v25 offset:43648
    s_setprio 0
    s_waitcnt lgkmcnt(8)
    v_mfma_f32_16x16x32_bf16 v[36:39], a[88:91], a[16:19], v[36:39]
    v_mfma_f32_16x16x32_bf16 v[52:55], a[88:91], a[20:23], v[52:55]
    ds_read_b64_tr_b16 a[112:113], v26 offset:43136
    ds_read_b64_tr_b16 a[114:115], v26 offset:43648
    s_waitcnt lgkmcnt(8)
    v_mfma_f32_16x16x32_bf16 v[56:59], a[92:95], a[20:23], v[56:59]
    ds_read_b64_tr_b16 a[116:117], v27 offset:43136
    v_mfma_f32_16x16x32_bf16 v[40:43], a[92:95], a[16:19], v[40:43]
    ds_read_b64_tr_b16 a[118:119], v27 offset:43648
    s_barrier
    s_setprio 3
    s_waitcnt lgkmcnt(6)
    v_mfma_f32_16x16x32_bf16 v[28:31], a[104:107], a[24:27], v[28:31]
    ds_read_b128 a[32:35], v76 offset:0
    ds_read_b128 a[36:39], v78 offset:0
    v_mfma_f32_16x16x32_bf16 v[44:47], a[104:107], a[28:31], v[44:47]
    ds_read_b64_tr_b16 a[80:81], v20 offset:0
    s_waitcnt lgkmcnt(7)
    v_mfma_f32_16x16x32_bf16 v[48:51], a[108:111], a[28:31], v[48:51]
    ds_read_b64_tr_b16 a[82:83], v20 offset:512
    v_mfma_f32_16x16x32_bf16 v[32:35], a[108:111], a[24:27], v[32:35]
    ds_read_b64_tr_b16 a[84:85], v21 offset:0
    s_setprio 2
    s_waitcnt lgkmcnt(7)
    v_mfma_f32_16x16x32_bf16 v[36:39], a[112:115], a[24:27], v[36:39]
    ds_read_b64_tr_b16 a[86:87], v21 offset:512
    ds_read_b64_tr_b16 a[88:89], v22 offset:0
    v_mfma_f32_16x16x32_bf16 v[52:55], a[112:115], a[28:31], v[52:55]
    ds_read_b64_tr_b16 a[90:91], v22 offset:512
    s_waitcnt lgkmcnt(8)
    v_mfma_f32_16x16x32_bf16 v[56:59], a[116:119], a[28:31], v[56:59]
    ds_read_b64_tr_b16 a[92:93], v23 offset:0
    v_mfma_f32_16x16x32_bf16 v[40:43], a[116:119], a[24:27], v[40:43]
    ds_read_b64_tr_b16 a[94:95], v23 offset:512
    s_cmp_eq_u32 s42, 8
    s_cbranch_scc1 Lxe8
Lxe8_b:
    s_setprio 1
    s_waitcnt lgkmcnt(6)
    v_mfma_f32_16x16x32_bf16 v[28:31], a[80:83], a[32:35], v[28:31]
    ds_read_b128 a[40:43], v77 offset:0
    ds_read_b128 a[44:47], v79 offset:0
    v_mfma_f32_16x16x32_bf16 v[44:47], a[80:83], a[36:39], v[44:47]
    ds_read_b64_tr_b16 a[104:105], v20 offset:4096
    s_waitcnt lgkmcnt(7)
    v_mfma_f32_16x16x32_bf16 v[48:51], a[84:87], a[36:39], v[48:51]
    ds_read_b64_tr_b16 a[106:107], v20 offset:4608
    v_mfma_f32_16x16x32_bf16 v[32:35], a[84:87], a[32:35], v[32:35]
    ds_read_b64_tr_b16 a[108:109], v21 offset:4096
    s_setprio 0
    s_waitcnt lgkmcnt(7)
    v_mfma_f32_16x16x32_bf16 v[36:39], a[88:91], a[32:35], v[36:39]
    ds_read_b64_tr_b16 a[110:111], v21 offset:4608
    ds_read_b64_tr_b16 a[112:113], v22 offset:4096
    v_mfma_f32_16x16x32_bf16 v[52:55], a[88:91], a[36:39], v[52:55]
    ds_read_b64_tr_b16 a[114:115], v22 offset:4608
    s_waitcnt lgkmcnt(8)
    v_mfma_f32_16x16x32_bf16 v[56:59], a[92:95], a[36:39], v[56:59]
    ds_read_b64_tr_b16 a[116:117], v23 offset:4096
    v_mfma_f32_16x16x32_bf16 v[40:43], a[92:95], a[32:35], v[40:43]
    ds_read_b64_tr_b16 a[118:119], v23 offset:4608
    s_waitcnt lgkmcnt(0)
    s_barrier
    s_setprio 3
    v_mfma_f32_16x16x32_bf16 v[28:31], a[104:107], a[40:43], v[28:31]
    ds_read_b128 a[48:51], v76 offset:39040
    ds_read_b128 a[52:55], v78 offset:39040
    v_mfma_f32_16x16x32_bf16 v[44:47], a[104:107], a[44:47], v[44:47]
    ds_read_b64_tr_b16 a[80:81], v20 offset:39040
    v_mfma_f32_16x16x32_bf16 v[48:51], a[108:111], a[44:47], v[48:51]
    ds_read_b64_tr_b16 a[82:83], v20 offset:39552
    v_mfma_f32_16x16x32_bf16 v[32:35], a[108:111], a[40:43], v[32:35]
    ds_read_b64_tr_b16 a[84:85], v21 offset:39040
    s_setprio 2
    v_mfma_f32_16x16x32_bf16 v[36:39], a[112:115], a[40:43], v[36:39]
    ds_read_b64_tr_b16 a[86:87], v21 offset:39552
    ds_read_b64_tr_b16 a[88:89], v22 offset:39040
    v_mfma_f32_16x16x32_bf16 v[52:55], a[112:115], a[44:47], v[52:55]
    ds_read_b64_tr_b16 a[90:91], v22 offset:39552
    v_mfma_f32_16x16x32_bf16 v[56:59], a[116:119], a[44:47], v[56:59]
    ds_read_b64_tr_b16 a[92:93], v23 offset:39040
    v_mfma_f32_16x16x32_bf16 v[40:43], a[116:119], a[40:43], v[40:43]
    ds_read_b64_tr_b16 a[94:95], v23 offset:39552
    v_mov_b32 v98, s34
    s_waitcnt vmcnt(0)
    s_mov_b64 exec, 1
    buffer_store_dword v98, v97, s[28:31], s24 offen sc1
    s_mov_b64 exec, -1
    s_cmp_eq_u32 s42, 9
    s_cbranch_scc1 Lxe9
Lxe9_b:
    s_setprio 1
    s_waitcnt lgkmcnt(6)
    v_mfma_f32_16x16x32_bf16 v[28:31], a[80:83], a[48:51], v[28:31]
    ds_read_b128 a[56:59], v77 offset:39040
    ds_read_b128 a[60:63], v79 offset:39040
    ds_read_b64_tr_b16 a[104:105], v20 offset:43136
    v_mfma_f32_16x16x32_bf16 v[44:47], a[80:83], a[52:55], v[44:47]
    ds_read_b64_tr_b16 a[106:107], v20 offset:43648
    ds_read_b64_tr_b16 a[108:109], v21 offset:43136
    s_waitcnt lgkmcnt(9)
    v_mfma_f32_16x16x32_bf16 v[48:51], a[84:87], a[52:55], v[48:51]
    ds_read_b64_tr_b16 a[110:111], v21 offset:43648
    ds_read_b64_tr_b16 a[112:113], v22 offset:43136
    ds_read_b64_tr_b16 a[114:115], v22 offset:43648
    v_mfma_f32_16x16x32_bf16 v[32:35], a[84:87], a[48:51], v[32:35]
    ds_read_b64_tr_b16 a[116:117], v23 offset:43136
    ds_read_b64_tr_b16 a[118:119], v23 offset:43648
    s_setprio 0
    s_waitcnt lgkmcnt(12)
    v_mfma_f32_16x16x32_bf16 v[36:39], a[88:91], a[48:51], v[36:39]
    ds_read_b32 v120, v94
    ds_read_b32 v121, v94 offset:512
    v_xor_b32 v94, 64, v94
    v_mfma_f32_16x16x32_bf16 v[52:55], a[88:91], a[52:55], v[52:55]
    ds_read_b32 v122, v94
    ds_read_b32 v123, v92 offset:512
    s_waitcnt lgkmcnt(14)
    v_mfma_f32_16x16x32_bf16 v[56:59], a[92:95], a[52:55], v[56:59]
    ds_read_b32 v126, v93 offset:520
    v_mov_b32 v24, v84
    v_mov_b32 v25, v85
    v_mfma_f32_16x16x32_bf16 v[40:43], a[92:95], a[48:51], v[40:43]
    v_mov_b32 v26, v86
    v_mov_b32 v27, v87
    s_waitcnt lgkmcnt(5)
    v_mfma_f32_16x16x32_bf16 v[44:47], a[104:107], a[60:63], v[44:47]
    v_mfma_f32_16x16x32_bf16 v[48:51], a[108:111], a[60:63], v[48:51]
    v_mfma_f32_16x16x32_bf16 v[52:55], a[112:115], a[60:63], v[52:55]
    v_mfma_f32_16x16x32_bf16 v[56:59], a[116:119], a[60:63], v[56:59]
    v_mfma_f32_16x16x32_bf16 v[28:31], a[104:107], a[56:59], v[28:31]
    v_mfma_f32_16x16x32_bf16 v[32:35], a[108:111], a[56:59], v[32:35]
    ds_read_b32 v7, v96
    ds_read_b128 v[76:79], v95 offset:0
    ds_read_b128 v[80:83], v95 offset:64
    ds_read_b128 v[84:87], v95 offset:128
    ds_read_b128 v[88:91], v95 offset:192
    v_mfma_f32_16x16x32_bf16 v[36:39], a[112:115], a[56:59], v[36:39]
    v_mfma_f32_16x16x32_bf16 v[40:43], a[116:119], a[56:59], v[40:43]
    s_waitcnt lgkmcnt(0)
Lqf:
    v_readfirstlane_b32 s38, v7
    s_nop 0
    s_cmp_eq_u32 s38, 0
    s_cbranch_scc1 Lqf_re
    s_cmp_eq_u32 s27, 0
    v_fmac_f32 v44, v76, v122
    v_fmac_f32 v45, v77, v122
    v_fmac_f32 v46, v78, v122
    v_fmac_f32 v47, v79, v122
    v_cvt_pk_bf16_f32 v44, v44, v45
    v_cvt_pk_bf16_f32 v45, v46, v47
    v_fmac_f32 v48, v80, v122
    v_fmac_f32 v49, v81, v122
    v_fmac_f32 v50, v82, v122
    v_fmac_f32 v51, v83, v122
    v_cvt_pk_bf16_f32 v46, v48, v49
    v_cvt_pk_bf16_f32 v47, v50, v51
    v_fmac_f32 v52, v84, v122
    v_fmac_f32 v53, v85, v122
    v_fmac_f32 v54, v86, v122
    v_fmac_f32 v55, v87, v122
    v_cvt_pk_bf16_f32 v48, v52, v53
    v_cvt_pk_bf16_f32 v49, v54, v55
    v_fmac_f32 v56, v88, v122
    v_fmac_f32 v57, v89, v122
    v_fmac_f32 v58, v90, v122
    v_fmac_f32 v59, v91, v122
    v_cvt_pk_bf16_f32 v50, v56, v57
    v_cvt_pk_bf16_f32 v51, v58, v59
    s_cbranch_scc1 Lh1
    s_setprio 3
    ds_write_b128 v125, v[44:47] offset:2048
    ds_write_b128 v125, v[48:51] offset:3072
    v_fmac_f32 v28, v76, v120
    v_fmac_f32 v29, v77, v120
    v_fmac_f32 v30, v78, v120
    v_fmac_f32 v31, v79, v120
    v_cvt_pk_bf16_f32 v52, v28, v29
    v_cvt_pk_bf16_f32 v53, v30, v31
    v_fmac_f32 v32, v80, v120
    v_fmac_f32 v33, v81, v120
    v_fmac_f32 v34, v82, v120
    v_fmac_f32 v35, v83, v120
    v_cvt_pk_bf16_f32 v54, v32, v33
    v_cvt_pk_bf16_f32 v55, v34, v35
    v_fmac_f32 v36, v84, v120
    v_fmac_f32 v37, v85, v120
    v_fmac_f32 v38, v86, v120
    v_fmac_f32 v39, v87, v120
    v_cvt_pk_bf16_f32 v56, v36, v37
    v_cvt_pk_bf16_f32 v57, v38, v39
    v_fmac_f32 v40, v88, v120
    v_fmac_f32 v41, v89, v120
    v_fmac_f32 v42, v90, v120
    v_fmac_f32 v43, v91, v120
    v_cvt_pk_bf16_f32 v58, v40, v41
    v_cvt_pk_bf16_f32 v59, v42, v43
    ds_write_b128 v125, v[52:55] offset:4096
    ds_write_b128 v125, v[56:59] offset:5120
    v_mov_b32 v5, 157972
    v_mov_b32 v6, 1
    s_mov_b64 exec, 1
    ds_add_u32 v5, v6
    s_mov_b64 exec, -1
    v_mov_b32 v8, s22
    v_mov_b32 v9, s22
    v_mov_b32 v10, s22
    v_mov_b32 v11, s22
Lcw_1:
    s_sub_u32 s35, s35, 1
    s_cbranch_scc1 Lend
    ds_read_b32 v6, v5
    s_waitcnt lgkmcnt(0)
    v_readfirstlane_b32 s38, v6
    s_nop 0
    s_cmp_lt_u32 s38, 8
    s_cbranch_scc1 Lcw_1
    ds_read_b128 v[28:31], v125 offset:0
    ds_read_b128 v[32:35], v125 offset:1024
Lh_join:
    buffer_load_dword v20, v12, s[28:31], s24 offen sc1
    ds_read_b64_tr_b16 a[64:65], v26 offset:0
    ds_read_b64_tr_b16 a[66:67], v26 offset:512
    ds_read_b64_tr_b16 a[68:69], v27 offset:0
    ds_read_b64_tr_b16 a[70:71], v27 offset:512
    ds_read_b64_tr_b16 a[72:73], v26 offset:4096
    ds_read_b64_tr_b16 a[74:75], v26 offset:4608
    ds_read_b64_tr_b16 a[76:77], v27 offset:4096
    ds_read_b64_tr_b16 a[78:79], v27 offset:4608
    s_waitcnt lgkmcnt(8)
    s_setprio 3
    v_cndmask_b32 v92, 0, v30, s[6:7]
    v_cndmask_b32 v93, 0, v31, s[6:7]
    v_cndmask_b32 v94, 0, v32, s[12:13]
    v_cndmask_b32 v95, 0, v33, s[12:13]
    v_cndmask_b32 v104, 0, v30, s[8:9]
    v_cndmask_b32 v105, 0, v31, s[8:9]
    v_mfma_f32_16x16x32_bf16 v[76:79], v[46:49], v[92:95], v[8:11]
    v_mfma_f32_16x16x32_bf16 v[80:83], v[54:57], v[92:95], 0
    v_cndmask_b32 v106, 0, v32, s[14:15]
    v_cndmask_b32 v107, 0, v33, s[14:15]
    v_mov_b32 v96, v28
    v_mov_b32 v97, v29
    v_mfma_f32_16x16x32_bf16 v[84:87], v[46:49], v[104:107], v[8:11]
    v_mfma_f32_16x16x32_bf16 v[88:91], v[54:57], v[104:107], 0
    v_cndmask_b32 v98, 0, v30, s[10:11]
    v_cndmask_b32 v99, 0, v31, s[10:11]
    v_cndmask_b32 v100, 0, v32, s[16:17]
    v_cndmask_b32 v101, 0, v33, s[16:17]
    v_mfma_f32_16x16x32_bf16 v[36:39], v[44:47], v[96:99], v[8:11]
    v_mfma_f32_16x16x32_bf16 v[40:43], v[52:55], v[96:99], 0
    v_cndmask_b32 v76, v76, v77, s[4:5]
    v_cndmask_b32 v80, v80, v81, s[4:5]
    v_cndmask_b32 v78, v78, v79, s[4:5]
    v_cndmask_b32 v82, v82, v83, s[4:5]
    v_cndmask_b32 v92, v76, v80, s[18:19]
    v_cndmask_b32 v94, v78, v82, s[20:21]
    v_min_u32 v4, -2, v92
    v_min_u32 v5, -2, v94
    v_cndmask_b32 v84, v84, v85, s[4:5]
    v_cndmask_b32 v88, v88, v89, s[4:5]
    v_cndmask_b32 v86, v86, v87, s[4:5]
    v_cndmask_b32 v90, v90, v91, s[4:5]
    v_cndmask_b32 v104, v84, v88, s[18:19]
    v_cndmask_b32 v106, v86, v90, s[20:21]
    v_min_u32 v6, -2, v104
    v_min_u32 v7, -2, v106
    buffer_store_dwordx4 v[4:7], v13, s[28:31], s58 offen sc0 sc1
    s_setprio 2
    ds_read_b64_tr_b16 a[80:81], v26 offset:39040
    ds_read_b64_tr_b16 a[82:83], v26 offset:39552
    ds_read_b64_tr_b16 a[84:85], v27 offset:39040
    ds_read_b64_tr_b16 a[86:87], v27 offset:39552
    ds_read_b64_tr_b16 a[88:89], v26 offset:43136
    ds_read_b64_tr_b16 a[90:91], v26 offset:43648
    ds_read_b64_tr_b16 a[92:93], v27 offset:43136
    ds_read_b64_tr_b16 a[94:95], v27 offset:43648
    ds_read_b64_tr_b16 a[96:97], v24 offset:0
    ds_read_b64_tr_b16 a[98:99], v24 offset:512
    ds_read_b64_tr_b16 a[100:101], v25 offset:0
    ds_read_b64_tr_b16 a[102:103], v25 offset:512
    ds_read_b64_tr_b16 a[104:105], v24 offset:4096
    ds_read_b64_tr_b16 a[106:107], v24 offset:4608
    ds_read_b64_tr_b16 a[108:109], v25 offset:4096
    ds_read_b64_tr_b16 a[110:111], v25 offset:4608
    ds_read_b64_tr_b16 a[112:113], v24 offset:39040
    ds_read_b64_tr_b16 a[114:115], v24 offset:39552
    ds_read_b64_tr_b16 a[116:117], v25 offset:39040
    ds_read_b64_tr_b16 a[118:119], v25 offset:39552
    ds_read_b64_tr_b16 a[120:121], v24 offset:43136
    ds_read_b64_tr_b16 a[122:123], v24 offset:43648
    ds_read_b64_tr_b16 a[124:125], v25 offset:43136
    ds_read_b64_tr_b16 a[126:127], v25 offset:43648
    s_waitcnt lgkmcnt(15)
    v_mfma_f32_16x16x32_bf16 v[60:63], a[0:3], a[64:67], v[60:63]
    v_mov_b32 v102, v34
    v_mov_b32 v103, v35
    v_mul_f32 v4, s25, v121
    v_mfma_f32_16x16x32_bf16 v[68:71], a[4:7], a[64:67], v[68:71]
    v_mfma_f32_16x16x32_bf16 v[76:79], v[48:51], v[100:103], v[8:11]
    v_mfma_f32_16x16x32_bf16 v[80:83], v[56:59], v[100:103], 0
    v_mul_f32 v123, v123, v4
    v_mfma_f32_16x16x32_bf16 v[64:67], a[0:3], a[68:71], v[64:67]
    v_mul_f32 v126, v126, v4
    v_cndmask_b32 v36, v36, v37, s[4:5]
    v_cndmask_b32 v40, v40, v41, s[4:5]
    v_mfma_f32_16x16x32_bf16 v[72:75], a[4:7], a[68:71], v[72:75]
    v_cndmask_b32 v38, v38, v39, s[4:5]
    v_cndmask_b32 v42, v42, v43, s[4:5]
    v_cndmask_b32 v96, v36, v40, s[18:19]
    v_mfma_f32_16x16x32_bf16 v[60:63], a[8:11], a[72:75], v[60:63]
    v_cndmask_b32 v98, v38, v42, s[20:21]
    v_cndmask_b32 v76, v76, v77, s[4:5]
    v_cndmask_b32 v80, v80, v81, s[4:5]
    v_mfma_f32_16x16x32_bf16 v[68:71], a[12:15], a[72:75], v[68:71]
    v_cndmask_b32 v78, v78, v79, s[4:5]
    v_cndmask_b32 v82, v82, v83, s[4:5]
    v_cndmask_b32 v100, v76, v80, s[18:19]
    v_mfma_f32_16x16x32_bf16 v[64:67], a[8:11], a[76:79], v[64:67]
    v_cndmask_b32 v102, v78, v82, s[20:21]
    v_mul_f32 v96, v96, v123
    v_mul_f32 v98, v98, v126
    v_mfma_f32_16x16x32_bf16 v[72:75], a[12:15], a[76:79], v[72:75]
    v_mul_f32 v100, v100, v123
    v_mul_f32 v102, v102, v126
    v_max_f32 v4, v96, v98
    v_mfma_f32_16x16x32_bf16 v[60:63], a[16:19], a[80:83], v[60:63]
    v_max_f32 v5, v100, v102
    v_mov_b32 v6, v4
    v_mov_b32 v7, v5
    v_mfma_f32_16x16x32_bf16 v[68:71], a[20:23], a[80:83], v[68:71]
    v_permlane32_swap_b32 v4, v6
    v_permlane32_swap_b32 v5, v7
    v_max_f32 v4, v4, v6
    v_mfma_f32_16x16x32_bf16 v[64:67], a[16:19], a[84:87], v[64:67]
    v_max_f32 v5, v5, v7
    v_mov_b32 v6, v4
    v_mov_b32 v7, v5
    v_mfma_f32_16x16x32_bf16 v[72:75], a[20:23], a[84:87], v[72:75]
    v_permlane16_swap_b32 v4, v6
    v_permlane16_swap_b32 v5, v7
    s_setprio 1
    v_mfma_f32_16x16x32_bf16 v[60:63], a[24:27], a[88:91], v[60:63]
    v_max_f32 v4, v4, v6
    v_max_f32 v5, v5, v7
    v_sub_f32 v96, v96, v4
    v_mfma_f32_16x16x32_bf16 v[68:71], a[28:31], a[88:91], v[68:71]
    v_sub_f32 v98, v98, v4
    v_sub_f32 v100, v100, v5
    v_sub_f32 v102, v102, v5
    v_mfma_f32_16x16x32_bf16 v[64:67], a[24:27], a[92:95], v[64:67]
    v_exp_f32 v96, v96
    v_exp_f32 v98, v98
    v_exp_f32 v100, v100
    v_mfma_f32_16x16x32_bf16 v[72:75], a[28:31], a[92:95], v[72:75]
    v_exp_f32 v102, v102
    v_cvt_pk_bf16_f32 v96, v96, v96
    s_waitcnt lgkmcnt(12)
    v_mfma_f32_16x16x32_bf16 v[60:63], a[32:35], a[96:99], v[60:63]
    v_cvt_pk_bf16_f32 v97, v98, v98
    v_cvt_pk_bf16_f32 v100, v100, v100
    v_cvt_pk_bf16_f32 v101, v102, v102
    v_mfma_f32_16x16x32_bf16 v[68:71], a[36:39], a[96:99], v[68:71]
    v_and_b32 v98, v96, v118
    v_and_b32 v99, v97, v119
    v_and_b32 v96, v96, v116
    v_mfma_f32_16x16x32_bf16 v[64:67], a[32:35], a[100:103], v[64:67]
    v_and_b32 v97, v97, v117
    v_and_b32 v102, v100, v118
    v_and_b32 v103, v101, v119
    v_mfma_f32_16x16x32_bf16 v[72:75], a[36:39], a[100:103], v[72:75]
    v_and_b32 v100, v100, v116
    v_and_b32 v101, v101, v117
    s_waitcnt lgkmcnt(8)
    v_mfma_f32_16x16x32_bf16 v[60:63], a[40:43], a[104:107], v[60:63]
    s_lshl_b32 s36, s44, 6
    s_add_u32 s36, s36, 156160
    v_lshl_add_u32 v48, v2, 4, s36
    v_xor_b32 v49, 64, v48
    ds_read_b128 v[28:31], v48 offset:0
    v_mfma_f32_16x16x32_bf16 v[68:71], a[44:47], a[104:107], v[68:71]
    ds_read_b128 v[32:35], v48 offset:512
    ds_read_b128 v[36:39], v49 offset:0
    ds_read_b128 v[40:43], v49 offset:512
    s_lshl_b32 s36, s27, 3
    s_add_u32 s36, s36, 157696
    v_mfma_f32_16x16x32_bf16 v[64:67], a[40:43], a[108:111], v[64:67]
    v_lshl_add_u32 v48, v3, 4, s36
    v_mov_b32 v49, 157952
    v_lshl_add_u32 v125, v1, 3, s45
    s_lshl_b32 s36, s27, 10
    v_add_u32 v50, s36, v125
    v_mfma_f32_16x16x32_bf16 v[72:75], a[44:47], a[108:111], v[72:75]
    s_lshl_b32 s37, s27, 12
    s_sub_u32 s37, 2048, s37
    v_add_u32 v51, s37, v50
    v_subrev_u32 v125, 2048, v125
    s_setprio 0
    s_waitcnt lgkmcnt(8)
    v_mfma_f32_16x16x32_bf16 v[60:63], a[48:51], a[112:115], v[60:63]
    v_mfma_f32_16x16x32_bf16 v[68:71], a[52:55], a[112:115], v[68:71]
    v_mfma_f32_16x16x32_bf16 v[64:67], a[48:51], a[116:119], v[64:67]
    v_mfma_f32_16x16x32_bf16 v[72:75], a[52:55], a[116:119], v[72:75]
    s_waitcnt vmcnt(1)
Lfl_chk:
    v_cmp_eq_u32 vcc, s34, v20
    s_nop 0
    s_and_b32 s36, vcc_lo, 0x3ff
    s_cmp_lg_u32 s36, 0x3ff
    s_cbranch_scc1 Lfl_re
    buffer_load_dwordx2 v[52:53], v13, s[28:31], s59 offen offset:8 sc1
    buffer_load_dwordx2 v[54:55], v13, s[28:31], s60 offen offset:0 sc1
    s_waitcnt lgkmcnt(4)
    v_mfma_f32_16x16x32_bf16 v[60:63], a[56:59], a[120:123], v[60:63]
    v_mfma_f32_16x16x32_bf16 v[68:71], a[60:63], a[120:123], v[68:71]
    v_mfma_f32_16x16x32_bf16 v[64:67], a[56:59], a[124:127], v[64:67]
    v_mfma_f32_16x16x32_bf16 v[72:75], a[60:63], a[124:127], v[72:75]
    ds_read_b32 v46, v49
    ds_read_b64 v[44:45], v48
    s_waitcnt lgkmcnt(0)
Lcsv:
    v_readfirstlane_b32 s38, v46
    s_nop 0
    s_cmp_eq_u32 s38, 0
    s_cbranch_scc1 Lcsv_re
    v_fmac_f32 v60, v28, v44
    v_fmac_f32 v61, v29, v44
    v_fmac_f32 v62, v30, v44
    v_fmac_f32 v63, v31, v44
    v_mul_f32 v60, v60, v32
    v_mul_f32 v61, v61, v33
    v_mul_f32 v62, v62, v34
    v_mul_f32 v63, v63, v35
    v_cvt_pk_bf16_f32 v60, v60, v61
    v_cvt_pk_bf16_f32 v61, v62, v63
    ds_write_b64 v50, v[60:61] offset:0
    v_fmac_f32 v64, v28, v45
    v_fmac_f32 v65, v29, v45
    v_fmac_f32 v66, v30, v45
    v_fmac_f32 v67, v31, v45
    v_mul_f32 v64, v64, v32
    v_mul_f32 v65, v65, v33
    v_mul_f32 v66, v66, v34
    v_mul_f32 v67, v67, v35
    v_cvt_pk_bf16_f32 v64, v64, v65
    v_cvt_pk_bf16_f32 v65, v66, v67
    ds_write_b64 v50, v[64:65] offset:512
    v_fmac_f32 v68, v36, v44
    v_fmac_f32 v69, v37, v44
    v_fmac_f32 v70, v38, v44
    v_fmac_f32 v71, v39, v44
    v_mul_f32 v68, v68, v40
    v_mul_f32 v69, v69, v41
    v_mul_f32 v70, v70, v42
    v_mul_f32 v71, v71, v43
    v_cvt_pk_bf16_f32 v68, v68, v69
    v_cvt_pk_bf16_f32 v69, v70, v71
    ds_write_b64 v51, v[68:69] offset:0
    v_fmac_f32 v72, v36, v45
    v_fmac_f32 v73, v37, v45
    v_fmac_f32 v74, v38, v45
    v_fmac_f32 v75, v39, v45
    v_mul_f32 v72, v72, v40
    v_mul_f32 v73, v73, v41
    v_mul_f32 v74, v74, v42
    v_mul_f32 v75, v75, v43
    v_cvt_pk_bf16_f32 v72, v72, v73
    v_cvt_pk_bf16_f32 v73, v74, v75
    ds_write_b64 v51, v[72:73] offset:512
    v_mov_b32 v8, 157976
    v_mov_b32 v9, 1
    s_mov_b64 exec, 1
    ds_add_u32 v8, v9
    s_mov_b64 exec, -1
Lcw_4:
    s_sub_u32 s35, s35, 1
    s_cbranch_scc1 Lend
    ds_read_b32 v9, v8
    s_waitcnt lgkmcnt(0)
    v_readfirstlane_b32 s38, v9
    s_nop 0
    s_cmp_lt_u32 s38, 7
    s_cbranch_scc1 Lcw_4
    s_setprio 2
    ds_read2st64_b64 v[60:63], v125 offset0:0 offset1:4
    ds_read2st64_b64 v[64:67], v125 offset0:1 offset1:5
    ds_read2st64_b64 v[68:71], v125 offset0:2 offset1:6
    ds_read2st64_b64 v[72:75], v125 offset0:3 offset1:7
    v_mfma_f32_16x16x32_bf16 v[80:83], v[14:17], v[96:99], 0
    v_mfma_f32_16x16x32_bf16 v[84:87], v[14:17], v[100:103], 0
    v_and_b32 v6, 3, v1
    v_lshl_add_u32 v6, v6, 3, v19
    v_add_u32 v20, v6, v18
    v_xor_b32 v21, 32, v20
    v_xor_b32 v22, 64, v20
    v_xor_b32 v23, 96, v20
    s_waitcnt lgkmcnt(0)
    v_mfma_f32_16x16x32_bf16 v[28:31], v[60:63], v[96:99], 0
    v_add_u32 v24, 63616, v20
    v_mfma_f32_16x16x32_bf16 v[40:43], v[72:75], v[100:103], 0
    v_add_u32 v25, 63616, v21
    v_mfma_f32_16x16x32_bf16 v[32:35], v[64:67], v[96:99], 0
    v_add_u32 v26, 63616, v22
    v_mfma_f32_16x16x32_bf16 v[36:39], v[68:71], v[100:103], 0
    v_add_u32 v27, 63616, v23
    v_rcp_f32 v80, v80
    v_rcp_f32 v84, v84
    v_mul_f32 v28, v28, v80
    v_mul_f32 v29, v29, v80
    v_mul_f32 v30, v30, v80
    v_mul_f32 v31, v31, v80
    v_cvt_pk_bf16_f32 v8, v28, v29
    v_cvt_pk_bf16_f32 v9, v30, v31
    v_min_u32 v8, -2, v8
    v_min_u32 v9, -2, v9
    v_mul_f32 v40, v40, v84
    v_mul_f32 v41, v41, v84
    v_mul_f32 v42, v42, v84
    v_mul_f32 v43, v43, v84
    v_cvt_pk_bf16_f32 v10, v40, v41
    v_cvt_pk_bf16_f32 v11, v42, v43
    v_min_u32 v10, -2, v10
    v_min_u32 v11, -2, v11
    buffer_store_dwordx4 v[8:11], v13, s[28:31], s23 offen sc0 sc1
    s_waitcnt vmcnt(1)
Lrx_chk:
    v_and_b32 v52, s61, v52
    v_and_b32 v53, s61, v53
    v_and_b32 v54, s62, v54
    v_and_b32 v55, s62, v55
    v_max3_u32 v4, v52, v53, v54
    v_max_u32 v4, v4, v55
    v_cmp_eq_u32 vcc, -1, v4
    s_nop 0
    s_cbranch_vccnz Lrx_re
    v_add_f32 v92, v92, v52
    v_add_f32 v94, v94, v53
    v_add_f32 v104, v104, v54
    v_add_f32 v106, v106, v55
    v_mul_f32 v92, v92, v123
    v_mul_f32 v94, v94, v126
    v_mul_f32 v104, v104, v123
    v_mul_f32 v106, v106, v126
    v_max_f32 v4, v92, v94
    v_max_f32 v5, v104, v106
    v_mov_b32 v6, v4
    v_mov_b32 v7, v5
    s_nop 0
    v_permlane32_swap_b32 v4, v6
    v_permlane32_swap_b32 v5, v7
    v_max_f32 v4, v4, v6
    v_max_f32 v5, v5, v7
    v_mov_b32 v6, v4
    v_mov_b32 v7, v5
    s_nop 0
    v_permlane16_swap_b32 v4, v6
    v_permlane16_swap_b32 v5, v7
    v_max_f32 v4, v4, v6
    v_max_f32 v5, v5, v7
    v_sub_f32 v92, v92, v4
    v_sub_f32 v94, v94, v4
    v_sub_f32 v104, v104, v5
    v_sub_f32 v106, v106, v5
    v_exp_f32 v92, v92
    v_exp_f32 v94, v94
    v_exp_f32 v104, v104
    v_exp_f32 v106, v106
    v_cvt_pk_bf16_f32 v92, v92, v92
    v_cvt_pk_bf16_f32 v93, v94, v94
    v_cvt_pk_bf16_f32 v104, v104, v104
    v_cvt_pk_bf16_f32 v105, v106, v106
    v_and_b32 v94, v92, v118
    v_and_b32 v95, v93, v119
    v_and_b32 v92, v92, v116
    v_and_b32 v93, v93, v117
    v_and_b32 v106, v104, v118
    v_and_b32 v107, v105, v119
    v_and_b32 v104, v104, v116
    v_and_b32 v105, v105, v117
    v_mfma_f32_16x16x32_bf16 v[76:79], v[14:17], v[92:95], 0
    s_nop 0
    v_mfma_f32_16x16x32_bf16 v[88:91], v[14:17], v[104:107], 0
    v_mfma_f32_16x16x32_bf16 v[44:47], v[64:67], v[92:95], 0
    v_mfma_f32_16x16x32_bf16 v[48:51], v[68:71], v[92:95], 0
    v_mfma_f32_16x16x32_bf16 v[52:55], v[64:67], v[104:107], 0
    v_mfma_f32_16x16x32_bf16 v[56:59], v[68:71], v[104:107], 0
    s_nop 1
    v_rcp_f32 v76, v76
    s_nop 0
    v_rcp_f32 v88, v88
    v_cndmask_b32 v82, v80, v76, s[6:7]
    v_cndmask_b32 v82, v82, v88, s[8:9]
    v_cndmask_b32 v32, v32, v44, s[6:7]
    v_cndmask_b32 v33, v33, v45, s[6:7]
    v_cndmask_b32 v34, v34, v46, s[6:7]
    v_cndmask_b32 v35, v35, v47, s[6:7]
    v_cndmask_b32 v32, v32, v52, s[8:9]
    v_cndmask_b32 v33, v33, v53, s[8:9]
    v_cndmask_b32 v34, v34, v54, s[8:9]
    v_cndmask_b32 v35, v35, v55, s[8:9]
    v_mul_f32 v32, v32, v82
    v_mul_f32 v33, v33, v82
    v_mul_f32 v34, v34, v82
    v_mul_f32 v35, v35, v82
    v_cvt_pk_bf16_f32 v4, v32, v33
    v_cvt_pk_bf16_f32 v5, v34, v35
    v_min_u32 v4, -2, v4
    v_min_u32 v5, -2, v5
    v_cndmask_b32 v86, v84, v76, s[12:13]
    v_cndmask_b32 v86, v86, v88, s[14:15]
    v_cndmask_b32 v36, v36, v48, s[12:13]
    v_cndmask_b32 v37, v37, v49, s[12:13]
    v_cndmask_b32 v38, v38, v50, s[12:13]
    v_cndmask_b32 v39, v39, v51, s[12:13]
    v_cndmask_b32 v36, v36, v56, s[14:15]
    v_cndmask_b32 v37, v37, v57, s[14:15]
    v_cndmask_b32 v38, v38, v58, s[14:15]
    v_cndmask_b32 v39, v39, v59, s[14:15]
    v_mul_f32 v36, v36, v86
    v_mul_f32 v37, v37, v86
    v_mul_f32 v38, v38, v86
    v_mul_f32 v39, v39, v86
    v_cvt_pk_bf16_f32 v6, v36, v37
    v_cvt_pk_bf16_f32 v7, v38, v39
    v_min_u32 v6, -2, v6
    v_min_u32 v7, -2, v7
    buffer_store_dwordx4 v[4:7], v13, s[28:31], s23 offen offset:1024 sc0 sc1
    s_setprio 1
    v_mov_b32 v10, 157980
Lcw_3:
    s_sub_u32 s35, s35, 1
    s_cbranch_scc1 Lend
    ds_read_b32 v11, v10
    s_waitcnt lgkmcnt(0)
    v_readfirstlane_b32 s38, v11
    s_nop 0
    s_cmp_lt_u32 s38, 2
    s_cbranch_scc1 Lcw_3
    s_mul_i32 s36, s32, 96
    s_lshl_b32 s37, s44, 4
    s_add_u32 s36, s36, s37
    s_sub_u32 s36, s36, 32
    v_add_u32 v126, s36, v3
    v_lshrrev_b32 v6, 3, v1
    v_add_u32 v6, s36, v6
    v_mul_u32_u24 v6, 1280, v6
    v_and_b32 v7, 7, v1
    v_xor_b32 v7, v7, v2
    v_lshl_add_u32 v122, v7, 4, v6
    v_xor_b32 v123, 64, v122
    v_add_u32 v123, 10240, v123
    s_lshl_b32 s36, s44, 11
    s_add_u32 s36, s36, 102656
    v_add_u32 v124, s36, v124
    v_add_u32 v125, s36, v13
    s_lshl_b32 s24, s33, 7
    v_mov_b32 v10, 157960
    s_mov_b32 s41, 0
    s_mov_b32 s47, 3
    v_lshlrev_b32 v28, 16, v108
    ds_read_b64_tr_b16 a[0:1], v20 offset:0
    ds_read_b64_tr_b16 a[2:3], v20 offset:512
    ds_read_b64_tr_b16 a[4:5], v21 offset:0
    ds_read_b64_tr_b16 a[6:7], v21 offset:512
    ds_read_b64_tr_b16 a[8:9], v22 offset:0
    ds_read_b64_tr_b16 a[10:11], v22 offset:512
    ds_read_b64_tr_b16 a[12:13], v23 offset:0
    ds_read_b64_tr_b16 a[14:15], v23 offset:512
    v_and_b32 v29, 0xffff0000, v108
    v_lshlrev_b32 v30, 16, v109
    v_and_b32 v31, 0xffff0000, v109
    v_lshlrev_b32 v32, 16, v110
    v_and_b32 v33, 0xffff0000, v110
    v_lshlrev_b32 v34, 16, v111
    v_and_b32 v35, 0xffff0000, v111
    v_lshlrev_b32 v36, 16, v112
    v_and_b32 v37, 0xffff0000, v112
    v_lshlrev_b32 v38, 16, v113
    v_and_b32 v39, 0xffff0000, v113
    v_lshlrev_b32 v40, 16, v114
    v_and_b32 v41, 0xffff0000, v114
    v_lshlrev_b32 v42, 16, v115
    ds_read_b64_tr_b16 a[16:17], v20 offset:4096
    ds_read_b64_tr_b16 a[18:19], v20 offset:4608
    ds_read_b64_tr_b16 a[20:21], v21 offset:4096
    ds_read_b64_tr_b16 a[22:23], v21 offset:4608
    ds_read_b64_tr_b16 a[24:25], v22 offset:4096
    ds_read_b64_tr_b16 a[26:27], v22 offset:4608
    ds_read_b64_tr_b16 a[28:29], v23 offset:4096
    ds_read_b64_tr_b16 a[30:31], v23 offset:4608
    v_and_b32 v43, 0xffff0000, v115
    v_mul_f32 v4, v120, v121
    v_mul_f32 v5, 0xbfb8aa3b, v121
    v_mul_f32 v6, 0xbfb8aa3b, v4
    v_fma_f32 v44, v28, v5, v6
    v_fma_f32 v45, v29, v5, v6
    v_fma_f32 v46, v30, v5, v6
    v_fma_f32 v47, v31, v5, v6
    v_fma_f32 v48, v32, v5, v6
    v_fma_f32 v49, v33, v5, v6
    v_fma_f32 v50, v34, v5, v6
    v_fma_f32 v51, v35, v5, v6
    v_fma_f32 v52, v36, v5, v6
    v_fma_f32 v53, v37, v5, v6
    ds_read_b64_tr_b16 a[32:33], v20 offset:8192
    ds_read_b64_tr_b16 a[34:35], v20 offset:8704
    ds_read_b64_tr_b16 a[36:37], v21 offset:8192
    ds_read_b64_tr_b16 a[38:39], v21 offset:8704
    ds_read_b64_tr_b16 a[40:41], v22 offset:8192
    ds_read_b64_tr_b16 a[42:43], v22 offset:8704
    ds_read_b64_tr_b16 a[44:45], v23 offset:8192
    ds_read_b64_tr_b16 a[46:47], v23 offset:8704
    v_fma_f32 v54, v38, v5, v6
    v_fma_f32 v55, v39, v5, v6
    v_fma_f32 v56, v40, v5, v6
    v_fma_f32 v57, v41, v5, v6
    v_fma_f32 v58, v42, v5, v6
    v_fma_f32 v59, v43, v5, v6
    v_exp_f32 v44, v44
    v_exp_f32 v45, v45
    v_exp_f32 v46, v46
    v_exp_f32 v47, v47
    v_exp_f32 v48, v48
    v_exp_f32 v49, v49
    v_exp_f32 v50, v50
    v_exp_f32 v51, v51
    v_exp_f32 v52, v52
    ds_read_b64_tr_b16 a[48:49], v20 offset:12288
    ds_read_b64_tr_b16 a[50:51], v20 offset:12800
    ds_read_b64_tr_b16 a[52:53], v21 offset:12288
    ds_read_b64_tr_b16 a[54:55], v21 offset:12800
    ds_read_b64_tr_b16 a[56:57], v22 offset:12288
    ds_read_b64_tr_b16 a[58:59], v22 offset:12800
    ds_read_b64_tr_b16 a[60:61], v23 offset:12288
    ds_read_b64_tr_b16 a[62:63], v23 offset:12800
    v_exp_f32 v53, v53
    v_exp_f32 v54, v54
    v_exp_f32 v55, v55
    v_exp_f32 v56, v56
    v_exp_f32 v57, v57
    v_exp_f32 v58, v58
    v_exp_f32 v59, v59
    v_add_f32 v44, 1.0, v44
    v_add_f32 v45, 1.0, v45
    buffer_load_dwordx4 v[60:63], v13, s[28:31], s53 offen offset:0 sc1
    buffer_load_dwordx4 v[64:67], v13, s[28:31], s53 offen offset:2048 sc1
    buffer_load_dwordx4 v[68:71], v13, s[28:31], s54 offen offset:0 sc1
    buffer_load_dwordx4 v[72:75], v13, s[28:31], s54 offen offset:2048 sc1
    buffer_load_dwordx4 v[76:79], v13, s[28:31], s55 offen offset:0 sc1
    buffer_load_dwordx4 v[80:83], v13, s[28:31], s55 offen offset:2048 sc1
    buffer_load_dwordx4 v[84:87], v13, s[28:31], s56 offen offset:0 sc1
    buffer_load_dwordx4 v[88:91], v13, s[28:31], s56 offen offset:2048 sc1
    s_setprio 0
    v_add_f32 v46, 1.0, v46
    v_add_f32 v47, 1.0, v47
    v_add_f32 v48, 1.0, v48
    v_add_f32 v49, 1.0, v49
    v_add_f32 v50, 1.0, v50
    ds_read_b64_tr_b16 a[64:65], v20 offset:24576
    ds_read_b64_tr_b16 a[66:67], v20 offset:25088
    ds_read_b64_tr_b16 a[68:69], v21 offset:24576
    ds_read_b64_tr_b16 a[70:71], v21 offset:25088
    ds_read_b64_tr_b16 a[72:73], v22 offset:24576
    ds_read_b64_tr_b16 a[74:75], v22 offset:25088
    ds_read_b64_tr_b16 a[76:77], v23 offset:24576
    ds_read_b64_tr_b16 a[78:79], v23 offset:25088
    v_add_f32 v51, 1.0, v51
    v_add_f32 v52, 1.0, v52
    v_add_f32 v53, 1.0, v53
    v_add_f32 v54, 1.0, v54
    v_add_f32 v55, 1.0, v55
    v_add_f32 v56, 1.0, v56
    v_add_f32 v57, 1.0, v57
    v_add_f32 v58, 1.0, v58
    v_add_f32 v59, 1.0, v59
    v_rcp_f32 v44, v44
    v_rcp_f32 v45, v45
    v_rcp_f32 v46, v46
    v_rcp_f32 v47, v47
    v_rcp_f32 v48, v48
    ds_read_b64_tr_b16 a[80:81], v20 offset:28672
    ds_read_b64_tr_b16 a[82:83], v20 offset:29184
    ds_read_b64_tr_b16 a[84:85], v21 offset:28672
    ds_read_b64_tr_b16 a[86:87], v21 offset:29184
    ds_read_b64_tr_b16 a[88:89], v22 offset:28672
    ds_read_b64_tr_b16 a[90:91], v22 offset:29184
    ds_read_b64_tr_b16 a[92:93], v23 offset:28672
    ds_read_b64_tr_b16 a[94:95], v23 offset:29184
    v_rcp_f32 v49, v49
    v_rcp_f32 v50, v50
    v_rcp_f32 v51, v51
    v_rcp_f32 v52, v52
    v_rcp_f32 v53, v53
    v_rcp_f32 v54, v54
    v_rcp_f32 v55, v55
    v_rcp_f32 v56, v56
    v_rcp_f32 v57, v57
    v_rcp_f32 v58, v58
    v_rcp_f32 v59, v59
    v_fma_f32 v7, v28, v121, v4
    v_mul_f32 v44, v44, v7
    v_fma_f32 v11, v29, v121, v4
    v_mul_f32 v45, v45, v11
    ds_read_b64_tr_b16 a[96:97], v24 offset:59520
    ds_read_b64_tr_b16 a[98:99], v24 offset:60032
    ds_read_b64_tr_b16 a[100:101], v25 offset:59520
    ds_read_b64_tr_b16 a[102:103], v25 offset:60032
    ds_read_b64_tr_b16 a[104:105], v26 offset:59520
    ds_read_b64_tr_b16 a[106:107], v26 offset:60032
    ds_read_b64_tr_b16 a[108:109], v27 offset:59520
    ds_read_b64_tr_b16 a[110:111], v27 offset:60032
    v_fma_f32 v7, v30, v121, v4
    v_mul_f32 v46, v46, v7
    v_fma_f32 v11, v31, v121, v4
    v_mul_f32 v47, v47, v11
    v_fma_f32 v7, v32, v121, v4
    v_mul_f32 v48, v48, v7
    v_fma_f32 v11, v33, v121, v4
    v_mul_f32 v49, v49, v11
    v_fma_f32 v7, v34, v121, v4
    v_mul_f32 v50, v50, v7
    v_fma_f32 v11, v35, v121, v4
    v_mul_f32 v51, v51, v11
    v_fma_f32 v7, v36, v121, v4
    v_mul_f32 v52, v52, v7
    ds_read_b64_tr_b16 a[112:113], v24 offset:63616
    ds_read_b64_tr_b16 a[114:115], v24 offset:64128
    ds_read_b64_tr_b16 a[116:117], v25 offset:63616
    ds_read_b64_tr_b16 a[118:119], v25 offset:64128
    ds_read_b64_tr_b16 a[120:121], v26 offset:63616
    ds_read_b64_tr_b16 a[122:123], v26 offset:64128
    ds_read_b64_tr_b16 a[124:125], v27 offset:63616
    ds_read_b64_tr_b16 a[126:127], v27 offset:64128
    v_fma_f32 v11, v37, v121, v4
    v_mul_f32 v53, v53, v11
    v_fma_f32 v7, v38, v121, v4
    v_mul_f32 v54, v54, v7
    v_fma_f32 v11, v39, v121, v4
    v_mul_f32 v55, v55, v11
    v_fma_f32 v7, v40, v121, v4
    v_mul_f32 v56, v56, v7
    v_fma_f32 v11, v41, v121, v4
    v_mul_f32 v57, v57, v11
    v_fma_f32 v7, v42, v121, v4
    v_mul_f32 v58, v58, v7
    v_fma_f32 v11, v43, v121, v4
    v_mul_f32 v59, v59, v11
Lwo_go:
    s_setprio 3
    ds_read_b64 v[8:9], v10
    s_waitcnt vmcnt(6)
    v_max3_u32 v18, v60, v61, v62
    v_max3_u32 v19, v64, v65, v66
    v_max3_u32 v18, v18, v63, v67
    v_max_u32 v18, v18, v19
    v_cmp_eq_u32 vcc, -1, v18
    s_nop 0
    s_cbranch_vccnz Lre_0
Lck_0:
    s_waitcnt lgkmcnt(15)
    v_mfma_f32_16x16x32_bf16 v[108:111], a[0:3], v[60:63], 0
    ds_read_b64_tr_b16 a[0:1], v24 offset:16384
    ds_read_b64_tr_b16 a[2:3], v24 offset:16896
    buffer_load_dwordx4 v[92:95], v13, s[28:31], s57 offen offset:0 sc1
    v_mfma_f32_16x16x32_bf16 v[112:115], a[4:7], v[60:63], 0
    ds_read_b64_tr_b16 a[4:5], v25 offset:16384
    ds_read_b64_tr_b16 a[6:7], v25 offset:16896
    v_mfma_f32_16x16x32_bf16 v[116:119], a[8:11], v[60:63], 0
    ds_read_b64_tr_b16 a[8:9], v26 offset:16384
    buffer_load_dwordx4 v[96:99], v13, s[28:31], s57 offen offset:2048 sc1
    v_mfma_f32_16x16x32_bf16 v[14:17], a[12:15], v[60:63], 0
    ds_read_b64_tr_b16 a[10:11], v26 offset:16896
    ds_read_b64_tr_b16 a[12:13], v27 offset:16384
    v_mfma_f32_16x16x32_bf16 v[108:111], a[16:19], v[64:67], v[108:111]
    ds_read_b64_tr_b16 a[14:15], v27 offset:16896
    s_waitcnt vmcnt(6)
    v_max3_u32 v18, v68, v69, v70
    v_mfma_f32_16x16x32_bf16 v[112:115], a[20:23], v[64:67], v[112:115]
    ds_read_b64_tr_b16 a[16:17], v24 offset:20480
    ds_read_b64_tr_b16 a[18:19], v24 offset:20992
    v_max3_u32 v19, v72, v73, v74
    v_max3_u32 v18, v18, v71, v75
    v_mfma_f32_16x16x32_bf16 v[116:119], a[24:27], v[64:67], v[116:119]
    ds_read_b64_tr_b16 a[20:21], v25 offset:20480
    ds_read_b64_tr_b16 a[22:23], v25 offset:20992
    v_max_u32 v18, v18, v19
    v_cmp_eq_u32 vcc, -1, v18
    v_mfma_f32_16x16x32_bf16 v[14:17], a[28:31], v[64:67], v[14:17]
    ds_read_b64_tr_b16 a[24:25], v26 offset:20480
    s_cbranch_vccnz Lre_1
Lck_1:
    s_waitcnt lgkmcnt(13)
Linfo:
    v_readfirstlane_b32 s39, v8
    s_nop 0
    s_cmp_eq_u32 s39, -2
    s_cbranch_scc1 Linfo_re
    v_mfma_f32_16x16x32_bf16 v[108:111], a[32:35], v[68:71], v[108:111]
    ds_read_b64_tr_b16 a[26:27], v26 offset:20992
    ds_read_b64_tr_b16 a[28:29], v27 offset:20480
    buffer_load_dwordx4 v[100:103], v13, s[28:31], s53 offen offset:1024 sc1
    v_mfma_f32_16x16x32_bf16 v[112:115], a[36:39], v[68:71], v[112:115]
    ds_read_b64_tr_b16 a[30:31], v27 offset:20992
    v_mfma_f32_16x16x32_bf16 v[116:119], a[40:43], v[68:71], v[116:119]
    ds_read_b64_tr_b16 a[32:33], v20 offset:32768
    ds_read_b64_tr_b16 a[34:35], v20 offset:33280
    buffer_load_dwordx4 v[104:107], v13, s[28:31], s53 offen offset:3072 sc1
    v_mfma_f32_16x16x32_bf16 v[14:17], a[44:47], v[68:71], v[14:17]
    ds_read_b64_tr_b16 a[36:37], v21 offset:32768
    ds_read_b64_tr_b16 a[38:39], v21 offset:33280
    v_mfma_f32_16x16x32_bf16 v[108:111], a[48:51], v[72:75], v[108:111]
    ds_read_b64_tr_b16 a[40:41], v22 offset:32768
    s_waitcnt vmcnt(6)
    v_max3_u32 v18, v76, v77, v78
    v_mfma_f32_16x16x32_bf16 v[112:115], a[52:55], v[72:75], v[112:115]
    ds_read_b64_tr_b16 a[42:43], v22 offset:33280
    ds_read_b64_tr_b16 a[44:45], v23 offset:32768
    v_max3_u32 v19, v80, v81, v82
    v_max3_u32 v18, v18, v79, v83
    v_mfma_f32_16x16x32_bf16 v[116:119], a[56:59], v[72:75], v[116:119]
    ds_read_b64_tr_b16 a[46:47], v23 offset:33280
    v_max_u32 v18, v18, v19
    v_cmp_eq_u32 vcc, -1, v18
    v_mfma_f32_16x16x32_bf16 v[14:17], a[60:63], v[72:75], v[14:17]
    ds_read_b64_tr_b16 a[48:49], v20 offset:36864
    ds_read_b64_tr_b16 a[50:51], v20 offset:37376
    s_cbranch_vccnz Lre_2
Lck_2:
    v_mfma_f32_16x16x32_bf16 v[108:111], a[64:67], v[76:79], v[108:111]
    ds_read_b64_tr_b16 a[52:53], v21 offset:36864
    ds_read_b64_tr_b16 a[54:55], v21 offset:37376
    buffer_load_dwordx4 v[60:63], v13, s[28:31], s54 offen offset:1024 sc1
    v_mfma_f32_16x16x32_bf16 v[112:115], a[68:71], v[76:79], v[112:115]
    ds_read_b64_tr_b16 a[56:57], v22 offset:36864
    v_mfma_f32_16x16x32_bf16 v[116:119], a[72:75], v[76:79], v[116:119]
    ds_read_b64_tr_b16 a[58:59], v22 offset:37376
    ds_read_b64_tr_b16 a[60:61], v23 offset:36864
    buffer_load_dwordx4 v[64:67], v13, s[28:31], s54 offen offset:3072 sc1
    v_mfma_f32_16x16x32_bf16 v[14:17], a[76:79], v[76:79], v[14:17]
    ds_read_b64_tr_b16 a[62:63], v23 offset:37376
    v_mfma_f32_16x16x32_bf16 v[108:111], a[80:83], v[80:83], v[108:111]
    ds_read_b64_tr_b16 a[64:65], v20 offset:40960
    ds_read_b64_tr_b16 a[66:67], v20 offset:41472
    s_waitcnt vmcnt(6)
    v_max3_u32 v18, v84, v85, v86
    v_mfma_f32_16x16x32_bf16 v[112:115], a[84:87], v[80:83], v[112:115]
    ds_read_b64_tr_b16 a[68:69], v21 offset:40960
    ds_read_b64_tr_b16 a[70:71], v21 offset:41472
    v_max3_u32 v19, v88, v89, v90
    v_max3_u32 v18, v18, v87, v91
    v_mfma_f32_16x16x32_bf16 v[116:119], a[88:91], v[80:83], v[116:119]
    ds_read_b64_tr_b16 a[72:73], v22 offset:40960
    v_max_u32 v18, v18, v19
    v_cmp_eq_u32 vcc, -1, v18
    v_mfma_f32_16x16x32_bf16 v[14:17], a[92:95], v[80:83], v[14:17]
    ds_read_b64_tr_b16 a[74:75], v22 offset:41472
    ds_read_b64_tr_b16 a[76:77], v23 offset:40960
    s_cbranch_vccnz Lre_3
Lck_3:
    s_setprio 2
    v_mfma_f32_16x16x32_bf16 v[108:111], a[96:99], v[84:87], v[108:111]
    ds_read_b64_tr_b16 a[78:79], v23 offset:41472
    buffer_load_dwordx4 v[68:71], v13, s[28:31], s55 offen offset:1024 sc1
    v_mfma_f32_16x16x32_bf16 v[112:115], a[100:103], v[84:87], v[112:115]
    ds_read_b64_tr_b16 a[80:81], v20 offset:45056
    ds_read_b64_tr_b16 a[82:83], v20 offset:45568
    v_mfma_f32_16x16x32_bf16 v[116:119], a[104:107], v[84:87], v[116:119]
    ds_read_b64_tr_b16 a[84:85], v21 offset:45056
    ds_read_b64_tr_b16 a[86:87], v21 offset:45568
    buffer_load_dwordx4 v[72:75], v13, s[28:31], s55 offen offset:3072 sc1
    v_mfma_f32_16x16x32_bf16 v[14:17], a[108:111], v[84:87], v[14:17]
    ds_read_b64_tr_b16 a[88:89], v22 offset:45056
    v_mfma_f32_16x16x32_bf16 v[108:111], a[112:115], v[88:91], v[108:111]
    ds_read_b64_tr_b16 a[90:91], v22 offset:45568
    ds_read_b64_tr_b16 a[92:93], v23 offset:45056
    s_waitcnt vmcnt(6)
    v_max3_u32 v18, v92, v93, v94
    v_mfma_f32_16x16x32_bf16 v[112:115], a[116:119], v[88:91], v[112:115]
    ds_read_b64_tr_b16 a[94:95], v23 offset:45568
    v_max3_u32 v19, v96, v97, v98
    v_max3_u32 v18, v18, v95, v99
    v_mfma_f32_16x16x32_bf16 v[116:119], a[120:123], v[88:91], v[116:119]
    ds_read_b64_tr_b16 a[96:97], v24 offset:0
    ds_read_b64_tr_b16 a[98:99], v24 offset:512
    v_max_u32 v18, v18, v19
    v_cmp_eq_u32 vcc, -1, v18
    v_mfma_f32_16x16x32_bf16 v[14:17], a[124:127], v[88:91], v[14:17]
    ds_read_b64_tr_b16 a[100:101], v25 offset:0
    ds_read_b64_tr_b16 a[102:103], v25 offset:512
    s_cbranch_vccnz Lre_4
Lck_4:
    s_waitcnt lgkmcnt(15)
    v_mfma_f32_16x16x32_bf16 v[108:111], a[0:3], v[92:95], v[108:111]
    ds_read_b64_tr_b16 a[104:105], v26 offset:0
    buffer_load_dwordx4 v[76:79], v13, s[28:31], s56 offen offset:1024 sc1
    v_mfma_f32_16x16x32_bf16 v[112:115], a[4:7], v[92:95], v[112:115]
    ds_read_b64_tr_b16 a[106:107], v26 offset:512
    ds_read_b64_tr_b16 a[108:109], v27 offset:0
    v_mfma_f32_16x16x32_bf16 v[116:119], a[8:11], v[92:95], v[116:119]
    ds_read_b64_tr_b16 a[110:111], v27 offset:512
    buffer_load_dwordx4 v[80:83], v13, s[28:31], s56 offen offset:3072 sc1
    v_mfma_f32_16x16x32_bf16 v[14:17], a[12:15], v[92:95], v[14:17]
    ds_read_b64_tr_b16 a[112:113], v24 offset:4096
    ds_read_b64_tr_b16 a[114:115], v24 offset:4608
    v_mfma_f32_16x16x32_bf16 v[108:111], a[16:19], v[96:99], v[108:111]
    ds_read_b64_tr_b16 a[116:117], v25 offset:4096
    ds_read_b64_tr_b16 a[118:119], v25 offset:4608
    s_waitcnt vmcnt(6)
    v_max3_u32 v18, v100, v101, v102
    v_mfma_f32_16x16x32_bf16 v[112:115], a[20:23], v[96:99], v[112:115]
    ds_read_b64_tr_b16 a[120:121], v26 offset:4096
    v_max3_u32 v19, v104, v105, v106
    v_max3_u32 v18, v18, v103, v107
    v_mfma_f32_16x16x32_bf16 v[116:119], a[24:27], v[96:99], v[116:119]
    ds_read_b64_tr_b16 a[122:123], v26 offset:4608
    ds_read_b64_tr_b16 a[124:125], v27 offset:4096
    v_max_u32 v18, v18, v19
    v_cmp_eq_u32 vcc, -1, v18
    v_mfma_f32_16x16x32_bf16 v[14:17], a[28:31], v[96:99], v[14:17]
    ds_read_b64_tr_b16 a[126:127], v27 offset:4608
    s_cbranch_vccnz Lre_5
Lck_5:
    v_mfma_f32_16x16x32_bf16 v[108:111], a[32:35], v[100:103], v[108:111]
    ds_read_b64_tr_b16 a[0:1], v24 offset:8192
    ds_read_b64_tr_b16 a[2:3], v24 offset:8704
    buffer_load_dwordx4 v[84:87], v13, s[28:31], s57 offen offset:1024 sc1
    v_mfma_f32_16x16x32_bf16 v[112:115], a[36:39], v[100:103], v[112:115]
    ds_read_b64_tr_b16 a[4:5], v25 offset:8192
    ds_read_b64_tr_b16 a[6:7], v25 offset:8704
    v_mfma_f32_16x16x32_bf16 v[116:119], a[40:43], v[100:103], v[116:119]
    ds_read_b64_tr_b16 a[8:9], v26 offset:8192
    buffer_load_dwordx4 v[88:91], v13, s[28:31], s57 offen offset:3072 sc1
    v_mfma_f32_16x16x32_bf16 v[14:17], a[44:47], v[100:103], v[14:17]
    ds_read_b64_tr_b16 a[10:11], v26 offset:8704
    ds_read_b64_tr_b16 a[12:13], v27 offset:8192
    v_mfma_f32_16x16x32_bf16 v[108:111], a[48:51], v[104:107], v[108:111]
    ds_read_b64_tr_b16 a[14:15], v27 offset:8704
    s_waitcnt vmcnt(6)
    v_max3_u32 v18, v60, v61, v62
    v_mfma_f32_16x16x32_bf16 v[112:115], a[52:55], v[104:107], v[112:115]
    ds_read_b64_tr_b16 a[16:17], v24 offset:12288
    ds_read_b64_tr_b16 a[18:19], v24 offset:12800
    v_max3_u32 v19, v64, v65, v66
    v_max3_u32 v18, v18, v63, v67
    v_mfma_f32_16x16x32_bf16 v[116:119], a[56:59], v[104:107], v[116:119]
    ds_read_b64_tr_b16 a[20:21], v25 offset:12288
    ds_read_b64_tr_b16 a[22:23], v25 offset:12800
    v_max_u32 v18, v18, v19
    v_cmp_eq_u32 vcc, -1, v18
    v_mfma_f32_16x16x32_bf16 v[14:17], a[60:63], v[104:107], v[14:17]
    ds_read_b64_tr_b16 a[24:25], v26 offset:12288
    s_cbranch_vccnz Lre_6
Lck_6:
    s_setprio 1
    s_waitcnt lgkmcnt(15)
    v_mfma_f32_16x16x32_bf16 v[108:111], a[64:67], v[60:63], v[108:111]
    ds_read_b64_tr_b16 a[26:27], v26 offset:12800
    ds_read_b64_tr_b16 a[28:29], v27 offset:12288
    v_mfma_f32_16x16x32_bf16 v[112:115], a[68:71], v[60:63], v[112:115]
    ds_read_b64_tr_b16 a[30:31], v27 offset:12800
    v_mfma_f32_16x16x32_bf16 v[116:119], a[72:75], v[60:63], v[116:119]
    ds_read_b64_tr_b16 a[32:33], v20 offset:49152
    ds_read_b64_tr_b16 a[34:35], v20 offset:49664
    v_mfma_f32_16x16x32_bf16 v[14:17], a[76:79], v[60:63], v[14:17]
    ds_read_b64_tr_b16 a[36:37], v21 offset:49152
    ds_read_b64_tr_b16 a[38:39], v21 offset:49664
    v_mfma_f32_16x16x32_bf16 v[108:111], a[80:83], v[64:67], v[108:111]
    ds_read_b64_tr_b16 a[40:41], v22 offset:49152
    s_waitcnt vmcnt(4)
    v_max3_u32 v18, v68, v69, v70
    v_mfma_f32_16x16x32_bf16 v[112:115], a[84:87], v[64:67], v[112:115]
    ds_read_b64_tr_b16 a[42:43], v22 offset:49664
    ds_read_b64_tr_b16 a[44:45], v23 offset:49152
    v_max3_u32 v19, v72, v73, v74
    v_max3_u32 v18, v18, v71, v75
    v_mfma_f32_16x16x32_bf16 v[116:119], a[88:91], v[64:67], v[116:119]
    ds_read_b64_tr_b16 a[46:47], v23 offset:49664
    v_max_u32 v18, v18, v19
    v_cmp_eq_u32 vcc, -1, v18
    v_mfma_f32_16x16x32_bf16 v[14:17], a[92:95], v[64:67], v[14:17]
    ds_read_b64_tr_b16 a[48:49], v24 offset:24576
    ds_read_b64_tr_b16 a[50:51], v24 offset:25088
    s_cbranch_vccnz Lre_7
Lck_7:
    v_mfma_f32_16x16x32_bf16 v[108:111], a[96:99], v[68:71], v[108:111]
    ds_read_b64_tr_b16 a[52:53], v25 offset:24576
    ds_read_b64_tr_b16 a[54:55], v25 offset:25088
    v_mfma_f32_16x16x32_bf16 v[112:115], a[100:103], v[68:71], v[112:115]
    ds_read_b64_tr_b16 a[56:57], v26 offset:24576
    v_mfma_f32_16x16x32_bf16 v[116:119], a[104:107], v[68:71], v[116:119]
    ds_read_b64_tr_b16 a[58:59], v26 offset:25088
    ds_read_b64_tr_b16 a[60:61], v27 offset:24576
    v_mfma_f32_16x16x32_bf16 v[14:17], a[108:111], v[68:71], v[14:17]
    ds_read_b64_tr_b16 a[62:63], v27 offset:25088
    s_waitcnt lgkmcnt(15)
    v_mfma_f32_16x16x32_bf16 v[108:111], a[112:115], v[72:75], v[108:111]
    s_waitcnt vmcnt(2)
    v_max3_u32 v18, v76, v77, v78
    v_mfma_f32_16x16x32_bf16 v[112:115], a[116:119], v[72:75], v[112:115]
    v_max3_u32 v19, v80, v81, v82
    v_max3_u32 v18, v18, v79, v83
    v_mfma_f32_16x16x32_bf16 v[116:119], a[120:123], v[72:75], v[116:119]
    v_max_u32 v18, v18, v19
    v_cmp_eq_u32 vcc, -1, v18
    v_mfma_f32_16x16x32_bf16 v[14:17], a[124:127], v[72:75], v[14:17]
    s_cbranch_vccnz Lre_8
Lck_8:
    s_setprio 0
    v_mfma_f32_16x16x32_bf16 v[108:111], a[0:3], v[76:79], v[108:111]
    v_mfma_f32_16x16x32_bf16 v[112:115], a[4:7], v[76:79], v[112:115]
    v_mfma_f32_16x16x32_bf16 v[116:119], a[8:11], v[76:79], v[116:119]
    v_mfma_f32_16x16x32_bf16 v[14:17], a[12:15], v[76:79], v[14:17]
    v_mfma_f32_16x16x32_bf16 v[108:111], a[16:19], v[80:83], v[108:111]
    s_waitcnt vmcnt(0)
    v_max3_u32 v18, v84, v85, v86
    v_mfma_f32_16x16x32_bf16 v[112:115], a[20:23], v[80:83], v[112:115]
    v_max3_u32 v19, v88, v89, v90
    v_max3_u32 v18, v18, v87, v91
    v_mfma_f32_16x16x32_bf16 v[116:119], a[24:27], v[80:83], v[116:119]
    v_max_u32 v18, v18, v19
    v_cmp_eq_u32 vcc, -1, v18
    v_mfma_f32_16x16x32_bf16 v[14:17], a[28:31], v[80:83], v[14:17]
    s_cbranch_vccnz Lre_9
Lck_9:
    s_waitcnt lgkmcnt(8)
    v_mfma_f32_16x16x32_bf16 v[108:111], a[32:35], v[84:87], v[108:111]
    v_mfma_f32_16x16x32_bf16 v[112:115], a[36:39], v[84:87], v[112:115]
    v_mfma_f32_16x16x32_bf16 v[116:119], a[40:43], v[84:87], v[116:119]
    v_mfma_f32_16x16x32_bf16 v[14:17], a[44:47], v[84:87], v[14:17]
    s_waitcnt lgkmcnt(0)
    v_mfma_f32_16x16x32_bf16 v[108:111], a[48:51], v[88:91], v[108:111]
    v_mfma_f32_16x16x32_bf16 v[112:115], a[52:55], v[88:91], v[112:115]
    v_mfma_f32_16x16x32_bf16 v[116:119], a[56:59], v[88:91], v[116:119]
    v_mfma_f32_16x16x32_bf16 v[14:17], a[60:63], v[88:91], v[14:17]
    v_xor_b32 v60, 32, v124
    v_xor_b32 v61, 64, v124
    v_xor_b32 v62, 96, v124
    v_cmp_eq_u32 s[36:37], v8, v126
    v_cmp_eq_u32 s[38:39], v9, v126
    s_nop 0
    s_or_b64 vcc, s[36:37], s[38:39]
    s_cbranch_scc1 Lfix
Lnofix:
    v_fma_f32 v108, v108, v44, v28
    v_fma_f32 v109, v109, v45, v29
    v_fma_f32 v110, v110, v46, v30
    v_fma_f32 v111, v111, v47, v31
    v_cvt_pk_bf16_f32 v68, v108, v109
    v_cvt_pk_bf16_f32 v69, v110, v111
    ds_write_b64 v124, v[68:69]
    v_fma_f32 v112, v112, v48, v32
    v_fma_f32 v113, v113, v49, v33
    v_fma_f32 v114, v114, v50, v34
    v_fma_f32 v115, v115, v51, v35
    v_cvt_pk_bf16_f32 v70, v112, v113
    v_cvt_pk_bf16_f32 v71, v114, v115
    ds_write_b64 v60, v[70:71]
    v_fma_f32 v116, v116, v52, v36
    v_fma_f32 v117, v117, v53, v37
    v_fma_f32 v118, v118, v54, v38
    v_fma_f32 v119, v119, v55, v39
    v_cvt_pk_bf16_f32 v72, v116, v117
    v_cvt_pk_bf16_f32 v73, v118, v119
    ds_write_b64 v61, v[72:73]
    v_fma_f32 v14, v14, v56, v40
    v_fma_f32 v15, v15, v57, v41
    v_fma_f32 v16, v16, v58, v42
    v_fma_f32 v17, v17, v59, v43
    v_cvt_pk_bf16_f32 v74, v14, v15
    v_cvt_pk_bf16_f32 v75, v16, v17
    ds_write_b64 v62, v[74:75]
    ds_read_b128 v[76:79], v125 offset:0
    ds_read_b128 v[80:83], v125 offset:1024
    s_waitcnt lgkmcnt(1)
    buffer_store_dwordx4 v[76:79], v122, s[48:51], s24 offen sc0 sc1
    s_waitcnt lgkmcnt(0)
    buffer_store_dwordx4 v[80:83], v123, s[48:51], s24 offen sc0 sc1
    s_endpgm
Lh1:
    ds_write_b128 v125, v[44:47] offset:0
    ds_write_b128 v125, v[48:51] offset:1024
    v_mov_b32 v5, 157972
    v_mov_b32 v6, 1
    s_mov_b64 exec, 1
    ds_add_u32 v5, v6
    s_mov_b64 exec, -1
    v_fmac_f32 v28, v76, v120
    v_fmac_f32 v29, v77, v120
    v_fmac_f32 v30, v78, v120
    v_fmac_f32 v31, v79, v120
    v_cvt_pk_bf16_f32 v28, v28, v29
    v_cvt_pk_bf16_f32 v29, v30, v31
    v_fmac_f32 v32, v80, v120
    v_fmac_f32 v33, v81, v120
    v_fmac_f32 v34, v82, v120
    v_fmac_f32 v35, v83, v120
    v_cvt_pk_bf16_f32 v30, v32, v33
    v_cvt_pk_bf16_f32 v31, v34, v35
    v_fmac_f32 v36, v84, v120
    v_fmac_f32 v37, v85, v120
    v_fmac_f32 v38, v86, v120
    v_fmac_f32 v39, v87, v120
    v_cvt_pk_bf16_f32 v32, v36, v37
    v_cvt_pk_bf16_f32 v33, v38, v39
    v_fmac_f32 v40, v88, v120
    v_fmac_f32 v41, v89, v120
    v_fmac_f32 v42, v90, v120
    v_fmac_f32 v43, v91, v120
    v_cvt_pk_bf16_f32 v34, v40, v41
    v_cvt_pk_bf16_f32 v35, v42, v43
    v_subrev_u32 v4, 6144, v125
    v_mov_b32 v8, s22
    v_mov_b32 v9, s22
    v_mov_b32 v10, s22
    v_mov_b32 v11, s22
Lcw_2:
    s_sub_u32 s35, s35, 1
    s_cbranch_scc1 Lend
    ds_read_b32 v6, v5
    s_waitcnt lgkmcnt(0)
    v_readfirstlane_b32 s38, v6
    s_nop 0
    s_cmp_lt_u32 s38, 8
    s_cbranch_scc1 Lcw_2
    ds_read_b128 v[52:55], v125 offset:2048
    ds_read_b128 v[56:59], v125 offset:3072
    ds_read_b128 v[44:47], v4 offset:4096
    ds_read_b128 v[48:51], v4 offset:5120
    s_branch Lh_join
Lqf_re:
    s_sub_u32 s35, s35, 1
    s_cbranch_scc1 Lend
    ds_read_b32 v7, v96
    ds_read_b128 v[76:79], v95 offset:0
    ds_read_b128 v[80:83], v95 offset:64
    ds_read_b128 v[84:87], v95 offset:128
    ds_read_b128 v[88:91], v95 offset:192
    s_waitcnt lgkmcnt(0)
    s_branch Lqf
Lcsv_re:
    s_sub_u32 s35, s35, 1
    s_cbranch_scc1 Lend
    ds_read_b32 v46, v49
    ds_read_b64 v[44:45], v48
    s_waitcnt lgkmcnt(0)
    s_branch Lcsv
Lrx_re:
    s_sub_u32 s35, s35, 1
    s_cbranch_scc1 Lend
    buffer_load_dwordx2 v[52:53], v13, s[28:31], s59 offen offset:8 sc1
    buffer_load_dwordx2 v[54:55], v13, s[28:31], s60 offen offset:0 sc1
    s_waitcnt vmcnt(0)
    s_branch Lrx_chk
Linfo_re:
    s_sub_u32 s35, s35, 1
    s_cbranch_scc1 Lend
    ds_read_b64 v[8:9], v10
    s_waitcnt lgkmcnt(0)
    s_branch Linfo
Lfl_re:
    s_sub_u32 s35, s35, 1
    s_cbranch_scc1 Lend
    buffer_load_dword v20, v12, s[28:31], s24 offen sc1
    s_waitcnt vmcnt(0)
    s_branch Lfl_chk
Lxe0:
    ds_read_b64 v[108:109], v4
    ds_read_b64 v[110:111], v5
    ds_read_b64 v[112:113], v6
    ds_read_b64 v[114:115], v7
    s_branch Lxe0_b
Lxe1:
    ds_read_b64 v[108:109], v4
    ds_read_b64 v[110:111], v5
    ds_read_b64 v[112:113], v6
    ds_read_b64 v[114:115], v7
    s_branch Lxe1_b
Lxe2:
    ds_read_b64 v[108:109], v4
    ds_read_b64 v[110:111], v5
    ds_read_b64 v[112:113], v6
    ds_read_b64 v[114:115], v7
    s_branch Lxe2_b
Lxe3:
    ds_read_b64 v[108:109], v4
    ds_read_b64 v[110:111], v5
    ds_read_b64 v[112:113], v6
    ds_read_b64 v[114:115], v7
    s_branch Lxe3_b
Lxe4:
    ds_read_b64 v[108:109], v4
    ds_read_b64 v[110:111], v5
    ds_read_b64 v[112:113], v6
    ds_read_b64 v[114:115], v7
    s_branch Lxe4_b
Lxe5:
    ds_read_b64 v[108:109], v4
    ds_read_b64 v[110:111], v5
    ds_read_b64 v[112:113], v6
    ds_read_b64 v[114:115], v7
    s_branch Lxe5_b
Lxe6:
    ds_read_b64 v[108:109], v4
    ds_read_b64 v[110:111], v5
    ds_read_b64 v[112:113], v6
    ds_read_b64 v[114:115], v7
    s_branch Lxe6_b
Lxe7:
    ds_read_b64 v[108:109], v4
    ds_read_b64 v[110:111], v5
    ds_read_b64 v[112:113], v6
    ds_read_b64 v[114:115], v7
    s_branch Lxe7_b
Lxe8:
    ds_read_b64 v[108:109], v4
    ds_read_b64 v[110:111], v5
    ds_read_b64 v[112:113], v6
    ds_read_b64 v[114:115], v7
    s_branch Lxe8_b
Lxe9:
    ds_read_b64 v[108:109], v4
    ds_read_b64 v[110:111], v5
    ds_read_b64 v[112:113], v6
    ds_read_b64 v[114:115], v7
    s_branch Lxe9_b
Lre_0:
    s_mov_b32 s41, 1
    s_sub_u32 s35, s35, 1
    s_cbranch_scc1 Lend
    s_sleep 2
    buffer_load_dwordx4 v[60:63], v13, s[28:31], s53 offen offset:0 sc1
    buffer_load_dwordx4 v[64:67], v13, s[28:31], s53 offen offset:2048 sc1
    s_waitcnt vmcnt(0)
    v_max3_u32 v18, v60, v61, v62
    v_max3_u32 v19, v64, v65, v66
    v_max3_u32 v18, v18, v63, v67
    v_max_u32 v18, v18, v19
    v_cmp_eq_u32 vcc, -1, v18
    s_nop 0
    s_cbranch_vccnz Lre_0
    buffer_load_dwordx4 v[68:71], v13, s[28:31], s54 offen offset:0 sc1
    buffer_load_dwordx4 v[72:75], v13, s[28:31], s54 offen offset:2048 sc1
    buffer_load_dwordx4 v[76:79], v13, s[28:31], s55 offen offset:0 sc1
    buffer_load_dwordx4 v[80:83], v13, s[28:31], s55 offen offset:2048 sc1
    buffer_load_dwordx4 v[84:87], v13, s[28:31], s56 offen offset:0 sc1
    buffer_load_dwordx4 v[88:91], v13, s[28:31], s56 offen offset:2048 sc1
    s_branch Lck_0
Lre_1:
    s_mov_b32 s41, 1
    s_sub_u32 s35, s35, 1
    s_cbranch_scc1 Lend
    s_sleep 2
    buffer_load_dwordx4 v[68:71], v13, s[28:31], s54 offen offset:0 sc1
    buffer_load_dwordx4 v[72:75], v13, s[28:31], s54 offen offset:2048 sc1
    s_waitcnt vmcnt(0)
    v_max3_u32 v18, v68, v69, v70
    v_max3_u32 v19, v72, v73, v74
    v_max3_u32 v18, v18, v71, v75
    v_max_u32 v18, v18, v19
    v_cmp_eq_u32 vcc, -1, v18
    s_nop 0
    s_cbranch_vccnz Lre_1
    buffer_load_dwordx4 v[76:79], v13, s[28:31], s55 offen offset:0 sc1
    buffer_load_dwordx4 v[80:83], v13, s[28:31], s55 offen offset:2048 sc1
    buffer_load_dwordx4 v[84:87], v13, s[28:31], s56 offen offset:0 sc1
    buffer_load_dwordx4 v[88:91], v13, s[28:31], s56 offen offset:2048 sc1
    buffer_load_dwordx4 v[92:95], v13, s[28:31], s57 offen offset:0 sc1
    buffer_load_dwordx4 v[96:99], v13, s[28:31], s57 offen offset:2048 sc1
    s_branch Lck_1
Lre_2:
    s_mov_b32 s41, 1
    s_sub_u32 s35, s35, 1
    s_cbranch_scc1 Lend
    s_sleep 2
    buffer_load_dwordx4 v[76:79], v13, s[28:31], s55 offen offset:0 sc1
    buffer_load_dwordx4 v[80:83], v13, s[28:31], s55 offen offset:2048 sc1
    s_waitcnt vmcnt(0)
    v_max3_u32 v18, v76, v77, v78
    v_max3_u32 v19, v80, v81, v82
    v_max3_u32 v18, v18, v79, v83
    v_max_u32 v18, v18, v19
    v_cmp_eq_u32 vcc, -1, v18
    s_nop 0
    s_cbranch_vccnz Lre_2
    buffer_load_dwordx4 v[84:87], v13, s[28:31], s56 offen offset:0 sc1
    buffer_load_dwordx4 v[88:91], v13, s[28:31], s56 offen offset:2048 sc1
    buffer_load_dwordx4 v[92:95], v13, s[28:31], s57 offen offset:0 sc1
    buffer_load_dwordx4 v[96:99], v13, s[28:31], s57 offen offset:2048 sc1
    buffer_load_dwordx4 v[100:103], v13, s[28:31], s53 offen offset:1024 sc1
    buffer_load_dwordx4 v[104:107], v13, s[28:31], s53 offen offset:3072 sc1
    s_branch Lck_2
Lre_3:
    s_mov_b32 s41, 1
    s_sub_u32 s35, s35, 1
    s_cbranch_scc1 Lend
    s_sleep 2
    buffer_load_dwordx4 v[84:87], v13, s[28:31], s56 offen offset:0 sc1
    buffer_load_dwordx4 v[88:91], v13, s[28:31], s56 offen offset:2048 sc1
    s_waitcnt vmcnt(0)
    v_max3_u32 v18, v84, v85, v86
    v_max3_u32 v19, v88, v89, v90
    v_max3_u32 v18, v18, v87, v91
    v_max_u32 v18, v18, v19
    v_cmp_eq_u32 vcc, -1, v18
    s_nop 0
    s_cbranch_vccnz Lre_3
    buffer_load_dwordx4 v[92:95], v13, s[28:31], s57 offen offset:0 sc1
    buffer_load_dwordx4 v[96:99], v13, s[28:31], s57 offen offset:2048 sc1
    buffer_load_dwordx4 v[100:103], v13, s[28:31], s53 offen offset:1024 sc1
    buffer_load_dwordx4 v[104:107], v13, s[28:31], s53 offen offset:3072 sc1
    buffer_load_dwordx4 v[60:63], v13, s[28:31], s54 offen offset:1024 sc1
    buffer_load_dwordx4 v[64:67], v13, s[28:31], s54 offen offset:3072 sc1
    s_branch Lck_3
Lre_4:
    s_mov_b32 s41, 1
    s_sub_u32 s35, s35, 1
    s_cbranch_scc1 Lend
    s_sleep 2
    buffer_load_dwordx4 v[92:95], v13, s[28:31], s57 offen offset:0 sc1
    buffer_load_dwordx4 v[96:99], v13, s[28:31], s57 offen offset:2048 sc1
    s_waitcnt vmcnt(0)
    v_max3_u32 v18, v92, v93, v94
    v_max3_u32 v19, v96, v97, v98
    v_max3_u32 v18, v18, v95, v99
    v_max_u32 v18, v18, v19
    v_cmp_eq_u32 vcc, -1, v18
    s_nop 0
    s_cbranch_vccnz Lre_4
    buffer_load_dwordx4 v[100:103], v13, s[28:31], s53 offen offset:1024 sc1
    buffer_load_dwordx4 v[104:107], v13, s[28:31], s53 offen offset:3072 sc1
    buffer_load_dwordx4 v[60:63], v13, s[28:31], s54 offen offset:1024 sc1
    buffer_load_dwordx4 v[64:67], v13, s[28:31], s54 offen offset:3072 sc1
    buffer_load_dwordx4 v[68:71], v13, s[28:31], s55 offen offset:1024 sc1
    buffer_load_dwordx4 v[72:75], v13, s[28:31], s55 offen offset:3072 sc1
    s_branch Lck_4
Lre_5:
    s_mov_b32 s41, 1
    s_sub_u32 s35, s35, 1
    s_cbranch_scc1 Lend
    s_sleep 2
    buffer_load_dwordx4 v[100:103], v13, s[28:31], s53 offen offset:1024 sc1
    buffer_load_dwordx4 v[104:107], v13, s[28:31], s53 offen offset:3072 sc1
    s_waitcnt vmcnt(0)
    v_max3_u32 v18, v100, v101, v102
    v_max3_u32 v19, v104, v105, v106
    v_max3_u32 v18, v18, v103, v107
    v_max_u32 v18, v18, v19
    v_cmp_eq_u32 vcc, -1, v18
    s_nop 0
    s_cbranch_vccnz Lre_5
    buffer_load_dwordx4 v[60:63], v13, s[28:31], s54 offen offset:1024 sc1
    buffer_load_dwordx4 v[64:67], v13, s[28:31], s54 offen offset:3072 sc1
    buffer_load_dwordx4 v[68:71], v13, s[28:31], s55 offen offset:1024 sc1
    buffer_load_dwordx4 v[72:75], v13, s[28:31], s55 offen offset:3072 sc1
    buffer_load_dwordx4 v[76:79], v13, s[28:31], s56 offen offset:1024 sc1
    buffer_load_dwordx4 v[80:83], v13, s[28:31], s56 offen offset:3072 sc1
    s_branch Lck_5
Lre_6:
    s_mov_b32 s41, 1
    s_sub_u32 s35, s35, 1
    s_cbranch_scc1 Lend
    s_sleep 2
    buffer_load_dwordx4 v[60:63], v13, s[28:31], s54 offen offset:1024 sc1
    buffer_load_dwordx4 v[64:67], v13, s[28:31], s54 offen offset:3072 sc1
    s_waitcnt vmcnt(0)
    v_max3_u32 v18, v60, v61, v62
    v_max3_u32 v19, v64, v65, v66
    v_max3_u32 v18, v18, v63, v67
    v_max_u32 v18, v18, v19
    v_cmp_eq_u32 vcc, -1, v18
    s_nop 0
    s_cbranch_vccnz Lre_6
    buffer_load_dwordx4 v[68:71], v13, s[28:31], s55 offen offset:1024 sc1
    buffer_load_dwordx4 v[72:75], v13, s[28:31], s55 offen offset:3072 sc1
    buffer_load_dwordx4 v[76:79], v13, s[28:31], s56 offen offset:1024 sc1
    buffer_load_dwordx4 v[80:83], v13, s[28:31], s56 offen offset:3072 sc1
    buffer_load_dwordx4 v[84:87], v13, s[28:31], s57 offen offset:1024 sc1
    buffer_load_dwordx4 v[88:91], v13, s[28:31], s57 offen offset:3072 sc1
    s_branch Lck_6
Lre_7:
    s_mov_b32 s41, 1
    s_sub_u32 s35, s35, 1
    s_cbranch_scc1 Lend
    s_sleep 2
    buffer_load_dwordx4 v[68:71], v13, s[28:31], s55 offen offset:1024 sc1
    buffer_load_dwordx4 v[72:75], v13, s[28:31], s55 offen offset:3072 sc1
    s_waitcnt vmcnt(0)
    v_max3_u32 v18, v68, v69, v70
    v_max3_u32 v19, v72, v73, v74
    v_max3_u32 v18, v18, v71, v75
    v_max_u32 v18, v18, v19
    v_cmp_eq_u32 vcc, -1, v18
    s_nop 0
    s_cbranch_vccnz Lre_7
    buffer_load_dwordx4 v[76:79], v13, s[28:31], s56 offen offset:1024 sc1
    buffer_load_dwordx4 v[80:83], v13, s[28:31], s56 offen offset:3072 sc1
    buffer_load_dwordx4 v[84:87], v13, s[28:31], s57 offen offset:1024 sc1
    buffer_load_dwordx4 v[88:91], v13, s[28:31], s57 offen offset:3072 sc1
    s_branch Lck_7
Lre_8:
    s_mov_b32 s41, 1
    s_sub_u32 s35, s35, 1
    s_cbranch_scc1 Lend
    s_sleep 2
    buffer_load_dwordx4 v[76:79], v13, s[28:31], s56 offen offset:1024 sc1
    buffer_load_dwordx4 v[80:83], v13, s[28:31], s56 offen offset:3072 sc1
    s_waitcnt vmcnt(0)
    v_max3_u32 v18, v76, v77, v78
    v_max3_u32 v19, v80, v81, v82
    v_max3_u32 v18, v18, v79, v83
    v_max_u32 v18, v18, v19
    v_cmp_eq_u32 vcc, -1, v18
    s_nop 0
    s_cbranch_vccnz Lre_8
    buffer_load_dwordx4 v[84:87], v13, s[28:31], s57 offen offset:1024 sc1
    buffer_load_dwordx4 v[88:91], v13, s[28:31], s57 offen offset:3072 sc1
    s_branch Lck_8
Lre_9:
    s_mov_b32 s41, 1
    s_sub_u32 s35, s35, 1
    s_cbranch_scc1 Lend
    s_sleep 2
    buffer_load_dwordx4 v[84:87], v13, s[28:31], s57 offen offset:1024 sc1
    buffer_load_dwordx4 v[88:91], v13, s[28:31], s57 offen offset:3072 sc1
    s_waitcnt vmcnt(0)
    v_max3_u32 v18, v84, v85, v86
    v_max3_u32 v19, v88, v89, v90
    v_max3_u32 v18, v18, v87, v91
    v_max_u32 v18, v18, v19
    v_cmp_eq_u32 vcc, -1, v18
    s_nop 0
    s_cbranch_vccnz Lre_9
    s_branch Lck_9
Lfix:
    s_mov_b64 vcc, s[38:39]
    v_lshlrev_b32 v6, 4, v2
    v_add_u32 v6, 158208, v6
    v_mov_b32 v10, 157956
Lcw_5:
    s_sub_u32 s35, s35, 1
    s_cbranch_scc1 Lend
    ds_read_b32 v11, v10
    s_waitcnt lgkmcnt(0)
    v_readfirstlane_b32 s38, v11
    s_nop 0
    s_cmp_lt_u32 s38, 1
    s_cbranch_scc1 Lcw_5
    s_mov_b64 exec, s[36:37]
    ds_read_b128 v[44:47], v6 offset:0
    ds_read_b128 v[48:51], v6 offset:64
    ds_read_b128 v[52:55], v6 offset:128
    ds_read_b128 v[56:59], v6 offset:192
    s_mov_b64 exec, vcc
    ds_read_b128 v[44:47], v6 offset:256
    ds_read_b128 v[48:51], v6 offset:320
    ds_read_b128 v[52:55], v6 offset:384
    ds_read_b128 v[56:59], v6 offset:448
    s_mov_b64 exec, -1
    s_waitcnt lgkmcnt(0)
    s_branch Lnofix
Lhalo:
    s_mov_b32 vcc_lo, 0x00010001
    s_mov_b32 vcc_hi, 0x00010001
    v_mov_b32 v11, 38912
    v_cndmask_b32 v76, v76, v11, vcc
    v_xor_b32 v77, 64, v76
    v_add_u32 v80, 78080, v76
    v_add_u32 v81, 78080, v77
    v_mov_b32 v14, 0x3f803f80
    v_mov_b32 v15, 0x3f803f80
    v_mov_b32 v16, 0x3f803f80
    v_mov_b32 v17, 0x3f803f80
    v_and_b32 v4, 7, v1
    v_lshlrev_b32 v4, 4, v4
    v_mul_u32_u24 v5, 39040, v2
    v_add_u32 v4, v4, v5
    ds_write_b128 v4, v[14:17] offset:38912
    v_mov_b32 v4, 157952
    v_mov_b32 v8, 0
    v_mov_b32 v9, 0
    v_mov_b32 v10, -2
    v_mov_b32 v11, -2
    ds_write_b128 v4, v[8:11]
    v_min_u32 v5, 23, v1
    v_lshl_add_u32 v5, v5, 2, v4
    ds_write_b32 v5, v8 offset:16
    s_mul_i32 s36, s32, 96
    s_sub_u32 s36, s36, 16
    v_add_u32 v96, s36, v1
    v_min_u32 v5, 47, v1
    v_add3_u32 v97, s36, v5, 64
    v_mov_b32 v6, 2047
    v_med3_i32 v96, v96, 0, v6
    v_med3_i32 v97, v97, 0, v6
    v_lshlrev_b32 v96, 3, v96
    v_lshlrev_b32 v97, 3, v97
    s_mov_b32 s46, 8192000
    v_mov_b32 v127, 157984
    s_lshl_b32 s36, s3, 2
    s_add_u32 s36, s36, 158016
    v_mov_b32 v10, s36
    s_mov_b32 vcc_lo, 0x00010001
    s_mov_b32 vcc_hi, 0x00010001
    v_cndmask_b32 v116, 0, v14, vcc
    v_cndmask_b32 v117, 0, v15, vcc
    v_cndmask_b32 v118, 0, v16, vcc
    v_cndmask_b32 v119, 0, v17, vcc
    s_waitcnt vmcnt(0)
    s_waitcnt lgkmcnt(0)
    s_barrier
    s_add_u32 s34, s34, 0x9e3779b8
    s_or_b32 s34, s34, 1
    ds_read_b128 v[108:111], v76 offset:0
    ds_read_b128 v[112:115], v77 offset:0
    ds_read_b64_tr_b16 a[0:1], v20 offset:0
    ds_read_b64_tr_b16 a[2:3], v20 offset:512
    ds_read_b64_tr_b16 a[4:5], v21 offset:0
    ds_read_b64_tr_b16 a[6:7], v21 offset:512
    ds_read_b64_tr_b16 a[8:9], v22 offset:0
    ds_read_b64_tr_b16 a[10:11], v22 offset:512
    ds_read_b64_tr_b16 a[12:13], v23 offset:0
    ds_read_b64_tr_b16 a[14:15], v23 offset:512
    ds_read_b64_tr_b16 a[16:17], v20 offset:8192
    ds_read_b64_tr_b16 a[18:19], v20 offset:8704
    ds_read_b64_tr_b16 a[20:21], v21 offset:8192
    ds_read_b64_tr_b16 a[22:23], v21 offset:8704
    ds_read_b64_tr_b16 a[24:25], v22 offset:8192
    ds_read_b64_tr_b16 a[26:27], v22 offset:8704
    s_waitcnt lgkmcnt(12)
    v_mfma_f32_16x16x32_bf16 v[28:31], a[0:3], v[116:119], 0
    ds_read_b64_tr_b16 a[28:29], v23 offset:8192
    ds_read_b64_tr_b16 a[30:31], v23 offset:8704
    s_waitcnt lgkmcnt(12)
    v_mfma_f32_16x16x32_bf16 v[32:35], a[4:7], v[116:119], 0
    ds_read_b64_tr_b16 a[32:33], v20 offset:16384
    ds_read_b64_tr_b16 a[34:35], v20 offset:16896
    s_waitcnt lgkmcnt(12)
    v_mfma_f32_16x16x32_bf16 v[36:39], a[8:11], v[116:119], 0
    ds_read_b64_tr_b16 a[36:37], v21 offset:16384
    ds_read_b64_tr_b16 a[38:39], v21 offset:16896
    s_waitcnt lgkmcnt(12)
    v_mfma_f32_16x16x32_bf16 v[40:43], a[12:15], v[116:119], 0
    ds_read_b64_tr_b16 a[40:41], v22 offset:16384
    ds_read_b64_tr_b16 a[42:43], v22 offset:16896
    s_waitcnt lgkmcnt(12)
    v_mfma_f32_16x16x32_bf16 v[44:47], a[16:19], v[108:111], 0
    ds_read_b64_tr_b16 a[44:45], v23 offset:16384
    ds_read_b64_tr_b16 a[46:47], v23 offset:16896
    s_waitcnt lgkmcnt(12)
    v_mfma_f32_16x16x32_bf16 v[48:51], a[20:23], v[108:111], 0
    ds_read_b64_tr_b16 a[48:49], v20 offset:4096
    ds_read_b64_tr_b16 a[50:51], v20 offset:4608
    s_waitcnt lgkmcnt(12)
    v_mfma_f32_16x16x32_bf16 v[52:55], a[24:27], v[108:111], 0
    ds_read_b64_tr_b16 a[52:53], v21 offset:4096
    ds_read_b64_tr_b16 a[54:55], v21 offset:4608
    s_waitcnt lgkmcnt(12)
    v_mfma_f32_16x16x32_bf16 v[56:59], a[28:31], v[108:111], 0
    ds_read_b64_tr_b16 a[56:57], v22 offset:4096
    ds_read_b64_tr_b16 a[58:59], v22 offset:4608
    s_waitcnt lgkmcnt(12)
    v_mfma_f32_16x16x32_bf16 v[60:63], v[108:111], a[32:35], 0
    ds_read_b64_tr_b16 a[60:61], v23 offset:4096
    ds_read_b64_tr_b16 a[62:63], v23 offset:4608
    s_waitcnt lgkmcnt(12)
    v_mfma_f32_16x16x32_bf16 v[64:67], v[108:111], a[36:39], 0
    ds_read_b64_tr_b16 a[64:65], v20 offset:12288
    ds_read_b64_tr_b16 a[66:67], v20 offset:12800
    s_waitcnt lgkmcnt(12)
    v_mfma_f32_16x16x32_bf16 v[68:71], v[108:111], a[40:43], 0
    ds_read_b64_tr_b16 a[68:69], v21 offset:12288
    ds_read_b64_tr_b16 a[70:71], v21 offset:12800
    s_waitcnt lgkmcnt(12)
    v_mfma_f32_16x16x32_bf16 v[72:75], v[108:111], a[44:47], 0
    ds_read_b64_tr_b16 a[72:73], v22 offset:12288
    ds_read_b64_tr_b16 a[74:75], v22 offset:12800
    s_waitcnt lgkmcnt(12)
    v_mfma_f32_16x16x32_bf16 v[28:31], a[48:51], v[116:119], v[28:31]
    ds_read_b64_tr_b16 a[76:77], v23 offset:12288
    ds_read_b64_tr_b16 a[78:79], v23 offset:12800
    s_waitcnt lgkmcnt(12)
    v_mfma_f32_16x16x32_bf16 v[32:35], a[52:55], v[116:119], v[32:35]
    ds_read_b64_tr_b16 a[80:81], v20 offset:20480
    ds_read_b64_tr_b16 a[82:83], v20 offset:20992
    s_waitcnt lgkmcnt(12)
    v_mfma_f32_16x16x32_bf16 v[36:39], a[56:59], v[116:119], v[36:39]
    ds_read_b64_tr_b16 a[84:85], v21 offset:20480
    ds_read_b64_tr_b16 a[86:87], v21 offset:20992
    s_waitcnt lgkmcnt(12)
    v_mfma_f32_16x16x32_bf16 v[40:43], a[60:63], v[116:119], v[40:43]
    ds_read_b64_tr_b16 a[88:89], v22 offset:20480
    ds_read_b64_tr_b16 a[90:91], v22 offset:20992
    s_waitcnt lgkmcnt(12)
    v_mfma_f32_16x16x32_bf16 v[44:47], a[64:67], v[112:115], v[44:47]
    ds_read_b64_tr_b16 a[92:93], v23 offset:20480
    ds_read_b64_tr_b16 a[94:95], v23 offset:20992
    s_waitcnt lgkmcnt(12)
    v_mfma_f32_16x16x32_bf16 v[48:51], a[68:71], v[112:115], v[48:51]
    s_waitcnt lgkmcnt(10)
    v_mfma_f32_16x16x32_bf16 v[52:55], a[72:75], v[112:115], v[52:55]
    s_waitcnt lgkmcnt(8)
    v_mfma_f32_16x16x32_bf16 v[56:59], a[76:79], v[112:115], v[56:59]
    s_waitcnt lgkmcnt(6)
    v_mfma_f32_16x16x32_bf16 v[60:63], v[112:115], a[80:83], v[60:63]
    s_waitcnt lgkmcnt(4)
    v_mfma_f32_16x16x32_bf16 v[64:67], v[112:115], a[84:87], v[64:67]
    s_waitcnt lgkmcnt(2)
    v_mfma_f32_16x16x32_bf16 v[68:71], v[112:115], a[88:91], v[68:71]
    s_waitcnt lgkmcnt(0)
    v_mfma_f32_16x16x32_bf16 v[72:75], v[112:115], a[92:95], v[72:75]
    s_barrier
    ds_read_b128 v[108:111], v76 offset:39040
    ds_read_b128 v[112:115], v77 offset:39040
    ds_read_b64_tr_b16 a[0:1], v20 offset:39040
    ds_read_b64_tr_b16 a[2:3], v20 offset:39552
    ds_read_b64_tr_b16 a[4:5], v21 offset:39040
    ds_read_b64_tr_b16 a[6:7], v21 offset:39552
    ds_read_b64_tr_b16 a[8:9], v22 offset:39040
    ds_read_b64_tr_b16 a[10:11], v22 offset:39552
    ds_read_b64_tr_b16 a[12:13], v23 offset:39040
    ds_read_b64_tr_b16 a[14:15], v23 offset:39552
    ds_read_b64_tr_b16 a[16:17], v20 offset:47232
    ds_read_b64_tr_b16 a[18:19], v20 offset:47744
    ds_read_b64_tr_b16 a[20:21], v21 offset:47232
    ds_read_b64_tr_b16 a[22:23], v21 offset:47744
    ds_read_b64_tr_b16 a[24:25], v22 offset:47232
    ds_read_b64_tr_b16 a[26:27], v22 offset:47744
    s_waitcnt lgkmcnt(12)
    v_mfma_f32_16x16x32_bf16 v[28:31], a[0:3], v[116:119], v[28:31]
    ds_read_b64_tr_b16 a[28:29], v23 offset:47232
    ds_read_b64_tr_b16 a[30:31], v23 offset:47744
    s_waitcnt lgkmcnt(12)
    v_mfma_f32_16x16x32_bf16 v[32:35], a[4:7], v[116:119], v[32:35]
    ds_read_b64_tr_b16 a[32:33], v20 offset:55424
    ds_read_b64_tr_b16 a[34:35], v20 offset:55936
    s_waitcnt lgkmcnt(12)
    v_mfma_f32_16x16x32_bf16 v[36:39], a[8:11], v[116:119], v[36:39]
    ds_read_b64_tr_b16 a[36:37], v21 offset:55424
    ds_read_b64_tr_b16 a[38:39], v21 offset:55936
    s_waitcnt lgkmcnt(12)
    v_mfma_f32_16x16x32_bf16 v[40:43], a[12:15], v[116:119], v[40:43]
    ds_read_b64_tr_b16 a[40:41], v22 offset:55424
    ds_read_b64_tr_b16 a[42:43], v22 offset:55936
    s_waitcnt lgkmcnt(12)
    v_mfma_f32_16x16x32_bf16 v[44:47], a[16:19], v[108:111], v[44:47]
    ds_read_b64_tr_b16 a[44:45], v23 offset:55424
    ds_read_b64_tr_b16 a[46:47], v23 offset:55936
    s_waitcnt lgkmcnt(12)
    v_mfma_f32_16x16x32_bf16 v[48:51], a[20:23], v[108:111], v[48:51]
    ds_read_b64_tr_b16 a[48:49], v20 offset:43136
    ds_read_b64_tr_b16 a[50:51], v20 offset:43648
    s_waitcnt lgkmcnt(12)
    v_mfma_f32_16x16x32_bf16 v[52:55], a[24:27], v[108:111], v[52:55]
    ds_read_b64_tr_b16 a[52:53], v21 offset:43136
    ds_read_b64_tr_b16 a[54:55], v21 offset:43648
    s_waitcnt lgkmcnt(12)
    v_mfma_f32_16x16x32_bf16 v[56:59], a[28:31], v[108:111], v[56:59]
    ds_read_b64_tr_b16 a[56:57], v22 offset:43136
    ds_read_b64_tr_b16 a[58:59], v22 offset:43648
    s_waitcnt lgkmcnt(12)
    v_mfma_f32_16x16x32_bf16 v[60:63], v[108:111], a[32:35], v[60:63]
    ds_read_b64_tr_b16 a[60:61], v23 offset:43136
    ds_read_b64_tr_b16 a[62:63], v23 offset:43648
    s_waitcnt lgkmcnt(12)
    v_mfma_f32_16x16x32_bf16 v[64:67], v[108:111], a[36:39], v[64:67]
    ds_read_b64_tr_b16 a[64:65], v20 offset:51328
    ds_read_b64_tr_b16 a[66:67], v20 offset:51840
    s_waitcnt lgkmcnt(12)
    v_mfma_f32_16x16x32_bf16 v[68:71], v[108:111], a[40:43], v[68:71]
    ds_read_b64_tr_b16 a[68:69], v21 offset:51328
    ds_read_b64_tr_b16 a[70:71], v21 offset:51840
    s_waitcnt lgkmcnt(12)
    v_mfma_f32_16x16x32_bf16 v[72:75], v[108:111], a[44:47], v[72:75]
    ds_read_b64_tr_b16 a[72:73], v22 offset:51328
    ds_read_b64_tr_b16 a[74:75], v22 offset:51840
    s_waitcnt lgkmcnt(12)
    v_mfma_f32_16x16x32_bf16 v[28:31], a[48:51], v[116:119], v[28:31]
    ds_read_b64_tr_b16 a[76:77], v23 offset:51328
    ds_read_b64_tr_b16 a[78:79], v23 offset:51840
    s_waitcnt lgkmcnt(12)
    v_mfma_f32_16x16x32_bf16 v[32:35], a[52:55], v[116:119], v[32:35]
    ds_read_b64_tr_b16 a[80:81], v20 offset:59520
    ds_read_b64_tr_b16 a[82:83], v20 offset:60032
    s_waitcnt lgkmcnt(12)
    v_mfma_f32_16x16x32_bf16 v[36:39], a[56:59], v[116:119], v[36:39]
    ds_read_b64_tr_b16 a[84:85], v21 offset:59520
    ds_read_b64_tr_b16 a[86:87], v21 offset:60032
    s_waitcnt lgkmcnt(12)
    v_mfma_f32_16x16x32_bf16 v[40:43], a[60:63], v[116:119], v[40:43]
    ds_read_b64_tr_b16 a[88:89], v22 offset:59520
    ds_read_b64_tr_b16 a[90:91], v22 offset:60032
    s_waitcnt lgkmcnt(12)
    v_mfma_f32_16x16x32_bf16 v[44:47], a[64:67], v[112:115], v[44:47]
    ds_read_b64_tr_b16 a[92:93], v23 offset:59520
    ds_read_b64_tr_b16 a[94:95], v23 offset:60032
    s_waitcnt lgkmcnt(12)
    v_mfma_f32_16x16x32_bf16 v[48:51], a[68:71], v[112:115], v[48:51]
    s_waitcnt lgkmcnt(10)
    v_mfma_f32_16x16x32_bf16 v[52:55], a[72:75], v[112:115], v[52:55]
    s_waitcnt lgkmcnt(8)
    v_mfma_f32_16x16x32_bf16 v[56:59], a[76:79], v[112:115], v[56:59]
    s_waitcnt lgkmcnt(6)
    v_mfma_f32_16x16x32_bf16 v[60:63], v[112:115], a[80:83], v[60:63]
    s_waitcnt lgkmcnt(4)
    v_mfma_f32_16x16x32_bf16 v[64:67], v[112:115], a[84:87], v[64:67]
    s_waitcnt lgkmcnt(2)
    v_mfma_f32_16x16x32_bf16 v[68:71], v[112:115], a[88:91], v[68:71]
    s_waitcnt lgkmcnt(0)
    v_mfma_f32_16x16x32_bf16 v[72:75], v[112:115], a[92:95], v[72:75]
    s_mov_b64 exec, 1
    s_lshl_b32 s36, s2, 2
    s_add_u32 s36, s36, 8323072
    v_mov_b32 v4, s34
    v_mov_b32 v5, s36
    buffer_store_dword v4, v5, s[28:31], 0 offen sc1
    s_mov_b64 exec, -1
    s_barrier
    ds_read_b128 v[108:111], v80 offset:0
    ds_read_b128 v[112:115], v81 offset:0
    ds_read_b64_tr_b16 a[0:1], v24 offset:0
    ds_read_b64_tr_b16 a[2:3], v24 offset:512
    ds_read_b64_tr_b16 a[4:5], v25 offset:0
    ds_read_b64_tr_b16 a[6:7], v25 offset:512
    ds_read_b64_tr_b16 a[8:9], v26 offset:0
    ds_read_b64_tr_b16 a[10:11], v26 offset:512
    ds_read_b64_tr_b16 a[12:13], v27 offset:0
    ds_read_b64_tr_b16 a[14:15], v27 offset:512
    ds_read_b64_tr_b16 a[16:17], v24 offset:8192
    ds_read_b64_tr_b16 a[18:19], v24 offset:8704
    ds_read_b64_tr_b16 a[20:21], v25 offset:8192
    ds_read_b64_tr_b16 a[22:23], v25 offset:8704
    ds_read_b64_tr_b16 a[24:25], v26 offset:8192
    ds_read_b64_tr_b16 a[26:27], v26 offset:8704
    s_waitcnt lgkmcnt(12)
    v_mfma_f32_16x16x32_bf16 v[28:31], a[0:3], v[116:119], v[28:31]
    ds_read_b64_tr_b16 a[28:29], v27 offset:8192
    ds_read_b64_tr_b16 a[30:31], v27 offset:8704
    s_waitcnt lgkmcnt(12)
    v_mfma_f32_16x16x32_bf16 v[32:35], a[4:7], v[116:119], v[32:35]
    ds_read_b64_tr_b16 a[32:33], v24 offset:16384
    ds_read_b64_tr_b16 a[34:35], v24 offset:16896
    s_waitcnt lgkmcnt(12)
    v_mfma_f32_16x16x32_bf16 v[36:39], a[8:11], v[116:119], v[36:39]
    ds_read_b64_tr_b16 a[36:37], v25 offset:16384
    ds_read_b64_tr_b16 a[38:39], v25 offset:16896
    s_waitcnt lgkmcnt(12)
    v_mfma_f32_16x16x32_bf16 v[40:43], a[12:15], v[116:119], v[40:43]
    ds_read_b64_tr_b16 a[40:41], v26 offset:16384
    ds_read_b64_tr_b16 a[42:43], v26 offset:16896
    s_waitcnt lgkmcnt(12)
    v_mfma_f32_16x16x32_bf16 v[44:47], a[16:19], v[108:111], v[44:47]
    ds_read_b64_tr_b16 a[44:45], v27 offset:16384
    ds_read_b64_tr_b16 a[46:47], v27 offset:16896
    s_waitcnt lgkmcnt(12)
    v_mfma_f32_16x16x32_bf16 v[48:51], a[20:23], v[108:111], v[48:51]
    ds_read_b64_tr_b16 a[48:49], v24 offset:4096
    ds_read_b64_tr_b16 a[50:51], v24 offset:4608
    s_waitcnt lgkmcnt(12)
    v_mfma_f32_16x16x32_bf16 v[52:55], a[24:27], v[108:111], v[52:55]
    ds_read_b64_tr_b16 a[52:53], v25 offset:4096
    ds_read_b64_tr_b16 a[54:55], v25 offset:4608
    s_waitcnt lgkmcnt(12)
    v_mfma_f32_16x16x32_bf16 v[56:59], a[28:31], v[108:111], v[56:59]
    ds_read_b64_tr_b16 a[56:57], v26 offset:4096
    ds_read_b64_tr_b16 a[58:59], v26 offset:4608
    s_waitcnt lgkmcnt(12)
    v_mfma_f32_16x16x32_bf16 v[60:63], v[108:111], a[32:35], v[60:63]
    ds_read_b64_tr_b16 a[60:61], v27 offset:4096
    ds_read_b64_tr_b16 a[62:63], v27 offset:4608
    s_waitcnt lgkmcnt(12)
    v_mfma_f32_16x16x32_bf16 v[64:67], v[108:111], a[36:39], v[64:67]
    ds_read_b64_tr_b16 a[64:65], v24 offset:12288
    ds_read_b64_tr_b16 a[66:67], v24 offset:12800
    s_waitcnt lgkmcnt(12)
    v_mfma_f32_16x16x32_bf16 v[68:71], v[108:111], a[40:43], v[68:71]
    ds_read_b64_tr_b16 a[68:69], v25 offset:12288
    ds_read_b64_tr_b16 a[70:71], v25 offset:12800
    s_waitcnt lgkmcnt(12)
    v_mfma_f32_16x16x32_bf16 v[72:75], v[108:111], a[44:47], v[72:75]
    ds_read_b64_tr_b16 a[72:73], v26 offset:12288
    ds_read_b64_tr_b16 a[74:75], v26 offset:12800
    s_waitcnt lgkmcnt(12)
    v_mfma_f32_16x16x32_bf16 v[28:31], a[48:51], v[116:119], v[28:31]
    ds_read_b64_tr_b16 a[76:77], v27 offset:12288
    ds_read_b64_tr_b16 a[78:79], v27 offset:12800
    s_waitcnt lgkmcnt(12)
    v_mfma_f32_16x16x32_bf16 v[32:35], a[52:55], v[116:119], v[32:35]
    ds_read_b64_tr_b16 a[80:81], v24 offset:20480
    ds_read_b64_tr_b16 a[82:83], v24 offset:20992
    s_waitcnt lgkmcnt(12)
    v_mfma_f32_16x16x32_bf16 v[36:39], a[56:59], v[116:119], v[36:39]
    ds_read_b64_tr_b16 a[84:85], v25 offset:20480
    ds_read_b64_tr_b16 a[86:87], v25 offset:20992
    s_waitcnt lgkmcnt(12)
    v_mfma_f32_16x16x32_bf16 v[40:43], a[60:63], v[116:119], v[40:43]
    ds_read_b64_tr_b16 a[88:89], v26 offset:20480
    ds_read_b64_tr_b16 a[90:91], v26 offset:20992
    s_waitcnt lgkmcnt(12)
    v_mfma_f32_16x16x32_bf16 v[44:47], a[64:67], v[112:115], v[44:47]
    ds_read_b64_tr_b16 a[92:93], v27 offset:20480
    ds_read_b64_tr_b16 a[94:95], v27 offset:20992
    s_waitcnt lgkmcnt(12)
    v_mfma_f32_16x16x32_bf16 v[48:51], a[68:71], v[112:115], v[48:51]
    s_waitcnt lgkmcnt(10)
    v_mfma_f32_16x16x32_bf16 v[52:55], a[72:75], v[112:115], v[52:55]
    s_waitcnt lgkmcnt(8)
    v_mfma_f32_16x16x32_bf16 v[56:59], a[76:79], v[112:115], v[56:59]
    s_waitcnt lgkmcnt(6)
    v_mfma_f32_16x16x32_bf16 v[60:63], v[112:115], a[80:83], v[60:63]
    s_waitcnt lgkmcnt(4)
    v_mfma_f32_16x16x32_bf16 v[64:67], v[112:115], a[84:87], v[64:67]
    s_waitcnt lgkmcnt(2)
    v_mfma_f32_16x16x32_bf16 v[68:71], v[112:115], a[88:91], v[68:71]
    s_waitcnt lgkmcnt(0)
    v_mfma_f32_16x16x32_bf16 v[72:75], v[112:115], a[92:95], v[72:75]
    s_barrier
    ds_read_b128 v[108:111], v80 offset:39040
    ds_read_b128 v[112:115], v81 offset:39040
    ds_read_b64_tr_b16 a[0:1], v24 offset:39040
    ds_read_b64_tr_b16 a[2:3], v24 offset:39552
    ds_read_b64_tr_b16 a[4:5], v25 offset:39040
    ds_read_b64_tr_b16 a[6:7], v25 offset:39552
    ds_read_b64_tr_b16 a[8:9], v26 offset:39040
    ds_read_b64_tr_b16 a[10:11], v26 offset:39552
    ds_read_b64_tr_b16 a[12:13], v27 offset:39040
    ds_read_b64_tr_b16 a[14:15], v27 offset:39552
    ds_read_b64_tr_b16 a[16:17], v24 offset:47232
    ds_read_b64_tr_b16 a[18:19], v24 offset:47744
    ds_read_b64_tr_b16 a[20:21], v25 offset:47232
    ds_read_b64_tr_b16 a[22:23], v25 offset:47744
    ds_read_b64_tr_b16 a[24:25], v26 offset:47232
    ds_read_b64_tr_b16 a[26:27], v26 offset:47744
    s_waitcnt lgkmcnt(12)
    v_mfma_f32_16x16x32_bf16 v[28:31], a[0:3], v[116:119], v[28:31]
    ds_read_b64_tr_b16 a[28:29], v27 offset:47232
    ds_read_b64_tr_b16 a[30:31], v27 offset:47744
    s_waitcnt lgkmcnt(12)
    v_mfma_f32_16x16x32_bf16 v[32:35], a[4:7], v[116:119], v[32:35]
    ds_read_b64_tr_b16 a[32:33], v24 offset:55424
    ds_read_b64_tr_b16 a[34:35], v24 offset:55936
    s_waitcnt lgkmcnt(12)
    v_mfma_f32_16x16x32_bf16 v[36:39], a[8:11], v[116:119], v[36:39]
    ds_read_b64_tr_b16 a[36:37], v25 offset:55424
    ds_read_b64_tr_b16 a[38:39], v25 offset:55936
    s_waitcnt lgkmcnt(12)
    v_mfma_f32_16x16x32_bf16 v[40:43], a[12:15], v[116:119], v[40:43]
    ds_read_b64_tr_b16 a[40:41], v26 offset:55424
    ds_read_b64_tr_b16 a[42:43], v26 offset:55936
    s_waitcnt lgkmcnt(12)
    v_mfma_f32_16x16x32_bf16 v[44:47], a[16:19], v[108:111], v[44:47]
    ds_read_b64_tr_b16 a[44:45], v27 offset:55424
    ds_read_b64_tr_b16 a[46:47], v27 offset:55936
    s_waitcnt lgkmcnt(12)
    v_mfma_f32_16x16x32_bf16 v[48:51], a[20:23], v[108:111], v[48:51]
    ds_read_b64_tr_b16 a[48:49], v24 offset:43136
    ds_read_b64_tr_b16 a[50:51], v24 offset:43648
    s_waitcnt lgkmcnt(12)
    v_mfma_f32_16x16x32_bf16 v[52:55], a[24:27], v[108:111], v[52:55]
    ds_read_b64_tr_b16 a[52:53], v25 offset:43136
    ds_read_b64_tr_b16 a[54:55], v25 offset:43648
    s_waitcnt lgkmcnt(12)
    v_mfma_f32_16x16x32_bf16 v[56:59], a[28:31], v[108:111], v[56:59]
    ds_read_b64_tr_b16 a[56:57], v26 offset:43136
    ds_read_b64_tr_b16 a[58:59], v26 offset:43648
    s_waitcnt lgkmcnt(12)
    v_mfma_f32_16x16x32_bf16 v[60:63], v[108:111], a[32:35], v[60:63]
    ds_read_b64_tr_b16 a[60:61], v27 offset:43136
    ds_read_b64_tr_b16 a[62:63], v27 offset:43648
    s_waitcnt lgkmcnt(12)
    v_mfma_f32_16x16x32_bf16 v[64:67], v[108:111], a[36:39], v[64:67]
    ds_read_b64_tr_b16 a[64:65], v24 offset:51328
    ds_read_b64_tr_b16 a[66:67], v24 offset:51840
    s_waitcnt lgkmcnt(12)
    v_mfma_f32_16x16x32_bf16 v[68:71], v[108:111], a[40:43], v[68:71]
    ds_read_b64_tr_b16 a[68:69], v25 offset:51328
    ds_read_b64_tr_b16 a[70:71], v25 offset:51840
    s_waitcnt lgkmcnt(12)
    v_mfma_f32_16x16x32_bf16 v[72:75], v[108:111], a[44:47], v[72:75]
    ds_read_b64_tr_b16 a[72:73], v26 offset:51328
    ds_read_b64_tr_b16 a[74:75], v26 offset:51840
    s_waitcnt lgkmcnt(12)
    v_mfma_f32_16x16x32_bf16 v[28:31], a[48:51], v[116:119], v[28:31]
    ds_read_b64_tr_b16 a[76:77], v27 offset:51328
    ds_read_b64_tr_b16 a[78:79], v27 offset:51840
    s_waitcnt lgkmcnt(12)
    v_mfma_f32_16x16x32_bf16 v[32:35], a[52:55], v[116:119], v[32:35]
    ds_read_b64_tr_b16 a[80:81], v24 offset:59520
    ds_read_b64_tr_b16 a[82:83], v24 offset:60032
    s_waitcnt lgkmcnt(12)
    v_mfma_f32_16x16x32_bf16 v[36:39], a[56:59], v[116:119], v[36:39]
    ds_read_b64_tr_b16 a[84:85], v25 offset:59520
    ds_read_b64_tr_b16 a[86:87], v25 offset:60032
    s_waitcnt lgkmcnt(12)
    v_mfma_f32_16x16x32_bf16 v[40:43], a[60:63], v[116:119], v[40:43]
    ds_read_b64_tr_b16 a[88:89], v26 offset:59520
    ds_read_b64_tr_b16 a[90:91], v26 offset:60032
    s_waitcnt lgkmcnt(12)
    v_mfma_f32_16x16x32_bf16 v[44:47], a[64:67], v[112:115], v[44:47]
    ds_read_b64_tr_b16 a[92:93], v27 offset:59520
    ds_read_b64_tr_b16 a[94:95], v27 offset:60032
    s_waitcnt lgkmcnt(12)
    v_mfma_f32_16x16x32_bf16 v[48:51], a[68:71], v[112:115], v[48:51]
    s_waitcnt lgkmcnt(10)
    v_mfma_f32_16x16x32_bf16 v[52:55], a[72:75], v[112:115], v[52:55]
    s_waitcnt lgkmcnt(8)
    v_mfma_f32_16x16x32_bf16 v[56:59], a[76:79], v[112:115], v[56:59]
    s_waitcnt lgkmcnt(6)
    v_mfma_f32_16x16x32_bf16 v[60:63], v[112:115], a[80:83], v[60:63]
    s_waitcnt lgkmcnt(4)
    v_mfma_f32_16x16x32_bf16 v[64:67], v[112:115], a[84:87], v[64:67]
    s_waitcnt lgkmcnt(2)
    v_mfma_f32_16x16x32_bf16 v[68:71], v[112:115], a[88:91], v[68:71]
    s_waitcnt lgkmcnt(0)
    v_mfma_f32_16x16x32_bf16 v[72:75], v[112:115], a[92:95], v[72:75]
    v_add_u32 v4, 156224, v12
    v_min_u32 v5, 47, v1
    v_lshlrev_b32 v5, 2, v5
    v_add_u32 v5, 156480, v5
    v_lshlrev_b32 v6, 4, v2
    v_add_u32 v6, 157184, v6
    v_mov_b32 v7, 157968
    v_lshlrev_b32 v11, 2, v3
    v_add_u32 v11, 156224, v11
    s_barrier
    ds_read_b128 v[108:111], v76 offset:0
    ds_read_b128 v[112:115], v77 offset:0
    ds_read_b64_tr_b16 a[0:1], v20 offset:0
    ds_read_b64_tr_b16 a[2:3], v20 offset:512
    ds_read_b64_tr_b16 a[4:5], v21 offset:0
    ds_read_b64_tr_b16 a[6:7], v21 offset:512
    ds_read_b64_tr_b16 a[8:9], v22 offset:0
    ds_read_b64_tr_b16 a[10:11], v22 offset:512
    ds_read_b64_tr_b16 a[12:13], v23 offset:0
    ds_read_b64_tr_b16 a[14:15], v23 offset:512
    ds_read_b64_tr_b16 a[16:17], v20 offset:8192
    ds_read_b64_tr_b16 a[18:19], v20 offset:8704
    ds_read_b64_tr_b16 a[20:21], v21 offset:8192
    ds_read_b64_tr_b16 a[22:23], v21 offset:8704
    ds_read_b64_tr_b16 a[24:25], v22 offset:8192
    ds_read_b64_tr_b16 a[26:27], v22 offset:8704
    s_waitcnt lgkmcnt(12)
    v_mfma_f32_16x16x32_bf16 v[28:31], a[0:3], v[116:119], v[28:31]
    ds_read_b64_tr_b16 a[28:29], v23 offset:8192
    ds_read_b64_tr_b16 a[30:31], v23 offset:8704
    s_waitcnt lgkmcnt(12)
    v_mfma_f32_16x16x32_bf16 v[32:35], a[4:7], v[116:119], v[32:35]
    ds_read_b64_tr_b16 a[32:33], v20 offset:16384
    ds_read_b64_tr_b16 a[34:35], v20 offset:16896
    s_waitcnt lgkmcnt(12)
    v_mfma_f32_16x16x32_bf16 v[36:39], a[8:11], v[116:119], v[36:39]
    ds_read_b64_tr_b16 a[36:37], v21 offset:16384
    ds_read_b64_tr_b16 a[38:39], v21 offset:16896
    s_waitcnt lgkmcnt(12)
    v_mfma_f32_16x16x32_bf16 v[40:43], a[12:15], v[116:119], v[40:43]
    ds_read_b64_tr_b16 a[40:41], v22 offset:16384
    ds_read_b64_tr_b16 a[42:43], v22 offset:16896
    s_waitcnt lgkmcnt(12)
    v_mfma_f32_16x16x32_bf16 v[44:47], a[16:19], v[108:111], v[44:47]
    ds_read_b64_tr_b16 a[44:45], v23 offset:16384
    ds_read_b64_tr_b16 a[46:47], v23 offset:16896
    s_waitcnt lgkmcnt(12)
    v_mfma_f32_16x16x32_bf16 v[48:51], a[20:23], v[108:111], v[48:51]
    ds_read_b64_tr_b16 a[48:49], v20 offset:4096
    ds_read_b64_tr_b16 a[50:51], v20 offset:4608
    s_waitcnt lgkmcnt(12)
    v_mfma_f32_16x16x32_bf16 v[52:55], a[24:27], v[108:111], v[52:55]
    ds_read_b64_tr_b16 a[52:53], v21 offset:4096
    ds_read_b64_tr_b16 a[54:55], v21 offset:4608
    s_waitcnt lgkmcnt(12)
    v_mfma_f32_16x16x32_bf16 v[56:59], a[28:31], v[108:111], v[56:59]
    ds_read_b64_tr_b16 a[56:57], v22 offset:4096
    ds_read_b64_tr_b16 a[58:59], v22 offset:4608
    s_waitcnt lgkmcnt(12)
    v_mfma_f32_16x16x32_bf16 v[60:63], v[108:111], a[32:35], v[60:63]
    ds_read_b64_tr_b16 a[60:61], v23 offset:4096
    ds_read_b64_tr_b16 a[62:63], v23 offset:4608
    s_waitcnt lgkmcnt(12)
    v_mfma_f32_16x16x32_bf16 v[64:67], v[108:111], a[36:39], v[64:67]
    ds_read_b64_tr_b16 a[64:65], v20 offset:12288
    ds_read_b64_tr_b16 a[66:67], v20 offset:12800
    s_waitcnt lgkmcnt(12)
    v_mfma_f32_16x16x32_bf16 v[68:71], v[108:111], a[40:43], v[68:71]
    ds_read_b64_tr_b16 a[68:69], v21 offset:12288
    ds_read_b64_tr_b16 a[70:71], v21 offset:12800
    s_waitcnt lgkmcnt(12)
    v_mfma_f32_16x16x32_bf16 v[72:75], v[108:111], a[44:47], v[72:75]
    ds_read_b64_tr_b16 a[72:73], v22 offset:12288
    ds_read_b64_tr_b16 a[74:75], v22 offset:12800
    s_waitcnt lgkmcnt(12)
    v_mfma_f32_16x16x32_bf16 v[28:31], a[48:51], v[116:119], v[28:31]
    ds_read_b64_tr_b16 a[76:77], v23 offset:12288
    ds_read_b64_tr_b16 a[78:79], v23 offset:12800
    s_waitcnt lgkmcnt(12)
    v_mfma_f32_16x16x32_bf16 v[32:35], a[52:55], v[116:119], v[32:35]
    ds_read_b64_tr_b16 a[80:81], v20 offset:20480
    ds_read_b64_tr_b16 a[82:83], v20 offset:20992
    s_waitcnt lgkmcnt(12)
    v_mfma_f32_16x16x32_bf16 v[36:39], a[56:59], v[116:119], v[36:39]
    ds_read_b64_tr_b16 a[84:85], v21 offset:20480
    ds_read_b64_tr_b16 a[86:87], v21 offset:20992
    s_waitcnt lgkmcnt(12)
    v_mfma_f32_16x16x32_bf16 v[40:43], a[60:63], v[116:119], v[40:43]
    ds_read_b64_tr_b16 a[88:89], v22 offset:20480
    ds_read_b64_tr_b16 a[90:91], v22 offset:20992
    s_waitcnt lgkmcnt(12)
    v_mfma_f32_16x16x32_bf16 v[44:47], a[64:67], v[112:115], v[44:47]
    ds_read_b64_tr_b16 a[92:93], v23 offset:20480
    ds_read_b64_tr_b16 a[94:95], v23 offset:20992
    s_waitcnt lgkmcnt(12)
    v_mfma_f32_16x16x32_bf16 v[48:51], a[68:71], v[112:115], v[48:51]
    s_waitcnt lgkmcnt(10)
    v_mfma_f32_16x16x32_bf16 v[52:55], a[72:75], v[112:115], v[52:55]
    s_waitcnt lgkmcnt(8)
    v_mfma_f32_16x16x32_bf16 v[56:59], a[76:79], v[112:115], v[56:59]
    s_waitcnt lgkmcnt(6)
    v_mfma_f32_16x16x32_bf16 v[60:63], v[112:115], a[80:83], v[60:63]
    s_waitcnt lgkmcnt(4)
    v_mfma_f32_16x16x32_bf16 v[64:67], v[112:115], a[84:87], v[64:67]
    s_waitcnt lgkmcnt(2)
    v_mfma_f32_16x16x32_bf16 v[68:71], v[112:115], a[88:91], v[68:71]
    s_waitcnt lgkmcnt(0)
    v_mfma_f32_16x16x32_bf16 v[72:75], v[112:115], a[92:95], v[72:75]
    s_barrier
    ds_read_b128 v[108:111], v76 offset:39040
    ds_read_b128 v[112:115], v77 offset:39040
    ds_read_b64_tr_b16 a[0:1], v20 offset:39040
    ds_read_b64_tr_b16 a[2:3], v20 offset:39552
    ds_read_b64_tr_b16 a[4:5], v21 offset:39040
    ds_read_b64_tr_b16 a[6:7], v21 offset:39552
    ds_read_b64_tr_b16 a[8:9], v22 offset:39040
    ds_read_b64_tr_b16 a[10:11], v22 offset:39552
    ds_read_b64_tr_b16 a[12:13], v23 offset:39040
    ds_read_b64_tr_b16 a[14:15], v23 offset:39552
    ds_read_b64_tr_b16 a[16:17], v20 offset:47232
    ds_read_b64_tr_b16 a[18:19], v20 offset:47744
    ds_read_b64_tr_b16 a[20:21], v21 offset:47232
    ds_read_b64_tr_b16 a[22:23], v21 offset:47744
    ds_read_b64_tr_b16 a[24:25], v22 offset:47232
    ds_read_b64_tr_b16 a[26:27], v22 offset:47744
    s_waitcnt lgkmcnt(12)
    v_mfma_f32_16x16x32_bf16 v[28:31], a[0:3], v[116:119], v[28:31]
    ds_read_b64_tr_b16 a[28:29], v23 offset:47232
    ds_read_b64_tr_b16 a[30:31], v23 offset:47744
    s_waitcnt lgkmcnt(12)
    v_mfma_f32_16x16x32_bf16 v[32:35], a[4:7], v[116:119], v[32:35]
    ds_read_b64_tr_b16 a[32:33], v20 offset:55424
    ds_read_b64_tr_b16 a[34:35], v20 offset:55936
    s_waitcnt lgkmcnt(12)
    v_mfma_f32_16x16x32_bf16 v[36:39], a[8:11], v[116:119], v[36:39]
    ds_read_b64_tr_b16 a[36:37], v21 offset:55424
    ds_read_b64_tr_b16 a[38:39], v21 offset:55936
    s_waitcnt lgkmcnt(12)
    v_mfma_f32_16x16x32_bf16 v[40:43], a[12:15], v[116:119], v[40:43]
    ds_read_b64_tr_b16 a[40:41], v22 offset:55424
    ds_read_b64_tr_b16 a[42:43], v22 offset:55936
    s_waitcnt lgkmcnt(12)
    v_mfma_f32_16x16x32_bf16 v[44:47], a[16:19], v[108:111], v[44:47]
    ds_read_b64_tr_b16 a[44:45], v23 offset:55424
    ds_read_b64_tr_b16 a[46:47], v23 offset:55936
    s_waitcnt lgkmcnt(12)
    v_mfma_f32_16x16x32_bf16 v[48:51], a[20:23], v[108:111], v[48:51]
    ds_read_b64_tr_b16 a[48:49], v20 offset:43136
    ds_read_b64_tr_b16 a[50:51], v20 offset:43648
    s_waitcnt lgkmcnt(12)
    v_mfma_f32_16x16x32_bf16 v[52:55], a[24:27], v[108:111], v[52:55]
    ds_read_b64_tr_b16 a[52:53], v21 offset:43136
    ds_read_b64_tr_b16 a[54:55], v21 offset:43648
    s_waitcnt lgkmcnt(12)
    v_mfma_f32_16x16x32_bf16 v[56:59], a[28:31], v[108:111], v[56:59]
    ds_read_b64_tr_b16 a[56:57], v22 offset:43136
    ds_read_b64_tr_b16 a[58:59], v22 offset:43648
    s_waitcnt lgkmcnt(12)
    v_mfma_f32_16x16x32_bf16 v[60:63], v[108:111], a[32:35], v[60:63]
    ds_read_b64_tr_b16 a[60:61], v23 offset:43136
    ds_read_b64_tr_b16 a[62:63], v23 offset:43648
    s_waitcnt lgkmcnt(12)
    v_mfma_f32_16x16x32_bf16 v[64:67], v[108:111], a[36:39], v[64:67]
    ds_read_b64_tr_b16 a[64:65], v20 offset:51328
    ds_read_b64_tr_b16 a[66:67], v20 offset:51840
    s_waitcnt lgkmcnt(12)
    v_mfma_f32_16x16x32_bf16 v[68:71], v[108:111], a[40:43], v[68:71]
    ds_read_b64_tr_b16 a[68:69], v21 offset:51328
    ds_read_b64_tr_b16 a[70:71], v21 offset:51840
    s_waitcnt lgkmcnt(12)
    v_mfma_f32_16x16x32_bf16 v[72:75], v[108:111], a[44:47], v[72:75]
    ds_read_b64_tr_b16 a[72:73], v22 offset:51328
    ds_read_b64_tr_b16 a[74:75], v22 offset:51840
    s_waitcnt lgkmcnt(12)
    v_mfma_f32_16x16x32_bf16 v[28:31], a[48:51], v[116:119], v[28:31]
    ds_read_b64_tr_b16 a[76:77], v23 offset:51328
    ds_read_b64_tr_b16 a[78:79], v23 offset:51840
    s_waitcnt lgkmcnt(12)
    v_mfma_f32_16x16x32_bf16 v[32:35], a[52:55], v[116:119], v[32:35]
    ds_read_b64_tr_b16 a[80:81], v20 offset:59520
    ds_read_b64_tr_b16 a[82:83], v20 offset:60032
    s_waitcnt lgkmcnt(12)
    v_mfma_f32_16x16x32_bf16 v[36:39], a[56:59], v[116:119], v[36:39]
    ds_read_b64_tr_b16 a[84:85], v21 offset:59520
    ds_read_b64_tr_b16 a[86:87], v21 offset:60032
    s_waitcnt lgkmcnt(12)
    v_mfma_f32_16x16x32_bf16 v[40:43], a[60:63], v[116:119], v[40:43]
    ds_read_b64_tr_b16 a[88:89], v22 offset:59520
    ds_read_b64_tr_b16 a[90:91], v22 offset:60032
    s_waitcnt lgkmcnt(12)
    v_mfma_f32_16x16x32_bf16 v[44:47], a[64:67], v[112:115], v[44:47]
    ds_read_b64_tr_b16 a[92:93], v23 offset:59520
    ds_read_b64_tr_b16 a[94:95], v23 offset:60032
    s_waitcnt lgkmcnt(12)
    v_mfma_f32_16x16x32_bf16 v[48:51], a[68:71], v[112:115], v[48:51]
    s_waitcnt lgkmcnt(10)
    v_mfma_f32_16x16x32_bf16 v[52:55], a[72:75], v[112:115], v[52:55]
    s_waitcnt lgkmcnt(8)
    v_mfma_f32_16x16x32_bf16 v[56:59], a[76:79], v[112:115], v[56:59]
    s_waitcnt lgkmcnt(6)
    v_mfma_f32_16x16x32_bf16 v[60:63], v[112:115], a[80:83], v[60:63]
    s_waitcnt lgkmcnt(4)
    v_mfma_f32_16x16x32_bf16 v[64:67], v[112:115], a[84:87], v[64:67]
    s_waitcnt lgkmcnt(2)
    v_mfma_f32_16x16x32_bf16 v[68:71], v[112:115], a[88:91], v[68:71]
    s_waitcnt lgkmcnt(0)
    v_mfma_f32_16x16x32_bf16 v[72:75], v[112:115], a[92:95], v[72:75]
    s_barrier
    ds_read_b128 a[96:99], v80 offset:0
    ds_read_b128 a[100:103], v81 offset:0
    ds_read_b64_tr_b16 a[0:1], v24 offset:0
    ds_read_b64_tr_b16 a[2:3], v24 offset:512
    ds_read_b64_tr_b16 a[4:5], v25 offset:0
    ds_read_b64_tr_b16 a[6:7], v25 offset:512
    ds_read_b64_tr_b16 a[8:9], v26 offset:0
    ds_read_b64_tr_b16 a[10:11], v26 offset:512
    ds_read_b64_tr_b16 a[12:13], v27 offset:0
    ds_read_b64_tr_b16 a[14:15], v27 offset:512
    ds_read_b64_tr_b16 a[16:17], v24 offset:8192
    ds_read_b64_tr_b16 a[18:19], v24 offset:8704
    ds_read_b64_tr_b16 a[20:21], v25 offset:8192
    ds_read_b64_tr_b16 a[22:23], v25 offset:8704
    ds_read_b64_tr_b16 a[24:25], v26 offset:8192
    ds_read_b64_tr_b16 a[26:27], v26 offset:8704
    s_waitcnt lgkmcnt(12)
    v_mfma_f32_16x16x32_bf16 v[28:31], a[0:3], v[116:119], v[28:31]
    ds_read_b64_tr_b16 a[28:29], v27 offset:8192
    ds_read_b64_tr_b16 a[30:31], v27 offset:8704
    s_waitcnt lgkmcnt(12)
    v_mfma_f32_16x16x32_bf16 v[32:35], a[4:7], v[116:119], v[32:35]
    ds_read_b64_tr_b16 a[48:49], v24 offset:4096
    ds_read_b64_tr_b16 a[50:51], v24 offset:4608
    s_waitcnt lgkmcnt(12)
    v_mfma_f32_16x16x32_bf16 v[36:39], a[8:11], v[116:119], v[36:39]
    ds_read_b64_tr_b16 a[52:53], v25 offset:4096
    ds_read_b64_tr_b16 a[54:55], v25 offset:4608
    s_waitcnt lgkmcnt(12)
    v_mfma_f32_16x16x32_bf16 v[40:43], a[12:15], v[116:119], v[40:43]
    ds_read_b64_tr_b16 a[56:57], v26 offset:4096
    ds_read_b64_tr_b16 a[58:59], v26 offset:4608
    s_waitcnt lgkmcnt(12)
    v_mfma_f32_16x16x32_bf16 v[44:47], a[16:19], a[96:99], v[44:47]
    ds_read_b64_tr_b16 a[60:61], v27 offset:4096
    ds_read_b64_tr_b16 a[62:63], v27 offset:4608
    s_waitcnt lgkmcnt(12)
    v_mfma_f32_16x16x32_bf16 v[48:51], a[20:23], a[96:99], v[48:51]
    ds_read_b64_tr_b16 a[64:65], v24 offset:12288
    ds_read_b64_tr_b16 a[66:67], v24 offset:12800
    s_waitcnt lgkmcnt(12)
    v_mfma_f32_16x16x32_bf16 v[52:55], a[24:27], a[96:99], v[52:55]
    ds_read_b64_tr_b16 a[68:69], v25 offset:12288
    ds_read_b64_tr_b16 a[70:71], v25 offset:12800
    s_waitcnt lgkmcnt(12)
    v_mfma_f32_16x16x32_bf16 v[56:59], a[28:31], a[96:99], v[56:59]
    ds_read_b64_tr_b16 a[72:73], v26 offset:12288
    ds_read_b64_tr_b16 a[74:75], v26 offset:12800
    s_waitcnt lgkmcnt(12)
    v_mfma_f32_16x16x32_bf16 v[28:31], a[48:51], v[116:119], v[28:31]
    ds_read_b64_tr_b16 a[76:77], v27 offset:12288
    ds_read_b64_tr_b16 a[78:79], v27 offset:12800
    s_waitcnt lgkmcnt(12)
    v_mfma_f32_16x16x32_bf16 v[32:35], a[52:55], v[116:119], v[32:35]
    s_waitcnt lgkmcnt(10)
    v_mfma_f32_16x16x32_bf16 v[36:39], a[56:59], v[116:119], v[36:39]
    s_waitcnt lgkmcnt(8)
    v_mfma_f32_16x16x32_bf16 v[40:43], a[60:63], v[116:119], v[40:43]
    s_waitcnt lgkmcnt(6)
    v_mfma_f32_16x16x32_bf16 v[44:47], a[64:67], a[100:103], v[44:47]
    s_waitcnt lgkmcnt(4)
    v_mfma_f32_16x16x32_bf16 v[48:51], a[68:71], a[100:103], v[48:51]
    s_waitcnt lgkmcnt(2)
    v_mfma_f32_16x16x32_bf16 v[52:55], a[72:75], a[100:103], v[52:55]
    s_waitcnt lgkmcnt(0)
    v_mfma_f32_16x16x32_bf16 v[56:59], a[76:79], a[100:103], v[56:59]
    s_barrier
    ds_read_b128 a[104:107], v80 offset:39040
    ds_read_b128 a[108:111], v81 offset:39040
    ds_read_b64_tr_b16 a[0:1], v24 offset:39040
    ds_read_b64_tr_b16 a[2:3], v24 offset:39552
    ds_read_b64_tr_b16 a[4:5], v25 offset:39040
    ds_read_b64_tr_b16 a[6:7], v25 offset:39552
    ds_read_b64_tr_b16 a[8:9], v26 offset:39040
    ds_read_b64_tr_b16 a[10:11], v26 offset:39552
    ds_read_b64_tr_b16 a[12:13], v27 offset:39040
    ds_read_b64_tr_b16 a[14:15], v27 offset:39552
    ds_read_b64_tr_b16 a[16:17], v24 offset:47232
    ds_read_b64_tr_b16 a[18:19], v24 offset:47744
    ds_read_b64_tr_b16 a[20:21], v25 offset:47232
    ds_read_b64_tr_b16 a[22:23], v25 offset:47744
    ds_read_b64_tr_b16 a[24:25], v26 offset:47232
    ds_read_b64_tr_b16 a[26:27], v26 offset:47744
    s_waitcnt lgkmcnt(12)
    v_mfma_f32_16x16x32_bf16 v[28:31], a[0:3], v[116:119], v[28:31]
    ds_read_b64_tr_b16 a[28:29], v27 offset:47232
    ds_read_b64_tr_b16 a[30:31], v27 offset:47744
    s_waitcnt lgkmcnt(12)
    v_mfma_f32_16x16x32_bf16 v[32:35], a[4:7], v[116:119], v[32:35]
    ds_read_b64_tr_b16 a[48:49], v24 offset:43136
    ds_read_b64_tr_b16 a[50:51], v24 offset:43648
    s_waitcnt lgkmcnt(12)
    v_mfma_f32_16x16x32_bf16 v[36:39], a[8:11], v[116:119], v[36:39]
    ds_read_b64_tr_b16 a[52:53], v25 offset:43136
    ds_read_b64_tr_b16 a[54:55], v25 offset:43648
    s_waitcnt lgkmcnt(12)
    v_mfma_f32_16x16x32_bf16 v[40:43], a[12:15], v[116:119], v[40:43]
    ds_read_b64_tr_b16 a[56:57], v26 offset:43136
    ds_read_b64_tr_b16 a[58:59], v26 offset:43648
    s_waitcnt lgkmcnt(12)
    v_mfma_f32_16x16x32_bf16 v[44:47], a[16:19], a[104:107], v[44:47]
    ds_read_b64_tr_b16 a[60:61], v27 offset:43136
    ds_read_b64_tr_b16 a[62:63], v27 offset:43648
    s_waitcnt lgkmcnt(12)
    v_mfma_f32_16x16x32_bf16 v[48:51], a[20:23], a[104:107], v[48:51]
    ds_read_b64_tr_b16 a[64:65], v24 offset:51328
    ds_read_b64_tr_b16 a[66:67], v24 offset:51840
    s_waitcnt lgkmcnt(12)
    v_mfma_f32_16x16x32_bf16 v[52:55], a[24:27], a[104:107], v[52:55]
    ds_read_b64_tr_b16 a[68:69], v25 offset:51328
    ds_read_b64_tr_b16 a[70:71], v25 offset:51840
    s_waitcnt lgkmcnt(12)
    v_mfma_f32_16x16x32_bf16 v[56:59], a[28:31], a[104:107], v[56:59]
    ds_read_b64_tr_b16 a[72:73], v26 offset:51328
    ds_read_b64_tr_b16 a[74:75], v26 offset:51840
    s_waitcnt lgkmcnt(12)
    v_mfma_f32_16x16x32_bf16 v[28:31], a[48:51], v[116:119], v[28:31]
    ds_read_b64_tr_b16 a[76:77], v27 offset:51328
    ds_read_b64_tr_b16 a[78:79], v27 offset:51840
    s_waitcnt lgkmcnt(12)
    v_mfma_f32_16x16x32_bf16 v[32:35], a[52:55], v[116:119], v[32:35]
    s_waitcnt lgkmcnt(10)
    v_mfma_f32_16x16x32_bf16 v[36:39], a[56:59], v[116:119], v[36:39]
    s_waitcnt lgkmcnt(8)
    v_mfma_f32_16x16x32_bf16 v[40:43], a[60:63], v[116:119], v[40:43]
    s_waitcnt lgkmcnt(6)
    v_mfma_f32_16x16x32_bf16 v[44:47], a[64:67], a[108:111], v[44:47]
    s_waitcnt lgkmcnt(4)
    v_mfma_f32_16x16x32_bf16 v[48:51], a[68:71], a[108:111], v[48:51]
    s_waitcnt lgkmcnt(2)
    v_mfma_f32_16x16x32_bf16 v[52:55], a[72:75], a[108:111], v[52:55]
    s_waitcnt lgkmcnt(0)
    v_mfma_f32_16x16x32_bf16 v[56:59], a[76:79], a[108:111], v[56:59]
    buffer_load_dwordx2 v[92:93], v96, s[28:31], s46 offen sc1
    buffer_load_dwordx2 v[94:95], v97, s[28:31], s46 offen sc1
    s_barrier
    ds_read_b128 a[112:115], v76 offset:0
    ds_read_b128 a[116:119], v77 offset:0
    ds_read_b64_tr_b16 a[0:1], v20 offset:0
    ds_read_b64_tr_b16 a[2:3], v20 offset:512
    ds_read_b64_tr_b16 a[4:5], v21 offset:0
    ds_read_b64_tr_b16 a[6:7], v21 offset:512
    ds_read_b64_tr_b16 a[8:9], v22 offset:0
    ds_read_b64_tr_b16 a[10:11], v22 offset:512
    ds_read_b64_tr_b16 a[12:13], v23 offset:0
    ds_read_b64_tr_b16 a[14:15], v23 offset:512
    ds_read_b64_tr_b16 a[16:17], v20 offset:8192
    ds_read_b64_tr_b16 a[18:19], v20 offset:8704
    ds_read_b64_tr_b16 a[20:21], v21 offset:8192
    ds_read_b64_tr_b16 a[22:23], v21 offset:8704
    ds_read_b64_tr_b16 a[24:25], v22 offset:8192
    ds_read_b64_tr_b16 a[26:27], v22 offset:8704
    s_waitcnt lgkmcnt(12)
    v_mfma_f32_16x16x32_bf16 v[28:31], a[0:3], v[116:119], v[28:31]
    ds_read_b64_tr_b16 a[28:29], v23 offset:8192
    ds_read_b64_tr_b16 a[30:31], v23 offset:8704
    s_waitcnt lgkmcnt(12)
    v_mfma_f32_16x16x32_bf16 v[32:35], a[4:7], v[116:119], v[32:35]
    ds_read_b64_tr_b16 a[48:49], v20 offset:4096
    ds_read_b64_tr_b16 a[50:51], v20 offset:4608
    s_waitcnt lgkmcnt(12)
    v_mfma_f32_16x16x32_bf16 v[36:39], a[8:11], v[116:119], v[36:39]
    ds_read_b64_tr_b16 a[52:53], v21 offset:4096
    ds_read_b64_tr_b16 a[54:55], v21 offset:4608
    s_waitcnt lgkmcnt(12)
    v_mfma_f32_16x16x32_bf16 v[40:43], a[12:15], v[116:119], v[40:43]
    ds_read_b64_tr_b16 a[56:57], v22 offset:4096
    ds_read_b64_tr_b16 a[58:59], v22 offset:4608
    s_waitcnt lgkmcnt(12)
    v_mfma_f32_16x16x32_bf16 v[44:47], a[16:19], a[112:115], v[44:47]
    ds_read_b64_tr_b16 a[60:61], v23 offset:4096
    ds_read_b64_tr_b16 a[62:63], v23 offset:4608
    s_waitcnt lgkmcnt(12)
    v_mfma_f32_16x16x32_bf16 v[48:51], a[20:23], a[112:115], v[48:51]
    ds_read_b64_tr_b16 a[64:65], v20 offset:12288
    ds_read_b64_tr_b16 a[66:67], v20 offset:12800
    s_waitcnt lgkmcnt(12)
    v_mfma_f32_16x16x32_bf16 v[52:55], a[24:27], a[112:115], v[52:55]
    ds_read_b64_tr_b16 a[68:69], v21 offset:12288
    ds_read_b64_tr_b16 a[70:71], v21 offset:12800
    s_waitcnt lgkmcnt(12)
    v_mfma_f32_16x16x32_bf16 v[56:59], a[28:31], a[112:115], v[56:59]
    ds_read_b64_tr_b16 a[72:73], v22 offset:12288
    ds_read_b64_tr_b16 a[74:75], v22 offset:12800
    s_waitcnt lgkmcnt(12)
    v_mfma_f32_16x16x32_bf16 v[28:31], a[48:51], v[116:119], v[28:31]
    ds_read_b64_tr_b16 a[76:77], v23 offset:12288
    ds_read_b64_tr_b16 a[78:79], v23 offset:12800
    s_waitcnt lgkmcnt(12)
    v_mfma_f32_16x16x32_bf16 v[32:35], a[52:55], v[116:119], v[32:35]
    s_waitcnt lgkmcnt(10)
    v_mfma_f32_16x16x32_bf16 v[36:39], a[56:59], v[116:119], v[36:39]
    s_waitcnt vmcnt(0)
Lst_chk:
    v_cmp_ne_u32 vcc, s34, v93
    v_cmp_ne_u32 s[36:37], s34, v95
    s_nop 0
    s_or_b64 s[36:37], s[36:37], vcc
    s_cbranch_scc1 Lst_re
    v_lshlrev_b32 v93, 16, v92
    s_waitcnt lgkmcnt(8)
    v_mfma_f32_16x16x32_bf16 v[40:43], a[60:63], v[116:119], v[40:43]
    v_and_b32 v92, 0xffff0000, v92
    v_rcp_f32 v93, v93
    s_waitcnt lgkmcnt(6)
    v_mfma_f32_16x16x32_bf16 v[44:47], a[64:67], a[116:119], v[44:47]
    v_lshlrev_b32 v95, 16, v94
    v_and_b32 v94, 0xffff0000, v94
    s_waitcnt lgkmcnt(4)
    v_mfma_f32_16x16x32_bf16 v[48:51], a[68:71], a[116:119], v[48:51]
    v_rcp_f32 v95, v95
    ds_write2st64_b32 v4, v92, v93 offset0:0 offset1:2
    s_waitcnt lgkmcnt(3)
    v_mfma_f32_16x16x32_bf16 v[52:55], a[72:75], a[116:119], v[52:55]
    ds_write2st64_b32 v5, v94, v95 offset0:0 offset1:2
    ds_read_b32 v120, v11
    s_waitcnt lgkmcnt(3)
    v_mfma_f32_16x16x32_bf16 v[56:59], a[76:79], a[116:119], v[56:59]
    s_waitcnt lgkmcnt(0)
    s_barrier
    ds_read_b128 a[120:123], v76 offset:39040
    ds_read_b128 a[124:127], v77 offset:39040
    ds_read_b64_tr_b16 a[0:1], v20 offset:39040
    ds_read_b64_tr_b16 a[2:3], v20 offset:39552
    ds_read_b64_tr_b16 a[4:5], v21 offset:39040
    ds_read_b64_tr_b16 a[6:7], v21 offset:39552
    ds_read_b64_tr_b16 a[8:9], v22 offset:39040
    ds_read_b64_tr_b16 a[10:11], v22 offset:39552
    ds_read_b64_tr_b16 a[12:13], v23 offset:39040
    ds_read_b64_tr_b16 a[14:15], v23 offset:39552
    ds_read_b64_tr_b16 a[16:17], v20 offset:47232
    ds_read_b64_tr_b16 a[18:19], v20 offset:47744
    ds_read_b64_tr_b16 a[20:21], v21 offset:47232
    ds_read_b64_tr_b16 a[22:23], v21 offset:47744
    ds_read_b64_tr_b16 a[24:25], v22 offset:47232
    ds_read_b64_tr_b16 a[26:27], v22 offset:47744
    s_waitcnt lgkmcnt(12)
    v_mfma_f32_16x16x32_bf16 v[28:31], a[0:3], v[116:119], v[28:31]
    ds_read_b64_tr_b16 a[28:29], v23 offset:47232
    ds_read_b64_tr_b16 a[30:31], v23 offset:47744
    s_waitcnt lgkmcnt(12)
    v_mfma_f32_16x16x32_bf16 v[32:35], a[4:7], v[116:119], v[32:35]
    ds_read_b64_tr_b16 a[48:49], v20 offset:43136
    ds_read_b64_tr_b16 a[50:51], v20 offset:43648
    s_waitcnt lgkmcnt(12)
    v_mfma_f32_16x16x32_bf16 v[36:39], a[8:11], v[116:119], v[36:39]
    ds_read_b64_tr_b16 a[52:53], v21 offset:43136
    ds_read_b64_tr_b16 a[54:55], v21 offset:43648
    s_waitcnt lgkmcnt(12)
    v_mfma_f32_16x16x32_bf16 v[40:43], a[12:15], v[116:119], v[40:43]
    ds_read_b64_tr_b16 a[56:57], v22 offset:43136
    ds_read_b64_tr_b16 a[58:59], v22 offset:43648
    s_waitcnt lgkmcnt(12)
    v_mfma_f32_16x16x32_bf16 v[44:47], a[16:19], a[120:123], v[44:47]
    ds_read_b64_tr_b16 a[60:61], v23 offset:43136
    ds_read_b64_tr_b16 a[62:63], v23 offset:43648
    s_waitcnt lgkmcnt(12)
    v_mfma_f32_16x16x32_bf16 v[48:51], a[20:23], a[120:123], v[48:51]
    ds_read_b64_tr_b16 a[64:65], v20 offset:51328
    ds_read_b64_tr_b16 a[66:67], v20 offset:51840
    s_waitcnt lgkmcnt(12)
    v_mfma_f32_16x16x32_bf16 v[52:55], a[24:27], a[120:123], v[52:55]
    ds_read_b64_tr_b16 a[68:69], v21 offset:51328
    ds_read_b64_tr_b16 a[70:71], v21 offset:51840
    s_waitcnt lgkmcnt(12)
    v_mfma_f32_16x16x32_bf16 v[56:59], a[28:31], a[120:123], v[56:59]
    ds_read_b64_tr_b16 a[72:73], v22 offset:51328
    ds_read_b64_tr_b16 a[74:75], v22 offset:51840
    s_waitcnt lgkmcnt(12)
    v_mfma_f32_16x16x32_bf16 v[28:31], a[48:51], v[116:119], v[28:31]
    ds_read_b64_tr_b16 a[76:77], v23 offset:51328
    ds_read_b64_tr_b16 a[78:79], v23 offset:51840
    s_waitcnt lgkmcnt(12)
    v_mfma_f32_16x16x32_bf16 v[32:35], a[52:55], v[116:119], v[32:35]
    s_waitcnt lgkmcnt(10)
    v_mfma_f32_16x16x32_bf16 v[36:39], a[56:59], v[116:119], v[36:39]
    s_waitcnt lgkmcnt(8)
    v_mfma_f32_16x16x32_bf16 v[40:43], a[60:63], v[116:119], v[40:43]
    s_waitcnt lgkmcnt(6)
    v_mfma_f32_16x16x32_bf16 v[44:47], a[64:67], a[124:127], v[44:47]
    s_waitcnt lgkmcnt(4)
    v_mfma_f32_16x16x32_bf16 v[48:51], a[68:71], a[124:127], v[48:51]
    s_waitcnt lgkmcnt(2)
    v_mfma_f32_16x16x32_bf16 v[52:55], a[72:75], a[124:127], v[52:55]
    s_waitcnt lgkmcnt(0)
    v_mfma_f32_16x16x32_bf16 v[56:59], a[76:79], a[124:127], v[56:59]
    s_mov_b32 exec_lo, 0x00010001
    s_mov_b32 exec_hi, 0x00010001
    ds_write_b128 v6, v[28:31] offset:0
    ds_write_b128 v6, v[32:35] offset:64
    ds_write_b128 v6, v[36:39] offset:128
    ds_write_b128 v6, v[40:43] offset:192
    ds_write_b128 v6, v[44:47] offset:256
    ds_write_b128 v6, v[48:51] offset:320
    ds_write_b128 v6, v[52:55] offset:384
    ds_write_b128 v6, v[56:59] offset:448
    ds_write_b32 v7, v7
    s_mov_b64 exec, -1
    ds_read_b128 v[76:79], v6 offset:256
    ds_read_b128 v[80:83], v6 offset:320
    ds_read_b128 v[84:87], v6 offset:384
    ds_read_b128 v[88:91], v6 offset:448
    s_waitcnt lgkmcnt(0)
    v_fmac_f32 v44, v76, v120
    v_fmac_f32 v45, v77, v120
    v_fmac_f32 v46, v78, v120
    v_fmac_f32 v47, v79, v120
    v_cvt_pk_bf16_f32 v44, v44, v45
    v_cvt_pk_bf16_f32 v45, v46, v47
    v_fmac_f32 v48, v80, v120
    v_fmac_f32 v49, v81, v120
    v_fmac_f32 v50, v82, v120
    v_fmac_f32 v51, v83, v120
    v_cvt_pk_bf16_f32 v46, v48, v49
    v_cvt_pk_bf16_f32 v47, v50, v51
    v_fmac_f32 v52, v84, v120
    v_fmac_f32 v53, v85, v120
    v_fmac_f32 v54, v86, v120
    v_fmac_f32 v55, v87, v120
    v_cvt_pk_bf16_f32 v48, v52, v53
    v_cvt_pk_bf16_f32 v49, v54, v55
    v_fmac_f32 v56, v88, v120
    v_fmac_f32 v57, v89, v120
    v_fmac_f32 v58, v90, v120
    v_fmac_f32 v59, v91, v120
    v_cvt_pk_bf16_f32 v50, v56, v57
    v_cvt_pk_bf16_f32 v51, v58, v59
    ds_write_b128 v125, v[44:47] offset:4096
    ds_write_b128 v125, v[48:51] offset:5120
    v_mov_b32 v5, 157972
    v_mov_b32 v6, 1
    s_mov_b64 exec, 1
    ds_add_u32 v5, v6
    s_mov_b64 exec, -1
    v_mov_b32 v5, 157980
Lcw_6:
    s_sub_u32 s35, s35, 1
    s_cbranch_scc1 Lend
    ds_read_b32 v6, v5
    s_waitcnt lgkmcnt(0)
    v_readfirstlane_b32 s38, v6
    s_nop 0
    s_cmp_lt_u32 s38, 1
    s_cbranch_scc1 Lcw_6
    ds_read_b64_tr_b16 a[0:1], v24 offset:16384
    ds_read_b64_tr_b16 a[2:3], v24 offset:16896
    ds_read_b64_tr_b16 a[4:5], v25 offset:16384
    ds_read_b64_tr_b16 a[6:7], v25 offset:16896
    ds_read_b64_tr_b16 a[8:9], v26 offset:16384
    ds_read_b64_tr_b16 a[10:11], v26 offset:16896
    ds_read_b64_tr_b16 a[12:13], v27 offset:16384
    ds_read_b64_tr_b16 a[14:15], v27 offset:16896
    ds_read_b64_tr_b16 a[16:17], v24 offset:20480
    ds_read_b64_tr_b16 a[18:19], v24 offset:20992
    ds_read_b64_tr_b16 a[20:21], v25 offset:20480
    ds_read_b64_tr_b16 a[22:23], v25 offset:20992
    ds_read_b64_tr_b16 a[24:25], v26 offset:20480
    ds_read_b64_tr_b16 a[26:27], v26 offset:20992
    ds_read_b64_tr_b16 a[28:29], v27 offset:20480
    ds_read_b64_tr_b16 a[30:31], v27 offset:20992
    ds_read_b64_tr_b16 a[32:33], v24 offset:55424
    ds_read_b64_tr_b16 a[34:35], v24 offset:55936
    ds_read_b64_tr_b16 a[36:37], v25 offset:55424
    ds_read_b64_tr_b16 a[38:39], v25 offset:55936
    ds_read_b64_tr_b16 a[40:41], v26 offset:55424
    ds_read_b64_tr_b16 a[42:43], v26 offset:55936
    ds_read_b64_tr_b16 a[44:45], v27 offset:55424
    ds_read_b64_tr_b16 a[46:47], v27 offset:55936
    ds_read_b64_tr_b16 a[48:49], v24 offset:59520
    ds_read_b64_tr_b16 a[50:51], v24 offset:60032
    ds_read_b64_tr_b16 a[52:53], v25 offset:59520
    ds_read_b64_tr_b16 a[54:55], v25 offset:60032
    ds_read_b64_tr_b16 a[56:57], v26 offset:59520
    ds_read_b64_tr_b16 a[58:59], v26 offset:60032
    ds_read_b64_tr_b16 a[60:61], v27 offset:59520
    ds_read_b64_tr_b16 a[62:63], v27 offset:60032
    ds_read_b64_tr_b16 a[64:65], v20 offset:16384
    ds_read_b64_tr_b16 a[66:67], v20 offset:16896
    ds_read_b64_tr_b16 a[68:69], v21 offset:16384
    ds_read_b64_tr_b16 a[70:71], v21 offset:16896
    ds_read_b64_tr_b16 a[72:73], v22 offset:16384
    ds_read_b64_tr_b16 a[74:75], v22 offset:16896
    ds_read_b64_tr_b16 a[76:77], v23 offset:16384
    ds_read_b64_tr_b16 a[78:79], v23 offset:16896
    ds_read_b64_tr_b16 a[80:81], v20 offset:20480
    ds_read_b64_tr_b16 a[82:83], v20 offset:20992
    ds_read_b64_tr_b16 a[84:85], v21 offset:20480
    ds_read_b64_tr_b16 a[86:87], v21 offset:20992
    ds_read_b64_tr_b16 a[88:89], v22 offset:20480
    ds_read_b64_tr_b16 a[90:91], v22 offset:20992
    ds_read_b64_tr_b16 a[92:93], v23 offset:20480
    ds_read_b64_tr_b16 a[94:95], v23 offset:20992
    s_waitcnt lgkmcnt(15)
    v_mfma_f32_16x16x32_bf16 v[60:63], a[96:99], a[0:3], v[60:63]
    v_mfma_f32_16x16x32_bf16 v[64:67], a[96:99], a[4:7], v[64:67]
    v_mfma_f32_16x16x32_bf16 v[68:71], a[96:99], a[8:11], v[68:71]
    v_mfma_f32_16x16x32_bf16 v[72:75], a[96:99], a[12:15], v[72:75]
    ds_read_b64_tr_b16 a[0:1], v20 offset:55424
    ds_read_b64_tr_b16 a[2:3], v20 offset:55936
    ds_read_b64_tr_b16 a[4:5], v21 offset:55424
    ds_read_b64_tr_b16 a[6:7], v21 offset:55936
    ds_read_b64_tr_b16 a[8:9], v22 offset:55424
    ds_read_b64_tr_b16 a[10:11], v22 offset:55936
    ds_read_b64_tr_b16 a[12:13], v23 offset:55424
    ds_read_b64_tr_b16 a[14:15], v23 offset:55936
    v_mfma_f32_16x16x32_bf16 v[60:63], a[100:103], a[16:19], v[60:63]
    v_mfma_f32_16x16x32_bf16 v[64:67], a[100:103], a[20:23], v[64:67]
    v_mfma_f32_16x16x32_bf16 v[68:71], a[100:103], a[24:27], v[68:71]
    v_mfma_f32_16x16x32_bf16 v[72:75], a[100:103], a[28:31], v[72:75]
    ds_read_b64_tr_b16 a[16:17], v20 offset:59520
    ds_read_b64_tr_b16 a[18:19], v20 offset:60032
    ds_read_b64_tr_b16 a[20:21], v21 offset:59520
    ds_read_b64_tr_b16 a[22:23], v21 offset:60032
    ds_read_b64_tr_b16 a[24:25], v22 offset:59520
    ds_read_b64_tr_b16 a[26:27], v22 offset:60032
    ds_read_b64_tr_b16 a[28:29], v23 offset:59520
    ds_read_b64_tr_b16 a[30:31], v23 offset:60032
    v_mfma_f32_16x16x32_bf16 v[60:63], a[104:107], a[32:35], v[60:63]
    v_mfma_f32_16x16x32_bf16 v[64:67], a[104:107], a[36:39], v[64:67]
    v_mfma_f32_16x16x32_bf16 v[68:71], a[104:107], a[40:43], v[68:71]
    v_mfma_f32_16x16x32_bf16 v[72:75], a[104:107], a[44:47], v[72:75]
    v_mfma_f32_16x16x32_bf16 v[60:63], a[108:111], a[48:51], v[60:63]
    v_mfma_f32_16x16x32_bf16 v[64:67], a[108:111], a[52:55], v[64:67]
    v_mfma_f32_16x16x32_bf16 v[68:71], a[108:111], a[56:59], v[68:71]
    v_mfma_f32_16x16x32_bf16 v[72:75], a[108:111], a[60:63], v[72:75]
    s_waitcnt lgkmcnt(15)
    v_mfma_f32_16x16x32_bf16 v[60:63], a[112:115], a[64:67], v[60:63]
    v_mfma_f32_16x16x32_bf16 v[64:67], a[112:115], a[68:71], v[64:67]
    v_mfma_f32_16x16x32_bf16 v[68:71], a[112:115], a[72:75], v[68:71]
    v_mfma_f32_16x16x32_bf16 v[72:75], a[112:115], a[76:79], v[72:75]
    v_mfma_f32_16x16x32_bf16 v[60:63], a[116:119], a[80:83], v[60:63]
    v_mfma_f32_16x16x32_bf16 v[64:67], a[116:119], a[84:87], v[64:67]
    v_mfma_f32_16x16x32_bf16 v[68:71], a[116:119], a[88:91], v[68:71]
    v_mfma_f32_16x16x32_bf16 v[72:75], a[116:119], a[92:95], v[72:75]
    s_waitcnt lgkmcnt(8)
    v_mfma_f32_16x16x32_bf16 v[60:63], a[120:123], a[0:3], v[60:63]
    v_mfma_f32_16x16x32_bf16 v[64:67], a[120:123], a[4:7], v[64:67]
    v_mfma_f32_16x16x32_bf16 v[68:71], a[120:123], a[8:11], v[68:71]
    v_mfma_f32_16x16x32_bf16 v[72:75], a[120:123], a[12:15], v[72:75]
    s_waitcnt lgkmcnt(0)
    v_mfma_f32_16x16x32_bf16 v[60:63], a[124:127], a[16:19], v[60:63]
    v_mfma_f32_16x16x32_bf16 v[64:67], a[124:127], a[20:23], v[64:67]
    v_mfma_f32_16x16x32_bf16 v[68:71], a[124:127], a[24:27], v[68:71]
    v_mfma_f32_16x16x32_bf16 v[72:75], a[124:127], a[28:31], v[72:75]
    v_lshlrev_b32 v5, 4, v3
    v_add_u32 v5, 157696, v5
    v_mov_b32 v6, 157952
    v_lshlrev_b32 v4, 4, v2
    v_add_u32 v4, 156224, v4
    v_lshl_add_u32 v125, v1, 3, s45
    s_mov_b64 exec, 0xffff
    ds_write_b32 v5, v60 offset:0
    ds_write_b32 v5, v64 offset:4
    ds_write_b32 v5, v68 offset:8
    ds_write_b32 v5, v72 offset:12
    ds_write_b32 v6, v6
    s_mov_b64 exec, -1
    ds_read_b128 v[36:39], v5
    ds_read_b128 v[28:31], v4
    ds_read_b128 v[32:35], v4 offset:512
    s_waitcnt lgkmcnt(0)
    v_fmac_f32 v60, v28, v36
    v_fmac_f32 v61, v29, v36
    v_fmac_f32 v62, v30, v36
    v_fmac_f32 v63, v31, v36
    v_mul_f32 v60, v60, v32
    v_mul_f32 v61, v61, v33
    v_mul_f32 v62, v62, v34
    v_mul_f32 v63, v63, v35
    v_cvt_pk_bf16_f32 v60, v60, v61
    v_cvt_pk_bf16_f32 v61, v62, v63
    ds_write_b64 v125, v[60:61] offset:0
    v_fmac_f32 v64, v28, v37
    v_fmac_f32 v65, v29, v37
    v_fmac_f32 v66, v30, v37
    v_fmac_f32 v67, v31, v37
    v_mul_f32 v64, v64, v32
    v_mul_f32 v65, v65, v33
    v_mul_f32 v66, v66, v34
    v_mul_f32 v67, v67, v35
    v_cvt_pk_bf16_f32 v64, v64, v65
    v_cvt_pk_bf16_f32 v65, v66, v67
    ds_write_b64 v125, v[64:65] offset:512
    v_fmac_f32 v68, v28, v38
    v_fmac_f32 v69, v29, v38
    v_fmac_f32 v70, v30, v38
    v_fmac_f32 v71, v31, v38
    v_mul_f32 v68, v68, v32
    v_mul_f32 v69, v69, v33
    v_mul_f32 v70, v70, v34
    v_mul_f32 v71, v71, v35
    v_cvt_pk_bf16_f32 v68, v68, v69
    v_cvt_pk_bf16_f32 v69, v70, v71
    ds_write_b64 v125, v[68:69] offset:1024
    v_fmac_f32 v72, v28, v39
    v_fmac_f32 v73, v29, v39
    v_fmac_f32 v74, v30, v39
    v_fmac_f32 v75, v31, v39
    v_mul_f32 v72, v72, v32
    v_mul_f32 v73, v73, v33
    v_mul_f32 v74, v74, v34
    v_mul_f32 v75, v75, v35
    v_cvt_pk_bf16_f32 v72, v72, v73
    v_cvt_pk_bf16_f32 v73, v74, v75
    ds_write_b64 v125, v[72:73] offset:1536
    v_mov_b32 v8, 157976
    v_mov_b32 v9, 1
    s_mov_b64 exec, 1
    ds_add_u32 v8, v9
    s_mov_b64 exec, -1
    s_branch Lagent
Lst_re:
    s_sub_u32 s35, s35, 1
    s_cbranch_scc1 Lend
    buffer_load_dwordx2 v[92:93], v96, s[28:31], s46 offen sc1
    buffer_load_dwordx2 v[94:95], v97, s[28:31], s46 offen sc1
    s_waitcnt vmcnt(0)
    s_branch Lst_chk
Laux:
    s_lshl_b32 s32, s37, 3
    s_lshl_b32 s39, s38, 2
    s_add_u32 s32, s32, s36
    s_cmp_lt_u32 s37, 4
    s_cselect_b32 s39, s39, 0
    s_add_u32 s32, s32, s39
    s_and_b32 s33, s2, 3
    s_lshl_b32 s33, s33, 3
    s_and_b32 s39, s2, 4
    s_add_u32 s33, s33, s39
    s_add_u32 s33, s33, s37
    s_cmp_ge_u32 s32, 32
    s_cbranch_scc1 Lmst
    v_lshrrev_b32 v5, 3, v1
    v_and_b32 v6, 7, v1
    s_lshl_b32 s40, s3, 14
    s_cmp_eq_u32 s27, 0
    s_cbranch_scc0 Laux_u
    s_lshl_b32 s36, s33, 6
    s_lshl_b32 s37, s26, 4
    s_add_u32 s36, s36, s37
    v_add_u32 v7, s36, v5
    v_mul_u32_u24 v7, 1280, v7
    v_xor_b32 v8, v6, v2
    v_lshl_add_u32 v92, v8, 4, v7
    v_add_u32 v92, 4096, v92
    v_xor_b32 v93, 64, v92
    v_add_u32 v93, 9216, v93
    v_subrev_u32 v94, 1920, v92
    v_subrev_u32 v95, 1920, v93
    s_waitcnt lgkmcnt(0)
    s_sub_u32 s52, s4, 4096
    s_subb_u32 s53, s5, 0
    s_mov_b32 s54, 2625536
    s_mov_b32 s55, 0x20000
    s_mov_b64 s[60:61], s[12:13]
    s_mov_b32 s62, 1280
    s_mov_b32 s63, 0x20000
    s_mov_b32 m0, 131072
    s_nop 0
    buffer_load_dwordx4 v13, s[60:63], 0 offen lds
    s_mov_b64 exec, 0xffff
    buffer_load_dwordx4 v13, s[60:63], 0 offen offset:1024 lds
    s_mov_b64 exec, -1
    s_add_u32 m0, s40, 0
    s_mov_b32 s41, 0
    buffer_load_dwordx4 v92, s[52:55], s41 offen lds
    buffer_load_dwordx4 v93, s[52:55], s41 offen offset:1024 lds
    buffer_load_dwordx4 v94, s[52:55], s41 offen offset:2048 lds
    buffer_load_dwordx4 v95, s[52:55], s41 offen offset:3072 lds
    s_add_u32 m0, s40, 4096
    s_mov_b32 s41, 256
    buffer_load_dwordx4 v92, s[52:55], s41 offen lds
    buffer_load_dwordx4 v93, s[52:55], s41 offen offset:1024 lds
    buffer_load_dwordx4 v94, s[52:55], s41 offen offset:2048 lds
    buffer_load_dwordx4 v95, s[52:55], s41 offen offset:3072 lds
    s_add_u32 m0, s40, 8192
    s_mov_b32 s41, 512
    buffer_load_dwordx4 v92, s[52:55], s41 offen lds
    buffer_load_dwordx4 v93, s[52:55], s41 offen offset:1024 lds
    buffer_load_dwordx4 v94, s[52:55], s41 offen offset:2048 lds
    buffer_load_dwordx4 v95, s[52:55], s41 offen offset:3072 lds
    s_add_u32 m0, s40, 12288
    s_mov_b32 s41, 768
    buffer_load_dwordx4 v92, s[52:55], s41 offen lds
    buffer_load_dwordx4 v93, s[52:55], s41 offen offset:1024 lds
    buffer_load_dwordx4 v94, s[52:55], s41 offen offset:2048 lds
    buffer_load_dwordx4 v95, s[52:55], s41 offen offset:3072 lds
    s_mov_b64 s[28:29], s[24:25]
    s_mov_b32 s30, 268435456
    s_mov_b32 s31, 0x20000
    s_load_dword s34, s[28:29], 0
    s_mov_b64 s[44:45], s[14:15]
    s_mov_b32 s46, 2211840
    s_mov_b32 s47, 0x20000
    s_mov_b64 s[48:49], s[18:19]
    s_mov_b32 s50, 2211840
    s_mov_b32 s51, 0x20000
    v_and_b32 v8, 1, v2
    v_lshlrev_b32 v8, 1, v8
    v_xor_b32 v8, v8, v6
    v_lshlrev_b32 v8, 4, v8
    v_mul_u32_u24 v9, 3456, v5
    s_lshl_b32 s38, s32, 7
    v_add3_u32 v18, v9, v8, s38
    v_xor_b32 v19, 64, v18
    v_add_u32 v19, 26624, v19
    v_add_u32 v20, 53248, v18
    v_add_u32 v21, 53248, v19
    s_mul_i32 s42, s26, 110592
    v_mul_u32_u24 v9, 1280, v5
    v_add_u32 v22, v9, v8
    v_xor_b32 v23, 64, v22
    v_add_u32 v23, 9216, v23
    v_add_u32 v24, 18432, v22
    v_add_u32 v25, 18432, v23
    s_mul_i32 s43, s32, 81920
    s_lshl_b32 s38, s3, 7
    s_add_u32 s43, s43, s38
    v_mov_b32 v96, 0x3f803f80
    v_mov_b32 v97, 0x3f803f80
    v_mov_b32 v98, 0x3f803f80
    v_mov_b32 v99, 0x3f803f80
    v_lshlrev_b32 v100, 4, v2
    v_add_u32 v100, 131072, v100
    v_lshrrev_b32 v10, 1, v3
    v_xor_b32 v10, v10, v2
    v_lshlrev_b32 v10, 4, v10
    v_lshl_add_u32 v10, v3, 7, v10
    v_add_u32 v102, s40, v10
    v_xor_b32 v103, 64, v102
    s_mov_b32 s58, 0xaaaaaaaa
    s_mov_b32 s59, 0xaaaaaaaa
    s_mov_b32 s64, 0xcccccccc
    s_mov_b32 s65, 0xcccccccc
    v_lshrrev_b32 v101, 2, v3
    v_lshl_add_u32 v101, v101, 4, v3
    v_lshlrev_b32 v101, 2, v101
    s_lshl_b32 s36, s26, 4
    v_add_u32 v10, s36, v3
    s_lshl_b32 s37, s33, 6
    s_sub_u32 s37, 2047, s37
    v_sub_u32 v106, s37, v10
    v_lshlrev_b32 v107, 2, v10
    v_add_u32 v107, 132608, v107
    s_lshl_b32 s36, s33, 9
    s_add_u32 s36, s36, 8192000
    v_lshl_add_u32 v108, v10, 3, s36
    v_bfe_u32 v10, v1, 2, 2
    v_and_b32 v8, 3, v1
    v_lshl_add_u32 v14, v2, 3, v10
    v_lshlrev_b32 v14, 7, v14
    v_lshlrev_b32 v9, 2, v1
    v_and_b32 v9, 0x60, v9
    v_add3_u32 v14, v14, v9, s40
    v_lshl_add_u32 v14, v8, 3, v14
    v_xor_b32 v15, 32, v14
    v_xor_b32 v16, 64, v14
    v_xor_b32 v17, 96, v14
    s_lshl_b32 s36, s26, 6
    s_add_u32 s36, s36, 141312
    v_lshl_add_u32 v26, v2, 4, s36
    v_min_u32 v8, 2, v3
    v_mul_u32_u24 v8, 1536, v8
    v_add_u32 v26, v26, v8
    v_add_u32 v4, 132864, v12
    v_mov_b32 v5, 0
    ds_write_b32 v4, v5
    s_waitcnt lgkmcnt(0)
    s_add_u32 s34, s34, 0x9e3779b8
    s_or_b32 s34, s34, 1
    s_waitcnt vmcnt(12)
    ds_read_b128 a[80:83], v102 offset:0
    ds_read_b128 a[84:87], v100 offset:0
    ds_read_b128 a[88:91], v103 offset:0
    ds_read_b128 a[92:95], v100 offset:64
    ds_read_b128 a[96:99], v102 offset:2048
    ds_read_b128 a[100:103], v100 offset:128
    ds_read_b128 a[104:107], v103 offset:2048
    ds_read_b128 a[108:111], v100 offset:192
    s_waitcnt lgkmcnt(0)
    s_add_u32 m0, s40, 0
    s_mov_b32 s41, 1024
    buffer_load_dwordx4 v92, s[52:55], s41 offen lds
    buffer_load_dwordx4 v93, s[52:55], s41 offen offset:1024 lds
    buffer_load_dwordx4 v94, s[52:55], s41 offen offset:2048 lds
    buffer_load_dwordx4 v95, s[52:55], s41 offen offset:3072 lds
    s_barrier
    v_mfma_f32_16x16x32_bf16 v[116:119], a[80:83], a[80:83], 0
    v_mfma_f32_16x16x32_bf16 v[112:115], v[96:99], a[80:83], 0
    v_mfma_f32_16x16x32_bf16 v[120:123], a[84:87], a[80:83], 0
    v_mfma_f32_16x16x32_bf16 v[124:127], a[84:87], v[96:99], 0
    v_mfma_f32_16x16x32_bf16 v[116:119], a[88:91], a[88:91], v[116:119]
    v_mfma_f32_16x16x32_bf16 v[112:115], v[96:99], a[88:91], v[112:115]
    v_mfma_f32_16x16x32_bf16 v[120:123], a[92:95], a[88:91], v[120:123]
    v_mfma_f32_16x16x32_bf16 v[124:127], a[92:95], v[96:99], v[124:127]
    v_mfma_f32_16x16x32_bf16 v[116:119], a[96:99], a[96:99], v[116:119]
    v_mfma_f32_16x16x32_bf16 v[112:115], v[96:99], a[96:99], v[112:115]
    v_mfma_f32_16x16x32_bf16 v[120:123], a[100:103], a[96:99], v[120:123]
    v_mfma_f32_16x16x32_bf16 v[124:127], a[100:103], v[96:99], v[124:127]
    v_mfma_f32_16x16x32_bf16 v[116:119], a[104:107], a[104:107], v[116:119]
    v_mfma_f32_16x16x32_bf16 v[112:115], v[96:99], a[104:107], v[112:115]
    v_mfma_f32_16x16x32_bf16 v[120:123], a[108:111], a[104:107], v[120:123]
    v_mfma_f32_16x16x32_bf16 v[124:127], a[108:111], v[96:99], v[124:127]
    s_waitcnt vmcnt(12)
    ds_read_b128 a[80:83], v102 offset:4096
    ds_read_b128 a[84:87], v100 offset:256
    ds_read_b128 a[88:91], v103 offset:4096
    ds_read_b128 a[92:95], v100 offset:320
    ds_read_b128 a[96:99], v102 offset:6144
    ds_read_b128 a[100:103], v100 offset:384
    ds_read_b128 a[104:107], v103 offset:6144
    ds_read_b128 a[108:111], v100 offset:448
    s_waitcnt lgkmcnt(0)
    v_mfma_f32_16x16x32_bf16 v[116:119], a[80:83], a[80:83], v[116:119]
    v_mfma_f32_16x16x32_bf16 v[112:115], v[96:99], a[80:83], v[112:115]
    v_mfma_f32_16x16x32_bf16 v[120:123], a[84:87], a[80:83], v[120:123]
    v_mfma_f32_16x16x32_bf16 v[124:127], a[84:87], v[96:99], v[124:127]
    v_mfma_f32_16x16x32_bf16 v[116:119], a[88:91], a[88:91], v[116:119]
    v_mfma_f32_16x16x32_bf16 v[112:115], v[96:99], a[88:91], v[112:115]
    v_mfma_f32_16x16x32_bf16 v[120:123], a[92:95], a[88:91], v[120:123]
    v_mfma_f32_16x16x32_bf16 v[124:127], a[92:95], v[96:99], v[124:127]
    v_mfma_f32_16x16x32_bf16 v[116:119], a[96:99], a[96:99], v[116:119]
    v_mfma_f32_16x16x32_bf16 v[112:115], v[96:99], a[96:99], v[112:115]
    v_mfma_f32_16x16x32_bf16 v[120:123], a[100:103], a[96:99], v[120:123]
    v_mfma_f32_16x16x32_bf16 v[124:127], a[100:103], v[96:99], v[124:127]
    v_mfma_f32_16x16x32_bf16 v[116:119], a[104:107], a[104:107], v[116:119]
    v_mfma_f32_16x16x32_bf16 v[112:115], v[96:99], a[104:107], v[112:115]
    v_mfma_f32_16x16x32_bf16 v[120:123], a[108:111], a[104:107], v[120:123]
    v_mfma_f32_16x16x32_bf16 v[124:127], a[108:111], v[96:99], v[124:127]
    s_waitcnt vmcnt(8)
    ds_read_b128 a[80:83], v102 offset:8192
    ds_read_b128 a[84:87], v100 offset:512
    ds_read_b128 a[88:91], v103 offset:8192
    ds_read_b128 a[92:95], v100 offset:576
    ds_read_b128 a[96:99], v102 offset:10240
    ds_read_b128 a[100:103], v100 offset:640
    ds_read_b128 a[104:107], v103 offset:10240
    ds_read_b128 a[108:111], v100 offset:704
    s_waitcnt lgkmcnt(0)
    v_mfma_f32_16x16x32_bf16 v[116:119], a[80:83], a[80:83], v[116:119]
    v_mfma_f32_16x16x32_bf16 v[112:115], v[96:99], a[80:83], v[112:115]
    v_mfma_f32_16x16x32_bf16 v[120:123], a[84:87], a[80:83], v[120:123]
    v_mfma_f32_16x16x32_bf16 v[124:127], a[84:87], v[96:99], v[124:127]
    v_mfma_f32_16x16x32_bf16 v[116:119], a[88:91], a[88:91], v[116:119]
    v_mfma_f32_16x16x32_bf16 v[112:115], v[96:99], a[88:91], v[112:115]
    v_mfma_f32_16x16x32_bf16 v[120:123], a[92:95], a[88:91], v[120:123]
    v_mfma_f32_16x16x32_bf16 v[124:127], a[92:95], v[96:99], v[124:127]
    v_mfma_f32_16x16x32_bf16 v[116:119], a[96:99], a[96:99], v[116:119]
    v_mfma_f32_16x16x32_bf16 v[112:115], v[96:99], a[96:99], v[112:115]
    v_mfma_f32_16x16x32_bf16 v[120:123], a[100:103], a[96:99], v[120:123]
    v_mfma_f32_16x16x32_bf16 v[124:127], a[100:103], v[96:99], v[124:127]
    v_mfma_f32_16x16x32_bf16 v[116:119], a[104:107], a[104:107], v[116:119]
    v_mfma_f32_16x16x32_bf16 v[112:115], v[96:99], a[104:107], v[112:115]
    v_mfma_f32_16x16x32_bf16 v[120:123], a[108:111], a[104:107], v[120:123]
    v_mfma_f32_16x16x32_bf16 v[124:127], a[108:111], v[96:99], v[124:127]
    s_waitcnt vmcnt(4)
    ds_read_b128 a[80:83], v102 offset:12288
    ds_read_b128 a[84:87], v100 offset:768
    ds_read_b128 a[88:91], v103 offset:12288
    ds_read_b128 a[92:95], v100 offset:832
    ds_read_b128 a[96:99], v102 offset:14336
    ds_read_b128 a[100:103], v100 offset:896
    ds_read_b128 a[104:107], v103 offset:14336
    ds_read_b128 a[108:111], v100 offset:960
    s_waitcnt lgkmcnt(0)
    v_mfma_f32_16x16x32_bf16 v[116:119], a[80:83], a[80:83], v[116:119]
    v_mfma_f32_16x16x32_bf16 v[112:115], v[96:99], a[80:83], v[112:115]
    v_mfma_f32_16x16x32_bf16 v[120:123], a[84:87], a[80:83], v[120:123]
    v_mfma_f32_16x16x32_bf16 v[124:127], a[84:87], v[96:99], v[124:127]
    v_mfma_f32_16x16x32_bf16 v[116:119], a[88:91], a[88:91], v[116:119]
    v_mfma_f32_16x16x32_bf16 v[112:115], v[96:99], a[88:91], v[112:115]
    v_mfma_f32_16x16x32_bf16 v[120:123], a[92:95], a[88:91], v[120:123]
    v_mfma_f32_16x16x32_bf16 v[124:127], a[92:95], v[96:99], v[124:127]
    v_mfma_f32_16x16x32_bf16 v[116:119], a[96:99], a[96:99], v[116:119]
    v_mfma_f32_16x16x32_bf16 v[112:115], v[96:99], a[96:99], v[112:115]
    v_mfma_f32_16x16x32_bf16 v[120:123], a[100:103], a[96:99], v[120:123]
    v_mfma_f32_16x16x32_bf16 v[124:127], a[100:103], v[96:99], v[124:127]
    v_mfma_f32_16x16x32_bf16 v[116:119], a[104:107], a[104:107], v[116:119]
    v_mfma_f32_16x16x32_bf16 v[112:115], v[96:99], a[104:107], v[112:115]
    v_mfma_f32_16x16x32_bf16 v[120:123], a[108:111], a[104:107], v[120:123]
    v_mfma_f32_16x16x32_bf16 v[124:127], a[108:111], v[96:99], v[124:127]
    s_waitcnt vmcnt(0)
    ds_read_b128 a[80:83], v102 offset:0
    ds_read_b128 a[84:87], v100 offset:1024
    ds_read_b128 a[88:91], v103 offset:0
    ds_read_b128 a[92:95], v100 offset:1088
    ds_read_b128 a[96:99], v102 offset:2048
    ds_read_b128 a[100:103], v100 offset:1152
    ds_read_b128 a[104:107], v103 offset:2048
    ds_read_b128 a[108:111], v100 offset:1216
    s_waitcnt lgkmcnt(0)
    v_mfma_f32_16x16x32_bf16 v[116:119], a[80:83], a[80:83], v[116:119]
    v_mfma_f32_16x16x32_bf16 v[112:115], v[96:99], a[80:83], v[112:115]
    v_mfma_f32_16x16x32_bf16 v[120:123], a[84:87], a[80:83], v[120:123]
    v_mfma_f32_16x16x32_bf16 v[124:127], a[84:87], v[96:99], v[124:127]
    v_mfma_f32_16x16x32_bf16 v[116:119], a[88:91], a[88:91], v[116:119]
    v_mfma_f32_16x16x32_bf16 v[112:115], v[96:99], a[88:91], v[112:115]
    v_mfma_f32_16x16x32_bf16 v[120:123], a[92:95], a[88:91], v[120:123]
    v_mfma_f32_16x16x32_bf16 v[124:127], a[92:95], v[96:99], v[124:127]
    v_mfma_f32_16x16x32_bf16 v[116:119], a[96:99], a[96:99], v[116:119]
    v_mfma_f32_16x16x32_bf16 v[112:115], v[96:99], a[96:99], v[112:115]
    v_mfma_f32_16x16x32_bf16 v[120:123], a[100:103], a[96:99], v[120:123]
    v_mfma_f32_16x16x32_bf16 v[124:127], a[100:103], v[96:99], v[124:127]
    v_mfma_f32_16x16x32_bf16 v[116:119], a[104:107], a[104:107], v[116:119]
    v_mfma_f32_16x16x32_bf16 v[112:115], v[96:99], a[104:107], v[112:115]
    v_mfma_f32_16x16x32_bf16 v[120:123], a[108:111], a[104:107], v[120:123]
    v_mfma_f32_16x16x32_bf16 v[124:127], a[108:111], v[96:99], v[124:127]
    s_nop 4
    v_cndmask_b32 v4, v116, v117, s[58:59]
    v_cndmask_b32 v5, v118, v119, s[58:59]
    v_cndmask_b32 v4, v4, v5, s[64:65]
    ds_bpermute_b32 v4, v101, v4
    v_mul_f32 v5, 0xbacccccd, v112
    v_cvt_pk_bf16_f32 v104, v5, v5
    v_lshlrev_b32 v104, 16, v104
    v_mul_f32 v5, v5, v5
    v_mov_b32 v6, 0x3acccccd
    s_waitcnt lgkmcnt(0)
    v_fma_f32 v4, v4, v6, -v5
    v_max_f32 v4, 0, v4
    v_cvt_pk_bf16_f32 v4, v4, v4
    v_lshlrev_b32 v4, 16, v4
    v_add_f32 v4, 0x3727c5ac, v4
    v_cvt_pk_bf16_f32 v4, v4, v4
    v_lshlrev_b32 v4, 16, v4
    v_sqrt_f32 v4, v4
    s_nop 0
    v_cvt_pk_bf16_f32 v4, v4, v4
    v_lshlrev_b32 v4, 16, v4
    v_rcp_f32 v105, v4
    v_lshrrev_b32 v8, 16, v4
    v_fma_f32 v4, v104, v124, v120
    v_mul_f32 v4, v4, v105
    v_cvt_pk_bf16_f32 v4, v4, v4
    v_ashrrev_i32 v5, 31, v4
    v_or_b32 v5, 0x80000000, v5
    v_xor_b32 v4, v4, v5
    v_and_b32 v4, 0xffff0000, v4
    v_or_b32 v4, v4, v106
    ds_write_b32 v107, v4
    v_mov_b32 v11, 132864
    v_mov_b32 v7, 1
    s_mov_b64 exec, 1
    ds_add_u32 v11, v7
    s_mov_b64 exec, -1
    v_or_b32 v8, v8, v104
    v_mov_b32 v9, s34
    s_mov_b64 exec, 0xffff
    buffer_store_dwordx2 v[8:9], v108, s[28:31], 0 offen sc1
    s_mov_b64 exec, -1
    s_cmp_lg_u32 s26, 0
    s_cbranch_scc1 Lpub_done
    s_setprio 3
Lcw_8:
    s_sub_u32 s35, s35, 1
    s_cbranch_scc1 Lend
    ds_read_b32 v7, v11
    s_waitcnt lgkmcnt(0)
    v_readfirstlane_b32 s38, v7
    s_nop 0
    s_cmp_lt_u32 s38, 4
    s_cbranch_scc1 Lcw_8
    v_add_u32 v5, 132608, v12
    ds_read_b32 v6, v5
    s_waitcnt lgkmcnt(0)
    v_mov_b32 v4, v6
    s_nop 1
    v_max_u32_dpp v4, v4, v4 row_ror:8 row_mask:0xf bank_mask:0xf
    s_nop 1
    v_max_u32_dpp v4, v4, v4 row_ror:4 row_mask:0xf bank_mask:0xf
    s_nop 1
    v_max_u32_dpp v4, v4, v4 row_ror:2 row_mask:0xf bank_mask:0xf
    s_nop 1
    v_max_u32_dpp v4, v4, v4 row_ror:1 row_mask:0xf bank_mask:0xf
    s_nop 0
    v_readlane_b32 s66, v4, 0
    v_readlane_b32 s36, v4, 16
    v_readlane_b32 s37, v4, 32
    v_readlane_b32 s38, v4, 48
    s_max_u32 s66, s66, s36
    s_max_u32 s37, s37, s38
    s_max_u32 s66, s66, s37
    v_cmp_eq_u32 vcc, s66, v6
    s_nop 1
    v_cndmask_b32 v4, v6, 0, vcc
    s_nop 1
    v_max_u32_dpp v4, v4, v4 row_ror:8 row_mask:0xf bank_mask:0xf
    s_nop 1
    v_max_u32_dpp v4, v4, v4 row_ror:4 row_mask:0xf bank_mask:0xf
    s_nop 1
    v_max_u32_dpp v4, v4, v4 row_ror:2 row_mask:0xf bank_mask:0xf
    s_nop 1
    v_max_u32_dpp v4, v4, v4 row_ror:1 row_mask:0xf bank_mask:0xf
    s_nop 0
    v_readlane_b32 s67, v4, 0
    v_readlane_b32 s36, v4, 16
    v_readlane_b32 s37, v4, 32
    v_readlane_b32 s38, v4, 48
    s_max_u32 s67, s67, s36
    s_max_u32 s37, s37, s38
    s_max_u32 s67, s67, s37
    v_mov_b32 v112, s66
    v_mov_b32 v113, s34
    v_mov_b32 v114, s67
    v_mov_b32 v115, s34
    s_lshl_b32 s36, s32, 7
    s_add_u32 s36, s36, 8126464
    s_mov_b64 exec, 0xff
    buffer_store_dwordx4 v[112:115], v13, s[28:31], s36 offen sc1
    s_mov_b64 exec, -1
    v_mov_b32 v11, 132864
    v_mov_b32 v7, 1
    s_mov_b64 exec, 1
    ds_add_u32 v11, v7
    s_mov_b64 exec, -1
    s_mov_b64 exec, 1
    s_lshl_b32 s36, s2, 2
    s_add_u32 s36, s36, 8323072
    v_mov_b32 v4, s34
    v_mov_b32 v5, s36
    buffer_store_dword v4, v5, s[28:31], 0 offen sc1
    s_mov_b64 exec, -1
    s_setprio 0
Lpub_done:
Lcw_9:
    s_sub_u32 s35, s35, 1
    s_cbranch_scc1 Lend
    ds_read_b32 v7, v11
    s_waitcnt lgkmcnt(0)
    v_readfirstlane_b32 s38, v7
    s_nop 0
    s_cmp_lt_u32 s38, 5
    s_cbranch_scc1 Lcw_9
    s_cmp_ge_u32 s32, 27
    s_cbranch_scc1 Lhelp_r
    s_add_u32 m0, s40, 0
    s_add_u32 s41, s42, 0
    buffer_load_dwordx4 v18, s[44:47], s41 offen nt lds
    buffer_load_dwordx4 v19, s[44:47], s41 offen offset:1024 nt lds
    buffer_load_dwordx4 v20, s[44:47], s41 offen offset:2048 nt lds
    buffer_load_dwordx4 v21, s[44:47], s41 offen offset:3072 nt lds
    s_add_u32 m0, s40, 4096
    s_add_u32 s41, s42, 442368
    buffer_load_dwordx4 v18, s[44:47], s41 offen nt lds
    buffer_load_dwordx4 v19, s[44:47], s41 offen offset:1024 nt lds
    buffer_load_dwordx4 v20, s[44:47], s41 offen offset:2048 nt lds
    buffer_load_dwordx4 v21, s[44:47], s41 offen offset:3072 nt lds
    s_add_u32 m0, s40, 8192
    s_add_u32 s41, s42, 884736
    buffer_load_dwordx4 v18, s[44:47], s41 offen nt lds
    buffer_load_dwordx4 v19, s[44:47], s41 offen offset:1024 nt lds
    buffer_load_dwordx4 v20, s[44:47], s41 offen offset:2048 nt lds
    buffer_load_dwordx4 v21, s[44:47], s41 offen offset:3072 nt lds
    s_add_u32 m0, s40, 12288
    s_add_u32 s41, s42, 1327104
    buffer_load_dwordx4 v18, s[44:47], s41 offen nt lds
    buffer_load_dwordx4 v19, s[44:47], s41 offen offset:1024 nt lds
    buffer_load_dwordx4 v20, s[44:47], s41 offen offset:2048 nt lds
    buffer_load_dwordx4 v21, s[44:47], s41 offen offset:3072 nt lds
    s_waitcnt vmcnt(12)
    ds_read_b64_tr_b16 a[0:1], v14 offset:0
    ds_read_b64_tr_b16 a[2:3], v14 offset:512
    ds_read_b64_tr_b16 a[4:5], v15 offset:0
    ds_read_b64_tr_b16 a[6:7], v15 offset:512
    ds_read_b64_tr_b16 a[8:9], v16 offset:0
    ds_read_b64_tr_b16 a[10:11], v16 offset:512
    ds_read_b64_tr_b16 a[12:13], v17 offset:0
    ds_read_b64_tr_b16 a[14:15], v17 offset:512
    s_waitcnt lgkmcnt(0)
    s_add_u32 m0, s40, 0
    s_add_u32 s41, s42, 1769472
    buffer_load_dwordx4 v18, s[44:47], s41 offen nt lds
    buffer_load_dwordx4 v19, s[44:47], s41 offen offset:1024 nt lds
    buffer_load_dwordx4 v20, s[44:47], s41 offen offset:2048 nt lds
    buffer_load_dwordx4 v21, s[44:47], s41 offen offset:3072 nt lds
    v_mov_b32 v11, 132864
    v_mov_b32 v7, 1
    s_mov_b64 exec, 1
    ds_add_u32 v11, v7
    s_mov_b64 exec, -1
    s_waitcnt vmcnt(12)
    ds_read_b64_tr_b16 a[16:17], v14 offset:4096
    ds_read_b64_tr_b16 a[18:19], v14 offset:4608
    ds_read_b64_tr_b16 a[20:21], v15 offset:4096
    ds_read_b64_tr_b16 a[22:23], v15 offset:4608
    ds_read_b64_tr_b16 a[24:25], v16 offset:4096
    ds_read_b64_tr_b16 a[26:27], v16 offset:4608
    ds_read_b64_tr_b16 a[28:29], v17 offset:4096
    ds_read_b64_tr_b16 a[30:31], v17 offset:4608
    s_waitcnt lgkmcnt(0)
    s_add_u32 m0, s40, 4096
    s_add_u32 s41, s43, 0
    buffer_load_dwordx4 v22, s[48:51], s41 offen nt lds
    buffer_load_dwordx4 v23, s[48:51], s41 offen offset:1024 nt lds
    buffer_load_dwordx4 v24, s[48:51], s41 offen offset:2048 nt lds
    buffer_load_dwordx4 v25, s[48:51], s41 offen offset:3072 nt lds
    s_waitcnt vmcnt(12)
    ds_read_b64_tr_b16 a[32:33], v14 offset:8192
    ds_read_b64_tr_b16 a[34:35], v14 offset:8704
    ds_read_b64_tr_b16 a[36:37], v15 offset:8192
    ds_read_b64_tr_b16 a[38:39], v15 offset:8704
    ds_read_b64_tr_b16 a[40:41], v16 offset:8192
    ds_read_b64_tr_b16 a[42:43], v16 offset:8704
    ds_read_b64_tr_b16 a[44:45], v17 offset:8192
    ds_read_b64_tr_b16 a[46:47], v17 offset:8704
    s_waitcnt lgkmcnt(0)
    s_add_u32 m0, s40, 8192
    s_add_u32 s41, s43, 40960
    buffer_load_dwordx4 v22, s[48:51], s41 offen nt lds
    buffer_load_dwordx4 v23, s[48:51], s41 offen offset:1024 nt lds
    buffer_load_dwordx4 v24, s[48:51], s41 offen offset:2048 nt lds
    buffer_load_dwordx4 v25, s[48:51], s41 offen offset:3072 nt lds
    s_waitcnt vmcnt(12)
    ds_read_b64_tr_b16 a[48:49], v14 offset:12288
    ds_read_b64_tr_b16 a[50:51], v14 offset:12800
    ds_read_b64_tr_b16 a[52:53], v15 offset:12288
    ds_read_b64_tr_b16 a[54:55], v15 offset:12800
    ds_read_b64_tr_b16 a[56:57], v16 offset:12288
    ds_read_b64_tr_b16 a[58:59], v16 offset:12800
    ds_read_b64_tr_b16 a[60:61], v17 offset:12288
    ds_read_b64_tr_b16 a[62:63], v17 offset:12800
    s_waitcnt vmcnt(8)
    ds_read_b64_tr_b16 a[64:65], v14 offset:0
    ds_read_b64_tr_b16 a[66:67], v14 offset:512
    ds_read_b64_tr_b16 a[68:69], v15 offset:0
    ds_read_b64_tr_b16 a[70:71], v15 offset:512
    ds_read_b64_tr_b16 a[72:73], v16 offset:0
    ds_read_b64_tr_b16 a[74:75], v16 offset:512
    ds_read_b64_tr_b16 a[76:77], v17 offset:0
    ds_read_b64_tr_b16 a[78:79], v17 offset:512
    s_branch Laux_mm
Laux_u:
    s_cmp_ge_u32 s32, 27
    s_cbranch_scc1 Lend
    v_and_b32 v8, 1, v2
    v_lshlrev_b32 v8, 1, v8
    v_xor_b32 v8, v8, v6
    v_lshlrev_b32 v8, 4, v8
    v_mul_u32_u24 v9, 3456, v5
    s_lshl_b32 s38, s32, 7
    v_add3_u32 v18, v9, v8, s38
    v_xor_b32 v19, 64, v18
    v_add_u32 v19, 26624, v19
    v_add_u32 v20, 53248, v18
    v_add_u32 v21, 53248, v19
    s_mul_i32 s42, s26, 110592
    v_mul_u32_u24 v9, 1280, v5
    v_add_u32 v22, v9, v8
    v_xor_b32 v23, 64, v22
    v_add_u32 v23, 9216, v23
    v_add_u32 v24, 18432, v22
    v_add_u32 v25, 18432, v23
    s_mul_i32 s43, s32, 81920
    s_lshl_b32 s38, s3, 7
    s_add_u32 s43, s43, s38
    s_waitcnt lgkmcnt(0)
    s_mov_b64 s[44:45], s[16:17]
    s_mov_b32 s46, 2211840
    s_mov_b32 s47, 0x20000
    s_mov_b64 s[28:29], s[24:25]
    s_mov_b32 s30, 268435456
    s_mov_b32 s31, 0x20000
    s_load_dword s34, s[28:29], 0
    s_mov_b64 s[52:53], s[4:5]
    s_mov_b32 s54, 2621440
    s_mov_b32 s55, 0x20000
    s_mov_b64 s[48:49], s[18:19]
    s_mov_b32 s50, 2211840
    s_mov_b32 s51, 0x20000
    s_mov_b64 s[68:69], s[18:19]
    s_mov_b32 s70, 2211840
    s_mov_b32 s71, 0x20000
    s_cmp_ge_u32 s26, 2
    s_cselect_b32 s70, 0, s70
    v_bfe_u32 v10, v1, 2, 2
    v_and_b32 v8, 3, v1
    v_lshl_add_u32 v14, v2, 3, v10
    v_lshlrev_b32 v14, 7, v14
    v_lshlrev_b32 v9, 2, v1
    v_and_b32 v9, 0x60, v9
    v_add3_u32 v14, v14, v9, s40
    v_lshl_add_u32 v14, v8, 3, v14
    v_xor_b32 v15, 32, v14
    v_xor_b32 v16, 64, v14
    v_xor_b32 v17, 96, v14
    s_lshl_b32 s36, s26, 6
    s_add_u32 s36, s36, 141312
    v_lshl_add_u32 v26, v2, 4, s36
    v_min_u32 v8, 2, v3
    v_mul_u32_u24 v8, 1536, v8
    v_add_u32 v26, v26, v8
    s_waitcnt lgkmcnt(0)
    s_add_u32 s34, s34, 0x9e3779b8
    s_or_b32 s34, s34, 1
    s_cmp_lg_u32 s3, 7
    s_cbranch_scc1 Lnop7
    s_setprio 3
Lnop7:
    s_barrier
    s_add_u32 m0, s40, 0
    s_add_u32 s41, s42, 0
    buffer_load_dwordx4 v18, s[44:47], s41 offen nt lds
    buffer_load_dwordx4 v19, s[44:47], s41 offen offset:1024 nt lds
    buffer_load_dwordx4 v20, s[44:47], s41 offen offset:2048 nt lds
    buffer_load_dwordx4 v21, s[44:47], s41 offen offset:3072 nt lds
    s_add_u32 m0, s40, 4096
    s_add_u32 s41, s42, 442368
    buffer_load_dwordx4 v18, s[44:47], s41 offen nt lds
    buffer_load_dwordx4 v19, s[44:47], s41 offen offset:1024 nt lds
    buffer_load_dwordx4 v20, s[44:47], s41 offen offset:2048 nt lds
    buffer_load_dwordx4 v21, s[44:47], s41 offen offset:3072 nt lds
    s_add_u32 m0, s40, 8192
    s_add_u32 s41, s42, 884736
    buffer_load_dwordx4 v18, s[44:47], s41 offen nt lds
    buffer_load_dwordx4 v19, s[44:47], s41 offen offset:1024 nt lds
    buffer_load_dwordx4 v20, s[44:47], s41 offen offset:2048 nt lds
    buffer_load_dwordx4 v21, s[44:47], s41 offen offset:3072 nt lds
    s_add_u32 m0, s40, 12288
    s_add_u32 s41, s42, 1327104
    buffer_load_dwordx4 v18, s[44:47], s41 offen nt lds
    buffer_load_dwordx4 v19, s[44:47], s41 offen offset:1024 nt lds
    buffer_load_dwordx4 v20, s[44:47], s41 offen offset:2048 nt lds
    buffer_load_dwordx4 v21, s[44:47], s41 offen offset:3072 nt lds
    v_mov_b32 v11, 132864
Lcw_10:
    s_sub_u32 s35, s35, 1
    s_cbranch_scc1 Lend
    s_sleep 4
    ds_read_b32 v7, v11
    s_waitcnt lgkmcnt(0)
    v_readfirstlane_b32 s38, v7
    s_nop 0
    s_cmp_lt_u32 s38, 5
    s_cbranch_scc1 Lcw_10
    s_waitcnt vmcnt(12)
    ds_read_b64_tr_b16 a[0:1], v14 offset:0
    ds_read_b64_tr_b16 a[2:3], v14 offset:512
    ds_read_b64_tr_b16 a[4:5], v15 offset:0
    ds_read_b64_tr_b16 a[6:7], v15 offset:512
    ds_read_b64_tr_b16 a[8:9], v16 offset:0
    ds_read_b64_tr_b16 a[10:11], v16 offset:512
    ds_read_b64_tr_b16 a[12:13], v17 offset:0
    ds_read_b64_tr_b16 a[14:15], v17 offset:512
    s_waitcnt lgkmcnt(0)
    s_add_u32 m0, s40, 0
    s_add_u32 s41, s42, 1769472
    buffer_load_dwordx4 v18, s[44:47], s41 offen nt lds
    buffer_load_dwordx4 v19, s[44:47], s41 offen offset:1024 nt lds
    buffer_load_dwordx4 v20, s[44:47], s41 offen offset:2048 nt lds
    buffer_load_dwordx4 v21, s[44:47], s41 offen offset:3072 nt lds
    s_waitcnt vmcnt(12)
    ds_read_b64_tr_b16 a[16:17], v14 offset:4096
    ds_read_b64_tr_b16 a[18:19], v14 offset:4608
    ds_read_b64_tr_b16 a[20:21], v15 offset:4096
    ds_read_b64_tr_b16 a[22:23], v15 offset:4608
    ds_read_b64_tr_b16 a[24:25], v16 offset:4096
    ds_read_b64_tr_b16 a[26:27], v16 offset:4608
    ds_read_b64_tr_b16 a[28:29], v17 offset:4096
    ds_read_b64_tr_b16 a[30:31], v17 offset:4608
    s_waitcnt vmcnt(8)
    ds_read_b64_tr_b16 a[32:33], v14 offset:8192
    ds_read_b64_tr_b16 a[34:35], v14 offset:8704
    ds_read_b64_tr_b16 a[36:37], v15 offset:8192
    ds_read_b64_tr_b16 a[38:39], v15 offset:8704
    ds_read_b64_tr_b16 a[40:41], v16 offset:8192
    ds_read_b64_tr_b16 a[42:43], v16 offset:8704
    ds_read_b64_tr_b16 a[44:45], v17 offset:8192
    ds_read_b64_tr_b16 a[46:47], v17 offset:8704
    s_waitcnt vmcnt(4)
    ds_read_b64_tr_b16 a[48:49], v14 offset:12288
    ds_read_b64_tr_b16 a[50:51], v14 offset:12800
    ds_read_b64_tr_b16 a[52:53], v15 offset:12288
    ds_read_b64_tr_b16 a[54:55], v15 offset:12800
    ds_read_b64_tr_b16 a[56:57], v16 offset:12288
    ds_read_b64_tr_b16 a[58:59], v16 offset:12800
    ds_read_b64_tr_b16 a[60:61], v17 offset:12288
    ds_read_b64_tr_b16 a[62:63], v17 offset:12800
    s_waitcnt vmcnt(0)
    ds_read_b64_tr_b16 a[64:65], v14 offset:0
    ds_read_b64_tr_b16 a[66:67], v14 offset:512
    ds_read_b64_tr_b16 a[68:69], v15 offset:0
    ds_read_b64_tr_b16 a[70:71], v15 offset:512
    ds_read_b64_tr_b16 a[72:73], v16 offset:0
    ds_read_b64_tr_b16 a[74:75], v16 offset:512
    ds_read_b64_tr_b16 a[76:77], v17 offset:0
    ds_read_b64_tr_b16 a[78:79], v17 offset:512
    s_cmp_lg_u32 s3, 7
    s_cbranch_scc1 Lnofx
    v_mov_b32 v92, 0x3f803f80
    v_mov_b32 v93, 0x3f803f80
    v_mov_b32 v94, 0x3f803f80
    v_mov_b32 v95, 0x3f803f80
    v_add_u32 v4, 144384, v13
    ds_write_b128 v4, v[92:95]
    ds_write_b128 v4, v[92:95] offset:1024
    v_and_b32 v120, 31, v1
    v_lshlrev_b32 v120, 7, v120
    v_add_u32 v120, 8126464, v120
Lpt_11:
    s_sub_u32 s35, s35, 1
    s_cbranch_scc1 Lend
    s_sleep 2
    buffer_load_dwordx4 v[124:127], v120, s[28:31], 0 offen sc1
    s_waitcnt vmcnt(0)
    v_cmp_ne_u32 vcc, s34, v125
    v_cmp_ne_u32 s[36:37], s34, v127
    s_nop 0
    s_or_b64 s[36:37], s[36:37], vcc
    s_cbranch_scc1 Lpt_11
    v_mov_b32 v120, v124
    s_nop 1
    v_max_u32_dpp v120, v120, v120 row_ror:8 row_mask:0xf bank_mask:0xf
    s_nop 1
    v_max_u32_dpp v120, v120, v120 row_ror:4 row_mask:0xf bank_mask:0xf
    s_nop 1
    v_max_u32_dpp v120, v120, v120 row_ror:2 row_mask:0xf bank_mask:0xf
    s_nop 1
    v_max_u32_dpp v120, v120, v120 row_ror:1 row_mask:0xf bank_mask:0xf
    s_nop 0
    v_readlane_b32 s56, v120, 0
    v_readlane_b32 s36, v120, 16
    v_readlane_b32 s37, v120, 32
    v_readlane_b32 s38, v120, 48
    s_max_u32 s56, s56, s36
    s_max_u32 s37, s37, s38
    s_max_u32 s56, s56, s37
    v_cmp_eq_u32 vcc, s56, v124
    s_nop 1
    v_cndmask_b32 v120, v124, v126, vcc
    s_nop 1
    v_max_u32_dpp v120, v120, v120 row_ror:8 row_mask:0xf bank_mask:0xf
    s_nop 1
    v_max_u32_dpp v120, v120, v120 row_ror:4 row_mask:0xf bank_mask:0xf
    s_nop 1
    v_max_u32_dpp v120, v120, v120 row_ror:2 row_mask:0xf bank_mask:0xf
    s_nop 1
    v_max_u32_dpp v120, v120, v120 row_ror:1 row_mask:0xf bank_mask:0xf
    s_nop 0
    v_readlane_b32 s57, v120, 0
    v_readlane_b32 s36, v120, 16
    v_readlane_b32 s37, v120, 32
    v_readlane_b32 s38, v120, 48
    s_max_u32 s57, s57, s36
    s_max_u32 s37, s37, s38
    s_max_u32 s57, s57, s37
    s_and_b32 s36, s56, 0x7ff
    s_sub_u32 s36, 2047, s36
    s_and_b32 s37, s57, 0x7ff
    s_sub_u32 s37, 2047, s37
    s_mul_i32 s38, s36, 1280
    s_mul_i32 s39, s37, 1280
    s_mov_b32 m0, 141312
    v_mov_b32 v4, s36
    buffer_load_dwordx4 v13, s[52:55], s38 offen lds
    s_mov_b32 m0, 142848
    v_mov_b32 v5, s37
    buffer_load_dwordx4 v13, s[52:55], s39 offen lds
    s_mov_b64 exec, 0xffff
    buffer_load_dwordx4 v13, s[52:55], s39 offen offset:1024 lds
    s_mov_b32 m0, 141312
    s_mov_b32 vcc_lo, 0xaaaaaaaa
    buffer_load_dwordx4 v13, s[52:55], s38 offen offset:1024 lds
    s_mov_b64 exec, 3
    v_cndmask_b32 v4, v4, v5, vcc
    v_lshlrev_b32 v118, 3, v4
    v_add_u32 v118, 8192000, v118
    v_add_u32 v9, 132872, v12
Lxs_chk:
    s_sub_u32 s35, s35, 1
    s_cbranch_scc1 Lend
    buffer_load_dwordx2 v[116:117], v118, s[28:31], 0 offen sc1
    s_waitcnt vmcnt(0)
    v_cmp_ne_u32 vcc, s34, v117
    s_nop 0
    s_cbranch_vccnz Lxs_chk
    ds_write_b32 v9, v116
    s_mov_b64 exec, -1
    v_mov_b32 v10, 132868
    v_mov_b32 v7, 1
    s_mov_b64 exec, 1
    ds_add_u32 v10, v7
    s_mov_b64 exec, -1
Lnofx:
Lcw_12:
    s_sub_u32 s35, s35, 1
    s_cbranch_scc1 Lend
    s_sleep 2
    ds_read_b32 v7, v11
    s_waitcnt lgkmcnt(0)
    v_readfirstlane_b32 s38, v7
    s_nop 0
    s_cmp_lt_u32 s38, 9
    s_cbranch_scc1 Lcw_12
    s_add_u32 m0, s40, 4096
    s_add_u32 s41, s43, 0
    buffer_load_dwordx4 v22, s[48:51], s41 offen nt lds
    buffer_load_dwordx4 v23, s[48:51], s41 offen offset:1024 nt lds
    buffer_load_dwordx4 v24, s[48:51], s41 offen offset:2048 nt lds
    buffer_load_dwordx4 v25, s[48:51], s41 offen offset:3072 nt lds
    s_add_u32 m0, s40, 8192
    s_add_u32 s41, s43, 40960
    buffer_load_dwordx4 v22, s[48:51], s41 offen nt lds
    buffer_load_dwordx4 v23, s[48:51], s41 offen offset:1024 nt lds
    buffer_load_dwordx4 v24, s[48:51], s41 offen offset:2048 nt lds
    buffer_load_dwordx4 v25, s[48:51], s41 offen offset:3072 nt lds
    s_add_u32 m0, s40, 12288
    s_add_u32 s41, s43, 512
    buffer_load_dwordx4 v22, s[68:71], s41 offen nt lds
    buffer_load_dwordx4 v23, s[68:71], s41 offen offset:1024 nt lds
    buffer_load_dwordx4 v24, s[68:71], s41 offen offset:2048 nt lds
    buffer_load_dwordx4 v25, s[68:71], s41 offen offset:3072 nt lds
    s_add_u32 m0, s40, 0
    s_add_u32 s41, s43, 41472
    buffer_load_dwordx4 v22, s[68:71], s41 offen nt lds
    buffer_load_dwordx4 v23, s[68:71], s41 offen offset:1024 nt lds
    buffer_load_dwordx4 v24, s[68:71], s41 offen offset:2048 nt lds
    buffer_load_dwordx4 v25, s[68:71], s41 offen offset:3072 nt lds
Laux_mm:
    v_mov_b32 v10, 132868
Lcw_13:
    s_sub_u32 s35, s35, 1
    s_cbranch_scc1 Lend
    s_sleep 1
    ds_read_b32 v7, v10
    s_waitcnt lgkmcnt(0)
    v_readfirstlane_b32 s38, v7
    s_nop 0
    s_cmp_lt_u32 s38, 1
    s_cbranch_scc1 Lcw_13
    ds_read_b128 v[92:95], v26 offset:0
    ds_read_b128 v[96:99], v26 offset:256
    ds_read_b128 v[100:103], v26 offset:512
    ds_read_b128 v[104:107], v26 offset:768
    ds_read_b128 v[108:111], v26 offset:1024
    ds_read_b64 v[116:117], v10 offset:4
    s_waitcnt lgkmcnt(0)
    v_readfirstlane_b32 s56, v116
    v_readfirstlane_b32 s57, v117
    v_mfma_f32_16x16x32_bf16 v[112:115], a[0:3], v[92:95], 0
    v_mfma_f32_16x16x32_bf16 v[116:119], a[4:7], v[92:95], 0
    v_mfma_f32_16x16x32_bf16 v[120:123], a[8:11], v[92:95], 0
    v_mfma_f32_16x16x32_bf16 v[124:127], a[12:15], v[92:95], 0
    v_mfma_f32_16x16x32_bf16 v[112:115], a[16:19], v[96:99], v[112:115]
    v_mfma_f32_16x16x32_bf16 v[116:119], a[20:23], v[96:99], v[116:119]
    v_mfma_f32_16x16x32_bf16 v[120:123], a[24:27], v[96:99], v[120:123]
    v_mfma_f32_16x16x32_bf16 v[124:127], a[28:31], v[96:99], v[124:127]
    v_mfma_f32_16x16x32_bf16 v[112:115], a[32:35], v[100:103], v[112:115]
    v_mfma_f32_16x16x32_bf16 v[116:119], a[36:39], v[100:103], v[116:119]
    v_mfma_f32_16x16x32_bf16 v[120:123], a[40:43], v[100:103], v[120:123]
    v_mfma_f32_16x16x32_bf16 v[124:127], a[44:47], v[100:103], v[124:127]
    v_mfma_f32_16x16x32_bf16 v[112:115], a[48:51], v[104:107], v[112:115]
    v_mfma_f32_16x16x32_bf16 v[116:119], a[52:55], v[104:107], v[116:119]
    v_mfma_f32_16x16x32_bf16 v[120:123], a[56:59], v[104:107], v[120:123]
    v_mfma_f32_16x16x32_bf16 v[124:127], a[60:63], v[104:107], v[124:127]
    v_mfma_f32_16x16x32_bf16 v[112:115], a[64:67], v[108:111], v[112:115]
    v_mfma_f32_16x16x32_bf16 v[116:119], a[68:71], v[108:111], v[116:119]
    v_mfma_f32_16x16x32_bf16 v[120:123], a[72:75], v[108:111], v[120:123]
    v_mfma_f32_16x16x32_bf16 v[124:127], a[76:79], v[108:111], v[124:127]
    s_mul_i32 s36, s3, 768
    s_add_u32 s36, s36, 133120
    v_lshlrev_b32 v4, 8, v3
    v_lshl_add_u32 v4, v2, 4, v4
    v_add_u32 v4, s36, v4
    v_add_u32 v5, 133120, v12
    s_lshl_b32 s37, s3, 8
    s_add_u32 s37, s37, 139264
    v_lshl_add_u32 v6, v1, 1, s37
    v_and_b32 v7, 1, v1
    v_lshlrev_b32 v7, 7, v7
    v_lshl_add_u32 v7, v2, 4, v7
    v_add_u32 v7, s37, v7
    s_lshl_b32 s38, s56, 16
    s_lshl_b32 s39, s57, 16
    v_rcp_f32 v8, s38
    v_rcp_f32 v9, s39
    s_and_b32 s56, s56, 0xffff0000
    s_and_b32 s57, s57, 0xffff0000
    s_mov_b32 exec_lo, 0x00070007
    s_mov_b32 exec_hi, 0x00070007
    ds_write_b128 v4, v[112:115] offset:0
    ds_write_b128 v4, v[116:119] offset:64
    ds_write_b128 v4, v[120:123] offset:128
    ds_write_b128 v4, v[124:127] offset:192
    s_mov_b64 exec, -1
    s_waitcnt lgkmcnt(0)
    s_barrier
    ds_read2st64_b32 v[92:93], v5 offset0:0 offset1:1
    ds_read2st64_b32 v[94:95], v5 offset0:2 offset1:3
    ds_read2st64_b32 v[96:97], v5 offset0:4 offset1:5
    ds_read2st64_b32 v[98:99], v5 offset0:6 offset1:7
    ds_read2st64_b32 v[100:101], v5 offset0:8 offset1:9
    ds_read2st64_b32 v[102:103], v5 offset0:10 offset1:11
    ds_read2st64_b32 v[116:117], v5 offset0:12 offset1:13
    ds_read2st64_b32 v[118:119], v5 offset0:14 offset1:15
    ds_read2st64_b32 v[120:121], v5 offset0:16 offset1:17
    ds_read2st64_b32 v[122:123], v5 offset0:18 offset1:19
    ds_read2st64_b32 v[124:125], v5 offset0:20 offset1:21
    ds_read2st64_b32 v[126:127], v5 offset0:22 offset1:23
    v_cmp_eq_u32 s[72:73], 1, v2
    v_cmp_eq_u32 s[74:75], 2, v2
    v_cmp_eq_u32 s[76:77], 3, v2
    s_mul_i32 s37, s32, 10
    s_add_u32 s37, s37, s3
    s_lshl_b32 s37, s37, 10
    s_add_u32 s37, s37, 7405568
    s_waitcnt lgkmcnt(0)
    v_add_f32 v92, v92, v95
    v_add_f32 v98, v98, v101
    v_add_f32 v92, v92, v98
    v_add_f32 v93, v93, v96
    v_add_f32 v99, v99, v102
    v_add_f32 v93, v93, v99
    v_add_f32 v94, v94, v97
    v_add_f32 v100, v100, v103
    v_add_f32 v94, v94, v100
    v_add_f32 v116, v116, v119
    v_add_f32 v122, v122, v125
    v_add_f32 v116, v116, v122
    v_add_f32 v117, v117, v120
    v_add_f32 v123, v123, v126
    v_add_f32 v117, v117, v123
    v_add_f32 v118, v118, v121
    v_add_f32 v124, v124, v127
    v_add_f32 v118, v118, v124
    v_fmac_f32 v92, s56, v94
    v_mul_f32 v112, v92, v8
    v_fmac_f32 v93, s57, v94
    v_mul_f32 v113, v93, v9
    v_fmac_f32 v116, s56, v118
    v_mul_f32 v120, v116, v8
    v_fmac_f32 v117, s57, v118
    v_mul_f32 v121, v117, v9
    v_cvt_pk_bf16_f32 v113, v112, v113
    v_lshlrev_b32 v112, 16, v113
    v_and_b32 v113, 0xffff0000, v113
    v_cvt_pk_bf16_f32 v121, v120, v121
    v_lshlrev_b32 v120, 16, v121
    v_and_b32 v121, 0xffff0000, v121
    v_mul_f32 v114, 0xbfb8aa3b, v112
    v_mul_f32 v115, 0xbfb8aa3b, v113
    v_exp_f32 v114, v114
    v_exp_f32 v115, v115
    v_add_f32 v114, 1.0, v114
    v_add_f32 v115, 1.0, v115
    v_rcp_f32 v114, v114
    v_rcp_f32 v115, v115
    v_mul_f32 v114, v114, v112
    v_mul_f32 v115, v115, v113
    v_cvt_pk_bf16_f32 v115, v114, v115
    v_lshlrev_b32 v114, 16, v115
    v_and_b32 v115, 0xffff0000, v115
    v_mul_f32 v114, v114, v120
    v_mul_f32 v115, v115, v121
    v_cvt_pk_bf16_f32 v114, v114, v115
    ds_write_b16 v6, v114
    ds_write_b16_d16_hi v6, v114 offset:128
    ds_read_b128 v[92:95], v7 offset:0
    ds_read_b128 v[96:99], v7 offset:64
    v_mov_b32 v101, s34
    v_mov_b32 v103, s34
    s_waitcnt vmcnt(0)
    ds_read_b64_tr_b16 v[28:29], v14 offset:4096
    ds_read_b64_tr_b16 v[30:31], v14 offset:4608
    ds_read_b64_tr_b16 v[32:33], v15 offset:4096
    ds_read_b64_tr_b16 v[34:35], v15 offset:4608
    ds_read_b64_tr_b16 v[36:37], v16 offset:4096
    ds_read_b64_tr_b16 v[38:39], v16 offset:4608
    ds_read_b64_tr_b16 v[40:41], v17 offset:4096
    ds_read_b64_tr_b16 v[42:43], v17 offset:4608
    ds_read_b64_tr_b16 v[44:45], v14 offset:8192
    ds_read_b64_tr_b16 v[46:47], v14 offset:8704
    ds_read_b64_tr_b16 v[48:49], v15 offset:8192
    ds_read_b64_tr_b16 v[50:51], v15 offset:8704
    ds_read_b64_tr_b16 v[52:53], v16 offset:8192
    ds_read_b64_tr_b16 v[54:55], v16 offset:8704
    ds_read_b64_tr_b16 v[56:57], v17 offset:8192
    ds_read_b64_tr_b16 v[58:59], v17 offset:8704
    s_waitcnt lgkmcnt(0)
    v_mfma_f32_16x16x32_bf16 v[112:115], v[92:95], v[28:31], 0
    v_mfma_f32_16x16x32_bf16 v[116:119], v[92:95], v[32:35], 0
    v_mfma_f32_16x16x32_bf16 v[120:123], v[92:95], v[36:39], 0
    v_mfma_f32_16x16x32_bf16 v[124:127], v[92:95], v[40:43], 0
    v_mfma_f32_16x16x32_bf16 v[112:115], v[96:99], v[44:47], v[112:115]
    v_mfma_f32_16x16x32_bf16 v[116:119], v[96:99], v[48:51], v[116:119]
    v_mfma_f32_16x16x32_bf16 v[120:123], v[96:99], v[52:55], v[120:123]
    v_mfma_f32_16x16x32_bf16 v[124:127], v[96:99], v[56:59], v[124:127]
    s_nop 5
    v_cndmask_b32 v100, v112, v116, s[72:73]
    v_cndmask_b32 v100, v100, v120, s[74:75]
    v_cndmask_b32 v100, v100, v124, s[76:77]
    v_cndmask_b32 v102, v113, v117, s[72:73]
    v_cndmask_b32 v102, v102, v121, s[74:75]
    v_cndmask_b32 v102, v102, v125, s[76:77]
    buffer_store_dwordx4 v[100:103], v13, s[28:31], s37 offen sc1
    s_sub_u32 s36, s3, 4
    s_cmp_ge_u32 s36, 2
    s_cbranch_scc1 Laux_end
    s_add_u32 s37, s37, 4096
    ds_read_b64_tr_b16 v[60:61], v14 offset:12288
    ds_read_b64_tr_b16 v[62:63], v14 offset:12800
    ds_read_b64_tr_b16 v[64:65], v15 offset:12288
    ds_read_b64_tr_b16 v[66:67], v15 offset:12800
    ds_read_b64_tr_b16 v[68:69], v16 offset:12288
    ds_read_b64_tr_b16 v[70:71], v16 offset:12800
    ds_read_b64_tr_b16 v[72:73], v17 offset:12288
    ds_read_b64_tr_b16 v[74:75], v17 offset:12800
    ds_read_b64_tr_b16 v[76:77], v14 offset:0
    ds_read_b64_tr_b16 v[78:79], v14 offset:512
    ds_read_b64_tr_b16 v[80:81], v15 offset:0
    ds_read_b64_tr_b16 v[82:83], v15 offset:512
    ds_read_b64_tr_b16 v[84:85], v16 offset:0
    ds_read_b64_tr_b16 v[86:87], v16 offset:512
    ds_read_b64_tr_b16 v[88:89], v17 offset:0
    ds_read_b64_tr_b16 v[90:91], v17 offset:512
    s_waitcnt lgkmcnt(0)
    v_mfma_f32_16x16x32_bf16 v[112:115], v[92:95], v[60:63], 0
    v_mfma_f32_16x16x32_bf16 v[116:119], v[92:95], v[64:67], 0
    v_mfma_f32_16x16x32_bf16 v[120:123], v[92:95], v[68:71], 0
    v_mfma_f32_16x16x32_bf16 v[124:127], v[92:95], v[72:75], 0
    v_mfma_f32_16x16x32_bf16 v[112:115], v[96:99], v[76:79], v[112:115]
    v_mfma_f32_16x16x32_bf16 v[116:119], v[96:99], v[80:83], v[116:119]
    v_mfma_f32_16x16x32_bf16 v[120:123], v[96:99], v[84:87], v[120:123]
    v_mfma_f32_16x16x32_bf16 v[124:127], v[96:99], v[88:91], v[124:127]
    s_nop 5
    v_cndmask_b32 v100, v112, v116, s[72:73]
    v_cndmask_b32 v100, v100, v120, s[74:75]
    v_cndmask_b32 v100, v100, v124, s[76:77]
    v_cndmask_b32 v102, v113, v117, s[72:73]
    v_cndmask_b32 v102, v102, v121, s[74:75]
    v_cndmask_b32 v102, v102, v125, s[76:77]
    buffer_store_dwordx4 v[100:103], v13, s[28:31], s37 offen sc1
Laux_end:
    s_endpgm
Lmst:
    s_cmp_lg_u32 s3, 0
    s_cbranch_scc1 Lhelp_i
    s_waitcnt lgkmcnt(0)
    s_mov_b64 s[28:29], s[24:25]
    s_mov_b32 s30, 268435456
    s_mov_b32 s31, 0x20000
    s_load_dword s34, s[28:29], 0
    s_waitcnt lgkmcnt(0)
    s_add_u32 s34, s34, 0x9e3779b8
    s_or_b32 s34, s34, 1
    s_mov_b64 exec, 1
    s_lshl_b32 s36, s2, 2
    s_add_u32 s36, s36, 8323072
    v_mov_b32 v4, s34
    v_mov_b32 v5, s36
    buffer_store_dword v4, v5, s[28:31], 0 offen sc1
    s_mov_b64 exec, -1
    s_cmp_lg_u32 s32, 32
    s_cbranch_scc1 Lend
Lmst_bc:
    v_and_b32 v4, 31, v1
    v_lshlrev_b32 v4, 7, v4
    v_add_u32 v4, 8126464, v4
Lpt_14:
    s_sub_u32 s35, s35, 1
    s_cbranch_scc1 Lend
    s_sleep 8
    buffer_load_dwordx4 v[8:11], v4, s[28:31], 0 offen sc1
    s_waitcnt vmcnt(0)
    v_cmp_ne_u32 vcc, s34, v9
    v_cmp_ne_u32 s[36:37], s34, v11
    s_nop 0
    s_or_b64 s[36:37], s[36:37], vcc
    s_cbranch_scc1 Lpt_14
    v_mov_b32 v4, v8
    s_nop 1
    v_max_u32_dpp v4, v4, v4 row_ror:8 row_mask:0xf bank_mask:0xf
    s_nop 1
    v_max_u32_dpp v4, v4, v4 row_ror:4 row_mask:0xf bank_mask:0xf
    s_nop 1
    v_max_u32_dpp v4, v4, v4 row_ror:2 row_mask:0xf bank_mask:0xf
    s_nop 1
    v_max_u32_dpp v4, v4, v4 row_ror:1 row_mask:0xf bank_mask:0xf
    s_nop 0
    v_readlane_b32 s40, v4, 0
    v_readlane_b32 s36, v4, 16
    v_readlane_b32 s37, v4, 32
    v_readlane_b32 s38, v4, 48
    s_max_u32 s40, s40, s36
    s_max_u32 s37, s37, s38
    s_max_u32 s40, s40, s37
    v_cmp_eq_u32 vcc, s40, v8
    s_nop 1
    v_cndmask_b32 v4, v8, v10, vcc
    s_nop 1
    v_max_u32_dpp v4, v4, v4 row_ror:8 row_mask:0xf bank_mask:0xf
    s_nop 1
    v_max_u32_dpp v4, v4, v4 row_ror:4 row_mask:0xf bank_mask:0xf
    s_nop 1
    v_max_u32_dpp v4, v4, v4 row_ror:2 row_mask:0xf bank_mask:0xf
    s_nop 1
    v_max_u32_dpp v4, v4, v4 row_ror:1 row_mask:0xf bank_mask:0xf
    s_nop 0
    v_readlane_b32 s41, v4, 0
    v_readlane_b32 s36, v4, 16
    v_readlane_b32 s37, v4, 32
    v_readlane_b32 s38, v4, 48
    s_max_u32 s41, s41, s36
    s_max_u32 s37, s37, s38
    s_max_u32 s41, s41, s37
    v_mov_b32 v8, s40
    v_mov_b32 v9, s34
    v_mov_b32 v10, s41
    v_mov_b32 v11, s34
    s_mov_b32 s36, 8257536
    buffer_store_dwordx4 v[8:11], v13, s[28:31], s36 offen offset:0 sc1
    buffer_store_dwordx4 v[8:11], v13, s[28:31], s36 offen offset:1024 sc1
    buffer_store_dwordx4 v[8:11], v13, s[28:31], s36 offen offset:2048 sc1
    s_mov_b32 s36, 8323072
Lmaster:
    s_sub_u32 s35, s35, 1
    s_cbranch_scc1 Lend
    s_sleep 16
    buffer_load_dwordx4 v[4:7], v13, s[28:31], s36 offen sc1
    s_waitcnt vmcnt(0)
    v_xor_b32 v4, s34, v4
    v_xor_b32 v5, s34, v5
    v_xor_b32 v6, s34, v6
    v_xor_b32 v7, s34, v7
    v_or3_b32 v4, v4, v5, v6
    v_or_b32 v4, v4, v7
    v_cmp_ne_u32 vcc, 0, v4
    s_nop 0
    s_cbranch_vccnz Lmaster
    s_mov_b64 exec, 1
    buffer_store_dword v9, v4, s[28:31], 0 offen sc1
    s_endpgm
Lhelp_r:
    s_sub_u32 s72, s32, 27
    s_add_u32 s72, s72, 9
    s_mov_b32 s73, 5
    s_mov_b32 s37, 2
    s_branch Lhelp
Lhelp_i:
    s_cmp_eq_u32 s32, 32
    s_cbranch_scc1 Lend
    s_cmp_eq_u32 s27, 0
    s_cbranch_scc1 Lend
    s_sub_u32 s72, s32, 33
    s_mov_b32 s73, 3
    s_mov_b32 s37, 3
Lhelp:
    s_lshl_b32 s38, s26, 6
    v_add_u32 v4, s38, v1
    v_mul_u32_u24 v4, 1280, v4
    s_waitcnt lgkmcnt(0)
    s_mov_b64 s[68:69], s[8:9]
    s_mov_b32 s70, 819200
    s_mov_b32 s71, 0x20000
    v_add_u32 v7, s38, v1
    v_lshlrev_b32 v7, 7, v7
    s_cmp_eq_u32 s73, 3
    s_cselect_b32 s36, 5, 2
    s_cselect_b32 s39, 33, 27
    s_cselect_b32 s38, 0, 15
    s_sub_u32 s39, s32, s39
    s_mul_i32 s39, s39, s36
    s_add_u32 s39, s39, s38
    s_lshl_b32 s39, s39, 15
Lhelp1:
    buffer_load_dword v5, v7, s[68:71], s39 offen
    s_add_u32 s39, s39, 32768
    s_sub_u32 s36, s36, 1
    s_cmp_lg_u32 s36, 0
    s_cbranch_scc1 Lhelp1
    s_mov_b64 s[68:69], s[18:19]
    s_mov_b32 s70, 2211840
    s_mov_b32 s71, 0x20000
Lhelp2:
    s_mul_i32 s38, s72, 9363
    s_lshr_b32 s38, s38, 16
    s_mul_i32 s39, s38, 7
    s_sub_u32 s39, s72, s39
    s_mul_i32 s39, s39, 327680
    s_lshl_b32 s38, s38, 7
    s_sub_u32 s39, s39, s38
    s_add_u32 s39, s39, 1152
    v_add_u32 v6, s39, v4
    buffer_load_dword v5, v6, s[68:71], 0 offen
    s_add_u32 s72, s72, s73
    s_sub_u32 s37, s37, 1
    s_cmp_lg_u32 s37, 0
    s_cbranch_scc1 Lhelp2
Lend:
    s_endpgm
.section .rodata,"a"
.p2align 6
.amdhsa_kernel recurrent_scan__sliding_local_dilated__moe_arch_mod__prompt_kernel
  .amdhsa_next_free_vgpr 256
  .amdhsa_next_free_sgpr 102
  .amdhsa_accum_offset 128
  .amdhsa_group_segment_fixed_size 0
  .amdhsa_kernarg_size 88
  .amdhsa_user_sgpr_count 2
  .amdhsa_user_sgpr_kernarg_segment_ptr 1
  .amdhsa_system_sgpr_workgroup_id_x 1
  .amdhsa_float_denorm_mode_32 3
.end_amdhsa_kernel
```

```asm
; @launch grid=(256,1,1) block=(512,1,1) lds=163840
.amdgcn_target "amdgcn-amd-amdhsa--gfx950"
.text
.globl recurrent_scan__sliding_local_dilated__moe_arch_mod__prompt_kernel
.p2align 8
.type recurrent_scan__sliding_local_dilated__moe_arch_mod__prompt_kernel,@function
recurrent_scan__sliding_local_dilated__moe_arch_mod__prompt_kernel:
    s_load_dwordx16 s[4:19], s[0:1], 0
    s_load_dwordx4 s[20:23], s[0:1], 64
    s_load_dwordx2 s[24:25], s[0:1], 80
    v_lshrrev_b32 v4, 6, v0
    v_and_b32 v1, 63, v0
    s_cmp_ge_u32 s2, 256
    s_cbranch_scc1 Lend
    v_readfirstlane_b32 s3, v4
    s_getpc_b64 s[36:37]
Lpc:
    s_and_b32 s38, s2, 0xf8
    v_add_u32 v5, s38, v4
    v_and_b32 v6, 1, v0
    v_lshl_add_u32 v5, v5, 1, v6
    v_lshlrev_b32 v5, 7, v5
    v_min_u32 v5, Lend-Lpc, v5
    v_mov_b32 v7, s37
    v_add_co_u32 v6, vcc, s36, v5
    s_nop 1
    v_addc_co_u32 v7, vcc, 0, v7, vcc
    global_load_dword v0, v[6:7], off
    v_lshrrev_b32 v2, 4, v1
    v_and_b32 v3, 15, v1
    v_lshlrev_b32 v12, 2, v1
    v_lshlrev_b32 v13, 4, v1
    s_mov_b32 s35, 2000000
    s_and_b32 s36, s2, 7
    s_lshr_b32 s37, s2, 3
    s_and_b32 s38, s36, 1
    s_lshr_b32 s36, s36, 1
    s_add_u32 s39, s38, 4
    s_and_b32 s26, s3, 3
    s_lshr_b32 s27, s3, 2
    s_cmp_lt_u32 s37, s39
    s_cbranch_scc1 Laux
    s_lshr_b32 s33, s36, 1
    s_and_b32 s36, s36, 1
    s_mul_i32 s36, s36, 55
    s_mul_i32 s38, s38, 28
    s_add_u32 s36, s36, s38
    s_add_u32 s36, s36, s37
    s_sub_u32 s36, s36, s39
    s_mul_i32 s32, s36, 13108
    s_lshr_b32 s32, s32, 16
    s_mul_i32 s37, s32, 5
    s_sub_u32 s36, s36, s37
    s_mul_i32 s33, s33, 5
    s_add_u32 s33, s33, s36
    s_add_u32 s42, s33, s32
    s_mul_i32 s36, s42, 13108
    s_lshr_b32 s36, s36, 16
    s_mul_i32 s36, s36, 5
    s_sub_u32 s42, s42, s36
    s_and_b32 s43, s2, 7
    s_lshl_b32 s43, s43, 2
    s_lshr_b32 s43, 0x30858530, s43
    s_and_b32 s43, s43, 15
    s_cmp_lg_u32 s3, 0
    s_cbranch_scc1 Lcomp
Lloader:
    s_setprio 3
    v_lshrrev_b32 v5, 3, v1
    v_and_b32 v6, 7, v1
    v_and_b32 v8, 1, v2
    v_lshlrev_b32 v8, 1, v8
    v_xor_b32 v8, v8, v6
    s_lshl_b32 s39, s33, 7
    v_lshl_add_u32 v50, v8, 4, s39
    v_mov_b32 v7, 3840
    v_mad_u32_u24 v28, v5, v7, v50
    v_xor_b32 v29, 64, v28
    v_add_u32 v29, 29696, v29
    v_add_u32 v30, 59392, v28
    v_add_u32 v31, 59392, v29
    v_add_u32 v32, 122880, v28
    v_add_u32 v33, 122880, v29
    v_add_u32 v34, 182272, v28
    v_add_u32 v35, 182272, v29
    s_lshl_b32 s79, s42, 2
    s_lshr_b32 s79, 0x11000, s79
    s_and_b32 s79, s79, 15
    s_add_u32 s79, s79, s43
    s_sub_u32 s38, s79, 10
    s_cmp_ge_u32 s79, 10
    s_cselect_b32 s79, s38, s79
    s_mul_i32 s68, s79, 245760
    s_lshl_b32 s78, s79, 7
    s_waitcnt lgkmcnt(0)
    s_mov_b64 s[48:49], s[6:7]
    s_mov_b32 s50, 2457600
    s_mov_b32 s51, 0x20000
    s_add_u32 s52, s6, 1280
    s_addc_u32 s53, s7, 0
    s_mov_b32 s54, 2456320
    s_mov_b32 s55, 0x20000
    s_add_u32 s56, s6, 2560
    s_addc_u32 s57, s7, 0
    s_mov_b32 s58, 2455040
    s_mov_b32 s59, 0x20000
    s_lshr_b32 s69, 10, s42
    s_and_b32 s69, s69, 1
    s_mul_i32 s70, s69, 122880
    s_sub_u32 s71, 122880, s70
    s_add_u32 s70, s70, s68
    s_add_u32 s71, s71, s68
    s_lshl_b32 s72, s69, 12
    s_xor_b32 s73, s72, 4096
    s_add_u32 m0, s72, 0
    s_mul_i32 s38, s32, 96
    s_sub_u32 s38, s38, 16
    v_add_u32 v7, s38, v5
    v_xor_b32 v9, v6, v2
    v_lshlrev_b32 v9, 4, v9
    buffer_load_dwordx4 v28, s[48:51], s70 offen lds
    v_xor_b32 v10, 64, v9
    v_mov_b32 v11, 2052
    v_mov_b32 v8, 1280
    v_add_u32 v36, 0, v7
    buffer_load_dwordx4 v29, s[48:51], s70 offen offset:1024 lds
    v_med3_i32 v36, v36, 0, v11
    v_mad_u32_u24 v36, v36, v8, v9
    v_add_u32 v36, 4096, v36
    v_add_u32 v37, 8, v7
    buffer_load_dwordx4 v30, s[48:51], s70 offen offset:2048 lds
    v_med3_i32 v37, v37, 0, v11
    v_mad_u32_u24 v37, v37, v8, v10
    v_add_u32 v37, 3072, v37
    v_add_u32 v38, 16, v7
    v_med3_i32 v38, v38, 0, v11
    buffer_load_dwordx4 v31, s[48:51], s70 offen offset:3072 lds
    v_mad_u32_u24 v38, v38, v8, v9
    v_add_u32 v38, 2048, v38
    v_add_u32 v39, 24, v7
    v_med3_i32 v39, v39, 0, v11
    s_add_u32 m0, s72, 8192
    v_mad_u32_u24 v39, v39, v8, v10
    v_add_u32 v39, 1024, v39
    v_add_u32 v40, 32, v7
    v_med3_i32 v40, v40, 0, v11
    buffer_load_dwordx4 v28, s[52:55], s70 offen lds
    v_mad_u32_u24 v40, v40, v8, v9
    v_add_u32 v40, 4096, v40
    v_add_u32 v41, 40, v7
    v_med3_i32 v41, v41, 0, v11
    v_mad_u32_u24 v41, v41, v8, v10
    buffer_load_dwordx4 v29, s[52:55], s70 offen offset:1024 lds
    v_add_u32 v41, 3072, v41
    v_add_u32 v42, 48, v7
    v_med3_i32 v42, v42, 0, v11
    v_mad_u32_u24 v42, v42, v8, v9
    buffer_load_dwordx4 v30, s[52:55], s70 offen offset:2048 lds
    v_add_u32 v42, 2048, v42
    v_add_u32 v43, 56, v7
    v_med3_i32 v43, v43, 0, v11
    v_mad_u32_u24 v43, v43, v8, v10
    buffer_load_dwordx4 v31, s[52:55], s70 offen offset:3072 lds
    v_add_u32 v43, 1024, v43
    v_add_u32 v44, 64, v7
    v_med3_i32 v44, v44, 0, v11
    v_mad_u32_u24 v44, v44, v8, v9
    v_add_u32 v44, 4096, v44
    s_add_u32 m0, s72, 16384
    v_add_u32 v45, 72, v7
    v_med3_i32 v45, v45, 0, v11
    v_mad_u32_u24 v45, v45, v8, v10
    v_add_u32 v45, 3072, v45
    buffer_load_dwordx4 v28, s[56:59], s70 offen lds
    v_add_u32 v46, 80, v7
    v_med3_i32 v46, v46, 0, v11
    v_mad_u32_u24 v46, v46, v8, v9
    v_add_u32 v46, 2048, v46
    buffer_load_dwordx4 v29, s[56:59], s70 offen offset:1024 lds
    v_add_u32 v47, 88, v7
    v_med3_i32 v47, v47, 0, v11
    v_mad_u32_u24 v47, v47, v8, v10
    v_add_u32 v47, 1024, v47
    v_add_u32 v48, 96, v7
    buffer_load_dwordx4 v30, s[56:59], s70 offen offset:2048 lds
    v_med3_i32 v48, v48, 0, v11
    v_mad_u32_u24 v48, v48, v8, v9
    v_add_u32 v48, 4096, v48
    v_add_u32 v49, 104, v7
    buffer_load_dwordx4 v31, s[56:59], s70 offen offset:3072 lds
    v_med3_i32 v49, v49, 0, v11
    v_mad_u32_u24 v49, v49, v8, v10
    v_add_u32 v49, 3072, v49
    s_sub_u32 s44, s4, 4096
    s_subb_u32 s45, s5, 0
    s_mov_b32 s46, 2625536
    s_mov_b32 s47, 0x20000
    s_mov_b32 m0, 24576
    s_nop 0
    buffer_load_dwordx4 v36, s[44:47], s78 offen lds
    buffer_load_dwordx4 v37, s[44:47], s78 offen offset:1024 lds
    buffer_load_dwordx4 v38, s[44:47], s78 offen offset:2048 lds
    buffer_load_dwordx4 v39, s[44:47], s78 offen offset:3072 lds
    s_mov_b32 m0, 28672
    s_nop 0
    buffer_load_dwordx4 v40, s[44:47], s78 offen lds
    buffer_load_dwordx4 v41, s[44:47], s78 offen offset:1024 lds
    buffer_load_dwordx4 v42, s[44:47], s78 offen offset:2048 lds
    buffer_load_dwordx4 v43, s[44:47], s78 offen offset:3072 lds
    s_mov_b32 m0, 32768
    s_nop 0
    buffer_load_dwordx4 v44, s[44:47], s78 offen lds
    buffer_load_dwordx4 v45, s[44:47], s78 offen offset:1024 lds
    buffer_load_dwordx4 v46, s[44:47], s78 offen offset:2048 lds
    buffer_load_dwordx4 v47, s[44:47], s78 offen offset:3072 lds
    s_mov_b32 m0, 36864
    s_nop 0
    buffer_load_dwordx4 v48, s[44:47], s78 offen lds
    buffer_load_dwordx4 v49, s[44:47], s78 offen offset:1024 lds
    s_add_u32 m0, s73, 0
    s_nop 0
    buffer_load_dwordx4 v28, s[48:51], s71 offen lds
    buffer_load_dwordx4 v29, s[48:51], s71 offen offset:1024 lds
    buffer_load_dwordx4 v30, s[48:51], s71 offen offset:2048 lds
    buffer_load_dwordx4 v31, s[48:51], s71 offen offset:3072 lds
    s_add_u32 m0, s73, 8192
    s_nop 0
    buffer_load_dwordx4 v28, s[52:55], s71 offen lds
    buffer_load_dwordx4 v29, s[52:55], s71 offen offset:1024 lds
    buffer_load_dwordx4 v30, s[52:55], s71 offen offset:2048 lds
    buffer_load_dwordx4 v31, s[52:55], s71 offen offset:3072 lds
    s_add_u32 m0, s73, 16384
    s_nop 0
    buffer_load_dwordx4 v28, s[56:59], s71 offen lds
    buffer_load_dwordx4 v29, s[56:59], s71 offen offset:1024 lds
    buffer_load_dwordx4 v30, s[56:59], s71 offen offset:2048 lds
    buffer_load_dwordx4 v31, s[56:59], s71 offen offset:3072 lds
    s_mov_b32 s80, 0x86542310
    s_mov_b32 s81, 0x97
    s_cmp_eq_u32 s42, 1
    s_cselect_b32 s80, 0x76453210, s80
    s_cselect_b32 s81, 0x98, s81
    s_cmp_eq_u32 s42, 2
    s_cselect_b32 s80, 0x67543120, s80
    s_cselect_b32 s81, 0x98, s81
    s_cmp_eq_u32 s42, 3
    s_cselect_b32 s80, 0x76534201, s80
    s_cselect_b32 s81, 0x89, s81
    s_cmp_eq_u32 s42, 4
    s_cselect_b32 s80, 0x75643201, s80
    s_cselect_b32 s81, 0x98, s81
    s_lshr_b64 s[80:81], s[80:81], 4
    s_and_b32 s79, s80, 15
    s_add_u32 s79, s79, s43
    s_sub_u32 s38, s79, 10
    s_cmp_ge_u32 s79, 10
    s_cselect_b32 s79, s38, s79
    s_mov_b64 s[28:29], s[24:25]
    s_mov_b32 s30, 268435456
    s_mov_b32 s31, 0x20000
    s_load_dword s34, s[28:29], 0
    s_mov_b64 s[60:61], s[8:9]
    s_mov_b32 s62, 819200
    s_mov_b32 s63, 0x20000
    v_mov_b32 v51, 157984
    v_and_b32 v66, 7, v1
    v_max_u32 v66, 1, v66
    v_lshlrev_b32 v66, 2, v66
    v_add_u32 v66, 158016, v66
    s_mul_i32 s69, s79, 245760
    s_lshl_b32 s78, s79, 7
    s_mov_b32 m0, 63616
    s_nop 0
    buffer_load_dwordx4 v36, s[44:47], s78 offen lds
    buffer_load_dwordx4 v37, s[44:47], s78 offen offset:1024 lds
    buffer_load_dwordx4 v38, s[44:47], s78 offen offset:2048 lds
    buffer_load_dwordx4 v39, s[44:47], s78 offen offset:3072 lds
    s_mov_b32 m0, 39040
    s_nop 0
    buffer_load_dwordx4 v28, s[48:51], s69 offen lds
    buffer_load_dwordx4 v29, s[48:51], s69 offen offset:1024 lds
    buffer_load_dwordx4 v30, s[48:51], s69 offen offset:2048 lds
    buffer_load_dwordx4 v31, s[48:51], s69 offen offset:3072 lds
    s_mov_b32 m0, 67712
    s_nop 0
    buffer_load_dwordx4 v40, s[44:47], s78 offen lds
    buffer_load_dwordx4 v41, s[44:47], s78 offen offset:1024 lds
    buffer_load_dwordx4 v42, s[44:47], s78 offen offset:2048 lds
    buffer_load_dwordx4 v43, s[44:47], s78 offen offset:3072 lds
    s_mov_b32 m0, 47232
    s_nop 0
    buffer_load_dwordx4 v28, s[52:55], s69 offen lds
    buffer_load_dwordx4 v29, s[52:55], s69 offen offset:1024 lds
    buffer_load_dwordx4 v30, s[52:55], s69 offen offset:2048 lds
    buffer_load_dwordx4 v31, s[52:55], s69 offen offset:3072 lds
    s_mov_b32 m0, 71808
    s_nop 0
    buffer_load_dwordx4 v44, s[44:47], s78 offen lds
    buffer_load_dwordx4 v45, s[44:47], s78 offen offset:1024 lds
    buffer_load_dwordx4 v46, s[44:47], s78 offen offset:2048 lds
    buffer_load_dwordx4 v47, s[44:47], s78 offen offset:3072 lds
    s_mov_b32 m0, 55424
    s_nop 0
    buffer_load_dwordx4 v28, s[56:59], s69 offen lds
    buffer_load_dwordx4 v29, s[56:59], s69 offen offset:1024 lds
    buffer_load_dwordx4 v30, s[56:59], s69 offen offset:2048 lds
    buffer_load_dwordx4 v31, s[56:59], s69 offen offset:3072 lds
    s_mov_b32 m0, 75904
    s_nop 0
    buffer_load_dwordx4 v48, s[44:47], s78 offen lds
    s_waitcnt vmcnt(55)
    buffer_load_dwordx4 v49, s[44:47], s78 offen offset:1024 lds
    s_mov_b32 m0, 43136
    s_nop 0
    buffer_load_dwordx4 v32, s[48:51], s69 offen lds
    buffer_load_dwordx4 v33, s[48:51], s69 offen offset:1024 lds
    buffer_load_dwordx4 v34, s[48:51], s69 offen offset:2048 lds
    buffer_load_dwordx4 v35, s[48:51], s69 offen offset:3072 lds
    s_mov_b32 m0, 51328
    s_nop 0
    buffer_load_dwordx4 v32, s[52:55], s69 offen lds
    buffer_load_dwordx4 v33, s[52:55], s69 offen offset:1024 lds
    buffer_load_dwordx4 v34, s[52:55], s69 offen offset:2048 lds
    s_waitcnt vmcnt(55)
    buffer_load_dwordx4 v35, s[52:55], s69 offen offset:3072 lds
    s_mov_b32 m0, 59520
    s_nop 0
    buffer_load_dwordx4 v32, s[56:59], s69 offen lds
    buffer_load_dwordx4 v33, s[56:59], s69 offen offset:1024 lds
    buffer_load_dwordx4 v34, s[56:59], s69 offen offset:2048 lds
    buffer_load_dwordx4 v35, s[56:59], s69 offen offset:3072 lds
    s_waitcnt vmcnt(38) lgkmcnt(0)
    s_barrier
    s_add_u32 s34, s34, 0x9e3779b8
    s_or_b32 s34, s34, 1
    s_lshr_b64 s[80:81], s[80:81], 4
    s_and_b32 s79, s80, 15
    s_add_u32 s79, s79, s43
    s_sub_u32 s38, s79, 10
    s_cmp_ge_u32 s79, 10
    s_cselect_b32 s79, s38, s79
    s_mul_i32 s70, s79, 245760
    s_lshl_b32 s78, s79, 7
    s_mov_b32 m0, 102656
    s_nop 0
    buffer_load_dwordx4 v36, s[44:47], s78 offen lds
    buffer_load_dwordx4 v37, s[44:47], s78 offen offset:1024 lds
    buffer_load_dwordx4 v38, s[44:47], s78 offen offset:2048 lds
    buffer_load_dwordx4 v39, s[44:47], s78 offen offset:3072 lds
    s_mov_b32 m0, 78080
    s_nop 0
    buffer_load_dwordx4 v28, s[48:51], s70 offen lds
    buffer_load_dwordx4 v29, s[48:51], s70 offen offset:1024 lds
    buffer_load_dwordx4 v30, s[48:51], s70 offen offset:2048 lds
    buffer_load_dwordx4 v31, s[48:51], s70 offen offset:3072 lds
    s_mov_b32 m0, 106752
    s_nop 0
    buffer_load_dwordx4 v40, s[44:47], s78 offen lds
    buffer_load_dwordx4 v41, s[44:47], s78 offen offset:1024 lds
    buffer_load_dwordx4 v42, s[44:47], s78 offen offset:2048 lds
    buffer_load_dwordx4 v43, s[44:47], s78 offen offset:3072 lds
    s_mov_b32 m0, 86272
    s_nop 0
    buffer_load_dwordx4 v28, s[52:55], s70 offen lds
    buffer_load_dwordx4 v29, s[52:55], s70 offen offset:1024 lds
    buffer_load_dwordx4 v30, s[52:55], s70 offen offset:2048 lds
    buffer_load_dwordx4 v31, s[52:55], s70 offen offset:3072 lds
    s_mov_b32 m0, 110848
    s_nop 0
    buffer_load_dwordx4 v44, s[44:47], s78 offen lds
    buffer_load_dwordx4 v45, s[44:47], s78 offen offset:1024 lds
    buffer_load_dwordx4 v46, s[44:47], s78 offen offset:2048 lds
    buffer_load_dwordx4 v47, s[44:47], s78 offen offset:3072 lds
    s_mov_b32 m0, 94464
    s_nop 0
    buffer_load_dwordx4 v28, s[56:59], s70 offen lds
    buffer_load_dwordx4 v29, s[56:59], s70 offen offset:1024 lds
    buffer_load_dwordx4 v30, s[56:59], s70 offen offset:2048 lds
    buffer_load_dwordx4 v31, s[56:59], s70 offen offset:3072 lds
    s_mov_b32 m0, 114944
    s_nop 0
    buffer_load_dwordx4 v48, s[44:47], s78 offen lds
    s_waitcnt vmcnt(55)
    buffer_load_dwordx4 v49, s[44:47], s78 offen offset:1024 lds
    s_mov_b32 m0, 82176
    s_nop 0
    buffer_load_dwordx4 v32, s[48:51], s70 offen lds
    buffer_load_dwordx4 v33, s[48:51], s70 offen offset:1024 lds
    buffer_load_dwordx4 v34, s[48:51], s70 offen offset:2048 lds
    buffer_load_dwordx4 v35, s[48:51], s70 offen offset:3072 lds
    s_mov_b32 m0, 90368
    s_nop 0
    buffer_load_dwordx4 v32, s[52:55], s70 offen lds
    buffer_load_dwordx4 v33, s[52:55], s70 offen offset:1024 lds
    buffer_load_dwordx4 v34, s[52:55], s70 offen offset:2048 lds
    s_waitcnt vmcnt(55)
    buffer_load_dwordx4 v35, s[52:55], s70 offen offset:3072 lds
    s_mov_b32 m0, 98560
    s_nop 0
    buffer_load_dwordx4 v32, s[56:59], s70 offen lds
    buffer_load_dwordx4 v33, s[56:59], s70 offen offset:1024 lds
    buffer_load_dwordx4 v34, s[56:59], s70 offen offset:2048 lds
    buffer_load_dwordx4 v35, s[56:59], s70 offen offset:3072 lds
    s_waitcnt vmcnt(38) lgkmcnt(0)
    s_barrier
    s_lshr_b64 s[80:81], s[80:81], 4
    s_and_b32 s79, s80, 15
    s_add_u32 s79, s79, s43
    s_sub_u32 s38, s79, 10
    s_cmp_ge_u32 s79, 10
    s_cselect_b32 s79, s38, s79
    s_mul_i32 s71, s79, 245760
    s_lshl_b32 s78, s79, 7
    s_mov_b32 m0, 141696
    s_nop 0
    buffer_load_dwordx4 v36, s[44:47], s78 offen lds
    buffer_load_dwordx4 v37, s[44:47], s78 offen offset:1024 lds
    buffer_load_dwordx4 v38, s[44:47], s78 offen offset:2048 lds
    buffer_load_dwordx4 v39, s[44:47], s78 offen offset:3072 lds
    s_mov_b32 m0, 117120
    s_nop 0
    buffer_load_dwordx4 v28, s[48:51], s71 offen lds
    buffer_load_dwordx4 v29, s[48:51], s71 offen offset:1024 lds
    buffer_load_dwordx4 v30, s[48:51], s71 offen offset:2048 lds
    buffer_load_dwordx4 v31, s[48:51], s71 offen offset:3072 lds
    s_mov_b32 m0, 145792
    s_nop 0
    buffer_load_dwordx4 v40, s[44:47], s78 offen lds
    buffer_load_dwordx4 v41, s[44:47], s78 offen offset:1024 lds
    buffer_load_dwordx4 v42, s[44:47], s78 offen offset:2048 lds
    buffer_load_dwordx4 v43, s[44:47], s78 offen offset:3072 lds
    s_mov_b32 m0, 125312
    s_nop 0
    buffer_load_dwordx4 v28, s[52:55], s71 offen lds
    buffer_load_dwordx4 v29, s[52:55], s71 offen offset:1024 lds
    buffer_load_dwordx4 v30, s[52:55], s71 offen offset:2048 lds
    buffer_load_dwordx4 v31, s[52:55], s71 offen offset:3072 lds
    s_mov_b32 m0, 149888
    s_nop 0
    buffer_load_dwordx4 v44, s[44:47], s78 offen lds
    buffer_load_dwordx4 v45, s[44:47], s78 offen offset:1024 lds
    buffer_load_dwordx4 v46, s[44:47], s78 offen offset:2048 lds
    buffer_load_dwordx4 v47, s[44:47], s78 offen offset:3072 lds
    s_mov_b32 m0, 133504
    s_nop 0
    buffer_load_dwordx4 v28, s[56:59], s71 offen lds
    buffer_load_dwordx4 v29, s[56:59], s71 offen offset:1024 lds
    buffer_load_dwordx4 v30, s[56:59], s71 offen offset:2048 lds
    buffer_load_dwordx4 v31, s[56:59], s71 offen offset:3072 lds
    s_mov_b32 m0, 153984
    s_nop 0
    buffer_load_dwordx4 v48, s[44:47], s78 offen lds
    s_waitcnt vmcnt(55)
    buffer_load_dwordx4 v49, s[44:47], s78 offen offset:1024 lds
    s_mov_b32 m0, 121216
    s_nop 0
    buffer_load_dwordx4 v32, s[48:51], s71 offen lds
    buffer_load_dwordx4 v33, s[48:51], s71 offen offset:1024 lds
    buffer_load_dwordx4 v34, s[48:51], s71 offen offset:2048 lds
    buffer_load_dwordx4 v35, s[48:51], s71 offen offset:3072 lds
    s_mov_b32 m0, 129408
    s_nop 0
    buffer_load_dwordx4 v32, s[52:55], s71 offen lds
    buffer_load_dwordx4 v33, s[52:55], s71 offen offset:1024 lds
    buffer_load_dwordx4 v34, s[52:55], s71 offen offset:2048 lds
    s_waitcnt vmcnt(55)
    buffer_load_dwordx4 v35, s[52:55], s71 offen offset:3072 lds
    s_mov_b32 m0, 137600
    s_nop 0
    buffer_load_dwordx4 v32, s[56:59], s71 offen lds
    buffer_load_dwordx4 v33, s[56:59], s71 offen offset:1024 lds
    buffer_load_dwordx4 v34, s[56:59], s71 offen offset:2048 lds
    buffer_load_dwordx4 v35, s[56:59], s71 offen offset:3072 lds
    s_waitcnt vmcnt(38) lgkmcnt(0)
    s_barrier
    s_lshr_b64 s[80:81], s[80:81], 4
    s_and_b32 s79, s80, 15
    s_add_u32 s79, s79, s43
    s_sub_u32 s38, s79, 10
    s_cmp_ge_u32 s79, 10
    s_cselect_b32 s79, s38, s79
    s_mul_i32 s72, s79, 245760
    s_lshl_b32 s78, s79, 7
    s_mov_b32 m0, 24576
    s_nop 0
    buffer_load_dwordx4 v36, s[44:47], s78 offen lds
    buffer_load_dwordx4 v37, s[44:47], s78 offen offset:1024 lds
    buffer_load_dwordx4 v38, s[44:47], s78 offen offset:2048 lds
    buffer_load_dwordx4 v39, s[44:47], s78 offen offset:3072 lds
    s_mov_b32 m0, 0
    s_nop 0
    buffer_load_dwordx4 v28, s[48:51], s72 offen lds
    buffer_load_dwordx4 v29, s[48:51], s72 offen offset:1024 lds
    buffer_load_dwordx4 v30, s[48:51], s72 offen offset:2048 lds
    buffer_load_dwordx4 v31, s[48:51], s72 offen offset:3072 lds
    s_mov_b32 m0, 28672
    s_nop 0
    buffer_load_dwordx4 v40, s[44:47], s78 offen lds
    buffer_load_dwordx4 v41, s[44:47], s78 offen offset:1024 lds
    buffer_load_dwordx4 v42, s[44:47], s78 offen offset:2048 lds
    buffer_load_dwordx4 v43, s[44:47], s78 offen offset:3072 lds
    s_mov_b32 m0, 8192
    s_nop 0
    buffer_load_dwordx4 v28, s[52:55], s72 offen lds
    buffer_load_dwordx4 v29, s[52:55], s72 offen offset:1024 lds
    buffer_load_dwordx4 v30, s[52:55], s72 offen offset:2048 lds
    buffer_load_dwordx4 v31, s[52:55], s72 offen offset:3072 lds
    s_mov_b32 m0, 32768
    s_nop 0
    buffer_load_dwordx4 v44, s[44:47], s78 offen lds
    buffer_load_dwordx4 v45, s[44:47], s78 offen offset:1024 lds
    buffer_load_dwordx4 v46, s[44:47], s78 offen offset:2048 lds
    buffer_load_dwordx4 v47, s[44:47], s78 offen offset:3072 lds
    s_mov_b32 m0, 16384
    s_nop 0
    buffer_load_dwordx4 v28, s[56:59], s72 offen lds
    buffer_load_dwordx4 v29, s[56:59], s72 offen offset:1024 lds
    buffer_load_dwordx4 v30, s[56:59], s72 offen offset:2048 lds
    buffer_load_dwordx4 v31, s[56:59], s72 offen offset:3072 lds
    s_mov_b32 m0, 36864
    s_nop 0
    buffer_load_dwordx4 v48, s[44:47], s78 offen lds
    s_waitcnt vmcnt(55)
    buffer_load_dwordx4 v49, s[44:47], s78 offen offset:1024 lds
    s_mov_b32 m0, 4096
    s_nop 0
    buffer_load_dwordx4 v32, s[48:51], s72 offen lds
    buffer_load_dwordx4 v33, s[48:51], s72 offen offset:1024 lds
    buffer_load_dwordx4 v34, s[48:51], s72 offen offset:2048 lds
    buffer_load_dwordx4 v35, s[48:51], s72 offen offset:3072 lds
    s_mov_b32 m0, 12288
    s_nop 0
    buffer_load_dwordx4 v32, s[52:55], s72 offen lds
    buffer_load_dwordx4 v33, s[52:55], s72 offen offset:1024 lds
    buffer_load_dwordx4 v34, s[52:55], s72 offen offset:2048 lds
    s_waitcnt vmcnt(55)
    buffer_load_dwordx4 v35, s[52:55], s72 offen offset:3072 lds
    s_mov_b32 m0, 20480
    s_nop 0
    buffer_load_dwordx4 v32, s[56:59], s72 offen lds
    buffer_load_dwordx4 v33, s[56:59], s72 offen offset:1024 lds
    buffer_load_dwordx4 v34, s[56:59], s72 offen offset:2048 lds
    buffer_load_dwordx4 v35, s[56:59], s72 offen offset:3072 lds
    s_waitcnt vmcnt(38) lgkmcnt(0)
    s_barrier
    s_lshr_b64 s[80:81], s[80:81], 4
    s_and_b32 s79, s80, 15
    s_add_u32 s79, s79, s43
    s_sub_u32 s38, s79, 10
    s_cmp_ge_u32 s79, 10
    s_cselect_b32 s79, s38, s79
    s_mul_i32 s73, s79, 245760
    s_lshl_b32 s78, s79, 7
    s_mov_b32 m0, 63616
    s_nop 0
    buffer_load_dwordx4 v36, s[44:47], s78 offen lds
    buffer_load_dwordx4 v37, s[44:47], s78 offen offset:1024 lds
    buffer_load_dwordx4 v38, s[44:47], s78 offen offset:2048 lds
    buffer_load_dwordx4 v39, s[44:47], s78 offen offset:3072 lds
    s_mov_b32 m0, 39040
    s_nop 0
    buffer_load_dwordx4 v28, s[48:51], s73 offen lds
    buffer_load_dwordx4 v29, s[48:51], s73 offen offset:1024 lds
    buffer_load_dwordx4 v30, s[48:51], s73 offen offset:2048 lds
    buffer_load_dwordx4 v31, s[48:51], s73 offen offset:3072 lds
    s_mov_b32 m0, 67712
    s_nop 0
    buffer_load_dwordx4 v40, s[44:47], s78 offen lds
    buffer_load_dwordx4 v41, s[44:47], s78 offen offset:1024 lds
    buffer_load_dwordx4 v42, s[44:47], s78 offen offset:2048 lds
    buffer_load_dwordx4 v43, s[44:47], s78 offen offset:3072 lds
    s_mov_b32 m0, 47232
    s_nop 0
    buffer_load_dwordx4 v28, s[52:55], s73 offen lds
    buffer_load_dwordx4 v29, s[52:55], s73 offen offset:1024 lds
    buffer_load_dwordx4 v30, s[52:55], s73 offen offset:2048 lds
    buffer_load_dwordx4 v31, s[52:55], s73 offen offset:3072 lds
    s_mov_b32 m0, 71808
    s_nop 0
    buffer_load_dwordx4 v44, s[44:47], s78 offen lds
    buffer_load_dwordx4 v45, s[44:47], s78 offen offset:1024 lds
    buffer_load_dwordx4 v46, s[44:47], s78 offen offset:2048 lds
    buffer_load_dwordx4 v47, s[44:47], s78 offen offset:3072 lds
    s_mov_b32 m0, 55424
    s_nop 0
    buffer_load_dwordx4 v28, s[56:59], s73 offen lds
    buffer_load_dwordx4 v29, s[56:59], s73 offen offset:1024 lds
    buffer_load_dwordx4 v30, s[56:59], s73 offen offset:2048 lds
    buffer_load_dwordx4 v31, s[56:59], s73 offen offset:3072 lds
    s_mov_b32 m0, 75904
    s_nop 0
    buffer_load_dwordx4 v48, s[44:47], s78 offen lds
    s_waitcnt vmcnt(55)
    buffer_load_dwordx4 v49, s[44:47], s78 offen offset:1024 lds
    s_mov_b32 m0, 43136
    s_nop 0
    buffer_load_dwordx4 v32, s[48:51], s73 offen lds
    buffer_load_dwordx4 v33, s[48:51], s73 offen offset:1024 lds
    buffer_load_dwordx4 v34, s[48:51], s73 offen offset:2048 lds
    buffer_load_dwordx4 v35, s[48:51], s73 offen offset:3072 lds
    s_mov_b32 m0, 51328
    s_nop 0
    buffer_load_dwordx4 v32, s[52:55], s73 offen lds
    buffer_load_dwordx4 v33, s[52:55], s73 offen offset:1024 lds
    buffer_load_dwordx4 v34, s[52:55], s73 offen offset:2048 lds
    s_waitcnt vmcnt(55)
    buffer_load_dwordx4 v35, s[52:55], s73 offen offset:3072 lds
    s_mov_b32 m0, 59520
    s_nop 0
    buffer_load_dwordx4 v32, s[56:59], s73 offen lds
    buffer_load_dwordx4 v33, s[56:59], s73 offen offset:1024 lds
    buffer_load_dwordx4 v34, s[56:59], s73 offen offset:2048 lds
    buffer_load_dwordx4 v35, s[56:59], s73 offen offset:3072 lds
    s_waitcnt vmcnt(38) lgkmcnt(0)
    s_barrier
    s_lshr_b64 s[80:81], s[80:81], 4
    s_and_b32 s79, s80, 15
    s_add_u32 s79, s79, s43
    s_sub_u32 s38, s79, 10
    s_cmp_ge_u32 s79, 10
    s_cselect_b32 s79, s38, s79
    s_mul_i32 s74, s79, 245760
    s_lshl_b32 s78, s79, 7
    s_mov_b32 m0, 102656
    s_nop 0
    buffer_load_dwordx4 v36, s[44:47], s78 offen lds
    buffer_load_dwordx4 v37, s[44:47], s78 offen offset:1024 lds
    buffer_load_dwordx4 v38, s[44:47], s78 offen offset:2048 lds
    buffer_load_dwordx4 v39, s[44:47], s78 offen offset:3072 lds
    s_mov_b32 m0, 78080
    s_nop 0
    buffer_load_dwordx4 v28, s[48:51], s74 offen lds
    buffer_load_dwordx4 v29, s[48:51], s74 offen offset:1024 lds
    buffer_load_dwordx4 v30, s[48:51], s74 offen offset:2048 lds
    buffer_load_dwordx4 v31, s[48:51], s74 offen offset:3072 lds
    s_mov_b32 m0, 106752
    s_nop 0
    buffer_load_dwordx4 v40, s[44:47], s78 offen lds
    buffer_load_dwordx4 v41, s[44:47], s78 offen offset:1024 lds
    buffer_load_dwordx4 v42, s[44:47], s78 offen offset:2048 lds
    buffer_load_dwordx4 v43, s[44:47], s78 offen offset:3072 lds
    s_mov_b32 m0, 86272
    s_nop 0
    buffer_load_dwordx4 v28, s[52:55], s74 offen lds
    buffer_load_dwordx4 v29, s[52:55], s74 offen offset:1024 lds
    buffer_load_dwordx4 v30, s[52:55], s74 offen offset:2048 lds
    buffer_load_dwordx4 v31, s[52:55], s74 offen offset:3072 lds
    s_mov_b32 m0, 110848
    s_nop 0
    buffer_load_dwordx4 v44, s[44:47], s78 offen lds
    buffer_load_dwordx4 v45, s[44:47], s78 offen offset:1024 lds
    buffer_load_dwordx4 v46, s[44:47], s78 offen offset:2048 lds
    buffer_load_dwordx4 v47, s[44:47], s78 offen offset:3072 lds
    s_mov_b32 m0, 82176
    s_nop 0
    buffer_load_dwordx4 v32, s[48:51], s74 offen lds
    buffer_load_dwordx4 v33, s[48:51], s74 offen offset:1024 lds
    buffer_load_dwordx4 v34, s[48:51], s74 offen offset:2048 lds
    buffer_load_dwordx4 v35, s[48:51], s74 offen offset:3072 lds
    s_mov_b32 m0, 114944
    s_nop 0
    buffer_load_dwordx4 v48, s[44:47], s78 offen lds
    s_waitcnt vmcnt(55)
    buffer_load_dwordx4 v49, s[44:47], s78 offen offset:1024 lds
    s_mov_b32 m0, 90368
    s_nop 0
    buffer_load_dwordx4 v32, s[52:55], s74 offen lds
    buffer_load_dwordx4 v33, s[52:55], s74 offen offset:1024 lds
    buffer_load_dwordx4 v34, s[52:55], s74 offen offset:2048 lds
    buffer_load_dwordx4 v35, s[52:55], s74 offen offset:3072 lds
    s_waitcnt vmcnt(30) lgkmcnt(0)
    s_barrier
    s_lshr_b64 s[80:81], s[80:81], 4
    s_and_b32 s79, s80, 15
    s_add_u32 s79, s79, s43
    s_sub_u32 s38, s79, 10
    s_cmp_ge_u32 s79, 10
    s_cselect_b32 s79, s38, s79
    s_mul_i32 s75, s79, 245760
    s_lshl_b32 s78, s79, 7
    s_mov_b32 m0, 141696
    s_nop 0
    buffer_load_dwordx4 v36, s[44:47], s78 offen lds
    buffer_load_dwordx4 v37, s[44:47], s78 offen offset:1024 lds
    buffer_load_dwordx4 v38, s[44:47], s78 offen offset:2048 lds
    buffer_load_dwordx4 v39, s[44:47], s78 offen offset:3072 lds
    s_mov_b32 m0, 117120
    s_nop 0
    buffer_load_dwordx4 v28, s[48:51], s75 offen lds
    buffer_load_dwordx4 v29, s[48:51], s75 offen offset:1024 lds
    buffer_load_dwordx4 v30, s[48:51], s75 offen offset:2048 lds
    buffer_load_dwordx4 v31, s[48:51], s75 offen offset:3072 lds
    s_mov_b32 m0, 145792
    s_nop 0
    buffer_load_dwordx4 v40, s[44:47], s78 offen lds
    buffer_load_dwordx4 v41, s[44:47], s78 offen offset:1024 lds
    buffer_load_dwordx4 v42, s[44:47], s78 offen offset:2048 lds
    buffer_load_dwordx4 v43, s[44:47], s78 offen offset:3072 lds
    s_mov_b32 m0, 125312
    s_nop 0
    buffer_load_dwordx4 v28, s[52:55], s75 offen lds
    buffer_load_dwordx4 v29, s[52:55], s75 offen offset:1024 lds
    buffer_load_dwordx4 v30, s[52:55], s75 offen offset:2048 lds
    buffer_load_dwordx4 v31, s[52:55], s75 offen offset:3072 lds
    s_mov_b32 m0, 149888
    s_nop 0
    buffer_load_dwordx4 v44, s[44:47], s78 offen lds
    buffer_load_dwordx4 v45, s[44:47], s78 offen offset:1024 lds
    buffer_load_dwordx4 v46, s[44:47], s78 offen offset:2048 lds
    buffer_load_dwordx4 v47, s[44:47], s78 offen offset:3072 lds
    s_mov_b32 m0, 121216
    s_nop 0
    buffer_load_dwordx4 v32, s[48:51], s75 offen lds
    buffer_load_dwordx4 v33, s[48:51], s75 offen offset:1024 lds
    buffer_load_dwordx4 v34, s[48:51], s75 offen offset:2048 lds
    buffer_load_dwordx4 v35, s[48:51], s75 offen offset:3072 lds
    s_mov_b32 m0, 153984
    s_nop 0
    buffer_load_dwordx4 v48, s[44:47], s78 offen lds
    buffer_load_dwordx4 v49, s[44:47], s78 offen offset:1024 lds
    s_mov_b32 m0, 129408
    s_nop 0
    buffer_load_dwordx4 v32, s[52:55], s75 offen lds
    buffer_load_dwordx4 v33, s[52:55], s75 offen offset:1024 lds
    buffer_load_dwordx4 v34, s[52:55], s75 offen offset:2048 lds
    buffer_load_dwordx4 v35, s[52:55], s75 offen offset:3072 lds
    s_waitcnt vmcnt(30) lgkmcnt(0)
    s_barrier
    s_lshr_b64 s[80:81], s[80:81], 4
    s_and_b32 s79, s80, 15
    s_add_u32 s79, s79, s43
    s_sub_u32 s38, s79, 10
    s_cmp_ge_u32 s79, 10
    s_cselect_b32 s79, s38, s79
    s_mul_i32 s76, s79, 245760
    s_lshl_b32 s78, s79, 7
    s_mov_b32 m0, 24576
    s_nop 0
    buffer_load_dwordx4 v36, s[44:47], s78 offen lds
    buffer_load_dwordx4 v37, s[44:47], s78 offen offset:1024 lds
    buffer_load_dwordx4 v38, s[44:47], s78 offen offset:2048 lds
    buffer_load_dwordx4 v39, s[44:47], s78 offen offset:3072 lds
    s_mov_b32 m0, 0
    s_nop 0
    buffer_load_dwordx4 v28, s[48:51], s76 offen lds
    buffer_load_dwordx4 v29, s[48:51], s76 offen offset:1024 lds
    buffer_load_dwordx4 v30, s[48:51], s76 offen offset:2048 lds
    buffer_load_dwordx4 v31, s[48:51], s76 offen offset:3072 lds
    s_mov_b32 m0, 28672
    s_nop 0
    buffer_load_dwordx4 v40, s[44:47], s78 offen lds
    buffer_load_dwordx4 v41, s[44:47], s78 offen offset:1024 lds
    buffer_load_dwordx4 v42, s[44:47], s78 offen offset:2048 lds
    buffer_load_dwordx4 v43, s[44:47], s78 offen offset:3072 lds
    s_mov_b32 m0, 8192
    s_nop 0
    buffer_load_dwordx4 v28, s[52:55], s76 offen lds
    buffer_load_dwordx4 v29, s[52:55], s76 offen offset:1024 lds
    buffer_load_dwordx4 v30, s[52:55], s76 offen offset:2048 lds
    buffer_load_dwordx4 v31, s[52:55], s76 offen offset:3072 lds
    s_mov_b32 m0, 32768
    s_nop 0
    buffer_load_dwordx4 v44, s[44:47], s78 offen lds
    buffer_load_dwordx4 v45, s[44:47], s78 offen offset:1024 lds
    buffer_load_dwordx4 v46, s[44:47], s78 offen offset:2048 lds
    buffer_load_dwordx4 v47, s[44:47], s78 offen offset:3072 lds
    s_mov_b32 m0, 4096
    s_nop 0
    buffer_load_dwordx4 v32, s[48:51], s76 offen lds
    buffer_load_dwordx4 v33, s[48:51], s76 offen offset:1024 lds
    buffer_load_dwordx4 v34, s[48:51], s76 offen offset:2048 lds
    buffer_load_dwordx4 v35, s[48:51], s76 offen offset:3072 lds
    s_mov_b32 m0, 36864
    s_nop 0
    buffer_load_dwordx4 v48, s[44:47], s78 offen lds
    buffer_load_dwordx4 v49, s[44:47], s78 offen offset:1024 lds
    s_mov_b32 m0, 12288
    s_nop 0
    buffer_load_dwordx4 v32, s[52:55], s76 offen lds
    buffer_load_dwordx4 v33, s[52:55], s76 offen offset:1024 lds
    buffer_load_dwordx4 v34, s[52:55], s76 offen offset:2048 lds
    buffer_load_dwordx4 v35, s[52:55], s76 offen offset:3072 lds
    s_waitcnt vmcnt(30) lgkmcnt(0)
    s_barrier
    s_lshr_b64 s[80:81], s[80:81], 4
    s_and_b32 s79, s80, 15
    s_add_u32 s79, s79, s43
    s_sub_u32 s38, s79, 10
    s_cmp_ge_u32 s79, 10
    s_cselect_b32 s79, s38, s79
    s_mul_i32 s77, s79, 245760
    s_lshl_b32 s78, s79, 7
    s_mov_b32 m0, 63616
    s_nop 0
    buffer_load_dwordx4 v36, s[44:47], s78 offen lds
    buffer_load_dwordx4 v37, s[44:47], s78 offen offset:1024 lds
    buffer_load_dwordx4 v38, s[44:47], s78 offen offset:2048 lds
    buffer_load_dwordx4 v39, s[44:47], s78 offen offset:3072 lds
    s_mov_b32 m0, 39040
    s_nop 0
    buffer_load_dwordx4 v28, s[48:51], s77 offen lds
    buffer_load_dwordx4 v29, s[48:51], s77 offen offset:1024 lds
    buffer_load_dwordx4 v30, s[48:51], s77 offen offset:2048 lds
    buffer_load_dwordx4 v31, s[48:51], s77 offen offset:3072 lds
    s_mov_b32 m0, 67712
    s_nop 0
    buffer_load_dwordx4 v40, s[44:47], s78 offen lds
    buffer_load_dwordx4 v41, s[44:47], s78 offen offset:1024 lds
    buffer_load_dwordx4 v42, s[44:47], s78 offen offset:2048 lds
    buffer_load_dwordx4 v43, s[44:47], s78 offen offset:3072 lds
    s_mov_b32 m0, 47232
    s_nop 0
    buffer_load_dwordx4 v28, s[52:55], s77 offen lds
    buffer_load_dwordx4 v29, s[52:55], s77 offen offset:1024 lds
    buffer_load_dwordx4 v30, s[52:55], s77 offen offset:2048 lds
    buffer_load_dwordx4 v31, s[52:55], s77 offen offset:3072 lds
    s_mov_b32 m0, 71808
    s_nop 0
    buffer_load_dwordx4 v44, s[44:47], s78 offen lds
    buffer_load_dwordx4 v45, s[44:47], s78 offen offset:1024 lds
    buffer_load_dwordx4 v46, s[44:47], s78 offen offset:2048 lds
    buffer_load_dwordx4 v47, s[44:47], s78 offen offset:3072 lds
    s_mov_b32 m0, 43136
    s_nop 0
    buffer_load_dwordx4 v32, s[48:51], s77 offen lds
    buffer_load_dwordx4 v33, s[48:51], s77 offen offset:1024 lds
    buffer_load_dwordx4 v34, s[48:51], s77 offen offset:2048 lds
    buffer_load_dwordx4 v35, s[48:51], s77 offen offset:3072 lds
    s_mov_b32 m0, 75904
    s_nop 0
    buffer_load_dwordx4 v48, s[44:47], s78 offen lds
    buffer_load_dwordx4 v49, s[44:47], s78 offen offset:1024 lds
    s_mov_b32 m0, 51328
    s_nop 0
    buffer_load_dwordx4 v32, s[52:55], s77 offen lds
    buffer_load_dwordx4 v33, s[52:55], s77 offen offset:1024 lds
    buffer_load_dwordx4 v34, s[52:55], s77 offen offset:2048 lds
    buffer_load_dwordx4 v35, s[52:55], s77 offen offset:3072 lds
    s_waitcnt vmcnt(30) lgkmcnt(0)
    s_barrier
    s_lshr_b64 s[80:81], s[80:81], 4
    s_and_b32 s79, s80, 15
    s_add_u32 s79, s79, s43
    s_sub_u32 s38, s79, 10
    s_cmp_ge_u32 s79, 10
    s_cselect_b32 s79, s38, s79
    s_mov_b32 m0, 94464
    s_nop 0
    buffer_load_dwordx4 v28, s[56:59], s74 offen lds
    buffer_load_dwordx4 v29, s[56:59], s74 offen offset:1024 lds
    buffer_load_dwordx4 v30, s[56:59], s74 offen offset:2048 lds
    buffer_load_dwordx4 v31, s[56:59], s74 offen offset:3072 lds
    s_mov_b32 m0, 98560
    s_nop 0
    buffer_load_dwordx4 v32, s[56:59], s74 offen lds
    buffer_load_dwordx4 v33, s[56:59], s74 offen offset:1024 lds
    buffer_load_dwordx4 v34, s[56:59], s74 offen offset:2048 lds
    buffer_load_dwordx4 v35, s[56:59], s74 offen offset:3072 lds
    s_mov_b32 m0, 133504
    s_nop 0
    buffer_load_dwordx4 v28, s[56:59], s75 offen lds
    buffer_load_dwordx4 v29, s[56:59], s75 offen offset:1024 lds
    buffer_load_dwordx4 v30, s[56:59], s75 offen offset:2048 lds
    buffer_load_dwordx4 v31, s[56:59], s75 offen offset:3072 lds
    s_waitcnt vmcnt(12) lgkmcnt(0)
    s_barrier
    s_mov_b32 m0, 137600
    s_nop 0
    buffer_load_dwordx4 v32, s[56:59], s75 offen lds
    buffer_load_dwordx4 v33, s[56:59], s75 offen offset:1024 lds
    buffer_load_dwordx4 v34, s[56:59], s75 offen offset:2048 lds
    buffer_load_dwordx4 v35, s[56:59], s75 offen offset:3072 lds
    s_mov_b32 m0, 16384
    s_nop 0
    buffer_load_dwordx4 v28, s[56:59], s76 offen lds
    buffer_load_dwordx4 v29, s[56:59], s76 offen offset:1024 lds
    buffer_load_dwordx4 v30, s[56:59], s76 offen offset:2048 lds
    buffer_load_dwordx4 v31, s[56:59], s76 offen offset:3072 lds
    s_mov_b32 m0, 20480
    s_nop 0
    buffer_load_dwordx4 v32, s[56:59], s76 offen lds
    buffer_load_dwordx4 v33, s[56:59], s76 offen offset:1024 lds
    buffer_load_dwordx4 v34, s[56:59], s76 offen offset:2048 lds
    buffer_load_dwordx4 v35, s[56:59], s76 offen offset:3072 lds
    s_mov_b32 m0, 55424
    s_nop 0
    buffer_load_dwordx4 v28, s[56:59], s77 offen lds
    buffer_load_dwordx4 v29, s[56:59], s77 offen offset:1024 lds
    buffer_load_dwordx4 v30, s[56:59], s77 offen offset:2048 lds
    buffer_load_dwordx4 v31, s[56:59], s77 offen offset:3072 lds
    s_mov_b32 m0, 59520
    s_nop 0
    buffer_load_dwordx4 v32, s[56:59], s77 offen lds
    buffer_load_dwordx4 v33, s[56:59], s77 offen offset:1024 lds
    buffer_load_dwordx4 v34, s[56:59], s77 offen offset:2048 lds
    buffer_load_dwordx4 v35, s[56:59], s77 offen offset:3072 lds
    s_mov_b32 s10, 20480
    v_lshrrev_b32 v52, 5, v1
    v_lshlrev_b32 v52, 3, v52
    v_add_u32 v56, 8, v52
    v_mul_u32_u24 v52, 3, v52
    v_add_u32 v53, 2, v52
    v_add_u32 v54, 4, v52
    v_add_u32 v55, 6, v52
    v_add_u32 v57, 2, v56
    v_add_u32 v58, 4, v56
    v_add_u32 v59, 6, v56
    v_and_b32 v7, 3, v5
    v_mul_u32_u24 v7, 1280, v7
    v_add_u32 v60, v7, v50
    v_xor_b32 v61, 64, v60
    v_add_u32 v61, 4096, v61
    v_add_u32 v62, 8192, v60
    v_add_u32 v63, 8192, v61
    s_mov_b32 s42, 0
    s_mov_b32 s5, 0xbfe10856
    s_mov_b32 s6, 0xaff80255
    s_mov_b32 s7, 0xabfe4015
    s_mov_b32 s8, 0xaa7fd005
    s_mov_b32 s9, 0x6adfb401
    s_cmp_eq_u32 s42, 1
    s_cselect_b32 s5, 0xabfe4015, s5
    s_cselect_b32 s6, 0xaa7fd005, s6
    s_cselect_b32 s7, 0x6adfb401, s7
    s_cselect_b32 s8, 0xbfe10856, s8
    s_cselect_b32 s9, 0xaff80255, s9
    s_cmp_eq_u32 s42, 2
    s_cselect_b32 s5, 0x6adfb401, s5
    s_cselect_b32 s6, 0xbfe10856, s6
    s_cselect_b32 s7, 0xaff80255, s7
    s_cselect_b32 s8, 0xabfe4015, s8
    s_cselect_b32 s9, 0xaa7fd005, s9
    s_cmp_eq_u32 s42, 3
    s_cselect_b32 s5, 0xaff80255, s5
    s_cselect_b32 s6, 0xabfe4015, s6
    s_cselect_b32 s7, 0xaa7fd005, s7
    s_cselect_b32 s8, 0x6adfb401, s8
    s_cselect_b32 s9, 0xbfe10856, s9
    s_cmp_eq_u32 s42, 4
    s_cselect_b32 s5, 0xaa7fd005, s5
    s_cselect_b32 s6, 0x6adfb401, s6
    s_cselect_b32 s7, 0xbfe10856, s7
    s_cselect_b32 s8, 0xaff80255, s8
    s_cselect_b32 s9, 0xabfe4015, s9
    s_mul_i32 s4, s42, 163840
    s_mov_b32 m0, 0
    s_mov_b32 s4, 0
    v_bfe_u32 v64, s5, v52, 2
    v_mad_u32_u24 v64, v64, s10, v60
    buffer_load_dwordx4 v64, s[60:63], s4 offen lds
    v_bfe_u32 v65, s5, v53, 2
    v_mad_u32_u24 v65, v65, s10, v61
    buffer_load_dwordx4 v65, s[60:63], s4 offen offset:1024 lds
    v_bfe_u32 v64, s5, v54, 2
    v_mad_u32_u24 v64, v64, s10, v62
    buffer_load_dwordx4 v64, s[60:63], s4 offen offset:2048 lds
    v_bfe_u32 v65, s5, v55, 2
    v_mad_u32_u24 v65, v65, s10, v63
    buffer_load_dwordx4 v65, s[60:63], s4 offen offset:3072 lds
    s_mov_b32 m0, 4096
    s_mov_b32 s4, 81920
    v_bfe_u32 v64, s6, v52, 2
    v_mad_u32_u24 v64, v64, s10, v60
    buffer_load_dwordx4 v64, s[60:63], s4 offen lds
    v_bfe_u32 v65, s6, v53, 2
    v_mad_u32_u24 v65, v65, s10, v61
    buffer_load_dwordx4 v65, s[60:63], s4 offen offset:1024 lds
    v_bfe_u32 v64, s6, v54, 2
    v_mad_u32_u24 v64, v64, s10, v62
    buffer_load_dwordx4 v64, s[60:63], s4 offen offset:2048 lds
    v_bfe_u32 v65, s6, v55, 2
    v_mad_u32_u24 v65, v65, s10, v63
    buffer_load_dwordx4 v65, s[60:63], s4 offen offset:3072 lds
    s_mov_b32 m0, 8192
    s_mov_b32 s4, 163840
    v_bfe_u32 v64, s7, v52, 2
    v_mad_u32_u24 v64, v64, s10, v60
    buffer_load_dwordx4 v64, s[60:63], s4 offen lds
    v_bfe_u32 v65, s7, v53, 2
    v_mad_u32_u24 v65, v65, s10, v61
    buffer_load_dwordx4 v65, s[60:63], s4 offen offset:1024 lds
    v_bfe_u32 v64, s7, v54, 2
    v_mad_u32_u24 v64, v64, s10, v62
    buffer_load_dwordx4 v64, s[60:63], s4 offen offset:2048 lds
    v_bfe_u32 v65, s7, v55, 2
    v_mad_u32_u24 v65, v65, s10, v63
    buffer_load_dwordx4 v65, s[60:63], s4 offen offset:3072 lds
    s_mov_b32 m0, 12288
    s_mov_b32 s4, 245760
    v_bfe_u32 v64, s8, v52, 2
    v_mad_u32_u24 v64, v64, s10, v60
    buffer_load_dwordx4 v64, s[60:63], s4 offen lds
    v_bfe_u32 v65, s8, v53, 2
    v_mad_u32_u24 v65, v65, s10, v61
    buffer_load_dwordx4 v65, s[60:63], s4 offen offset:1024 lds
    v_bfe_u32 v64, s8, v54, 2
    v_mad_u32_u24 v64, v64, s10, v62
    buffer_load_dwordx4 v64, s[60:63], s4 offen offset:2048 lds
    v_bfe_u32 v65, s8, v55, 2
    v_mad_u32_u24 v65, v65, s10, v63
    buffer_load_dwordx4 v65, s[60:63], s4 offen offset:3072 lds
    s_waitcnt vmcnt(16)
    v_mov_b32 v5, 157980
    v_mov_b32 v6, 1
    s_mov_b64 exec, 1
    ds_add_u32 v5, v6
    s_mov_b64 exec, -1
    v_mov_b32 v5, 157972
    v_mov_b32 v6, 1
    s_mov_b64 exec, 1
    ds_add_u32 v5, v6
    s_mov_b64 exec, -1
    s_mov_b32 m0, 24576
    s_mov_b32 s4, 327680
    v_bfe_u32 v64, s9, v52, 2
    v_mad_u32_u24 v64, v64, s10, v60
    buffer_load_dwordx4 v64, s[60:63], s4 offen lds
    v_bfe_u32 v65, s9, v53, 2
    v_mad_u32_u24 v65, v65, s10, v61
    buffer_load_dwordx4 v65, s[60:63], s4 offen offset:1024 lds
    v_bfe_u32 v64, s9, v54, 2
    v_mad_u32_u24 v64, v64, s10, v62
    buffer_load_dwordx4 v64, s[60:63], s4 offen offset:2048 lds
    v_bfe_u32 v65, s9, v55, 2
    v_mad_u32_u24 v65, v65, s10, v63
    buffer_load_dwordx4 v65, s[60:63], s4 offen offset:3072 lds
    s_mov_b32 m0, 28672
    s_mov_b32 s4, 409600
    v_bfe_u32 v64, s5, v52, 2
    v_mad_u32_u24 v64, v64, s10, v60
    buffer_load_dwordx4 v64, s[60:63], s4 offen lds
    v_bfe_u32 v65, s5, v53, 2
    v_mad_u32_u24 v65, v65, s10, v61
    buffer_load_dwordx4 v65, s[60:63], s4 offen offset:1024 lds
    v_bfe_u32 v64, s5, v54, 2
    v_mad_u32_u24 v64, v64, s10, v62
    buffer_load_dwordx4 v64, s[60:63], s4 offen offset:2048 lds
    v_bfe_u32 v65, s5, v55, 2
    v_mad_u32_u24 v65, v65, s10, v63
    buffer_load_dwordx4 v65, s[60:63], s4 offen offset:3072 lds
    s_mov_b32 m0, 123136
    s_mov_b32 s4, 491520
    v_bfe_u32 v64, s6, v52, 2
    v_mad_u32_u24 v64, v64, s10, v60
    buffer_load_dwordx4 v64, s[60:63], s4 offen lds
    v_bfe_u32 v65, s6, v53, 2
    v_mad_u32_u24 v65, v65, s10, v61
    buffer_load_dwordx4 v65, s[60:63], s4 offen offset:1024 lds
    v_bfe_u32 v64, s6, v54, 2
    v_mad_u32_u24 v64, v64, s10, v62
    buffer_load_dwordx4 v64, s[60:63], s4 offen offset:2048 lds
    v_bfe_u32 v65, s6, v55, 2
    v_mad_u32_u24 v65, v65, s10, v63
    buffer_load_dwordx4 v65, s[60:63], s4 offen offset:3072 lds
    s_mov_b32 m0, 127232
    s_mov_b32 s4, 573440
    v_bfe_u32 v64, s7, v52, 2
    v_mad_u32_u24 v64, v64, s10, v60
    buffer_load_dwordx4 v64, s[60:63], s4 offen lds
    v_bfe_u32 v65, s7, v53, 2
    v_mad_u32_u24 v65, v65, s10, v61
    buffer_load_dwordx4 v65, s[60:63], s4 offen offset:1024 lds
    v_bfe_u32 v64, s7, v54, 2
    v_mad_u32_u24 v64, v64, s10, v62
    buffer_load_dwordx4 v64, s[60:63], s4 offen offset:2048 lds
    v_bfe_u32 v65, s7, v55, 2
    v_mad_u32_u24 v65, v65, s10, v63
    buffer_load_dwordx4 v65, s[60:63], s4 offen offset:3072 lds
    s_mov_b32 m0, 80000
    s_mov_b32 s4, 655360
    v_bfe_u32 v64, s8, v52, 2
    v_mad_u32_u24 v64, v64, s10, v60
    buffer_load_dwordx4 v64, s[60:63], s4 offen lds
    v_bfe_u32 v65, s8, v53, 2
    v_mad_u32_u24 v65, v65, s10, v61
    buffer_load_dwordx4 v65, s[60:63], s4 offen offset:1024 lds
    v_bfe_u32 v64, s8, v54, 2
    v_mad_u32_u24 v64, v64, s10, v62
    buffer_load_dwordx4 v64, s[60:63], s4 offen offset:2048 lds
    v_bfe_u32 v65, s8, v55, 2
    v_mad_u32_u24 v65, v65, s10, v63
    buffer_load_dwordx4 v65, s[60:63], s4 offen offset:3072 lds
    s_mov_b32 m0, 84096
    s_mov_b32 s4, 737280
    v_bfe_u32 v64, s9, v52, 2
    v_mad_u32_u24 v64, v64, s10, v60
    buffer_load_dwordx4 v64, s[60:63], s4 offen lds
    v_bfe_u32 v65, s9, v53, 2
    v_mad_u32_u24 v65, v65, s10, v61
    buffer_load_dwordx4 v65, s[60:63], s4 offen offset:1024 lds
    v_bfe_u32 v64, s9, v54, 2
    v_mad_u32_u24 v64, v64, s10, v62
    buffer_load_dwordx4 v64, s[60:63], s4 offen offset:2048 lds
    v_bfe_u32 v65, s9, v55, 2
    v_mad_u32_u24 v65, v65, s10, v63
    buffer_load_dwordx4 v65, s[60:63], s4 offen offset:3072 lds
    s_waitcnt vmcnt(0)
    v_mov_b32 v7, 157980
    v_mov_b32 v6, 1
    s_mov_b64 exec, 1
    ds_add_u32 v7, v6
    s_mov_b64 exec, -1
Lcw_7:
    s_sub_u32 s35, s35, 1
    s_cbranch_scc1 Lend
    s_sleep 2
    ds_read_b32 v6, v5
    s_waitcnt lgkmcnt(0)
    v_readfirstlane_b32 s38, v6
    s_nop 0
    s_cmp_lt_u32 s38, 8
    s_cbranch_scc1 Lcw_7
    s_lshl_b32 s36, s32, 7
    s_add_u32 s36, s36, 8257536
    v_mov_b32 v69, s36
    buffer_load_dwordx4 v[70:73], v69, s[28:31], 0 offen sc1
    s_mov_b32 m0, 32768
    s_mov_b32 s4, 0
    v_bfe_u32 v64, s5, v56, 2
    v_mad_u32_u24 v64, v64, s10, v60
    buffer_load_dwordx4 v64, s[60:63], s4 offen lds
    v_bfe_u32 v65, s5, v57, 2
    v_mad_u32_u24 v65, v65, s10, v61
    buffer_load_dwordx4 v65, s[60:63], s4 offen offset:1024 lds
    v_bfe_u32 v64, s5, v58, 2
    v_mad_u32_u24 v64, v64, s10, v62
    buffer_load_dwordx4 v64, s[60:63], s4 offen offset:2048 lds
    v_bfe_u32 v65, s5, v59, 2
    v_mad_u32_u24 v65, v65, s10, v63
    buffer_load_dwordx4 v65, s[60:63], s4 offen offset:3072 lds
    s_mov_b32 m0, 36864
    s_mov_b32 s4, 81920
    v_bfe_u32 v64, s6, v56, 2
    v_mad_u32_u24 v64, v64, s10, v60
    buffer_load_dwordx4 v64, s[60:63], s4 offen lds
    v_bfe_u32 v65, s6, v57, 2
    v_mad_u32_u24 v65, v65, s10, v61
    buffer_load_dwordx4 v65, s[60:63], s4 offen offset:1024 lds
    v_bfe_u32 v64, s6, v58, 2
    v_mad_u32_u24 v64, v64, s10, v62
    buffer_load_dwordx4 v64, s[60:63], s4 offen offset:2048 lds
    v_bfe_u32 v65, s6, v59, 2
    v_mad_u32_u24 v65, v65, s10, v63
    buffer_load_dwordx4 v65, s[60:63], s4 offen offset:3072 lds
    s_mov_b32 m0, 40960
    s_mov_b32 s4, 163840
    v_bfe_u32 v64, s7, v56, 2
    v_mad_u32_u24 v64, v64, s10, v60
    buffer_load_dwordx4 v64, s[60:63], s4 offen lds
    v_bfe_u32 v65, s7, v57, 2
    v_mad_u32_u24 v65, v65, s10, v61
    buffer_load_dwordx4 v65, s[60:63], s4 offen offset:1024 lds
    v_bfe_u32 v64, s7, v58, 2
    v_mad_u32_u24 v64, v64, s10, v62
    buffer_load_dwordx4 v64, s[60:63], s4 offen offset:2048 lds
    v_bfe_u32 v65, s7, v59, 2
    v_mad_u32_u24 v65, v65, s10, v63
    buffer_load_dwordx4 v65, s[60:63], s4 offen offset:3072 lds
    s_mov_b32 m0, 45056
    s_mov_b32 s4, 245760
    v_bfe_u32 v64, s8, v56, 2
    v_mad_u32_u24 v64, v64, s10, v60
    buffer_load_dwordx4 v64, s[60:63], s4 offen lds
    v_bfe_u32 v65, s8, v57, 2
    v_mad_u32_u24 v65, v65, s10, v61
    buffer_load_dwordx4 v65, s[60:63], s4 offen offset:1024 lds
    v_bfe_u32 v64, s8, v58, 2
    v_mad_u32_u24 v64, v64, s10, v62
    buffer_load_dwordx4 v64, s[60:63], s4 offen offset:2048 lds
    v_bfe_u32 v65, s8, v59, 2
    v_mad_u32_u24 v65, v65, s10, v63
    buffer_load_dwordx4 v65, s[60:63], s4 offen offset:3072 lds
    s_mov_b32 m0, 63616
    s_mov_b32 s4, 327680
    v_bfe_u32 v64, s9, v56, 2
    v_mad_u32_u24 v64, v64, s10, v60
    buffer_load_dwordx4 v64, s[60:63], s4 offen lds
    v_bfe_u32 v65, s9, v57, 2
    v_mad_u32_u24 v65, v65, s10, v61
    buffer_load_dwordx4 v65, s[60:63], s4 offen offset:1024 lds
    v_bfe_u32 v64, s9, v58, 2
    v_mad_u32_u24 v64, v64, s10, v62
    buffer_load_dwordx4 v64, s[60:63], s4 offen offset:2048 lds
    v_bfe_u32 v65, s9, v59, 2
    v_mad_u32_u24 v65, v65, s10, v63
    buffer_load_dwordx4 v65, s[60:63], s4 offen offset:3072 lds
    s_mov_b32 m0, 67712
    s_mov_b32 s4, 409600
    v_bfe_u32 v64, s5, v56, 2
    v_mad_u32_u24 v64, v64, s10, v60
    buffer_load_dwordx4 v64, s[60:63], s4 offen lds
    v_bfe_u32 v65, s5, v57, 2
    v_mad_u32_u24 v65, v65, s10, v61
    buffer_load_dwordx4 v65, s[60:63], s4 offen offset:1024 lds
    v_bfe_u32 v64, s5, v58, 2
    v_mad_u32_u24 v64, v64, s10, v62
    buffer_load_dwordx4 v64, s[60:63], s4 offen offset:2048 lds
    v_bfe_u32 v65, s5, v59, 2
    v_mad_u32_u24 v65, v65, s10, v63
    buffer_load_dwordx4 v65, s[60:63], s4 offen offset:3072 lds
    s_mov_b32 m0, 71808
    s_mov_b32 s4, 491520
    v_bfe_u32 v64, s6, v56, 2
    v_mad_u32_u24 v64, v64, s10, v60
    buffer_load_dwordx4 v64, s[60:63], s4 offen lds
    v_bfe_u32 v65, s6, v57, 2
    v_mad_u32_u24 v65, v65, s10, v61
    buffer_load_dwordx4 v65, s[60:63], s4 offen offset:1024 lds
    v_bfe_u32 v64, s6, v58, 2
    v_mad_u32_u24 v64, v64, s10, v62
    buffer_load_dwordx4 v64, s[60:63], s4 offen offset:2048 lds
    v_bfe_u32 v65, s6, v59, 2
    v_mad_u32_u24 v65, v65, s10, v63
    buffer_load_dwordx4 v65, s[60:63], s4 offen offset:3072 lds
    s_mov_b32 m0, 75904
    s_mov_b32 s4, 573440
    v_bfe_u32 v64, s7, v56, 2
    v_mad_u32_u24 v64, v64, s10, v60
    buffer_load_dwordx4 v64, s[60:63], s4 offen lds
    v_bfe_u32 v65, s7, v57, 2
    v_mad_u32_u24 v65, v65, s10, v61
    buffer_load_dwordx4 v65, s[60:63], s4 offen offset:1024 lds
    v_bfe_u32 v64, s7, v58, 2
    v_mad_u32_u24 v64, v64, s10, v62
    buffer_load_dwordx4 v64, s[60:63], s4 offen offset:2048 lds
    v_bfe_u32 v65, s7, v59, 2
    v_mad_u32_u24 v65, v65, s10, v63
    buffer_load_dwordx4 v65, s[60:63], s4 offen offset:3072 lds
    s_mov_b32 m0, 49152
    s_mov_b32 s4, 655360
    v_bfe_u32 v64, s8, v56, 2
    v_mad_u32_u24 v64, v64, s10, v60
    buffer_load_dwordx4 v64, s[60:63], s4 offen lds
    v_bfe_u32 v65, s8, v57, 2
    v_mad_u32_u24 v65, v65, s10, v61
    buffer_load_dwordx4 v65, s[60:63], s4 offen offset:1024 lds
    v_bfe_u32 v64, s8, v58, 2
    v_mad_u32_u24 v64, v64, s10, v62
    buffer_load_dwordx4 v64, s[60:63], s4 offen offset:2048 lds
    v_bfe_u32 v65, s8, v59, 2
    v_mad_u32_u24 v65, v65, s10, v63
    buffer_load_dwordx4 v65, s[60:63], s4 offen offset:3072 lds
    s_mov_b32 m0, 88192
    s_mov_b32 s4, 737280
    v_bfe_u32 v64, s9, v56, 2
    v_mad_u32_u24 v64, v64, s10, v60
    buffer_load_dwordx4 v64, s[60:63], s4 offen lds
    v_bfe_u32 v65, s9, v57, 2
    v_mad_u32_u24 v65, v65, s10, v61
    buffer_load_dwordx4 v65, s[60:63], s4 offen offset:1024 lds
    v_bfe_u32 v64, s9, v58, 2
    v_mad_u32_u24 v64, v64, s10, v62
    buffer_load_dwordx4 v64, s[60:63], s4 offen offset:2048 lds
    v_bfe_u32 v65, s9, v59, 2
    v_mad_u32_u24 v65, v65, s10, v63
    buffer_load_dwordx4 v65, s[60:63], s4 offen offset:3072 lds
    s_waitcnt vmcnt(0)
Lbc:
    v_readfirstlane_b32 s11, v70
    v_readfirstlane_b32 s36, v71
    v_readfirstlane_b32 s12, v72
    v_readfirstlane_b32 s37, v73
    s_cmp_eq_u32 s36, s34
    s_cselect_b32 s37, s37, s36
    s_cmp_eq_u32 s37, s34
    s_cbranch_scc1 Lbc_ok
Lbc_re:
    s_sub_u32 s35, s35, 1
    s_cbranch_scc1 Lend
    buffer_load_dwordx4 v[70:73], v69, s[28:31], 0 offen sc1
    s_waitcnt vmcnt(0)
    s_branch Lbc
Lbc_ok:
    s_mul_i32 s36, s32, 96
    s_and_b32 s13, s11, 0x7ff
    s_sub_u32 s13, 2047, s13
    s_sub_u32 s37, s13, s36
    s_cmp_lt_u32 s37, 96
    s_cselect_b32 s13, s13, -1
    s_and_b32 s14, s12, 0x7ff
    s_sub_u32 s14, 2047, s14
    s_sub_u32 s37, s14, s36
    s_cmp_lt_u32 s37, 96
    s_cselect_b32 s14, s14, -1
    v_mov_b32 v4, s13
    v_mov_b32 v5, s14
    v_mov_b32 v6, 157960
    s_cmp_lg_u32 s3, 0
    s_cbranch_scc1 Lag2
    ds_write_b64 v6, v[4:5]
    s_branch Lw0_done
Lag2:
    s_and_b32 s37, s13, s14
    s_cmp_eq_u32 s37, -1
    s_cbranch_scc1 Lw0_done
    s_max_i32 s36, s13, 0
    s_mul_i32 s36, s36, 1280
    s_lshl_b32 s37, s33, 7
    s_add_u32 s36, s36, s37
    s_add_u32 s36, s36, 4096
    v_lshlrev_b32 v8, 1, v1
    buffer_load_ushort v124, v8, s[44:47], s36 offen
    s_max_i32 s36, s14, 0
    s_mul_i32 s36, s36, 1280
    s_lshl_b32 s37, s33, 7
    s_add_u32 s36, s36, s37
    s_add_u32 s36, s36, 4096
    v_lshlrev_b32 v8, 1, v1
    buffer_load_ushort v125, v8, s[44:47], s36 offen
    v_min_u32 v7, 26, v1
    v_mul_u32_u24 v7, 10240, v7
Ly_poll:
    s_sub_u32 s35, s35, 1
    s_cbranch_scc1 Lend
    s_sleep 4
    s_lshl_b32 s36, s33, 10
    s_add_u32 s36, s36, 7405568
    buffer_load_dword v4, v7, s[28:31], s36 offen offset:1020 sc1
    s_waitcnt vmcnt(0)
    v_cmp_ne_u32 vcc, s34, v4
    s_nop 0
    s_cbranch_vccnz Ly_poll
    buffer_load_dwordx4 v[16:19], v13, s[28:31], s36 offen sc1
    s_add_u32 s36, s36, 10240
    buffer_load_dwordx4 v[20:23], v13, s[28:31], s36 offen sc1
    s_add_u32 s36, s36, 10240
    buffer_load_dwordx4 v[24:27], v13, s[28:31], s36 offen sc1
    s_add_u32 s36, s36, 10240
    buffer_load_dwordx4 v[28:31], v13, s[28:31], s36 offen sc1
    s_add_u32 s36, s36, 10240
    buffer_load_dwordx4 v[32:35], v13, s[28:31], s36 offen sc1
    s_add_u32 s36, s36, 10240
    buffer_load_dwordx4 v[36:39], v13, s[28:31], s36 offen sc1
    s_add_u32 s36, s36, 10240
    buffer_load_dwordx4 v[40:43], v13, s[28:31], s36 offen sc1
    s_add_u32 s36, s36, 10240
    buffer_load_dwordx4 v[44:47], v13, s[28:31], s36 offen sc1
    s_add_u32 s36, s36, 10240
    buffer_load_dwordx4 v[48:51], v13, s[28:31], s36 offen sc1
    s_add_u32 s36, s36, 10240
    buffer_load_dwordx4 v[52:55], v13, s[28:31], s36 offen sc1
    s_add_u32 s36, s36, 10240
    buffer_load_dwordx4 v[56:59], v13, s[28:31], s36 offen sc1
    s_add_u32 s36, s36, 10240
    buffer_load_dwordx4 v[60:63], v13, s[28:31], s36 offen sc1
    s_add_u32 s36, s36, 10240
    buffer_load_dwordx4 v[64:67], v13, s[28:31], s36 offen sc1
    s_add_u32 s36, s36, 10240
    buffer_load_dwordx4 v[68:71], v13, s[28:31], s36 offen sc1
    s_add_u32 s36, s36, 10240
    buffer_load_dwordx4 v[72:75], v13, s[28:31], s36 offen sc1
    s_add_u32 s36, s36, 10240
    buffer_load_dwordx4 v[76:79], v13, s[28:31], s36 offen sc1
    s_add_u32 s36, s36, 10240
    buffer_load_dwordx4 v[80:83], v13, s[28:31], s36 offen sc1
    s_add_u32 s36, s36, 10240
    buffer_load_dwordx4 v[84:87], v13, s[28:31], s36 offen sc1
    s_add_u32 s36, s36, 10240
    buffer_load_dwordx4 v[88:91], v13, s[28:31], s36 offen sc1
    s_add_u32 s36, s36, 10240
    buffer_load_dwordx4 v[92:95], v13, s[28:31], s36 offen sc1
    s_add_u32 s36, s36, 10240
    buffer_load_dwordx4 v[96:99], v13, s[28:31], s36 offen sc1
    s_add_u32 s36, s36, 10240
    buffer_load_dwordx4 v[100:103], v13, s[28:31], s36 offen sc1
    s_add_u32 s36, s36, 10240
    buffer_load_dwordx4 v[104:107], v13, s[28:31], s36 offen sc1
    s_add_u32 s36, s36, 10240
    buffer_load_dwordx4 v[108:111], v13, s[28:31], s36 offen sc1
    s_add_u32 s36, s36, 10240
    buffer_load_dwordx4 v[112:115], v13, s[28:31], s36 offen sc1
    s_add_u32 s36, s36, 10240
    buffer_load_dwordx4 v[116:119], v13, s[28:31], s36 offen sc1
    s_add_u32 s36, s36, 10240
    buffer_load_dwordx4 v[120:123], v13, s[28:31], s36 offen sc1
    s_add_u32 s36, s36, 10240
    s_waitcnt vmcnt(0)
    v_xor_b32 v4, s34, v17
    v_xor_b32 v5, s34, v19
    v_or_b32 v4, v4, v5
    v_xor_b32 v5, s34, v21
    v_or_b32 v4, v4, v5
    v_xor_b32 v5, s34, v23
    v_or_b32 v4, v4, v5
    v_xor_b32 v5, s34, v25
    v_or_b32 v4, v4, v5
    v_xor_b32 v5, s34, v27
    v_or_b32 v4, v4, v5
    v_xor_b32 v5, s34, v29
    v_or_b32 v4, v4, v5
    v_xor_b32 v5, s34, v31
    v_or_b32 v4, v4, v5
    v_xor_b32 v5, s34, v33
    v_or_b32 v4, v4, v5
    v_xor_b32 v5, s34, v35
    v_or_b32 v4, v4, v5
    v_xor_b32 v5, s34, v37
    v_or_b32 v4, v4, v5
    v_xor_b32 v5, s34, v39
    v_or_b32 v4, v4, v5
    v_xor_b32 v5, s34, v41
    v_or_b32 v4, v4, v5
    v_xor_b32 v5, s34, v43
    v_or_b32 v4, v4, v5
    v_xor_b32 v5, s34, v45
    v_or_b32 v4, v4, v5
    v_xor_b32 v5, s34, v47
    v_or_b32 v4, v4, v5
    v_xor_b32 v5, s34, v49
    v_or_b32 v4, v4, v5
    v_xor_b32 v5, s34, v51
    v_or_b32 v4, v4, v5
    v_xor_b32 v5, s34, v53
    v_or_b32 v4, v4, v5
    v_xor_b32 v5, s34, v55
    v_or_b32 v4, v4, v5
    v_xor_b32 v5, s34, v57
    v_or_b32 v4, v4, v5
    v_xor_b32 v5, s34, v59
    v_or_b32 v4, v4, v5
    v_xor_b32 v5, s34, v61
    v_or_b32 v4, v4, v5
    v_xor_b32 v5, s34, v63
    v_or_b32 v4, v4, v5
    v_xor_b32 v5, s34, v65
    v_or_b32 v4, v4, v5
    v_xor_b32 v5, s34, v67
    v_or_b32 v4, v4, v5
    v_xor_b32 v5, s34, v69
    v_or_b32 v4, v4, v5
    v_xor_b32 v5, s34, v71
    v_or_b32 v4, v4, v5
    v_xor_b32 v5, s34, v73
    v_or_b32 v4, v4, v5
    v_xor_b32 v5, s34, v75
    v_or_b32 v4, v4, v5
    v_xor_b32 v5, s34, v77
    v_or_b32 v4, v4, v5
    v_xor_b32 v5, s34, v79
    v_or_b32 v4, v4, v5
    v_xor_b32 v5, s34, v81
    v_or_b32 v4, v4, v5
    v_xor_b32 v5, s34, v83
    v_or_b32 v4, v4, v5
    v_xor_b32 v5, s34, v85
    v_or_b32 v4, v4, v5
    v_xor_b32 v5, s34, v87
    v_or_b32 v4, v4, v5
    v_xor_b32 v5, s34, v89
    v_or_b32 v4, v4, v5
    v_xor_b32 v5, s34, v91
    v_or_b32 v4, v4, v5
    v_xor_b32 v5, s34, v93
    v_or_b32 v4, v4, v5
    v_xor_b32 v5, s34, v95
    v_or_b32 v4, v4, v5
    v_xor_b32 v5, s34, v97
    v_or_b32 v4, v4, v5
    v_xor_b32 v5, s34, v99
    v_or_b32 v4, v4, v5
    v_xor_b32 v5, s34, v101
    v_or_b32 v4, v4, v5
    v_xor_b32 v5, s34, v103
    v_or_b32 v4, v4, v5
    v_xor_b32 v5, s34, v105
    v_or_b32 v4, v4, v5
    v_xor_b32 v5, s34, v107
    v_or_b32 v4, v4, v5
    v_xor_b32 v5, s34, v109
    v_or_b32 v4, v4, v5
    v_xor_b32 v5, s34, v111
    v_or_b32 v4, v4, v5
    v_xor_b32 v5, s34, v113
    v_or_b32 v4, v4, v5
    v_xor_b32 v5, s34, v115
    v_or_b32 v4, v4, v5
    v_xor_b32 v5, s34, v117
    v_or_b32 v4, v4, v5
    v_xor_b32 v5, s34, v119
    v_or_b32 v4, v4, v5
    v_xor_b32 v5, s34, v121
    v_or_b32 v4, v4, v5
    v_xor_b32 v5, s34, v123
    v_or_b32 v4, v4, v5
    v_cmp_ne_u32 vcc, 0, v4
    s_nop 0
    s_cmp_lg_u64 vcc, 0
    s_cbranch_scc1 Ly_poll
    v_add_f32 v16, v16, v20
    v_add_f32 v18, v18, v22
    v_add_f32 v16, v16, v24
    v_add_f32 v18, v18, v26
    v_add_f32 v16, v16, v28
    v_add_f32 v18, v18, v30
    v_add_f32 v16, v16, v32
    v_add_f32 v18, v18, v34
    v_add_f32 v16, v16, v36
    v_add_f32 v18, v18, v38
    v_add_f32 v16, v16, v40
    v_add_f32 v18, v18, v42
    v_add_f32 v16, v16, v44
    v_add_f32 v18, v18, v46
    v_add_f32 v16, v16, v48
    v_add_f32 v18, v18, v50
    v_add_f32 v16, v16, v52
    v_add_f32 v18, v18, v54
    v_add_f32 v16, v16, v56
    v_add_f32 v18, v18, v58
    v_add_f32 v16, v16, v60
    v_add_f32 v18, v18, v62
    v_add_f32 v16, v16, v64
    v_add_f32 v18, v18, v66
    v_add_f32 v16, v16, v68
    v_add_f32 v18, v18, v70
    v_add_f32 v16, v16, v72
    v_add_f32 v18, v18, v74
    v_add_f32 v16, v16, v76
    v_add_f32 v18, v18, v78
    v_add_f32 v16, v16, v80
    v_add_f32 v18, v18, v82
    v_add_f32 v16, v16, v84
    v_add_f32 v18, v18, v86
    v_add_f32 v16, v16, v88
    v_add_f32 v18, v18, v90
    v_add_f32 v16, v16, v92
    v_add_f32 v18, v18, v94
    v_add_f32 v16, v16, v96
    v_add_f32 v18, v18, v98
    v_add_f32 v16, v16, v100
    v_add_f32 v18, v18, v102
    v_add_f32 v16, v16, v104
    v_add_f32 v18, v18, v106
    v_add_f32 v16, v16, v108
    v_add_f32 v18, v18, v110
    v_add_f32 v16, v16, v112
    v_add_f32 v18, v18, v114
    v_add_f32 v16, v16, v116
    v_add_f32 v18, v18, v118
    v_add_f32 v16, v16, v120
    v_add_f32 v18, v18, v122
    s_lshr_b32 s36, s11, 16
    s_cmp_ge_u32 s36, 0x8000
    s_cselect_b32 s37, 0x8000, -1
    s_xor_b32 s36, s36, s37
    s_lshl_b32 s36, s36, 16
    v_mov_b32 v4, s36
    v_mul_f32 v4, 0xbfb8aa3b, v4
    v_exp_f32 v4, v4
    s_nop 0
    v_add_f32 v4, 1.0, v4
    v_rcp_f32 v4, v4
    s_nop 0
    v_cvt_pk_bf16_f32 v4, v4, v4
    v_lshlrev_b32 v4, 16, v4
    v_cvt_pk_bf16_f32 v16, v16, v16
    v_lshlrev_b32 v16, 16, v16
    v_mul_f32 v16, v16, v4
    v_cvt_pk_bf16_f32 v16, v16, v16
    v_lshlrev_b32 v16, 16, v16
    s_lshr_b32 s36, s12, 16
    s_cmp_ge_u32 s36, 0x8000
    s_cselect_b32 s37, 0x8000, -1
    s_xor_b32 s36, s36, s37
    s_lshl_b32 s36, s36, 16
    v_mov_b32 v4, s36
    v_mul_f32 v4, 0xbfb8aa3b, v4
    v_exp_f32 v4, v4
    s_nop 0
    v_add_f32 v4, 1.0, v4
    v_rcp_f32 v4, v4
    s_nop 0
    v_cvt_pk_bf16_f32 v4, v4, v4
    v_lshlrev_b32 v4, 16, v4
    v_cvt_pk_bf16_f32 v18, v18, v18
    v_lshlrev_b32 v18, 16, v18
    v_mul_f32 v18, v18, v4
    v_cvt_pk_bf16_f32 v18, v18, v18
    v_lshlrev_b32 v18, 16, v18
    s_mul_i32 s36, s32, 96
    s_sub_u32 s36, s13, s36
    s_max_i32 s36, s36, 0
    s_lshl_b32 s36, s36, 2
    s_add_u32 s36, s36, 156288
    v_mov_b32 v4, s36
    ds_read2st64_b32 v[4:5], v4 offset0:0 offset1:2
    v_lshlrev_b32 v124, 16, v124
    s_waitcnt lgkmcnt(0)
    v_add_f32 v20, v124, v4
    v_cvt_pk_bf16_f32 v20, v20, v20
    v_lshlrev_b32 v20, 16, v20
    v_mul_f32 v20, v20, v5
    v_cvt_pk_bf16_f32 v20, v20, v20
    v_lshlrev_b32 v20, 16, v20
    v_add_f32 v20, v20, v16
    v_cvt_pk_bf16_f32 v20, v20, v20
    v_lshlrev_b32 v20, 16, v20
    v_mul_f32 v16, 0xbfb8aa3b, v20
    v_exp_f32 v16, v16
    s_nop 0
    v_add_f32 v16, 1.0, v16
    v_rcp_f32 v16, v16
    s_nop 0
    v_mul_f32 v16, v16, v20
    v_cvt_pk_bf16_f32 v16, v16, v16
    v_lshlrev_b32 v16, 16, v16
    s_mul_i32 s36, s32, 96
    s_sub_u32 s36, s14, s36
    s_max_i32 s36, s36, 0
    s_lshl_b32 s36, s36, 2
    s_add_u32 s36, s36, 156288
    v_mov_b32 v4, s36
    ds_read2st64_b32 v[4:5], v4 offset0:0 offset1:2
    v_lshlrev_b32 v125, 16, v125
    s_waitcnt lgkmcnt(0)
    v_add_f32 v22, v125, v4
    v_cvt_pk_bf16_f32 v22, v22, v22
    v_lshlrev_b32 v22, 16, v22
    v_mul_f32 v22, v22, v5
    v_cvt_pk_bf16_f32 v22, v22, v22
    v_lshlrev_b32 v22, 16, v22
    v_add_f32 v22, v22, v18
    v_cvt_pk_bf16_f32 v22, v22, v22
    v_lshlrev_b32 v22, 16, v22
    v_mul_f32 v18, 0xbfb8aa3b, v22
    v_exp_f32 v18, v18
    s_nop 0
    v_add_f32 v18, 1.0, v18
    v_rcp_f32 v18, v18
    s_nop 0
    v_mul_f32 v18, v18, v22
    v_cvt_pk_bf16_f32 v18, v18, v18
    v_lshlrev_b32 v18, 16, v18
    v_add_u32 v5, 158208, v12
    ds_write2st64_b32 v5, v16, v18 offset0:0 offset1:1
    v_mov_b32 v6, 157956
    v_mov_b32 v7, 1
    s_mov_b64 exec, 1
    ds_add_u32 v6, v7
    s_mov_b64 exec, -1
Lw0_done:
    s_endpgm
Lagent:
    s_sub_u32 s44, s4, 4096
    s_subb_u32 s45, s5, 0
    s_mov_b32 s46, 2625536
    s_mov_b32 s47, 0x20000
    s_lshl_b32 s36, s32, 7
    s_add_u32 s36, s36, 8257536
    v_mov_b32 v69, s36
    s_branch Lbc_re
Lcomp:
    s_lshl_b32 s44, s26, 1
    s_add_u32 s44, s44, s27
    s_sub_u32 s36, s33, 5
    s_cmp_ge_u32 s33, 5
    s_cselect_b32 s40, s36, s33
    s_mov_b32 s41, 0xbfe10856
    s_cmp_eq_u32 s40, 1
    s_cselect_b32 s41, 0xaff80255, s41
    s_cmp_eq_u32 s40, 2
    s_cselect_b32 s41, 0xabfe4015, s41
    s_cmp_eq_u32 s40, 3
    s_cselect_b32 s41, 0xaa7fd005, s41
    s_cmp_eq_u32 s40, 4
    s_cselect_b32 s41, 0x6adfb401, s41
    s_lshl_b32 s37, s27, 13
    s_cmp_eq_u32 s44, 1
    s_cselect_b32 s37, 0, s37
    v_bfe_u32 v7, v1, 2, 2
    v_and_b32 v8, 3, v1
    v_lshl_add_u32 v18, v2, 3, v7
    v_lshlrev_b32 v18, 7, v18
    v_lshlrev_b32 v19, 2, v1
    v_and_b32 v19, 0x60, v19
    v_lshlrev_b32 v10, 1, v8
    v_add_u32 v9, s37, v18
    v_add_u32 v11, 0, v10
    v_bfe_u32 v11, s41, v11, 2
    v_lshl_add_u32 v11, v11, 2, v8
    v_lshlrev_b32 v11, 3, v11
    v_xad_u32 v20, v11, v19, v9
    v_add_u32 v11, 8, v10
    v_bfe_u32 v11, s41, v11, 2
    v_lshl_add_u32 v11, v11, 2, v8
    v_lshlrev_b32 v11, 3, v11
    v_xad_u32 v21, v11, v19, v9
    v_add_u32 v11, 16, v10
    v_bfe_u32 v11, s41, v11, 2
    v_lshl_add_u32 v11, v11, 2, v8
    v_lshlrev_b32 v11, 3, v11
    v_xad_u32 v22, v11, v19, v9
    v_add_u32 v11, 24, v10
    v_bfe_u32 v11, s41, v11, 2
    v_lshl_add_u32 v11, v11, 2, v8
    v_lshlrev_b32 v11, 3, v11
    v_xad_u32 v23, v11, v19, v9
    v_add_u32 v24, 78080, v20
    v_add_u32 v25, 78080, v21
    v_add_u32 v26, 78080, v22
    v_add_u32 v27, 78080, v23
    v_lshrrev_b32 v10, 1, v3
    v_xor_b32 v9, v10, v2
    v_lshlrev_b32 v9, 4, v9
    v_lshl_add_u32 v9, v3, 7, v9
    s_lshl_b32 s36, s44, 11
    s_xor_b32 s38, s36, 2048
    s_add_u32 s36, s36, 22528
    s_add_u32 s38, s38, 22528
    v_add_u32 v76, s36, v9
    v_add_u32 v78, s38, v9
    s_mul_i32 s39, s26, 6144
    s_add_u32 s39, s39, 98560
    v_add_u32 v125, s39, v13
    s_lshl_b32 s45, s44, 11
    s_add_u32 s45, s45, 139648
    s_waitcnt lgkmcnt(0)
    s_mov_b64 s[28:29], s[24:25]
    s_mov_b32 s30, 268435456
    s_mov_b32 s31, 0x20000
    s_load_dword s34, s[28:29], 0
    s_cmp_eq_u32 s44, 1
    s_cbranch_scc1 Lhalo
    v_xor_b32 v77, 64, v76
    v_xor_b32 v79, 64, v78
    v_add_u32 v80, 78080, v76
    v_add_u32 v81, 78080, v77
    v_add_u32 v82, 78080, v78
    v_add_u32 v83, 78080, v79
    s_cmp_eq_u32 s27, 0
    s_cselect_b64 vcc, 0, -1
    s_sub_u32 s37, 16384, s37
    v_cndmask_b32 v84, v20, v22, vcc
    v_cndmask_b32 v85, v21, v23, vcc
    v_add_u32 v84, s37, v84
    v_add_u32 v85, s37, v85
    v_add_u32 v86, 78080, v84
    v_add_u32 v87, 78080, v85
    v_lshrrev_b32 v8, 1, v2
    v_xor_b32 v8, v8, v10
    v_lshlrev_b32 v8, 4, v8
    v_lshl_add_u32 v8, v3, 7, v8
    v_and_b32 v7, 1, v2
    v_lshl_add_u32 v124, v7, 3, v8
    s_mov_b32 s46, 0
    s_mov_b32 s38, 0x86542310
    s_mov_b32 s39, 0x97
    s_cmp_eq_u32 s42, 1
    s_cselect_b32 s38, 0x76453210, s38
    s_cselect_b32 s39, 0x98, s39
    s_cmp_eq_u32 s42, 2
    s_cselect_b32 s38, 0x67543120, s38
    s_cselect_b32 s39, 0x98, s39
    s_cmp_eq_u32 s42, 3
    s_cselect_b32 s38, 0x76534201, s38
    s_cselect_b32 s39, 0x89, s39
    s_cmp_eq_u32 s42, 4
    s_cselect_b32 s38, 0x75643201, s38
    s_cselect_b32 s39, 0x98, s39
    s_sub_u32 s42, s33, s43
    s_cselect_b32 s43, 10, 0
    s_add_u32 s42, s42, s43
    s_lshl_b32 s42, s42, 2
    s_lshr_b64 s[38:39], s[38:39], s42
    s_and_b32 s42, s38, 15
    s_and_b32 s38, s42, 3
    s_mul_i32 s38, s38, 39040
    s_add_u32 s38, s38, s36
    v_add_u32 v4, s38, v124
    v_xor_b32 v5, 32, v4
    v_xor_b32 v6, 64, v4
    v_xor_b32 v7, 0x60, v4
    s_mov_b64 s[48:49], s[20:21]
    s_mov_b32 s50, 2621440
    s_mov_b32 s51, 0x20000
    v_mov_b32 v14, 0x3f803f80
    v_mov_b32 v15, 0x3f803f80
    v_mov_b32 v16, 0x3f803f80
    v_mov_b32 v17, 0x3f803f80
    s_mov_b32 s4, 0xaae00455
    s_cmp_eq_u32 s40, 1
    s_cselect_b32 s4, 0xaaf80155, s4
    s_cmp_eq_u32 s40, 2
    s_cselect_b32 s4, 0xaafe4055, s4
    s_cmp_eq_u32 s40, 3
    s_cselect_b32 s4, 0xaabfd055, s4
    s_cmp_eq_u32 s40, 4
    s_cselect_b32 s4, 0xaaeff455, s4
    v_lshlrev_b32 v10, 1, v2
    v_add_u32 v10, 8, v10
    v_bfe_u32 v10, s4, v10, 2
    v_cmp_eq_u32 s[6:7], 0, v10
    v_cmp_eq_u32 s[8:9], 3, v10
    v_cmp_eq_u32 s[10:11], 1, v10
    v_lshlrev_b32 v10, 1, v2
    v_add_u32 v10, 16, v10
    v_bfe_u32 v10, s4, v10, 2
    v_cmp_eq_u32 s[12:13], 0, v10
    v_cmp_eq_u32 s[14:15], 3, v10
    v_cmp_eq_u32 s[16:17], 2, v10
    s_mov_b32 s4, 0xaaaaaaaa
    s_mov_b32 s5, 0xaaaaaaaa
    s_mov_b32 s18, 0xfff0ffff
    s_mov_b32 s19, 0xf000ff00
    s_mov_b32 s20, 0xffc0fffc
    s_mov_b32 s21, 0xc000fc00
    v_mov_b32 v8, 0xffff
    v_not_b32 v9, v8
    v_cndmask_b32 v8, v8, v9, s[4:5]
    v_cndmask_b32 v118, 0, v8, s[18:19]
    v_cndmask_b32 v119, 0, v8, s[20:21]
    v_xor_b32 v116, v118, v8
    v_xor_b32 v117, v119, v8
    s_cmp_eq_u32 s32, 0
    s_cselect_b32 s36, s44, 0
    s_cmp_eq_u32 s36, 2
    s_cselect_b32 s22, 0xff800000, 0
    s_mul_i32 s36, s32, 6
    s_add_u32 s36, s36, s44
    s_sub_u32 s36, s36, 2
    s_lshl_b32 s24, s36, 7
    s_add_u32 s24, s24, 7340032
    s_mul_i32 s52, s36, 20480
    s_add_u32 s52, s52, 4194304
    s_lshl_b32 s36, s33, 11
    s_add_u32 s23, s36, s52
    s_add_u32 s53, s52, s46
    s_add_u32 s46, s46, 4096
    s_cmp_eq_u32 s46, 20480
    s_cselect_b32 s46, 0, s46
    s_add_u32 s54, s52, s46
    s_add_u32 s46, s46, 4096
    s_cmp_eq_u32 s46, 20480
    s_cselect_b32 s46, 0, s46
    s_add_u32 s55, s52, s46
    s_add_u32 s46, s46, 4096
    s_cmp_eq_u32 s46, 20480
    s_cselect_b32 s46, 0, s46
    s_add_u32 s56, s52, s46
    s_add_u32 s46, s46, 4096
    s_cmp_eq_u32 s46, 20480
    s_cselect_b32 s46, 0, s46
    s_add_u32 s57, s52, s46
    s_add_u32 s46, s46, 4096
    s_cmp_eq_u32 s46, 20480
    s_cselect_b32 s46, 0, s46
    s_mul_i32 s36, s32, 10
    s_add_u32 s36, s36, s33
    s_mul_i32 s58, s36, 6144
    s_lshl_b32 s36, s44, 10
    s_add_u32 s58, s58, s36
    s_add_u32 s58, s58, 1046528
    s_sub_u32 s59, s58, 6144
    s_add_u32 s60, s58, 6144
    s_cmp_eq_u32 s40, 0
    s_cselect_b32 s61, 0, -1
    s_cmp_eq_u32 s40, 4
    s_cselect_b32 s62, 0, -1
    s_lshl_b32 s36, s33, 2
    v_mov_b32 v97, s36
    s_mov_b32 s25, 0x3ea52b5c
    s_lshl_b32 s36, s44, 6
    s_add_u32 s36, s36, 156160
    v_lshl_add_u32 v94, v3, 2, s36
    v_and_b32 v8, 1, v1
    v_lshl_add_u32 v8, v2, 2, v8
    v_lshl_add_u32 v8, v8, 2, s36
    v_subrev_u32 v9, 64, v8
    v_cndmask_b32 v92, v9, v8, s[18:19]
    v_cndmask_b32 v93, v9, v8, s[20:21]
    v_lshlrev_b32 v95, 4, v2
    s_lshl_b32 s36, s27, 8
    s_add_u32 s36, s36, 157184
    v_add_u32 v95, s36, v95
    v_mov_b32 v96, 157968
    s_lshl_b32 s36, s27, 11
    v_add_u32 v99, s36, v125
    v_mov_b32 v100, -1
    v_mov_b32 v101, -1
    v_mov_b32 v102, -1
    v_mov_b32 v103, -1
    v_mov_b32 v127, 157984
    s_lshl_b32 s36, s3, 2
    s_add_u32 s36, s36, 158016
    v_mov_b32 v10, s36
    v_xor_b32 v11, 16, v10
    v_cndmask_b32 v127, v127, v11, s[4:5]
    s_waitcnt vmcnt(0)
    s_waitcnt lgkmcnt(0)
    s_barrier
    ds_read_b128 a[64:67], v76 offset:0
    ds_read_b128 a[68:71], v78 offset:0
    ds_read_b64_tr_b16 a[80:81], v20 offset:0
    ds_read_b64_tr_b16 a[82:83], v20 offset:512
    ds_read_b64_tr_b16 a[84:85], v21 offset:0
    ds_read_b64_tr_b16 a[86:87], v21 offset:512
    ds_read_b64_tr_b16 a[88:89], v22 offset:0
    ds_read_b64_tr_b16 a[90:91], v22 offset:512
    ds_read_b64_tr_b16 a[92:93], v23 offset:0
    ds_read_b64_tr_b16 a[94:95], v23 offset:512
    ds_read_b64_tr_b16 a[96:97], v84 offset:0
    ds_read_b64_tr_b16 a[98:99], v84 offset:512
    ds_read_b64_tr_b16 a[100:101], v85 offset:0
    ds_read_b64_tr_b16 a[102:103], v85 offset:512
    s_add_u32 s34, s34, 0x9e3779b8
    s_or_b32 s34, s34, 1
    s_cmp_eq_u32 s42, 0
    s_cbranch_scc1 Lxe0
Lxe0_b:
    s_setprio 1
    s_waitcnt lgkmcnt(10)
    v_mfma_f32_16x16x32_bf16 v[28:31], a[80:83], a[64:67], 0
    ds_read_b128 a[72:75], v77 offset:0
    ds_read_b128 a[76:79], v79 offset:0
    v_mfma_f32_16x16x32_bf16 v[44:47], a[80:83], a[68:71], 0
    ds_read_b64_tr_b16 a[104:105], v20 offset:4096
    s_waitcnt lgkmcnt(11)
    v_mfma_f32_16x16x32_bf16 v[48:51], a[84:87], a[68:71], 0
    ds_read_b64_tr_b16 a[106:107], v20 offset:4608
    v_mfma_f32_16x16x32_bf16 v[32:35], a[84:87], a[64:67], 0
    ds_read_b64_tr_b16 a[108:109], v21 offset:4096
    s_waitcnt lgkmcnt(11)
    v_mfma_f32_16x16x32_bf16 v[36:39], a[88:91], a[64:67], 0
    ds_read_b64_tr_b16 a[110:111], v21 offset:4608
    ds_read_b64_tr_b16 a[112:113], v22 offset:4096
    v_mfma_f32_16x16x32_bf16 v[52:55], a[88:91], a[68:71], 0
    ds_read_b64_tr_b16 a[114:115], v22 offset:4608
    s_setprio 0
    s_waitcnt lgkmcnt(12)
    v_mfma_f32_16x16x32_bf16 v[56:59], a[92:95], a[68:71], 0
    ds_read_b64_tr_b16 a[116:117], v23 offset:4096
    v_mfma_f32_16x16x32_bf16 v[40:43], a[92:95], a[64:67], 0
    ds_read_b64_tr_b16 a[118:119], v23 offset:4608
    s_waitcnt lgkmcnt(12)
    v_mfma_f32_16x16x32_bf16 v[60:63], a[64:67], a[96:99], 0
    ds_read_b64_tr_b16 a[120:121], v84 offset:4096
    v_mfma_f32_16x16x32_bf16 v[68:71], a[68:71], a[96:99], 0
    ds_read_b64_tr_b16 a[122:123], v84 offset:4608
    s_waitcnt lgkmcnt(12)
    v_mfma_f32_16x16x32_bf16 v[72:75], a[68:71], a[100:103], 0
    ds_read_b64_tr_b16 a[124:125], v85 offset:4096
    v_mfma_f32_16x16x32_bf16 v[64:67], a[64:67], a[100:103], 0
    ds_read_b64_tr_b16 a[126:127], v85 offset:4608
    s_barrier
    s_setprio 3
    s_waitcnt lgkmcnt(10)
    v_mfma_f32_16x16x32_bf16 v[28:31], a[104:107], a[72:75], v[28:31]
    ds_read_b128 a[64:67], v76 offset:39040
    ds_read_b128 a[68:71], v78 offset:39040
    v_mfma_f32_16x16x32_bf16 v[44:47], a[104:107], a[76:79], v[44:47]
    ds_read_b64_tr_b16 a[80:81], v20 offset:39040
    s_waitcnt lgkmcnt(11)
    v_mfma_f32_16x16x32_bf16 v[48:51], a[108:111], a[76:79], v[48:51]
    ds_read_b64_tr_b16 a[82:83], v20 offset:39552
    v_mfma_f32_16x16x32_bf16 v[32:35], a[108:111], a[72:75], v[32:35]
    ds_read_b64_tr_b16 a[84:85], v21 offset:39040
    s_waitcnt lgkmcnt(11)
    v_mfma_f32_16x16x32_bf16 v[36:39], a[112:115], a[72:75], v[36:39]
    ds_read_b64_tr_b16 a[86:87], v21 offset:39552
    v_mfma_f32_16x16x32_bf16 v[52:55], a[112:115], a[76:79], v[52:55]
    ds_read_b64_tr_b16 a[88:89], v22 offset:39040
    s_setprio 2
    s_waitcnt lgkmcnt(11)
    v_mfma_f32_16x16x32_bf16 v[56:59], a[116:119], a[76:79], v[56:59]
    ds_read_b64_tr_b16 a[90:91], v22 offset:39552
    ds_read_b64_tr_b16 a[92:93], v23 offset:39040
    v_mfma_f32_16x16x32_bf16 v[40:43], a[116:119], a[72:75], v[40:43]
    ds_read_b64_tr_b16 a[94:95], v23 offset:39552
    s_waitcnt lgkmcnt(12)
    v_mfma_f32_16x16x32_bf16 v[60:63], a[72:75], a[120:123], v[60:63]
    ds_read_b64_tr_b16 a[96:97], v84 offset:39040
    v_mfma_f32_16x16x32_bf16 v[68:71], a[76:79], a[120:123], v[68:71]
    ds_read_b64_tr_b16 a[98:99], v84 offset:39552
    s_waitcnt lgkmcnt(12)
    v_mfma_f32_16x16x32_bf16 v[72:75], a[76:79], a[124:127], v[72:75]
    ds_read_b64_tr_b16 a[100:101], v85 offset:39040
    v_mfma_f32_16x16x32_bf16 v[64:67], a[72:75], a[124:127], v[64:67]
    ds_read_b64_tr_b16 a[102:103], v85 offset:39552
    s_cmp_eq_u32 s42, 1
    s_cbranch_scc1 Lxe1
Lxe1_b:
    s_setprio 1
    s_waitcnt lgkmcnt(10)
    v_mfma_f32_16x16x32_bf16 v[28:31], a[80:83], a[64:67], v[28:31]
    ds_read_b128 a[72:75], v77 offset:39040
    ds_read_b128 a[76:79], v79 offset:39040
    v_mfma_f32_16x16x32_bf16 v[44:47], a[80:83], a[68:71], v[44:47]
    ds_read_b64_tr_b16 a[104:105], v20 offset:43136
    s_waitcnt lgkmcnt(11)
    v_mfma_f32_16x16x32_bf16 v[48:51], a[84:87], a[68:71], v[48:51]
    ds_read_b64_tr_b16 a[106:107], v20 offset:43648
    v_mfma_f32_16x16x32_bf16 v[32:35], a[84:87], a[64:67], v[32:35]
    ds_read_b64_tr_b16 a[108:109], v21 offset:43136
    s_waitcnt lgkmcnt(11)
    v_mfma_f32_16x16x32_bf16 v[36:39], a[88:91], a[64:67], v[36:39]
    ds_read_b64_tr_b16 a[110:111], v21 offset:43648
    ds_read_b64_tr_b16 a[112:113], v22 offset:43136
    v_mfma_f32_16x16x32_bf16 v[52:55], a[88:91], a[68:71], v[52:55]
    ds_read_b64_tr_b16 a[114:115], v22 offset:43648
    s_setprio 0
    s_waitcnt lgkmcnt(12)
    v_mfma_f32_16x16x32_bf16 v[56:59], a[92:95], a[68:71], v[56:59]
    ds_read_b64_tr_b16 a[116:117], v23 offset:43136
    v_mfma_f32_16x16x32_bf16 v[40:43], a[92:95], a[64:67], v[40:43]
    ds_read_b64_tr_b16 a[118:119], v23 offset:43648
    s_waitcnt lgkmcnt(12)
    v_mfma_f32_16x16x32_bf16 v[60:63], a[64:67], a[96:99], v[60:63]
    ds_read_b64_tr_b16 a[120:121], v84 offset:43136
    v_mfma_f32_16x16x32_bf16 v[68:71], a[68:71], a[96:99], v[68:71]
    ds_read_b64_tr_b16 a[122:123], v84 offset:43648
    s_waitcnt lgkmcnt(12)
    v_mfma_f32_16x16x32_bf16 v[72:75], a[68:71], a[100:103], v[72:75]
    ds_read_b64_tr_b16 a[124:125], v85 offset:43136
    v_mfma_f32_16x16x32_bf16 v[64:67], a[64:67], a[100:103], v[64:67]
    ds_read_b64_tr_b16 a[126:127], v85 offset:43648
    s_barrier
    s_setprio 3
    s_waitcnt lgkmcnt(10)
    v_mfma_f32_16x16x32_bf16 v[28:31], a[104:107], a[72:75], v[28:31]
    ds_read_b128 a[64:67], v80 offset:0
    ds_read_b128 a[68:71], v82 offset:0
    v_mfma_f32_16x16x32_bf16 v[44:47], a[104:107], a[76:79], v[44:47]
    ds_read_b64_tr_b16 a[80:81], v24 offset:0
    s_waitcnt lgkmcnt(11)
    v_mfma_f32_16x16x32_bf16 v[48:51], a[108:111], a[76:79], v[48:51]
    ds_read_b64_tr_b16 a[82:83], v24 offset:512
    v_mfma_f32_16x16x32_bf16 v[32:35], a[108:111], a[72:75], v[32:35]
    ds_read_b64_tr_b16 a[84:85], v25 offset:0
    s_waitcnt lgkmcnt(11)
    v_mfma_f32_16x16x32_bf16 v[36:39], a[112:115], a[72:75], v[36:39]
    ds_read_b64_tr_b16 a[86:87], v25 offset:512
    v_mfma_f32_16x16x32_bf16 v[52:55], a[112:115], a[76:79], v[52:55]
    ds_read_b64_tr_b16 a[88:89], v26 offset:0
    s_setprio 2
    s_waitcnt lgkmcnt(11)
    v_mfma_f32_16x16x32_bf16 v[56:59], a[116:119], a[76:79], v[56:59]
    ds_read_b64_tr_b16 a[90:91], v26 offset:512
    ds_read_b64_tr_b16 a[92:93], v27 offset:0
    v_mfma_f32_16x16x32_bf16 v[40:43], a[116:119], a[72:75], v[40:43]
    ds_read_b64_tr_b16 a[94:95], v27 offset:512
    s_waitcnt lgkmcnt(12)
    v_mfma_f32_16x16x32_bf16 v[60:63], a[72:75], a[120:123], v[60:63]
    ds_read_b64_tr_b16 a[96:97], v86 offset:0
    v_mfma_f32_16x16x32_bf16 v[68:71], a[76:79], a[120:123], v[68:71]
    ds_read_b64_tr_b16 a[98:99], v86 offset:512
    s_waitcnt lgkmcnt(12)
    v_mfma_f32_16x16x32_bf16 v[72:75], a[76:79], a[124:127], v[72:75]
    ds_read_b64_tr_b16 a[100:101], v87 offset:0
    v_mfma_f32_16x16x32_bf16 v[64:67], a[72:75], a[124:127], v[64:67]
    ds_read_b64_tr_b16 a[102:103], v87 offset:512
    buffer_store_dwordx4 v[100:103], v13, s[28:31], s58 offen sc1
    s_cmp_eq_u32 s42, 2
    s_cbranch_scc1 Lxe2
Lxe2_b:
    s_setprio 1
    s_waitcnt lgkmcnt(10)
    v_mfma_f32_16x16x32_bf16 v[28:31], a[80:83], a[64:67], v[28:31]
    ds_read_b128 a[72:75], v81 offset:0
    ds_read_b128 a[76:79], v83 offset:0
    v_mfma_f32_16x16x32_bf16 v[44:47], a[80:83], a[68:71], v[44:47]
    ds_read_b64_tr_b16 a[104:105], v24 offset:4096
    s_waitcnt lgkmcnt(11)
    v_mfma_f32_16x16x32_bf16 v[48:51], a[84:87], a[68:71], v[48:51]
    ds_read_b64_tr_b16 a[106:107], v24 offset:4608
    v_mfma_f32_16x16x32_bf16 v[32:35], a[84:87], a[64:67], v[32:35]
    ds_read_b64_tr_b16 a[108:109], v25 offset:4096
    s_waitcnt lgkmcnt(11)
    v_mfma_f32_16x16x32_bf16 v[36:39], a[88:91], a[64:67], v[36:39]
    ds_read_b64_tr_b16 a[110:111], v25 offset:4608
    ds_read_b64_tr_b16 a[112:113], v26 offset:4096
    v_mfma_f32_16x16x32_bf16 v[52:55], a[88:91], a[68:71], v[52:55]
    ds_read_b64_tr_b16 a[114:115], v26 offset:4608
    s_setprio 0
    s_waitcnt lgkmcnt(12)
    v_mfma_f32_16x16x32_bf16 v[56:59], a[92:95], a[68:71], v[56:59]
    ds_read_b64_tr_b16 a[116:117], v27 offset:4096
    v_mfma_f32_16x16x32_bf16 v[40:43], a[92:95], a[64:67], v[40:43]
    ds_read_b64_tr_b16 a[118:119], v27 offset:4608
    s_waitcnt lgkmcnt(12)
    v_mfma_f32_16x16x32_bf16 v[60:63], a[64:67], a[96:99], v[60:63]
    ds_read_b64_tr_b16 a[120:121], v86 offset:4096
    v_mfma_f32_16x16x32_bf16 v[68:71], a[68:71], a[96:99], v[68:71]
    ds_read_b64_tr_b16 a[122:123], v86 offset:4608
    s_waitcnt lgkmcnt(12)
    v_mfma_f32_16x16x32_bf16 v[72:75], a[68:71], a[100:103], v[72:75]
    ds_read_b64_tr_b16 a[124:125], v87 offset:4096
    v_mfma_f32_16x16x32_bf16 v[64:67], a[64:67], a[100:103], v[64:67]
    ds_read_b64_tr_b16 a[126:127], v87 offset:4608
    s_barrier
    s_setprio 3
    s_waitcnt lgkmcnt(10)
    v_mfma_f32_16x16x32_bf16 v[28:31], a[104:107], a[72:75], v[28:31]
    ds_read_b128 a[64:67], v80 offset:39040
    ds_read_b128 a[68:71], v82 offset:39040
    v_mfma_f32_16x16x32_bf16 v[44:47], a[104:107], a[76:79], v[44:47]
    ds_read_b64_tr_b16 a[80:81], v24 offset:39040
    s_waitcnt lgkmcnt(11)
    v_mfma_f32_16x16x32_bf16 v[48:51], a[108:111], a[76:79], v[48:51]
    ds_read_b64_tr_b16 a[82:83], v24 offset:39552
    v_mfma_f32_16x16x32_bf16 v[32:35], a[108:111], a[72:75], v[32:35]
    ds_read_b64_tr_b16 a[84:85], v25 offset:39040
    s_waitcnt lgkmcnt(11)
    v_mfma_f32_16x16x32_bf16 v[36:39], a[112:115], a[72:75], v[36:39]
    ds_read_b64_tr_b16 a[86:87], v25 offset:39552
    v_mfma_f32_16x16x32_bf16 v[52:55], a[112:115], a[76:79], v[52:55]
    ds_read_b64_tr_b16 a[88:89], v26 offset:39040
    s_setprio 2
    s_waitcnt lgkmcnt(11)
    v_mfma_f32_16x16x32_bf16 v[56:59], a[116:119], a[76:79], v[56:59]
    ds_read_b64_tr_b16 a[90:91], v26 offset:39552
    ds_read_b64_tr_b16 a[92:93], v27 offset:39040
    v_mfma_f32_16x16x32_bf16 v[40:43], a[116:119], a[72:75], v[40:43]
    ds_read_b64_tr_b16 a[94:95], v27 offset:39552
    s_waitcnt lgkmcnt(12)
    v_mfma_f32_16x16x32_bf16 v[60:63], a[72:75], a[120:123], v[60:63]
    ds_read_b64_tr_b16 a[96:97], v86 offset:39040
    v_mfma_f32_16x16x32_bf16 v[68:71], a[76:79], a[120:123], v[68:71]
    ds_read_b64_tr_b16 a[98:99], v86 offset:39552
    s_waitcnt lgkmcnt(12)
    v_mfma_f32_16x16x32_bf16 v[72:75], a[76:79], a[124:127], v[72:75]
    ds_read_b64_tr_b16 a[100:101], v87 offset:39040
    v_mfma_f32_16x16x32_bf16 v[64:67], a[72:75], a[124:127], v[64:67]
    ds_read_b64_tr_b16 a[102:103], v87 offset:39552
    s_cmp_eq_u32 s42, 3
    s_cbranch_scc1 Lxe3
Lxe3_b:
    s_setprio 1
    s_waitcnt lgkmcnt(10)
    v_mfma_f32_16x16x32_bf16 v[28:31], a[80:83], a[64:67], v[28:31]
    ds_read_b128 a[72:75], v81 offset:39040
    ds_read_b128 a[76:79], v83 offset:39040
    v_mfma_f32_16x16x32_bf16 v[44:47], a[80:83], a[68:71], v[44:47]
    ds_read_b64_tr_b16 a[104:105], v24 offset:43136
    s_waitcnt lgkmcnt(11)
    v_mfma_f32_16x16x32_bf16 v[48:51], a[84:87], a[68:71], v[48:51]
    ds_read_b64_tr_b16 a[106:107], v24 offset:43648
    v_mfma_f32_16x16x32_bf16 v[32:35], a[84:87], a[64:67], v[32:35]
    ds_read_b64_tr_b16 a[108:109], v25 offset:43136
    s_waitcnt lgkmcnt(11)
    v_mfma_f32_16x16x32_bf16 v[36:39], a[88:91], a[64:67], v[36:39]
    ds_read_b64_tr_b16 a[110:111], v25 offset:43648
    ds_read_b64_tr_b16 a[112:113], v26 offset:43136
    v_mfma_f32_16x16x32_bf16 v[52:55], a[88:91], a[68:71], v[52:55]
    ds_read_b64_tr_b16 a[114:115], v26 offset:43648
    s_setprio 0
    s_waitcnt lgkmcnt(12)
    v_mfma_f32_16x16x32_bf16 v[56:59], a[92:95], a[68:71], v[56:59]
    ds_read_b64_tr_b16 a[116:117], v27 offset:43136
    v_mfma_f32_16x16x32_bf16 v[40:43], a[92:95], a[64:67], v[40:43]
    ds_read_b64_tr_b16 a[118:119], v27 offset:43648
    s_waitcnt lgkmcnt(12)
    v_mfma_f32_16x16x32_bf16 v[60:63], a[64:67], a[96:99], v[60:63]
    ds_read_b64_tr_b16 a[120:121], v86 offset:43136
    v_mfma_f32_16x16x32_bf16 v[68:71], a[68:71], a[96:99], v[68:71]
    ds_read_b64_tr_b16 a[122:123], v86 offset:43648
    s_waitcnt lgkmcnt(12)
    v_mfma_f32_16x16x32_bf16 v[72:75], a[68:71], a[100:103], v[72:75]
    ds_read_b64_tr_b16 a[124:125], v87 offset:43136
    v_mfma_f32_16x16x32_bf16 v[64:67], a[64:67], a[100:103], v[64:67]
    ds_read_b64_tr_b16 a[126:127], v87 offset:43648
    s_barrier
    s_setprio 3
    s_waitcnt lgkmcnt(10)
    v_mfma_f32_16x16x32_bf16 v[28:31], a[104:107], a[72:75], v[28:31]
    ds_read_b128 a[64:67], v76 offset:0
    ds_read_b128 a[68:71], v78 offset:0
    v_mfma_f32_16x16x32_bf16 v[44:47], a[104:107], a[76:79], v[44:47]
    ds_read_b64_tr_b16 a[80:81], v20 offset:0
    s_waitcnt lgkmcnt(11)
    v_mfma_f32_16x16x32_bf16 v[48:51], a[108:111], a[76:79], v[48:51]
    ds_read_b64_tr_b16 a[82:83], v20 offset:512
    v_mfma_f32_16x16x32_bf16 v[32:35], a[108:111], a[72:75], v[32:35]
    ds_read_b64_tr_b16 a[84:85], v21 offset:0
    s_waitcnt lgkmcnt(11)
    v_mfma_f32_16x16x32_bf16 v[36:39], a[112:115], a[72:75], v[36:39]
    ds_read_b64_tr_b16 a[86:87], v21 offset:512
    v_mfma_f32_16x16x32_bf16 v[52:55], a[112:115], a[76:79], v[52:55]
    ds_read_b64_tr_b16 a[88:89], v22 offset:0
    s_setprio 2
    s_waitcnt lgkmcnt(11)
    v_mfma_f32_16x16x32_bf16 v[56:59], a[116:119], a[76:79], v[56:59]
    ds_read_b64_tr_b16 a[90:91], v22 offset:512
    ds_read_b64_tr_b16 a[92:93], v23 offset:0
    v_mfma_f32_16x16x32_bf16 v[40:43], a[116:119], a[72:75], v[40:43]
    ds_read_b64_tr_b16 a[94:95], v23 offset:512
    s_waitcnt lgkmcnt(12)
    v_mfma_f32_16x16x32_bf16 v[60:63], a[72:75], a[120:123], v[60:63]
    ds_read_b64_tr_b16 a[96:97], v84 offset:0
    v_mfma_f32_16x16x32_bf16 v[68:71], a[76:79], a[120:123], v[68:71]
    ds_read_b64_tr_b16 a[98:99], v84 offset:512
    s_waitcnt lgkmcnt(12)
    v_mfma_f32_16x16x32_bf16 v[72:75], a[76:79], a[124:127], v[72:75]
    ds_read_b64_tr_b16 a[100:101], v85 offset:0
    v_mfma_f32_16x16x32_bf16 v[64:67], a[72:75], a[124:127], v[64:67]
    ds_read_b64_tr_b16 a[102:103], v85 offset:512
    buffer_store_dwordx4 v[100:103], v13, s[28:31], s23 offen offset:0 sc1
    s_cmp_eq_u32 s42, 4
    s_cbranch_scc1 Lxe4
Lxe4_b:
    s_setprio 1
    s_waitcnt lgkmcnt(10)
    v_mfma_f32_16x16x32_bf16 v[28:31], a[80:83], a[64:67], v[28:31]
    ds_read_b128 a[72:75], v77 offset:0
    ds_read_b128 a[76:79], v79 offset:0
    v_mfma_f32_16x16x32_bf16 v[44:47], a[80:83], a[68:71], v[44:47]
    ds_read_b64_tr_b16 a[104:105], v20 offset:4096
    s_waitcnt lgkmcnt(11)
    v_mfma_f32_16x16x32_bf16 v[48:51], a[84:87], a[68:71], v[48:51]
    ds_read_b64_tr_b16 a[106:107], v20 offset:4608
    v_mfma_f32_16x16x32_bf16 v[32:35], a[84:87], a[64:67], v[32:35]
    ds_read_b64_tr_b16 a[108:109], v21 offset:4096
    s_waitcnt lgkmcnt(11)
    v_mfma_f32_16x16x32_bf16 v[36:39], a[88:91], a[64:67], v[36:39]
    ds_read_b64_tr_b16 a[110:111], v21 offset:4608
    ds_read_b64_tr_b16 a[112:113], v22 offset:4096
    v_mfma_f32_16x16x32_bf16 v[52:55], a[88:91], a[68:71], v[52:55]
    ds_read_b64_tr_b16 a[114:115], v22 offset:4608
    s_setprio 0
    s_waitcnt lgkmcnt(12)
    v_mfma_f32_16x16x32_bf16 v[56:59], a[92:95], a[68:71], v[56:59]
    ds_read_b64_tr_b16 a[116:117], v23 offset:4096
    v_mfma_f32_16x16x32_bf16 v[40:43], a[92:95], a[64:67], v[40:43]
    ds_read_b64_tr_b16 a[118:119], v23 offset:4608
    s_waitcnt lgkmcnt(12)
    v_mfma_f32_16x16x32_bf16 v[60:63], a[64:67], a[96:99], v[60:63]
    ds_read_b64_tr_b16 a[120:121], v84 offset:4096
    v_mfma_f32_16x16x32_bf16 v[68:71], a[68:71], a[96:99], v[68:71]
    ds_read_b64_tr_b16 a[122:123], v84 offset:4608
    s_waitcnt lgkmcnt(12)
    v_mfma_f32_16x16x32_bf16 v[72:75], a[68:71], a[100:103], v[72:75]
    ds_read_b64_tr_b16 a[124:125], v85 offset:4096
    v_mfma_f32_16x16x32_bf16 v[64:67], a[64:67], a[100:103], v[64:67]
    ds_read_b64_tr_b16 a[126:127], v85 offset:4608
    s_barrier
    s_setprio 3
    s_waitcnt lgkmcnt(10)
    v_mfma_f32_16x16x32_bf16 v[28:31], a[104:107], a[72:75], v[28:31]
    ds_read_b128 a[64:67], v76 offset:39040
    ds_read_b128 a[68:71], v78 offset:39040
    v_mfma_f32_16x16x32_bf16 v[44:47], a[104:107], a[76:79], v[44:47]
    ds_read_b64_tr_b16 a[80:81], v20 offset:39040
    s_waitcnt lgkmcnt(11)
    v_mfma_f32_16x16x32_bf16 v[48:51], a[108:111], a[76:79], v[48:51]
    ds_read_b64_tr_b16 a[82:83], v20 offset:39552
    v_mfma_f32_16x16x32_bf16 v[32:35], a[108:111], a[72:75], v[32:35]
    ds_read_b64_tr_b16 a[84:85], v21 offset:39040
    s_waitcnt lgkmcnt(11)
    v_mfma_f32_16x16x32_bf16 v[36:39], a[112:115], a[72:75], v[36:39]
    ds_read_b64_tr_b16 a[86:87], v21 offset:39552
    v_mfma_f32_16x16x32_bf16 v[52:55], a[112:115], a[76:79], v[52:55]
    ds_read_b64_tr_b16 a[88:89], v22 offset:39040
    s_setprio 2
    s_waitcnt lgkmcnt(11)
    v_mfma_f32_16x16x32_bf16 v[56:59], a[116:119], a[76:79], v[56:59]
    ds_read_b64_tr_b16 a[90:91], v22 offset:39552
    ds_read_b64_tr_b16 a[92:93], v23 offset:39040
    v_mfma_f32_16x16x32_bf16 v[40:43], a[116:119], a[72:75], v[40:43]
    ds_read_b64_tr_b16 a[94:95], v23 offset:39552
    s_waitcnt lgkmcnt(12)
    v_mfma_f32_16x16x32_bf16 v[60:63], a[72:75], a[120:123], v[60:63]
    ds_read_b64_tr_b16 a[96:97], v84 offset:39040
    v_mfma_f32_16x16x32_bf16 v[68:71], a[76:79], a[120:123], v[68:71]
    ds_read_b64_tr_b16 a[98:99], v84 offset:39552
    s_waitcnt lgkmcnt(12)
    v_mfma_f32_16x16x32_bf16 v[72:75], a[76:79], a[124:127], v[72:75]
    ds_read_b64_tr_b16 a[100:101], v85 offset:39040
    v_mfma_f32_16x16x32_bf16 v[64:67], a[72:75], a[124:127], v[64:67]
    ds_read_b64_tr_b16 a[102:103], v85 offset:39552
    s_cmp_eq_u32 s42, 5
    s_cbranch_scc1 Lxe5
Lxe5_b:
    s_setprio 1
    s_waitcnt lgkmcnt(10)
    v_mfma_f32_16x16x32_bf16 v[28:31], a[80:83], a[64:67], v[28:31]
    ds_read_b128 a[72:75], v77 offset:39040
    ds_read_b128 a[76:79], v79 offset:39040
    v_mfma_f32_16x16x32_bf16 v[44:47], a[80:83], a[68:71], v[44:47]
    ds_read_b64_tr_b16 a[104:105], v20 offset:43136
    s_waitcnt lgkmcnt(11)
    v_mfma_f32_16x16x32_bf16 v[48:51], a[84:87], a[68:71], v[48:51]
    ds_read_b64_tr_b16 a[106:107], v20 offset:43648
    v_mfma_f32_16x16x32_bf16 v[32:35], a[84:87], a[64:67], v[32:35]
    ds_read_b64_tr_b16 a[108:109], v21 offset:43136
    s_waitcnt lgkmcnt(11)
    v_mfma_f32_16x16x32_bf16 v[36:39], a[88:91], a[64:67], v[36:39]
    ds_read_b64_tr_b16 a[110:111], v21 offset:43648
    ds_read_b64_tr_b16 a[112:113], v22 offset:43136
    v_mfma_f32_16x16x32_bf16 v[52:55], a[88:91], a[68:71], v[52:55]
    ds_read_b64_tr_b16 a[114:115], v22 offset:43648
    s_setprio 0
    s_waitcnt lgkmcnt(12)
    v_mfma_f32_16x16x32_bf16 v[56:59], a[92:95], a[68:71], v[56:59]
    ds_read_b64_tr_b16 a[116:117], v23 offset:43136
    v_mfma_f32_16x16x32_bf16 v[40:43], a[92:95], a[64:67], v[40:43]
    ds_read_b64_tr_b16 a[118:119], v23 offset:43648
    s_waitcnt lgkmcnt(12)
    v_mfma_f32_16x16x32_bf16 v[60:63], a[64:67], a[96:99], v[60:63]
    ds_read_b64_tr_b16 a[120:121], v84 offset:43136
    v_mfma_f32_16x16x32_bf16 v[68:71], a[68:71], a[96:99], v[68:71]
    ds_read_b64_tr_b16 a[122:123], v84 offset:43648
    s_waitcnt lgkmcnt(12)
    v_mfma_f32_16x16x32_bf16 v[72:75], a[68:71], a[100:103], v[72:75]
    ds_read_b64_tr_b16 a[124:125], v85 offset:43136
    v_mfma_f32_16x16x32_bf16 v[64:67], a[64:67], a[100:103], v[64:67]
    ds_read_b64_tr_b16 a[126:127], v85 offset:43648
    s_barrier
    s_setprio 3
    s_waitcnt lgkmcnt(10)
    v_mfma_f32_16x16x32_bf16 v[28:31], a[104:107], a[72:75], v[28:31]
    ds_read_b128 a[0:3], v80 offset:0
    v_mfma_f32_16x16x32_bf16 v[44:47], a[104:107], a[76:79], v[44:47]
    ds_read_b128 a[4:7], v82 offset:0
    s_waitcnt lgkmcnt(10)
    v_mfma_f32_16x16x32_bf16 v[48:51], a[108:111], a[76:79], v[48:51]
    ds_read_b64_tr_b16 a[80:81], v24 offset:0
    v_mfma_f32_16x16x32_bf16 v[32:35], a[108:111], a[72:75], v[32:35]
    ds_read_b64_tr_b16 a[82:83], v24 offset:512
    s_waitcnt lgkmcnt(10)
    v_mfma_f32_16x16x32_bf16 v[36:39], a[112:115], a[72:75], v[36:39]
    ds_read_b64_tr_b16 a[84:85], v25 offset:0
    v_mfma_f32_16x16x32_bf16 v[52:55], a[112:115], a[76:79], v[52:55]
    s_setprio 2
    s_waitcnt lgkmcnt(9)
    v_mfma_f32_16x16x32_bf16 v[56:59], a[116:119], a[76:79], v[56:59]
    ds_read_b64_tr_b16 a[86:87], v25 offset:512
    v_mfma_f32_16x16x32_bf16 v[40:43], a[116:119], a[72:75], v[40:43]
    ds_read_b64_tr_b16 a[88:89], v26 offset:0
    s_waitcnt lgkmcnt(9)
    v_mfma_f32_16x16x32_bf16 v[60:63], a[72:75], a[120:123], v[60:63]
    ds_read_b64_tr_b16 a[90:91], v26 offset:512
    v_mfma_f32_16x16x32_bf16 v[68:71], a[76:79], a[120:123], v[68:71]
    ds_read_b64_tr_b16 a[92:93], v27 offset:0
    s_waitcnt lgkmcnt(9)
    v_mfma_f32_16x16x32_bf16 v[72:75], a[76:79], a[124:127], v[72:75]
    ds_read_b64_tr_b16 a[94:95], v27 offset:512
    v_mfma_f32_16x16x32_bf16 v[64:67], a[72:75], a[124:127], v[64:67]
    buffer_store_dwordx4 v[100:103], v13, s[28:31], s23 offen offset:1024 sc1
    s_cmp_eq_u32 s42, 6
    s_cbranch_scc1 Lxe6
Lxe6_b:
    s_setprio 1
    s_waitcnt lgkmcnt(6)
    v_mfma_f32_16x16x32_bf16 v[28:31], a[80:83], a[0:3], v[28:31]
    ds_read_b128 a[8:11], v81 offset:0
    ds_read_b128 a[12:15], v83 offset:0
    v_mfma_f32_16x16x32_bf16 v[44:47], a[80:83], a[4:7], v[44:47]
    ds_read_b64_tr_b16 a[104:105], v24 offset:4096
    s_waitcnt lgkmcnt(7)
    v_mfma_f32_16x16x32_bf16 v[48:51], a[84:87], a[4:7], v[48:51]
    ds_read_b64_tr_b16 a[106:107], v24 offset:4608
    ds_read_b64_tr_b16 a[108:109], v25 offset:4096
    v_mfma_f32_16x16x32_bf16 v[32:35], a[84:87], a[0:3], v[32:35]
    ds_read_b64_tr_b16 a[110:111], v25 offset:4608
    s_setprio 0
    s_waitcnt lgkmcnt(8)
    v_mfma_f32_16x16x32_bf16 v[36:39], a[88:91], a[0:3], v[36:39]
    v_mfma_f32_16x16x32_bf16 v[52:55], a[88:91], a[4:7], v[52:55]
    ds_read_b64_tr_b16 a[112:113], v26 offset:4096
    ds_read_b64_tr_b16 a[114:115], v26 offset:4608
    s_waitcnt lgkmcnt(8)
    v_mfma_f32_16x16x32_bf16 v[56:59], a[92:95], a[4:7], v[56:59]
    ds_read_b64_tr_b16 a[116:117], v27 offset:4096
    v_mfma_f32_16x16x32_bf16 v[40:43], a[92:95], a[0:3], v[40:43]
    ds_read_b64_tr_b16 a[118:119], v27 offset:4608
    s_barrier
    s_setprio 3
    s_waitcnt lgkmcnt(6)
    v_mfma_f32_16x16x32_bf16 v[28:31], a[104:107], a[8:11], v[28:31]
    ds_read_b128 a[16:19], v80 offset:39040
    ds_read_b128 a[20:23], v82 offset:39040
    v_mfma_f32_16x16x32_bf16 v[44:47], a[104:107], a[12:15], v[44:47]
    ds_read_b64_tr_b16 a[80:81], v24 offset:39040
    s_waitcnt lgkmcnt(7)
    v_mfma_f32_16x16x32_bf16 v[48:51], a[108:111], a[12:15], v[48:51]
    ds_read_b64_tr_b16 a[82:83], v24 offset:39552
    v_mfma_f32_16x16x32_bf16 v[32:35], a[108:111], a[8:11], v[32:35]
    ds_read_b64_tr_b16 a[84:85], v25 offset:39040
    s_setprio 2
    s_waitcnt lgkmcnt(7)
    v_mfma_f32_16x16x32_bf16 v[36:39], a[112:115], a[8:11], v[36:39]
    ds_read_b64_tr_b16 a[86:87], v25 offset:39552
    ds_read_b64_tr_b16 a[88:89], v26 offset:39040
    v_mfma_f32_16x16x32_bf16 v[52:55], a[112:115], a[12:15], v[52:55]
    ds_read_b64_tr_b16 a[90:91], v26 offset:39552
    s_waitcnt lgkmcnt(8)
    v_mfma_f32_16x16x32_bf16 v[56:59], a[116:119], a[12:15], v[56:59]
    ds_read_b64_tr_b16 a[92:93], v27 offset:39040
    v_mfma_f32_16x16x32_bf16 v[40:43], a[116:119], a[8:11], v[40:43]
    ds_read_b64_tr_b16 a[94:95], v27 offset:39552
    s_cmp_eq_u32 s42, 7
    s_cbranch_scc1 Lxe7
Lxe7_b:
    s_setprio 1
    s_waitcnt lgkmcnt(6)
    v_mfma_f32_16x16x32_bf16 v[28:31], a[80:83], a[16:19], v[28:31]
    ds_read_b128 a[24:27], v81 offset:39040
    ds_read_b128 a[28:31], v83 offset:39040
    v_mfma_f32_16x16x32_bf16 v[44:47], a[80:83], a[20:23], v[44:47]
    ds_read_b64_tr_b16 a[104:105], v24 offset:43136
    s_waitcnt lgkmcnt(7)
    v_mfma_f32_16x16x32_bf16 v[48:51], a[84:87], a[20:23], v[48:51]
    ds_read_b64_tr_b16 a[106:107], v24 offset:43648
    ds_read_b64_tr_b16 a[108:109], v25 offset:43136
    v_mfma_f32_16x16x32_bf16 v[32:35], a[84:87], a[16:19], v[32:35]
    ds_read_b64_tr_b16 a[110:111], v25 offset:43648
    s_setprio 0
    s_waitcnt lgkmcnt(8)
    v_mfma_f32_16x16x32_bf16 v[36:39], a[88:91], a[16:19], v[36:39]
    v_mfma_f32_16x16x32_bf16 v[52:55], a[88:91], a[20:23], v[52:55]
    ds_read_b64_tr_b16 a[112:113], v26 offset:43136
    ds_read_b64_tr_b16 a[114:115], v26 offset:43648
    s_waitcnt lgkmcnt(8)
    v_mfma_f32_16x16x32_bf16 v[56:59], a[92:95], a[20:23], v[56:59]
    ds_read_b64_tr_b16 a[116:117], v27 offset:43136
    v_mfma_f32_16x16x32_bf16 v[40:43], a[92:95], a[16:19], v[40:43]
    ds_read_b64_tr_b16 a[118:119], v27 offset:43648
    s_barrier
    s_setprio 3
    s_waitcnt lgkmcnt(6)
    v_mfma_f32_16x16x32_bf16 v[28:31], a[104:107], a[24:27], v[28:31]
    ds_read_b128 a[32:35], v76 offset:0
    ds_read_b128 a[36:39], v78 offset:0
    v_mfma_f32_16x16x32_bf16 v[44:47], a[104:107], a[28:31], v[44:47]
    ds_read_b64_tr_b16 a[80:81], v20 offset:0
    s_waitcnt lgkmcnt(7)
    v_mfma_f32_16x16x32_bf16 v[48:51], a[108:111], a[28:31], v[48:51]
    ds_read_b64_tr_b16 a[82:83], v20 offset:512
    v_mfma_f32_16x16x32_bf16 v[32:35], a[108:111], a[24:27], v[32:35]
    ds_read_b64_tr_b16 a[84:85], v21 offset:0
    s_setprio 2
    s_waitcnt lgkmcnt(7)
    v_mfma_f32_16x16x32_bf16 v[36:39], a[112:115], a[24:27], v[36:39]
    ds_read_b64_tr_b16 a[86:87], v21 offset:512
    ds_read_b64_tr_b16 a[88:89], v22 offset:0
    v_mfma_f32_16x16x32_bf16 v[52:55], a[112:115], a[28:31], v[52:55]
    ds_read_b64_tr_b16 a[90:91], v22 offset:512
    s_waitcnt lgkmcnt(8)
    v_mfma_f32_16x16x32_bf16 v[56:59], a[116:119], a[28:31], v[56:59]
    ds_read_b64_tr_b16 a[92:93], v23 offset:0
    v_mfma_f32_16x16x32_bf16 v[40:43], a[116:119], a[24:27], v[40:43]
    ds_read_b64_tr_b16 a[94:95], v23 offset:512
    s_cmp_eq_u32 s42, 8
    s_cbranch_scc1 Lxe8
Lxe8_b:
    s_setprio 1
    s_waitcnt lgkmcnt(6)
    v_mfma_f32_16x16x32_bf16 v[28:31], a[80:83], a[32:35], v[28:31]
    ds_read_b128 a[40:43], v77 offset:0
    ds_read_b128 a[44:47], v79 offset:0
    v_mfma_f32_16x16x32_bf16 v[44:47], a[80:83], a[36:39], v[44:47]
    ds_read_b64_tr_b16 a[104:105], v20 offset:4096
    s_waitcnt lgkmcnt(7)
    v_mfma_f32_16x16x32_bf16 v[48:51], a[84:87], a[36:39], v[48:51]
    ds_read_b64_tr_b16 a[106:107], v20 offset:4608
    v_mfma_f32_16x16x32_bf16 v[32:35], a[84:87], a[32:35], v[32:35]
    ds_read_b64_tr_b16 a[108:109], v21 offset:4096
    s_setprio 0
    s_waitcnt lgkmcnt(7)
    v_mfma_f32_16x16x32_bf16 v[36:39], a[88:91], a[32:35], v[36:39]
    ds_read_b64_tr_b16 a[110:111], v21 offset:4608
    ds_read_b64_tr_b16 a[112:113], v22 offset:4096
    v_mfma_f32_16x16x32_bf16 v[52:55], a[88:91], a[36:39], v[52:55]
    ds_read_b64_tr_b16 a[114:115], v22 offset:4608
    s_waitcnt lgkmcnt(8)
    v_mfma_f32_16x16x32_bf16 v[56:59], a[92:95], a[36:39], v[56:59]
    ds_read_b64_tr_b16 a[116:117], v23 offset:4096
    v_mfma_f32_16x16x32_bf16 v[40:43], a[92:95], a[32:35], v[40:43]
    ds_read_b64_tr_b16 a[118:119], v23 offset:4608
    s_waitcnt lgkmcnt(0)
    s_barrier
    s_setprio 3
    v_mfma_f32_16x16x32_bf16 v[28:31], a[104:107], a[40:43], v[28:31]
    ds_read_b128 a[48:51], v76 offset:39040
    ds_read_b128 a[52:55], v78 offset:39040
    v_mfma_f32_16x16x32_bf16 v[44:47], a[104:107], a[44:47], v[44:47]
    ds_read_b64_tr_b16 a[80:81], v20 offset:39040
    v_mfma_f32_16x16x32_bf16 v[48:51], a[108:111], a[44:47], v[48:51]
    ds_read_b64_tr_b16 a[82:83], v20 offset:39552
    v_mfma_f32_16x16x32_bf16 v[32:35], a[108:111], a[40:43], v[32:35]
    ds_read_b64_tr_b16 a[84:85], v21 offset:39040
    s_setprio 2
    v_mfma_f32_16x16x32_bf16 v[36:39], a[112:115], a[40:43], v[36:39]
    ds_read_b64_tr_b16 a[86:87], v21 offset:39552
    ds_read_b64_tr_b16 a[88:89], v22 offset:39040
    v_mfma_f32_16x16x32_bf16 v[52:55], a[112:115], a[44:47], v[52:55]
    ds_read_b64_tr_b16 a[90:91], v22 offset:39552
    v_mfma_f32_16x16x32_bf16 v[56:59], a[116:119], a[44:47], v[56:59]
    ds_read_b64_tr_b16 a[92:93], v23 offset:39040
    v_mfma_f32_16x16x32_bf16 v[40:43], a[116:119], a[40:43], v[40:43]
    ds_read_b64_tr_b16 a[94:95], v23 offset:39552
    v_mov_b32 v98, s34
    s_waitcnt vmcnt(0)
    s_mov_b64 exec, 1
    buffer_store_dword v98, v97, s[28:31], s24 offen sc1
    s_mov_b64 exec, -1
    s_cmp_eq_u32 s42, 9
    s_cbranch_scc1 Lxe9
Lxe9_b:
    s_setprio 1
    s_waitcnt lgkmcnt(6)
    v_mfma_f32_16x16x32_bf16 v[28:31], a[80:83], a[48:51], v[28:31]
    ds_read_b128 a[56:59], v77 offset:39040
    ds_read_b128 a[60:63], v79 offset:39040
    ds_read_b64_tr_b16 a[104:105], v20 offset:43136
    v_mfma_f32_16x16x32_bf16 v[44:47], a[80:83], a[52:55], v[44:47]
    ds_read_b64_tr_b16 a[106:107], v20 offset:43648
    ds_read_b64_tr_b16 a[108:109], v21 offset:43136
    s_waitcnt lgkmcnt(9)
    v_mfma_f32_16x16x32_bf16 v[48:51], a[84:87], a[52:55], v[48:51]
    ds_read_b64_tr_b16 a[110:111], v21 offset:43648
    ds_read_b64_tr_b16 a[112:113], v22 offset:43136
    ds_read_b64_tr_b16 a[114:115], v22 offset:43648
    v_mfma_f32_16x16x32_bf16 v[32:35], a[84:87], a[48:51], v[32:35]
    ds_read_b64_tr_b16 a[116:117], v23 offset:43136
    ds_read_b64_tr_b16 a[118:119], v23 offset:43648
    s_setprio 0
    s_waitcnt lgkmcnt(12)
    v_mfma_f32_16x16x32_bf16 v[36:39], a[88:91], a[48:51], v[36:39]
    ds_read_b32 v120, v94
    ds_read_b32 v121, v94 offset:512
    v_xor_b32 v94, 64, v94
    v_mfma_f32_16x16x32_bf16 v[52:55], a[88:91], a[52:55], v[52:55]
    ds_read_b32 v122, v94
    ds_read_b32 v123, v92 offset:512
    s_waitcnt lgkmcnt(14)
    v_mfma_f32_16x16x32_bf16 v[56:59], a[92:95], a[52:55], v[56:59]
    ds_read_b32 v126, v93 offset:520
    v_mov_b32 v24, v84
    v_mov_b32 v25, v85
    v_mfma_f32_16x16x32_bf16 v[40:43], a[92:95], a[48:51], v[40:43]
    v_mov_b32 v26, v86
    v_mov_b32 v27, v87
    s_waitcnt lgkmcnt(5)
    v_mfma_f32_16x16x32_bf16 v[44:47], a[104:107], a[60:63], v[44:47]
    v_mfma_f32_16x16x32_bf16 v[48:51], a[108:111], a[60:63], v[48:51]
    v_mfma_f32_16x16x32_bf16 v[52:55], a[112:115], a[60:63], v[52:55]
    v_mfma_f32_16x16x32_bf16 v[56:59], a[116:119], a[60:63], v[56:59]
    v_mfma_f32_16x16x32_bf16 v[28:31], a[104:107], a[56:59], v[28:31]
    v_mfma_f32_16x16x32_bf16 v[32:35], a[108:111], a[56:59], v[32:35]
    ds_read_b32 v7, v96
    ds_read_b128 v[76:79], v95 offset:0
    ds_read_b128 v[80:83], v95 offset:64
    ds_read_b128 v[84:87], v95 offset:128
    ds_read_b128 v[88:91], v95 offset:192
    v_mfma_f32_16x16x32_bf16 v[36:39], a[112:115], a[56:59], v[36:39]
    v_mfma_f32_16x16x32_bf16 v[40:43], a[116:119], a[56:59], v[40:43]
    s_waitcnt lgkmcnt(0)
Lqf:
    v_readfirstlane_b32 s38, v7
    s_nop 0
    s_cmp_eq_u32 s38, 0
    s_cbranch_scc1 Lqf_re
    s_cmp_eq_u32 s27, 0
    v_fmac_f32 v44, v76, v122
    v_fmac_f32 v45, v77, v122
    v_fmac_f32 v46, v78, v122
    v_fmac_f32 v47, v79, v122
    v_cvt_pk_bf16_f32 v44, v44, v45
    v_cvt_pk_bf16_f32 v45, v46, v47
    v_fmac_f32 v48, v80, v122
    v_fmac_f32 v49, v81, v122
    v_fmac_f32 v50, v82, v122
    v_fmac_f32 v51, v83, v122
    v_cvt_pk_bf16_f32 v46, v48, v49
    v_cvt_pk_bf16_f32 v47, v50, v51
    v_fmac_f32 v52, v84, v122
    v_fmac_f32 v53, v85, v122
    v_fmac_f32 v54, v86, v122
    v_fmac_f32 v55, v87, v122
    v_cvt_pk_bf16_f32 v48, v52, v53
    v_cvt_pk_bf16_f32 v49, v54, v55
    v_fmac_f32 v56, v88, v122
    v_fmac_f32 v57, v89, v122
    v_fmac_f32 v58, v90, v122
    v_fmac_f32 v59, v91, v122
    v_cvt_pk_bf16_f32 v50, v56, v57
    v_cvt_pk_bf16_f32 v51, v58, v59
    s_cbranch_scc1 Lh1
    s_setprio 3
    ds_write_b128 v125, v[44:47] offset:2048
    ds_write_b128 v125, v[48:51] offset:3072
    v_fmac_f32 v28, v76, v120
    v_fmac_f32 v29, v77, v120
    v_fmac_f32 v30, v78, v120
    v_fmac_f32 v31, v79, v120
    v_cvt_pk_bf16_f32 v52, v28, v29
    v_cvt_pk_bf16_f32 v53, v30, v31
    v_fmac_f32 v32, v80, v120
    v_fmac_f32 v33, v81, v120
    v_fmac_f32 v34, v82, v120
    v_fmac_f32 v35, v83, v120
    v_cvt_pk_bf16_f32 v54, v32, v33
    v_cvt_pk_bf16_f32 v55, v34, v35
    v_fmac_f32 v36, v84, v120
    v_fmac_f32 v37, v85, v120
    v_fmac_f32 v38, v86, v120
    v_fmac_f32 v39, v87, v120
    v_cvt_pk_bf16_f32 v56, v36, v37
    v_cvt_pk_bf16_f32 v57, v38, v39
    v_fmac_f32 v40, v88, v120
    v_fmac_f32 v41, v89, v120
    v_fmac_f32 v42, v90, v120
    v_fmac_f32 v43, v91, v120
    v_cvt_pk_bf16_f32 v58, v40, v41
    v_cvt_pk_bf16_f32 v59, v42, v43
    ds_write_b128 v125, v[52:55] offset:4096
    ds_write_b128 v125, v[56:59] offset:5120
    v_mov_b32 v5, 157972
    v_mov_b32 v6, 1
    s_mov_b64 exec, 1
    ds_add_u32 v5, v6
    s_mov_b64 exec, -1
    v_mov_b32 v8, s22
    v_mov_b32 v9, s22
    v_mov_b32 v10, s22
    v_mov_b32 v11, s22
Lcw_1:
    s_sub_u32 s35, s35, 1
    s_cbranch_scc1 Lend
    ds_read_b32 v6, v5
    s_waitcnt lgkmcnt(0)
    v_readfirstlane_b32 s38, v6
    s_nop 0
    s_cmp_lt_u32 s38, 8
    s_cbranch_scc1 Lcw_1
    ds_read_b128 v[28:31], v125 offset:0
    ds_read_b128 v[32:35], v125 offset:1024
Lh_join:
    buffer_load_dword v20, v12, s[28:31], s24 offen sc1
    ds_read_b64_tr_b16 a[64:65], v26 offset:0
    ds_read_b64_tr_b16 a[66:67], v26 offset:512
    ds_read_b64_tr_b16 a[68:69], v27 offset:0
    ds_read_b64_tr_b16 a[70:71], v27 offset:512
    ds_read_b64_tr_b16 a[72:73], v26 offset:4096
    ds_read_b64_tr_b16 a[74:75], v26 offset:4608
    ds_read_b64_tr_b16 a[76:77], v27 offset:4096
    ds_read_b64_tr_b16 a[78:79], v27 offset:4608
    s_waitcnt lgkmcnt(8)
    s_setprio 3
    v_cndmask_b32 v92, 0, v30, s[6:7]
    v_cndmask_b32 v93, 0, v31, s[6:7]
    v_cndmask_b32 v94, 0, v32, s[12:13]
    v_cndmask_b32 v95, 0, v33, s[12:13]
    v_cndmask_b32 v104, 0, v30, s[8:9]
    v_cndmask_b32 v105, 0, v31, s[8:9]
    v_mfma_f32_16x16x32_bf16 v[76:79], v[46:49], v[92:95], v[8:11]
    v_mfma_f32_16x16x32_bf16 v[80:83], v[54:57], v[92:95], 0
    v_cndmask_b32 v106, 0, v32, s[14:15]
    v_cndmask_b32 v107, 0, v33, s[14:15]
    v_mov_b32 v96, v28
    v_mov_b32 v97, v29
    v_mfma_f32_16x16x32_bf16 v[84:87], v[46:49], v[104:107], v[8:11]
    v_mfma_f32_16x16x32_bf16 v[88:91], v[54:57], v[104:107], 0
    v_cndmask_b32 v98, 0, v30, s[10:11]
    v_cndmask_b32 v99, 0, v31, s[10:11]
    v_cndmask_b32 v100, 0, v32, s[16:17]
    v_cndmask_b32 v101, 0, v33, s[16:17]
    v_mfma_f32_16x16x32_bf16 v[36:39], v[44:47], v[96:99], v[8:11]
    v_mfma_f32_16x16x32_bf16 v[40:43], v[52:55], v[96:99], 0
    v_cndmask_b32 v76, v76, v77, s[4:5]
    v_cndmask_b32 v80, v80, v81, s[4:5]
    v_cndmask_b32 v78, v78, v79, s[4:5]
    v_cndmask_b32 v82, v82, v83, s[4:5]
    v_cndmask_b32 v92, v76, v80, s[18:19]
    v_cndmask_b32 v94, v78, v82, s[20:21]
    v_min_u32 v4, -2, v92
    v_min_u32 v5, -2, v94
    v_cndmask_b32 v84, v84, v85, s[4:5]
    v_cndmask_b32 v88, v88, v89, s[4:5]
    v_cndmask_b32 v86, v86, v87, s[4:5]
    v_cndmask_b32 v90, v90, v91, s[4:5]
    v_cndmask_b32 v104, v84, v88, s[18:19]
    v_cndmask_b32 v106, v86, v90, s[20:21]
    v_min_u32 v6, -2, v104
    v_min_u32 v7, -2, v106
    buffer_store_dwordx4 v[4:7], v13, s[28:31], s58 offen sc0 sc1
    s_setprio 2
    ds_read_b64_tr_b16 a[80:81], v26 offset:39040
    ds_read_b64_tr_b16 a[82:83], v26 offset:39552
    ds_read_b64_tr_b16 a[84:85], v27 offset:39040
    ds_read_b64_tr_b16 a[86:87], v27 offset:39552
    ds_read_b64_tr_b16 a[88:89], v26 offset:43136
    ds_read_b64_tr_b16 a[90:91], v26 offset:43648
    ds_read_b64_tr_b16 a[92:93], v27 offset:43136
    ds_read_b64_tr_b16 a[94:95], v27 offset:43648
    ds_read_b64_tr_b16 a[96:97], v24 offset:0
    ds_read_b64_tr_b16 a[98:99], v24 offset:512
    ds_read_b64_tr_b16 a[100:101], v25 offset:0
    ds_read_b64_tr_b16 a[102:103], v25 offset:512
    ds_read_b64_tr_b16 a[104:105], v24 offset:4096
    ds_read_b64_tr_b16 a[106:107], v24 offset:4608
    ds_read_b64_tr_b16 a[108:109], v25 offset:4096
    ds_read_b64_tr_b16 a[110:111], v25 offset:4608
    ds_read_b64_tr_b16 a[112:113], v24 offset:39040
    ds_read_b64_tr_b16 a[114:115], v24 offset:39552
    ds_read_b64_tr_b16 a[116:117], v25 offset:39040
    ds_read_b64_tr_b16 a[118:119], v25 offset:39552
    ds_read_b64_tr_b16 a[120:121], v24 offset:43136
    ds_read_b64_tr_b16 a[122:123], v24 offset:43648
    ds_read_b64_tr_b16 a[124:125], v25 offset:43136
    ds_read_b64_tr_b16 a[126:127], v25 offset:43648
    s_waitcnt lgkmcnt(15)
    v_mfma_f32_16x16x32_bf16 v[60:63], a[0:3], a[64:67], v[60:63]
    v_mov_b32 v102, v34
    v_mov_b32 v103, v35
    v_mul_f32 v4, s25, v121
    v_mfma_f32_16x16x32_bf16 v[68:71], a[4:7], a[64:67], v[68:71]
    v_mfma_f32_16x16x32_bf16 v[76:79], v[48:51], v[100:103], v[8:11]
    v_mfma_f32_16x16x32_bf16 v[80:83], v[56:59], v[100:103], 0
    v_mul_f32 v123, v123, v4
    v_mfma_f32_16x16x32_bf16 v[64:67], a[0:3], a[68:71], v[64:67]
    v_mul_f32 v126, v126, v4
    v_cndmask_b32 v36, v36, v37, s[4:5]
    v_cndmask_b32 v40, v40, v41, s[4:5]
    v_mfma_f32_16x16x32_bf16 v[72:75], a[4:7], a[68:71], v[72:75]
    v_cndmask_b32 v38, v38, v39, s[4:5]
    v_cndmask_b32 v42, v42, v43, s[4:5]
    v_cndmask_b32 v96, v36, v40, s[18:19]
    v_mfma_f32_16x16x32_bf16 v[60:63], a[8:11], a[72:75], v[60:63]
    v_cndmask_b32 v98, v38, v42, s[20:21]
    v_cndmask_b32 v76, v76, v77, s[4:5]
    v_cndmask_b32 v80, v80, v81, s[4:5]
    v_mfma_f32_16x16x32_bf16 v[68:71], a[12:15], a[72:75], v[68:71]
    v_cndmask_b32 v78, v78, v79, s[4:5]
    v_cndmask_b32 v82, v82, v83, s[4:5]
    v_cndmask_b32 v100, v76, v80, s[18:19]
    v_mfma_f32_16x16x32_bf16 v[64:67], a[8:11], a[76:79], v[64:67]
    v_cndmask_b32 v102, v78, v82, s[20:21]
    v_mul_f32 v96, v96, v123
    v_mul_f32 v98, v98, v126
    v_mfma_f32_16x16x32_bf16 v[72:75], a[12:15], a[76:79], v[72:75]
    v_mul_f32 v100, v100, v123
    v_mul_f32 v102, v102, v126
    v_max_f32 v4, v96, v98
    v_mfma_f32_16x16x32_bf16 v[60:63], a[16:19], a[80:83], v[60:63]
    v_max_f32 v5, v100, v102
    v_mov_b32 v6, v4
    v_mov_b32 v7, v5
    v_mfma_f32_16x16x32_bf16 v[68:71], a[20:23], a[80:83], v[68:71]
    v_permlane32_swap_b32 v4, v6
    v_permlane32_swap_b32 v5, v7
    v_max_f32 v4, v4, v6
    v_mfma_f32_16x16x32_bf16 v[64:67], a[16:19], a[84:87], v[64:67]
    v_max_f32 v5, v5, v7
    v_mov_b32 v6, v4
    v_mov_b32 v7, v5
    v_mfma_f32_16x16x32_bf16 v[72:75], a[20:23], a[84:87], v[72:75]
    v_permlane16_swap_b32 v4, v6
    v_permlane16_swap_b32 v5, v7
    s_setprio 1
    v_mfma_f32_16x16x32_bf16 v[60:63], a[24:27], a[88:91], v[60:63]
    v_max_f32 v4, v4, v6
    v_max_f32 v5, v5, v7
    v_sub_f32 v96, v96, v4
    v_mfma_f32_16x16x32_bf16 v[68:71], a[28:31], a[88:91], v[68:71]
    v_sub_f32 v98, v98, v4
    v_sub_f32 v100, v100, v5
    v_sub_f32 v102, v102, v5
    v_mfma_f32_16x16x32_bf16 v[64:67], a[24:27], a[92:95], v[64:67]
    v_exp_f32 v96, v96
    v_exp_f32 v98, v98
    v_exp_f32 v100, v100
    v_mfma_f32_16x16x32_bf16 v[72:75], a[28:31], a[92:95], v[72:75]
    v_exp_f32 v102, v102
    v_cvt_pk_bf16_f32 v96, v96, v96
    s_waitcnt lgkmcnt(12)
    v_mfma_f32_16x16x32_bf16 v[60:63], a[32:35], a[96:99], v[60:63]
    v_cvt_pk_bf16_f32 v97, v98, v98
    v_cvt_pk_bf16_f32 v100, v100, v100
    v_cvt_pk_bf16_f32 v101, v102, v102
    v_mfma_f32_16x16x32_bf16 v[68:71], a[36:39], a[96:99], v[68:71]
    v_and_b32 v98, v96, v118
    v_and_b32 v99, v97, v119
    v_and_b32 v96, v96, v116
    v_mfma_f32_16x16x32_bf16 v[64:67], a[32:35], a[100:103], v[64:67]
    v_and_b32 v97, v97, v117
    v_and_b32 v102, v100, v118
    v_and_b32 v103, v101, v119
    v_mfma_f32_16x16x32_bf16 v[72:75], a[36:39], a[100:103], v[72:75]
    v_and_b32 v100, v100, v116
    v_and_b32 v101, v101, v117
    s_waitcnt lgkmcnt(8)
    v_mfma_f32_16x16x32_bf16 v[60:63], a[40:43], a[104:107], v[60:63]
    s_lshl_b32 s36, s44, 6
    s_add_u32 s36, s36, 156160
    v_lshl_add_u32 v48, v2, 4, s36
    v_xor_b32 v49, 64, v48
    ds_read_b128 v[28:31], v48 offset:0
    v_mfma_f32_16x16x32_bf16 v[68:71], a[44:47], a[104:107], v[68:71]
    ds_read_b128 v[32:35], v48 offset:512
    ds_read_b128 v[36:39], v49 offset:0
    ds_read_b128 v[40:43], v49 offset:512
    s_lshl_b32 s36, s27, 3
    s_add_u32 s36, s36, 157696
    v_mfma_f32_16x16x32_bf16 v[64:67], a[40:43], a[108:111], v[64:67]
    v_lshl_add_u32 v48, v3, 4, s36
    v_mov_b32 v49, 157952
    v_lshl_add_u32 v125, v1, 3, s45
    s_lshl_b32 s36, s27, 10
    v_add_u32 v50, s36, v125
    v_mfma_f32_16x16x32_bf16 v[72:75], a[44:47], a[108:111], v[72:75]
    s_lshl_b32 s37, s27, 12
    s_sub_u32 s37, 2048, s37
    v_add_u32 v51, s37, v50
    v_subrev_u32 v125, 2048, v125
    s_setprio 0
    s_waitcnt lgkmcnt(8)
    v_mfma_f32_16x16x32_bf16 v[60:63], a[48:51], a[112:115], v[60:63]
    v_mfma_f32_16x16x32_bf16 v[68:71], a[52:55], a[112:115], v[68:71]
    v_mfma_f32_16x16x32_bf16 v[64:67], a[48:51], a[116:119], v[64:67]
    v_mfma_f32_16x16x32_bf16 v[72:75], a[52:55], a[116:119], v[72:75]
    s_waitcnt vmcnt(1)
Lfl_chk:
    v_cmp_eq_u32 vcc, s34, v20
    s_nop 0
    s_and_b32 s36, vcc_lo, 0x3ff
    s_cmp_lg_u32 s36, 0x3ff
    s_cbranch_scc1 Lfl_re
    buffer_load_dwordx2 v[52:53], v13, s[28:31], s59 offen offset:8 sc1
    buffer_load_dwordx2 v[54:55], v13, s[28:31], s60 offen offset:0 sc1
    s_waitcnt lgkmcnt(4)
    v_mfma_f32_16x16x32_bf16 v[60:63], a[56:59], a[120:123], v[60:63]
    v_mfma_f32_16x16x32_bf16 v[68:71], a[60:63], a[120:123], v[68:71]
    v_mfma_f32_16x16x32_bf16 v[64:67], a[56:59], a[124:127], v[64:67]
    v_mfma_f32_16x16x32_bf16 v[72:75], a[60:63], a[124:127], v[72:75]
    ds_read_b32 v46, v49
    ds_read_b64 v[44:45], v48
    s_waitcnt lgkmcnt(0)
Lcsv:
    v_readfirstlane_b32 s38, v46
    s_nop 0
    s_cmp_eq_u32 s38, 0
    s_cbranch_scc1 Lcsv_re
    v_fmac_f32 v60, v28, v44
    v_fmac_f32 v61, v29, v44
    v_fmac_f32 v62, v30, v44
    v_fmac_f32 v63, v31, v44
    v_mul_f32 v60, v60, v32
    v_mul_f32 v61, v61, v33
    v_mul_f32 v62, v62, v34
    v_mul_f32 v63, v63, v35
    v_cvt_pk_bf16_f32 v60, v60, v61
    v_cvt_pk_bf16_f32 v61, v62, v63
    ds_write_b64 v50, v[60:61] offset:0
    v_fmac_f32 v64, v28, v45
    v_fmac_f32 v65, v29, v45
    v_fmac_f32 v66, v30, v45
    v_fmac_f32 v67, v31, v45
    v_mul_f32 v64, v64, v32
    v_mul_f32 v65, v65, v33
    v_mul_f32 v66, v66, v34
    v_mul_f32 v67, v67, v35
    v_cvt_pk_bf16_f32 v64, v64, v65
    v_cvt_pk_bf16_f32 v65, v66, v67
    ds_write_b64 v50, v[64:65] offset:512
    v_fmac_f32 v68, v36, v44
    v_fmac_f32 v69, v37, v44
    v_fmac_f32 v70, v38, v44
    v_fmac_f32 v71, v39, v44
    v_mul_f32 v68, v68, v40
    v_mul_f32 v69, v69, v41
    v_mul_f32 v70, v70, v42
    v_mul_f32 v71, v71, v43
    v_cvt_pk_bf16_f32 v68, v68, v69
    v_cvt_pk_bf16_f32 v69, v70, v71
    ds_write_b64 v51, v[68:69] offset:0
    v_fmac_f32 v72, v36, v45
    v_fmac_f32 v73, v37, v45
    v_fmac_f32 v74, v38, v45
    v_fmac_f32 v75, v39, v45
    v_mul_f32 v72, v72, v40
    v_mul_f32 v73, v73, v41
    v_mul_f32 v74, v74, v42
    v_mul_f32 v75, v75, v43
    v_cvt_pk_bf16_f32 v72, v72, v73
    v_cvt_pk_bf16_f32 v73, v74, v75
    ds_write_b64 v51, v[72:73] offset:512
    v_mov_b32 v8, 157976
    v_mov_b32 v9, 1
    s_mov_b64 exec, 1
    ds_add_u32 v8, v9
    s_mov_b64 exec, -1
Lcw_4:
    s_sub_u32 s35, s35, 1
    s_cbranch_scc1 Lend
    ds_read_b32 v9, v8
    s_waitcnt lgkmcnt(0)
    v_readfirstlane_b32 s38, v9
    s_nop 0
    s_cmp_lt_u32 s38, 7
    s_cbranch_scc1 Lcw_4
    s_setprio 2
    ds_read2st64_b64 v[60:63], v125 offset0:0 offset1:4
    ds_read2st64_b64 v[64:67], v125 offset0:1 offset1:5
    ds_read2st64_b64 v[68:71], v125 offset0:2 offset1:6
    ds_read2st64_b64 v[72:75], v125 offset0:3 offset1:7
    v_mfma_f32_16x16x32_bf16 v[80:83], v[14:17], v[96:99], 0
    v_mfma_f32_16x16x32_bf16 v[84:87], v[14:17], v[100:103], 0
    v_and_b32 v6, 3, v1
    v_lshl_add_u32 v6, v6, 3, v19
    v_add_u32 v20, v6, v18
    v_xor_b32 v21, 32, v20
    v_xor_b32 v22, 64, v20
    v_xor_b32 v23, 96, v20
    s_waitcnt lgkmcnt(0)
    v_mfma_f32_16x16x32_bf16 v[28:31], v[60:63], v[96:99], 0
    v_add_u32 v24, 63616, v20
    v_mfma_f32_16x16x32_bf16 v[40:43], v[72:75], v[100:103], 0
    v_add_u32 v25, 63616, v21
    v_mfma_f32_16x16x32_bf16 v[32:35], v[64:67], v[96:99], 0
    v_add_u32 v26, 63616, v22
    v_mfma_f32_16x16x32_bf16 v[36:39], v[68:71], v[100:103], 0
    v_add_u32 v27, 63616, v23
    v_rcp_f32 v80, v80
    v_rcp_f32 v84, v84
    v_mul_f32 v28, v28, v80
    v_mul_f32 v29, v29, v80
    v_mul_f32 v30, v30, v80
    v_mul_f32 v31, v31, v80
    v_cvt_pk_bf16_f32 v8, v28, v29
    v_cvt_pk_bf16_f32 v9, v30, v31
    v_min_u32 v8, -2, v8
    v_min_u32 v9, -2, v9
    v_mul_f32 v40, v40, v84
    v_mul_f32 v41, v41, v84
    v_mul_f32 v42, v42, v84
    v_mul_f32 v43, v43, v84
    v_cvt_pk_bf16_f32 v10, v40, v41
    v_cvt_pk_bf16_f32 v11, v42, v43
    v_min_u32 v10, -2, v10
    v_min_u32 v11, -2, v11
    buffer_store_dwordx4 v[8:11], v13, s[28:31], s23 offen sc0 sc1
    s_waitcnt vmcnt(1)
Lrx_chk:
    v_and_b32 v52, s61, v52
    v_and_b32 v53, s61, v53
    v_and_b32 v54, s62, v54
    v_and_b32 v55, s62, v55
    v_max3_u32 v4, v52, v53, v54
    v_max_u32 v4, v4, v55
    v_cmp_eq_u32 vcc, -1, v4
    s_nop 0
    s_cbranch_vccnz Lrx_re
    v_add_f32 v92, v92, v52
    v_add_f32 v94, v94, v53
    v_add_f32 v104, v104, v54
    v_add_f32 v106, v106, v55
    v_mul_f32 v92, v92, v123
    v_mul_f32 v94, v94, v126
    v_mul_f32 v104, v104, v123
    v_mul_f32 v106, v106, v126
    v_max_f32 v4, v92, v94
    v_max_f32 v5, v104, v106
    v_mov_b32 v6, v4
    v_mov_b32 v7, v5
    s_nop 0
    v_permlane32_swap_b32 v4, v6
    v_permlane32_swap_b32 v5, v7
    v_max_f32 v4, v4, v6
    v_max_f32 v5, v5, v7
    v_mov_b32 v6, v4
    v_mov_b32 v7, v5
    s_nop 0
    v_permlane16_swap_b32 v4, v6
    v_permlane16_swap_b32 v5, v7
    v_max_f32 v4, v4, v6
    v_max_f32 v5, v5, v7
    v_sub_f32 v92, v92, v4
    v_sub_f32 v94, v94, v4
    v_sub_f32 v104, v104, v5
    v_sub_f32 v106, v106, v5
    v_exp_f32 v92, v92
    v_exp_f32 v94, v94
    v_exp_f32 v104, v104
    v_exp_f32 v106, v106
    v_cvt_pk_bf16_f32 v92, v92, v92
    v_cvt_pk_bf16_f32 v93, v94, v94
    v_cvt_pk_bf16_f32 v104, v104, v104
    v_cvt_pk_bf16_f32 v105, v106, v106
    v_and_b32 v94, v92, v118
    v_and_b32 v95, v93, v119
    v_and_b32 v92, v92, v116
    v_and_b32 v93, v93, v117
    v_and_b32 v106, v104, v118
    v_and_b32 v107, v105, v119
    v_and_b32 v104, v104, v116
    v_and_b32 v105, v105, v117
    v_mfma_f32_16x16x32_bf16 v[76:79], v[14:17], v[92:95], 0
    s_nop 0
    v_mfma_f32_16x16x32_bf16 v[88:91], v[14:17], v[104:107], 0
    v_mfma_f32_16x16x32_bf16 v[44:47], v[64:67], v[92:95], 0
    v_mfma_f32_16x16x32_bf16 v[48:51], v[68:71], v[92:95], 0
    v_mfma_f32_16x16x32_bf16 v[52:55], v[64:67], v[104:107], 0
    v_mfma_f32_16x16x32_bf16 v[56:59], v[68:71], v[104:107], 0
    s_nop 1
    v_rcp_f32 v76, v76
    s_nop 0
    v_rcp_f32 v88, v88
    v_cndmask_b32 v82, v80, v76, s[6:7]
    v_cndmask_b32 v82, v82, v88, s[8:9]
    v_cndmask_b32 v32, v32, v44, s[6:7]
    v_cndmask_b32 v33, v33, v45, s[6:7]
    v_cndmask_b32 v34, v34, v46, s[6:7]
    v_cndmask_b32 v35, v35, v47, s[6:7]
    v_cndmask_b32 v32, v32, v52, s[8:9]
    v_cndmask_b32 v33, v33, v53, s[8:9]
    v_cndmask_b32 v34, v34, v54, s[8:9]
    v_cndmask_b32 v35, v35, v55, s[8:9]
    v_mul_f32 v32, v32, v82
    v_mul_f32 v33, v33, v82
    v_mul_f32 v34, v34, v82
    v_mul_f32 v35, v35, v82
    v_cvt_pk_bf16_f32 v4, v32, v33
    v_cvt_pk_bf16_f32 v5, v34, v35
    v_min_u32 v4, -2, v4
    v_min_u32 v5, -2, v5
    v_cndmask_b32 v86, v84, v76, s[12:13]
    v_cndmask_b32 v86, v86, v88, s[14:15]
    v_cndmask_b32 v36, v36, v48, s[12:13]
    v_cndmask_b32 v37, v37, v49, s[12:13]
    v_cndmask_b32 v38, v38, v50, s[12:13]
    v_cndmask_b32 v39, v39, v51, s[12:13]
    v_cndmask_b32 v36, v36, v56, s[14:15]
    v_cndmask_b32 v37, v37, v57, s[14:15]
    v_cndmask_b32 v38, v38, v58, s[14:15]
    v_cndmask_b32 v39, v39, v59, s[14:15]
    v_mul_f32 v36, v36, v86
    v_mul_f32 v37, v37, v86
    v_mul_f32 v38, v38, v86
    v_mul_f32 v39, v39, v86
    v_cvt_pk_bf16_f32 v6, v36, v37
    v_cvt_pk_bf16_f32 v7, v38, v39
    v_min_u32 v6, -2, v6
    v_min_u32 v7, -2, v7
    buffer_store_dwordx4 v[4:7], v13, s[28:31], s23 offen offset:1024 sc0 sc1
    s_setprio 1
    v_mov_b32 v10, 157980
Lcw_3:
    s_sub_u32 s35, s35, 1
    s_cbranch_scc1 Lend
    ds_read_b32 v11, v10
    s_waitcnt lgkmcnt(0)
    v_readfirstlane_b32 s38, v11
    s_nop 0
    s_cmp_lt_u32 s38, 2
    s_cbranch_scc1 Lcw_3
    s_mul_i32 s36, s32, 96
    s_lshl_b32 s37, s44, 4
    s_add_u32 s36, s36, s37
    s_sub_u32 s36, s36, 32
    v_add_u32 v126, s36, v3
    v_lshrrev_b32 v6, 3, v1
    v_add_u32 v6, s36, v6
    v_mul_u32_u24 v6, 1280, v6
    v_and_b32 v7, 7, v1
    v_xor_b32 v7, v7, v2
    v_lshl_add_u32 v122, v7, 4, v6
    v_xor_b32 v123, 64, v122
    v_add_u32 v123, 10240, v123
    s_lshl_b32 s36, s44, 11
    s_add_u32 s36, s36, 102656
    v_add_u32 v124, s36, v124
    v_add_u32 v125, s36, v13
    s_lshl_b32 s24, s33, 7
    v_mov_b32 v10, 157960
    s_mov_b32 s41, 0
    s_mov_b32 s47, 3
    v_lshlrev_b32 v28, 16, v108
    ds_read_b64_tr_b16 a[0:1], v20 offset:0
    ds_read_b64_tr_b16 a[2:3], v20 offset:512
    ds_read_b64_tr_b16 a[4:5], v21 offset:0
    ds_read_b64_tr_b16 a[6:7], v21 offset:512
    ds_read_b64_tr_b16 a[8:9], v22 offset:0
    ds_read_b64_tr_b16 a[10:11], v22 offset:512
    ds_read_b64_tr_b16 a[12:13], v23 offset:0
    ds_read_b64_tr_b16 a[14:15], v23 offset:512
    v_and_b32 v29, 0xffff0000, v108
    v_lshlrev_b32 v30, 16, v109
    v_and_b32 v31, 0xffff0000, v109
    v_lshlrev_b32 v32, 16, v110
    v_and_b32 v33, 0xffff0000, v110
    v_lshlrev_b32 v34, 16, v111
    v_and_b32 v35, 0xffff0000, v111
    v_lshlrev_b32 v36, 16, v112
    v_and_b32 v37, 0xffff0000, v112
    v_lshlrev_b32 v38, 16, v113
    v_and_b32 v39, 0xffff0000, v113
    v_lshlrev_b32 v40, 16, v114
    v_and_b32 v41, 0xffff0000, v114
    v_lshlrev_b32 v42, 16, v115
    ds_read_b64_tr_b16 a[16:17], v20 offset:4096
    ds_read_b64_tr_b16 a[18:19], v20 offset:4608
    ds_read_b64_tr_b16 a[20:21], v21 offset:4096
    ds_read_b64_tr_b16 a[22:23], v21 offset:4608
    ds_read_b64_tr_b16 a[24:25], v22 offset:4096
    ds_read_b64_tr_b16 a[26:27], v22 offset:4608
    ds_read_b64_tr_b16 a[28:29], v23 offset:4096
    ds_read_b64_tr_b16 a[30:31], v23 offset:4608
    v_and_b32 v43, 0xffff0000, v115
    v_mul_f32 v4, v120, v121
    v_mul_f32 v5, 0xbfb8aa3b, v121
    v_mul_f32 v6, 0xbfb8aa3b, v4
    v_fma_f32 v44, v28, v5, v6
    v_fma_f32 v45, v29, v5, v6
    v_fma_f32 v46, v30, v5, v6
    v_fma_f32 v47, v31, v5, v6
    v_fma_f32 v48, v32, v5, v6
    v_fma_f32 v49, v33, v5, v6
    v_fma_f32 v50, v34, v5, v6
    v_fma_f32 v51, v35, v5, v6
    v_fma_f32 v52, v36, v5, v6
    v_fma_f32 v53, v37, v5, v6
    ds_read_b64_tr_b16 a[32:33], v20 offset:8192
    ds_read_b64_tr_b16 a[34:35], v20 offset:8704
    ds_read_b64_tr_b16 a[36:37], v21 offset:8192
    ds_read_b64_tr_b16 a[38:39], v21 offset:8704
    ds_read_b64_tr_b16 a[40:41], v22 offset:8192
    ds_read_b64_tr_b16 a[42:43], v22 offset:8704
    ds_read_b64_tr_b16 a[44:45], v23 offset:8192
    ds_read_b64_tr_b16 a[46:47], v23 offset:8704
    v_fma_f32 v54, v38, v5, v6
    v_fma_f32 v55, v39, v5, v6
    v_fma_f32 v56, v40, v5, v6
    v_fma_f32 v57, v41, v5, v6
    v_fma_f32 v58, v42, v5, v6
    v_fma_f32 v59, v43, v5, v6
    v_exp_f32 v44, v44
    v_exp_f32 v45, v45
    v_exp_f32 v46, v46
    v_exp_f32 v47, v47
    v_exp_f32 v48, v48
    v_exp_f32 v49, v49
    v_exp_f32 v50, v50
    v_exp_f32 v51, v51
    v_exp_f32 v52, v52
    ds_read_b64_tr_b16 a[48:49], v20 offset:12288
    ds_read_b64_tr_b16 a[50:51], v20 offset:12800
    ds_read_b64_tr_b16 a[52:53], v21 offset:12288
    ds_read_b64_tr_b16 a[54:55], v21 offset:12800
    ds_read_b64_tr_b16 a[56:57], v22 offset:12288
    ds_read_b64_tr_b16 a[58:59], v22 offset:12800
    ds_read_b64_tr_b16 a[60:61], v23 offset:12288
    ds_read_b64_tr_b16 a[62:63], v23 offset:12800
    v_exp_f32 v53, v53
    v_exp_f32 v54, v54
    v_exp_f32 v55, v55
    v_exp_f32 v56, v56
    v_exp_f32 v57, v57
    v_exp_f32 v58, v58
    v_exp_f32 v59, v59
    v_add_f32 v44, 1.0, v44
    v_add_f32 v45, 1.0, v45
    buffer_load_dwordx4 v[60:63], v13, s[28:31], s53 offen offset:0 sc1
    buffer_load_dwordx4 v[64:67], v13, s[28:31], s53 offen offset:2048 sc1
    buffer_load_dwordx4 v[68:71], v13, s[28:31], s54 offen offset:0 sc1
    buffer_load_dwordx4 v[72:75], v13, s[28:31], s54 offen offset:2048 sc1
    buffer_load_dwordx4 v[92:95], v13, s[28:31], s55 offen offset:0 sc1
    buffer_load_dwordx4 v[96:99], v13, s[28:31], s55 offen offset:2048 sc1
    buffer_load_dwordx4 v[100:103], v13, s[28:31], s56 offen offset:0 sc1
    buffer_load_dwordx4 v[104:107], v13, s[28:31], s56 offen offset:2048 sc1
    s_setprio 0
    v_add_f32 v46, 1.0, v46
    v_add_f32 v47, 1.0, v47
    v_add_f32 v48, 1.0, v48
    v_add_f32 v49, 1.0, v49
    v_add_f32 v50, 1.0, v50
    ds_read_b64_tr_b16 a[64:65], v20 offset:24576
    ds_read_b64_tr_b16 a[66:67], v20 offset:25088
    ds_read_b64_tr_b16 a[68:69], v21 offset:24576
    ds_read_b64_tr_b16 a[70:71], v21 offset:25088
    ds_read_b64_tr_b16 a[72:73], v22 offset:24576
    ds_read_b64_tr_b16 a[74:75], v22 offset:25088
    ds_read_b64_tr_b16 a[76:77], v23 offset:24576
    ds_read_b64_tr_b16 a[78:79], v23 offset:25088
    v_add_f32 v51, 1.0, v51
    v_add_f32 v52, 1.0, v52
    v_add_f32 v53, 1.0, v53
    v_add_f32 v54, 1.0, v54
    v_add_f32 v55, 1.0, v55
    v_add_f32 v56, 1.0, v56
    v_add_f32 v57, 1.0, v57
    v_add_f32 v58, 1.0, v58
    v_add_f32 v59, 1.0, v59
    v_rcp_f32 v44, v44
    v_rcp_f32 v45, v45
    v_rcp_f32 v46, v46
    v_rcp_f32 v47, v47
    v_rcp_f32 v48, v48
    ds_read_b64_tr_b16 a[80:81], v20 offset:28672
    ds_read_b64_tr_b16 a[82:83], v20 offset:29184
    ds_read_b64_tr_b16 a[84:85], v21 offset:28672
    ds_read_b64_tr_b16 a[86:87], v21 offset:29184
    ds_read_b64_tr_b16 a[88:89], v22 offset:28672
    ds_read_b64_tr_b16 a[90:91], v22 offset:29184
    ds_read_b64_tr_b16 a[92:93], v23 offset:28672
    ds_read_b64_tr_b16 a[94:95], v23 offset:29184
    v_rcp_f32 v49, v49
    v_rcp_f32 v50, v50
    v_rcp_f32 v51, v51
    v_rcp_f32 v52, v52
    v_rcp_f32 v53, v53
    v_rcp_f32 v54, v54
    v_rcp_f32 v55, v55
    v_rcp_f32 v56, v56
    v_rcp_f32 v57, v57
    v_rcp_f32 v58, v58
    v_rcp_f32 v59, v59
    v_fma_f32 v7, v28, v121, v4
    v_mul_f32 v44, v44, v7
    v_fma_f32 v11, v29, v121, v4
    v_mul_f32 v45, v45, v11
    ds_read_b64_tr_b16 a[96:97], v24 offset:59520
    ds_read_b64_tr_b16 a[98:99], v24 offset:60032
    ds_read_b64_tr_b16 a[100:101], v25 offset:59520
    ds_read_b64_tr_b16 a[102:103], v25 offset:60032
    ds_read_b64_tr_b16 a[104:105], v26 offset:59520
    ds_read_b64_tr_b16 a[106:107], v26 offset:60032
    ds_read_b64_tr_b16 a[108:109], v27 offset:59520
    ds_read_b64_tr_b16 a[110:111], v27 offset:60032
    v_fma_f32 v7, v30, v121, v4
    v_mul_f32 v46, v46, v7
    v_fma_f32 v11, v31, v121, v4
    v_mul_f32 v47, v47, v11
    v_fma_f32 v7, v32, v121, v4
    v_mul_f32 v48, v48, v7
    v_fma_f32 v11, v33, v121, v4
    v_mul_f32 v49, v49, v11
    v_fma_f32 v7, v34, v121, v4
    v_mul_f32 v50, v50, v7
    v_fma_f32 v11, v35, v121, v4
    v_mul_f32 v51, v51, v11
    v_fma_f32 v7, v36, v121, v4
    v_mul_f32 v52, v52, v7
    ds_read_b64_tr_b16 a[112:113], v24 offset:63616
    ds_read_b64_tr_b16 a[114:115], v24 offset:64128
    ds_read_b64_tr_b16 a[116:117], v25 offset:63616
    ds_read_b64_tr_b16 a[118:119], v25 offset:64128
    ds_read_b64_tr_b16 a[120:121], v26 offset:63616
    ds_read_b64_tr_b16 a[122:123], v26 offset:64128
    ds_read_b64_tr_b16 a[124:125], v27 offset:63616
    ds_read_b64_tr_b16 a[126:127], v27 offset:64128
    v_fma_f32 v11, v37, v121, v4
    v_mul_f32 v53, v53, v11
    v_fma_f32 v7, v38, v121, v4
    v_mul_f32 v54, v54, v7
    v_fma_f32 v11, v39, v121, v4
    v_mul_f32 v55, v55, v11
    v_fma_f32 v7, v40, v121, v4
    v_mul_f32 v56, v56, v7
    v_fma_f32 v11, v41, v121, v4
    v_mul_f32 v57, v57, v11
    v_fma_f32 v7, v42, v121, v4
    v_mul_f32 v58, v58, v7
    v_fma_f32 v11, v43, v121, v4
    v_mul_f32 v59, v59, v11
Lwo_go:
    s_setprio 3
    ds_read_b64 v[8:9], v10
    s_waitcnt vmcnt(6)
    v_max3_u32 v18, v60, v61, v62
    v_max3_u32 v19, v64, v65, v66
    v_max3_u32 v18, v18, v63, v67
    v_max_u32 v18, v18, v19
    v_cmp_eq_u32 vcc, -1, v18
    s_nop 0
    s_cbranch_vccnz Lre_0
Lck_0:
    s_waitcnt lgkmcnt(15)
    v_mfma_f32_16x16x32_bf16 v[108:111], a[0:3], v[60:63], 0
    ds_read_b64_tr_b16 a[0:1], v24 offset:16384
    ds_read_b64_tr_b16 a[2:3], v24 offset:16896
    buffer_load_dwordx4 v[76:79], v13, s[28:31], s57 offen offset:0 sc1
    v_mfma_f32_16x16x32_bf16 v[112:115], a[4:7], v[60:63], 0
    ds_read_b64_tr_b16 a[4:5], v25 offset:16384
    ds_read_b64_tr_b16 a[6:7], v25 offset:16896
    v_mfma_f32_16x16x32_bf16 v[116:119], a[8:11], v[60:63], 0
    ds_read_b64_tr_b16 a[8:9], v26 offset:16384
    buffer_load_dwordx4 v[80:83], v13, s[28:31], s57 offen offset:2048 sc1
    v_mfma_f32_16x16x32_bf16 v[14:17], a[12:15], v[60:63], 0
    ds_read_b64_tr_b16 a[10:11], v26 offset:16896
    ds_read_b64_tr_b16 a[12:13], v27 offset:16384
    v_mfma_f32_16x16x32_bf16 v[108:111], a[16:19], v[64:67], v[108:111]
    ds_read_b64_tr_b16 a[14:15], v27 offset:16896
    s_waitcnt vmcnt(6)
    v_max3_u32 v18, v68, v69, v70
    v_mfma_f32_16x16x32_bf16 v[112:115], a[20:23], v[64:67], v[112:115]
    ds_read_b64_tr_b16 a[16:17], v24 offset:20480
    ds_read_b64_tr_b16 a[18:19], v24 offset:20992
    v_max3_u32 v19, v72, v73, v74
    v_max3_u32 v18, v18, v71, v75
    v_mfma_f32_16x16x32_bf16 v[116:119], a[24:27], v[64:67], v[116:119]
    ds_read_b64_tr_b16 a[20:21], v25 offset:20480
    ds_read_b64_tr_b16 a[22:23], v25 offset:20992
    v_max_u32 v18, v18, v19
    v_cmp_eq_u32 vcc, -1, v18
    v_mfma_f32_16x16x32_bf16 v[14:17], a[28:31], v[64:67], v[14:17]
    ds_read_b64_tr_b16 a[24:25], v26 offset:20480
    s_cbranch_vccnz Lre_1
Lck_1:
    s_waitcnt lgkmcnt(13)
Linfo:
    v_readfirstlane_b32 s39, v8
    s_nop 0
    s_cmp_eq_u32 s39, -2
    s_cbranch_scc1 Linfo_re
    v_mfma_f32_16x16x32_bf16 v[108:111], a[32:35], v[68:71], v[108:111]
    ds_read_b64_tr_b16 a[26:27], v26 offset:20992
    ds_read_b64_tr_b16 a[28:29], v27 offset:20480
    buffer_load_dwordx4 v[84:87], v13, s[28:31], s53 offen offset:1024 sc1
    v_mfma_f32_16x16x32_bf16 v[112:115], a[36:39], v[68:71], v[112:115]
    ds_read_b64_tr_b16 a[30:31], v27 offset:20992
    v_mfma_f32_16x16x32_bf16 v[116:119], a[40:43], v[68:71], v[116:119]
    ds_read_b64_tr_b16 a[32:33], v20 offset:32768
    ds_read_b64_tr_b16 a[34:35], v20 offset:33280
    buffer_load_dwordx4 v[88:91], v13, s[28:31], s53 offen offset:3072 sc1
    v_mfma_f32_16x16x32_bf16 v[14:17], a[44:47], v[68:71], v[14:17]
    ds_read_b64_tr_b16 a[36:37], v21 offset:32768
    ds_read_b64_tr_b16 a[38:39], v21 offset:33280
    v_mfma_f32_16x16x32_bf16 v[108:111], a[48:51], v[72:75], v[108:111]
    ds_read_b64_tr_b16 a[40:41], v22 offset:32768
    s_waitcnt vmcnt(6)
    v_max3_u32 v18, v92, v93, v94
    v_mfma_f32_16x16x32_bf16 v[112:115], a[52:55], v[72:75], v[112:115]
    ds_read_b64_tr_b16 a[42:43], v22 offset:33280
    ds_read_b64_tr_b16 a[44:45], v23 offset:32768
    v_max3_u32 v19, v96, v97, v98
    v_max3_u32 v18, v18, v95, v99
    v_mfma_f32_16x16x32_bf16 v[116:119], a[56:59], v[72:75], v[116:119]
    ds_read_b64_tr_b16 a[46:47], v23 offset:33280
    v_max_u32 v18, v18, v19
    v_cmp_eq_u32 vcc, -1, v18
    v_mfma_f32_16x16x32_bf16 v[14:17], a[60:63], v[72:75], v[14:17]
    ds_read_b64_tr_b16 a[48:49], v20 offset:36864
    ds_read_b64_tr_b16 a[50:51], v20 offset:37376
    s_cbranch_vccnz Lre_2
Lck_2:
    v_mfma_f32_16x16x32_bf16 v[108:111], a[64:67], v[92:95], v[108:111]
    ds_read_b64_tr_b16 a[52:53], v21 offset:36864
    ds_read_b64_tr_b16 a[54:55], v21 offset:37376
    buffer_load_dwordx4 v[60:63], v13, s[28:31], s54 offen offset:1024 sc1
    v_mfma_f32_16x16x32_bf16 v[112:115], a[68:71], v[92:95], v[112:115]
    ds_read_b64_tr_b16 a[56:57], v22 offset:36864
    v_mfma_f32_16x16x32_bf16 v[116:119], a[72:75], v[92:95], v[116:119]
    ds_read_b64_tr_b16 a[58:59], v22 offset:37376
    ds_read_b64_tr_b16 a[60:61], v23 offset:36864
    buffer_load_dwordx4 v[64:67], v13, s[28:31], s54 offen offset:3072 sc1
    v_mfma_f32_16x16x32_bf16 v[14:17], a[76:79], v[92:95], v[14:17]
    ds_read_b64_tr_b16 a[62:63], v23 offset:37376
    v_mfma_f32_16x16x32_bf16 v[108:111], a[80:83], v[96:99], v[108:111]
    ds_read_b64_tr_b16 a[64:65], v20 offset:40960
    ds_read_b64_tr_b16 a[66:67], v20 offset:41472
    s_waitcnt vmcnt(6)
    v_max3_u32 v18, v100, v101, v102
    v_mfma_f32_16x16x32_bf16 v[112:115], a[84:87], v[96:99], v[112:115]
    ds_read_b64_tr_b16 a[68:69], v21 offset:40960
    ds_read_b64_tr_b16 a[70:71], v21 offset:41472
    v_max3_u32 v19, v104, v105, v106
    v_max3_u32 v18, v18, v103, v107
    v_mfma_f32_16x16x32_bf16 v[116:119], a[88:91], v[96:99], v[116:119]
    ds_read_b64_tr_b16 a[72:73], v22 offset:40960
    v_max_u32 v18, v18, v19
    v_cmp_eq_u32 vcc, -1, v18
    v_mfma_f32_16x16x32_bf16 v[14:17], a[92:95], v[96:99], v[14:17]
    ds_read_b64_tr_b16 a[74:75], v22 offset:41472
    ds_read_b64_tr_b16 a[76:77], v23 offset:40960
    s_cbranch_vccnz Lre_3
Lck_3:
    s_setprio 2
    v_mfma_f32_16x16x32_bf16 v[108:111], a[96:99], v[100:103], v[108:111]
    ds_read_b64_tr_b16 a[78:79], v23 offset:41472
    buffer_load_dwordx4 v[68:71], v13, s[28:31], s55 offen offset:1024 sc1
    v_mfma_f32_16x16x32_bf16 v[112:115], a[100:103], v[100:103], v[112:115]
    ds_read_b64_tr_b16 a[80:81], v20 offset:45056
    ds_read_b64_tr_b16 a[82:83], v20 offset:45568
    v_mfma_f32_16x16x32_bf16 v[116:119], a[104:107], v[100:103], v[116:119]
    ds_read_b64_tr_b16 a[84:85], v21 offset:45056
    ds_read_b64_tr_b16 a[86:87], v21 offset:45568
    buffer_load_dwordx4 v[72:75], v13, s[28:31], s55 offen offset:3072 sc1
    v_mfma_f32_16x16x32_bf16 v[14:17], a[108:111], v[100:103], v[14:17]
    ds_read_b64_tr_b16 a[88:89], v22 offset:45056
    v_mfma_f32_16x16x32_bf16 v[108:111], a[112:115], v[104:107], v[108:111]
    ds_read_b64_tr_b16 a[90:91], v22 offset:45568
    ds_read_b64_tr_b16 a[92:93], v23 offset:45056
    s_waitcnt vmcnt(6)
    v_max3_u32 v18, v76, v77, v78
    v_mfma_f32_16x16x32_bf16 v[112:115], a[116:119], v[104:107], v[112:115]
    ds_read_b64_tr_b16 a[94:95], v23 offset:45568
    v_max3_u32 v19, v80, v81, v82
    v_max3_u32 v18, v18, v79, v83
    v_mfma_f32_16x16x32_bf16 v[116:119], a[120:123], v[104:107], v[116:119]
    ds_read_b64_tr_b16 a[96:97], v24 offset:0
    ds_read_b64_tr_b16 a[98:99], v24 offset:512
    v_max_u32 v18, v18, v19
    v_cmp_eq_u32 vcc, -1, v18
    v_mfma_f32_16x16x32_bf16 v[14:17], a[124:127], v[104:107], v[14:17]
    ds_read_b64_tr_b16 a[100:101], v25 offset:0
    ds_read_b64_tr_b16 a[102:103], v25 offset:512
    s_cbranch_vccnz Lre_4
Lck_4:
    s_waitcnt lgkmcnt(15)
    v_mfma_f32_16x16x32_bf16 v[108:111], a[0:3], v[76:79], v[108:111]
    ds_read_b64_tr_b16 a[104:105], v26 offset:0
    buffer_load_dwordx4 v[92:95], v13, s[28:31], s56 offen offset:1024 sc1
    v_mfma_f32_16x16x32_bf16 v[112:115], a[4:7], v[76:79], v[112:115]
    ds_read_b64_tr_b16 a[106:107], v26 offset:512
    ds_read_b64_tr_b16 a[108:109], v27 offset:0
    v_mfma_f32_16x16x32_bf16 v[116:119], a[8:11], v[76:79], v[116:119]
    ds_read_b64_tr_b16 a[110:111], v27 offset:512
    buffer_load_dwordx4 v[96:99], v13, s[28:31], s56 offen offset:3072 sc1
    v_mfma_f32_16x16x32_bf16 v[14:17], a[12:15], v[76:79], v[14:17]
    ds_read_b64_tr_b16 a[112:113], v24 offset:4096
    ds_read_b64_tr_b16 a[114:115], v24 offset:4608
    v_mfma_f32_16x16x32_bf16 v[108:111], a[16:19], v[80:83], v[108:111]
    ds_read_b64_tr_b16 a[116:117], v25 offset:4096
    ds_read_b64_tr_b16 a[118:119], v25 offset:4608
    s_waitcnt vmcnt(6)
    v_max3_u32 v18, v84, v85, v86
    v_mfma_f32_16x16x32_bf16 v[112:115], a[20:23], v[80:83], v[112:115]
    ds_read_b64_tr_b16 a[120:121], v26 offset:4096
    v_max3_u32 v19, v88, v89, v90
    v_max3_u32 v18, v18, v87, v91
    v_mfma_f32_16x16x32_bf16 v[116:119], a[24:27], v[80:83], v[116:119]
    ds_read_b64_tr_b16 a[122:123], v26 offset:4608
    ds_read_b64_tr_b16 a[124:125], v27 offset:4096
    v_max_u32 v18, v18, v19
    v_cmp_eq_u32 vcc, -1, v18
    v_mfma_f32_16x16x32_bf16 v[14:17], a[28:31], v[80:83], v[14:17]
    ds_read_b64_tr_b16 a[126:127], v27 offset:4608
    s_cbranch_vccnz Lre_5
Lck_5:
    v_mfma_f32_16x16x32_bf16 v[108:111], a[32:35], v[84:87], v[108:111]
    ds_read_b64_tr_b16 a[0:1], v24 offset:8192
    ds_read_b64_tr_b16 a[2:3], v24 offset:8704
    buffer_load_dwordx4 v[100:103], v13, s[28:31], s57 offen offset:1024 sc1
    v_mfma_f32_16x16x32_bf16 v[112:115], a[36:39], v[84:87], v[112:115]
    ds_read_b64_tr_b16 a[4:5], v25 offset:8192
    ds_read_b64_tr_b16 a[6:7], v25 offset:8704
    v_mfma_f32_16x16x32_bf16 v[116:119], a[40:43], v[84:87], v[116:119]
    ds_read_b64_tr_b16 a[8:9], v26 offset:8192
    buffer_load_dwordx4 v[104:107], v13, s[28:31], s57 offen offset:3072 sc1
    v_mfma_f32_16x16x32_bf16 v[14:17], a[44:47], v[84:87], v[14:17]
    ds_read_b64_tr_b16 a[10:11], v26 offset:8704
    ds_read_b64_tr_b16 a[12:13], v27 offset:8192
    v_mfma_f32_16x16x32_bf16 v[108:111], a[48:51], v[88:91], v[108:111]
    ds_read_b64_tr_b16 a[14:15], v27 offset:8704
    s_waitcnt vmcnt(6)
    v_max3_u32 v18, v60, v61, v62
    v_mfma_f32_16x16x32_bf16 v[112:115], a[52:55], v[88:91], v[112:115]
    ds_read_b64_tr_b16 a[16:17], v24 offset:12288
    ds_read_b64_tr_b16 a[18:19], v24 offset:12800
    v_max3_u32 v19, v64, v65, v66
    v_max3_u32 v18, v18, v63, v67
    v_mfma_f32_16x16x32_bf16 v[116:119], a[56:59], v[88:91], v[116:119]
    ds_read_b64_tr_b16 a[20:21], v25 offset:12288
    ds_read_b64_tr_b16 a[22:23], v25 offset:12800
    v_max_u32 v18, v18, v19
    v_cmp_eq_u32 vcc, -1, v18
    v_mfma_f32_16x16x32_bf16 v[14:17], a[60:63], v[88:91], v[14:17]
    ds_read_b64_tr_b16 a[24:25], v26 offset:12288
    s_cbranch_vccnz Lre_6
Lck_6:
    s_setprio 1
    s_waitcnt lgkmcnt(15)
    v_mfma_f32_16x16x32_bf16 v[108:111], a[64:67], v[60:63], v[108:111]
    ds_read_b64_tr_b16 a[26:27], v26 offset:12800
    ds_read_b64_tr_b16 a[28:29], v27 offset:12288
    v_mfma_f32_16x16x32_bf16 v[112:115], a[68:71], v[60:63], v[112:115]
    ds_read_b64_tr_b16 a[30:31], v27 offset:12800
    v_mfma_f32_16x16x32_bf16 v[116:119], a[72:75], v[60:63], v[116:119]
    ds_read_b64_tr_b16 a[32:33], v20 offset:49152
    ds_read_b64_tr_b16 a[34:35], v20 offset:49664
    v_mfma_f32_16x16x32_bf16 v[14:17], a[76:79], v[60:63], v[14:17]
    ds_read_b64_tr_b16 a[36:37], v21 offset:49152
    ds_read_b64_tr_b16 a[38:39], v21 offset:49664
    v_mfma_f32_16x16x32_bf16 v[108:111], a[80:83], v[64:67], v[108:111]
    ds_read_b64_tr_b16 a[40:41], v22 offset:49152
    s_waitcnt vmcnt(4)
    v_max3_u32 v18, v68, v69, v70
    v_mfma_f32_16x16x32_bf16 v[112:115], a[84:87], v[64:67], v[112:115]
    ds_read_b64_tr_b16 a[42:43], v22 offset:49664
    ds_read_b64_tr_b16 a[44:45], v23 offset:49152
    v_max3_u32 v19, v72, v73, v74
    v_max3_u32 v18, v18, v71, v75
    v_mfma_f32_16x16x32_bf16 v[116:119], a[88:91], v[64:67], v[116:119]
    ds_read_b64_tr_b16 a[46:47], v23 offset:49664
    v_max_u32 v18, v18, v19
    v_cmp_eq_u32 vcc, -1, v18
    v_mfma_f32_16x16x32_bf16 v[14:17], a[92:95], v[64:67], v[14:17]
    ds_read_b64_tr_b16 a[48:49], v24 offset:24576
    ds_read_b64_tr_b16 a[50:51], v24 offset:25088
    s_cbranch_vccnz Lre_7
Lck_7:
    v_mfma_f32_16x16x32_bf16 v[108:111], a[96:99], v[68:71], v[108:111]
    ds_read_b64_tr_b16 a[52:53], v25 offset:24576
    ds_read_b64_tr_b16 a[54:55], v25 offset:25088
    v_mfma_f32_16x16x32_bf16 v[112:115], a[100:103], v[68:71], v[112:115]
    ds_read_b64_tr_b16 a[56:57], v26 offset:24576
    v_mfma_f32_16x16x32_bf16 v[116:119], a[104:107], v[68:71], v[116:119]
    ds_read_b64_tr_b16 a[58:59], v26 offset:25088
    ds_read_b64_tr_b16 a[60:61], v27 offset:24576
    v_mfma_f32_16x16x32_bf16 v[14:17], a[108:111], v[68:71], v[14:17]
    ds_read_b64_tr_b16 a[62:63], v27 offset:25088
    s_waitcnt lgkmcnt(15)
    v_mfma_f32_16x16x32_bf16 v[108:111], a[112:115], v[72:75], v[108:111]
    s_waitcnt vmcnt(2)
    v_max3_u32 v18, v92, v93, v94
    v_mfma_f32_16x16x32_bf16 v[112:115], a[116:119], v[72:75], v[112:115]
    v_max3_u32 v19, v96, v97, v98
    v_max3_u32 v18, v18, v95, v99
    v_mfma_f32_16x16x32_bf16 v[116:119], a[120:123], v[72:75], v[116:119]
    v_max_u32 v18, v18, v19
    v_cmp_eq_u32 vcc, -1, v18
    v_mfma_f32_16x16x32_bf16 v[14:17], a[124:127], v[72:75], v[14:17]
    s_cbranch_vccnz Lre_8
Lck_8:
    s_setprio 0
    v_mfma_f32_16x16x32_bf16 v[108:111], a[0:3], v[92:95], v[108:111]
    v_mfma_f32_16x16x32_bf16 v[112:115], a[4:7], v[92:95], v[112:115]
    v_mfma_f32_16x16x32_bf16 v[116:119], a[8:11], v[92:95], v[116:119]
    v_mfma_f32_16x16x32_bf16 v[14:17], a[12:15], v[92:95], v[14:17]
    v_mfma_f32_16x16x32_bf16 v[108:111], a[16:19], v[96:99], v[108:111]
    s_waitcnt vmcnt(0)
    v_max3_u32 v18, v100, v101, v102
    v_mfma_f32_16x16x32_bf16 v[112:115], a[20:23], v[96:99], v[112:115]
    v_max3_u32 v19, v104, v105, v106
    v_max3_u32 v18, v18, v103, v107
    v_mfma_f32_16x16x32_bf16 v[116:119], a[24:27], v[96:99], v[116:119]
    v_max_u32 v18, v18, v19
    v_cmp_eq_u32 vcc, -1, v18
    v_mfma_f32_16x16x32_bf16 v[14:17], a[28:31], v[96:99], v[14:17]
    s_cbranch_vccnz Lre_9
Lck_9:
    s_waitcnt lgkmcnt(8)
    v_mfma_f32_16x16x32_bf16 v[108:111], a[32:35], v[100:103], v[108:111]
    v_mfma_f32_16x16x32_bf16 v[112:115], a[36:39], v[100:103], v[112:115]
    v_mfma_f32_16x16x32_bf16 v[116:119], a[40:43], v[100:103], v[116:119]
    v_mfma_f32_16x16x32_bf16 v[14:17], a[44:47], v[100:103], v[14:17]
    s_waitcnt lgkmcnt(0)
    v_mfma_f32_16x16x32_bf16 v[108:111], a[48:51], v[104:107], v[108:111]
    v_mfma_f32_16x16x32_bf16 v[112:115], a[52:55], v[104:107], v[112:115]
    v_mfma_f32_16x16x32_bf16 v[116:119], a[56:59], v[104:107], v[116:119]
    v_mfma_f32_16x16x32_bf16 v[14:17], a[60:63], v[104:107], v[14:17]
    v_xor_b32 v60, 32, v124
    v_xor_b32 v61, 64, v124
    v_xor_b32 v62, 96, v124
    v_cmp_eq_u32 s[36:37], v8, v126
    v_cmp_eq_u32 s[38:39], v9, v126
    s_nop 0
    s_or_b64 vcc, s[36:37], s[38:39]
    s_cbranch_scc1 Lfix
Lnofix:
    v_fma_f32 v108, v108, v44, v28
    v_fma_f32 v109, v109, v45, v29
    v_fma_f32 v110, v110, v46, v30
    v_fma_f32 v111, v111, v47, v31
    v_cvt_pk_bf16_f32 v68, v108, v109
    v_cvt_pk_bf16_f32 v69, v110, v111
    ds_write_b64 v124, v[68:69]
    v_fma_f32 v112, v112, v48, v32
    v_fma_f32 v113, v113, v49, v33
    v_fma_f32 v114, v114, v50, v34
    v_fma_f32 v115, v115, v51, v35
    v_cvt_pk_bf16_f32 v70, v112, v113
    v_cvt_pk_bf16_f32 v71, v114, v115
    ds_write_b64 v60, v[70:71]
    v_fma_f32 v116, v116, v52, v36
    v_fma_f32 v117, v117, v53, v37
    v_fma_f32 v118, v118, v54, v38
    v_fma_f32 v119, v119, v55, v39
    v_cvt_pk_bf16_f32 v72, v116, v117
    v_cvt_pk_bf16_f32 v73, v118, v119
    ds_write_b64 v61, v[72:73]
    v_fma_f32 v14, v14, v56, v40
    v_fma_f32 v15, v15, v57, v41
    v_fma_f32 v16, v16, v58, v42
    v_fma_f32 v17, v17, v59, v43
    v_cvt_pk_bf16_f32 v74, v14, v15
    v_cvt_pk_bf16_f32 v75, v16, v17
    ds_write_b64 v62, v[74:75]
    ds_read_b128 v[76:79], v125 offset:0
    ds_read_b128 v[80:83], v125 offset:1024
    s_waitcnt lgkmcnt(1)
    buffer_store_dwordx4 v[76:79], v122, s[48:51], s24 offen sc0 sc1
    s_waitcnt lgkmcnt(0)
    buffer_store_dwordx4 v[80:83], v123, s[48:51], s24 offen sc0 sc1
    s_endpgm
Lh1:
    ds_write_b128 v125, v[44:47] offset:0
    ds_write_b128 v125, v[48:51] offset:1024
    v_mov_b32 v5, 157972
    v_mov_b32 v6, 1
    s_mov_b64 exec, 1
    ds_add_u32 v5, v6
    s_mov_b64 exec, -1
    v_fmac_f32 v28, v76, v120
    v_fmac_f32 v29, v77, v120
    v_fmac_f32 v30, v78, v120
    v_fmac_f32 v31, v79, v120
    v_cvt_pk_bf16_f32 v28, v28, v29
    v_cvt_pk_bf16_f32 v29, v30, v31
    v_fmac_f32 v32, v80, v120
    v_fmac_f32 v33, v81, v120
    v_fmac_f32 v34, v82, v120
    v_fmac_f32 v35, v83, v120
    v_cvt_pk_bf16_f32 v30, v32, v33
    v_cvt_pk_bf16_f32 v31, v34, v35
    v_fmac_f32 v36, v84, v120
    v_fmac_f32 v37, v85, v120
    v_fmac_f32 v38, v86, v120
    v_fmac_f32 v39, v87, v120
    v_cvt_pk_bf16_f32 v32, v36, v37
    v_cvt_pk_bf16_f32 v33, v38, v39
    v_fmac_f32 v40, v88, v120
    v_fmac_f32 v41, v89, v120
    v_fmac_f32 v42, v90, v120
    v_fmac_f32 v43, v91, v120
    v_cvt_pk_bf16_f32 v34, v40, v41
    v_cvt_pk_bf16_f32 v35, v42, v43
    v_subrev_u32 v4, 6144, v125
    v_mov_b32 v8, s22
    v_mov_b32 v9, s22
    v_mov_b32 v10, s22
    v_mov_b32 v11, s22
Lcw_2:
    s_sub_u32 s35, s35, 1
    s_cbranch_scc1 Lend
    ds_read_b32 v6, v5
    s_waitcnt lgkmcnt(0)
    v_readfirstlane_b32 s38, v6
    s_nop 0
    s_cmp_lt_u32 s38, 8
    s_cbranch_scc1 Lcw_2
    ds_read_b128 v[52:55], v125 offset:2048
    ds_read_b128 v[56:59], v125 offset:3072
    ds_read_b128 v[44:47], v4 offset:4096
    ds_read_b128 v[48:51], v4 offset:5120
    s_branch Lh_join
Lqf_re:
    s_sub_u32 s35, s35, 1
    s_cbranch_scc1 Lend
    ds_read_b32 v7, v96
    ds_read_b128 v[76:79], v95 offset:0
    ds_read_b128 v[80:83], v95 offset:64
    ds_read_b128 v[84:87], v95 offset:128
    ds_read_b128 v[88:91], v95 offset:192
    s_waitcnt lgkmcnt(0)
    s_branch Lqf
Lcsv_re:
    s_sub_u32 s35, s35, 1
    s_cbranch_scc1 Lend
    ds_read_b32 v46, v49
    ds_read_b64 v[44:45], v48
    s_waitcnt lgkmcnt(0)
    s_branch Lcsv
Lrx_re:
    s_sub_u32 s35, s35, 1
    s_cbranch_scc1 Lend
    buffer_load_dwordx2 v[52:53], v13, s[28:31], s59 offen offset:8 sc1
    buffer_load_dwordx2 v[54:55], v13, s[28:31], s60 offen offset:0 sc1
    s_waitcnt vmcnt(0)
    s_branch Lrx_chk
Linfo_re:
    s_sub_u32 s35, s35, 1
    s_cbranch_scc1 Lend
    ds_read_b64 v[8:9], v10
    s_waitcnt lgkmcnt(0)
    s_branch Linfo
Lfl_re:
    s_sub_u32 s35, s35, 1
    s_cbranch_scc1 Lend
    buffer_load_dword v20, v12, s[28:31], s24 offen sc1
    s_waitcnt vmcnt(0)
    s_branch Lfl_chk
Lxe0:
    ds_read_b64 v[108:109], v4
    ds_read_b64 v[110:111], v5
    ds_read_b64 v[112:113], v6
    ds_read_b64 v[114:115], v7
    s_branch Lxe0_b
Lxe1:
    ds_read_b64 v[108:109], v4
    ds_read_b64 v[110:111], v5
    ds_read_b64 v[112:113], v6
    ds_read_b64 v[114:115], v7
    s_branch Lxe1_b
Lxe2:
    ds_read_b64 v[108:109], v4
    ds_read_b64 v[110:111], v5
    ds_read_b64 v[112:113], v6
    ds_read_b64 v[114:115], v7
    s_branch Lxe2_b
Lxe3:
    ds_read_b64 v[108:109], v4
    ds_read_b64 v[110:111], v5
    ds_read_b64 v[112:113], v6
    ds_read_b64 v[114:115], v7
    s_branch Lxe3_b
Lxe4:
    ds_read_b64 v[108:109], v4
    ds_read_b64 v[110:111], v5
    ds_read_b64 v[112:113], v6
    ds_read_b64 v[114:115], v7
    s_branch Lxe4_b
Lxe5:
    ds_read_b64 v[108:109], v4
    ds_read_b64 v[110:111], v5
    ds_read_b64 v[112:113], v6
    ds_read_b64 v[114:115], v7
    s_branch Lxe5_b
Lxe6:
    ds_read_b64 v[108:109], v4
    ds_read_b64 v[110:111], v5
    ds_read_b64 v[112:113], v6
    ds_read_b64 v[114:115], v7
    s_branch Lxe6_b
Lxe7:
    ds_read_b64 v[108:109], v4
    ds_read_b64 v[110:111], v5
    ds_read_b64 v[112:113], v6
    ds_read_b64 v[114:115], v7
    s_branch Lxe7_b
Lxe8:
    ds_read_b64 v[108:109], v4
    ds_read_b64 v[110:111], v5
    ds_read_b64 v[112:113], v6
    ds_read_b64 v[114:115], v7
    s_branch Lxe8_b
Lxe9:
    ds_read_b64 v[108:109], v4
    ds_read_b64 v[110:111], v5
    ds_read_b64 v[112:113], v6
    ds_read_b64 v[114:115], v7
    s_branch Lxe9_b
Lre_0:
    s_mov_b32 s41, 1
    s_sub_u32 s35, s35, 1
    s_cbranch_scc1 Lend
    s_sleep 2
    buffer_load_dwordx4 v[60:63], v13, s[28:31], s53 offen offset:0 sc1
    buffer_load_dwordx4 v[64:67], v13, s[28:31], s53 offen offset:2048 sc1
    s_waitcnt vmcnt(0)
    v_max3_u32 v18, v60, v61, v62
    v_max3_u32 v19, v64, v65, v66
    v_max3_u32 v18, v18, v63, v67
    v_max_u32 v18, v18, v19
    v_cmp_eq_u32 vcc, -1, v18
    s_nop 0
    s_cbranch_vccnz Lre_0
    buffer_load_dwordx4 v[68:71], v13, s[28:31], s54 offen offset:0 sc1
    buffer_load_dwordx4 v[72:75], v13, s[28:31], s54 offen offset:2048 sc1
    buffer_load_dwordx4 v[92:95], v13, s[28:31], s55 offen offset:0 sc1
    buffer_load_dwordx4 v[96:99], v13, s[28:31], s55 offen offset:2048 sc1
    buffer_load_dwordx4 v[100:103], v13, s[28:31], s56 offen offset:0 sc1
    buffer_load_dwordx4 v[104:107], v13, s[28:31], s56 offen offset:2048 sc1
    s_branch Lck_0
Lre_1:
    s_mov_b32 s41, 1
    s_sub_u32 s35, s35, 1
    s_cbranch_scc1 Lend
    s_sleep 2
    buffer_load_dwordx4 v[68:71], v13, s[28:31], s54 offen offset:0 sc1
    buffer_load_dwordx4 v[72:75], v13, s[28:31], s54 offen offset:2048 sc1
    s_waitcnt vmcnt(0)
    v_max3_u32 v18, v68, v69, v70
    v_max3_u32 v19, v72, v73, v74
    v_max3_u32 v18, v18, v71, v75
    v_max_u32 v18, v18, v19
    v_cmp_eq_u32 vcc, -1, v18
    s_nop 0
    s_cbranch_vccnz Lre_1
    buffer_load_dwordx4 v[92:95], v13, s[28:31], s55 offen offset:0 sc1
    buffer_load_dwordx4 v[96:99], v13, s[28:31], s55 offen offset:2048 sc1
    buffer_load_dwordx4 v[100:103], v13, s[28:31], s56 offen offset:0 sc1
    buffer_load_dwordx4 v[104:107], v13, s[28:31], s56 offen offset:2048 sc1
    buffer_load_dwordx4 v[76:79], v13, s[28:31], s57 offen offset:0 sc1
    buffer_load_dwordx4 v[80:83], v13, s[28:31], s57 offen offset:2048 sc1
    s_branch Lck_1
Lre_2:
    s_mov_b32 s41, 1
    s_sub_u32 s35, s35, 1
    s_cbranch_scc1 Lend
    s_sleep 2
    buffer_load_dwordx4 v[92:95], v13, s[28:31], s55 offen offset:0 sc1
    buffer_load_dwordx4 v[96:99], v13, s[28:31], s55 offen offset:2048 sc1
    s_waitcnt vmcnt(0)
    v_max3_u32 v18, v92, v93, v94
    v_max3_u32 v19, v96, v97, v98
    v_max3_u32 v18, v18, v95, v99
    v_max_u32 v18, v18, v19
    v_cmp_eq_u32 vcc, -1, v18
    s_nop 0
    s_cbranch_vccnz Lre_2
    buffer_load_dwordx4 v[100:103], v13, s[28:31], s56 offen offset:0 sc1
    buffer_load_dwordx4 v[104:107], v13, s[28:31], s56 offen offset:2048 sc1
    buffer_load_dwordx4 v[76:79], v13, s[28:31], s57 offen offset:0 sc1
    buffer_load_dwordx4 v[80:83], v13, s[28:31], s57 offen offset:2048 sc1
    buffer_load_dwordx4 v[84:87], v13, s[28:31], s53 offen offset:1024 sc1
    buffer_load_dwordx4 v[88:91], v13, s[28:31], s53 offen offset:3072 sc1
    s_branch Lck_2
Lre_3:
    s_mov_b32 s41, 1
    s_sub_u32 s35, s35, 1
    s_cbranch_scc1 Lend
    s_sleep 2
    buffer_load_dwordx4 v[100:103], v13, s[28:31], s56 offen offset:0 sc1
    buffer_load_dwordx4 v[104:107], v13, s[28:31], s56 offen offset:2048 sc1
    s_waitcnt vmcnt(0)
    v_max3_u32 v18, v100, v101, v102
    v_max3_u32 v19, v104, v105, v106
    v_max3_u32 v18, v18, v103, v107
    v_max_u32 v18, v18, v19
    v_cmp_eq_u32 vcc, -1, v18
    s_nop 0
    s_cbranch_vccnz Lre_3
    buffer_load_dwordx4 v[76:79], v13, s[28:31], s57 offen offset:0 sc1
    buffer_load_dwordx4 v[80:83], v13, s[28:31], s57 offen offset:2048 sc1
    buffer_load_dwordx4 v[84:87], v13, s[28:31], s53 offen offset:1024 sc1
    buffer_load_dwordx4 v[88:91], v13, s[28:31], s53 offen offset:3072 sc1
    buffer_load_dwordx4 v[60:63], v13, s[28:31], s54 offen offset:1024 sc1
    buffer_load_dwordx4 v[64:67], v13, s[28:31], s54 offen offset:3072 sc1
    s_branch Lck_3
Lre_4:
    s_mov_b32 s41, 1
    s_sub_u32 s35, s35, 1
    s_cbranch_scc1 Lend
    s_sleep 2
    buffer_load_dwordx4 v[76:79], v13, s[28:31], s57 offen offset:0 sc1
    buffer_load_dwordx4 v[80:83], v13, s[28:31], s57 offen offset:2048 sc1
    s_waitcnt vmcnt(0)
    v_max3_u32 v18, v76, v77, v78
    v_max3_u32 v19, v80, v81, v82
    v_max3_u32 v18, v18, v79, v83
    v_max_u32 v18, v18, v19
    v_cmp_eq_u32 vcc, -1, v18
    s_nop 0
    s_cbranch_vccnz Lre_4
    buffer_load_dwordx4 v[84:87], v13, s[28:31], s53 offen offset:1024 sc1
    buffer_load_dwordx4 v[88:91], v13, s[28:31], s53 offen offset:3072 sc1
    buffer_load_dwordx4 v[60:63], v13, s[28:31], s54 offen offset:1024 sc1
    buffer_load_dwordx4 v[64:67], v13, s[28:31], s54 offen offset:3072 sc1
    buffer_load_dwordx4 v[68:71], v13, s[28:31], s55 offen offset:1024 sc1
    buffer_load_dwordx4 v[72:75], v13, s[28:31], s55 offen offset:3072 sc1
    s_branch Lck_4
Lre_5:
    s_mov_b32 s41, 1
    s_sub_u32 s35, s35, 1
    s_cbranch_scc1 Lend
    s_sleep 2
    buffer_load_dwordx4 v[84:87], v13, s[28:31], s53 offen offset:1024 sc1
    buffer_load_dwordx4 v[88:91], v13, s[28:31], s53 offen offset:3072 sc1
    s_waitcnt vmcnt(0)
    v_max3_u32 v18, v84, v85, v86
    v_max3_u32 v19, v88, v89, v90
    v_max3_u32 v18, v18, v87, v91
    v_max_u32 v18, v18, v19
    v_cmp_eq_u32 vcc, -1, v18
    s_nop 0
    s_cbranch_vccnz Lre_5
    buffer_load_dwordx4 v[60:63], v13, s[28:31], s54 offen offset:1024 sc1
    buffer_load_dwordx4 v[64:67], v13, s[28:31], s54 offen offset:3072 sc1
    buffer_load_dwordx4 v[68:71], v13, s[28:31], s55 offen offset:1024 sc1
    buffer_load_dwordx4 v[72:75], v13, s[28:31], s55 offen offset:3072 sc1
    buffer_load_dwordx4 v[92:95], v13, s[28:31], s56 offen offset:1024 sc1
    buffer_load_dwordx4 v[96:99], v13, s[28:31], s56 offen offset:3072 sc1
    s_branch Lck_5
Lre_6:
    s_mov_b32 s41, 1
    s_sub_u32 s35, s35, 1
    s_cbranch_scc1 Lend
    s_sleep 2
    buffer_load_dwordx4 v[60:63], v13, s[28:31], s54 offen offset:1024 sc1
    buffer_load_dwordx4 v[64:67], v13, s[28:31], s54 offen offset:3072 sc1
    s_waitcnt vmcnt(0)
    v_max3_u32 v18, v60, v61, v62
    v_max3_u32 v19, v64, v65, v66
    v_max3_u32 v18, v18, v63, v67
    v_max_u32 v18, v18, v19
    v_cmp_eq_u32 vcc, -1, v18
    s_nop 0
    s_cbranch_vccnz Lre_6
    buffer_load_dwordx4 v[68:71], v13, s[28:31], s55 offen offset:1024 sc1
    buffer_load_dwordx4 v[72:75], v13, s[28:31], s55 offen offset:3072 sc1
    buffer_load_dwordx4 v[92:95], v13, s[28:31], s56 offen offset:1024 sc1
    buffer_load_dwordx4 v[96:99], v13, s[28:31], s56 offen offset:3072 sc1
    buffer_load_dwordx4 v[100:103], v13, s[28:31], s57 offen offset:1024 sc1
    buffer_load_dwordx4 v[104:107], v13, s[28:31], s57 offen offset:3072 sc1
    s_branch Lck_6
Lre_7:
    s_mov_b32 s41, 1
    s_sub_u32 s35, s35, 1
    s_cbranch_scc1 Lend
    s_sleep 2
    buffer_load_dwordx4 v[68:71], v13, s[28:31], s55 offen offset:1024 sc1
    buffer_load_dwordx4 v[72:75], v13, s[28:31], s55 offen offset:3072 sc1
    s_waitcnt vmcnt(0)
    v_max3_u32 v18, v68, v69, v70
    v_max3_u32 v19, v72, v73, v74
    v_max3_u32 v18, v18, v71, v75
    v_max_u32 v18, v18, v19
    v_cmp_eq_u32 vcc, -1, v18
    s_nop 0
    s_cbranch_vccnz Lre_7
    buffer_load_dwordx4 v[92:95], v13, s[28:31], s56 offen offset:1024 sc1
    buffer_load_dwordx4 v[96:99], v13, s[28:31], s56 offen offset:3072 sc1
    buffer_load_dwordx4 v[100:103], v13, s[28:31], s57 offen offset:1024 sc1
    buffer_load_dwordx4 v[104:107], v13, s[28:31], s57 offen offset:3072 sc1
    s_branch Lck_7
Lre_8:
    s_mov_b32 s41, 1
    s_sub_u32 s35, s35, 1
    s_cbranch_scc1 Lend
    s_sleep 2
    buffer_load_dwordx4 v[92:95], v13, s[28:31], s56 offen offset:1024 sc1
    buffer_load_dwordx4 v[96:99], v13, s[28:31], s56 offen offset:3072 sc1
    s_waitcnt vmcnt(0)
    v_max3_u32 v18, v92, v93, v94
    v_max3_u32 v19, v96, v97, v98
    v_max3_u32 v18, v18, v95, v99
    v_max_u32 v18, v18, v19
    v_cmp_eq_u32 vcc, -1, v18
    s_nop 0
    s_cbranch_vccnz Lre_8
    buffer_load_dwordx4 v[100:103], v13, s[28:31], s57 offen offset:1024 sc1
    buffer_load_dwordx4 v[104:107], v13, s[28:31], s57 offen offset:3072 sc1
    s_branch Lck_8
Lre_9:
    s_mov_b32 s41, 1
    s_sub_u32 s35, s35, 1
    s_cbranch_scc1 Lend
    s_sleep 2
    buffer_load_dwordx4 v[100:103], v13, s[28:31], s57 offen offset:1024 sc1
    buffer_load_dwordx4 v[104:107], v13, s[28:31], s57 offen offset:3072 sc1
    s_waitcnt vmcnt(0)
    v_max3_u32 v18, v100, v101, v102
    v_max3_u32 v19, v104, v105, v106
    v_max3_u32 v18, v18, v103, v107
    v_max_u32 v18, v18, v19
    v_cmp_eq_u32 vcc, -1, v18
    s_nop 0
    s_cbranch_vccnz Lre_9
    s_branch Lck_9
Lfix:
    s_mov_b64 vcc, s[38:39]
    v_lshlrev_b32 v6, 4, v2
    v_add_u32 v6, 158208, v6
    v_mov_b32 v10, 157956
Lcw_5:
    s_sub_u32 s35, s35, 1
    s_cbranch_scc1 Lend
    ds_read_b32 v11, v10
    s_waitcnt lgkmcnt(0)
    v_readfirstlane_b32 s38, v11
    s_nop 0
    s_cmp_lt_u32 s38, 1
    s_cbranch_scc1 Lcw_5
    s_mov_b64 exec, s[36:37]
    ds_read_b128 v[44:47], v6 offset:0
    ds_read_b128 v[48:51], v6 offset:64
    ds_read_b128 v[52:55], v6 offset:128
    ds_read_b128 v[56:59], v6 offset:192
    s_mov_b64 exec, vcc
    ds_read_b128 v[44:47], v6 offset:256
    ds_read_b128 v[48:51], v6 offset:320
    ds_read_b128 v[52:55], v6 offset:384
    ds_read_b128 v[56:59], v6 offset:448
    s_mov_b64 exec, -1
    s_waitcnt lgkmcnt(0)
    s_branch Lnofix
Lhalo:
    s_mov_b32 vcc_lo, 0x00010001
    s_mov_b32 vcc_hi, 0x00010001
    v_mov_b32 v11, 38912
    v_cndmask_b32 v76, v76, v11, vcc
    v_xor_b32 v77, 64, v76
    v_add_u32 v80, 78080, v76
    v_add_u32 v81, 78080, v77
    v_mov_b32 v14, 0x3f803f80
    v_mov_b32 v15, 0x3f803f80
    v_mov_b32 v16, 0x3f803f80
    v_mov_b32 v17, 0x3f803f80
    v_and_b32 v4, 7, v1
    v_lshlrev_b32 v4, 4, v4
    v_mul_u32_u24 v5, 39040, v2
    v_add_u32 v4, v4, v5
    ds_write_b128 v4, v[14:17] offset:38912
    v_mov_b32 v4, 157952
    v_mov_b32 v8, 0
    v_mov_b32 v9, 0
    v_mov_b32 v10, -2
    v_mov_b32 v11, -2
    ds_write_b128 v4, v[8:11]
    v_min_u32 v5, 23, v1
    v_lshl_add_u32 v5, v5, 2, v4
    ds_write_b32 v5, v8 offset:16
    s_mul_i32 s36, s32, 96
    s_sub_u32 s36, s36, 16
    v_add_u32 v96, s36, v1
    v_min_u32 v5, 47, v1
    v_add3_u32 v97, s36, v5, 64
    v_mov_b32 v6, 2047
    v_med3_i32 v96, v96, 0, v6
    v_med3_i32 v97, v97, 0, v6
    v_lshlrev_b32 v96, 3, v96
    v_lshlrev_b32 v97, 3, v97
    s_mov_b32 s46, 8192000
    v_mov_b32 v127, 157984
    s_lshl_b32 s36, s3, 2
    s_add_u32 s36, s36, 158016
    v_mov_b32 v10, s36
    s_mov_b32 vcc_lo, 0x00010001
    s_mov_b32 vcc_hi, 0x00010001
    v_cndmask_b32 v116, 0, v14, vcc
    v_cndmask_b32 v117, 0, v15, vcc
    v_cndmask_b32 v118, 0, v16, vcc
    v_cndmask_b32 v119, 0, v17, vcc
    s_waitcnt vmcnt(0)
    s_waitcnt lgkmcnt(0)
    s_barrier
    s_add_u32 s34, s34, 0x9e3779b8
    s_or_b32 s34, s34, 1
    ds_read_b128 v[108:111], v76 offset:0
    ds_read_b128 v[112:115], v77 offset:0
    ds_read_b64_tr_b16 a[0:1], v20 offset:0
    ds_read_b64_tr_b16 a[2:3], v20 offset:512
    ds_read_b64_tr_b16 a[4:5], v21 offset:0
    ds_read_b64_tr_b16 a[6:7], v21 offset:512
    ds_read_b64_tr_b16 a[8:9], v22 offset:0
    ds_read_b64_tr_b16 a[10:11], v22 offset:512
    ds_read_b64_tr_b16 a[12:13], v23 offset:0
    ds_read_b64_tr_b16 a[14:15], v23 offset:512
    ds_read_b64_tr_b16 a[16:17], v20 offset:8192
    ds_read_b64_tr_b16 a[18:19], v20 offset:8704
    ds_read_b64_tr_b16 a[20:21], v21 offset:8192
    ds_read_b64_tr_b16 a[22:23], v21 offset:8704
    ds_read_b64_tr_b16 a[24:25], v22 offset:8192
    ds_read_b64_tr_b16 a[26:27], v22 offset:8704
    s_waitcnt lgkmcnt(12)
    v_mfma_f32_16x16x32_bf16 v[28:31], a[0:3], v[116:119], 0
    ds_read_b64_tr_b16 a[28:29], v23 offset:8192
    ds_read_b64_tr_b16 a[30:31], v23 offset:8704
    s_waitcnt lgkmcnt(12)
    v_mfma_f32_16x16x32_bf16 v[32:35], a[4:7], v[116:119], 0
    ds_read_b64_tr_b16 a[32:33], v20 offset:16384
    ds_read_b64_tr_b16 a[34:35], v20 offset:16896
    s_waitcnt lgkmcnt(12)
    v_mfma_f32_16x16x32_bf16 v[36:39], a[8:11], v[116:119], 0
    ds_read_b64_tr_b16 a[36:37], v21 offset:16384
    ds_read_b64_tr_b16 a[38:39], v21 offset:16896
    s_waitcnt lgkmcnt(12)
    v_mfma_f32_16x16x32_bf16 v[40:43], a[12:15], v[116:119], 0
    ds_read_b64_tr_b16 a[40:41], v22 offset:16384
    ds_read_b64_tr_b16 a[42:43], v22 offset:16896
    s_waitcnt lgkmcnt(12)
    v_mfma_f32_16x16x32_bf16 v[44:47], a[16:19], v[108:111], 0
    ds_read_b64_tr_b16 a[44:45], v23 offset:16384
    ds_read_b64_tr_b16 a[46:47], v23 offset:16896
    s_waitcnt lgkmcnt(12)
    v_mfma_f32_16x16x32_bf16 v[48:51], a[20:23], v[108:111], 0
    ds_read_b64_tr_b16 a[48:49], v20 offset:4096
    ds_read_b64_tr_b16 a[50:51], v20 offset:4608
    s_waitcnt lgkmcnt(12)
    v_mfma_f32_16x16x32_bf16 v[52:55], a[24:27], v[108:111], 0
    ds_read_b64_tr_b16 a[52:53], v21 offset:4096
    ds_read_b64_tr_b16 a[54:55], v21 offset:4608
    s_waitcnt lgkmcnt(12)
    v_mfma_f32_16x16x32_bf16 v[56:59], a[28:31], v[108:111], 0
    ds_read_b64_tr_b16 a[56:57], v22 offset:4096
    ds_read_b64_tr_b16 a[58:59], v22 offset:4608
    s_waitcnt lgkmcnt(12)
    v_mfma_f32_16x16x32_bf16 v[60:63], v[108:111], a[32:35], 0
    ds_read_b64_tr_b16 a[60:61], v23 offset:4096
    ds_read_b64_tr_b16 a[62:63], v23 offset:4608
    s_waitcnt lgkmcnt(12)
    v_mfma_f32_16x16x32_bf16 v[64:67], v[108:111], a[36:39], 0
    ds_read_b64_tr_b16 a[64:65], v20 offset:12288
    ds_read_b64_tr_b16 a[66:67], v20 offset:12800
    s_waitcnt lgkmcnt(12)
    v_mfma_f32_16x16x32_bf16 v[68:71], v[108:111], a[40:43], 0
    ds_read_b64_tr_b16 a[68:69], v21 offset:12288
    ds_read_b64_tr_b16 a[70:71], v21 offset:12800
    s_waitcnt lgkmcnt(12)
    v_mfma_f32_16x16x32_bf16 v[72:75], v[108:111], a[44:47], 0
    ds_read_b64_tr_b16 a[72:73], v22 offset:12288
    ds_read_b64_tr_b16 a[74:75], v22 offset:12800
    s_waitcnt lgkmcnt(12)
    v_mfma_f32_16x16x32_bf16 v[28:31], a[48:51], v[116:119], v[28:31]
    ds_read_b64_tr_b16 a[76:77], v23 offset:12288
    ds_read_b64_tr_b16 a[78:79], v23 offset:12800
    s_waitcnt lgkmcnt(12)
    v_mfma_f32_16x16x32_bf16 v[32:35], a[52:55], v[116:119], v[32:35]
    ds_read_b64_tr_b16 a[80:81], v20 offset:20480
    ds_read_b64_tr_b16 a[82:83], v20 offset:20992
    s_waitcnt lgkmcnt(12)
    v_mfma_f32_16x16x32_bf16 v[36:39], a[56:59], v[116:119], v[36:39]
    ds_read_b64_tr_b16 a[84:85], v21 offset:20480
    ds_read_b64_tr_b16 a[86:87], v21 offset:20992
    s_waitcnt lgkmcnt(12)
    v_mfma_f32_16x16x32_bf16 v[40:43], a[60:63], v[116:119], v[40:43]
    ds_read_b64_tr_b16 a[88:89], v22 offset:20480
    ds_read_b64_tr_b16 a[90:91], v22 offset:20992
    s_waitcnt lgkmcnt(12)
    v_mfma_f32_16x16x32_bf16 v[44:47], a[64:67], v[112:115], v[44:47]
    ds_read_b64_tr_b16 a[92:93], v23 offset:20480
    ds_read_b64_tr_b16 a[94:95], v23 offset:20992
    s_waitcnt lgkmcnt(12)
    v_mfma_f32_16x16x32_bf16 v[48:51], a[68:71], v[112:115], v[48:51]
    s_waitcnt lgkmcnt(10)
    v_mfma_f32_16x16x32_bf16 v[52:55], a[72:75], v[112:115], v[52:55]
    s_waitcnt lgkmcnt(8)
    v_mfma_f32_16x16x32_bf16 v[56:59], a[76:79], v[112:115], v[56:59]
    s_waitcnt lgkmcnt(6)
    v_mfma_f32_16x16x32_bf16 v[60:63], v[112:115], a[80:83], v[60:63]
    s_waitcnt lgkmcnt(4)
    v_mfma_f32_16x16x32_bf16 v[64:67], v[112:115], a[84:87], v[64:67]
    s_waitcnt lgkmcnt(2)
    v_mfma_f32_16x16x32_bf16 v[68:71], v[112:115], a[88:91], v[68:71]
    s_waitcnt lgkmcnt(0)
    v_mfma_f32_16x16x32_bf16 v[72:75], v[112:115], a[92:95], v[72:75]
    s_barrier
    ds_read_b128 v[108:111], v76 offset:39040
    ds_read_b128 v[112:115], v77 offset:39040
    ds_read_b64_tr_b16 a[0:1], v20 offset:39040
    ds_read_b64_tr_b16 a[2:3], v20 offset:39552
    ds_read_b64_tr_b16 a[4:5], v21 offset:39040
    ds_read_b64_tr_b16 a[6:7], v21 offset:39552
    ds_read_b64_tr_b16 a[8:9], v22 offset:39040
    ds_read_b64_tr_b16 a[10:11], v22 offset:39552
    ds_read_b64_tr_b16 a[12:13], v23 offset:39040
    ds_read_b64_tr_b16 a[14:15], v23 offset:39552
    ds_read_b64_tr_b16 a[16:17], v20 offset:47232
    ds_read_b64_tr_b16 a[18:19], v20 offset:47744
    ds_read_b64_tr_b16 a[20:21], v21 offset:47232
    ds_read_b64_tr_b16 a[22:23], v21 offset:47744
    ds_read_b64_tr_b16 a[24:25], v22 offset:47232
    ds_read_b64_tr_b16 a[26:27], v22 offset:47744
    s_waitcnt lgkmcnt(12)
    v_mfma_f32_16x16x32_bf16 v[28:31], a[0:3], v[116:119], v[28:31]
    ds_read_b64_tr_b16 a[28:29], v23 offset:47232
    ds_read_b64_tr_b16 a[30:31], v23 offset:47744
    s_waitcnt lgkmcnt(12)
    v_mfma_f32_16x16x32_bf16 v[32:35], a[4:7], v[116:119], v[32:35]
    ds_read_b64_tr_b16 a[32:33], v20 offset:55424
    ds_read_b64_tr_b16 a[34:35], v20 offset:55936
    s_waitcnt lgkmcnt(12)
    v_mfma_f32_16x16x32_bf16 v[36:39], a[8:11], v[116:119], v[36:39]
    ds_read_b64_tr_b16 a[36:37], v21 offset:55424
    ds_read_b64_tr_b16 a[38:39], v21 offset:55936
    s_waitcnt lgkmcnt(12)
    v_mfma_f32_16x16x32_bf16 v[40:43], a[12:15], v[116:119], v[40:43]
    ds_read_b64_tr_b16 a[40:41], v22 offset:55424
    ds_read_b64_tr_b16 a[42:43], v22 offset:55936
    s_waitcnt lgkmcnt(12)
    v_mfma_f32_16x16x32_bf16 v[44:47], a[16:19], v[108:111], v[44:47]
    ds_read_b64_tr_b16 a[44:45], v23 offset:55424
    ds_read_b64_tr_b16 a[46:47], v23 offset:55936
    s_waitcnt lgkmcnt(12)
    v_mfma_f32_16x16x32_bf16 v[48:51], a[20:23], v[108:111], v[48:51]
    ds_read_b64_tr_b16 a[48:49], v20 offset:43136
    ds_read_b64_tr_b16 a[50:51], v20 offset:43648
    s_waitcnt lgkmcnt(12)
    v_mfma_f32_16x16x32_bf16 v[52:55], a[24:27], v[108:111], v[52:55]
    ds_read_b64_tr_b16 a[52:53], v21 offset:43136
    ds_read_b64_tr_b16 a[54:55], v21 offset:43648
    s_waitcnt lgkmcnt(12)
    v_mfma_f32_16x16x32_bf16 v[56:59], a[28:31], v[108:111], v[56:59]
    ds_read_b64_tr_b16 a[56:57], v22 offset:43136
    ds_read_b64_tr_b16 a[58:59], v22 offset:43648
    s_waitcnt lgkmcnt(12)
    v_mfma_f32_16x16x32_bf16 v[60:63], v[108:111], a[32:35], v[60:63]
    ds_read_b64_tr_b16 a[60:61], v23 offset:43136
    ds_read_b64_tr_b16 a[62:63], v23 offset:43648
    s_waitcnt lgkmcnt(12)
    v_mfma_f32_16x16x32_bf16 v[64:67], v[108:111], a[36:39], v[64:67]
    ds_read_b64_tr_b16 a[64:65], v20 offset:51328
    ds_read_b64_tr_b16 a[66:67], v20 offset:51840
    s_waitcnt lgkmcnt(12)
    v_mfma_f32_16x16x32_bf16 v[68:71], v[108:111], a[40:43], v[68:71]
    ds_read_b64_tr_b16 a[68:69], v21 offset:51328
    ds_read_b64_tr_b16 a[70:71], v21 offset:51840
    s_waitcnt lgkmcnt(12)
    v_mfma_f32_16x16x32_bf16 v[72:75], v[108:111], a[44:47], v[72:75]
    ds_read_b64_tr_b16 a[72:73], v22 offset:51328
    ds_read_b64_tr_b16 a[74:75], v22 offset:51840
    s_waitcnt lgkmcnt(12)
    v_mfma_f32_16x16x32_bf16 v[28:31], a[48:51], v[116:119], v[28:31]
    ds_read_b64_tr_b16 a[76:77], v23 offset:51328
    ds_read_b64_tr_b16 a[78:79], v23 offset:51840
    s_waitcnt lgkmcnt(12)
    v_mfma_f32_16x16x32_bf16 v[32:35], a[52:55], v[116:119], v[32:35]
    ds_read_b64_tr_b16 a[80:81], v20 offset:59520
    ds_read_b64_tr_b16 a[82:83], v20 offset:60032
    s_waitcnt lgkmcnt(12)
    v_mfma_f32_16x16x32_bf16 v[36:39], a[56:59], v[116:119], v[36:39]
    ds_read_b64_tr_b16 a[84:85], v21 offset:59520
    ds_read_b64_tr_b16 a[86:87], v21 offset:60032
    s_waitcnt lgkmcnt(12)
    v_mfma_f32_16x16x32_bf16 v[40:43], a[60:63], v[116:119], v[40:43]
    ds_read_b64_tr_b16 a[88:89], v22 offset:59520
    ds_read_b64_tr_b16 a[90:91], v22 offset:60032
    s_waitcnt lgkmcnt(12)
    v_mfma_f32_16x16x32_bf16 v[44:47], a[64:67], v[112:115], v[44:47]
    ds_read_b64_tr_b16 a[92:93], v23 offset:59520
    ds_read_b64_tr_b16 a[94:95], v23 offset:60032
    s_waitcnt lgkmcnt(12)
    v_mfma_f32_16x16x32_bf16 v[48:51], a[68:71], v[112:115], v[48:51]
    s_waitcnt lgkmcnt(10)
    v_mfma_f32_16x16x32_bf16 v[52:55], a[72:75], v[112:115], v[52:55]
    s_waitcnt lgkmcnt(8)
    v_mfma_f32_16x16x32_bf16 v[56:59], a[76:79], v[112:115], v[56:59]
    s_waitcnt lgkmcnt(6)
    v_mfma_f32_16x16x32_bf16 v[60:63], v[112:115], a[80:83], v[60:63]
    s_waitcnt lgkmcnt(4)
    v_mfma_f32_16x16x32_bf16 v[64:67], v[112:115], a[84:87], v[64:67]
    s_waitcnt lgkmcnt(2)
    v_mfma_f32_16x16x32_bf16 v[68:71], v[112:115], a[88:91], v[68:71]
    s_waitcnt lgkmcnt(0)
    v_mfma_f32_16x16x32_bf16 v[72:75], v[112:115], a[92:95], v[72:75]
    s_mov_b64 exec, 1
    s_lshl_b32 s36, s2, 2
    s_add_u32 s36, s36, 8323072
    v_mov_b32 v4, s34
    v_mov_b32 v5, s36
    buffer_store_dword v4, v5, s[28:31], 0 offen sc1
    s_mov_b64 exec, -1
    s_barrier
    ds_read_b128 v[108:111], v80 offset:0
    ds_read_b128 v[112:115], v81 offset:0
    ds_read_b64_tr_b16 a[0:1], v24 offset:0
    ds_read_b64_tr_b16 a[2:3], v24 offset:512
    ds_read_b64_tr_b16 a[4:5], v25 offset:0
    ds_read_b64_tr_b16 a[6:7], v25 offset:512
    ds_read_b64_tr_b16 a[8:9], v26 offset:0
    ds_read_b64_tr_b16 a[10:11], v26 offset:512
    ds_read_b64_tr_b16 a[12:13], v27 offset:0
    ds_read_b64_tr_b16 a[14:15], v27 offset:512
    ds_read_b64_tr_b16 a[16:17], v24 offset:8192
    ds_read_b64_tr_b16 a[18:19], v24 offset:8704
    ds_read_b64_tr_b16 a[20:21], v25 offset:8192
    ds_read_b64_tr_b16 a[22:23], v25 offset:8704
    ds_read_b64_tr_b16 a[24:25], v26 offset:8192
    ds_read_b64_tr_b16 a[26:27], v26 offset:8704
    s_waitcnt lgkmcnt(12)
    v_mfma_f32_16x16x32_bf16 v[28:31], a[0:3], v[116:119], v[28:31]
    ds_read_b64_tr_b16 a[28:29], v27 offset:8192
    ds_read_b64_tr_b16 a[30:31], v27 offset:8704
    s_waitcnt lgkmcnt(12)
    v_mfma_f32_16x16x32_bf16 v[32:35], a[4:7], v[116:119], v[32:35]
    ds_read_b64_tr_b16 a[32:33], v24 offset:16384
    ds_read_b64_tr_b16 a[34:35], v24 offset:16896
    s_waitcnt lgkmcnt(12)
    v_mfma_f32_16x16x32_bf16 v[36:39], a[8:11], v[116:119], v[36:39]
    ds_read_b64_tr_b16 a[36:37], v25 offset:16384
    ds_read_b64_tr_b16 a[38:39], v25 offset:16896
    s_waitcnt lgkmcnt(12)
    v_mfma_f32_16x16x32_bf16 v[40:43], a[12:15], v[116:119], v[40:43]
    ds_read_b64_tr_b16 a[40:41], v26 offset:16384
    ds_read_b64_tr_b16 a[42:43], v26 offset:16896
    s_waitcnt lgkmcnt(12)
    v_mfma_f32_16x16x32_bf16 v[44:47], a[16:19], v[108:111], v[44:47]
    ds_read_b64_tr_b16 a[44:45], v27 offset:16384
    ds_read_b64_tr_b16 a[46:47], v27 offset:16896
    s_waitcnt lgkmcnt(12)
    v_mfma_f32_16x16x32_bf16 v[48:51], a[20:23], v[108:111], v[48:51]
    ds_read_b64_tr_b16 a[48:49], v24 offset:4096
    ds_read_b64_tr_b16 a[50:51], v24 offset:4608
    s_waitcnt lgkmcnt(12)
    v_mfma_f32_16x16x32_bf16 v[52:55], a[24:27], v[108:111], v[52:55]
    ds_read_b64_tr_b16 a[52:53], v25 offset:4096
    ds_read_b64_tr_b16 a[54:55], v25 offset:4608
    s_waitcnt lgkmcnt(12)
    v_mfma_f32_16x16x32_bf16 v[56:59], a[28:31], v[108:111], v[56:59]
    ds_read_b64_tr_b16 a[56:57], v26 offset:4096
    ds_read_b64_tr_b16 a[58:59], v26 offset:4608
    s_waitcnt lgkmcnt(12)
    v_mfma_f32_16x16x32_bf16 v[60:63], v[108:111], a[32:35], v[60:63]
    ds_read_b64_tr_b16 a[60:61], v27 offset:4096
    ds_read_b64_tr_b16 a[62:63], v27 offset:4608
    s_waitcnt lgkmcnt(12)
    v_mfma_f32_16x16x32_bf16 v[64:67], v[108:111], a[36:39], v[64:67]
    ds_read_b64_tr_b16 a[64:65], v24 offset:12288
    ds_read_b64_tr_b16 a[66:67], v24 offset:12800
    s_waitcnt lgkmcnt(12)
    v_mfma_f32_16x16x32_bf16 v[68:71], v[108:111], a[40:43], v[68:71]
    ds_read_b64_tr_b16 a[68:69], v25 offset:12288
    ds_read_b64_tr_b16 a[70:71], v25 offset:12800
    s_waitcnt lgkmcnt(12)
    v_mfma_f32_16x16x32_bf16 v[72:75], v[108:111], a[44:47], v[72:75]
    ds_read_b64_tr_b16 a[72:73], v26 offset:12288
    ds_read_b64_tr_b16 a[74:75], v26 offset:12800
    s_waitcnt lgkmcnt(12)
    v_mfma_f32_16x16x32_bf16 v[28:31], a[48:51], v[116:119], v[28:31]
    ds_read_b64_tr_b16 a[76:77], v27 offset:12288
    ds_read_b64_tr_b16 a[78:79], v27 offset:12800
    s_waitcnt lgkmcnt(12)
    v_mfma_f32_16x16x32_bf16 v[32:35], a[52:55], v[116:119], v[32:35]
    ds_read_b64_tr_b16 a[80:81], v24 offset:20480
    ds_read_b64_tr_b16 a[82:83], v24 offset:20992
    s_waitcnt lgkmcnt(12)
    v_mfma_f32_16x16x32_bf16 v[36:39], a[56:59], v[116:119], v[36:39]
    ds_read_b64_tr_b16 a[84:85], v25 offset:20480
    ds_read_b64_tr_b16 a[86:87], v25 offset:20992
    s_waitcnt lgkmcnt(12)
    v_mfma_f32_16x16x32_bf16 v[40:43], a[60:63], v[116:119], v[40:43]
    ds_read_b64_tr_b16 a[88:89], v26 offset:20480
    ds_read_b64_tr_b16 a[90:91], v26 offset:20992
    s_waitcnt lgkmcnt(12)
    v_mfma_f32_16x16x32_bf16 v[44:47], a[64:67], v[112:115], v[44:47]
    ds_read_b64_tr_b16 a[92:93], v27 offset:20480
    ds_read_b64_tr_b16 a[94:95], v27 offset:20992
    s_waitcnt lgkmcnt(12)
    v_mfma_f32_16x16x32_bf16 v[48:51], a[68:71], v[112:115], v[48:51]
    s_waitcnt lgkmcnt(10)
    v_mfma_f32_16x16x32_bf16 v[52:55], a[72:75], v[112:115], v[52:55]
    s_waitcnt lgkmcnt(8)
    v_mfma_f32_16x16x32_bf16 v[56:59], a[76:79], v[112:115], v[56:59]
    s_waitcnt lgkmcnt(6)
    v_mfma_f32_16x16x32_bf16 v[60:63], v[112:115], a[80:83], v[60:63]
    s_waitcnt lgkmcnt(4)
    v_mfma_f32_16x16x32_bf16 v[64:67], v[112:115], a[84:87], v[64:67]
    s_waitcnt lgkmcnt(2)
    v_mfma_f32_16x16x32_bf16 v[68:71], v[112:115], a[88:91], v[68:71]
    s_waitcnt lgkmcnt(0)
    v_mfma_f32_16x16x32_bf16 v[72:75], v[112:115], a[92:95], v[72:75]
    s_barrier
    ds_read_b128 v[108:111], v80 offset:39040
    ds_read_b128 v[112:115], v81 offset:39040
    ds_read_b64_tr_b16 a[0:1], v24 offset:39040
    ds_read_b64_tr_b16 a[2:3], v24 offset:39552
    ds_read_b64_tr_b16 a[4:5], v25 offset:39040
    ds_read_b64_tr_b16 a[6:7], v25 offset:39552
    ds_read_b64_tr_b16 a[8:9], v26 offset:39040
    ds_read_b64_tr_b16 a[10:11], v26 offset:39552
    ds_read_b64_tr_b16 a[12:13], v27 offset:39040
    ds_read_b64_tr_b16 a[14:15], v27 offset:39552
    ds_read_b64_tr_b16 a[16:17], v24 offset:47232
    ds_read_b64_tr_b16 a[18:19], v24 offset:47744
    ds_read_b64_tr_b16 a[20:21], v25 offset:47232
    ds_read_b64_tr_b16 a[22:23], v25 offset:47744
    ds_read_b64_tr_b16 a[24:25], v26 offset:47232
    ds_read_b64_tr_b16 a[26:27], v26 offset:47744
    s_waitcnt lgkmcnt(12)
    v_mfma_f32_16x16x32_bf16 v[28:31], a[0:3], v[116:119], v[28:31]
    ds_read_b64_tr_b16 a[28:29], v27 offset:47232
    ds_read_b64_tr_b16 a[30:31], v27 offset:47744
    s_waitcnt lgkmcnt(12)
    v_mfma_f32_16x16x32_bf16 v[32:35], a[4:7], v[116:119], v[32:35]
    ds_read_b64_tr_b16 a[32:33], v24 offset:55424
    ds_read_b64_tr_b16 a[34:35], v24 offset:55936
    s_waitcnt lgkmcnt(12)
    v_mfma_f32_16x16x32_bf16 v[36:39], a[8:11], v[116:119], v[36:39]
    ds_read_b64_tr_b16 a[36:37], v25 offset:55424
    ds_read_b64_tr_b16 a[38:39], v25 offset:55936
    s_waitcnt lgkmcnt(12)
    v_mfma_f32_16x16x32_bf16 v[40:43], a[12:15], v[116:119], v[40:43]
    ds_read_b64_tr_b16 a[40:41], v26 offset:55424
    ds_read_b64_tr_b16 a[42:43], v26 offset:55936
    s_waitcnt lgkmcnt(12)
    v_mfma_f32_16x16x32_bf16 v[44:47], a[16:19], v[108:111], v[44:47]
    ds_read_b64_tr_b16 a[44:45], v27 offset:55424
    ds_read_b64_tr_b16 a[46:47], v27 offset:55936
    s_waitcnt lgkmcnt(12)
    v_mfma_f32_16x16x32_bf16 v[48:51], a[20:23], v[108:111], v[48:51]
    ds_read_b64_tr_b16 a[48:49], v24 offset:43136
    ds_read_b64_tr_b16 a[50:51], v24 offset:43648
    s_waitcnt lgkmcnt(12)
    v_mfma_f32_16x16x32_bf16 v[52:55], a[24:27], v[108:111], v[52:55]
    ds_read_b64_tr_b16 a[52:53], v25 offset:43136
    ds_read_b64_tr_b16 a[54:55], v25 offset:43648
    s_waitcnt lgkmcnt(12)
    v_mfma_f32_16x16x32_bf16 v[56:59], a[28:31], v[108:111], v[56:59]
    ds_read_b64_tr_b16 a[56:57], v26 offset:43136
    ds_read_b64_tr_b16 a[58:59], v26 offset:43648
    s_waitcnt lgkmcnt(12)
    v_mfma_f32_16x16x32_bf16 v[60:63], v[108:111], a[32:35], v[60:63]
    ds_read_b64_tr_b16 a[60:61], v27 offset:43136
    ds_read_b64_tr_b16 a[62:63], v27 offset:43648
    s_waitcnt lgkmcnt(12)
    v_mfma_f32_16x16x32_bf16 v[64:67], v[108:111], a[36:39], v[64:67]
    ds_read_b64_tr_b16 a[64:65], v24 offset:51328
    ds_read_b64_tr_b16 a[66:67], v24 offset:51840
    s_waitcnt lgkmcnt(12)
    v_mfma_f32_16x16x32_bf16 v[68:71], v[108:111], a[40:43], v[68:71]
    ds_read_b64_tr_b16 a[68:69], v25 offset:51328
    ds_read_b64_tr_b16 a[70:71], v25 offset:51840
    s_waitcnt lgkmcnt(12)
    v_mfma_f32_16x16x32_bf16 v[72:75], v[108:111], a[44:47], v[72:75]
    ds_read_b64_tr_b16 a[72:73], v26 offset:51328
    ds_read_b64_tr_b16 a[74:75], v26 offset:51840
    s_waitcnt lgkmcnt(12)
    v_mfma_f32_16x16x32_bf16 v[28:31], a[48:51], v[116:119], v[28:31]
    ds_read_b64_tr_b16 a[76:77], v27 offset:51328
    ds_read_b64_tr_b16 a[78:79], v27 offset:51840
    s_waitcnt lgkmcnt(12)
    v_mfma_f32_16x16x32_bf16 v[32:35], a[52:55], v[116:119], v[32:35]
    ds_read_b64_tr_b16 a[80:81], v24 offset:59520
    ds_read_b64_tr_b16 a[82:83], v24 offset:60032
    s_waitcnt lgkmcnt(12)
    v_mfma_f32_16x16x32_bf16 v[36:39], a[56:59], v[116:119], v[36:39]
    ds_read_b64_tr_b16 a[84:85], v25 offset:59520
    ds_read_b64_tr_b16 a[86:87], v25 offset:60032
    s_waitcnt lgkmcnt(12)
    v_mfma_f32_16x16x32_bf16 v[40:43], a[60:63], v[116:119], v[40:43]
    ds_read_b64_tr_b16 a[88:89], v26 offset:59520
    ds_read_b64_tr_b16 a[90:91], v26 offset:60032
    s_waitcnt lgkmcnt(12)
    v_mfma_f32_16x16x32_bf16 v[44:47], a[64:67], v[112:115], v[44:47]
    ds_read_b64_tr_b16 a[92:93], v27 offset:59520
    ds_read_b64_tr_b16 a[94:95], v27 offset:60032
    s_waitcnt lgkmcnt(12)
    v_mfma_f32_16x16x32_bf16 v[48:51], a[68:71], v[112:115], v[48:51]
    s_waitcnt lgkmcnt(10)
    v_mfma_f32_16x16x32_bf16 v[52:55], a[72:75], v[112:115], v[52:55]
    s_waitcnt lgkmcnt(8)
    v_mfma_f32_16x16x32_bf16 v[56:59], a[76:79], v[112:115], v[56:59]
    s_waitcnt lgkmcnt(6)
    v_mfma_f32_16x16x32_bf16 v[60:63], v[112:115], a[80:83], v[60:63]
    s_waitcnt lgkmcnt(4)
    v_mfma_f32_16x16x32_bf16 v[64:67], v[112:115], a[84:87], v[64:67]
    s_waitcnt lgkmcnt(2)
    v_mfma_f32_16x16x32_bf16 v[68:71], v[112:115], a[88:91], v[68:71]
    s_waitcnt lgkmcnt(0)
    v_mfma_f32_16x16x32_bf16 v[72:75], v[112:115], a[92:95], v[72:75]
    v_add_u32 v4, 156224, v12
    v_min_u32 v5, 47, v1
    v_lshlrev_b32 v5, 2, v5
    v_add_u32 v5, 156480, v5
    v_lshlrev_b32 v6, 4, v2
    v_add_u32 v6, 157184, v6
    v_mov_b32 v7, 157968
    v_lshlrev_b32 v11, 2, v3
    v_add_u32 v11, 156224, v11
    s_barrier
    ds_read_b128 v[108:111], v76 offset:0
    ds_read_b128 v[112:115], v77 offset:0
    ds_read_b64_tr_b16 a[0:1], v20 offset:0
    ds_read_b64_tr_b16 a[2:3], v20 offset:512
    ds_read_b64_tr_b16 a[4:5], v21 offset:0
    ds_read_b64_tr_b16 a[6:7], v21 offset:512
    ds_read_b64_tr_b16 a[8:9], v22 offset:0
    ds_read_b64_tr_b16 a[10:11], v22 offset:512
    ds_read_b64_tr_b16 a[12:13], v23 offset:0
    ds_read_b64_tr_b16 a[14:15], v23 offset:512
    ds_read_b64_tr_b16 a[16:17], v20 offset:8192
    ds_read_b64_tr_b16 a[18:19], v20 offset:8704
    ds_read_b64_tr_b16 a[20:21], v21 offset:8192
    ds_read_b64_tr_b16 a[22:23], v21 offset:8704
    ds_read_b64_tr_b16 a[24:25], v22 offset:8192
    ds_read_b64_tr_b16 a[26:27], v22 offset:8704
    s_waitcnt lgkmcnt(12)
    v_mfma_f32_16x16x32_bf16 v[28:31], a[0:3], v[116:119], v[28:31]
    ds_read_b64_tr_b16 a[28:29], v23 offset:8192
    ds_read_b64_tr_b16 a[30:31], v23 offset:8704
    s_waitcnt lgkmcnt(12)
    v_mfma_f32_16x16x32_bf16 v[32:35], a[4:7], v[116:119], v[32:35]
    ds_read_b64_tr_b16 a[32:33], v20 offset:16384
    ds_read_b64_tr_b16 a[34:35], v20 offset:16896
    s_waitcnt lgkmcnt(12)
    v_mfma_f32_16x16x32_bf16 v[36:39], a[8:11], v[116:119], v[36:39]
    ds_read_b64_tr_b16 a[36:37], v21 offset:16384
    ds_read_b64_tr_b16 a[38:39], v21 offset:16896
    s_waitcnt lgkmcnt(12)
    v_mfma_f32_16x16x32_bf16 v[40:43], a[12:15], v[116:119], v[40:43]
    ds_read_b64_tr_b16 a[40:41], v22 offset:16384
    ds_read_b64_tr_b16 a[42:43], v22 offset:16896
    s_waitcnt lgkmcnt(12)
    v_mfma_f32_16x16x32_bf16 v[44:47], a[16:19], v[108:111], v[44:47]
    ds_read_b64_tr_b16 a[44:45], v23 offset:16384
    ds_read_b64_tr_b16 a[46:47], v23 offset:16896
    s_waitcnt lgkmcnt(12)
    v_mfma_f32_16x16x32_bf16 v[48:51], a[20:23], v[108:111], v[48:51]
    ds_read_b64_tr_b16 a[48:49], v20 offset:4096
    ds_read_b64_tr_b16 a[50:51], v20 offset:4608
    s_waitcnt lgkmcnt(12)
    v_mfma_f32_16x16x32_bf16 v[52:55], a[24:27], v[108:111], v[52:55]
    ds_read_b64_tr_b16 a[52:53], v21 offset:4096
    ds_read_b64_tr_b16 a[54:55], v21 offset:4608
    s_waitcnt lgkmcnt(12)
    v_mfma_f32_16x16x32_bf16 v[56:59], a[28:31], v[108:111], v[56:59]
    ds_read_b64_tr_b16 a[56:57], v22 offset:4096
    ds_read_b64_tr_b16 a[58:59], v22 offset:4608
    s_waitcnt lgkmcnt(12)
    v_mfma_f32_16x16x32_bf16 v[60:63], v[108:111], a[32:35], v[60:63]
    ds_read_b64_tr_b16 a[60:61], v23 offset:4096
    ds_read_b64_tr_b16 a[62:63], v23 offset:4608
    s_waitcnt lgkmcnt(12)
    v_mfma_f32_16x16x32_bf16 v[64:67], v[108:111], a[36:39], v[64:67]
    ds_read_b64_tr_b16 a[64:65], v20 offset:12288
    ds_read_b64_tr_b16 a[66:67], v20 offset:12800
    s_waitcnt lgkmcnt(12)
    v_mfma_f32_16x16x32_bf16 v[68:71], v[108:111], a[40:43], v[68:71]
    ds_read_b64_tr_b16 a[68:69], v21 offset:12288
    ds_read_b64_tr_b16 a[70:71], v21 offset:12800
    s_waitcnt lgkmcnt(12)
    v_mfma_f32_16x16x32_bf16 v[72:75], v[108:111], a[44:47], v[72:75]
    ds_read_b64_tr_b16 a[72:73], v22 offset:12288
    ds_read_b64_tr_b16 a[74:75], v22 offset:12800
    s_waitcnt lgkmcnt(12)
    v_mfma_f32_16x16x32_bf16 v[28:31], a[48:51], v[116:119], v[28:31]
    ds_read_b64_tr_b16 a[76:77], v23 offset:12288
    ds_read_b64_tr_b16 a[78:79], v23 offset:12800
    s_waitcnt lgkmcnt(12)
    v_mfma_f32_16x16x32_bf16 v[32:35], a[52:55], v[116:119], v[32:35]
    ds_read_b64_tr_b16 a[80:81], v20 offset:20480
    ds_read_b64_tr_b16 a[82:83], v20 offset:20992
    s_waitcnt lgkmcnt(12)
    v_mfma_f32_16x16x32_bf16 v[36:39], a[56:59], v[116:119], v[36:39]
    ds_read_b64_tr_b16 a[84:85], v21 offset:20480
    ds_read_b64_tr_b16 a[86:87], v21 offset:20992
    s_waitcnt lgkmcnt(12)
    v_mfma_f32_16x16x32_bf16 v[40:43], a[60:63], v[116:119], v[40:43]
    ds_read_b64_tr_b16 a[88:89], v22 offset:20480
    ds_read_b64_tr_b16 a[90:91], v22 offset:20992
    s_waitcnt lgkmcnt(12)
    v_mfma_f32_16x16x32_bf16 v[44:47], a[64:67], v[112:115], v[44:47]
    ds_read_b64_tr_b16 a[92:93], v23 offset:20480
    ds_read_b64_tr_b16 a[94:95], v23 offset:20992
    s_waitcnt lgkmcnt(12)
    v_mfma_f32_16x16x32_bf16 v[48:51], a[68:71], v[112:115], v[48:51]
    s_waitcnt lgkmcnt(10)
    v_mfma_f32_16x16x32_bf16 v[52:55], a[72:75], v[112:115], v[52:55]
    s_waitcnt lgkmcnt(8)
    v_mfma_f32_16x16x32_bf16 v[56:59], a[76:79], v[112:115], v[56:59]
    s_waitcnt lgkmcnt(6)
    v_mfma_f32_16x16x32_bf16 v[60:63], v[112:115], a[80:83], v[60:63]
    s_waitcnt lgkmcnt(4)
    v_mfma_f32_16x16x32_bf16 v[64:67], v[112:115], a[84:87], v[64:67]
    s_waitcnt lgkmcnt(2)
    v_mfma_f32_16x16x32_bf16 v[68:71], v[112:115], a[88:91], v[68:71]
    s_waitcnt lgkmcnt(0)
    v_mfma_f32_16x16x32_bf16 v[72:75], v[112:115], a[92:95], v[72:75]
    s_barrier
    ds_read_b128 v[108:111], v76 offset:39040
    ds_read_b128 v[112:115], v77 offset:39040
    ds_read_b64_tr_b16 a[0:1], v20 offset:39040
    ds_read_b64_tr_b16 a[2:3], v20 offset:39552
    ds_read_b64_tr_b16 a[4:5], v21 offset:39040
    ds_read_b64_tr_b16 a[6:7], v21 offset:39552
    ds_read_b64_tr_b16 a[8:9], v22 offset:39040
    ds_read_b64_tr_b16 a[10:11], v22 offset:39552
    ds_read_b64_tr_b16 a[12:13], v23 offset:39040
    ds_read_b64_tr_b16 a[14:15], v23 offset:39552
    ds_read_b64_tr_b16 a[16:17], v20 offset:47232
    ds_read_b64_tr_b16 a[18:19], v20 offset:47744
    ds_read_b64_tr_b16 a[20:21], v21 offset:47232
    ds_read_b64_tr_b16 a[22:23], v21 offset:47744
    ds_read_b64_tr_b16 a[24:25], v22 offset:47232
    ds_read_b64_tr_b16 a[26:27], v22 offset:47744
    s_waitcnt lgkmcnt(12)
    v_mfma_f32_16x16x32_bf16 v[28:31], a[0:3], v[116:119], v[28:31]
    ds_read_b64_tr_b16 a[28:29], v23 offset:47232
    ds_read_b64_tr_b16 a[30:31], v23 offset:47744
    s_waitcnt lgkmcnt(12)
    v_mfma_f32_16x16x32_bf16 v[32:35], a[4:7], v[116:119], v[32:35]
    ds_read_b64_tr_b16 a[32:33], v20 offset:55424
    ds_read_b64_tr_b16 a[34:35], v20 offset:55936
    s_waitcnt lgkmcnt(12)
    v_mfma_f32_16x16x32_bf16 v[36:39], a[8:11], v[116:119], v[36:39]
    ds_read_b64_tr_b16 a[36:37], v21 offset:55424
    ds_read_b64_tr_b16 a[38:39], v21 offset:55936
    s_waitcnt lgkmcnt(12)
    v_mfma_f32_16x16x32_bf16 v[40:43], a[12:15], v[116:119], v[40:43]
    ds_read_b64_tr_b16 a[40:41], v22 offset:55424
    ds_read_b64_tr_b16 a[42:43], v22 offset:55936
    s_waitcnt lgkmcnt(12)
    v_mfma_f32_16x16x32_bf16 v[44:47], a[16:19], v[108:111], v[44:47]
    ds_read_b64_tr_b16 a[44:45], v23 offset:55424
    ds_read_b64_tr_b16 a[46:47], v23 offset:55936
    s_waitcnt lgkmcnt(12)
    v_mfma_f32_16x16x32_bf16 v[48:51], a[20:23], v[108:111], v[48:51]
    ds_read_b64_tr_b16 a[48:49], v20 offset:43136
    ds_read_b64_tr_b16 a[50:51], v20 offset:43648
    s_waitcnt lgkmcnt(12)
    v_mfma_f32_16x16x32_bf16 v[52:55], a[24:27], v[108:111], v[52:55]
    ds_read_b64_tr_b16 a[52:53], v21 offset:43136
    ds_read_b64_tr_b16 a[54:55], v21 offset:43648
    s_waitcnt lgkmcnt(12)
    v_mfma_f32_16x16x32_bf16 v[56:59], a[28:31], v[108:111], v[56:59]
    ds_read_b64_tr_b16 a[56:57], v22 offset:43136
    ds_read_b64_tr_b16 a[58:59], v22 offset:43648
    s_waitcnt lgkmcnt(12)
    v_mfma_f32_16x16x32_bf16 v[60:63], v[108:111], a[32:35], v[60:63]
    ds_read_b64_tr_b16 a[60:61], v23 offset:43136
    ds_read_b64_tr_b16 a[62:63], v23 offset:43648
    s_waitcnt lgkmcnt(12)
    v_mfma_f32_16x16x32_bf16 v[64:67], v[108:111], a[36:39], v[64:67]
    ds_read_b64_tr_b16 a[64:65], v20 offset:51328
    ds_read_b64_tr_b16 a[66:67], v20 offset:51840
    s_waitcnt lgkmcnt(12)
    v_mfma_f32_16x16x32_bf16 v[68:71], v[108:111], a[40:43], v[68:71]
    ds_read_b64_tr_b16 a[68:69], v21 offset:51328
    ds_read_b64_tr_b16 a[70:71], v21 offset:51840
    s_waitcnt lgkmcnt(12)
    v_mfma_f32_16x16x32_bf16 v[72:75], v[108:111], a[44:47], v[72:75]
    ds_read_b64_tr_b16 a[72:73], v22 offset:51328
    ds_read_b64_tr_b16 a[74:75], v22 offset:51840
    s_waitcnt lgkmcnt(12)
    v_mfma_f32_16x16x32_bf16 v[28:31], a[48:51], v[116:119], v[28:31]
    ds_read_b64_tr_b16 a[76:77], v23 offset:51328
    ds_read_b64_tr_b16 a[78:79], v23 offset:51840
    s_waitcnt lgkmcnt(12)
    v_mfma_f32_16x16x32_bf16 v[32:35], a[52:55], v[116:119], v[32:35]
    ds_read_b64_tr_b16 a[80:81], v20 offset:59520
    ds_read_b64_tr_b16 a[82:83], v20 offset:60032
    s_waitcnt lgkmcnt(12)
    v_mfma_f32_16x16x32_bf16 v[36:39], a[56:59], v[116:119], v[36:39]
    ds_read_b64_tr_b16 a[84:85], v21 offset:59520
    ds_read_b64_tr_b16 a[86:87], v21 offset:60032
    s_waitcnt lgkmcnt(12)
    v_mfma_f32_16x16x32_bf16 v[40:43], a[60:63], v[116:119], v[40:43]
    ds_read_b64_tr_b16 a[88:89], v22 offset:59520
    ds_read_b64_tr_b16 a[90:91], v22 offset:60032
    s_waitcnt lgkmcnt(12)
    v_mfma_f32_16x16x32_bf16 v[44:47], a[64:67], v[112:115], v[44:47]
    ds_read_b64_tr_b16 a[92:93], v23 offset:59520
    ds_read_b64_tr_b16 a[94:95], v23 offset:60032
    s_waitcnt lgkmcnt(12)
    v_mfma_f32_16x16x32_bf16 v[48:51], a[68:71], v[112:115], v[48:51]
    s_waitcnt lgkmcnt(10)
    v_mfma_f32_16x16x32_bf16 v[52:55], a[72:75], v[112:115], v[52:55]
    s_waitcnt lgkmcnt(8)
    v_mfma_f32_16x16x32_bf16 v[56:59], a[76:79], v[112:115], v[56:59]
    s_waitcnt lgkmcnt(6)
    v_mfma_f32_16x16x32_bf16 v[60:63], v[112:115], a[80:83], v[60:63]
    s_waitcnt lgkmcnt(4)
    v_mfma_f32_16x16x32_bf16 v[64:67], v[112:115], a[84:87], v[64:67]
    s_waitcnt lgkmcnt(2)
    v_mfma_f32_16x16x32_bf16 v[68:71], v[112:115], a[88:91], v[68:71]
    s_waitcnt lgkmcnt(0)
    v_mfma_f32_16x16x32_bf16 v[72:75], v[112:115], a[92:95], v[72:75]
    s_barrier
    ds_read_b128 a[96:99], v80 offset:0
    ds_read_b128 a[100:103], v81 offset:0
    ds_read_b64_tr_b16 a[0:1], v24 offset:0
    ds_read_b64_tr_b16 a[2:3], v24 offset:512
    ds_read_b64_tr_b16 a[4:5], v25 offset:0
    ds_read_b64_tr_b16 a[6:7], v25 offset:512
    ds_read_b64_tr_b16 a[8:9], v26 offset:0
    ds_read_b64_tr_b16 a[10:11], v26 offset:512
    ds_read_b64_tr_b16 a[12:13], v27 offset:0
    ds_read_b64_tr_b16 a[14:15], v27 offset:512
    ds_read_b64_tr_b16 a[16:17], v24 offset:8192
    ds_read_b64_tr_b16 a[18:19], v24 offset:8704
    ds_read_b64_tr_b16 a[20:21], v25 offset:8192
    ds_read_b64_tr_b16 a[22:23], v25 offset:8704
    ds_read_b64_tr_b16 a[24:25], v26 offset:8192
    ds_read_b64_tr_b16 a[26:27], v26 offset:8704
    s_waitcnt lgkmcnt(12)
    v_mfma_f32_16x16x32_bf16 v[28:31], a[0:3], v[116:119], v[28:31]
    ds_read_b64_tr_b16 a[28:29], v27 offset:8192
    ds_read_b64_tr_b16 a[30:31], v27 offset:8704
    s_waitcnt lgkmcnt(12)
    v_mfma_f32_16x16x32_bf16 v[32:35], a[4:7], v[116:119], v[32:35]
    ds_read_b64_tr_b16 a[48:49], v24 offset:4096
    ds_read_b64_tr_b16 a[50:51], v24 offset:4608
    s_waitcnt lgkmcnt(12)
    v_mfma_f32_16x16x32_bf16 v[36:39], a[8:11], v[116:119], v[36:39]
    ds_read_b64_tr_b16 a[52:53], v25 offset:4096
    ds_read_b64_tr_b16 a[54:55], v25 offset:4608
    s_waitcnt lgkmcnt(12)
    v_mfma_f32_16x16x32_bf16 v[40:43], a[12:15], v[116:119], v[40:43]
    ds_read_b64_tr_b16 a[56:57], v26 offset:4096
    ds_read_b64_tr_b16 a[58:59], v26 offset:4608
    s_waitcnt lgkmcnt(12)
    v_mfma_f32_16x16x32_bf16 v[44:47], a[16:19], a[96:99], v[44:47]
    ds_read_b64_tr_b16 a[60:61], v27 offset:4096
    ds_read_b64_tr_b16 a[62:63], v27 offset:4608
    s_waitcnt lgkmcnt(12)
    v_mfma_f32_16x16x32_bf16 v[48:51], a[20:23], a[96:99], v[48:51]
    ds_read_b64_tr_b16 a[64:65], v24 offset:12288
    ds_read_b64_tr_b16 a[66:67], v24 offset:12800
    s_waitcnt lgkmcnt(12)
    v_mfma_f32_16x16x32_bf16 v[52:55], a[24:27], a[96:99], v[52:55]
    ds_read_b64_tr_b16 a[68:69], v25 offset:12288
    ds_read_b64_tr_b16 a[70:71], v25 offset:12800
    s_waitcnt lgkmcnt(12)
    v_mfma_f32_16x16x32_bf16 v[56:59], a[28:31], a[96:99], v[56:59]
    ds_read_b64_tr_b16 a[72:73], v26 offset:12288
    ds_read_b64_tr_b16 a[74:75], v26 offset:12800
    s_waitcnt lgkmcnt(12)
    v_mfma_f32_16x16x32_bf16 v[28:31], a[48:51], v[116:119], v[28:31]
    ds_read_b64_tr_b16 a[76:77], v27 offset:12288
    ds_read_b64_tr_b16 a[78:79], v27 offset:12800
    s_waitcnt lgkmcnt(12)
    v_mfma_f32_16x16x32_bf16 v[32:35], a[52:55], v[116:119], v[32:35]
    s_waitcnt lgkmcnt(10)
    v_mfma_f32_16x16x32_bf16 v[36:39], a[56:59], v[116:119], v[36:39]
    s_waitcnt lgkmcnt(8)
    v_mfma_f32_16x16x32_bf16 v[40:43], a[60:63], v[116:119], v[40:43]
    s_waitcnt lgkmcnt(6)
    v_mfma_f32_16x16x32_bf16 v[44:47], a[64:67], a[100:103], v[44:47]
    s_waitcnt lgkmcnt(4)
    v_mfma_f32_16x16x32_bf16 v[48:51], a[68:71], a[100:103], v[48:51]
    s_waitcnt lgkmcnt(2)
    v_mfma_f32_16x16x32_bf16 v[52:55], a[72:75], a[100:103], v[52:55]
    s_waitcnt lgkmcnt(0)
    v_mfma_f32_16x16x32_bf16 v[56:59], a[76:79], a[100:103], v[56:59]
    s_barrier
    ds_read_b128 a[104:107], v80 offset:39040
    ds_read_b128 a[108:111], v81 offset:39040
    ds_read_b64_tr_b16 a[0:1], v24 offset:39040
    ds_read_b64_tr_b16 a[2:3], v24 offset:39552
    ds_read_b64_tr_b16 a[4:5], v25 offset:39040
    ds_read_b64_tr_b16 a[6:7], v25 offset:39552
    ds_read_b64_tr_b16 a[8:9], v26 offset:39040
    ds_read_b64_tr_b16 a[10:11], v26 offset:39552
    ds_read_b64_tr_b16 a[12:13], v27 offset:39040
    ds_read_b64_tr_b16 a[14:15], v27 offset:39552
    ds_read_b64_tr_b16 a[16:17], v24 offset:47232
    ds_read_b64_tr_b16 a[18:19], v24 offset:47744
    ds_read_b64_tr_b16 a[20:21], v25 offset:47232
    ds_read_b64_tr_b16 a[22:23], v25 offset:47744
    ds_read_b64_tr_b16 a[24:25], v26 offset:47232
    ds_read_b64_tr_b16 a[26:27], v26 offset:47744
    s_waitcnt lgkmcnt(12)
    v_mfma_f32_16x16x32_bf16 v[28:31], a[0:3], v[116:119], v[28:31]
    ds_read_b64_tr_b16 a[28:29], v27 offset:47232
    ds_read_b64_tr_b16 a[30:31], v27 offset:47744
    s_waitcnt lgkmcnt(12)
    v_mfma_f32_16x16x32_bf16 v[32:35], a[4:7], v[116:119], v[32:35]
    ds_read_b64_tr_b16 a[48:49], v24 offset:43136
    ds_read_b64_tr_b16 a[50:51], v24 offset:43648
    s_waitcnt lgkmcnt(12)
    v_mfma_f32_16x16x32_bf16 v[36:39], a[8:11], v[116:119], v[36:39]
    ds_read_b64_tr_b16 a[52:53], v25 offset:43136
    ds_read_b64_tr_b16 a[54:55], v25 offset:43648
    s_waitcnt lgkmcnt(12)
    v_mfma_f32_16x16x32_bf16 v[40:43], a[12:15], v[116:119], v[40:43]
    ds_read_b64_tr_b16 a[56:57], v26 offset:43136
    ds_read_b64_tr_b16 a[58:59], v26 offset:43648
    s_waitcnt lgkmcnt(12)
    v_mfma_f32_16x16x32_bf16 v[44:47], a[16:19], a[104:107], v[44:47]
    ds_read_b64_tr_b16 a[60:61], v27 offset:43136
    ds_read_b64_tr_b16 a[62:63], v27 offset:43648
    s_waitcnt lgkmcnt(12)
    v_mfma_f32_16x16x32_bf16 v[48:51], a[20:23], a[104:107], v[48:51]
    ds_read_b64_tr_b16 a[64:65], v24 offset:51328
    ds_read_b64_tr_b16 a[66:67], v24 offset:51840
    s_waitcnt lgkmcnt(12)
    v_mfma_f32_16x16x32_bf16 v[52:55], a[24:27], a[104:107], v[52:55]
    ds_read_b64_tr_b16 a[68:69], v25 offset:51328
    ds_read_b64_tr_b16 a[70:71], v25 offset:51840
    s_waitcnt lgkmcnt(12)
    v_mfma_f32_16x16x32_bf16 v[56:59], a[28:31], a[104:107], v[56:59]
    ds_read_b64_tr_b16 a[72:73], v26 offset:51328
    ds_read_b64_tr_b16 a[74:75], v26 offset:51840
    s_waitcnt lgkmcnt(12)
    v_mfma_f32_16x16x32_bf16 v[28:31], a[48:51], v[116:119], v[28:31]
    ds_read_b64_tr_b16 a[76:77], v27 offset:51328
    ds_read_b64_tr_b16 a[78:79], v27 offset:51840
    s_waitcnt lgkmcnt(12)
    v_mfma_f32_16x16x32_bf16 v[32:35], a[52:55], v[116:119], v[32:35]
    s_waitcnt lgkmcnt(10)
    v_mfma_f32_16x16x32_bf16 v[36:39], a[56:59], v[116:119], v[36:39]
    s_waitcnt lgkmcnt(8)
    v_mfma_f32_16x16x32_bf16 v[40:43], a[60:63], v[116:119], v[40:43]
    s_waitcnt lgkmcnt(6)
    v_mfma_f32_16x16x32_bf16 v[44:47], a[64:67], a[108:111], v[44:47]
    s_waitcnt lgkmcnt(4)
    v_mfma_f32_16x16x32_bf16 v[48:51], a[68:71], a[108:111], v[48:51]
    s_waitcnt lgkmcnt(2)
    v_mfma_f32_16x16x32_bf16 v[52:55], a[72:75], a[108:111], v[52:55]
    s_waitcnt lgkmcnt(0)
    v_mfma_f32_16x16x32_bf16 v[56:59], a[76:79], a[108:111], v[56:59]
    buffer_load_dwordx2 v[92:93], v96, s[28:31], s46 offen sc1
    buffer_load_dwordx2 v[94:95], v97, s[28:31], s46 offen sc1
    s_barrier
    ds_read_b128 a[112:115], v76 offset:0
    ds_read_b128 a[116:119], v77 offset:0
    ds_read_b64_tr_b16 a[0:1], v20 offset:0
    ds_read_b64_tr_b16 a[2:3], v20 offset:512
    ds_read_b64_tr_b16 a[4:5], v21 offset:0
    ds_read_b64_tr_b16 a[6:7], v21 offset:512
    ds_read_b64_tr_b16 a[8:9], v22 offset:0
    ds_read_b64_tr_b16 a[10:11], v22 offset:512
    ds_read_b64_tr_b16 a[12:13], v23 offset:0
    ds_read_b64_tr_b16 a[14:15], v23 offset:512
    ds_read_b64_tr_b16 a[16:17], v20 offset:8192
    ds_read_b64_tr_b16 a[18:19], v20 offset:8704
    ds_read_b64_tr_b16 a[20:21], v21 offset:8192
    ds_read_b64_tr_b16 a[22:23], v21 offset:8704
    ds_read_b64_tr_b16 a[24:25], v22 offset:8192
    ds_read_b64_tr_b16 a[26:27], v22 offset:8704
    s_waitcnt lgkmcnt(12)
    v_mfma_f32_16x16x32_bf16 v[28:31], a[0:3], v[116:119], v[28:31]
    ds_read_b64_tr_b16 a[28:29], v23 offset:8192
    ds_read_b64_tr_b16 a[30:31], v23 offset:8704
    s_waitcnt lgkmcnt(12)
    v_mfma_f32_16x16x32_bf16 v[32:35], a[4:7], v[116:119], v[32:35]
    ds_read_b64_tr_b16 a[48:49], v20 offset:4096
    ds_read_b64_tr_b16 a[50:51], v20 offset:4608
    s_waitcnt lgkmcnt(12)
    v_mfma_f32_16x16x32_bf16 v[36:39], a[8:11], v[116:119], v[36:39]
    ds_read_b64_tr_b16 a[52:53], v21 offset:4096
    ds_read_b64_tr_b16 a[54:55], v21 offset:4608
    s_waitcnt lgkmcnt(12)
    v_mfma_f32_16x16x32_bf16 v[40:43], a[12:15], v[116:119], v[40:43]
    ds_read_b64_tr_b16 a[56:57], v22 offset:4096
    ds_read_b64_tr_b16 a[58:59], v22 offset:4608
    s_waitcnt lgkmcnt(12)
    v_mfma_f32_16x16x32_bf16 v[44:47], a[16:19], a[112:115], v[44:47]
    ds_read_b64_tr_b16 a[60:61], v23 offset:4096
    ds_read_b64_tr_b16 a[62:63], v23 offset:4608
    s_waitcnt lgkmcnt(12)
    v_mfma_f32_16x16x32_bf16 v[48:51], a[20:23], a[112:115], v[48:51]
    ds_read_b64_tr_b16 a[64:65], v20 offset:12288
    ds_read_b64_tr_b16 a[66:67], v20 offset:12800
    s_waitcnt lgkmcnt(12)
    v_mfma_f32_16x16x32_bf16 v[52:55], a[24:27], a[112:115], v[52:55]
    ds_read_b64_tr_b16 a[68:69], v21 offset:12288
    ds_read_b64_tr_b16 a[70:71], v21 offset:12800
    s_waitcnt lgkmcnt(12)
    v_mfma_f32_16x16x32_bf16 v[56:59], a[28:31], a[112:115], v[56:59]
    ds_read_b64_tr_b16 a[72:73], v22 offset:12288
    ds_read_b64_tr_b16 a[74:75], v22 offset:12800
    s_waitcnt lgkmcnt(12)
    v_mfma_f32_16x16x32_bf16 v[28:31], a[48:51], v[116:119], v[28:31]
    ds_read_b64_tr_b16 a[76:77], v23 offset:12288
    ds_read_b64_tr_b16 a[78:79], v23 offset:12800
    s_waitcnt lgkmcnt(12)
    v_mfma_f32_16x16x32_bf16 v[32:35], a[52:55], v[116:119], v[32:35]
    s_waitcnt lgkmcnt(10)
    v_mfma_f32_16x16x32_bf16 v[36:39], a[56:59], v[116:119], v[36:39]
    s_waitcnt vmcnt(0)
Lst_chk:
    v_cmp_ne_u32 vcc, s34, v93
    v_cmp_ne_u32 s[36:37], s34, v95
    s_nop 0
    s_or_b64 s[36:37], s[36:37], vcc
    s_cbranch_scc1 Lst_re
    v_lshlrev_b32 v93, 16, v92
    s_waitcnt lgkmcnt(8)
    v_mfma_f32_16x16x32_bf16 v[40:43], a[60:63], v[116:119], v[40:43]
    v_and_b32 v92, 0xffff0000, v92
    v_rcp_f32 v93, v93
    s_waitcnt lgkmcnt(6)
    v_mfma_f32_16x16x32_bf16 v[44:47], a[64:67], a[116:119], v[44:47]
    v_lshlrev_b32 v95, 16, v94
    v_and_b32 v94, 0xffff0000, v94
    s_waitcnt lgkmcnt(4)
    v_mfma_f32_16x16x32_bf16 v[48:51], a[68:71], a[116:119], v[48:51]
    v_rcp_f32 v95, v95
    ds_write2st64_b32 v4, v92, v93 offset0:0 offset1:2
    s_waitcnt lgkmcnt(3)
    v_mfma_f32_16x16x32_bf16 v[52:55], a[72:75], a[116:119], v[52:55]
    ds_write2st64_b32 v5, v94, v95 offset0:0 offset1:2
    ds_read_b32 v120, v11
    s_waitcnt lgkmcnt(3)
    v_mfma_f32_16x16x32_bf16 v[56:59], a[76:79], a[116:119], v[56:59]
    s_waitcnt lgkmcnt(0)
    s_barrier
    ds_read_b128 a[120:123], v76 offset:39040
    ds_read_b128 a[124:127], v77 offset:39040
    ds_read_b64_tr_b16 a[0:1], v20 offset:39040
    ds_read_b64_tr_b16 a[2:3], v20 offset:39552
    ds_read_b64_tr_b16 a[4:5], v21 offset:39040
    ds_read_b64_tr_b16 a[6:7], v21 offset:39552
    ds_read_b64_tr_b16 a[8:9], v22 offset:39040
    ds_read_b64_tr_b16 a[10:11], v22 offset:39552
    ds_read_b64_tr_b16 a[12:13], v23 offset:39040
    ds_read_b64_tr_b16 a[14:15], v23 offset:39552
    ds_read_b64_tr_b16 a[16:17], v20 offset:47232
    ds_read_b64_tr_b16 a[18:19], v20 offset:47744
    ds_read_b64_tr_b16 a[20:21], v21 offset:47232
    ds_read_b64_tr_b16 a[22:23], v21 offset:47744
    ds_read_b64_tr_b16 a[24:25], v22 offset:47232
    ds_read_b64_tr_b16 a[26:27], v22 offset:47744
    s_waitcnt lgkmcnt(12)
    v_mfma_f32_16x16x32_bf16 v[28:31], a[0:3], v[116:119], v[28:31]
    ds_read_b64_tr_b16 a[28:29], v23 offset:47232
    ds_read_b64_tr_b16 a[30:31], v23 offset:47744
    s_waitcnt lgkmcnt(12)
    v_mfma_f32_16x16x32_bf16 v[32:35], a[4:7], v[116:119], v[32:35]
    ds_read_b64_tr_b16 a[48:49], v20 offset:43136
    ds_read_b64_tr_b16 a[50:51], v20 offset:43648
    s_waitcnt lgkmcnt(12)
    v_mfma_f32_16x16x32_bf16 v[36:39], a[8:11], v[116:119], v[36:39]
    ds_read_b64_tr_b16 a[52:53], v21 offset:43136
    ds_read_b64_tr_b16 a[54:55], v21 offset:43648
    s_waitcnt lgkmcnt(12)
    v_mfma_f32_16x16x32_bf16 v[40:43], a[12:15], v[116:119], v[40:43]
    ds_read_b64_tr_b16 a[56:57], v22 offset:43136
    ds_read_b64_tr_b16 a[58:59], v22 offset:43648
    s_waitcnt lgkmcnt(12)
    v_mfma_f32_16x16x32_bf16 v[44:47], a[16:19], a[120:123], v[44:47]
    ds_read_b64_tr_b16 a[60:61], v23 offset:43136
    ds_read_b64_tr_b16 a[62:63], v23 offset:43648
    s_waitcnt lgkmcnt(12)
    v_mfma_f32_16x16x32_bf16 v[48:51], a[20:23], a[120:123], v[48:51]
    ds_read_b64_tr_b16 a[64:65], v20 offset:51328
    ds_read_b64_tr_b16 a[66:67], v20 offset:51840
    s_waitcnt lgkmcnt(12)
    v_mfma_f32_16x16x32_bf16 v[52:55], a[24:27], a[120:123], v[52:55]
    ds_read_b64_tr_b16 a[68:69], v21 offset:51328
    ds_read_b64_tr_b16 a[70:71], v21 offset:51840
    s_waitcnt lgkmcnt(12)
    v_mfma_f32_16x16x32_bf16 v[56:59], a[28:31], a[120:123], v[56:59]
    ds_read_b64_tr_b16 a[72:73], v22 offset:51328
    ds_read_b64_tr_b16 a[74:75], v22 offset:51840
    s_waitcnt lgkmcnt(12)
    v_mfma_f32_16x16x32_bf16 v[28:31], a[48:51], v[116:119], v[28:31]
    ds_read_b64_tr_b16 a[76:77], v23 offset:51328
    ds_read_b64_tr_b16 a[78:79], v23 offset:51840
    s_waitcnt lgkmcnt(12)
    v_mfma_f32_16x16x32_bf16 v[32:35], a[52:55], v[116:119], v[32:35]
    s_waitcnt lgkmcnt(10)
    v_mfma_f32_16x16x32_bf16 v[36:39], a[56:59], v[116:119], v[36:39]
    s_waitcnt lgkmcnt(8)
    v_mfma_f32_16x16x32_bf16 v[40:43], a[60:63], v[116:119], v[40:43]
    s_waitcnt lgkmcnt(6)
    v_mfma_f32_16x16x32_bf16 v[44:47], a[64:67], a[124:127], v[44:47]
    s_waitcnt lgkmcnt(4)
    v_mfma_f32_16x16x32_bf16 v[48:51], a[68:71], a[124:127], v[48:51]
    s_waitcnt lgkmcnt(2)
    v_mfma_f32_16x16x32_bf16 v[52:55], a[72:75], a[124:127], v[52:55]
    s_waitcnt lgkmcnt(0)
    v_mfma_f32_16x16x32_bf16 v[56:59], a[76:79], a[124:127], v[56:59]
    s_mov_b32 exec_lo, 0x00010001
    s_mov_b32 exec_hi, 0x00010001
    ds_write_b128 v6, v[28:31] offset:0
    ds_write_b128 v6, v[32:35] offset:64
    ds_write_b128 v6, v[36:39] offset:128
    ds_write_b128 v6, v[40:43] offset:192
    ds_write_b128 v6, v[44:47] offset:256
    ds_write_b128 v6, v[48:51] offset:320
    ds_write_b128 v6, v[52:55] offset:384
    ds_write_b128 v6, v[56:59] offset:448
    ds_write_b32 v7, v7
    s_mov_b64 exec, -1
    ds_read_b128 v[76:79], v6 offset:256
    ds_read_b128 v[80:83], v6 offset:320
    ds_read_b128 v[84:87], v6 offset:384
    ds_read_b128 v[88:91], v6 offset:448
    s_waitcnt lgkmcnt(0)
    v_fmac_f32 v44, v76, v120
    v_fmac_f32 v45, v77, v120
    v_fmac_f32 v46, v78, v120
    v_fmac_f32 v47, v79, v120
    v_cvt_pk_bf16_f32 v44, v44, v45
    v_cvt_pk_bf16_f32 v45, v46, v47
    v_fmac_f32 v48, v80, v120
    v_fmac_f32 v49, v81, v120
    v_fmac_f32 v50, v82, v120
    v_fmac_f32 v51, v83, v120
    v_cvt_pk_bf16_f32 v46, v48, v49
    v_cvt_pk_bf16_f32 v47, v50, v51
    v_fmac_f32 v52, v84, v120
    v_fmac_f32 v53, v85, v120
    v_fmac_f32 v54, v86, v120
    v_fmac_f32 v55, v87, v120
    v_cvt_pk_bf16_f32 v48, v52, v53
    v_cvt_pk_bf16_f32 v49, v54, v55
    v_fmac_f32 v56, v88, v120
    v_fmac_f32 v57, v89, v120
    v_fmac_f32 v58, v90, v120
    v_fmac_f32 v59, v91, v120
    v_cvt_pk_bf16_f32 v50, v56, v57
    v_cvt_pk_bf16_f32 v51, v58, v59
    ds_write_b128 v125, v[44:47] offset:4096
    ds_write_b128 v125, v[48:51] offset:5120
    v_mov_b32 v5, 157972
    v_mov_b32 v6, 1
    s_mov_b64 exec, 1
    ds_add_u32 v5, v6
    s_mov_b64 exec, -1
    v_mov_b32 v5, 157980
Lcw_6:
    s_sub_u32 s35, s35, 1
    s_cbranch_scc1 Lend
    ds_read_b32 v6, v5
    s_waitcnt lgkmcnt(0)
    v_readfirstlane_b32 s38, v6
    s_nop 0
    s_cmp_lt_u32 s38, 1
    s_cbranch_scc1 Lcw_6
    ds_read_b64_tr_b16 a[0:1], v24 offset:16384
    ds_read_b64_tr_b16 a[2:3], v24 offset:16896
    ds_read_b64_tr_b16 a[4:5], v25 offset:16384
    ds_read_b64_tr_b16 a[6:7], v25 offset:16896
    ds_read_b64_tr_b16 a[8:9], v26 offset:16384
    ds_read_b64_tr_b16 a[10:11], v26 offset:16896
    ds_read_b64_tr_b16 a[12:13], v27 offset:16384
    ds_read_b64_tr_b16 a[14:15], v27 offset:16896
    ds_read_b64_tr_b16 a[16:17], v24 offset:20480
    ds_read_b64_tr_b16 a[18:19], v24 offset:20992
    ds_read_b64_tr_b16 a[20:21], v25 offset:20480
    ds_read_b64_tr_b16 a[22:23], v25 offset:20992
    ds_read_b64_tr_b16 a[24:25], v26 offset:20480
    ds_read_b64_tr_b16 a[26:27], v26 offset:20992
    ds_read_b64_tr_b16 a[28:29], v27 offset:20480
    ds_read_b64_tr_b16 a[30:31], v27 offset:20992
    ds_read_b64_tr_b16 a[32:33], v24 offset:55424
    ds_read_b64_tr_b16 a[34:35], v24 offset:55936
    ds_read_b64_tr_b16 a[36:37], v25 offset:55424
    ds_read_b64_tr_b16 a[38:39], v25 offset:55936
    ds_read_b64_tr_b16 a[40:41], v26 offset:55424
    ds_read_b64_tr_b16 a[42:43], v26 offset:55936
    ds_read_b64_tr_b16 a[44:45], v27 offset:55424
    ds_read_b64_tr_b16 a[46:47], v27 offset:55936
    ds_read_b64_tr_b16 a[48:49], v24 offset:59520
    ds_read_b64_tr_b16 a[50:51], v24 offset:60032
    ds_read_b64_tr_b16 a[52:53], v25 offset:59520
    ds_read_b64_tr_b16 a[54:55], v25 offset:60032
    ds_read_b64_tr_b16 a[56:57], v26 offset:59520
    ds_read_b64_tr_b16 a[58:59], v26 offset:60032
    ds_read_b64_tr_b16 a[60:61], v27 offset:59520
    ds_read_b64_tr_b16 a[62:63], v27 offset:60032
    ds_read_b64_tr_b16 a[64:65], v20 offset:16384
    ds_read_b64_tr_b16 a[66:67], v20 offset:16896
    ds_read_b64_tr_b16 a[68:69], v21 offset:16384
    ds_read_b64_tr_b16 a[70:71], v21 offset:16896
    ds_read_b64_tr_b16 a[72:73], v22 offset:16384
    ds_read_b64_tr_b16 a[74:75], v22 offset:16896
    ds_read_b64_tr_b16 a[76:77], v23 offset:16384
    ds_read_b64_tr_b16 a[78:79], v23 offset:16896
    ds_read_b64_tr_b16 a[80:81], v20 offset:20480
    ds_read_b64_tr_b16 a[82:83], v20 offset:20992
    ds_read_b64_tr_b16 a[84:85], v21 offset:20480
    ds_read_b64_tr_b16 a[86:87], v21 offset:20992
    ds_read_b64_tr_b16 a[88:89], v22 offset:20480
    ds_read_b64_tr_b16 a[90:91], v22 offset:20992
    ds_read_b64_tr_b16 a[92:93], v23 offset:20480
    ds_read_b64_tr_b16 a[94:95], v23 offset:20992
    s_waitcnt lgkmcnt(15)
    v_mfma_f32_16x16x32_bf16 v[60:63], a[96:99], a[0:3], v[60:63]
    v_mfma_f32_16x16x32_bf16 v[64:67], a[96:99], a[4:7], v[64:67]
    v_mfma_f32_16x16x32_bf16 v[68:71], a[96:99], a[8:11], v[68:71]
    v_mfma_f32_16x16x32_bf16 v[72:75], a[96:99], a[12:15], v[72:75]
    ds_read_b64_tr_b16 a[0:1], v20 offset:55424
    ds_read_b64_tr_b16 a[2:3], v20 offset:55936
    ds_read_b64_tr_b16 a[4:5], v21 offset:55424
    ds_read_b64_tr_b16 a[6:7], v21 offset:55936
    ds_read_b64_tr_b16 a[8:9], v22 offset:55424
    ds_read_b64_tr_b16 a[10:11], v22 offset:55936
    ds_read_b64_tr_b16 a[12:13], v23 offset:55424
    ds_read_b64_tr_b16 a[14:15], v23 offset:55936
    v_mfma_f32_16x16x32_bf16 v[60:63], a[100:103], a[16:19], v[60:63]
    v_mfma_f32_16x16x32_bf16 v[64:67], a[100:103], a[20:23], v[64:67]
    v_mfma_f32_16x16x32_bf16 v[68:71], a[100:103], a[24:27], v[68:71]
    v_mfma_f32_16x16x32_bf16 v[72:75], a[100:103], a[28:31], v[72:75]
    ds_read_b64_tr_b16 a[16:17], v20 offset:59520
    ds_read_b64_tr_b16 a[18:19], v20 offset:60032
    ds_read_b64_tr_b16 a[20:21], v21 offset:59520
    ds_read_b64_tr_b16 a[22:23], v21 offset:60032
    ds_read_b64_tr_b16 a[24:25], v22 offset:59520
    ds_read_b64_tr_b16 a[26:27], v22 offset:60032
    ds_read_b64_tr_b16 a[28:29], v23 offset:59520
    ds_read_b64_tr_b16 a[30:31], v23 offset:60032
    v_mfma_f32_16x16x32_bf16 v[60:63], a[104:107], a[32:35], v[60:63]
    v_mfma_f32_16x16x32_bf16 v[64:67], a[104:107], a[36:39], v[64:67]
    v_mfma_f32_16x16x32_bf16 v[68:71], a[104:107], a[40:43], v[68:71]
    v_mfma_f32_16x16x32_bf16 v[72:75], a[104:107], a[44:47], v[72:75]
    v_mfma_f32_16x16x32_bf16 v[60:63], a[108:111], a[48:51], v[60:63]
    v_mfma_f32_16x16x32_bf16 v[64:67], a[108:111], a[52:55], v[64:67]
    v_mfma_f32_16x16x32_bf16 v[68:71], a[108:111], a[56:59], v[68:71]
    v_mfma_f32_16x16x32_bf16 v[72:75], a[108:111], a[60:63], v[72:75]
    s_waitcnt lgkmcnt(15)
    v_mfma_f32_16x16x32_bf16 v[60:63], a[112:115], a[64:67], v[60:63]
    v_mfma_f32_16x16x32_bf16 v[64:67], a[112:115], a[68:71], v[64:67]
    v_mfma_f32_16x16x32_bf16 v[68:71], a[112:115], a[72:75], v[68:71]
    v_mfma_f32_16x16x32_bf16 v[72:75], a[112:115], a[76:79], v[72:75]
    v_mfma_f32_16x16x32_bf16 v[60:63], a[116:119], a[80:83], v[60:63]
    v_mfma_f32_16x16x32_bf16 v[64:67], a[116:119], a[84:87], v[64:67]
    v_mfma_f32_16x16x32_bf16 v[68:71], a[116:119], a[88:91], v[68:71]
    v_mfma_f32_16x16x32_bf16 v[72:75], a[116:119], a[92:95], v[72:75]
    s_waitcnt lgkmcnt(8)
    v_mfma_f32_16x16x32_bf16 v[60:63], a[120:123], a[0:3], v[60:63]
    v_mfma_f32_16x16x32_bf16 v[64:67], a[120:123], a[4:7], v[64:67]
    v_mfma_f32_16x16x32_bf16 v[68:71], a[120:123], a[8:11], v[68:71]
    v_mfma_f32_16x16x32_bf16 v[72:75], a[120:123], a[12:15], v[72:75]
    s_waitcnt lgkmcnt(0)
    v_mfma_f32_16x16x32_bf16 v[60:63], a[124:127], a[16:19], v[60:63]
    v_mfma_f32_16x16x32_bf16 v[64:67], a[124:127], a[20:23], v[64:67]
    v_mfma_f32_16x16x32_bf16 v[68:71], a[124:127], a[24:27], v[68:71]
    v_mfma_f32_16x16x32_bf16 v[72:75], a[124:127], a[28:31], v[72:75]
    v_lshlrev_b32 v5, 4, v3
    v_add_u32 v5, 157696, v5
    v_mov_b32 v6, 157952
    v_lshlrev_b32 v4, 4, v2
    v_add_u32 v4, 156224, v4
    v_lshl_add_u32 v125, v1, 3, s45
    s_mov_b64 exec, 0xffff
    ds_write_b32 v5, v60 offset:0
    ds_write_b32 v5, v64 offset:4
    ds_write_b32 v5, v68 offset:8
    ds_write_b32 v5, v72 offset:12
    ds_write_b32 v6, v6
    s_mov_b64 exec, -1
    ds_read_b128 v[36:39], v5
    ds_read_b128 v[28:31], v4
    ds_read_b128 v[32:35], v4 offset:512
    s_waitcnt lgkmcnt(0)
    v_fmac_f32 v60, v28, v36
    v_fmac_f32 v61, v29, v36
    v_fmac_f32 v62, v30, v36
    v_fmac_f32 v63, v31, v36
    v_mul_f32 v60, v60, v32
    v_mul_f32 v61, v61, v33
    v_mul_f32 v62, v62, v34
    v_mul_f32 v63, v63, v35
    v_cvt_pk_bf16_f32 v60, v60, v61
    v_cvt_pk_bf16_f32 v61, v62, v63
    ds_write_b64 v125, v[60:61] offset:0
    v_fmac_f32 v64, v28, v37
    v_fmac_f32 v65, v29, v37
    v_fmac_f32 v66, v30, v37
    v_fmac_f32 v67, v31, v37
    v_mul_f32 v64, v64, v32
    v_mul_f32 v65, v65, v33
    v_mul_f32 v66, v66, v34
    v_mul_f32 v67, v67, v35
    v_cvt_pk_bf16_f32 v64, v64, v65
    v_cvt_pk_bf16_f32 v65, v66, v67
    ds_write_b64 v125, v[64:65] offset:512
    v_fmac_f32 v68, v28, v38
    v_fmac_f32 v69, v29, v38
    v_fmac_f32 v70, v30, v38
    v_fmac_f32 v71, v31, v38
    v_mul_f32 v68, v68, v32
    v_mul_f32 v69, v69, v33
    v_mul_f32 v70, v70, v34
    v_mul_f32 v71, v71, v35
    v_cvt_pk_bf16_f32 v68, v68, v69
    v_cvt_pk_bf16_f32 v69, v70, v71
    ds_write_b64 v125, v[68:69] offset:1024
    v_fmac_f32 v72, v28, v39
    v_fmac_f32 v73, v29, v39
    v_fmac_f32 v74, v30, v39
    v_fmac_f32 v75, v31, v39
    v_mul_f32 v72, v72, v32
    v_mul_f32 v73, v73, v33
    v_mul_f32 v74, v74, v34
    v_mul_f32 v75, v75, v35
    v_cvt_pk_bf16_f32 v72, v72, v73
    v_cvt_pk_bf16_f32 v73, v74, v75
    ds_write_b64 v125, v[72:73] offset:1536
    v_mov_b32 v8, 157976
    v_mov_b32 v9, 1
    s_mov_b64 exec, 1
    ds_add_u32 v8, v9
    s_mov_b64 exec, -1
    s_branch Lagent
Lst_re:
    s_sub_u32 s35, s35, 1
    s_cbranch_scc1 Lend
    buffer_load_dwordx2 v[92:93], v96, s[28:31], s46 offen sc1
    buffer_load_dwordx2 v[94:95], v97, s[28:31], s46 offen sc1
    s_waitcnt vmcnt(0)
    s_branch Lst_chk
Laux:
    s_lshl_b32 s32, s37, 3
    s_lshl_b32 s39, s38, 2
    s_add_u32 s32, s32, s36
    s_cmp_lt_u32 s37, 4
    s_cselect_b32 s39, s39, 0
    s_add_u32 s32, s32, s39
    s_and_b32 s33, s2, 3
    s_lshl_b32 s33, s33, 3
    s_and_b32 s39, s2, 4
    s_add_u32 s33, s33, s39
    s_add_u32 s33, s33, s37
    s_cmp_ge_u32 s32, 32
    s_cbranch_scc1 Lmst
    v_lshrrev_b32 v5, 3, v1
    v_and_b32 v6, 7, v1
    s_lshl_b32 s40, s3, 14
    s_cmp_eq_u32 s27, 0
    s_cbranch_scc0 Laux_u
    s_lshl_b32 s36, s33, 6
    s_lshl_b32 s37, s26, 4
    s_add_u32 s36, s36, s37
    v_add_u32 v7, s36, v5
    v_mul_u32_u24 v7, 1280, v7
    v_xor_b32 v8, v6, v2
    v_lshl_add_u32 v92, v8, 4, v7
    v_add_u32 v92, 4096, v92
    v_xor_b32 v93, 64, v92
    v_add_u32 v93, 9216, v93
    v_subrev_u32 v94, 1920, v92
    v_subrev_u32 v95, 1920, v93
    s_waitcnt lgkmcnt(0)
    s_sub_u32 s52, s4, 4096
    s_subb_u32 s53, s5, 0
    s_mov_b32 s54, 2625536
    s_mov_b32 s55, 0x20000
    s_mov_b64 s[60:61], s[12:13]
    s_mov_b32 s62, 1280
    s_mov_b32 s63, 0x20000
    s_mov_b32 m0, 131072
    s_nop 0
    buffer_load_dwordx4 v13, s[60:63], 0 offen lds
    s_mov_b64 exec, 0xffff
    buffer_load_dwordx4 v13, s[60:63], 0 offen offset:1024 lds
    s_mov_b64 exec, -1
    s_add_u32 m0, s40, 0
    s_mov_b32 s41, 0
    buffer_load_dwordx4 v92, s[52:55], s41 offen lds
    buffer_load_dwordx4 v93, s[52:55], s41 offen offset:1024 lds
    buffer_load_dwordx4 v94, s[52:55], s41 offen offset:2048 lds
    buffer_load_dwordx4 v95, s[52:55], s41 offen offset:3072 lds
    s_add_u32 m0, s40, 4096
    s_mov_b32 s41, 256
    buffer_load_dwordx4 v92, s[52:55], s41 offen lds
    buffer_load_dwordx4 v93, s[52:55], s41 offen offset:1024 lds
    buffer_load_dwordx4 v94, s[52:55], s41 offen offset:2048 lds
    buffer_load_dwordx4 v95, s[52:55], s41 offen offset:3072 lds
    s_add_u32 m0, s40, 8192
    s_mov_b32 s41, 512
    buffer_load_dwordx4 v92, s[52:55], s41 offen lds
    buffer_load_dwordx4 v93, s[52:55], s41 offen offset:1024 lds
    buffer_load_dwordx4 v94, s[52:55], s41 offen offset:2048 lds
    buffer_load_dwordx4 v95, s[52:55], s41 offen offset:3072 lds
    s_add_u32 m0, s40, 12288
    s_mov_b32 s41, 768
    buffer_load_dwordx4 v92, s[52:55], s41 offen lds
    buffer_load_dwordx4 v93, s[52:55], s41 offen offset:1024 lds
    buffer_load_dwordx4 v94, s[52:55], s41 offen offset:2048 lds
    buffer_load_dwordx4 v95, s[52:55], s41 offen offset:3072 lds
    s_mov_b64 s[28:29], s[24:25]
    s_mov_b32 s30, 268435456
    s_mov_b32 s31, 0x20000
    s_load_dword s34, s[28:29], 0
    s_mov_b64 s[44:45], s[14:15]
    s_mov_b32 s46, 2211840
    s_mov_b32 s47, 0x20000
    s_mov_b64 s[48:49], s[18:19]
    s_mov_b32 s50, 2211840
    s_mov_b32 s51, 0x20000
    v_and_b32 v8, 1, v2
    v_lshlrev_b32 v8, 1, v8
    v_xor_b32 v8, v8, v6
    v_lshlrev_b32 v8, 4, v8
    v_mul_u32_u24 v9, 3456, v5
    s_lshl_b32 s38, s32, 7
    v_add3_u32 v18, v9, v8, s38
    v_xor_b32 v19, 64, v18
    v_add_u32 v19, 26624, v19
    v_add_u32 v20, 53248, v18
    v_add_u32 v21, 53248, v19
    s_mul_i32 s42, s26, 110592
    v_mul_u32_u24 v9, 1280, v5
    v_add_u32 v22, v9, v8
    v_xor_b32 v23, 64, v22
    v_add_u32 v23, 9216, v23
    v_add_u32 v24, 18432, v22
    v_add_u32 v25, 18432, v23
    s_mul_i32 s43, s32, 81920
    s_lshl_b32 s38, s3, 7
    s_add_u32 s43, s43, s38
    v_mov_b32 v96, 0x3f803f80
    v_mov_b32 v97, 0x3f803f80
    v_mov_b32 v98, 0x3f803f80
    v_mov_b32 v99, 0x3f803f80
    v_lshlrev_b32 v100, 4, v2
    v_add_u32 v100, 131072, v100
    v_lshrrev_b32 v10, 1, v3
    v_xor_b32 v10, v10, v2
    v_lshlrev_b32 v10, 4, v10
    v_lshl_add_u32 v10, v3, 7, v10
    v_add_u32 v102, s40, v10
    v_xor_b32 v103, 64, v102
    s_mov_b32 s58, 0xaaaaaaaa
    s_mov_b32 s59, 0xaaaaaaaa
    s_mov_b32 s64, 0xcccccccc
    s_mov_b32 s65, 0xcccccccc
    v_lshrrev_b32 v101, 2, v3
    v_lshl_add_u32 v101, v101, 4, v3
    v_lshlrev_b32 v101, 2, v101
    s_lshl_b32 s36, s26, 4
    v_add_u32 v10, s36, v3
    s_lshl_b32 s37, s33, 6
    s_sub_u32 s37, 2047, s37
    v_sub_u32 v106, s37, v10
    v_lshlrev_b32 v107, 2, v10
    v_add_u32 v107, 132608, v107
    s_lshl_b32 s36, s33, 9
    s_add_u32 s36, s36, 8192000
    v_lshl_add_u32 v108, v10, 3, s36
    v_bfe_u32 v10, v1, 2, 2
    v_and_b32 v8, 3, v1
    v_lshl_add_u32 v14, v2, 3, v10
    v_lshlrev_b32 v14, 7, v14
    v_lshlrev_b32 v9, 2, v1
    v_and_b32 v9, 0x60, v9
    v_add3_u32 v14, v14, v9, s40
    v_lshl_add_u32 v14, v8, 3, v14
    v_xor_b32 v15, 32, v14
    v_xor_b32 v16, 64, v14
    v_xor_b32 v17, 96, v14
    s_lshl_b32 s36, s26, 6
    s_add_u32 s36, s36, 141312
    v_lshl_add_u32 v26, v2, 4, s36
    v_min_u32 v8, 2, v3
    v_mul_u32_u24 v8, 1536, v8
    v_add_u32 v26, v26, v8
    v_add_u32 v4, 132864, v12
    v_mov_b32 v5, 0
    ds_write_b32 v4, v5
    s_waitcnt lgkmcnt(0)
    s_add_u32 s34, s34, 0x9e3779b8
    s_or_b32 s34, s34, 1
    s_waitcnt vmcnt(12)
    ds_read_b128 a[80:83], v102 offset:0
    ds_read_b128 a[84:87], v100 offset:0
    ds_read_b128 a[88:91], v103 offset:0
    ds_read_b128 a[92:95], v100 offset:64
    ds_read_b128 a[96:99], v102 offset:2048
    ds_read_b128 a[100:103], v100 offset:128
    ds_read_b128 a[104:107], v103 offset:2048
    ds_read_b128 a[108:111], v100 offset:192
    s_waitcnt lgkmcnt(0)
    s_add_u32 m0, s40, 0
    s_mov_b32 s41, 1024
    buffer_load_dwordx4 v92, s[52:55], s41 offen lds
    buffer_load_dwordx4 v93, s[52:55], s41 offen offset:1024 lds
    buffer_load_dwordx4 v94, s[52:55], s41 offen offset:2048 lds
    buffer_load_dwordx4 v95, s[52:55], s41 offen offset:3072 lds
    s_barrier
    v_mfma_f32_16x16x32_bf16 v[116:119], a[80:83], a[80:83], 0
    v_mfma_f32_16x16x32_bf16 v[112:115], v[96:99], a[80:83], 0
    v_mfma_f32_16x16x32_bf16 v[120:123], a[84:87], a[80:83], 0
    v_mfma_f32_16x16x32_bf16 v[124:127], a[84:87], v[96:99], 0
    v_mfma_f32_16x16x32_bf16 v[116:119], a[88:91], a[88:91], v[116:119]
    v_mfma_f32_16x16x32_bf16 v[112:115], v[96:99], a[88:91], v[112:115]
    v_mfma_f32_16x16x32_bf16 v[120:123], a[92:95], a[88:91], v[120:123]
    v_mfma_f32_16x16x32_bf16 v[124:127], a[92:95], v[96:99], v[124:127]
    v_mfma_f32_16x16x32_bf16 v[116:119], a[96:99], a[96:99], v[116:119]
    v_mfma_f32_16x16x32_bf16 v[112:115], v[96:99], a[96:99], v[112:115]
    v_mfma_f32_16x16x32_bf16 v[120:123], a[100:103], a[96:99], v[120:123]
    v_mfma_f32_16x16x32_bf16 v[124:127], a[100:103], v[96:99], v[124:127]
    v_mfma_f32_16x16x32_bf16 v[116:119], a[104:107], a[104:107], v[116:119]
    v_mfma_f32_16x16x32_bf16 v[112:115], v[96:99], a[104:107], v[112:115]
    v_mfma_f32_16x16x32_bf16 v[120:123], a[108:111], a[104:107], v[120:123]
    v_mfma_f32_16x16x32_bf16 v[124:127], a[108:111], v[96:99], v[124:127]
    s_waitcnt vmcnt(12)
    ds_read_b128 a[80:83], v102 offset:4096
    ds_read_b128 a[84:87], v100 offset:256
    ds_read_b128 a[88:91], v103 offset:4096
    ds_read_b128 a[92:95], v100 offset:320
    ds_read_b128 a[96:99], v102 offset:6144
    ds_read_b128 a[100:103], v100 offset:384
    ds_read_b128 a[104:107], v103 offset:6144
    ds_read_b128 a[108:111], v100 offset:448
    s_waitcnt lgkmcnt(0)
    v_mfma_f32_16x16x32_bf16 v[116:119], a[80:83], a[80:83], v[116:119]
    v_mfma_f32_16x16x32_bf16 v[112:115], v[96:99], a[80:83], v[112:115]
    v_mfma_f32_16x16x32_bf16 v[120:123], a[84:87], a[80:83], v[120:123]
    v_mfma_f32_16x16x32_bf16 v[124:127], a[84:87], v[96:99], v[124:127]
    v_mfma_f32_16x16x32_bf16 v[116:119], a[88:91], a[88:91], v[116:119]
    v_mfma_f32_16x16x32_bf16 v[112:115], v[96:99], a[88:91], v[112:115]
    v_mfma_f32_16x16x32_bf16 v[120:123], a[92:95], a[88:91], v[120:123]
    v_mfma_f32_16x16x32_bf16 v[124:127], a[92:95], v[96:99], v[124:127]
    v_mfma_f32_16x16x32_bf16 v[116:119], a[96:99], a[96:99], v[116:119]
    v_mfma_f32_16x16x32_bf16 v[112:115], v[96:99], a[96:99], v[112:115]
    v_mfma_f32_16x16x32_bf16 v[120:123], a[100:103], a[96:99], v[120:123]
    v_mfma_f32_16x16x32_bf16 v[124:127], a[100:103], v[96:99], v[124:127]
    v_mfma_f32_16x16x32_bf16 v[116:119], a[104:107], a[104:107], v[116:119]
    v_mfma_f32_16x16x32_bf16 v[112:115], v[96:99], a[104:107], v[112:115]
    v_mfma_f32_16x16x32_bf16 v[120:123], a[108:111], a[104:107], v[120:123]
    v_mfma_f32_16x16x32_bf16 v[124:127], a[108:111], v[96:99], v[124:127]
    s_waitcnt vmcnt(8)
    ds_read_b128 a[80:83], v102 offset:8192
    ds_read_b128 a[84:87], v100 offset:512
    ds_read_b128 a[88:91], v103 offset:8192
    ds_read_b128 a[92:95], v100 offset:576
    ds_read_b128 a[96:99], v102 offset:10240
    ds_read_b128 a[100:103], v100 offset:640
    ds_read_b128 a[104:107], v103 offset:10240
    ds_read_b128 a[108:111], v100 offset:704
    s_waitcnt lgkmcnt(0)
    v_mfma_f32_16x16x32_bf16 v[116:119], a[80:83], a[80:83], v[116:119]
    v_mfma_f32_16x16x32_bf16 v[112:115], v[96:99], a[80:83], v[112:115]
    v_mfma_f32_16x16x32_bf16 v[120:123], a[84:87], a[80:83], v[120:123]
    v_mfma_f32_16x16x32_bf16 v[124:127], a[84:87], v[96:99], v[124:127]
    v_mfma_f32_16x16x32_bf16 v[116:119], a[88:91], a[88:91], v[116:119]
    v_mfma_f32_16x16x32_bf16 v[112:115], v[96:99], a[88:91], v[112:115]
    v_mfma_f32_16x16x32_bf16 v[120:123], a[92:95], a[88:91], v[120:123]
    v_mfma_f32_16x16x32_bf16 v[124:127], a[92:95], v[96:99], v[124:127]
    v_mfma_f32_16x16x32_bf16 v[116:119], a[96:99], a[96:99], v[116:119]
    v_mfma_f32_16x16x32_bf16 v[112:115], v[96:99], a[96:99], v[112:115]
    v_mfma_f32_16x16x32_bf16 v[120:123], a[100:103], a[96:99], v[120:123]
    v_mfma_f32_16x16x32_bf16 v[124:127], a[100:103], v[96:99], v[124:127]
    v_mfma_f32_16x16x32_bf16 v[116:119], a[104:107], a[104:107], v[116:119]
    v_mfma_f32_16x16x32_bf16 v[112:115], v[96:99], a[104:107], v[112:115]
    v_mfma_f32_16x16x32_bf16 v[120:123], a[108:111], a[104:107], v[120:123]
    v_mfma_f32_16x16x32_bf16 v[124:127], a[108:111], v[96:99], v[124:127]
    s_waitcnt vmcnt(4)
    ds_read_b128 a[80:83], v102 offset:12288
    ds_read_b128 a[84:87], v100 offset:768
    ds_read_b128 a[88:91], v103 offset:12288
    ds_read_b128 a[92:95], v100 offset:832
    ds_read_b128 a[96:99], v102 offset:14336
    ds_read_b128 a[100:103], v100 offset:896
    ds_read_b128 a[104:107], v103 offset:14336
    ds_read_b128 a[108:111], v100 offset:960
    s_waitcnt lgkmcnt(0)
    v_mfma_f32_16x16x32_bf16 v[116:119], a[80:83], a[80:83], v[116:119]
    v_mfma_f32_16x16x32_bf16 v[112:115], v[96:99], a[80:83], v[112:115]
    v_mfma_f32_16x16x32_bf16 v[120:123], a[84:87], a[80:83], v[120:123]
    v_mfma_f32_16x16x32_bf16 v[124:127], a[84:87], v[96:99], v[124:127]
    v_mfma_f32_16x16x32_bf16 v[116:119], a[88:91], a[88:91], v[116:119]
    v_mfma_f32_16x16x32_bf16 v[112:115], v[96:99], a[88:91], v[112:115]
    v_mfma_f32_16x16x32_bf16 v[120:123], a[92:95], a[88:91], v[120:123]
    v_mfma_f32_16x16x32_bf16 v[124:127], a[92:95], v[96:99], v[124:127]
    v_mfma_f32_16x16x32_bf16 v[116:119], a[96:99], a[96:99], v[116:119]
    v_mfma_f32_16x16x32_bf16 v[112:115], v[96:99], a[96:99], v[112:115]
    v_mfma_f32_16x16x32_bf16 v[120:123], a[100:103], a[96:99], v[120:123]
    v_mfma_f32_16x16x32_bf16 v[124:127], a[100:103], v[96:99], v[124:127]
    v_mfma_f32_16x16x32_bf16 v[116:119], a[104:107], a[104:107], v[116:119]
    v_mfma_f32_16x16x32_bf16 v[112:115], v[96:99], a[104:107], v[112:115]
    v_mfma_f32_16x16x32_bf16 v[120:123], a[108:111], a[104:107], v[120:123]
    v_mfma_f32_16x16x32_bf16 v[124:127], a[108:111], v[96:99], v[124:127]
    s_waitcnt vmcnt(0)
    ds_read_b128 a[80:83], v102 offset:0
    ds_read_b128 a[84:87], v100 offset:1024
    ds_read_b128 a[88:91], v103 offset:0
    ds_read_b128 a[92:95], v100 offset:1088
    ds_read_b128 a[96:99], v102 offset:2048
    ds_read_b128 a[100:103], v100 offset:1152
    ds_read_b128 a[104:107], v103 offset:2048
    ds_read_b128 a[108:111], v100 offset:1216
    s_waitcnt lgkmcnt(0)
    v_mfma_f32_16x16x32_bf16 v[116:119], a[80:83], a[80:83], v[116:119]
    v_mfma_f32_16x16x32_bf16 v[112:115], v[96:99], a[80:83], v[112:115]
    v_mfma_f32_16x16x32_bf16 v[120:123], a[84:87], a[80:83], v[120:123]
    v_mfma_f32_16x16x32_bf16 v[124:127], a[84:87], v[96:99], v[124:127]
    v_mfma_f32_16x16x32_bf16 v[116:119], a[88:91], a[88:91], v[116:119]
    v_mfma_f32_16x16x32_bf16 v[112:115], v[96:99], a[88:91], v[112:115]
    v_mfma_f32_16x16x32_bf16 v[120:123], a[92:95], a[88:91], v[120:123]
    v_mfma_f32_16x16x32_bf16 v[124:127], a[92:95], v[96:99], v[124:127]
    v_mfma_f32_16x16x32_bf16 v[116:119], a[96:99], a[96:99], v[116:119]
    v_mfma_f32_16x16x32_bf16 v[112:115], v[96:99], a[96:99], v[112:115]
    v_mfma_f32_16x16x32_bf16 v[120:123], a[100:103], a[96:99], v[120:123]
    v_mfma_f32_16x16x32_bf16 v[124:127], a[100:103], v[96:99], v[124:127]
    v_mfma_f32_16x16x32_bf16 v[116:119], a[104:107], a[104:107], v[116:119]
    v_mfma_f32_16x16x32_bf16 v[112:115], v[96:99], a[104:107], v[112:115]
    v_mfma_f32_16x16x32_bf16 v[120:123], a[108:111], a[104:107], v[120:123]
    v_mfma_f32_16x16x32_bf16 v[124:127], a[108:111], v[96:99], v[124:127]
    s_nop 4
    v_cndmask_b32 v4, v116, v117, s[58:59]
    v_cndmask_b32 v5, v118, v119, s[58:59]
    v_cndmask_b32 v4, v4, v5, s[64:65]
    ds_bpermute_b32 v4, v101, v4
    v_mul_f32 v5, 0xbacccccd, v112
    v_cvt_pk_bf16_f32 v104, v5, v5
    v_lshlrev_b32 v104, 16, v104
    v_mul_f32 v5, v5, v5
    v_mov_b32 v6, 0x3acccccd
    s_waitcnt lgkmcnt(0)
    v_fma_f32 v4, v4, v6, -v5
    v_max_f32 v4, 0, v4
    v_cvt_pk_bf16_f32 v4, v4, v4
    v_lshlrev_b32 v4, 16, v4
    v_add_f32 v4, 0x3727c5ac, v4
    v_cvt_pk_bf16_f32 v4, v4, v4
    v_lshlrev_b32 v4, 16, v4
    v_sqrt_f32 v4, v4
    s_nop 0
    v_cvt_pk_bf16_f32 v4, v4, v4
    v_lshlrev_b32 v4, 16, v4
    v_rcp_f32 v105, v4
    v_lshrrev_b32 v8, 16, v4
    v_fma_f32 v4, v104, v124, v120
    v_mul_f32 v4, v4, v105
    v_cvt_pk_bf16_f32 v4, v4, v4
    v_ashrrev_i32 v5, 31, v4
    v_or_b32 v5, 0x80000000, v5
    v_xor_b32 v4, v4, v5
    v_and_b32 v4, 0xffff0000, v4
    v_or_b32 v4, v4, v106
    ds_write_b32 v107, v4
    v_mov_b32 v11, 132864
    v_mov_b32 v7, 1
    s_mov_b64 exec, 1
    ds_add_u32 v11, v7
    s_mov_b64 exec, -1
    v_or_b32 v8, v8, v104
    v_mov_b32 v9, s34
    s_mov_b64 exec, 0xffff
    buffer_store_dwordx2 v[8:9], v108, s[28:31], 0 offen sc1
    s_mov_b64 exec, -1
    s_cmp_lg_u32 s26, 0
    s_cbranch_scc1 Lpub_done
    s_setprio 3
Lcw_8:
    s_sub_u32 s35, s35, 1
    s_cbranch_scc1 Lend
    ds_read_b32 v7, v11
    s_waitcnt lgkmcnt(0)
    v_readfirstlane_b32 s38, v7
    s_nop 0
    s_cmp_lt_u32 s38, 4
    s_cbranch_scc1 Lcw_8
    v_add_u32 v5, 132608, v12
    ds_read_b32 v6, v5
    s_waitcnt lgkmcnt(0)
    v_mov_b32 v4, v6
    s_nop 1
    v_max_u32_dpp v4, v4, v4 row_ror:8 row_mask:0xf bank_mask:0xf
    s_nop 1
    v_max_u32_dpp v4, v4, v4 row_ror:4 row_mask:0xf bank_mask:0xf
    s_nop 1
    v_max_u32_dpp v4, v4, v4 row_ror:2 row_mask:0xf bank_mask:0xf
    s_nop 1
    v_max_u32_dpp v4, v4, v4 row_ror:1 row_mask:0xf bank_mask:0xf
    s_nop 0
    v_readlane_b32 s66, v4, 0
    v_readlane_b32 s36, v4, 16
    v_readlane_b32 s37, v4, 32
    v_readlane_b32 s38, v4, 48
    s_max_u32 s66, s66, s36
    s_max_u32 s37, s37, s38
    s_max_u32 s66, s66, s37
    v_cmp_eq_u32 vcc, s66, v6
    s_nop 1
    v_cndmask_b32 v4, v6, 0, vcc
    s_nop 1
    v_max_u32_dpp v4, v4, v4 row_ror:8 row_mask:0xf bank_mask:0xf
    s_nop 1
    v_max_u32_dpp v4, v4, v4 row_ror:4 row_mask:0xf bank_mask:0xf
    s_nop 1
    v_max_u32_dpp v4, v4, v4 row_ror:2 row_mask:0xf bank_mask:0xf
    s_nop 1
    v_max_u32_dpp v4, v4, v4 row_ror:1 row_mask:0xf bank_mask:0xf
    s_nop 0
    v_readlane_b32 s67, v4, 0
    v_readlane_b32 s36, v4, 16
    v_readlane_b32 s37, v4, 32
    v_readlane_b32 s38, v4, 48
    s_max_u32 s67, s67, s36
    s_max_u32 s37, s37, s38
    s_max_u32 s67, s67, s37
    v_mov_b32 v112, s66
    v_mov_b32 v113, s34
    v_mov_b32 v114, s67
    v_mov_b32 v115, s34
    s_lshl_b32 s36, s32, 7
    s_add_u32 s36, s36, 8126464
    s_mov_b64 exec, 0xff
    buffer_store_dwordx4 v[112:115], v13, s[28:31], s36 offen sc1
    s_mov_b64 exec, -1
    v_mov_b32 v11, 132864
    v_mov_b32 v7, 1
    s_mov_b64 exec, 1
    ds_add_u32 v11, v7
    s_mov_b64 exec, -1
    s_mov_b64 exec, 1
    s_lshl_b32 s36, s2, 2
    s_add_u32 s36, s36, 8323072
    v_mov_b32 v4, s34
    v_mov_b32 v5, s36
    buffer_store_dword v4, v5, s[28:31], 0 offen sc1
    s_mov_b64 exec, -1
    s_setprio 0
Lpub_done:
Lcw_9:
    s_sub_u32 s35, s35, 1
    s_cbranch_scc1 Lend
    ds_read_b32 v7, v11
    s_waitcnt lgkmcnt(0)
    v_readfirstlane_b32 s38, v7
    s_nop 0
    s_cmp_lt_u32 s38, 5
    s_cbranch_scc1 Lcw_9
    s_cmp_ge_u32 s32, 27
    s_cbranch_scc1 Lhelp_r
    s_add_u32 m0, s40, 0
    s_add_u32 s41, s42, 0
    buffer_load_dwordx4 v18, s[44:47], s41 offen nt lds
    buffer_load_dwordx4 v19, s[44:47], s41 offen offset:1024 nt lds
    buffer_load_dwordx4 v20, s[44:47], s41 offen offset:2048 nt lds
    buffer_load_dwordx4 v21, s[44:47], s41 offen offset:3072 nt lds
    s_add_u32 m0, s40, 4096
    s_add_u32 s41, s42, 442368
    buffer_load_dwordx4 v18, s[44:47], s41 offen nt lds
    buffer_load_dwordx4 v19, s[44:47], s41 offen offset:1024 nt lds
    buffer_load_dwordx4 v20, s[44:47], s41 offen offset:2048 nt lds
    buffer_load_dwordx4 v21, s[44:47], s41 offen offset:3072 nt lds
    s_add_u32 m0, s40, 8192
    s_add_u32 s41, s42, 884736
    buffer_load_dwordx4 v18, s[44:47], s41 offen nt lds
    buffer_load_dwordx4 v19, s[44:47], s41 offen offset:1024 nt lds
    buffer_load_dwordx4 v20, s[44:47], s41 offen offset:2048 nt lds
    buffer_load_dwordx4 v21, s[44:47], s41 offen offset:3072 nt lds
    s_add_u32 m0, s40, 12288
    s_add_u32 s41, s42, 1327104
    buffer_load_dwordx4 v18, s[44:47], s41 offen nt lds
    buffer_load_dwordx4 v19, s[44:47], s41 offen offset:1024 nt lds
    buffer_load_dwordx4 v20, s[44:47], s41 offen offset:2048 nt lds
    buffer_load_dwordx4 v21, s[44:47], s41 offen offset:3072 nt lds
    s_waitcnt vmcnt(12)
    ds_read_b64_tr_b16 a[0:1], v14 offset:0
    ds_read_b64_tr_b16 a[2:3], v14 offset:512
    ds_read_b64_tr_b16 a[4:5], v15 offset:0
    ds_read_b64_tr_b16 a[6:7], v15 offset:512
    ds_read_b64_tr_b16 a[8:9], v16 offset:0
    ds_read_b64_tr_b16 a[10:11], v16 offset:512
    ds_read_b64_tr_b16 a[12:13], v17 offset:0
    ds_read_b64_tr_b16 a[14:15], v17 offset:512
    s_waitcnt lgkmcnt(0)
    s_add_u32 m0, s40, 0
    s_add_u32 s41, s42, 1769472
    buffer_load_dwordx4 v18, s[44:47], s41 offen nt lds
    buffer_load_dwordx4 v19, s[44:47], s41 offen offset:1024 nt lds
    buffer_load_dwordx4 v20, s[44:47], s41 offen offset:2048 nt lds
    buffer_load_dwordx4 v21, s[44:47], s41 offen offset:3072 nt lds
    v_mov_b32 v11, 132864
    v_mov_b32 v7, 1
    s_mov_b64 exec, 1
    ds_add_u32 v11, v7
    s_mov_b64 exec, -1
    s_waitcnt vmcnt(12)
    ds_read_b64_tr_b16 a[16:17], v14 offset:4096
    ds_read_b64_tr_b16 a[18:19], v14 offset:4608
    ds_read_b64_tr_b16 a[20:21], v15 offset:4096
    ds_read_b64_tr_b16 a[22:23], v15 offset:4608
    ds_read_b64_tr_b16 a[24:25], v16 offset:4096
    ds_read_b64_tr_b16 a[26:27], v16 offset:4608
    ds_read_b64_tr_b16 a[28:29], v17 offset:4096
    ds_read_b64_tr_b16 a[30:31], v17 offset:4608
    s_waitcnt lgkmcnt(0)
    s_add_u32 m0, s40, 4096
    s_add_u32 s41, s43, 0
    buffer_load_dwordx4 v22, s[48:51], s41 offen nt lds
    buffer_load_dwordx4 v23, s[48:51], s41 offen offset:1024 nt lds
    buffer_load_dwordx4 v24, s[48:51], s41 offen offset:2048 nt lds
    buffer_load_dwordx4 v25, s[48:51], s41 offen offset:3072 nt lds
    s_waitcnt vmcnt(12)
    ds_read_b64_tr_b16 a[32:33], v14 offset:8192
    ds_read_b64_tr_b16 a[34:35], v14 offset:8704
    ds_read_b64_tr_b16 a[36:37], v15 offset:8192
    ds_read_b64_tr_b16 a[38:39], v15 offset:8704
    ds_read_b64_tr_b16 a[40:41], v16 offset:8192
    ds_read_b64_tr_b16 a[42:43], v16 offset:8704
    ds_read_b64_tr_b16 a[44:45], v17 offset:8192
    ds_read_b64_tr_b16 a[46:47], v17 offset:8704
    s_waitcnt lgkmcnt(0)
    s_add_u32 m0, s40, 8192
    s_add_u32 s41, s43, 40960
    buffer_load_dwordx4 v22, s[48:51], s41 offen nt lds
    buffer_load_dwordx4 v23, s[48:51], s41 offen offset:1024 nt lds
    buffer_load_dwordx4 v24, s[48:51], s41 offen offset:2048 nt lds
    buffer_load_dwordx4 v25, s[48:51], s41 offen offset:3072 nt lds
    s_waitcnt vmcnt(12)
    ds_read_b64_tr_b16 a[48:49], v14 offset:12288
    ds_read_b64_tr_b16 a[50:51], v14 offset:12800
    ds_read_b64_tr_b16 a[52:53], v15 offset:12288
    ds_read_b64_tr_b16 a[54:55], v15 offset:12800
    ds_read_b64_tr_b16 a[56:57], v16 offset:12288
    ds_read_b64_tr_b16 a[58:59], v16 offset:12800
    ds_read_b64_tr_b16 a[60:61], v17 offset:12288
    ds_read_b64_tr_b16 a[62:63], v17 offset:12800
    s_waitcnt vmcnt(8)
    ds_read_b64_tr_b16 a[64:65], v14 offset:0
    ds_read_b64_tr_b16 a[66:67], v14 offset:512
    ds_read_b64_tr_b16 a[68:69], v15 offset:0
    ds_read_b64_tr_b16 a[70:71], v15 offset:512
    ds_read_b64_tr_b16 a[72:73], v16 offset:0
    ds_read_b64_tr_b16 a[74:75], v16 offset:512
    ds_read_b64_tr_b16 a[76:77], v17 offset:0
    ds_read_b64_tr_b16 a[78:79], v17 offset:512
    s_branch Laux_mm
Laux_u:
    s_cmp_ge_u32 s32, 27
    s_cbranch_scc1 Lend
    v_and_b32 v8, 1, v2
    v_lshlrev_b32 v8, 1, v8
    v_xor_b32 v8, v8, v6
    v_lshlrev_b32 v8, 4, v8
    v_mul_u32_u24 v9, 3456, v5
    s_lshl_b32 s38, s32, 7
    v_add3_u32 v18, v9, v8, s38
    v_xor_b32 v19, 64, v18
    v_add_u32 v19, 26624, v19
    v_add_u32 v20, 53248, v18
    v_add_u32 v21, 53248, v19
    s_mul_i32 s42, s26, 110592
    v_mul_u32_u24 v9, 1280, v5
    v_add_u32 v22, v9, v8
    v_xor_b32 v23, 64, v22
    v_add_u32 v23, 9216, v23
    v_add_u32 v24, 18432, v22
    v_add_u32 v25, 18432, v23
    s_mul_i32 s43, s32, 81920
    s_lshl_b32 s38, s3, 7
    s_add_u32 s43, s43, s38
    s_waitcnt lgkmcnt(0)
    s_mov_b64 s[44:45], s[16:17]
    s_mov_b32 s46, 2211840
    s_mov_b32 s47, 0x20000
    s_mov_b64 s[28:29], s[24:25]
    s_mov_b32 s30, 268435456
    s_mov_b32 s31, 0x20000
    s_load_dword s34, s[28:29], 0
    s_mov_b64 s[52:53], s[4:5]
    s_mov_b32 s54, 2621440
    s_mov_b32 s55, 0x20000
    s_mov_b64 s[48:49], s[18:19]
    s_mov_b32 s50, 2211840
    s_mov_b32 s51, 0x20000
    s_mov_b64 s[68:69], s[18:19]
    s_mov_b32 s70, 2211840
    s_mov_b32 s71, 0x20000
    s_cmp_ge_u32 s26, 2
    s_cselect_b32 s70, 0, s70
    v_bfe_u32 v10, v1, 2, 2
    v_and_b32 v8, 3, v1
    v_lshl_add_u32 v14, v2, 3, v10
    v_lshlrev_b32 v14, 7, v14
    v_lshlrev_b32 v9, 2, v1
    v_and_b32 v9, 0x60, v9
    v_add3_u32 v14, v14, v9, s40
    v_lshl_add_u32 v14, v8, 3, v14
    v_xor_b32 v15, 32, v14
    v_xor_b32 v16, 64, v14
    v_xor_b32 v17, 96, v14
    s_lshl_b32 s36, s26, 6
    s_add_u32 s36, s36, 141312
    v_lshl_add_u32 v26, v2, 4, s36
    v_min_u32 v8, 2, v3
    v_mul_u32_u24 v8, 1536, v8
    v_add_u32 v26, v26, v8
    s_waitcnt lgkmcnt(0)
    s_add_u32 s34, s34, 0x9e3779b8
    s_or_b32 s34, s34, 1
    s_cmp_lg_u32 s3, 7
    s_cbranch_scc1 Lnop7
    s_setprio 3
Lnop7:
    s_barrier
    s_add_u32 m0, s40, 0
    s_add_u32 s41, s42, 0
    buffer_load_dwordx4 v18, s[44:47], s41 offen nt lds
    buffer_load_dwordx4 v19, s[44:47], s41 offen offset:1024 nt lds
    buffer_load_dwordx4 v20, s[44:47], s41 offen offset:2048 nt lds
    buffer_load_dwordx4 v21, s[44:47], s41 offen offset:3072 nt lds
    s_add_u32 m0, s40, 4096
    s_add_u32 s41, s42, 442368
    buffer_load_dwordx4 v18, s[44:47], s41 offen nt lds
    buffer_load_dwordx4 v19, s[44:47], s41 offen offset:1024 nt lds
    buffer_load_dwordx4 v20, s[44:47], s41 offen offset:2048 nt lds
    buffer_load_dwordx4 v21, s[44:47], s41 offen offset:3072 nt lds
    s_add_u32 m0, s40, 8192
    s_add_u32 s41, s42, 884736
    buffer_load_dwordx4 v18, s[44:47], s41 offen nt lds
    buffer_load_dwordx4 v19, s[44:47], s41 offen offset:1024 nt lds
    buffer_load_dwordx4 v20, s[44:47], s41 offen offset:2048 nt lds
    buffer_load_dwordx4 v21, s[44:47], s41 offen offset:3072 nt lds
    s_add_u32 m0, s40, 12288
    s_add_u32 s41, s42, 1327104
    buffer_load_dwordx4 v18, s[44:47], s41 offen nt lds
    buffer_load_dwordx4 v19, s[44:47], s41 offen offset:1024 nt lds
    buffer_load_dwordx4 v20, s[44:47], s41 offen offset:2048 nt lds
    buffer_load_dwordx4 v21, s[44:47], s41 offen offset:3072 nt lds
    v_mov_b32 v11, 132864
Lcw_10:
    s_sub_u32 s35, s35, 1
    s_cbranch_scc1 Lend
    s_sleep 4
    ds_read_b32 v7, v11
    s_waitcnt lgkmcnt(0)
    v_readfirstlane_b32 s38, v7
    s_nop 0
    s_cmp_lt_u32 s38, 5
    s_cbranch_scc1 Lcw_10
    s_waitcnt vmcnt(12)
    ds_read_b64_tr_b16 a[0:1], v14 offset:0
    ds_read_b64_tr_b16 a[2:3], v14 offset:512
    ds_read_b64_tr_b16 a[4:5], v15 offset:0
    ds_read_b64_tr_b16 a[6:7], v15 offset:512
    ds_read_b64_tr_b16 a[8:9], v16 offset:0
    ds_read_b64_tr_b16 a[10:11], v16 offset:512
    ds_read_b64_tr_b16 a[12:13], v17 offset:0
    ds_read_b64_tr_b16 a[14:15], v17 offset:512
    s_waitcnt lgkmcnt(0)
    s_add_u32 m0, s40, 0
    s_add_u32 s41, s42, 1769472
    buffer_load_dwordx4 v18, s[44:47], s41 offen nt lds
    buffer_load_dwordx4 v19, s[44:47], s41 offen offset:1024 nt lds
    buffer_load_dwordx4 v20, s[44:47], s41 offen offset:2048 nt lds
    buffer_load_dwordx4 v21, s[44:47], s41 offen offset:3072 nt lds
    s_waitcnt vmcnt(12)
    ds_read_b64_tr_b16 a[16:17], v14 offset:4096
    ds_read_b64_tr_b16 a[18:19], v14 offset:4608
    ds_read_b64_tr_b16 a[20:21], v15 offset:4096
    ds_read_b64_tr_b16 a[22:23], v15 offset:4608
    ds_read_b64_tr_b16 a[24:25], v16 offset:4096
    ds_read_b64_tr_b16 a[26:27], v16 offset:4608
    ds_read_b64_tr_b16 a[28:29], v17 offset:4096
    ds_read_b64_tr_b16 a[30:31], v17 offset:4608
    s_waitcnt vmcnt(8)
    ds_read_b64_tr_b16 a[32:33], v14 offset:8192
    ds_read_b64_tr_b16 a[34:35], v14 offset:8704
    ds_read_b64_tr_b16 a[36:37], v15 offset:8192
    ds_read_b64_tr_b16 a[38:39], v15 offset:8704
    ds_read_b64_tr_b16 a[40:41], v16 offset:8192
    ds_read_b64_tr_b16 a[42:43], v16 offset:8704
    ds_read_b64_tr_b16 a[44:45], v17 offset:8192
    ds_read_b64_tr_b16 a[46:47], v17 offset:8704
    s_waitcnt vmcnt(4)
    ds_read_b64_tr_b16 a[48:49], v14 offset:12288
    ds_read_b64_tr_b16 a[50:51], v14 offset:12800
    ds_read_b64_tr_b16 a[52:53], v15 offset:12288
    ds_read_b64_tr_b16 a[54:55], v15 offset:12800
    ds_read_b64_tr_b16 a[56:57], v16 offset:12288
    ds_read_b64_tr_b16 a[58:59], v16 offset:12800
    ds_read_b64_tr_b16 a[60:61], v17 offset:12288
    ds_read_b64_tr_b16 a[62:63], v17 offset:12800
    s_waitcnt vmcnt(0)
    ds_read_b64_tr_b16 a[64:65], v14 offset:0
    ds_read_b64_tr_b16 a[66:67], v14 offset:512
    ds_read_b64_tr_b16 a[68:69], v15 offset:0
    ds_read_b64_tr_b16 a[70:71], v15 offset:512
    ds_read_b64_tr_b16 a[72:73], v16 offset:0
    ds_read_b64_tr_b16 a[74:75], v16 offset:512
    ds_read_b64_tr_b16 a[76:77], v17 offset:0
    ds_read_b64_tr_b16 a[78:79], v17 offset:512
    s_cmp_lg_u32 s3, 7
    s_cbranch_scc1 Lnofx
    v_mov_b32 v92, 0x3f803f80
    v_mov_b32 v93, 0x3f803f80
    v_mov_b32 v94, 0x3f803f80
    v_mov_b32 v95, 0x3f803f80
    v_add_u32 v4, 144384, v13
    ds_write_b128 v4, v[92:95]
    ds_write_b128 v4, v[92:95] offset:1024
    v_and_b32 v120, 31, v1
    v_lshlrev_b32 v120, 7, v120
    v_add_u32 v120, 8126464, v120
Lpt_11:
    s_sub_u32 s35, s35, 1
    s_cbranch_scc1 Lend
    s_sleep 2
    buffer_load_dwordx4 v[124:127], v120, s[28:31], 0 offen sc1
    s_waitcnt vmcnt(0)
    v_cmp_ne_u32 vcc, s34, v125
    v_cmp_ne_u32 s[36:37], s34, v127
    s_nop 0
    s_or_b64 s[36:37], s[36:37], vcc
    s_cbranch_scc1 Lpt_11
    v_mov_b32 v120, v124
    s_nop 1
    v_max_u32_dpp v120, v120, v120 row_ror:8 row_mask:0xf bank_mask:0xf
    s_nop 1
    v_max_u32_dpp v120, v120, v120 row_ror:4 row_mask:0xf bank_mask:0xf
    s_nop 1
    v_max_u32_dpp v120, v120, v120 row_ror:2 row_mask:0xf bank_mask:0xf
    s_nop 1
    v_max_u32_dpp v120, v120, v120 row_ror:1 row_mask:0xf bank_mask:0xf
    s_nop 0
    v_readlane_b32 s56, v120, 0
    v_readlane_b32 s36, v120, 16
    v_readlane_b32 s37, v120, 32
    v_readlane_b32 s38, v120, 48
    s_max_u32 s56, s56, s36
    s_max_u32 s37, s37, s38
    s_max_u32 s56, s56, s37
    v_cmp_eq_u32 vcc, s56, v124
    s_nop 1
    v_cndmask_b32 v120, v124, v126, vcc
    s_nop 1
    v_max_u32_dpp v120, v120, v120 row_ror:8 row_mask:0xf bank_mask:0xf
    s_nop 1
    v_max_u32_dpp v120, v120, v120 row_ror:4 row_mask:0xf bank_mask:0xf
    s_nop 1
    v_max_u32_dpp v120, v120, v120 row_ror:2 row_mask:0xf bank_mask:0xf
    s_nop 1
    v_max_u32_dpp v120, v120, v120 row_ror:1 row_mask:0xf bank_mask:0xf
    s_nop 0
    v_readlane_b32 s57, v120, 0
    v_readlane_b32 s36, v120, 16
    v_readlane_b32 s37, v120, 32
    v_readlane_b32 s38, v120, 48
    s_max_u32 s57, s57, s36
    s_max_u32 s37, s37, s38
    s_max_u32 s57, s57, s37
    s_and_b32 s36, s56, 0x7ff
    s_sub_u32 s36, 2047, s36
    s_and_b32 s37, s57, 0x7ff
    s_sub_u32 s37, 2047, s37
    s_mul_i32 s38, s36, 1280
    s_mul_i32 s39, s37, 1280
    s_mov_b32 m0, 141312
    v_mov_b32 v4, s36
    buffer_load_dwordx4 v13, s[52:55], s38 offen lds
    s_mov_b32 m0, 142848
    v_mov_b32 v5, s37
    buffer_load_dwordx4 v13, s[52:55], s39 offen lds
    s_mov_b64 exec, 0xffff
    buffer_load_dwordx4 v13, s[52:55], s39 offen offset:1024 lds
    s_mov_b32 m0, 141312
    s_mov_b32 vcc_lo, 0xaaaaaaaa
    buffer_load_dwordx4 v13, s[52:55], s38 offen offset:1024 lds
    s_mov_b64 exec, 3
    v_cndmask_b32 v4, v4, v5, vcc
    v_lshlrev_b32 v118, 3, v4
    v_add_u32 v118, 8192000, v118
    v_add_u32 v9, 132872, v12
Lxs_chk:
    s_sub_u32 s35, s35, 1
    s_cbranch_scc1 Lend
    buffer_load_dwordx2 v[116:117], v118, s[28:31], 0 offen sc1
    s_waitcnt vmcnt(0)
    v_cmp_ne_u32 vcc, s34, v117
    s_nop 0
    s_cbranch_vccnz Lxs_chk
    ds_write_b32 v9, v116
    s_mov_b64 exec, -1
    v_mov_b32 v10, 132868
    v_mov_b32 v7, 1
    s_mov_b64 exec, 1
    ds_add_u32 v10, v7
    s_mov_b64 exec, -1
Lnofx:
Lcw_12:
    s_sub_u32 s35, s35, 1
    s_cbranch_scc1 Lend
    s_sleep 2
    ds_read_b32 v7, v11
    s_waitcnt lgkmcnt(0)
    v_readfirstlane_b32 s38, v7
    s_nop 0
    s_cmp_lt_u32 s38, 9
    s_cbranch_scc1 Lcw_12
    s_add_u32 m0, s40, 4096
    s_add_u32 s41, s43, 0
    buffer_load_dwordx4 v22, s[48:51], s41 offen nt lds
    buffer_load_dwordx4 v23, s[48:51], s41 offen offset:1024 nt lds
    buffer_load_dwordx4 v24, s[48:51], s41 offen offset:2048 nt lds
    buffer_load_dwordx4 v25, s[48:51], s41 offen offset:3072 nt lds
    s_add_u32 m0, s40, 8192
    s_add_u32 s41, s43, 40960
    buffer_load_dwordx4 v22, s[48:51], s41 offen nt lds
    buffer_load_dwordx4 v23, s[48:51], s41 offen offset:1024 nt lds
    buffer_load_dwordx4 v24, s[48:51], s41 offen offset:2048 nt lds
    buffer_load_dwordx4 v25, s[48:51], s41 offen offset:3072 nt lds
    s_add_u32 m0, s40, 12288
    s_add_u32 s41, s43, 512
    buffer_load_dwordx4 v22, s[68:71], s41 offen nt lds
    buffer_load_dwordx4 v23, s[68:71], s41 offen offset:1024 nt lds
    buffer_load_dwordx4 v24, s[68:71], s41 offen offset:2048 nt lds
    buffer_load_dwordx4 v25, s[68:71], s41 offen offset:3072 nt lds
    s_add_u32 m0, s40, 0
    s_add_u32 s41, s43, 41472
    buffer_load_dwordx4 v22, s[68:71], s41 offen nt lds
    buffer_load_dwordx4 v23, s[68:71], s41 offen offset:1024 nt lds
    buffer_load_dwordx4 v24, s[68:71], s41 offen offset:2048 nt lds
    buffer_load_dwordx4 v25, s[68:71], s41 offen offset:3072 nt lds
Laux_mm:
    v_mov_b32 v10, 132868
Lcw_13:
    s_sub_u32 s35, s35, 1
    s_cbranch_scc1 Lend
    s_sleep 1
    ds_read_b32 v7, v10
    s_waitcnt lgkmcnt(0)
    v_readfirstlane_b32 s38, v7
    s_nop 0
    s_cmp_lt_u32 s38, 1
    s_cbranch_scc1 Lcw_13
    ds_read_b128 v[92:95], v26 offset:0
    ds_read_b128 v[96:99], v26 offset:256
    ds_read_b128 v[100:103], v26 offset:512
    ds_read_b128 v[104:107], v26 offset:768
    ds_read_b128 v[108:111], v26 offset:1024
    ds_read_b64 v[116:117], v10 offset:4
    s_waitcnt lgkmcnt(0)
    v_readfirstlane_b32 s56, v116
    v_readfirstlane_b32 s57, v117
    v_mfma_f32_16x16x32_bf16 v[112:115], a[0:3], v[92:95], 0
    v_mfma_f32_16x16x32_bf16 v[116:119], a[4:7], v[92:95], 0
    v_mfma_f32_16x16x32_bf16 v[120:123], a[8:11], v[92:95], 0
    v_mfma_f32_16x16x32_bf16 v[124:127], a[12:15], v[92:95], 0
    v_mfma_f32_16x16x32_bf16 v[112:115], a[16:19], v[96:99], v[112:115]
    v_mfma_f32_16x16x32_bf16 v[116:119], a[20:23], v[96:99], v[116:119]
    v_mfma_f32_16x16x32_bf16 v[120:123], a[24:27], v[96:99], v[120:123]
    v_mfma_f32_16x16x32_bf16 v[124:127], a[28:31], v[96:99], v[124:127]
    v_mfma_f32_16x16x32_bf16 v[112:115], a[32:35], v[100:103], v[112:115]
    v_mfma_f32_16x16x32_bf16 v[116:119], a[36:39], v[100:103], v[116:119]
    v_mfma_f32_16x16x32_bf16 v[120:123], a[40:43], v[100:103], v[120:123]
    v_mfma_f32_16x16x32_bf16 v[124:127], a[44:47], v[100:103], v[124:127]
    v_mfma_f32_16x16x32_bf16 v[112:115], a[48:51], v[104:107], v[112:115]
    v_mfma_f32_16x16x32_bf16 v[116:119], a[52:55], v[104:107], v[116:119]
    v_mfma_f32_16x16x32_bf16 v[120:123], a[56:59], v[104:107], v[120:123]
    v_mfma_f32_16x16x32_bf16 v[124:127], a[60:63], v[104:107], v[124:127]
    v_mfma_f32_16x16x32_bf16 v[112:115], a[64:67], v[108:111], v[112:115]
    v_mfma_f32_16x16x32_bf16 v[116:119], a[68:71], v[108:111], v[116:119]
    v_mfma_f32_16x16x32_bf16 v[120:123], a[72:75], v[108:111], v[120:123]
    v_mfma_f32_16x16x32_bf16 v[124:127], a[76:79], v[108:111], v[124:127]
    s_mul_i32 s36, s3, 768
    s_add_u32 s36, s36, 133120
    v_lshlrev_b32 v4, 8, v3
    v_lshl_add_u32 v4, v2, 4, v4
    v_add_u32 v4, s36, v4
    v_add_u32 v5, 133120, v12
    s_lshl_b32 s37, s3, 8
    s_add_u32 s37, s37, 139264
    v_lshl_add_u32 v6, v1, 1, s37
    v_and_b32 v7, 1, v1
    v_lshlrev_b32 v7, 7, v7
    v_lshl_add_u32 v7, v2, 4, v7
    v_add_u32 v7, s37, v7
    s_lshl_b32 s38, s56, 16
    s_lshl_b32 s39, s57, 16
    v_rcp_f32 v8, s38
    v_rcp_f32 v9, s39
    s_and_b32 s56, s56, 0xffff0000
    s_and_b32 s57, s57, 0xffff0000
    s_mov_b32 exec_lo, 0x00070007
    s_mov_b32 exec_hi, 0x00070007
    ds_write_b128 v4, v[112:115] offset:0
    ds_write_b128 v4, v[116:119] offset:64
    ds_write_b128 v4, v[120:123] offset:128
    ds_write_b128 v4, v[124:127] offset:192
    s_mov_b64 exec, -1
    s_waitcnt lgkmcnt(0)
    s_barrier
    ds_read2st64_b32 v[92:93], v5 offset0:0 offset1:1
    ds_read2st64_b32 v[94:95], v5 offset0:2 offset1:3
    ds_read2st64_b32 v[96:97], v5 offset0:4 offset1:5
    ds_read2st64_b32 v[98:99], v5 offset0:6 offset1:7
    ds_read2st64_b32 v[100:101], v5 offset0:8 offset1:9
    ds_read2st64_b32 v[102:103], v5 offset0:10 offset1:11
    ds_read2st64_b32 v[116:117], v5 offset0:12 offset1:13
    ds_read2st64_b32 v[118:119], v5 offset0:14 offset1:15
    ds_read2st64_b32 v[120:121], v5 offset0:16 offset1:17
    ds_read2st64_b32 v[122:123], v5 offset0:18 offset1:19
    ds_read2st64_b32 v[124:125], v5 offset0:20 offset1:21
    ds_read2st64_b32 v[126:127], v5 offset0:22 offset1:23
    v_cmp_eq_u32 s[72:73], 1, v2
    v_cmp_eq_u32 s[74:75], 2, v2
    v_cmp_eq_u32 s[76:77], 3, v2
    s_mul_i32 s37, s32, 10
    s_add_u32 s37, s37, s3
    s_lshl_b32 s37, s37, 10
    s_add_u32 s37, s37, 7405568
    s_waitcnt lgkmcnt(0)
    v_add_f32 v92, v92, v95
    v_add_f32 v98, v98, v101
    v_add_f32 v92, v92, v98
    v_add_f32 v93, v93, v96
    v_add_f32 v99, v99, v102
    v_add_f32 v93, v93, v99
    v_add_f32 v94, v94, v97
    v_add_f32 v100, v100, v103
    v_add_f32 v94, v94, v100
    v_add_f32 v116, v116, v119
    v_add_f32 v122, v122, v125
    v_add_f32 v116, v116, v122
    v_add_f32 v117, v117, v120
    v_add_f32 v123, v123, v126
    v_add_f32 v117, v117, v123
    v_add_f32 v118, v118, v121
    v_add_f32 v124, v124, v127
    v_add_f32 v118, v118, v124
    v_fmac_f32 v92, s56, v94
    v_mul_f32 v112, v92, v8
    v_fmac_f32 v93, s57, v94
    v_mul_f32 v113, v93, v9
    v_fmac_f32 v116, s56, v118
    v_mul_f32 v120, v116, v8
    v_fmac_f32 v117, s57, v118
    v_mul_f32 v121, v117, v9
    v_cvt_pk_bf16_f32 v113, v112, v113
    v_lshlrev_b32 v112, 16, v113
    v_and_b32 v113, 0xffff0000, v113
    v_cvt_pk_bf16_f32 v121, v120, v121
    v_lshlrev_b32 v120, 16, v121
    v_and_b32 v121, 0xffff0000, v121
    v_mul_f32 v114, 0xbfb8aa3b, v112
    v_mul_f32 v115, 0xbfb8aa3b, v113
    v_exp_f32 v114, v114
    v_exp_f32 v115, v115
    v_add_f32 v114, 1.0, v114
    v_add_f32 v115, 1.0, v115
    v_rcp_f32 v114, v114
    v_rcp_f32 v115, v115
    v_mul_f32 v114, v114, v112
    v_mul_f32 v115, v115, v113
    v_cvt_pk_bf16_f32 v115, v114, v115
    v_lshlrev_b32 v114, 16, v115
    v_and_b32 v115, 0xffff0000, v115
    v_mul_f32 v114, v114, v120
    v_mul_f32 v115, v115, v121
    v_cvt_pk_bf16_f32 v114, v114, v115
    ds_write_b16 v6, v114
    ds_write_b16_d16_hi v6, v114 offset:128
    ds_read_b128 v[92:95], v7 offset:0
    ds_read_b128 v[96:99], v7 offset:64
    v_mov_b32 v101, s34
    v_mov_b32 v103, s34
    s_waitcnt vmcnt(0)
    ds_read_b64_tr_b16 v[28:29], v14 offset:4096
    ds_read_b64_tr_b16 v[30:31], v14 offset:4608
    ds_read_b64_tr_b16 v[32:33], v15 offset:4096
    ds_read_b64_tr_b16 v[34:35], v15 offset:4608
    ds_read_b64_tr_b16 v[36:37], v16 offset:4096
    ds_read_b64_tr_b16 v[38:39], v16 offset:4608
    ds_read_b64_tr_b16 v[40:41], v17 offset:4096
    ds_read_b64_tr_b16 v[42:43], v17 offset:4608
    ds_read_b64_tr_b16 v[44:45], v14 offset:8192
    ds_read_b64_tr_b16 v[46:47], v14 offset:8704
    ds_read_b64_tr_b16 v[48:49], v15 offset:8192
    ds_read_b64_tr_b16 v[50:51], v15 offset:8704
    ds_read_b64_tr_b16 v[52:53], v16 offset:8192
    ds_read_b64_tr_b16 v[54:55], v16 offset:8704
    ds_read_b64_tr_b16 v[56:57], v17 offset:8192
    ds_read_b64_tr_b16 v[58:59], v17 offset:8704
    s_waitcnt lgkmcnt(0)
    v_mfma_f32_16x16x32_bf16 v[112:115], v[92:95], v[28:31], 0
    v_mfma_f32_16x16x32_bf16 v[116:119], v[92:95], v[32:35], 0
    v_mfma_f32_16x16x32_bf16 v[120:123], v[92:95], v[36:39], 0
    v_mfma_f32_16x16x32_bf16 v[124:127], v[92:95], v[40:43], 0
    v_mfma_f32_16x16x32_bf16 v[112:115], v[96:99], v[44:47], v[112:115]
    v_mfma_f32_16x16x32_bf16 v[116:119], v[96:99], v[48:51], v[116:119]
    v_mfma_f32_16x16x32_bf16 v[120:123], v[96:99], v[52:55], v[120:123]
    v_mfma_f32_16x16x32_bf16 v[124:127], v[96:99], v[56:59], v[124:127]
    s_nop 5
    v_cndmask_b32 v100, v112, v116, s[72:73]
    v_cndmask_b32 v100, v100, v120, s[74:75]
    v_cndmask_b32 v100, v100, v124, s[76:77]
    v_cndmask_b32 v102, v113, v117, s[72:73]
    v_cndmask_b32 v102, v102, v121, s[74:75]
    v_cndmask_b32 v102, v102, v125, s[76:77]
    buffer_store_dwordx4 v[100:103], v13, s[28:31], s37 offen sc1
    s_sub_u32 s36, s3, 4
    s_cmp_ge_u32 s36, 2
    s_cbranch_scc1 Laux_end
    s_add_u32 s37, s37, 4096
    ds_read_b64_tr_b16 v[60:61], v14 offset:12288
    ds_read_b64_tr_b16 v[62:63], v14 offset:12800
    ds_read_b64_tr_b16 v[64:65], v15 offset:12288
    ds_read_b64_tr_b16 v[66:67], v15 offset:12800
    ds_read_b64_tr_b16 v[68:69], v16 offset:12288
    ds_read_b64_tr_b16 v[70:71], v16 offset:12800
    ds_read_b64_tr_b16 v[72:73], v17 offset:12288
    ds_read_b64_tr_b16 v[74:75], v17 offset:12800
    ds_read_b64_tr_b16 v[76:77], v14 offset:0
    ds_read_b64_tr_b16 v[78:79], v14 offset:512
    ds_read_b64_tr_b16 v[80:81], v15 offset:0
    ds_read_b64_tr_b16 v[82:83], v15 offset:512
    ds_read_b64_tr_b16 v[84:85], v16 offset:0
    ds_read_b64_tr_b16 v[86:87], v16 offset:512
    ds_read_b64_tr_b16 v[88:89], v17 offset:0
    ds_read_b64_tr_b16 v[90:91], v17 offset:512
    s_waitcnt lgkmcnt(0)
    v_mfma_f32_16x16x32_bf16 v[112:115], v[92:95], v[60:63], 0
    v_mfma_f32_16x16x32_bf16 v[116:119], v[92:95], v[64:67], 0
    v_mfma_f32_16x16x32_bf16 v[120:123], v[92:95], v[68:71], 0
    v_mfma_f32_16x16x32_bf16 v[124:127], v[92:95], v[72:75], 0
    v_mfma_f32_16x16x32_bf16 v[112:115], v[96:99], v[76:79], v[112:115]
    v_mfma_f32_16x16x32_bf16 v[116:119], v[96:99], v[80:83], v[116:119]
    v_mfma_f32_16x16x32_bf16 v[120:123], v[96:99], v[84:87], v[120:123]
    v_mfma_f32_16x16x32_bf16 v[124:127], v[96:99], v[88:91], v[124:127]
    s_nop 5
    v_cndmask_b32 v100, v112, v116, s[72:73]
    v_cndmask_b32 v100, v100, v120, s[74:75]
    v_cndmask_b32 v100, v100, v124, s[76:77]
    v_cndmask_b32 v102, v113, v117, s[72:73]
    v_cndmask_b32 v102, v102, v121, s[74:75]
    v_cndmask_b32 v102, v102, v125, s[76:77]
    buffer_store_dwordx4 v[100:103], v13, s[28:31], s37 offen sc1
Laux_end:
    s_endpgm
Lmst:
    s_cmp_lg_u32 s3, 0
    s_cbranch_scc1 Lhelp_i
    s_waitcnt lgkmcnt(0)
    s_mov_b64 s[28:29], s[24:25]
    s_mov_b32 s30, 268435456
    s_mov_b32 s31, 0x20000
    s_load_dword s34, s[28:29], 0
    s_waitcnt lgkmcnt(0)
    s_add_u32 s34, s34, 0x9e3779b8
    s_or_b32 s34, s34, 1
    s_mov_b64 exec, 1
    s_lshl_b32 s36, s2, 2
    s_add_u32 s36, s36, 8323072
    v_mov_b32 v4, s34
    v_mov_b32 v5, s36
    buffer_store_dword v4, v5, s[28:31], 0 offen sc1
    s_mov_b64 exec, -1
    s_cmp_lg_u32 s32, 32
    s_cbranch_scc1 Lend
Lmst_bc:
    v_and_b32 v4, 31, v1
    v_lshlrev_b32 v4, 7, v4
    v_add_u32 v4, 8126464, v4
Lpt_14:
    s_sub_u32 s35, s35, 1
    s_cbranch_scc1 Lend
    s_sleep 8
    buffer_load_dwordx4 v[8:11], v4, s[28:31], 0 offen sc1
    s_waitcnt vmcnt(0)
    v_cmp_ne_u32 vcc, s34, v9
    v_cmp_ne_u32 s[36:37], s34, v11
    s_nop 0
    s_or_b64 s[36:37], s[36:37], vcc
    s_cbranch_scc1 Lpt_14
    v_mov_b32 v4, v8
    s_nop 1
    v_max_u32_dpp v4, v4, v4 row_ror:8 row_mask:0xf bank_mask:0xf
    s_nop 1
    v_max_u32_dpp v4, v4, v4 row_ror:4 row_mask:0xf bank_mask:0xf
    s_nop 1
    v_max_u32_dpp v4, v4, v4 row_ror:2 row_mask:0xf bank_mask:0xf
    s_nop 1
    v_max_u32_dpp v4, v4, v4 row_ror:1 row_mask:0xf bank_mask:0xf
    s_nop 0
    v_readlane_b32 s40, v4, 0
    v_readlane_b32 s36, v4, 16
    v_readlane_b32 s37, v4, 32
    v_readlane_b32 s38, v4, 48
    s_max_u32 s40, s40, s36
    s_max_u32 s37, s37, s38
    s_max_u32 s40, s40, s37
    v_cmp_eq_u32 vcc, s40, v8
    s_nop 1
    v_cndmask_b32 v4, v8, v10, vcc
    s_nop 1
    v_max_u32_dpp v4, v4, v4 row_ror:8 row_mask:0xf bank_mask:0xf
    s_nop 1
    v_max_u32_dpp v4, v4, v4 row_ror:4 row_mask:0xf bank_mask:0xf
    s_nop 1
    v_max_u32_dpp v4, v4, v4 row_ror:2 row_mask:0xf bank_mask:0xf
    s_nop 1
    v_max_u32_dpp v4, v4, v4 row_ror:1 row_mask:0xf bank_mask:0xf
    s_nop 0
    v_readlane_b32 s41, v4, 0
    v_readlane_b32 s36, v4, 16
    v_readlane_b32 s37, v4, 32
    v_readlane_b32 s38, v4, 48
    s_max_u32 s41, s41, s36
    s_max_u32 s37, s37, s38
    s_max_u32 s41, s41, s37
    v_mov_b32 v8, s40
    v_mov_b32 v9, s34
    v_mov_b32 v10, s41
    v_mov_b32 v11, s34
    s_mov_b32 s36, 8257536
    buffer_store_dwordx4 v[8:11], v13, s[28:31], s36 offen offset:0 sc1
    buffer_store_dwordx4 v[8:11], v13, s[28:31], s36 offen offset:1024 sc1
    buffer_store_dwordx4 v[8:11], v13, s[28:31], s36 offen offset:2048 sc1
    s_mov_b32 s36, 8323072
Lmaster:
    s_sub_u32 s35, s35, 1
    s_cbranch_scc1 Lend
    s_sleep 16
    buffer_load_dwordx4 v[4:7], v13, s[28:31], s36 offen sc1
    s_waitcnt vmcnt(0)
    v_xor_b32 v4, s34, v4
    v_xor_b32 v5, s34, v5
    v_xor_b32 v6, s34, v6
    v_xor_b32 v7, s34, v7
    v_or3_b32 v4, v4, v5, v6
    v_or_b32 v4, v4, v7
    v_cmp_ne_u32 vcc, 0, v4
    s_nop 0
    s_cbranch_vccnz Lmaster
    s_mov_b64 exec, 1
    buffer_store_dword v9, v4, s[28:31], 0 offen sc1
    s_endpgm
Lhelp_r:
    s_sub_u32 s72, s32, 27
    s_add_u32 s72, s72, 9
    s_mov_b32 s73, 5
    s_mov_b32 s37, 2
    s_branch Lhelp
Lhelp_i:
    s_cmp_eq_u32 s32, 32
    s_cbranch_scc1 Lend
    s_cmp_eq_u32 s27, 0
    s_cbranch_scc1 Lend
    s_sub_u32 s72, s32, 33
    s_mov_b32 s73, 3
    s_mov_b32 s37, 3
Lhelp:
    s_lshl_b32 s38, s26, 6
    v_add_u32 v4, s38, v1
    v_mul_u32_u24 v4, 1280, v4
    s_waitcnt lgkmcnt(0)
    s_mov_b64 s[68:69], s[8:9]
    s_mov_b32 s70, 819200
    s_mov_b32 s71, 0x20000
    v_add_u32 v7, s38, v1
    v_lshlrev_b32 v7, 7, v7
    s_cmp_eq_u32 s73, 3
    s_cselect_b32 s36, 5, 2
    s_cselect_b32 s39, 33, 27
    s_cselect_b32 s38, 0, 15
    s_sub_u32 s39, s32, s39
    s_mul_i32 s39, s39, s36
    s_add_u32 s39, s39, s38
    s_lshl_b32 s39, s39, 15
Lhelp1:
    buffer_load_dword v5, v7, s[68:71], s39 offen
    s_add_u32 s39, s39, 32768
    s_sub_u32 s36, s36, 1
    s_cmp_lg_u32 s36, 0
    s_cbranch_scc1 Lhelp1
    s_mov_b64 s[68:69], s[18:19]
    s_mov_b32 s70, 2211840
    s_mov_b32 s71, 0x20000
Lhelp2:
    s_mul_i32 s38, s72, 9363
    s_lshr_b32 s38, s38, 16
    s_mul_i32 s39, s38, 7
    s_sub_u32 s39, s72, s39
    s_mul_i32 s39, s39, 327680
    s_lshl_b32 s38, s38, 7
    s_sub_u32 s39, s39, s38
    s_add_u32 s39, s39, 1152
    v_add_u32 v6, s39, v4
    buffer_load_dword v5, v6, s[68:71], 0 offen
    s_add_u32 s72, s72, s73
    s_sub_u32 s37, s37, 1
    s_cmp_lg_u32 s37, 0
    s_cbranch_scc1 Lhelp2
Lend:
    s_endpgm
.section .rodata,"a"
.p2align 6
.amdhsa_kernel recurrent_scan__sliding_local_dilated__moe_arch_mod__prompt_kernel
  .amdhsa_next_free_vgpr 256
  .amdhsa_next_free_sgpr 102
  .amdhsa_accum_offset 128
  .amdhsa_group_segment_fixed_size 0
  .amdhsa_kernarg_size 88
  .amdhsa_user_sgpr_count 2
  .amdhsa_user_sgpr_kernarg_segment_ptr 1
  .amdhsa_system_sgpr_workgroup_id_x 1
  .amdhsa_float_denorm_mode_32 3
.end_amdhsa_kernel
```

```asm
; @launch grid=(256,1,1) block=(512,1,1) lds=163840
.amdgcn_target "amdgcn-amd-amdhsa--gfx950"
.text
.globl recurrent_scan__sliding_local_dilated__moe_arch_mod__prompt_kernel
.p2align 8
.type recurrent_scan__sliding_local_dilated__moe_arch_mod__prompt_kernel,@function
recurrent_scan__sliding_local_dilated__moe_arch_mod__prompt_kernel:
    s_load_dwordx16 s[4:19], s[0:1], 0
    s_load_dwordx4 s[20:23], s[0:1], 64
    s_load_dwordx2 s[24:25], s[0:1], 80
    v_lshrrev_b32 v4, 6, v0
    v_and_b32 v1, 63, v0
    s_cmp_ge_u32 s2, 256
    s_cbranch_scc1 Lend
    v_readfirstlane_b32 s3, v4
    s_getpc_b64 s[36:37]
Lpc:
    s_and_b32 s38, s2, 0xf8
    v_add_u32 v5, s38, v4
    v_and_b32 v6, 1, v0
    v_lshl_add_u32 v5, v5, 1, v6
    v_lshlrev_b32 v5, 7, v5
    v_min_u32 v5, Lend-Lpc, v5
    v_mov_b32 v7, s37
    v_add_co_u32 v6, vcc, s36, v5
    s_nop 1
    v_addc_co_u32 v7, vcc, 0, v7, vcc
    global_load_dword v0, v[6:7], off
    v_lshrrev_b32 v2, 4, v1
    v_and_b32 v3, 15, v1
    v_lshlrev_b32 v12, 2, v1
    v_lshlrev_b32 v13, 4, v1
    s_mov_b32 s35, 2000000
    s_and_b32 s36, s2, 7
    s_lshr_b32 s37, s2, 3
    s_and_b32 s38, s36, 1
    s_lshr_b32 s36, s36, 1
    s_add_u32 s39, s38, 4
    s_and_b32 s26, s3, 3
    s_lshr_b32 s27, s3, 2
    s_cmp_lt_u32 s37, s39
    s_cbranch_scc1 Laux
    s_lshr_b32 s33, s36, 1
    s_and_b32 s36, s36, 1
    s_mul_i32 s36, s36, 55
    s_mul_i32 s38, s38, 28
    s_add_u32 s36, s36, s38
    s_add_u32 s36, s36, s37
    s_sub_u32 s36, s36, s39
    s_mul_i32 s32, s36, 13108
    s_lshr_b32 s32, s32, 16
    s_mul_i32 s37, s32, 5
    s_sub_u32 s36, s36, s37
    s_mul_i32 s33, s33, 5
    s_add_u32 s33, s33, s36
    s_add_u32 s42, s33, s32
    s_mul_i32 s36, s42, 13108
    s_lshr_b32 s36, s36, 16
    s_mul_i32 s36, s36, 5
    s_sub_u32 s42, s42, s36
    s_and_b32 s43, s2, 7
    s_lshl_b32 s43, s43, 2
    s_lshr_b32 s43, 0x30858530, s43
    s_and_b32 s43, s43, 15
    s_cmp_lg_u32 s3, 0
    s_cbranch_scc1 Lcomp
Lloader:
    s_setprio 3
    v_lshrrev_b32 v5, 3, v1
    v_and_b32 v6, 7, v1
    v_and_b32 v8, 1, v2
    v_lshlrev_b32 v8, 1, v8
    v_xor_b32 v8, v8, v6
    s_lshl_b32 s39, s33, 7
    v_lshl_add_u32 v50, v8, 4, s39
    v_mov_b32 v7, 3840
    v_mad_u32_u24 v28, v5, v7, v50
    v_xor_b32 v29, 64, v28
    v_add_u32 v29, 29696, v29
    v_add_u32 v30, 59392, v28
    v_add_u32 v31, 59392, v29
    v_add_u32 v32, 122880, v28
    v_add_u32 v33, 122880, v29
    v_add_u32 v34, 182272, v28
    v_add_u32 v35, 182272, v29
    s_lshl_b32 s79, s42, 2
    s_lshr_b32 s79, 0x11000, s79
    s_and_b32 s79, s79, 15
    s_add_u32 s79, s79, s43
    s_sub_u32 s38, s79, 10
    s_cmp_ge_u32 s79, 10
    s_cselect_b32 s79, s38, s79
    s_mul_i32 s68, s79, 245760
    s_lshl_b32 s78, s79, 7
    s_waitcnt lgkmcnt(0)
    s_mov_b64 s[48:49], s[6:7]
    s_mov_b32 s50, 2457600
    s_mov_b32 s51, 0x20000
    s_add_u32 s52, s6, 1280
    s_addc_u32 s53, s7, 0
    s_mov_b32 s54, 2456320
    s_mov_b32 s55, 0x20000
    s_add_u32 s56, s6, 2560
    s_addc_u32 s57, s7, 0
    s_mov_b32 s58, 2455040
    s_mov_b32 s59, 0x20000
    s_lshr_b32 s69, 10, s42
    s_and_b32 s69, s69, 1
    s_mul_i32 s70, s69, 122880
    s_sub_u32 s71, 122880, s70
    s_add_u32 s70, s70, s68
    s_add_u32 s71, s71, s68
    s_lshl_b32 s72, s69, 12
    s_xor_b32 s73, s72, 4096
    s_add_u32 m0, s72, 0
    s_mul_i32 s38, s32, 96
    s_sub_u32 s38, s38, 16
    v_add_u32 v7, s38, v5
    v_xor_b32 v9, v6, v2
    v_lshlrev_b32 v9, 4, v9
    buffer_load_dwordx4 v28, s[48:51], s70 offen lds
    v_xor_b32 v10, 64, v9
    v_mov_b32 v11, 2052
    v_mov_b32 v8, 1280
    v_add_u32 v36, 0, v7
    buffer_load_dwordx4 v29, s[48:51], s70 offen offset:1024 lds
    v_med3_i32 v36, v36, 0, v11
    v_mad_u32_u24 v36, v36, v8, v9
    v_add_u32 v36, 4096, v36
    v_add_u32 v37, 8, v7
    buffer_load_dwordx4 v30, s[48:51], s70 offen offset:2048 lds
    v_med3_i32 v37, v37, 0, v11
    v_mad_u32_u24 v37, v37, v8, v10
    v_add_u32 v37, 3072, v37
    v_add_u32 v38, 16, v7
    v_med3_i32 v38, v38, 0, v11
    buffer_load_dwordx4 v31, s[48:51], s70 offen offset:3072 lds
    v_mad_u32_u24 v38, v38, v8, v9
    v_add_u32 v38, 2048, v38
    v_add_u32 v39, 24, v7
    v_med3_i32 v39, v39, 0, v11
    s_add_u32 m0, s72, 8192
    v_mad_u32_u24 v39, v39, v8, v10
    v_add_u32 v39, 1024, v39
    v_add_u32 v40, 32, v7
    v_med3_i32 v40, v40, 0, v11
    buffer_load_dwordx4 v28, s[52:55], s70 offen lds
    v_mad_u32_u24 v40, v40, v8, v9
    v_add_u32 v40, 4096, v40
    v_add_u32 v41, 40, v7
    v_med3_i32 v41, v41, 0, v11
    v_mad_u32_u24 v41, v41, v8, v10
    buffer_load_dwordx4 v29, s[52:55], s70 offen offset:1024 lds
    v_add_u32 v41, 3072, v41
    v_add_u32 v42, 48, v7
    v_med3_i32 v42, v42, 0, v11
    v_mad_u32_u24 v42, v42, v8, v9
    buffer_load_dwordx4 v30, s[52:55], s70 offen offset:2048 lds
    v_add_u32 v42, 2048, v42
    v_add_u32 v43, 56, v7
    v_med3_i32 v43, v43, 0, v11
    v_mad_u32_u24 v43, v43, v8, v10
    buffer_load_dwordx4 v31, s[52:55], s70 offen offset:3072 lds
    v_add_u32 v43, 1024, v43
    v_add_u32 v44, 64, v7
    v_med3_i32 v44, v44, 0, v11
    v_mad_u32_u24 v44, v44, v8, v9
    v_add_u32 v44, 4096, v44
    s_add_u32 m0, s72, 16384
    v_add_u32 v45, 72, v7
    v_med3_i32 v45, v45, 0, v11
    v_mad_u32_u24 v45, v45, v8, v10
    v_add_u32 v45, 3072, v45
    buffer_load_dwordx4 v28, s[56:59], s70 offen lds
    v_add_u32 v46, 80, v7
    v_med3_i32 v46, v46, 0, v11
    v_mad_u32_u24 v46, v46, v8, v9
    v_add_u32 v46, 2048, v46
    buffer_load_dwordx4 v29, s[56:59], s70 offen offset:1024 lds
    v_add_u32 v47, 88, v7
    v_med3_i32 v47, v47, 0, v11
    v_mad_u32_u24 v47, v47, v8, v10
    v_add_u32 v47, 1024, v47
    v_add_u32 v48, 96, v7
    buffer_load_dwordx4 v30, s[56:59], s70 offen offset:2048 lds
    v_med3_i32 v48, v48, 0, v11
    v_mad_u32_u24 v48, v48, v8, v9
    v_add_u32 v48, 4096, v48
    v_add_u32 v49, 104, v7
    buffer_load_dwordx4 v31, s[56:59], s70 offen offset:3072 lds
    v_med3_i32 v49, v49, 0, v11
    v_mad_u32_u24 v49, v49, v8, v10
    v_add_u32 v49, 3072, v49
    s_sub_u32 s44, s4, 4096
    s_subb_u32 s45, s5, 0
    s_mov_b32 s46, 2625536
    s_mov_b32 s47, 0x20000
    s_mov_b32 m0, 24576
    s_nop 0
    buffer_load_dwordx4 v36, s[44:47], s78 offen lds
    buffer_load_dwordx4 v37, s[44:47], s78 offen offset:1024 lds
    buffer_load_dwordx4 v38, s[44:47], s78 offen offset:2048 lds
    buffer_load_dwordx4 v39, s[44:47], s78 offen offset:3072 lds
    s_mov_b32 m0, 28672
    s_nop 0
    buffer_load_dwordx4 v40, s[44:47], s78 offen lds
    buffer_load_dwordx4 v41, s[44:47], s78 offen offset:1024 lds
    buffer_load_dwordx4 v42, s[44:47], s78 offen offset:2048 lds
    buffer_load_dwordx4 v43, s[44:47], s78 offen offset:3072 lds
    s_mov_b32 m0, 32768
    s_nop 0
    buffer_load_dwordx4 v44, s[44:47], s78 offen lds
    buffer_load_dwordx4 v45, s[44:47], s78 offen offset:1024 lds
    buffer_load_dwordx4 v46, s[44:47], s78 offen offset:2048 lds
    buffer_load_dwordx4 v47, s[44:47], s78 offen offset:3072 lds
    s_mov_b32 m0, 36864
    s_nop 0
    buffer_load_dwordx4 v48, s[44:47], s78 offen lds
    buffer_load_dwordx4 v49, s[44:47], s78 offen offset:1024 lds
    s_add_u32 m0, s73, 0
    s_nop 0
    buffer_load_dwordx4 v28, s[48:51], s71 offen lds
    buffer_load_dwordx4 v29, s[48:51], s71 offen offset:1024 lds
    buffer_load_dwordx4 v30, s[48:51], s71 offen offset:2048 lds
    buffer_load_dwordx4 v31, s[48:51], s71 offen offset:3072 lds
    s_add_u32 m0, s73, 8192
    s_nop 0
    buffer_load_dwordx4 v28, s[52:55], s71 offen lds
    buffer_load_dwordx4 v29, s[52:55], s71 offen offset:1024 lds
    buffer_load_dwordx4 v30, s[52:55], s71 offen offset:2048 lds
    buffer_load_dwordx4 v31, s[52:55], s71 offen offset:3072 lds
    s_add_u32 m0, s73, 16384
    s_nop 0
    buffer_load_dwordx4 v28, s[56:59], s71 offen lds
    buffer_load_dwordx4 v29, s[56:59], s71 offen offset:1024 lds
    buffer_load_dwordx4 v30, s[56:59], s71 offen offset:2048 lds
    buffer_load_dwordx4 v31, s[56:59], s71 offen offset:3072 lds
    s_mov_b32 s80, 0x86542310
    s_mov_b32 s81, 0x97
    s_cmp_eq_u32 s42, 1
    s_cselect_b32 s80, 0x76453210, s80
    s_cselect_b32 s81, 0x98, s81
    s_cmp_eq_u32 s42, 2
    s_cselect_b32 s80, 0x67543120, s80
    s_cselect_b32 s81, 0x98, s81
    s_cmp_eq_u32 s42, 3
    s_cselect_b32 s80, 0x76534201, s80
    s_cselect_b32 s81, 0x89, s81
    s_cmp_eq_u32 s42, 4
    s_cselect_b32 s80, 0x75643201, s80
    s_cselect_b32 s81, 0x98, s81
    s_lshr_b64 s[80:81], s[80:81], 4
    s_and_b32 s79, s80, 15
    s_add_u32 s79, s79, s43
    s_sub_u32 s38, s79, 10
    s_cmp_ge_u32 s79, 10
    s_cselect_b32 s79, s38, s79
    s_mov_b64 s[28:29], s[24:25]
    s_mov_b32 s30, 268435456
    s_mov_b32 s31, 0x20000
    s_load_dword s34, s[28:29], 0
    s_mov_b64 s[60:61], s[8:9]
    s_mov_b32 s62, 819200
    s_mov_b32 s63, 0x20000
    v_mov_b32 v51, 157984
    v_and_b32 v66, 7, v1
    v_max_u32 v66, 1, v66
    v_lshlrev_b32 v66, 2, v66
    v_add_u32 v66, 158016, v66
    s_mul_i32 s69, s79, 245760
    s_lshl_b32 s78, s79, 7
    s_mov_b32 m0, 63616
    s_nop 0
    buffer_load_dwordx4 v36, s[44:47], s78 offen lds
    buffer_load_dwordx4 v37, s[44:47], s78 offen offset:1024 lds
    buffer_load_dwordx4 v38, s[44:47], s78 offen offset:2048 lds
    buffer_load_dwordx4 v39, s[44:47], s78 offen offset:3072 lds
    s_mov_b32 m0, 39040
    s_nop 0
    buffer_load_dwordx4 v28, s[48:51], s69 offen lds
    buffer_load_dwordx4 v29, s[48:51], s69 offen offset:1024 lds
    buffer_load_dwordx4 v30, s[48:51], s69 offen offset:2048 lds
    buffer_load_dwordx4 v31, s[48:51], s69 offen offset:3072 lds
    s_mov_b32 m0, 67712
    s_nop 0
    buffer_load_dwordx4 v40, s[44:47], s78 offen lds
    buffer_load_dwordx4 v41, s[44:47], s78 offen offset:1024 lds
    buffer_load_dwordx4 v42, s[44:47], s78 offen offset:2048 lds
    buffer_load_dwordx4 v43, s[44:47], s78 offen offset:3072 lds
    s_mov_b32 m0, 47232
    s_nop 0
    buffer_load_dwordx4 v28, s[52:55], s69 offen lds
    buffer_load_dwordx4 v29, s[52:55], s69 offen offset:1024 lds
    buffer_load_dwordx4 v30, s[52:55], s69 offen offset:2048 lds
    buffer_load_dwordx4 v31, s[52:55], s69 offen offset:3072 lds
    s_mov_b32 m0, 71808
    s_nop 0
    buffer_load_dwordx4 v44, s[44:47], s78 offen lds
    buffer_load_dwordx4 v45, s[44:47], s78 offen offset:1024 lds
    buffer_load_dwordx4 v46, s[44:47], s78 offen offset:2048 lds
    buffer_load_dwordx4 v47, s[44:47], s78 offen offset:3072 lds
    s_mov_b32 m0, 55424
    s_nop 0
    buffer_load_dwordx4 v28, s[56:59], s69 offen lds
    buffer_load_dwordx4 v29, s[56:59], s69 offen offset:1024 lds
    buffer_load_dwordx4 v30, s[56:59], s69 offen offset:2048 lds
    buffer_load_dwordx4 v31, s[56:59], s69 offen offset:3072 lds
    s_mov_b32 m0, 75904
    s_nop 0
    buffer_load_dwordx4 v48, s[44:47], s78 offen lds
    s_waitcnt vmcnt(55)
    buffer_load_dwordx4 v49, s[44:47], s78 offen offset:1024 lds
    s_mov_b32 m0, 43136
    s_nop 0
    buffer_load_dwordx4 v32, s[48:51], s69 offen lds
    buffer_load_dwordx4 v33, s[48:51], s69 offen offset:1024 lds
    buffer_load_dwordx4 v34, s[48:51], s69 offen offset:2048 lds
    buffer_load_dwordx4 v35, s[48:51], s69 offen offset:3072 lds
    s_mov_b32 m0, 51328
    s_nop 0
    buffer_load_dwordx4 v32, s[52:55], s69 offen lds
    buffer_load_dwordx4 v33, s[52:55], s69 offen offset:1024 lds
    buffer_load_dwordx4 v34, s[52:55], s69 offen offset:2048 lds
    s_waitcnt vmcnt(55)
    buffer_load_dwordx4 v35, s[52:55], s69 offen offset:3072 lds
    s_mov_b32 m0, 59520
    s_nop 0
    buffer_load_dwordx4 v32, s[56:59], s69 offen lds
    buffer_load_dwordx4 v33, s[56:59], s69 offen offset:1024 lds
    buffer_load_dwordx4 v34, s[56:59], s69 offen offset:2048 lds
    buffer_load_dwordx4 v35, s[56:59], s69 offen offset:3072 lds
    s_waitcnt vmcnt(38) lgkmcnt(0)
    s_barrier
    s_add_u32 s34, s34, 0x9e3779b8
    s_or_b32 s34, s34, 1
    s_lshr_b64 s[80:81], s[80:81], 4
    s_and_b32 s79, s80, 15
    s_add_u32 s79, s79, s43
    s_sub_u32 s38, s79, 10
    s_cmp_ge_u32 s79, 10
    s_cselect_b32 s79, s38, s79
    s_mul_i32 s70, s79, 245760
    s_lshl_b32 s78, s79, 7
    s_mov_b32 m0, 102656
    s_nop 0
    buffer_load_dwordx4 v36, s[44:47], s78 offen lds
    buffer_load_dwordx4 v37, s[44:47], s78 offen offset:1024 lds
    buffer_load_dwordx4 v38, s[44:47], s78 offen offset:2048 lds
    buffer_load_dwordx4 v39, s[44:47], s78 offen offset:3072 lds
    s_mov_b32 m0, 78080
    s_nop 0
    buffer_load_dwordx4 v28, s[48:51], s70 offen lds
    buffer_load_dwordx4 v29, s[48:51], s70 offen offset:1024 lds
    buffer_load_dwordx4 v30, s[48:51], s70 offen offset:2048 lds
    buffer_load_dwordx4 v31, s[48:51], s70 offen offset:3072 lds
    s_mov_b32 m0, 106752
    s_nop 0
    buffer_load_dwordx4 v40, s[44:47], s78 offen lds
    buffer_load_dwordx4 v41, s[44:47], s78 offen offset:1024 lds
    buffer_load_dwordx4 v42, s[44:47], s78 offen offset:2048 lds
    buffer_load_dwordx4 v43, s[44:47], s78 offen offset:3072 lds
    s_mov_b32 m0, 86272
    s_nop 0
    buffer_load_dwordx4 v28, s[52:55], s70 offen lds
    buffer_load_dwordx4 v29, s[52:55], s70 offen offset:1024 lds
    buffer_load_dwordx4 v30, s[52:55], s70 offen offset:2048 lds
    buffer_load_dwordx4 v31, s[52:55], s70 offen offset:3072 lds
    s_mov_b32 m0, 110848
    s_nop 0
    buffer_load_dwordx4 v44, s[44:47], s78 offen lds
    buffer_load_dwordx4 v45, s[44:47], s78 offen offset:1024 lds
    buffer_load_dwordx4 v46, s[44:47], s78 offen offset:2048 lds
    buffer_load_dwordx4 v47, s[44:47], s78 offen offset:3072 lds
    s_mov_b32 m0, 94464
    s_nop 0
    buffer_load_dwordx4 v28, s[56:59], s70 offen lds
    buffer_load_dwordx4 v29, s[56:59], s70 offen offset:1024 lds
    buffer_load_dwordx4 v30, s[56:59], s70 offen offset:2048 lds
    buffer_load_dwordx4 v31, s[56:59], s70 offen offset:3072 lds
    s_mov_b32 m0, 114944
    s_nop 0
    buffer_load_dwordx4 v48, s[44:47], s78 offen lds
    s_waitcnt vmcnt(55)
    buffer_load_dwordx4 v49, s[44:47], s78 offen offset:1024 lds
    s_mov_b32 m0, 82176
    s_nop 0
    buffer_load_dwordx4 v32, s[48:51], s70 offen lds
    buffer_load_dwordx4 v33, s[48:51], s70 offen offset:1024 lds
    buffer_load_dwordx4 v34, s[48:51], s70 offen offset:2048 lds
    buffer_load_dwordx4 v35, s[48:51], s70 offen offset:3072 lds
    s_mov_b32 m0, 90368
    s_nop 0
    buffer_load_dwordx4 v32, s[52:55], s70 offen lds
    buffer_load_dwordx4 v33, s[52:55], s70 offen offset:1024 lds
    buffer_load_dwordx4 v34, s[52:55], s70 offen offset:2048 lds
    s_waitcnt vmcnt(55)
    buffer_load_dwordx4 v35, s[52:55], s70 offen offset:3072 lds
    s_mov_b32 m0, 98560
    s_nop 0
    buffer_load_dwordx4 v32, s[56:59], s70 offen lds
    buffer_load_dwordx4 v33, s[56:59], s70 offen offset:1024 lds
    buffer_load_dwordx4 v34, s[56:59], s70 offen offset:2048 lds
    buffer_load_dwordx4 v35, s[56:59], s70 offen offset:3072 lds
    s_waitcnt vmcnt(38) lgkmcnt(0)
    s_barrier
    s_lshr_b64 s[80:81], s[80:81], 4
    s_and_b32 s79, s80, 15
    s_add_u32 s79, s79, s43
    s_sub_u32 s38, s79, 10
    s_cmp_ge_u32 s79, 10
    s_cselect_b32 s79, s38, s79
    s_mul_i32 s71, s79, 245760
    s_lshl_b32 s78, s79, 7
    s_mov_b32 m0, 141696
    s_nop 0
    buffer_load_dwordx4 v36, s[44:47], s78 offen lds
    buffer_load_dwordx4 v37, s[44:47], s78 offen offset:1024 lds
    buffer_load_dwordx4 v38, s[44:47], s78 offen offset:2048 lds
    buffer_load_dwordx4 v39, s[44:47], s78 offen offset:3072 lds
    s_mov_b32 m0, 117120
    s_nop 0
    buffer_load_dwordx4 v28, s[48:51], s71 offen lds
    buffer_load_dwordx4 v29, s[48:51], s71 offen offset:1024 lds
    buffer_load_dwordx4 v30, s[48:51], s71 offen offset:2048 lds
    buffer_load_dwordx4 v31, s[48:51], s71 offen offset:3072 lds
    s_mov_b32 m0, 145792
    s_nop 0
    buffer_load_dwordx4 v40, s[44:47], s78 offen lds
    buffer_load_dwordx4 v41, s[44:47], s78 offen offset:1024 lds
    buffer_load_dwordx4 v42, s[44:47], s78 offen offset:2048 lds
    buffer_load_dwordx4 v43, s[44:47], s78 offen offset:3072 lds
    s_mov_b32 m0, 125312
    s_nop 0
    buffer_load_dwordx4 v28, s[52:55], s71 offen lds
    buffer_load_dwordx4 v29, s[52:55], s71 offen offset:1024 lds
    buffer_load_dwordx4 v30, s[52:55], s71 offen offset:2048 lds
    buffer_load_dwordx4 v31, s[52:55], s71 offen offset:3072 lds
    s_mov_b32 m0, 149888
    s_nop 0
    buffer_load_dwordx4 v44, s[44:47], s78 offen lds
    buffer_load_dwordx4 v45, s[44:47], s78 offen offset:1024 lds
    buffer_load_dwordx4 v46, s[44:47], s78 offen offset:2048 lds
    buffer_load_dwordx4 v47, s[44:47], s78 offen offset:3072 lds
    s_mov_b32 m0, 133504
    s_nop 0
    buffer_load_dwordx4 v28, s[56:59], s71 offen lds
    buffer_load_dwordx4 v29, s[56:59], s71 offen offset:1024 lds
    buffer_load_dwordx4 v30, s[56:59], s71 offen offset:2048 lds
    buffer_load_dwordx4 v31, s[56:59], s71 offen offset:3072 lds
    s_mov_b32 m0, 153984
    s_nop 0
    buffer_load_dwordx4 v48, s[44:47], s78 offen lds
    s_waitcnt vmcnt(55)
    buffer_load_dwordx4 v49, s[44:47], s78 offen offset:1024 lds
    s_mov_b32 m0, 121216
    s_nop 0
    buffer_load_dwordx4 v32, s[48:51], s71 offen lds
    buffer_load_dwordx4 v33, s[48:51], s71 offen offset:1024 lds
    buffer_load_dwordx4 v34, s[48:51], s71 offen offset:2048 lds
    buffer_load_dwordx4 v35, s[48:51], s71 offen offset:3072 lds
    s_mov_b32 m0, 129408
    s_nop 0
    buffer_load_dwordx4 v32, s[52:55], s71 offen lds
    buffer_load_dwordx4 v33, s[52:55], s71 offen offset:1024 lds
    buffer_load_dwordx4 v34, s[52:55], s71 offen offset:2048 lds
    s_waitcnt vmcnt(55)
    buffer_load_dwordx4 v35, s[52:55], s71 offen offset:3072 lds
    s_mov_b32 m0, 137600
    s_nop 0
    buffer_load_dwordx4 v32, s[56:59], s71 offen lds
    buffer_load_dwordx4 v33, s[56:59], s71 offen offset:1024 lds
    buffer_load_dwordx4 v34, s[56:59], s71 offen offset:2048 lds
    buffer_load_dwordx4 v35, s[56:59], s71 offen offset:3072 lds
    s_waitcnt vmcnt(38) lgkmcnt(0)
    s_barrier
    s_lshr_b64 s[80:81], s[80:81], 4
    s_and_b32 s79, s80, 15
    s_add_u32 s79, s79, s43
    s_sub_u32 s38, s79, 10
    s_cmp_ge_u32 s79, 10
    s_cselect_b32 s79, s38, s79
    s_mul_i32 s72, s79, 245760
    s_lshl_b32 s78, s79, 7
    s_mov_b32 m0, 24576
    s_nop 0
    buffer_load_dwordx4 v36, s[44:47], s78 offen lds
    buffer_load_dwordx4 v37, s[44:47], s78 offen offset:1024 lds
    buffer_load_dwordx4 v38, s[44:47], s78 offen offset:2048 lds
    buffer_load_dwordx4 v39, s[44:47], s78 offen offset:3072 lds
    s_mov_b32 m0, 0
    s_nop 0
    buffer_load_dwordx4 v28, s[48:51], s72 offen lds
    buffer_load_dwordx4 v29, s[48:51], s72 offen offset:1024 lds
    buffer_load_dwordx4 v30, s[48:51], s72 offen offset:2048 lds
    buffer_load_dwordx4 v31, s[48:51], s72 offen offset:3072 lds
    s_mov_b32 m0, 28672
    s_nop 0
    buffer_load_dwordx4 v40, s[44:47], s78 offen lds
    buffer_load_dwordx4 v41, s[44:47], s78 offen offset:1024 lds
    buffer_load_dwordx4 v42, s[44:47], s78 offen offset:2048 lds
    buffer_load_dwordx4 v43, s[44:47], s78 offen offset:3072 lds
    s_mov_b32 m0, 8192
    s_nop 0
    buffer_load_dwordx4 v28, s[52:55], s72 offen lds
    buffer_load_dwordx4 v29, s[52:55], s72 offen offset:1024 lds
    buffer_load_dwordx4 v30, s[52:55], s72 offen offset:2048 lds
    buffer_load_dwordx4 v31, s[52:55], s72 offen offset:3072 lds
    s_mov_b32 m0, 32768
    s_nop 0
    buffer_load_dwordx4 v44, s[44:47], s78 offen lds
    buffer_load_dwordx4 v45, s[44:47], s78 offen offset:1024 lds
    buffer_load_dwordx4 v46, s[44:47], s78 offen offset:2048 lds
    buffer_load_dwordx4 v47, s[44:47], s78 offen offset:3072 lds
    s_mov_b32 m0, 16384
    s_nop 0
    buffer_load_dwordx4 v28, s[56:59], s72 offen lds
    buffer_load_dwordx4 v29, s[56:59], s72 offen offset:1024 lds
    buffer_load_dwordx4 v30, s[56:59], s72 offen offset:2048 lds
    buffer_load_dwordx4 v31, s[56:59], s72 offen offset:3072 lds
    s_mov_b32 m0, 36864
    s_nop 0
    buffer_load_dwordx4 v48, s[44:47], s78 offen lds
    s_waitcnt vmcnt(55)
    buffer_load_dwordx4 v49, s[44:47], s78 offen offset:1024 lds
    s_mov_b32 m0, 4096
    s_nop 0
    buffer_load_dwordx4 v32, s[48:51], s72 offen lds
    buffer_load_dwordx4 v33, s[48:51], s72 offen offset:1024 lds
    buffer_load_dwordx4 v34, s[48:51], s72 offen offset:2048 lds
    buffer_load_dwordx4 v35, s[48:51], s72 offen offset:3072 lds
    s_mov_b32 m0, 12288
    s_nop 0
    buffer_load_dwordx4 v32, s[52:55], s72 offen lds
    buffer_load_dwordx4 v33, s[52:55], s72 offen offset:1024 lds
    buffer_load_dwordx4 v34, s[52:55], s72 offen offset:2048 lds
    s_waitcnt vmcnt(55)
    buffer_load_dwordx4 v35, s[52:55], s72 offen offset:3072 lds
    s_mov_b32 m0, 20480
    s_nop 0
    buffer_load_dwordx4 v32, s[56:59], s72 offen lds
    buffer_load_dwordx4 v33, s[56:59], s72 offen offset:1024 lds
    buffer_load_dwordx4 v34, s[56:59], s72 offen offset:2048 lds
    buffer_load_dwordx4 v35, s[56:59], s72 offen offset:3072 lds
    s_waitcnt vmcnt(38) lgkmcnt(0)
    s_barrier
    s_lshr_b64 s[80:81], s[80:81], 4
    s_and_b32 s79, s80, 15
    s_add_u32 s79, s79, s43
    s_sub_u32 s38, s79, 10
    s_cmp_ge_u32 s79, 10
    s_cselect_b32 s79, s38, s79
    s_mul_i32 s73, s79, 245760
    s_lshl_b32 s78, s79, 7
    s_mov_b32 m0, 63616
    s_nop 0
    buffer_load_dwordx4 v36, s[44:47], s78 offen lds
    buffer_load_dwordx4 v37, s[44:47], s78 offen offset:1024 lds
    buffer_load_dwordx4 v38, s[44:47], s78 offen offset:2048 lds
    buffer_load_dwordx4 v39, s[44:47], s78 offen offset:3072 lds
    s_mov_b32 m0, 39040
    s_nop 0
    buffer_load_dwordx4 v28, s[48:51], s73 offen lds
    buffer_load_dwordx4 v29, s[48:51], s73 offen offset:1024 lds
    buffer_load_dwordx4 v30, s[48:51], s73 offen offset:2048 lds
    buffer_load_dwordx4 v31, s[48:51], s73 offen offset:3072 lds
    s_mov_b32 m0, 67712
    s_nop 0
    buffer_load_dwordx4 v40, s[44:47], s78 offen lds
    buffer_load_dwordx4 v41, s[44:47], s78 offen offset:1024 lds
    buffer_load_dwordx4 v42, s[44:47], s78 offen offset:2048 lds
    buffer_load_dwordx4 v43, s[44:47], s78 offen offset:3072 lds
    s_mov_b32 m0, 47232
    s_nop 0
    buffer_load_dwordx4 v28, s[52:55], s73 offen lds
    buffer_load_dwordx4 v29, s[52:55], s73 offen offset:1024 lds
    buffer_load_dwordx4 v30, s[52:55], s73 offen offset:2048 lds
    buffer_load_dwordx4 v31, s[52:55], s73 offen offset:3072 lds
    s_mov_b32 m0, 71808
    s_nop 0
    buffer_load_dwordx4 v44, s[44:47], s78 offen lds
    buffer_load_dwordx4 v45, s[44:47], s78 offen offset:1024 lds
    buffer_load_dwordx4 v46, s[44:47], s78 offen offset:2048 lds
    buffer_load_dwordx4 v47, s[44:47], s78 offen offset:3072 lds
    s_mov_b32 m0, 55424
    s_nop 0
    buffer_load_dwordx4 v28, s[56:59], s73 offen lds
    buffer_load_dwordx4 v29, s[56:59], s73 offen offset:1024 lds
    buffer_load_dwordx4 v30, s[56:59], s73 offen offset:2048 lds
    buffer_load_dwordx4 v31, s[56:59], s73 offen offset:3072 lds
    s_mov_b32 m0, 75904
    s_nop 0
    buffer_load_dwordx4 v48, s[44:47], s78 offen lds
    s_waitcnt vmcnt(55)
    buffer_load_dwordx4 v49, s[44:47], s78 offen offset:1024 lds
    s_mov_b32 m0, 43136
    s_nop 0
    buffer_load_dwordx4 v32, s[48:51], s73 offen lds
    buffer_load_dwordx4 v33, s[48:51], s73 offen offset:1024 lds
    buffer_load_dwordx4 v34, s[48:51], s73 offen offset:2048 lds
    buffer_load_dwordx4 v35, s[48:51], s73 offen offset:3072 lds
    s_mov_b32 m0, 51328
    s_nop 0
    buffer_load_dwordx4 v32, s[52:55], s73 offen lds
    buffer_load_dwordx4 v33, s[52:55], s73 offen offset:1024 lds
    buffer_load_dwordx4 v34, s[52:55], s73 offen offset:2048 lds
    s_waitcnt vmcnt(55)
    buffer_load_dwordx4 v35, s[52:55], s73 offen offset:3072 lds
    s_mov_b32 m0, 59520
    s_nop 0
    buffer_load_dwordx4 v32, s[56:59], s73 offen lds
    buffer_load_dwordx4 v33, s[56:59], s73 offen offset:1024 lds
    buffer_load_dwordx4 v34, s[56:59], s73 offen offset:2048 lds
    buffer_load_dwordx4 v35, s[56:59], s73 offen offset:3072 lds
    s_waitcnt vmcnt(38) lgkmcnt(0)
    s_barrier
    s_lshr_b64 s[80:81], s[80:81], 4
    s_and_b32 s79, s80, 15
    s_add_u32 s79, s79, s43
    s_sub_u32 s38, s79, 10
    s_cmp_ge_u32 s79, 10
    s_cselect_b32 s79, s38, s79
    s_mul_i32 s74, s79, 245760
    s_lshl_b32 s78, s79, 7
    s_mov_b32 m0, 102656
    s_nop 0
    buffer_load_dwordx4 v36, s[44:47], s78 offen lds
    buffer_load_dwordx4 v37, s[44:47], s78 offen offset:1024 lds
    buffer_load_dwordx4 v38, s[44:47], s78 offen offset:2048 lds
    buffer_load_dwordx4 v39, s[44:47], s78 offen offset:3072 lds
    s_mov_b32 m0, 78080
    s_nop 0
    buffer_load_dwordx4 v28, s[48:51], s74 offen lds
    buffer_load_dwordx4 v29, s[48:51], s74 offen offset:1024 lds
    buffer_load_dwordx4 v30, s[48:51], s74 offen offset:2048 lds
    buffer_load_dwordx4 v31, s[48:51], s74 offen offset:3072 lds
    s_mov_b32 m0, 106752
    s_nop 0
    buffer_load_dwordx4 v40, s[44:47], s78 offen lds
    buffer_load_dwordx4 v41, s[44:47], s78 offen offset:1024 lds
    buffer_load_dwordx4 v42, s[44:47], s78 offen offset:2048 lds
    buffer_load_dwordx4 v43, s[44:47], s78 offen offset:3072 lds
    s_mov_b32 m0, 86272
    s_nop 0
    buffer_load_dwordx4 v28, s[52:55], s74 offen lds
    buffer_load_dwordx4 v29, s[52:55], s74 offen offset:1024 lds
    buffer_load_dwordx4 v30, s[52:55], s74 offen offset:2048 lds
    buffer_load_dwordx4 v31, s[52:55], s74 offen offset:3072 lds
    s_mov_b32 m0, 110848
    s_nop 0
    buffer_load_dwordx4 v44, s[44:47], s78 offen lds
    buffer_load_dwordx4 v45, s[44:47], s78 offen offset:1024 lds
    buffer_load_dwordx4 v46, s[44:47], s78 offen offset:2048 lds
    buffer_load_dwordx4 v47, s[44:47], s78 offen offset:3072 lds
    s_mov_b32 m0, 82176
    s_nop 0
    buffer_load_dwordx4 v32, s[48:51], s74 offen lds
    buffer_load_dwordx4 v33, s[48:51], s74 offen offset:1024 lds
    buffer_load_dwordx4 v34, s[48:51], s74 offen offset:2048 lds
    buffer_load_dwordx4 v35, s[48:51], s74 offen offset:3072 lds
    s_mov_b32 m0, 114944
    s_nop 0
    buffer_load_dwordx4 v48, s[44:47], s78 offen lds
    s_waitcnt vmcnt(55)
    buffer_load_dwordx4 v49, s[44:47], s78 offen offset:1024 lds
    s_mov_b32 m0, 90368
    s_nop 0
    buffer_load_dwordx4 v32, s[52:55], s74 offen lds
    buffer_load_dwordx4 v33, s[52:55], s74 offen offset:1024 lds
    buffer_load_dwordx4 v34, s[52:55], s74 offen offset:2048 lds
    buffer_load_dwordx4 v35, s[52:55], s74 offen offset:3072 lds
    s_waitcnt vmcnt(30) lgkmcnt(0)
    s_barrier
    s_lshr_b64 s[80:81], s[80:81], 4
    s_and_b32 s79, s80, 15
    s_add_u32 s79, s79, s43
    s_sub_u32 s38, s79, 10
    s_cmp_ge_u32 s79, 10
    s_cselect_b32 s79, s38, s79
    s_mul_i32 s75, s79, 245760
    s_lshl_b32 s78, s79, 7
    s_mov_b32 m0, 141696
    s_nop 0
    buffer_load_dwordx4 v36, s[44:47], s78 offen lds
    buffer_load_dwordx4 v37, s[44:47], s78 offen offset:1024 lds
    buffer_load_dwordx4 v38, s[44:47], s78 offen offset:2048 lds
    buffer_load_dwordx4 v39, s[44:47], s78 offen offset:3072 lds
    s_mov_b32 m0, 117120
    s_nop 0
    buffer_load_dwordx4 v28, s[48:51], s75 offen lds
    buffer_load_dwordx4 v29, s[48:51], s75 offen offset:1024 lds
    buffer_load_dwordx4 v30, s[48:51], s75 offen offset:2048 lds
    buffer_load_dwordx4 v31, s[48:51], s75 offen offset:3072 lds
    s_mov_b32 m0, 145792
    s_nop 0
    buffer_load_dwordx4 v40, s[44:47], s78 offen lds
    buffer_load_dwordx4 v41, s[44:47], s78 offen offset:1024 lds
    buffer_load_dwordx4 v42, s[44:47], s78 offen offset:2048 lds
    buffer_load_dwordx4 v43, s[44:47], s78 offen offset:3072 lds
    s_mov_b32 m0, 125312
    s_nop 0
    buffer_load_dwordx4 v28, s[52:55], s75 offen lds
    buffer_load_dwordx4 v29, s[52:55], s75 offen offset:1024 lds
    buffer_load_dwordx4 v30, s[52:55], s75 offen offset:2048 lds
    buffer_load_dwordx4 v31, s[52:55], s75 offen offset:3072 lds
    s_mov_b32 m0, 149888
    s_nop 0
    buffer_load_dwordx4 v44, s[44:47], s78 offen lds
    buffer_load_dwordx4 v45, s[44:47], s78 offen offset:1024 lds
    buffer_load_dwordx4 v46, s[44:47], s78 offen offset:2048 lds
    buffer_load_dwordx4 v47, s[44:47], s78 offen offset:3072 lds
    s_mov_b32 m0, 121216
    s_nop 0
    buffer_load_dwordx4 v32, s[48:51], s75 offen lds
    buffer_load_dwordx4 v33, s[48:51], s75 offen offset:1024 lds
    buffer_load_dwordx4 v34, s[48:51], s75 offen offset:2048 lds
    buffer_load_dwordx4 v35, s[48:51], s75 offen offset:3072 lds
    s_mov_b32 m0, 153984
    s_nop 0
    buffer_load_dwordx4 v48, s[44:47], s78 offen lds
    buffer_load_dwordx4 v49, s[44:47], s78 offen offset:1024 lds
    s_mov_b32 m0, 129408
    s_nop 0
    buffer_load_dwordx4 v32, s[52:55], s75 offen lds
    buffer_load_dwordx4 v33, s[52:55], s75 offen offset:1024 lds
    buffer_load_dwordx4 v34, s[52:55], s75 offen offset:2048 lds
    buffer_load_dwordx4 v35, s[52:55], s75 offen offset:3072 lds
    s_waitcnt vmcnt(30) lgkmcnt(0)
    s_barrier
    s_lshr_b64 s[80:81], s[80:81], 4
    s_and_b32 s79, s80, 15
    s_add_u32 s79, s79, s43
    s_sub_u32 s38, s79, 10
    s_cmp_ge_u32 s79, 10
    s_cselect_b32 s79, s38, s79
    s_mul_i32 s76, s79, 245760
    s_lshl_b32 s78, s79, 7
    s_mov_b32 m0, 24576
    s_nop 0
    buffer_load_dwordx4 v36, s[44:47], s78 offen lds
    buffer_load_dwordx4 v37, s[44:47], s78 offen offset:1024 lds
    buffer_load_dwordx4 v38, s[44:47], s78 offen offset:2048 lds
    buffer_load_dwordx4 v39, s[44:47], s78 offen offset:3072 lds
    s_mov_b32 m0, 0
    s_nop 0
    buffer_load_dwordx4 v28, s[48:51], s76 offen lds
    buffer_load_dwordx4 v29, s[48:51], s76 offen offset:1024 lds
    buffer_load_dwordx4 v30, s[48:51], s76 offen offset:2048 lds
    buffer_load_dwordx4 v31, s[48:51], s76 offen offset:3072 lds
    s_mov_b32 m0, 28672
    s_nop 0
    buffer_load_dwordx4 v40, s[44:47], s78 offen lds
    buffer_load_dwordx4 v41, s[44:47], s78 offen offset:1024 lds
    buffer_load_dwordx4 v42, s[44:47], s78 offen offset:2048 lds
    buffer_load_dwordx4 v43, s[44:47], s78 offen offset:3072 lds
    s_mov_b32 m0, 8192
    s_nop 0
    buffer_load_dwordx4 v28, s[52:55], s76 offen lds
    buffer_load_dwordx4 v29, s[52:55], s76 offen offset:1024 lds
    buffer_load_dwordx4 v30, s[52:55], s76 offen offset:2048 lds
    buffer_load_dwordx4 v31, s[52:55], s76 offen offset:3072 lds
    s_mov_b32 m0, 32768
    s_nop 0
    buffer_load_dwordx4 v44, s[44:47], s78 offen lds
    buffer_load_dwordx4 v45, s[44:47], s78 offen offset:1024 lds
    buffer_load_dwordx4 v46, s[44:47], s78 offen offset:2048 lds
    buffer_load_dwordx4 v47, s[44:47], s78 offen offset:3072 lds
    s_mov_b32 m0, 4096
    s_nop 0
    buffer_load_dwordx4 v32, s[48:51], s76 offen lds
    buffer_load_dwordx4 v33, s[48:51], s76 offen offset:1024 lds
    buffer_load_dwordx4 v34, s[48:51], s76 offen offset:2048 lds
    buffer_load_dwordx4 v35, s[48:51], s76 offen offset:3072 lds
    s_mov_b32 m0, 36864
    s_nop 0
    buffer_load_dwordx4 v48, s[44:47], s78 offen lds
    buffer_load_dwordx4 v49, s[44:47], s78 offen offset:1024 lds
    s_mov_b32 m0, 12288
    s_nop 0
    buffer_load_dwordx4 v32, s[52:55], s76 offen lds
    buffer_load_dwordx4 v33, s[52:55], s76 offen offset:1024 lds
    buffer_load_dwordx4 v34, s[52:55], s76 offen offset:2048 lds
    buffer_load_dwordx4 v35, s[52:55], s76 offen offset:3072 lds
    s_waitcnt vmcnt(30) lgkmcnt(0)
    s_barrier
    s_lshr_b64 s[80:81], s[80:81], 4
    s_and_b32 s79, s80, 15
    s_add_u32 s79, s79, s43
    s_sub_u32 s38, s79, 10
    s_cmp_ge_u32 s79, 10
    s_cselect_b32 s79, s38, s79
    s_mul_i32 s77, s79, 245760
    s_lshl_b32 s78, s79, 7
    s_mov_b32 m0, 63616
    s_nop 0
    buffer_load_dwordx4 v36, s[44:47], s78 offen lds
    buffer_load_dwordx4 v37, s[44:47], s78 offen offset:1024 lds
    buffer_load_dwordx4 v38, s[44:47], s78 offen offset:2048 lds
    buffer_load_dwordx4 v39, s[44:47], s78 offen offset:3072 lds
    s_mov_b32 m0, 39040
    s_nop 0
    buffer_load_dwordx4 v28, s[48:51], s77 offen lds
    buffer_load_dwordx4 v29, s[48:51], s77 offen offset:1024 lds
    buffer_load_dwordx4 v30, s[48:51], s77 offen offset:2048 lds
    buffer_load_dwordx4 v31, s[48:51], s77 offen offset:3072 lds
    s_mov_b32 m0, 67712
    s_nop 0
    buffer_load_dwordx4 v40, s[44:47], s78 offen lds
    buffer_load_dwordx4 v41, s[44:47], s78 offen offset:1024 lds
    buffer_load_dwordx4 v42, s[44:47], s78 offen offset:2048 lds
    buffer_load_dwordx4 v43, s[44:47], s78 offen offset:3072 lds
    s_mov_b32 m0, 47232
    s_nop 0
    buffer_load_dwordx4 v28, s[52:55], s77 offen lds
    buffer_load_dwordx4 v29, s[52:55], s77 offen offset:1024 lds
    buffer_load_dwordx4 v30, s[52:55], s77 offen offset:2048 lds
    buffer_load_dwordx4 v31, s[52:55], s77 offen offset:3072 lds
    s_mov_b32 m0, 71808
    s_nop 0
    buffer_load_dwordx4 v44, s[44:47], s78 offen lds
    buffer_load_dwordx4 v45, s[44:47], s78 offen offset:1024 lds
    buffer_load_dwordx4 v46, s[44:47], s78 offen offset:2048 lds
    buffer_load_dwordx4 v47, s[44:47], s78 offen offset:3072 lds
    s_mov_b32 m0, 43136
    s_nop 0
    buffer_load_dwordx4 v32, s[48:51], s77 offen lds
    buffer_load_dwordx4 v33, s[48:51], s77 offen offset:1024 lds
    buffer_load_dwordx4 v34, s[48:51], s77 offen offset:2048 lds
    buffer_load_dwordx4 v35, s[48:51], s77 offen offset:3072 lds
    s_mov_b32 m0, 75904
    s_nop 0
    buffer_load_dwordx4 v48, s[44:47], s78 offen lds
    buffer_load_dwordx4 v49, s[44:47], s78 offen offset:1024 lds
    s_mov_b32 m0, 51328
    s_nop 0
    buffer_load_dwordx4 v32, s[52:55], s77 offen lds
    buffer_load_dwordx4 v33, s[52:55], s77 offen offset:1024 lds
    buffer_load_dwordx4 v34, s[52:55], s77 offen offset:2048 lds
    buffer_load_dwordx4 v35, s[52:55], s77 offen offset:3072 lds
    s_waitcnt vmcnt(30) lgkmcnt(0)
    s_barrier
    s_lshr_b64 s[80:81], s[80:81], 4
    s_and_b32 s79, s80, 15
    s_add_u32 s79, s79, s43
    s_sub_u32 s38, s79, 10
    s_cmp_ge_u32 s79, 10
    s_cselect_b32 s79, s38, s79
    s_mov_b32 m0, 94464
    s_nop 0
    buffer_load_dwordx4 v28, s[56:59], s74 offen lds
    buffer_load_dwordx4 v29, s[56:59], s74 offen offset:1024 lds
    buffer_load_dwordx4 v30, s[56:59], s74 offen offset:2048 lds
    buffer_load_dwordx4 v31, s[56:59], s74 offen offset:3072 lds
    s_mov_b32 m0, 98560
    s_nop 0
    buffer_load_dwordx4 v32, s[56:59], s74 offen lds
    buffer_load_dwordx4 v33, s[56:59], s74 offen offset:1024 lds
    buffer_load_dwordx4 v34, s[56:59], s74 offen offset:2048 lds
    buffer_load_dwordx4 v35, s[56:59], s74 offen offset:3072 lds
    s_mov_b32 m0, 133504
    s_nop 0
    buffer_load_dwordx4 v28, s[56:59], s75 offen lds
    buffer_load_dwordx4 v29, s[56:59], s75 offen offset:1024 lds
    buffer_load_dwordx4 v30, s[56:59], s75 offen offset:2048 lds
    buffer_load_dwordx4 v31, s[56:59], s75 offen offset:3072 lds
    s_waitcnt vmcnt(12) lgkmcnt(0)
    s_barrier
    s_mov_b32 m0, 137600
    s_nop 0
    buffer_load_dwordx4 v32, s[56:59], s75 offen lds
    buffer_load_dwordx4 v33, s[56:59], s75 offen offset:1024 lds
    buffer_load_dwordx4 v34, s[56:59], s75 offen offset:2048 lds
    buffer_load_dwordx4 v35, s[56:59], s75 offen offset:3072 lds
    s_mov_b32 m0, 16384
    s_nop 0
    buffer_load_dwordx4 v28, s[56:59], s76 offen lds
    buffer_load_dwordx4 v29, s[56:59], s76 offen offset:1024 lds
    buffer_load_dwordx4 v30, s[56:59], s76 offen offset:2048 lds
    buffer_load_dwordx4 v31, s[56:59], s76 offen offset:3072 lds
    s_mov_b32 m0, 20480
    s_nop 0
    buffer_load_dwordx4 v32, s[56:59], s76 offen lds
    buffer_load_dwordx4 v33, s[56:59], s76 offen offset:1024 lds
    buffer_load_dwordx4 v34, s[56:59], s76 offen offset:2048 lds
    buffer_load_dwordx4 v35, s[56:59], s76 offen offset:3072 lds
    s_mov_b32 m0, 55424
    s_nop 0
    buffer_load_dwordx4 v28, s[56:59], s77 offen lds
    buffer_load_dwordx4 v29, s[56:59], s77 offen offset:1024 lds
    buffer_load_dwordx4 v30, s[56:59], s77 offen offset:2048 lds
    buffer_load_dwordx4 v31, s[56:59], s77 offen offset:3072 lds
    s_mov_b32 m0, 59520
    s_nop 0
    buffer_load_dwordx4 v32, s[56:59], s77 offen lds
    buffer_load_dwordx4 v33, s[56:59], s77 offen offset:1024 lds
    buffer_load_dwordx4 v34, s[56:59], s77 offen offset:2048 lds
    buffer_load_dwordx4 v35, s[56:59], s77 offen offset:3072 lds
    s_mov_b32 s10, 20480
    v_lshrrev_b32 v52, 5, v1
    v_lshlrev_b32 v52, 3, v52
    v_add_u32 v56, 8, v52
    v_mul_u32_u24 v52, 3, v52
    v_add_u32 v53, 2, v52
    v_add_u32 v54, 4, v52
    v_add_u32 v55, 6, v52
    v_add_u32 v57, 2, v56
    v_add_u32 v58, 4, v56
    v_add_u32 v59, 6, v56
    v_and_b32 v7, 3, v5
    v_mul_u32_u24 v7, 1280, v7
    v_add_u32 v60, v7, v50
    v_xor_b32 v61, 64, v60
    v_add_u32 v61, 4096, v61
    v_add_u32 v62, 8192, v60
    v_add_u32 v63, 8192, v61
    s_mov_b32 s42, 0
    s_mov_b32 s5, 0xbfe10856
    s_mov_b32 s6, 0xaff80255
    s_mov_b32 s7, 0xabfe4015
    s_mov_b32 s8, 0xaa7fd005
    s_mov_b32 s9, 0x6adfb401
    s_cmp_eq_u32 s42, 1
    s_cselect_b32 s5, 0xabfe4015, s5
    s_cselect_b32 s6, 0xaa7fd005, s6
    s_cselect_b32 s7, 0x6adfb401, s7
    s_cselect_b32 s8, 0xbfe10856, s8
    s_cselect_b32 s9, 0xaff80255, s9
    s_cmp_eq_u32 s42, 2
    s_cselect_b32 s5, 0x6adfb401, s5
    s_cselect_b32 s6, 0xbfe10856, s6
    s_cselect_b32 s7, 0xaff80255, s7
    s_cselect_b32 s8, 0xabfe4015, s8
    s_cselect_b32 s9, 0xaa7fd005, s9
    s_cmp_eq_u32 s42, 3
    s_cselect_b32 s5, 0xaff80255, s5
    s_cselect_b32 s6, 0xabfe4015, s6
    s_cselect_b32 s7, 0xaa7fd005, s7
    s_cselect_b32 s8, 0x6adfb401, s8
    s_cselect_b32 s9, 0xbfe10856, s9
    s_cmp_eq_u32 s42, 4
    s_cselect_b32 s5, 0xaa7fd005, s5
    s_cselect_b32 s6, 0x6adfb401, s6
    s_cselect_b32 s7, 0xbfe10856, s7
    s_cselect_b32 s8, 0xaff80255, s8
    s_cselect_b32 s9, 0xabfe4015, s9
    s_mul_i32 s4, s42, 163840
    s_mov_b32 m0, 0
    s_mov_b32 s4, 0
    v_bfe_u32 v64, s5, v52, 2
    v_mad_u32_u24 v64, v64, s10, v60
    buffer_load_dwordx4 v64, s[60:63], s4 offen lds
    v_bfe_u32 v65, s5, v53, 2
    v_mad_u32_u24 v65, v65, s10, v61
    buffer_load_dwordx4 v65, s[60:63], s4 offen offset:1024 lds
    v_bfe_u32 v64, s5, v54, 2
    v_mad_u32_u24 v64, v64, s10, v62
    buffer_load_dwordx4 v64, s[60:63], s4 offen offset:2048 lds
    v_bfe_u32 v65, s5, v55, 2
    v_mad_u32_u24 v65, v65, s10, v63
    buffer_load_dwordx4 v65, s[60:63], s4 offen offset:3072 lds
    s_mov_b32 m0, 4096
    s_mov_b32 s4, 81920
    v_bfe_u32 v64, s6, v52, 2
    v_mad_u32_u24 v64, v64, s10, v60
    buffer_load_dwordx4 v64, s[60:63], s4 offen lds
    v_bfe_u32 v65, s6, v53, 2
    v_mad_u32_u24 v65, v65, s10, v61
    buffer_load_dwordx4 v65, s[60:63], s4 offen offset:1024 lds
    v_bfe_u32 v64, s6, v54, 2
    v_mad_u32_u24 v64, v64, s10, v62
    buffer_load_dwordx4 v64, s[60:63], s4 offen offset:2048 lds
    v_bfe_u32 v65, s6, v55, 2
    v_mad_u32_u24 v65, v65, s10, v63
    buffer_load_dwordx4 v65, s[60:63], s4 offen offset:3072 lds
    s_mov_b32 m0, 8192
    s_mov_b32 s4, 163840
    v_bfe_u32 v64, s7, v52, 2
    v_mad_u32_u24 v64, v64, s10, v60
    buffer_load_dwordx4 v64, s[60:63], s4 offen lds
    v_bfe_u32 v65, s7, v53, 2
    v_mad_u32_u24 v65, v65, s10, v61
    buffer_load_dwordx4 v65, s[60:63], s4 offen offset:1024 lds
    v_bfe_u32 v64, s7, v54, 2
    v_mad_u32_u24 v64, v64, s10, v62
    buffer_load_dwordx4 v64, s[60:63], s4 offen offset:2048 lds
    v_bfe_u32 v65, s7, v55, 2
    v_mad_u32_u24 v65, v65, s10, v63
    buffer_load_dwordx4 v65, s[60:63], s4 offen offset:3072 lds
    s_mov_b32 m0, 12288
    s_mov_b32 s4, 245760
    v_bfe_u32 v64, s8, v52, 2
    v_mad_u32_u24 v64, v64, s10, v60
    buffer_load_dwordx4 v64, s[60:63], s4 offen lds
    v_bfe_u32 v65, s8, v53, 2
    v_mad_u32_u24 v65, v65, s10, v61
    buffer_load_dwordx4 v65, s[60:63], s4 offen offset:1024 lds
    v_bfe_u32 v64, s8, v54, 2
    v_mad_u32_u24 v64, v64, s10, v62
    buffer_load_dwordx4 v64, s[60:63], s4 offen offset:2048 lds
    v_bfe_u32 v65, s8, v55, 2
    v_mad_u32_u24 v65, v65, s10, v63
    buffer_load_dwordx4 v65, s[60:63], s4 offen offset:3072 lds
    s_waitcnt vmcnt(16)
    v_mov_b32 v5, 157980
    v_mov_b32 v6, 1
    s_mov_b64 exec, 1
    ds_add_u32 v5, v6
    s_mov_b64 exec, -1
    v_mov_b32 v5, 157972
    v_mov_b32 v6, 1
    s_mov_b64 exec, 1
    ds_add_u32 v5, v6
    s_mov_b64 exec, -1
    s_mov_b32 m0, 24576
    s_mov_b32 s4, 327680
    v_bfe_u32 v64, s9, v52, 2
    v_mad_u32_u24 v64, v64, s10, v60
    buffer_load_dwordx4 v64, s[60:63], s4 offen lds
    v_bfe_u32 v65, s9, v53, 2
    v_mad_u32_u24 v65, v65, s10, v61
    buffer_load_dwordx4 v65, s[60:63], s4 offen offset:1024 lds
    v_bfe_u32 v64, s9, v54, 2
    v_mad_u32_u24 v64, v64, s10, v62
    buffer_load_dwordx4 v64, s[60:63], s4 offen offset:2048 lds
    v_bfe_u32 v65, s9, v55, 2
    v_mad_u32_u24 v65, v65, s10, v63
    buffer_load_dwordx4 v65, s[60:63], s4 offen offset:3072 lds
    s_mov_b32 m0, 28672
    s_mov_b32 s4, 409600
    v_bfe_u32 v64, s5, v52, 2
    v_mad_u32_u24 v64, v64, s10, v60
    buffer_load_dwordx4 v64, s[60:63], s4 offen lds
    v_bfe_u32 v65, s5, v53, 2
    v_mad_u32_u24 v65, v65, s10, v61
    buffer_load_dwordx4 v65, s[60:63], s4 offen offset:1024 lds
    v_bfe_u32 v64, s5, v54, 2
    v_mad_u32_u24 v64, v64, s10, v62
    buffer_load_dwordx4 v64, s[60:63], s4 offen offset:2048 lds
    v_bfe_u32 v65, s5, v55, 2
    v_mad_u32_u24 v65, v65, s10, v63
    buffer_load_dwordx4 v65, s[60:63], s4 offen offset:3072 lds
    s_mov_b32 m0, 123136
    s_mov_b32 s4, 491520
    v_bfe_u32 v64, s6, v52, 2
    v_mad_u32_u24 v64, v64, s10, v60
    buffer_load_dwordx4 v64, s[60:63], s4 offen lds
    v_bfe_u32 v65, s6, v53, 2
    v_mad_u32_u24 v65, v65, s10, v61
    buffer_load_dwordx4 v65, s[60:63], s4 offen offset:1024 lds
    v_bfe_u32 v64, s6, v54, 2
    v_mad_u32_u24 v64, v64, s10, v62
    buffer_load_dwordx4 v64, s[60:63], s4 offen offset:2048 lds
    v_bfe_u32 v65, s6, v55, 2
    v_mad_u32_u24 v65, v65, s10, v63
    buffer_load_dwordx4 v65, s[60:63], s4 offen offset:3072 lds
    s_mov_b32 m0, 127232
    s_mov_b32 s4, 573440
    v_bfe_u32 v64, s7, v52, 2
    v_mad_u32_u24 v64, v64, s10, v60
    buffer_load_dwordx4 v64, s[60:63], s4 offen lds
    v_bfe_u32 v65, s7, v53, 2
    v_mad_u32_u24 v65, v65, s10, v61
    buffer_load_dwordx4 v65, s[60:63], s4 offen offset:1024 lds
    v_bfe_u32 v64, s7, v54, 2
    v_mad_u32_u24 v64, v64, s10, v62
    buffer_load_dwordx4 v64, s[60:63], s4 offen offset:2048 lds
    v_bfe_u32 v65, s7, v55, 2
    v_mad_u32_u24 v65, v65, s10, v63
    buffer_load_dwordx4 v65, s[60:63], s4 offen offset:3072 lds
    s_mov_b32 m0, 80000
    s_mov_b32 s4, 655360
    v_bfe_u32 v64, s8, v52, 2
    v_mad_u32_u24 v64, v64, s10, v60
    buffer_load_dwordx4 v64, s[60:63], s4 offen lds
    v_bfe_u32 v65, s8, v53, 2
    v_mad_u32_u24 v65, v65, s10, v61
    buffer_load_dwordx4 v65, s[60:63], s4 offen offset:1024 lds
    v_bfe_u32 v64, s8, v54, 2
    v_mad_u32_u24 v64, v64, s10, v62
    buffer_load_dwordx4 v64, s[60:63], s4 offen offset:2048 lds
    v_bfe_u32 v65, s8, v55, 2
    v_mad_u32_u24 v65, v65, s10, v63
    buffer_load_dwordx4 v65, s[60:63], s4 offen offset:3072 lds
    s_mov_b32 m0, 84096
    s_mov_b32 s4, 737280
    v_bfe_u32 v64, s9, v52, 2
    v_mad_u32_u24 v64, v64, s10, v60
    buffer_load_dwordx4 v64, s[60:63], s4 offen lds
    v_bfe_u32 v65, s9, v53, 2
    v_mad_u32_u24 v65, v65, s10, v61
    buffer_load_dwordx4 v65, s[60:63], s4 offen offset:1024 lds
    v_bfe_u32 v64, s9, v54, 2
    v_mad_u32_u24 v64, v64, s10, v62
    buffer_load_dwordx4 v64, s[60:63], s4 offen offset:2048 lds
    v_bfe_u32 v65, s9, v55, 2
    v_mad_u32_u24 v65, v65, s10, v63
    buffer_load_dwordx4 v65, s[60:63], s4 offen offset:3072 lds
    s_waitcnt vmcnt(0)
    v_mov_b32 v7, 157980
    v_mov_b32 v6, 1
    s_mov_b64 exec, 1
    ds_add_u32 v7, v6
    s_mov_b64 exec, -1
Lcw_7:
    s_sub_u32 s35, s35, 1
    s_cbranch_scc1 Lend
    s_sleep 2
    ds_read_b32 v6, v5
    s_waitcnt lgkmcnt(0)
    v_readfirstlane_b32 s38, v6
    s_nop 0
    s_cmp_lt_u32 s38, 8
    s_cbranch_scc1 Lcw_7
    s_lshl_b32 s36, s32, 7
    s_add_u32 s36, s36, 8257536
    v_mov_b32 v69, s36
    buffer_load_dwordx4 v[70:73], v69, s[28:31], 0 offen sc1
    s_mov_b32 m0, 32768
    s_mov_b32 s4, 0
    v_bfe_u32 v64, s5, v56, 2
    v_mad_u32_u24 v64, v64, s10, v60
    buffer_load_dwordx4 v64, s[60:63], s4 offen lds
    v_bfe_u32 v65, s5, v57, 2
    v_mad_u32_u24 v65, v65, s10, v61
    buffer_load_dwordx4 v65, s[60:63], s4 offen offset:1024 lds
    v_bfe_u32 v64, s5, v58, 2
    v_mad_u32_u24 v64, v64, s10, v62
    buffer_load_dwordx4 v64, s[60:63], s4 offen offset:2048 lds
    v_bfe_u32 v65, s5, v59, 2
    v_mad_u32_u24 v65, v65, s10, v63
    buffer_load_dwordx4 v65, s[60:63], s4 offen offset:3072 lds
    s_mov_b32 m0, 36864
    s_mov_b32 s4, 81920
    v_bfe_u32 v64, s6, v56, 2
    v_mad_u32_u24 v64, v64, s10, v60
    buffer_load_dwordx4 v64, s[60:63], s4 offen lds
    v_bfe_u32 v65, s6, v57, 2
    v_mad_u32_u24 v65, v65, s10, v61
    buffer_load_dwordx4 v65, s[60:63], s4 offen offset:1024 lds
    v_bfe_u32 v64, s6, v58, 2
    v_mad_u32_u24 v64, v64, s10, v62
    buffer_load_dwordx4 v64, s[60:63], s4 offen offset:2048 lds
    v_bfe_u32 v65, s6, v59, 2
    v_mad_u32_u24 v65, v65, s10, v63
    buffer_load_dwordx4 v65, s[60:63], s4 offen offset:3072 lds
    s_mov_b32 m0, 40960
    s_mov_b32 s4, 163840
    v_bfe_u32 v64, s7, v56, 2
    v_mad_u32_u24 v64, v64, s10, v60
    buffer_load_dwordx4 v64, s[60:63], s4 offen lds
    v_bfe_u32 v65, s7, v57, 2
    v_mad_u32_u24 v65, v65, s10, v61
    buffer_load_dwordx4 v65, s[60:63], s4 offen offset:1024 lds
    v_bfe_u32 v64, s7, v58, 2
    v_mad_u32_u24 v64, v64, s10, v62
    buffer_load_dwordx4 v64, s[60:63], s4 offen offset:2048 lds
    v_bfe_u32 v65, s7, v59, 2
    v_mad_u32_u24 v65, v65, s10, v63
    buffer_load_dwordx4 v65, s[60:63], s4 offen offset:3072 lds
    s_mov_b32 m0, 45056
    s_mov_b32 s4, 245760
    v_bfe_u32 v64, s8, v56, 2
    v_mad_u32_u24 v64, v64, s10, v60
    buffer_load_dwordx4 v64, s[60:63], s4 offen lds
    v_bfe_u32 v65, s8, v57, 2
    v_mad_u32_u24 v65, v65, s10, v61
    buffer_load_dwordx4 v65, s[60:63], s4 offen offset:1024 lds
    v_bfe_u32 v64, s8, v58, 2
    v_mad_u32_u24 v64, v64, s10, v62
    buffer_load_dwordx4 v64, s[60:63], s4 offen offset:2048 lds
    v_bfe_u32 v65, s8, v59, 2
    v_mad_u32_u24 v65, v65, s10, v63
    buffer_load_dwordx4 v65, s[60:63], s4 offen offset:3072 lds
    s_mov_b32 m0, 63616
    s_mov_b32 s4, 327680
    v_bfe_u32 v64, s9, v56, 2
    v_mad_u32_u24 v64, v64, s10, v60
    buffer_load_dwordx4 v64, s[60:63], s4 offen lds
    v_bfe_u32 v65, s9, v57, 2
    v_mad_u32_u24 v65, v65, s10, v61
    buffer_load_dwordx4 v65, s[60:63], s4 offen offset:1024 lds
    v_bfe_u32 v64, s9, v58, 2
    v_mad_u32_u24 v64, v64, s10, v62
    buffer_load_dwordx4 v64, s[60:63], s4 offen offset:2048 lds
    v_bfe_u32 v65, s9, v59, 2
    v_mad_u32_u24 v65, v65, s10, v63
    buffer_load_dwordx4 v65, s[60:63], s4 offen offset:3072 lds
    s_mov_b32 m0, 67712
    s_mov_b32 s4, 409600
    v_bfe_u32 v64, s5, v56, 2
    v_mad_u32_u24 v64, v64, s10, v60
    buffer_load_dwordx4 v64, s[60:63], s4 offen lds
    v_bfe_u32 v65, s5, v57, 2
    v_mad_u32_u24 v65, v65, s10, v61
    buffer_load_dwordx4 v65, s[60:63], s4 offen offset:1024 lds
    v_bfe_u32 v64, s5, v58, 2
    v_mad_u32_u24 v64, v64, s10, v62
    buffer_load_dwordx4 v64, s[60:63], s4 offen offset:2048 lds
    v_bfe_u32 v65, s5, v59, 2
    v_mad_u32_u24 v65, v65, s10, v63
    buffer_load_dwordx4 v65, s[60:63], s4 offen offset:3072 lds
    s_mov_b32 m0, 71808
    s_mov_b32 s4, 491520
    v_bfe_u32 v64, s6, v56, 2
    v_mad_u32_u24 v64, v64, s10, v60
    buffer_load_dwordx4 v64, s[60:63], s4 offen lds
    v_bfe_u32 v65, s6, v57, 2
    v_mad_u32_u24 v65, v65, s10, v61
    buffer_load_dwordx4 v65, s[60:63], s4 offen offset:1024 lds
    v_bfe_u32 v64, s6, v58, 2
    v_mad_u32_u24 v64, v64, s10, v62
    buffer_load_dwordx4 v64, s[60:63], s4 offen offset:2048 lds
    v_bfe_u32 v65, s6, v59, 2
    v_mad_u32_u24 v65, v65, s10, v63
    buffer_load_dwordx4 v65, s[60:63], s4 offen offset:3072 lds
    s_mov_b32 m0, 75904
    s_mov_b32 s4, 573440
    v_bfe_u32 v64, s7, v56, 2
    v_mad_u32_u24 v64, v64, s10, v60
    buffer_load_dwordx4 v64, s[60:63], s4 offen lds
    v_bfe_u32 v65, s7, v57, 2
    v_mad_u32_u24 v65, v65, s10, v61
    buffer_load_dwordx4 v65, s[60:63], s4 offen offset:1024 lds
    v_bfe_u32 v64, s7, v58, 2
    v_mad_u32_u24 v64, v64, s10, v62
    buffer_load_dwordx4 v64, s[60:63], s4 offen offset:2048 lds
    v_bfe_u32 v65, s7, v59, 2
    v_mad_u32_u24 v65, v65, s10, v63
    buffer_load_dwordx4 v65, s[60:63], s4 offen offset:3072 lds
    s_mov_b32 m0, 49152
    s_mov_b32 s4, 655360
    v_bfe_u32 v64, s8, v56, 2
    v_mad_u32_u24 v64, v64, s10, v60
    buffer_load_dwordx4 v64, s[60:63], s4 offen lds
    v_bfe_u32 v65, s8, v57, 2
    v_mad_u32_u24 v65, v65, s10, v61
    buffer_load_dwordx4 v65, s[60:63], s4 offen offset:1024 lds
    v_bfe_u32 v64, s8, v58, 2
    v_mad_u32_u24 v64, v64, s10, v62
    buffer_load_dwordx4 v64, s[60:63], s4 offen offset:2048 lds
    v_bfe_u32 v65, s8, v59, 2
    v_mad_u32_u24 v65, v65, s10, v63
    buffer_load_dwordx4 v65, s[60:63], s4 offen offset:3072 lds
    s_mov_b32 m0, 88192
    s_mov_b32 s4, 737280
    v_bfe_u32 v64, s9, v56, 2
    v_mad_u32_u24 v64, v64, s10, v60
    buffer_load_dwordx4 v64, s[60:63], s4 offen lds
    v_bfe_u32 v65, s9, v57, 2
    v_mad_u32_u24 v65, v65, s10, v61
    buffer_load_dwordx4 v65, s[60:63], s4 offen offset:1024 lds
    v_bfe_u32 v64, s9, v58, 2
    v_mad_u32_u24 v64, v64, s10, v62
    buffer_load_dwordx4 v64, s[60:63], s4 offen offset:2048 lds
    v_bfe_u32 v65, s9, v59, 2
    v_mad_u32_u24 v65, v65, s10, v63
    buffer_load_dwordx4 v65, s[60:63], s4 offen offset:3072 lds
    s_waitcnt vmcnt(0)
Lbc:
    v_readfirstlane_b32 s11, v70
    v_readfirstlane_b32 s36, v71
    v_readfirstlane_b32 s12, v72
    v_readfirstlane_b32 s37, v73
    s_cmp_eq_u32 s36, s34
    s_cselect_b32 s37, s37, s36
    s_cmp_eq_u32 s37, s34
    s_cbranch_scc1 Lbc_ok
Lbc_re:
    s_sub_u32 s35, s35, 1
    s_cbranch_scc1 Lend
    buffer_load_dwordx4 v[70:73], v69, s[28:31], 0 offen sc1
    s_waitcnt vmcnt(0)
    s_branch Lbc
Lbc_ok:
    s_mul_i32 s36, s32, 96
    s_and_b32 s13, s11, 0x7ff
    s_sub_u32 s13, 2047, s13
    s_sub_u32 s37, s13, s36
    s_cmp_lt_u32 s37, 96
    s_cselect_b32 s13, s13, -1
    s_and_b32 s14, s12, 0x7ff
    s_sub_u32 s14, 2047, s14
    s_sub_u32 s37, s14, s36
    s_cmp_lt_u32 s37, 96
    s_cselect_b32 s14, s14, -1
    v_mov_b32 v4, s13
    v_mov_b32 v5, s14
    v_mov_b32 v6, 157960
    s_cmp_lg_u32 s3, 0
    s_cbranch_scc1 Lag2
    ds_write_b64 v6, v[4:5]
    s_branch Lw0_done
Lag2:
    s_and_b32 s37, s13, s14
    s_cmp_eq_u32 s37, -1
    s_cbranch_scc1 Lw0_done
    s_max_i32 s36, s13, 0
    s_mul_i32 s36, s36, 1280
    s_lshl_b32 s37, s33, 7
    s_add_u32 s36, s36, s37
    s_add_u32 s36, s36, 4096
    v_lshlrev_b32 v8, 1, v1
    buffer_load_ushort v124, v8, s[44:47], s36 offen
    s_max_i32 s36, s14, 0
    s_mul_i32 s36, s36, 1280
    s_lshl_b32 s37, s33, 7
    s_add_u32 s36, s36, s37
    s_add_u32 s36, s36, 4096
    v_lshlrev_b32 v8, 1, v1
    buffer_load_ushort v125, v8, s[44:47], s36 offen
    v_min_u32 v7, 26, v1
    v_mul_u32_u24 v7, 10240, v7
Ly_poll:
    s_sub_u32 s35, s35, 1
    s_cbranch_scc1 Lend
    s_sleep 4
    s_lshl_b32 s36, s33, 10
    s_add_u32 s36, s36, 7405568
    buffer_load_dword v4, v7, s[28:31], s36 offen offset:1020 sc1
    s_waitcnt vmcnt(0)
    v_cmp_ne_u32 vcc, s34, v4
    s_nop 0
    s_cbranch_vccnz Ly_poll
    buffer_load_dwordx4 v[16:19], v13, s[28:31], s36 offen sc1
    s_add_u32 s36, s36, 10240
    buffer_load_dwordx4 v[20:23], v13, s[28:31], s36 offen sc1
    s_add_u32 s36, s36, 10240
    buffer_load_dwordx4 v[24:27], v13, s[28:31], s36 offen sc1
    s_add_u32 s36, s36, 10240
    buffer_load_dwordx4 v[28:31], v13, s[28:31], s36 offen sc1
    s_add_u32 s36, s36, 10240
    buffer_load_dwordx4 v[32:35], v13, s[28:31], s36 offen sc1
    s_add_u32 s36, s36, 10240
    buffer_load_dwordx4 v[36:39], v13, s[28:31], s36 offen sc1
    s_add_u32 s36, s36, 10240
    buffer_load_dwordx4 v[40:43], v13, s[28:31], s36 offen sc1
    s_add_u32 s36, s36, 10240
    buffer_load_dwordx4 v[44:47], v13, s[28:31], s36 offen sc1
    s_add_u32 s36, s36, 10240
    buffer_load_dwordx4 v[48:51], v13, s[28:31], s36 offen sc1
    s_add_u32 s36, s36, 10240
    buffer_load_dwordx4 v[52:55], v13, s[28:31], s36 offen sc1
    s_add_u32 s36, s36, 10240
    buffer_load_dwordx4 v[56:59], v13, s[28:31], s36 offen sc1
    s_add_u32 s36, s36, 10240
    buffer_load_dwordx4 v[60:63], v13, s[28:31], s36 offen sc1
    s_add_u32 s36, s36, 10240
    buffer_load_dwordx4 v[64:67], v13, s[28:31], s36 offen sc1
    s_add_u32 s36, s36, 10240
    buffer_load_dwordx4 v[68:71], v13, s[28:31], s36 offen sc1
    s_add_u32 s36, s36, 10240
    buffer_load_dwordx4 v[72:75], v13, s[28:31], s36 offen sc1
    s_add_u32 s36, s36, 10240
    buffer_load_dwordx4 v[76:79], v13, s[28:31], s36 offen sc1
    s_add_u32 s36, s36, 10240
    buffer_load_dwordx4 v[80:83], v13, s[28:31], s36 offen sc1
    s_add_u32 s36, s36, 10240
    buffer_load_dwordx4 v[84:87], v13, s[28:31], s36 offen sc1
    s_add_u32 s36, s36, 10240
    buffer_load_dwordx4 v[88:91], v13, s[28:31], s36 offen sc1
    s_add_u32 s36, s36, 10240
    buffer_load_dwordx4 v[92:95], v13, s[28:31], s36 offen sc1
    s_add_u32 s36, s36, 10240
    buffer_load_dwordx4 v[96:99], v13, s[28:31], s36 offen sc1
    s_add_u32 s36, s36, 10240
    buffer_load_dwordx4 v[100:103], v13, s[28:31], s36 offen sc1
    s_add_u32 s36, s36, 10240
    buffer_load_dwordx4 v[104:107], v13, s[28:31], s36 offen sc1
    s_add_u32 s36, s36, 10240
    buffer_load_dwordx4 v[108:111], v13, s[28:31], s36 offen sc1
    s_add_u32 s36, s36, 10240
    buffer_load_dwordx4 v[112:115], v13, s[28:31], s36 offen sc1
    s_add_u32 s36, s36, 10240
    buffer_load_dwordx4 v[116:119], v13, s[28:31], s36 offen sc1
    s_add_u32 s36, s36, 10240
    buffer_load_dwordx4 v[120:123], v13, s[28:31], s36 offen sc1
    s_add_u32 s36, s36, 10240
    s_waitcnt vmcnt(0)
    v_xor_b32 v4, s34, v17
    v_xor_b32 v5, s34, v19
    v_or_b32 v4, v4, v5
    v_xor_b32 v5, s34, v21
    v_or_b32 v4, v4, v5
    v_xor_b32 v5, s34, v23
    v_or_b32 v4, v4, v5
    v_xor_b32 v5, s34, v25
    v_or_b32 v4, v4, v5
    v_xor_b32 v5, s34, v27
    v_or_b32 v4, v4, v5
    v_xor_b32 v5, s34, v29
    v_or_b32 v4, v4, v5
    v_xor_b32 v5, s34, v31
    v_or_b32 v4, v4, v5
    v_xor_b32 v5, s34, v33
    v_or_b32 v4, v4, v5
    v_xor_b32 v5, s34, v35
    v_or_b32 v4, v4, v5
    v_xor_b32 v5, s34, v37
    v_or_b32 v4, v4, v5
    v_xor_b32 v5, s34, v39
    v_or_b32 v4, v4, v5
    v_xor_b32 v5, s34, v41
    v_or_b32 v4, v4, v5
    v_xor_b32 v5, s34, v43
    v_or_b32 v4, v4, v5
    v_xor_b32 v5, s34, v45
    v_or_b32 v4, v4, v5
    v_xor_b32 v5, s34, v47
    v_or_b32 v4, v4, v5
    v_xor_b32 v5, s34, v49
    v_or_b32 v4, v4, v5
    v_xor_b32 v5, s34, v51
    v_or_b32 v4, v4, v5
    v_xor_b32 v5, s34, v53
    v_or_b32 v4, v4, v5
    v_xor_b32 v5, s34, v55
    v_or_b32 v4, v4, v5
    v_xor_b32 v5, s34, v57
    v_or_b32 v4, v4, v5
    v_xor_b32 v5, s34, v59
    v_or_b32 v4, v4, v5
    v_xor_b32 v5, s34, v61
    v_or_b32 v4, v4, v5
    v_xor_b32 v5, s34, v63
    v_or_b32 v4, v4, v5
    v_xor_b32 v5, s34, v65
    v_or_b32 v4, v4, v5
    v_xor_b32 v5, s34, v67
    v_or_b32 v4, v4, v5
    v_xor_b32 v5, s34, v69
    v_or_b32 v4, v4, v5
    v_xor_b32 v5, s34, v71
    v_or_b32 v4, v4, v5
    v_xor_b32 v5, s34, v73
    v_or_b32 v4, v4, v5
    v_xor_b32 v5, s34, v75
    v_or_b32 v4, v4, v5
    v_xor_b32 v5, s34, v77
    v_or_b32 v4, v4, v5
    v_xor_b32 v5, s34, v79
    v_or_b32 v4, v4, v5
    v_xor_b32 v5, s34, v81
    v_or_b32 v4, v4, v5
    v_xor_b32 v5, s34, v83
    v_or_b32 v4, v4, v5
    v_xor_b32 v5, s34, v85
    v_or_b32 v4, v4, v5
    v_xor_b32 v5, s34, v87
    v_or_b32 v4, v4, v5
    v_xor_b32 v5, s34, v89
    v_or_b32 v4, v4, v5
    v_xor_b32 v5, s34, v91
    v_or_b32 v4, v4, v5
    v_xor_b32 v5, s34, v93
    v_or_b32 v4, v4, v5
    v_xor_b32 v5, s34, v95
    v_or_b32 v4, v4, v5
    v_xor_b32 v5, s34, v97
    v_or_b32 v4, v4, v5
    v_xor_b32 v5, s34, v99
    v_or_b32 v4, v4, v5
    v_xor_b32 v5, s34, v101
    v_or_b32 v4, v4, v5
    v_xor_b32 v5, s34, v103
    v_or_b32 v4, v4, v5
    v_xor_b32 v5, s34, v105
    v_or_b32 v4, v4, v5
    v_xor_b32 v5, s34, v107
    v_or_b32 v4, v4, v5
    v_xor_b32 v5, s34, v109
    v_or_b32 v4, v4, v5
    v_xor_b32 v5, s34, v111
    v_or_b32 v4, v4, v5
    v_xor_b32 v5, s34, v113
    v_or_b32 v4, v4, v5
    v_xor_b32 v5, s34, v115
    v_or_b32 v4, v4, v5
    v_xor_b32 v5, s34, v117
    v_or_b32 v4, v4, v5
    v_xor_b32 v5, s34, v119
    v_or_b32 v4, v4, v5
    v_xor_b32 v5, s34, v121
    v_or_b32 v4, v4, v5
    v_xor_b32 v5, s34, v123
    v_or_b32 v4, v4, v5
    v_cmp_ne_u32 vcc, 0, v4
    s_nop 0
    s_cmp_lg_u64 vcc, 0
    s_cbranch_scc1 Ly_poll
    v_add_f32 v16, v16, v20
    v_add_f32 v18, v18, v22
    v_add_f32 v16, v16, v24
    v_add_f32 v18, v18, v26
    v_add_f32 v16, v16, v28
    v_add_f32 v18, v18, v30
    v_add_f32 v16, v16, v32
    v_add_f32 v18, v18, v34
    v_add_f32 v16, v16, v36
    v_add_f32 v18, v18, v38
    v_add_f32 v16, v16, v40
    v_add_f32 v18, v18, v42
    v_add_f32 v16, v16, v44
    v_add_f32 v18, v18, v46
    v_add_f32 v16, v16, v48
    v_add_f32 v18, v18, v50
    v_add_f32 v16, v16, v52
    v_add_f32 v18, v18, v54
    v_add_f32 v16, v16, v56
    v_add_f32 v18, v18, v58
    v_add_f32 v16, v16, v60
    v_add_f32 v18, v18, v62
    v_add_f32 v16, v16, v64
    v_add_f32 v18, v18, v66
    v_add_f32 v16, v16, v68
    v_add_f32 v18, v18, v70
    v_add_f32 v16, v16, v72
    v_add_f32 v18, v18, v74
    v_add_f32 v16, v16, v76
    v_add_f32 v18, v18, v78
    v_add_f32 v16, v16, v80
    v_add_f32 v18, v18, v82
    v_add_f32 v16, v16, v84
    v_add_f32 v18, v18, v86
    v_add_f32 v16, v16, v88
    v_add_f32 v18, v18, v90
    v_add_f32 v16, v16, v92
    v_add_f32 v18, v18, v94
    v_add_f32 v16, v16, v96
    v_add_f32 v18, v18, v98
    v_add_f32 v16, v16, v100
    v_add_f32 v18, v18, v102
    v_add_f32 v16, v16, v104
    v_add_f32 v18, v18, v106
    v_add_f32 v16, v16, v108
    v_add_f32 v18, v18, v110
    v_add_f32 v16, v16, v112
    v_add_f32 v18, v18, v114
    v_add_f32 v16, v16, v116
    v_add_f32 v18, v18, v118
    v_add_f32 v16, v16, v120
    v_add_f32 v18, v18, v122
    s_lshr_b32 s36, s11, 16
    s_cmp_ge_u32 s36, 0x8000
    s_cselect_b32 s37, 0x8000, -1
    s_xor_b32 s36, s36, s37
    s_lshl_b32 s36, s36, 16
    v_mov_b32 v4, s36
    v_mul_f32 v4, 0xbfb8aa3b, v4
    v_exp_f32 v4, v4
    s_nop 0
    v_add_f32 v4, 1.0, v4
    v_rcp_f32 v4, v4
    s_nop 0
    v_cvt_pk_bf16_f32 v4, v4, v4
    v_lshlrev_b32 v4, 16, v4
    v_cvt_pk_bf16_f32 v16, v16, v16
    v_lshlrev_b32 v16, 16, v16
    v_mul_f32 v16, v16, v4
    v_cvt_pk_bf16_f32 v16, v16, v16
    v_lshlrev_b32 v16, 16, v16
    s_lshr_b32 s36, s12, 16
    s_cmp_ge_u32 s36, 0x8000
    s_cselect_b32 s37, 0x8000, -1
    s_xor_b32 s36, s36, s37
    s_lshl_b32 s36, s36, 16
    v_mov_b32 v4, s36
    v_mul_f32 v4, 0xbfb8aa3b, v4
    v_exp_f32 v4, v4
    s_nop 0
    v_add_f32 v4, 1.0, v4
    v_rcp_f32 v4, v4
    s_nop 0
    v_cvt_pk_bf16_f32 v4, v4, v4
    v_lshlrev_b32 v4, 16, v4
    v_cvt_pk_bf16_f32 v18, v18, v18
    v_lshlrev_b32 v18, 16, v18
    v_mul_f32 v18, v18, v4
    v_cvt_pk_bf16_f32 v18, v18, v18
    v_lshlrev_b32 v18, 16, v18
    s_mul_i32 s36, s32, 96
    s_sub_u32 s36, s13, s36
    s_max_i32 s36, s36, 0
    s_lshl_b32 s36, s36, 2
    s_add_u32 s36, s36, 156288
    v_mov_b32 v4, s36
    ds_read2st64_b32 v[4:5], v4 offset0:0 offset1:2
    v_lshlrev_b32 v124, 16, v124
    s_waitcnt lgkmcnt(0)
    v_add_f32 v20, v124, v4
    v_cvt_pk_bf16_f32 v20, v20, v20
    v_lshlrev_b32 v20, 16, v20
    v_mul_f32 v20, v20, v5
    v_cvt_pk_bf16_f32 v20, v20, v20
    v_lshlrev_b32 v20, 16, v20
    v_add_f32 v20, v20, v16
    v_cvt_pk_bf16_f32 v20, v20, v20
    v_lshlrev_b32 v20, 16, v20
    v_mul_f32 v16, 0xbfb8aa3b, v20
    v_exp_f32 v16, v16
    s_nop 0
    v_add_f32 v16, 1.0, v16
    v_rcp_f32 v16, v16
    s_nop 0
    v_mul_f32 v16, v16, v20
    v_cvt_pk_bf16_f32 v16, v16, v16
    v_lshlrev_b32 v16, 16, v16
    s_mul_i32 s36, s32, 96
    s_sub_u32 s36, s14, s36
    s_max_i32 s36, s36, 0
    s_lshl_b32 s36, s36, 2
    s_add_u32 s36, s36, 156288
    v_mov_b32 v4, s36
    ds_read2st64_b32 v[4:5], v4 offset0:0 offset1:2
    v_lshlrev_b32 v125, 16, v125
    s_waitcnt lgkmcnt(0)
    v_add_f32 v22, v125, v4
    v_cvt_pk_bf16_f32 v22, v22, v22
    v_lshlrev_b32 v22, 16, v22
    v_mul_f32 v22, v22, v5
    v_cvt_pk_bf16_f32 v22, v22, v22
    v_lshlrev_b32 v22, 16, v22
    v_add_f32 v22, v22, v18
    v_cvt_pk_bf16_f32 v22, v22, v22
    v_lshlrev_b32 v22, 16, v22
    v_mul_f32 v18, 0xbfb8aa3b, v22
    v_exp_f32 v18, v18
    s_nop 0
    v_add_f32 v18, 1.0, v18
    v_rcp_f32 v18, v18
    s_nop 0
    v_mul_f32 v18, v18, v22
    v_cvt_pk_bf16_f32 v18, v18, v18
    v_lshlrev_b32 v18, 16, v18
    v_add_u32 v5, 158208, v12
    ds_write2st64_b32 v5, v16, v18 offset0:0 offset1:1
    v_mov_b32 v6, 157956
    v_mov_b32 v7, 1
    s_mov_b64 exec, 1
    ds_add_u32 v6, v7
    s_mov_b64 exec, -1
Lw0_done:
    s_endpgm
Lagent:
    s_sub_u32 s44, s4, 4096
    s_subb_u32 s45, s5, 0
    s_mov_b32 s46, 2625536
    s_mov_b32 s47, 0x20000
    s_lshl_b32 s36, s32, 7
    s_add_u32 s36, s36, 8257536
    v_mov_b32 v69, s36
    s_branch Lbc_re
Lcomp:
    s_lshl_b32 s44, s26, 1
    s_add_u32 s44, s44, s27
    s_sub_u32 s36, s33, 5
    s_cmp_ge_u32 s33, 5
    s_cselect_b32 s40, s36, s33
    s_mov_b32 s41, 0xbfe10856
    s_cmp_eq_u32 s40, 1
    s_cselect_b32 s41, 0xaff80255, s41
    s_cmp_eq_u32 s40, 2
    s_cselect_b32 s41, 0xabfe4015, s41
    s_cmp_eq_u32 s40, 3
    s_cselect_b32 s41, 0xaa7fd005, s41
    s_cmp_eq_u32 s40, 4
    s_cselect_b32 s41, 0x6adfb401, s41
    s_lshl_b32 s37, s27, 13
    s_cmp_eq_u32 s44, 1
    s_cselect_b32 s37, 0, s37
    v_bfe_u32 v7, v1, 2, 2
    v_and_b32 v8, 3, v1
    v_lshl_add_u32 v18, v2, 3, v7
    v_lshlrev_b32 v18, 7, v18
    v_lshlrev_b32 v19, 2, v1
    v_and_b32 v19, 0x60, v19
    v_lshlrev_b32 v10, 1, v8
    v_add_u32 v9, s37, v18
    v_add_u32 v11, 0, v10
    v_bfe_u32 v11, s41, v11, 2
    v_lshl_add_u32 v11, v11, 2, v8
    v_lshlrev_b32 v11, 3, v11
    v_xad_u32 v20, v11, v19, v9
    v_add_u32 v11, 8, v10
    v_bfe_u32 v11, s41, v11, 2
    v_lshl_add_u32 v11, v11, 2, v8
    v_lshlrev_b32 v11, 3, v11
    v_xad_u32 v21, v11, v19, v9
    v_add_u32 v11, 16, v10
    v_bfe_u32 v11, s41, v11, 2
    v_lshl_add_u32 v11, v11, 2, v8
    v_lshlrev_b32 v11, 3, v11
    v_xad_u32 v22, v11, v19, v9
    v_add_u32 v11, 24, v10
    v_bfe_u32 v11, s41, v11, 2
    v_lshl_add_u32 v11, v11, 2, v8
    v_lshlrev_b32 v11, 3, v11
    v_xad_u32 v23, v11, v19, v9
    v_add_u32 v24, 78080, v20
    v_add_u32 v25, 78080, v21
    v_add_u32 v26, 78080, v22
    v_add_u32 v27, 78080, v23
    v_lshrrev_b32 v10, 1, v3
    v_xor_b32 v9, v10, v2
    v_lshlrev_b32 v9, 4, v9
    v_lshl_add_u32 v9, v3, 7, v9
    s_lshl_b32 s36, s44, 11
    s_xor_b32 s38, s36, 2048
    s_add_u32 s36, s36, 22528
    s_add_u32 s38, s38, 22528
    v_add_u32 v76, s36, v9
    v_add_u32 v78, s38, v9
    s_mul_i32 s39, s26, 6144
    s_add_u32 s39, s39, 98560
    v_add_u32 v125, s39, v13
    s_lshl_b32 s45, s44, 11
    s_add_u32 s45, s45, 139648
    s_waitcnt lgkmcnt(0)
    s_mov_b64 s[28:29], s[24:25]
    s_mov_b32 s30, 268435456
    s_mov_b32 s31, 0x20000
    s_load_dword s34, s[28:29], 0
    s_cmp_eq_u32 s44, 1
    s_cbranch_scc1 Lhalo
    v_xor_b32 v77, 64, v76
    v_xor_b32 v79, 64, v78
    v_add_u32 v80, 78080, v76
    v_add_u32 v81, 78080, v77
    v_add_u32 v82, 78080, v78
    v_add_u32 v83, 78080, v79
    s_cmp_eq_u32 s27, 0
    s_cselect_b64 vcc, 0, -1
    s_sub_u32 s37, 16384, s37
    v_cndmask_b32 v84, v20, v22, vcc
    v_cndmask_b32 v85, v21, v23, vcc
    v_add_u32 v84, s37, v84
    v_add_u32 v85, s37, v85
    v_add_u32 v86, 78080, v84
    v_add_u32 v87, 78080, v85
    v_lshrrev_b32 v8, 1, v2
    v_xor_b32 v8, v8, v10
    v_lshlrev_b32 v8, 4, v8
    v_lshl_add_u32 v8, v3, 7, v8
    v_and_b32 v7, 1, v2
    v_lshl_add_u32 v124, v7, 3, v8
    s_mov_b32 s46, 0
    s_mov_b32 s38, 0x86542310
    s_mov_b32 s39, 0x97
    s_cmp_eq_u32 s42, 1
    s_cselect_b32 s38, 0x76453210, s38
    s_cselect_b32 s39, 0x98, s39
    s_cmp_eq_u32 s42, 2
    s_cselect_b32 s38, 0x67543120, s38
    s_cselect_b32 s39, 0x98, s39
    s_cmp_eq_u32 s42, 3
    s_cselect_b32 s38, 0x76534201, s38
    s_cselect_b32 s39, 0x89, s39
    s_cmp_eq_u32 s42, 4
    s_cselect_b32 s38, 0x75643201, s38
    s_cselect_b32 s39, 0x98, s39
    s_sub_u32 s42, s33, s43
    s_cselect_b32 s43, 10, 0
    s_add_u32 s42, s42, s43
    s_lshl_b32 s42, s42, 2
    s_lshr_b64 s[38:39], s[38:39], s42
    s_and_b32 s42, s38, 15
    s_and_b32 s38, s42, 3
    s_mul_i32 s38, s38, 39040
    s_add_u32 s38, s38, s36
    v_add_u32 v4, s38, v124
    v_xor_b32 v5, 32, v4
    v_xor_b32 v6, 64, v4
    v_xor_b32 v7, 0x60, v4
    s_mov_b64 s[48:49], s[20:21]
    s_mov_b32 s50, 2621440
    s_mov_b32 s51, 0x20000
    v_mov_b32 v14, 0x3f803f80
    v_mov_b32 v15, 0x3f803f80
    v_mov_b32 v16, 0x3f803f80
    v_mov_b32 v17, 0x3f803f80
    s_mov_b32 s4, 0xaae00455
    s_cmp_eq_u32 s40, 1
    s_cselect_b32 s4, 0xaaf80155, s4
    s_cmp_eq_u32 s40, 2
    s_cselect_b32 s4, 0xaafe4055, s4
    s_cmp_eq_u32 s40, 3
    s_cselect_b32 s4, 0xaabfd055, s4
    s_cmp_eq_u32 s40, 4
    s_cselect_b32 s4, 0xaaeff455, s4
    v_lshlrev_b32 v10, 1, v2
    v_add_u32 v10, 8, v10
    v_bfe_u32 v10, s4, v10, 2
    v_cmp_eq_u32 s[6:7], 0, v10
    v_cmp_eq_u32 s[8:9], 3, v10
    v_cmp_eq_u32 s[10:11], 1, v10
    v_lshlrev_b32 v10, 1, v2
    v_add_u32 v10, 16, v10
    v_bfe_u32 v10, s4, v10, 2
    v_cmp_eq_u32 s[12:13], 0, v10
    v_cmp_eq_u32 s[14:15], 3, v10
    v_cmp_eq_u32 s[16:17], 2, v10
    s_mov_b32 s4, 0xaaaaaaaa
    s_mov_b32 s5, 0xaaaaaaaa
    s_mov_b32 s18, 0xfff0ffff
    s_mov_b32 s19, 0xf000ff00
    s_mov_b32 s20, 0xffc0fffc
    s_mov_b32 s21, 0xc000fc00
    v_mov_b32 v8, 0xffff
    v_not_b32 v9, v8
    v_cndmask_b32 v8, v8, v9, s[4:5]
    v_cndmask_b32 v118, 0, v8, s[18:19]
    v_cndmask_b32 v119, 0, v8, s[20:21]
    v_xor_b32 v116, v118, v8
    v_xor_b32 v117, v119, v8
    s_cmp_eq_u32 s32, 0
    s_cselect_b32 s36, s44, 0
    s_cmp_eq_u32 s36, 2
    s_cselect_b32 s22, 0xff800000, 0
    s_mul_i32 s36, s32, 6
    s_add_u32 s36, s36, s44
    s_sub_u32 s36, s36, 2
    s_lshl_b32 s24, s36, 7
    s_add_u32 s24, s24, 7340032
    s_mul_i32 s52, s36, 20480
    s_add_u32 s52, s52, 4194304
    s_lshl_b32 s36, s33, 11
    s_add_u32 s23, s36, s52
    s_add_u32 s53, s52, s46
    s_add_u32 s46, s46, 4096
    s_cmp_eq_u32 s46, 20480
    s_cselect_b32 s46, 0, s46
    s_add_u32 s54, s52, s46
    s_add_u32 s46, s46, 4096
    s_cmp_eq_u32 s46, 20480
    s_cselect_b32 s46, 0, s46
    s_add_u32 s55, s52, s46
    s_add_u32 s46, s46, 4096
    s_cmp_eq_u32 s46, 20480
    s_cselect_b32 s46, 0, s46
    s_add_u32 s56, s52, s46
    s_add_u32 s46, s46, 4096
    s_cmp_eq_u32 s46, 20480
    s_cselect_b32 s46, 0, s46
    s_add_u32 s57, s52, s46
    s_add_u32 s46, s46, 4096
    s_cmp_eq_u32 s46, 20480
    s_cselect_b32 s46, 0, s46
    s_mul_i32 s36, s32, 10
    s_add_u32 s36, s36, s33
    s_mul_i32 s58, s36, 6144
    s_lshl_b32 s36, s44, 10
    s_add_u32 s58, s58, s36
    s_add_u32 s58, s58, 1046528
    s_sub_u32 s59, s58, 6144
    s_add_u32 s60, s58, 6144
    s_cmp_eq_u32 s40, 0
    s_cselect_b32 s61, 0, -1
    s_cmp_eq_u32 s40, 4
    s_cselect_b32 s62, 0, -1
    s_lshl_b32 s36, s33, 2
    v_mov_b32 v97, s36
    s_mov_b32 s25, 0x3ea52b5c
    s_lshl_b32 s36, s44, 6
    s_add_u32 s36, s36, 156160
    v_lshl_add_u32 v94, v3, 2, s36
    v_and_b32 v8, 1, v1
    v_lshl_add_u32 v8, v2, 2, v8
    v_lshl_add_u32 v8, v8, 2, s36
    v_subrev_u32 v9, 64, v8
    v_cndmask_b32 v92, v9, v8, s[18:19]
    v_cndmask_b32 v93, v9, v8, s[20:21]
    v_lshlrev_b32 v95, 4, v2
    s_lshl_b32 s36, s27, 8
    s_add_u32 s36, s36, 157184
    v_add_u32 v95, s36, v95
    v_mov_b32 v96, 157968
    s_lshl_b32 s36, s27, 11
    v_add_u32 v99, s36, v125
    v_mov_b32 v100, -1
    v_mov_b32 v101, -1
    v_mov_b32 v102, -1
    v_mov_b32 v103, -1
    v_mov_b32 v127, 157984
    s_lshl_b32 s36, s3, 2
    s_add_u32 s36, s36, 158016
    v_mov_b32 v10, s36
    v_xor_b32 v11, 16, v10
    v_cndmask_b32 v127, v127, v11, s[4:5]
    s_waitcnt vmcnt(0)
    s_waitcnt lgkmcnt(0)
    s_barrier
    ds_read_b128 a[96:99], v76 offset:0
    ds_read_b128 a[100:103], v78 offset:0
    ds_read_b64_tr_b16 a[64:65], v20 offset:0
    ds_read_b64_tr_b16 a[66:67], v20 offset:512
    ds_read_b64_tr_b16 a[68:69], v21 offset:0
    ds_read_b64_tr_b16 a[70:71], v21 offset:512
    ds_read_b64_tr_b16 a[72:73], v22 offset:0
    ds_read_b64_tr_b16 a[74:75], v22 offset:512
    ds_read_b64_tr_b16 a[76:77], v23 offset:0
    ds_read_b64_tr_b16 a[78:79], v23 offset:512
    ds_read_b64_tr_b16 a[112:113], v84 offset:0
    ds_read_b64_tr_b16 a[114:115], v84 offset:512
    ds_read_b64_tr_b16 a[116:117], v85 offset:0
    ds_read_b64_tr_b16 a[118:119], v85 offset:512
    s_add_u32 s34, s34, 0x9e3779b8
    s_or_b32 s34, s34, 1
    s_cmp_eq_u32 s42, 0
    s_cbranch_scc1 Lxe0
Lxe0_b:
    s_setprio 1
    s_waitcnt lgkmcnt(10)
    v_mfma_f32_16x16x32_bf16 v[28:31], a[64:67], a[96:99], 0
    ds_read_b128 a[104:107], v77 offset:0
    ds_read_b128 a[108:111], v79 offset:0
    v_mfma_f32_16x16x32_bf16 v[44:47], a[64:67], a[100:103], 0
    ds_read_b64_tr_b16 a[80:81], v20 offset:4096
    s_waitcnt lgkmcnt(11)
    v_mfma_f32_16x16x32_bf16 v[48:51], a[68:71], a[100:103], 0
    ds_read_b64_tr_b16 a[82:83], v20 offset:4608
    v_mfma_f32_16x16x32_bf16 v[32:35], a[68:71], a[96:99], 0
    ds_read_b64_tr_b16 a[84:85], v21 offset:4096
    s_waitcnt lgkmcnt(11)
    v_mfma_f32_16x16x32_bf16 v[36:39], a[72:75], a[96:99], 0
    ds_read_b64_tr_b16 a[86:87], v21 offset:4608
    ds_read_b64_tr_b16 a[88:89], v22 offset:4096
    v_mfma_f32_16x16x32_bf16 v[52:55], a[72:75], a[100:103], 0
    ds_read_b64_tr_b16 a[90:91], v22 offset:4608
    s_setprio 0
    s_waitcnt lgkmcnt(12)
    v_mfma_f32_16x16x32_bf16 v[56:59], a[76:79], a[100:103], 0
    ds_read_b64_tr_b16 a[92:93], v23 offset:4096
    v_mfma_f32_16x16x32_bf16 v[40:43], a[76:79], a[96:99], 0
    ds_read_b64_tr_b16 a[94:95], v23 offset:4608
    s_waitcnt lgkmcnt(12)
    v_mfma_f32_16x16x32_bf16 v[60:63], a[96:99], a[112:115], 0
    ds_read_b64_tr_b16 a[120:121], v84 offset:4096
    v_mfma_f32_16x16x32_bf16 v[68:71], a[100:103], a[112:115], 0
    ds_read_b64_tr_b16 a[122:123], v84 offset:4608
    s_waitcnt lgkmcnt(12)
    v_mfma_f32_16x16x32_bf16 v[72:75], a[100:103], a[116:119], 0
    ds_read_b64_tr_b16 a[124:125], v85 offset:4096
    v_mfma_f32_16x16x32_bf16 v[64:67], a[96:99], a[116:119], 0
    ds_read_b64_tr_b16 a[126:127], v85 offset:4608
    s_barrier
    s_setprio 3
    s_waitcnt lgkmcnt(10)
    v_mfma_f32_16x16x32_bf16 v[28:31], a[80:83], a[104:107], v[28:31]
    ds_read_b128 a[96:99], v76 offset:39040
    ds_read_b128 a[100:103], v78 offset:39040
    v_mfma_f32_16x16x32_bf16 v[44:47], a[80:83], a[108:111], v[44:47]
    ds_read_b64_tr_b16 a[64:65], v20 offset:39040
    s_waitcnt lgkmcnt(11)
    v_mfma_f32_16x16x32_bf16 v[48:51], a[84:87], a[108:111], v[48:51]
    ds_read_b64_tr_b16 a[66:67], v20 offset:39552
    v_mfma_f32_16x16x32_bf16 v[32:35], a[84:87], a[104:107], v[32:35]
    ds_read_b64_tr_b16 a[68:69], v21 offset:39040
    s_waitcnt lgkmcnt(11)
    v_mfma_f32_16x16x32_bf16 v[36:39], a[88:91], a[104:107], v[36:39]
    ds_read_b64_tr_b16 a[70:71], v21 offset:39552
    v_mfma_f32_16x16x32_bf16 v[52:55], a[88:91], a[108:111], v[52:55]
    ds_read_b64_tr_b16 a[72:73], v22 offset:39040
    s_setprio 2
    s_waitcnt lgkmcnt(11)
    v_mfma_f32_16x16x32_bf16 v[56:59], a[92:95], a[108:111], v[56:59]
    ds_read_b64_tr_b16 a[74:75], v22 offset:39552
    ds_read_b64_tr_b16 a[76:77], v23 offset:39040
    v_mfma_f32_16x16x32_bf16 v[40:43], a[92:95], a[104:107], v[40:43]
    ds_read_b64_tr_b16 a[78:79], v23 offset:39552
    s_waitcnt lgkmcnt(12)
    v_mfma_f32_16x16x32_bf16 v[60:63], a[104:107], a[120:123], v[60:63]
    ds_read_b64_tr_b16 a[112:113], v84 offset:39040
    v_mfma_f32_16x16x32_bf16 v[68:71], a[108:111], a[120:123], v[68:71]
    ds_read_b64_tr_b16 a[114:115], v84 offset:39552
    s_waitcnt lgkmcnt(12)
    v_mfma_f32_16x16x32_bf16 v[72:75], a[108:111], a[124:127], v[72:75]
    ds_read_b64_tr_b16 a[116:117], v85 offset:39040
    v_mfma_f32_16x16x32_bf16 v[64:67], a[104:107], a[124:127], v[64:67]
    ds_read_b64_tr_b16 a[118:119], v85 offset:39552
    s_cmp_eq_u32 s42, 1
    s_cbranch_scc1 Lxe1
Lxe1_b:
    s_setprio 1
    s_waitcnt lgkmcnt(10)
    v_mfma_f32_16x16x32_bf16 v[28:31], a[64:67], a[96:99], v[28:31]
    ds_read_b128 a[104:107], v77 offset:39040
    ds_read_b128 a[108:111], v79 offset:39040
    v_mfma_f32_16x16x32_bf16 v[44:47], a[64:67], a[100:103], v[44:47]
    ds_read_b64_tr_b16 a[80:81], v20 offset:43136
    s_waitcnt lgkmcnt(11)
    v_mfma_f32_16x16x32_bf16 v[48:51], a[68:71], a[100:103], v[48:51]
    ds_read_b64_tr_b16 a[82:83], v20 offset:43648
    v_mfma_f32_16x16x32_bf16 v[32:35], a[68:71], a[96:99], v[32:35]
    ds_read_b64_tr_b16 a[84:85], v21 offset:43136
    s_waitcnt lgkmcnt(11)
    v_mfma_f32_16x16x32_bf16 v[36:39], a[72:75], a[96:99], v[36:39]
    ds_read_b64_tr_b16 a[86:87], v21 offset:43648
    ds_read_b64_tr_b16 a[88:89], v22 offset:43136
    v_mfma_f32_16x16x32_bf16 v[52:55], a[72:75], a[100:103], v[52:55]
    ds_read_b64_tr_b16 a[90:91], v22 offset:43648
    s_setprio 0
    s_waitcnt lgkmcnt(12)
    v_mfma_f32_16x16x32_bf16 v[56:59], a[76:79], a[100:103], v[56:59]
    ds_read_b64_tr_b16 a[92:93], v23 offset:43136
    v_mfma_f32_16x16x32_bf16 v[40:43], a[76:79], a[96:99], v[40:43]
    ds_read_b64_tr_b16 a[94:95], v23 offset:43648
    s_waitcnt lgkmcnt(12)
    v_mfma_f32_16x16x32_bf16 v[60:63], a[96:99], a[112:115], v[60:63]
    ds_read_b64_tr_b16 a[120:121], v84 offset:43136
    v_mfma_f32_16x16x32_bf16 v[68:71], a[100:103], a[112:115], v[68:71]
    ds_read_b64_tr_b16 a[122:123], v84 offset:43648
    s_waitcnt lgkmcnt(12)
    v_mfma_f32_16x16x32_bf16 v[72:75], a[100:103], a[116:119], v[72:75]
    ds_read_b64_tr_b16 a[124:125], v85 offset:43136
    v_mfma_f32_16x16x32_bf16 v[64:67], a[96:99], a[116:119], v[64:67]
    ds_read_b64_tr_b16 a[126:127], v85 offset:43648
    s_barrier
    s_setprio 3
    s_waitcnt lgkmcnt(10)
    v_mfma_f32_16x16x32_bf16 v[28:31], a[80:83], a[104:107], v[28:31]
    ds_read_b128 a[96:99], v80 offset:0
    ds_read_b128 a[100:103], v82 offset:0
    v_mfma_f32_16x16x32_bf16 v[44:47], a[80:83], a[108:111], v[44:47]
    ds_read_b64_tr_b16 a[64:65], v24 offset:0
    s_waitcnt lgkmcnt(11)
    v_mfma_f32_16x16x32_bf16 v[48:51], a[84:87], a[108:111], v[48:51]
    ds_read_b64_tr_b16 a[66:67], v24 offset:512
    v_mfma_f32_16x16x32_bf16 v[32:35], a[84:87], a[104:107], v[32:35]
    ds_read_b64_tr_b16 a[68:69], v25 offset:0
    s_waitcnt lgkmcnt(11)
    v_mfma_f32_16x16x32_bf16 v[36:39], a[88:91], a[104:107], v[36:39]
    ds_read_b64_tr_b16 a[70:71], v25 offset:512
    v_mfma_f32_16x16x32_bf16 v[52:55], a[88:91], a[108:111], v[52:55]
    ds_read_b64_tr_b16 a[72:73], v26 offset:0
    s_setprio 2
    s_waitcnt lgkmcnt(11)
    v_mfma_f32_16x16x32_bf16 v[56:59], a[92:95], a[108:111], v[56:59]
    ds_read_b64_tr_b16 a[74:75], v26 offset:512
    ds_read_b64_tr_b16 a[76:77], v27 offset:0
    v_mfma_f32_16x16x32_bf16 v[40:43], a[92:95], a[104:107], v[40:43]
    ds_read_b64_tr_b16 a[78:79], v27 offset:512
    s_waitcnt lgkmcnt(12)
    v_mfma_f32_16x16x32_bf16 v[60:63], a[104:107], a[120:123], v[60:63]
    ds_read_b64_tr_b16 a[112:113], v86 offset:0
    v_mfma_f32_16x16x32_bf16 v[68:71], a[108:111], a[120:123], v[68:71]
    ds_read_b64_tr_b16 a[114:115], v86 offset:512
    s_waitcnt lgkmcnt(12)
    v_mfma_f32_16x16x32_bf16 v[72:75], a[108:111], a[124:127], v[72:75]
    ds_read_b64_tr_b16 a[116:117], v87 offset:0
    v_mfma_f32_16x16x32_bf16 v[64:67], a[104:107], a[124:127], v[64:67]
    ds_read_b64_tr_b16 a[118:119], v87 offset:512
    buffer_store_dwordx4 v[100:103], v13, s[28:31], s58 offen sc1
    s_cmp_eq_u32 s42, 2
    s_cbranch_scc1 Lxe2
Lxe2_b:
    s_setprio 1
    s_waitcnt lgkmcnt(10)
    v_mfma_f32_16x16x32_bf16 v[28:31], a[64:67], a[96:99], v[28:31]
    ds_read_b128 a[104:107], v81 offset:0
    ds_read_b128 a[108:111], v83 offset:0
    v_mfma_f32_16x16x32_bf16 v[44:47], a[64:67], a[100:103], v[44:47]
    ds_read_b64_tr_b16 a[80:81], v24 offset:4096
    s_waitcnt lgkmcnt(11)
    v_mfma_f32_16x16x32_bf16 v[48:51], a[68:71], a[100:103], v[48:51]
    ds_read_b64_tr_b16 a[82:83], v24 offset:4608
    v_mfma_f32_16x16x32_bf16 v[32:35], a[68:71], a[96:99], v[32:35]
    ds_read_b64_tr_b16 a[84:85], v25 offset:4096
    s_waitcnt lgkmcnt(11)
    v_mfma_f32_16x16x32_bf16 v[36:39], a[72:75], a[96:99], v[36:39]
    ds_read_b64_tr_b16 a[86:87], v25 offset:4608
    ds_read_b64_tr_b16 a[88:89], v26 offset:4096
    v_mfma_f32_16x16x32_bf16 v[52:55], a[72:75], a[100:103], v[52:55]
    ds_read_b64_tr_b16 a[90:91], v26 offset:4608
    s_setprio 0
    s_waitcnt lgkmcnt(12)
    v_mfma_f32_16x16x32_bf16 v[56:59], a[76:79], a[100:103], v[56:59]
    ds_read_b64_tr_b16 a[92:93], v27 offset:4096
    v_mfma_f32_16x16x32_bf16 v[40:43], a[76:79], a[96:99], v[40:43]
    ds_read_b64_tr_b16 a[94:95], v27 offset:4608
    s_waitcnt lgkmcnt(12)
    v_mfma_f32_16x16x32_bf16 v[60:63], a[96:99], a[112:115], v[60:63]
    ds_read_b64_tr_b16 a[120:121], v86 offset:4096
    v_mfma_f32_16x16x32_bf16 v[68:71], a[100:103], a[112:115], v[68:71]
    ds_read_b64_tr_b16 a[122:123], v86 offset:4608
    s_waitcnt lgkmcnt(12)
    v_mfma_f32_16x16x32_bf16 v[72:75], a[100:103], a[116:119], v[72:75]
    ds_read_b64_tr_b16 a[124:125], v87 offset:4096
    v_mfma_f32_16x16x32_bf16 v[64:67], a[96:99], a[116:119], v[64:67]
    ds_read_b64_tr_b16 a[126:127], v87 offset:4608
    s_barrier
    s_setprio 3
    s_waitcnt lgkmcnt(10)
    v_mfma_f32_16x16x32_bf16 v[28:31], a[80:83], a[104:107], v[28:31]
    ds_read_b128 a[96:99], v80 offset:39040
    ds_read_b128 a[100:103], v82 offset:39040
    v_mfma_f32_16x16x32_bf16 v[44:47], a[80:83], a[108:111], v[44:47]
    ds_read_b64_tr_b16 a[64:65], v24 offset:39040
    s_waitcnt lgkmcnt(11)
    v_mfma_f32_16x16x32_bf16 v[48:51], a[84:87], a[108:111], v[48:51]
    ds_read_b64_tr_b16 a[66:67], v24 offset:39552
    v_mfma_f32_16x16x32_bf16 v[32:35], a[84:87], a[104:107], v[32:35]
    ds_read_b64_tr_b16 a[68:69], v25 offset:39040
    s_waitcnt lgkmcnt(11)
    v_mfma_f32_16x16x32_bf16 v[36:39], a[88:91], a[104:107], v[36:39]
    ds_read_b64_tr_b16 a[70:71], v25 offset:39552
    v_mfma_f32_16x16x32_bf16 v[52:55], a[88:91], a[108:111], v[52:55]
    ds_read_b64_tr_b16 a[72:73], v26 offset:39040
    s_setprio 2
    s_waitcnt lgkmcnt(11)
    v_mfma_f32_16x16x32_bf16 v[56:59], a[92:95], a[108:111], v[56:59]
    ds_read_b64_tr_b16 a[74:75], v26 offset:39552
    ds_read_b64_tr_b16 a[76:77], v27 offset:39040
    v_mfma_f32_16x16x32_bf16 v[40:43], a[92:95], a[104:107], v[40:43]
    ds_read_b64_tr_b16 a[78:79], v27 offset:39552
    s_waitcnt lgkmcnt(12)
    v_mfma_f32_16x16x32_bf16 v[60:63], a[104:107], a[120:123], v[60:63]
    ds_read_b64_tr_b16 a[112:113], v86 offset:39040
    v_mfma_f32_16x16x32_bf16 v[68:71], a[108:111], a[120:123], v[68:71]
    ds_read_b64_tr_b16 a[114:115], v86 offset:39552
    s_waitcnt lgkmcnt(12)
    v_mfma_f32_16x16x32_bf16 v[72:75], a[108:111], a[124:127], v[72:75]
    ds_read_b64_tr_b16 a[116:117], v87 offset:39040
    v_mfma_f32_16x16x32_bf16 v[64:67], a[104:107], a[124:127], v[64:67]
    ds_read_b64_tr_b16 a[118:119], v87 offset:39552
    s_cmp_eq_u32 s42, 3
    s_cbranch_scc1 Lxe3
Lxe3_b:
    s_setprio 1
    s_waitcnt lgkmcnt(10)
    v_mfma_f32_16x16x32_bf16 v[28:31], a[64:67], a[96:99], v[28:31]
    ds_read_b128 a[104:107], v81 offset:39040
    ds_read_b128 a[108:111], v83 offset:39040
    v_mfma_f32_16x16x32_bf16 v[44:47], a[64:67], a[100:103], v[44:47]
    ds_read_b64_tr_b16 a[80:81], v24 offset:43136
    s_waitcnt lgkmcnt(11)
    v_mfma_f32_16x16x32_bf16 v[48:51], a[68:71], a[100:103], v[48:51]
    ds_read_b64_tr_b16 a[82:83], v24 offset:43648
    v_mfma_f32_16x16x32_bf16 v[32:35], a[68:71], a[96:99], v[32:35]
    ds_read_b64_tr_b16 a[84:85], v25 offset:43136
    s_waitcnt lgkmcnt(11)
    v_mfma_f32_16x16x32_bf16 v[36:39], a[72:75], a[96:99], v[36:39]
    ds_read_b64_tr_b16 a[86:87], v25 offset:43648
    ds_read_b64_tr_b16 a[88:89], v26 offset:43136
    v_mfma_f32_16x16x32_bf16 v[52:55], a[72:75], a[100:103], v[52:55]
    ds_read_b64_tr_b16 a[90:91], v26 offset:43648
    s_setprio 0
    s_waitcnt lgkmcnt(12)
    v_mfma_f32_16x16x32_bf16 v[56:59], a[76:79], a[100:103], v[56:59]
    ds_read_b64_tr_b16 a[92:93], v27 offset:43136
    v_mfma_f32_16x16x32_bf16 v[40:43], a[76:79], a[96:99], v[40:43]
    ds_read_b64_tr_b16 a[94:95], v27 offset:43648
    s_waitcnt lgkmcnt(12)
    v_mfma_f32_16x16x32_bf16 v[60:63], a[96:99], a[112:115], v[60:63]
    ds_read_b64_tr_b16 a[120:121], v86 offset:43136
    v_mfma_f32_16x16x32_bf16 v[68:71], a[100:103], a[112:115], v[68:71]
    ds_read_b64_tr_b16 a[122:123], v86 offset:43648
    s_waitcnt lgkmcnt(12)
    v_mfma_f32_16x16x32_bf16 v[72:75], a[100:103], a[116:119], v[72:75]
    ds_read_b64_tr_b16 a[124:125], v87 offset:43136
    v_mfma_f32_16x16x32_bf16 v[64:67], a[96:99], a[116:119], v[64:67]
    ds_read_b64_tr_b16 a[126:127], v87 offset:43648
    s_barrier
    s_setprio 3
    s_waitcnt lgkmcnt(10)
    v_mfma_f32_16x16x32_bf16 v[28:31], a[80:83], a[104:107], v[28:31]
    ds_read_b128 a[96:99], v76 offset:0
    ds_read_b128 a[100:103], v78 offset:0
    v_mfma_f32_16x16x32_bf16 v[44:47], a[80:83], a[108:111], v[44:47]
    ds_read_b64_tr_b16 a[64:65], v20 offset:0
    s_waitcnt lgkmcnt(11)
    v_mfma_f32_16x16x32_bf16 v[48:51], a[84:87], a[108:111], v[48:51]
    ds_read_b64_tr_b16 a[66:67], v20 offset:512
    v_mfma_f32_16x16x32_bf16 v[32:35], a[84:87], a[104:107], v[32:35]
    ds_read_b64_tr_b16 a[68:69], v21 offset:0
    s_waitcnt lgkmcnt(11)
    v_mfma_f32_16x16x32_bf16 v[36:39], a[88:91], a[104:107], v[36:39]
    ds_read_b64_tr_b16 a[70:71], v21 offset:512
    v_mfma_f32_16x16x32_bf16 v[52:55], a[88:91], a[108:111], v[52:55]
    ds_read_b64_tr_b16 a[72:73], v22 offset:0
    s_setprio 2
    s_waitcnt lgkmcnt(11)
    v_mfma_f32_16x16x32_bf16 v[56:59], a[92:95], a[108:111], v[56:59]
    ds_read_b64_tr_b16 a[74:75], v22 offset:512
    ds_read_b64_tr_b16 a[76:77], v23 offset:0
    v_mfma_f32_16x16x32_bf16 v[40:43], a[92:95], a[104:107], v[40:43]
    ds_read_b64_tr_b16 a[78:79], v23 offset:512
    s_waitcnt lgkmcnt(12)
    v_mfma_f32_16x16x32_bf16 v[60:63], a[104:107], a[120:123], v[60:63]
    ds_read_b64_tr_b16 a[112:113], v84 offset:0
    v_mfma_f32_16x16x32_bf16 v[68:71], a[108:111], a[120:123], v[68:71]
    ds_read_b64_tr_b16 a[114:115], v84 offset:512
    s_waitcnt lgkmcnt(12)
    v_mfma_f32_16x16x32_bf16 v[72:75], a[108:111], a[124:127], v[72:75]
    ds_read_b64_tr_b16 a[116:117], v85 offset:0
    v_mfma_f32_16x16x32_bf16 v[64:67], a[104:107], a[124:127], v[64:67]
    ds_read_b64_tr_b16 a[118:119], v85 offset:512
    buffer_store_dwordx4 v[100:103], v13, s[28:31], s23 offen offset:0 sc1
    s_cmp_eq_u32 s42, 4
    s_cbranch_scc1 Lxe4
Lxe4_b:
    s_setprio 1
    s_waitcnt lgkmcnt(10)
    v_mfma_f32_16x16x32_bf16 v[28:31], a[64:67], a[96:99], v[28:31]
    ds_read_b128 a[104:107], v77 offset:0
    ds_read_b128 a[108:111], v79 offset:0
    v_mfma_f32_16x16x32_bf16 v[44:47], a[64:67], a[100:103], v[44:47]
    ds_read_b64_tr_b16 a[80:81], v20 offset:4096
    s_waitcnt lgkmcnt(11)
    v_mfma_f32_16x16x32_bf16 v[48:51], a[68:71], a[100:103], v[48:51]
    ds_read_b64_tr_b16 a[82:83], v20 offset:4608
    v_mfma_f32_16x16x32_bf16 v[32:35], a[68:71], a[96:99], v[32:35]
    ds_read_b64_tr_b16 a[84:85], v21 offset:4096
    s_waitcnt lgkmcnt(11)
    v_mfma_f32_16x16x32_bf16 v[36:39], a[72:75], a[96:99], v[36:39]
    ds_read_b64_tr_b16 a[86:87], v21 offset:4608
    ds_read_b64_tr_b16 a[88:89], v22 offset:4096
    v_mfma_f32_16x16x32_bf16 v[52:55], a[72:75], a[100:103], v[52:55]
    ds_read_b64_tr_b16 a[90:91], v22 offset:4608
    s_setprio 0
    s_waitcnt lgkmcnt(12)
    v_mfma_f32_16x16x32_bf16 v[56:59], a[76:79], a[100:103], v[56:59]
    ds_read_b64_tr_b16 a[92:93], v23 offset:4096
    v_mfma_f32_16x16x32_bf16 v[40:43], a[76:79], a[96:99], v[40:43]
    ds_read_b64_tr_b16 a[94:95], v23 offset:4608
    s_waitcnt lgkmcnt(12)
    v_mfma_f32_16x16x32_bf16 v[60:63], a[96:99], a[112:115], v[60:63]
    ds_read_b64_tr_b16 a[120:121], v84 offset:4096
    v_mfma_f32_16x16x32_bf16 v[68:71], a[100:103], a[112:115], v[68:71]
    ds_read_b64_tr_b16 a[122:123], v84 offset:4608
    s_waitcnt lgkmcnt(12)
    v_mfma_f32_16x16x32_bf16 v[72:75], a[100:103], a[116:119], v[72:75]
    ds_read_b64_tr_b16 a[124:125], v85 offset:4096
    v_mfma_f32_16x16x32_bf16 v[64:67], a[96:99], a[116:119], v[64:67]
    ds_read_b64_tr_b16 a[126:127], v85 offset:4608
    s_barrier
    s_setprio 3
    s_waitcnt lgkmcnt(10)
    v_mfma_f32_16x16x32_bf16 v[28:31], a[80:83], a[104:107], v[28:31]
    ds_read_b128 a[96:99], v76 offset:39040
    ds_read_b128 a[100:103], v78 offset:39040
    v_mfma_f32_16x16x32_bf16 v[44:47], a[80:83], a[108:111], v[44:47]
    ds_read_b64_tr_b16 a[64:65], v20 offset:39040
    s_waitcnt lgkmcnt(11)
    v_mfma_f32_16x16x32_bf16 v[48:51], a[84:87], a[108:111], v[48:51]
    ds_read_b64_tr_b16 a[66:67], v20 offset:39552
    v_mfma_f32_16x16x32_bf16 v[32:35], a[84:87], a[104:107], v[32:35]
    ds_read_b64_tr_b16 a[68:69], v21 offset:39040
    s_waitcnt lgkmcnt(11)
    v_mfma_f32_16x16x32_bf16 v[36:39], a[88:91], a[104:107], v[36:39]
    ds_read_b64_tr_b16 a[70:71], v21 offset:39552
    v_mfma_f32_16x16x32_bf16 v[52:55], a[88:91], a[108:111], v[52:55]
    ds_read_b64_tr_b16 a[72:73], v22 offset:39040
    s_setprio 2
    s_waitcnt lgkmcnt(11)
    v_mfma_f32_16x16x32_bf16 v[56:59], a[92:95], a[108:111], v[56:59]
    ds_read_b64_tr_b16 a[74:75], v22 offset:39552
    ds_read_b64_tr_b16 a[76:77], v23 offset:39040
    v_mfma_f32_16x16x32_bf16 v[40:43], a[92:95], a[104:107], v[40:43]
    ds_read_b64_tr_b16 a[78:79], v23 offset:39552
    s_waitcnt lgkmcnt(12)
    v_mfma_f32_16x16x32_bf16 v[60:63], a[104:107], a[120:123], v[60:63]
    ds_read_b64_tr_b16 a[112:113], v84 offset:39040
    v_mfma_f32_16x16x32_bf16 v[68:71], a[108:111], a[120:123], v[68:71]
    ds_read_b64_tr_b16 a[114:115], v84 offset:39552
    s_waitcnt lgkmcnt(12)
    v_mfma_f32_16x16x32_bf16 v[72:75], a[108:111], a[124:127], v[72:75]
    ds_read_b64_tr_b16 a[116:117], v85 offset:39040
    v_mfma_f32_16x16x32_bf16 v[64:67], a[104:107], a[124:127], v[64:67]
    ds_read_b64_tr_b16 a[118:119], v85 offset:39552
    s_cmp_eq_u32 s42, 5
    s_cbranch_scc1 Lxe5
Lxe5_b:
    s_setprio 1
    s_waitcnt lgkmcnt(10)
    v_mfma_f32_16x16x32_bf16 v[28:31], a[64:67], a[96:99], v[28:31]
    ds_read_b128 a[104:107], v77 offset:39040
    ds_read_b128 a[108:111], v79 offset:39040
    v_mfma_f32_16x16x32_bf16 v[44:47], a[64:67], a[100:103], v[44:47]
    ds_read_b64_tr_b16 a[80:81], v20 offset:43136
    s_waitcnt lgkmcnt(11)
    v_mfma_f32_16x16x32_bf16 v[48:51], a[68:71], a[100:103], v[48:51]
    ds_read_b64_tr_b16 a[82:83], v20 offset:43648
    v_mfma_f32_16x16x32_bf16 v[32:35], a[68:71], a[96:99], v[32:35]
    ds_read_b64_tr_b16 a[84:85], v21 offset:43136
    s_waitcnt lgkmcnt(11)
    v_mfma_f32_16x16x32_bf16 v[36:39], a[72:75], a[96:99], v[36:39]
    ds_read_b64_tr_b16 a[86:87], v21 offset:43648
    ds_read_b64_tr_b16 a[88:89], v22 offset:43136
    v_mfma_f32_16x16x32_bf16 v[52:55], a[72:75], a[100:103], v[52:55]
    ds_read_b64_tr_b16 a[90:91], v22 offset:43648
    s_setprio 0
    s_waitcnt lgkmcnt(12)
    v_mfma_f32_16x16x32_bf16 v[56:59], a[76:79], a[100:103], v[56:59]
    ds_read_b64_tr_b16 a[92:93], v23 offset:43136
    v_mfma_f32_16x16x32_bf16 v[40:43], a[76:79], a[96:99], v[40:43]
    ds_read_b64_tr_b16 a[94:95], v23 offset:43648
    s_waitcnt lgkmcnt(12)
    v_mfma_f32_16x16x32_bf16 v[60:63], a[96:99], a[112:115], v[60:63]
    ds_read_b64_tr_b16 a[120:121], v84 offset:43136
    v_mfma_f32_16x16x32_bf16 v[68:71], a[100:103], a[112:115], v[68:71]
    ds_read_b64_tr_b16 a[122:123], v84 offset:43648
    s_waitcnt lgkmcnt(12)
    v_mfma_f32_16x16x32_bf16 v[72:75], a[100:103], a[116:119], v[72:75]
    ds_read_b64_tr_b16 a[124:125], v85 offset:43136
    v_mfma_f32_16x16x32_bf16 v[64:67], a[96:99], a[116:119], v[64:67]
    ds_read_b64_tr_b16 a[126:127], v85 offset:43648
    s_barrier
    s_setprio 3
    s_waitcnt lgkmcnt(10)
    v_mfma_f32_16x16x32_bf16 v[28:31], a[80:83], a[104:107], v[28:31]
    ds_read_b128 a[0:3], v80 offset:0
    v_mfma_f32_16x16x32_bf16 v[44:47], a[80:83], a[108:111], v[44:47]
    ds_read_b128 a[4:7], v82 offset:0
    s_waitcnt lgkmcnt(10)
    v_mfma_f32_16x16x32_bf16 v[48:51], a[84:87], a[108:111], v[48:51]
    ds_read_b64_tr_b16 a[64:65], v24 offset:0
    v_mfma_f32_16x16x32_bf16 v[32:35], a[84:87], a[104:107], v[32:35]
    ds_read_b64_tr_b16 a[66:67], v24 offset:512
    s_waitcnt lgkmcnt(10)
    v_mfma_f32_16x16x32_bf16 v[36:39], a[88:91], a[104:107], v[36:39]
    ds_read_b64_tr_b16 a[68:69], v25 offset:0
    v_mfma_f32_16x16x32_bf16 v[52:55], a[88:91], a[108:111], v[52:55]
    s_setprio 2
    s_waitcnt lgkmcnt(9)
    v_mfma_f32_16x16x32_bf16 v[56:59], a[92:95], a[108:111], v[56:59]
    ds_read_b64_tr_b16 a[70:71], v25 offset:512
    v_mfma_f32_16x16x32_bf16 v[40:43], a[92:95], a[104:107], v[40:43]
    ds_read_b64_tr_b16 a[72:73], v26 offset:0
    s_waitcnt lgkmcnt(9)
    v_mfma_f32_16x16x32_bf16 v[60:63], a[104:107], a[120:123], v[60:63]
    ds_read_b64_tr_b16 a[74:75], v26 offset:512
    v_mfma_f32_16x16x32_bf16 v[68:71], a[108:111], a[120:123], v[68:71]
    ds_read_b64_tr_b16 a[76:77], v27 offset:0
    s_waitcnt lgkmcnt(9)
    v_mfma_f32_16x16x32_bf16 v[72:75], a[108:111], a[124:127], v[72:75]
    ds_read_b64_tr_b16 a[78:79], v27 offset:512
    v_mfma_f32_16x16x32_bf16 v[64:67], a[104:107], a[124:127], v[64:67]
    buffer_store_dwordx4 v[100:103], v13, s[28:31], s23 offen offset:1024 sc1
    s_cmp_eq_u32 s42, 6
    s_cbranch_scc1 Lxe6
Lxe6_b:
    s_setprio 1
    s_waitcnt lgkmcnt(6)
    v_mfma_f32_16x16x32_bf16 v[28:31], a[64:67], a[0:3], v[28:31]
    ds_read_b128 a[8:11], v81 offset:0
    ds_read_b128 a[12:15], v83 offset:0
    v_mfma_f32_16x16x32_bf16 v[44:47], a[64:67], a[4:7], v[44:47]
    ds_read_b64_tr_b16 a[80:81], v24 offset:4096
    s_waitcnt lgkmcnt(7)
    v_mfma_f32_16x16x32_bf16 v[48:51], a[68:71], a[4:7], v[48:51]
    ds_read_b64_tr_b16 a[82:83], v24 offset:4608
    ds_read_b64_tr_b16 a[84:85], v25 offset:4096
    v_mfma_f32_16x16x32_bf16 v[32:35], a[68:71], a[0:3], v[32:35]
    ds_read_b64_tr_b16 a[86:87], v25 offset:4608
    s_setprio 0
    s_waitcnt lgkmcnt(8)
    v_mfma_f32_16x16x32_bf16 v[36:39], a[72:75], a[0:3], v[36:39]
    v_mfma_f32_16x16x32_bf16 v[52:55], a[72:75], a[4:7], v[52:55]
    ds_read_b64_tr_b16 a[88:89], v26 offset:4096
    ds_read_b64_tr_b16 a[90:91], v26 offset:4608
    s_waitcnt lgkmcnt(8)
    v_mfma_f32_16x16x32_bf16 v[56:59], a[76:79], a[4:7], v[56:59]
    ds_read_b64_tr_b16 a[92:93], v27 offset:4096
    v_mfma_f32_16x16x32_bf16 v[40:43], a[76:79], a[0:3], v[40:43]
    ds_read_b64_tr_b16 a[94:95], v27 offset:4608
    s_barrier
    s_setprio 3
    s_waitcnt lgkmcnt(6)
    v_mfma_f32_16x16x32_bf16 v[28:31], a[80:83], a[8:11], v[28:31]
    ds_read_b128 a[16:19], v80 offset:39040
    ds_read_b128 a[20:23], v82 offset:39040
    v_mfma_f32_16x16x32_bf16 v[44:47], a[80:83], a[12:15], v[44:47]
    ds_read_b64_tr_b16 a[64:65], v24 offset:39040
    s_waitcnt lgkmcnt(7)
    v_mfma_f32_16x16x32_bf16 v[48:51], a[84:87], a[12:15], v[48:51]
    ds_read_b64_tr_b16 a[66:67], v24 offset:39552
    v_mfma_f32_16x16x32_bf16 v[32:35], a[84:87], a[8:11], v[32:35]
    ds_read_b64_tr_b16 a[68:69], v25 offset:39040
    s_setprio 2
    s_waitcnt lgkmcnt(7)
    v_mfma_f32_16x16x32_bf16 v[36:39], a[88:91], a[8:11], v[36:39]
    ds_read_b64_tr_b16 a[70:71], v25 offset:39552
    ds_read_b64_tr_b16 a[72:73], v26 offset:39040
    v_mfma_f32_16x16x32_bf16 v[52:55], a[88:91], a[12:15], v[52:55]
    ds_read_b64_tr_b16 a[74:75], v26 offset:39552
    s_waitcnt lgkmcnt(8)
    v_mfma_f32_16x16x32_bf16 v[56:59], a[92:95], a[12:15], v[56:59]
    ds_read_b64_tr_b16 a[76:77], v27 offset:39040
    v_mfma_f32_16x16x32_bf16 v[40:43], a[92:95], a[8:11], v[40:43]
    ds_read_b64_tr_b16 a[78:79], v27 offset:39552
    s_cmp_eq_u32 s42, 7
    s_cbranch_scc1 Lxe7
Lxe7_b:
    s_setprio 1
    s_waitcnt lgkmcnt(6)
    v_mfma_f32_16x16x32_bf16 v[28:31], a[64:67], a[16:19], v[28:31]
    ds_read_b128 a[24:27], v81 offset:39040
    ds_read_b128 a[28:31], v83 offset:39040
    v_mfma_f32_16x16x32_bf16 v[44:47], a[64:67], a[20:23], v[44:47]
    ds_read_b64_tr_b16 a[80:81], v24 offset:43136
    s_waitcnt lgkmcnt(7)
    v_mfma_f32_16x16x32_bf16 v[48:51], a[68:71], a[20:23], v[48:51]
    ds_read_b64_tr_b16 a[82:83], v24 offset:43648
    ds_read_b64_tr_b16 a[84:85], v25 offset:43136
    v_mfma_f32_16x16x32_bf16 v[32:35], a[68:71], a[16:19], v[32:35]
    ds_read_b64_tr_b16 a[86:87], v25 offset:43648
    s_setprio 0
    s_waitcnt lgkmcnt(8)
    v_mfma_f32_16x16x32_bf16 v[36:39], a[72:75], a[16:19], v[36:39]
    v_mfma_f32_16x16x32_bf16 v[52:55], a[72:75], a[20:23], v[52:55]
    ds_read_b64_tr_b16 a[88:89], v26 offset:43136
    ds_read_b64_tr_b16 a[90:91], v26 offset:43648
    s_waitcnt lgkmcnt(8)
    v_mfma_f32_16x16x32_bf16 v[56:59], a[76:79], a[20:23], v[56:59]
    ds_read_b64_tr_b16 a[92:93], v27 offset:43136
    v_mfma_f32_16x16x32_bf16 v[40:43], a[76:79], a[16:19], v[40:43]
    ds_read_b64_tr_b16 a[94:95], v27 offset:43648
    s_barrier
    s_setprio 3
    s_waitcnt lgkmcnt(6)
    v_mfma_f32_16x16x32_bf16 v[28:31], a[80:83], a[24:27], v[28:31]
    ds_read_b128 a[32:35], v76 offset:0
    ds_read_b128 a[36:39], v78 offset:0
    v_mfma_f32_16x16x32_bf16 v[44:47], a[80:83], a[28:31], v[44:47]
    ds_read_b64_tr_b16 a[64:65], v20 offset:0
    s_waitcnt lgkmcnt(7)
    v_mfma_f32_16x16x32_bf16 v[48:51], a[84:87], a[28:31], v[48:51]
    ds_read_b64_tr_b16 a[66:67], v20 offset:512
    v_mfma_f32_16x16x32_bf16 v[32:35], a[84:87], a[24:27], v[32:35]
    ds_read_b64_tr_b16 a[68:69], v21 offset:0
    s_setprio 2
    s_waitcnt lgkmcnt(7)
    v_mfma_f32_16x16x32_bf16 v[36:39], a[88:91], a[24:27], v[36:39]
    ds_read_b64_tr_b16 a[70:71], v21 offset:512
    ds_read_b64_tr_b16 a[72:73], v22 offset:0
    v_mfma_f32_16x16x32_bf16 v[52:55], a[88:91], a[28:31], v[52:55]
    ds_read_b64_tr_b16 a[74:75], v22 offset:512
    s_waitcnt lgkmcnt(8)
    v_mfma_f32_16x16x32_bf16 v[56:59], a[92:95], a[28:31], v[56:59]
    ds_read_b64_tr_b16 a[76:77], v23 offset:0
    v_mfma_f32_16x16x32_bf16 v[40:43], a[92:95], a[24:27], v[40:43]
    ds_read_b64_tr_b16 a[78:79], v23 offset:512
    s_cmp_eq_u32 s42, 8
    s_cbranch_scc1 Lxe8
Lxe8_b:
    s_setprio 1
    s_waitcnt lgkmcnt(6)
    v_mfma_f32_16x16x32_bf16 v[28:31], a[64:67], a[32:35], v[28:31]
    ds_read_b128 a[40:43], v77 offset:0
    ds_read_b128 a[44:47], v79 offset:0
    v_mfma_f32_16x16x32_bf16 v[44:47], a[64:67], a[36:39], v[44:47]
    ds_read_b64_tr_b16 a[80:81], v20 offset:4096
    s_waitcnt lgkmcnt(7)
    v_mfma_f32_16x16x32_bf16 v[48:51], a[68:71], a[36:39], v[48:51]
    ds_read_b64_tr_b16 a[82:83], v20 offset:4608
    v_mfma_f32_16x16x32_bf16 v[32:35], a[68:71], a[32:35], v[32:35]
    ds_read_b64_tr_b16 a[84:85], v21 offset:4096
    s_setprio 0
    s_waitcnt lgkmcnt(7)
    v_mfma_f32_16x16x32_bf16 v[36:39], a[72:75], a[32:35], v[36:39]
    ds_read_b64_tr_b16 a[86:87], v21 offset:4608
    ds_read_b64_tr_b16 a[88:89], v22 offset:4096
    v_mfma_f32_16x16x32_bf16 v[52:55], a[72:75], a[36:39], v[52:55]
    ds_read_b64_tr_b16 a[90:91], v22 offset:4608
    s_waitcnt lgkmcnt(8)
    v_mfma_f32_16x16x32_bf16 v[56:59], a[76:79], a[36:39], v[56:59]
    ds_read_b64_tr_b16 a[92:93], v23 offset:4096
    v_mfma_f32_16x16x32_bf16 v[40:43], a[76:79], a[32:35], v[40:43]
    ds_read_b64_tr_b16 a[94:95], v23 offset:4608
    s_waitcnt lgkmcnt(0)
    s_barrier
    s_setprio 3
    v_mfma_f32_16x16x32_bf16 v[28:31], a[80:83], a[40:43], v[28:31]
    ds_read_b128 a[48:51], v76 offset:39040
    ds_read_b128 a[52:55], v78 offset:39040
    v_mfma_f32_16x16x32_bf16 v[44:47], a[80:83], a[44:47], v[44:47]
    ds_read_b64_tr_b16 a[64:65], v20 offset:39040
    v_mfma_f32_16x16x32_bf16 v[48:51], a[84:87], a[44:47], v[48:51]
    ds_read_b64_tr_b16 a[66:67], v20 offset:39552
    v_mfma_f32_16x16x32_bf16 v[32:35], a[84:87], a[40:43], v[32:35]
    ds_read_b64_tr_b16 a[68:69], v21 offset:39040
    s_setprio 2
    v_mfma_f32_16x16x32_bf16 v[36:39], a[88:91], a[40:43], v[36:39]
    ds_read_b64_tr_b16 a[70:71], v21 offset:39552
    ds_read_b64_tr_b16 a[72:73], v22 offset:39040
    v_mfma_f32_16x16x32_bf16 v[52:55], a[88:91], a[44:47], v[52:55]
    ds_read_b64_tr_b16 a[74:75], v22 offset:39552
    v_mfma_f32_16x16x32_bf16 v[56:59], a[92:95], a[44:47], v[56:59]
    ds_read_b64_tr_b16 a[76:77], v23 offset:39040
    v_mfma_f32_16x16x32_bf16 v[40:43], a[92:95], a[40:43], v[40:43]
    ds_read_b64_tr_b16 a[78:79], v23 offset:39552
    v_mov_b32 v98, s34
    s_waitcnt vmcnt(0)
    s_mov_b64 exec, 1
    buffer_store_dword v98, v97, s[28:31], s24 offen sc1
    s_mov_b64 exec, -1
    s_cmp_eq_u32 s42, 9
    s_cbranch_scc1 Lxe9
Lxe9_b:
    s_setprio 1
    s_waitcnt lgkmcnt(6)
    v_mfma_f32_16x16x32_bf16 v[28:31], a[64:67], a[48:51], v[28:31]
    ds_read_b128 a[56:59], v77 offset:39040
    ds_read_b128 a[60:63], v79 offset:39040
    ds_read_b64_tr_b16 a[80:81], v20 offset:43136
    v_mfma_f32_16x16x32_bf16 v[44:47], a[64:67], a[52:55], v[44:47]
    ds_read_b64_tr_b16 a[82:83], v20 offset:43648
    ds_read_b64_tr_b16 a[84:85], v21 offset:43136
    s_waitcnt lgkmcnt(9)
    v_mfma_f32_16x16x32_bf16 v[48:51], a[68:71], a[52:55], v[48:51]
    ds_read_b64_tr_b16 a[86:87], v21 offset:43648
    ds_read_b64_tr_b16 a[88:89], v22 offset:43136
    ds_read_b64_tr_b16 a[90:91], v22 offset:43648
    v_mfma_f32_16x16x32_bf16 v[32:35], a[68:71], a[48:51], v[32:35]
    ds_read_b64_tr_b16 a[92:93], v23 offset:43136
    ds_read_b64_tr_b16 a[94:95], v23 offset:43648
    s_setprio 0
    s_waitcnt lgkmcnt(12)
    v_mfma_f32_16x16x32_bf16 v[36:39], a[72:75], a[48:51], v[36:39]
    ds_read_b32 v120, v94
    ds_read_b32 v121, v94 offset:512
    v_xor_b32 v94, 64, v94
    v_mfma_f32_16x16x32_bf16 v[52:55], a[72:75], a[52:55], v[52:55]
    ds_read_b32 v122, v94
    ds_read_b32 v123, v92 offset:512
    s_waitcnt lgkmcnt(14)
    v_mfma_f32_16x16x32_bf16 v[56:59], a[76:79], a[52:55], v[56:59]
    ds_read_b32 v126, v93 offset:520
    v_mov_b32 v24, v84
    v_mov_b32 v25, v85
    v_mfma_f32_16x16x32_bf16 v[40:43], a[76:79], a[48:51], v[40:43]
    v_mov_b32 v26, v86
    v_mov_b32 v27, v87
    s_waitcnt lgkmcnt(5)
    v_mfma_f32_16x16x32_bf16 v[44:47], a[80:83], a[60:63], v[44:47]
    v_mfma_f32_16x16x32_bf16 v[48:51], a[84:87], a[60:63], v[48:51]
    v_mfma_f32_16x16x32_bf16 v[52:55], a[88:91], a[60:63], v[52:55]
    v_mfma_f32_16x16x32_bf16 v[56:59], a[92:95], a[60:63], v[56:59]
    v_mfma_f32_16x16x32_bf16 v[28:31], a[80:83], a[56:59], v[28:31]
    v_mfma_f32_16x16x32_bf16 v[32:35], a[84:87], a[56:59], v[32:35]
    ds_read_b32 v7, v96
    ds_read_b128 v[76:79], v95 offset:0
    ds_read_b128 v[80:83], v95 offset:64
    ds_read_b128 v[84:87], v95 offset:128
    ds_read_b128 v[88:91], v95 offset:192
    v_mfma_f32_16x16x32_bf16 v[36:39], a[88:91], a[56:59], v[36:39]
    v_mfma_f32_16x16x32_bf16 v[40:43], a[92:95], a[56:59], v[40:43]
    s_waitcnt lgkmcnt(0)
Lqf:
    v_readfirstlane_b32 s38, v7
    s_nop 0
    s_cmp_eq_u32 s38, 0
    s_cbranch_scc1 Lqf_re
    s_cmp_eq_u32 s27, 0
    v_fmac_f32 v44, v76, v122
    v_fmac_f32 v45, v77, v122
    v_fmac_f32 v46, v78, v122
    v_fmac_f32 v47, v79, v122
    v_cvt_pk_bf16_f32 v44, v44, v45
    v_cvt_pk_bf16_f32 v45, v46, v47
    v_fmac_f32 v48, v80, v122
    v_fmac_f32 v49, v81, v122
    v_fmac_f32 v50, v82, v122
    v_fmac_f32 v51, v83, v122
    v_cvt_pk_bf16_f32 v46, v48, v49
    v_cvt_pk_bf16_f32 v47, v50, v51
    v_fmac_f32 v52, v84, v122
    v_fmac_f32 v53, v85, v122
    v_fmac_f32 v54, v86, v122
    v_fmac_f32 v55, v87, v122
    v_cvt_pk_bf16_f32 v48, v52, v53
    v_cvt_pk_bf16_f32 v49, v54, v55
    v_fmac_f32 v56, v88, v122
    v_fmac_f32 v57, v89, v122
    v_fmac_f32 v58, v90, v122
    v_fmac_f32 v59, v91, v122
    v_cvt_pk_bf16_f32 v50, v56, v57
    v_cvt_pk_bf16_f32 v51, v58, v59
    s_cbranch_scc1 Lh1
    s_setprio 3
    ds_write_b128 v125, v[44:47] offset:2048
    ds_write_b128 v125, v[48:51] offset:3072
    v_fmac_f32 v28, v76, v120
    v_fmac_f32 v29, v77, v120
    v_fmac_f32 v30, v78, v120
    v_fmac_f32 v31, v79, v120
    v_cvt_pk_bf16_f32 v52, v28, v29
    v_cvt_pk_bf16_f32 v53, v30, v31
    v_fmac_f32 v32, v80, v120
    v_fmac_f32 v33, v81, v120
    v_fmac_f32 v34, v82, v120
    v_fmac_f32 v35, v83, v120
    v_cvt_pk_bf16_f32 v54, v32, v33
    v_cvt_pk_bf16_f32 v55, v34, v35
    v_fmac_f32 v36, v84, v120
    v_fmac_f32 v37, v85, v120
    v_fmac_f32 v38, v86, v120
    v_fmac_f32 v39, v87, v120
    v_cvt_pk_bf16_f32 v56, v36, v37
    v_cvt_pk_bf16_f32 v57, v38, v39
    v_fmac_f32 v40, v88, v120
    v_fmac_f32 v41, v89, v120
    v_fmac_f32 v42, v90, v120
    v_fmac_f32 v43, v91, v120
    v_cvt_pk_bf16_f32 v58, v40, v41
    v_cvt_pk_bf16_f32 v59, v42, v43
    ds_write_b128 v125, v[52:55] offset:4096
    ds_write_b128 v125, v[56:59] offset:5120
    v_mov_b32 v5, 157972
    v_mov_b32 v6, 1
    s_mov_b64 exec, 1
    ds_add_u32 v5, v6
    s_mov_b64 exec, -1
    v_mov_b32 v8, s22
    v_mov_b32 v9, s22
    v_mov_b32 v10, s22
    v_mov_b32 v11, s22
Lcw_1:
    s_sub_u32 s35, s35, 1
    s_cbranch_scc1 Lend
    ds_read_b32 v6, v5
    s_waitcnt lgkmcnt(0)
    v_readfirstlane_b32 s38, v6
    s_nop 0
    s_cmp_lt_u32 s38, 8
    s_cbranch_scc1 Lcw_1
    ds_read_b128 v[28:31], v125 offset:0
    ds_read_b128 v[32:35], v125 offset:1024
Lh_join:
    buffer_load_dword v20, v12, s[28:31], s24 offen sc1
    ds_read_b64_tr_b16 a[64:65], v26 offset:0
    ds_read_b64_tr_b16 a[66:67], v26 offset:512
    ds_read_b64_tr_b16 a[68:69], v27 offset:0
    ds_read_b64_tr_b16 a[70:71], v27 offset:512
    ds_read_b64_tr_b16 a[72:73], v26 offset:4096
    ds_read_b64_tr_b16 a[74:75], v26 offset:4608
    ds_read_b64_tr_b16 a[76:77], v27 offset:4096
    ds_read_b64_tr_b16 a[78:79], v27 offset:4608
    s_waitcnt lgkmcnt(8)
    s_setprio 3
    v_cndmask_b32 v92, 0, v30, s[6:7]
    v_cndmask_b32 v93, 0, v31, s[6:7]
    v_cndmask_b32 v94, 0, v32, s[12:13]
    v_cndmask_b32 v95, 0, v33, s[12:13]
    v_cndmask_b32 v104, 0, v30, s[8:9]
    v_cndmask_b32 v105, 0, v31, s[8:9]
    v_mfma_f32_16x16x32_bf16 v[76:79], v[46:49], v[92:95], v[8:11]
    v_mfma_f32_16x16x32_bf16 v[80:83], v[54:57], v[92:95], 0
    v_cndmask_b32 v106, 0, v32, s[14:15]
    v_cndmask_b32 v107, 0, v33, s[14:15]
    v_mov_b32 v96, v28
    v_mov_b32 v97, v29
    v_mfma_f32_16x16x32_bf16 v[84:87], v[46:49], v[104:107], v[8:11]
    v_mfma_f32_16x16x32_bf16 v[88:91], v[54:57], v[104:107], 0
    v_cndmask_b32 v98, 0, v30, s[10:11]
    v_cndmask_b32 v99, 0, v31, s[10:11]
    v_cndmask_b32 v100, 0, v32, s[16:17]
    v_cndmask_b32 v101, 0, v33, s[16:17]
    v_mfma_f32_16x16x32_bf16 v[36:39], v[44:47], v[96:99], v[8:11]
    v_mfma_f32_16x16x32_bf16 v[40:43], v[52:55], v[96:99], 0
    v_cndmask_b32 v76, v76, v77, s[4:5]
    v_cndmask_b32 v80, v80, v81, s[4:5]
    v_cndmask_b32 v78, v78, v79, s[4:5]
    v_cndmask_b32 v82, v82, v83, s[4:5]
    v_cndmask_b32 v92, v76, v80, s[18:19]
    v_cndmask_b32 v94, v78, v82, s[20:21]
    v_min_u32 v4, -2, v92
    v_min_u32 v5, -2, v94
    v_cndmask_b32 v84, v84, v85, s[4:5]
    v_cndmask_b32 v88, v88, v89, s[4:5]
    v_cndmask_b32 v86, v86, v87, s[4:5]
    v_cndmask_b32 v90, v90, v91, s[4:5]
    v_cndmask_b32 v104, v84, v88, s[18:19]
    v_cndmask_b32 v106, v86, v90, s[20:21]
    v_min_u32 v6, -2, v104
    v_min_u32 v7, -2, v106
    buffer_store_dwordx4 v[4:7], v13, s[28:31], s58 offen sc0 sc1
    s_setprio 2
    ds_read_b64_tr_b16 a[80:81], v26 offset:39040
    ds_read_b64_tr_b16 a[82:83], v26 offset:39552
    ds_read_b64_tr_b16 a[84:85], v27 offset:39040
    ds_read_b64_tr_b16 a[86:87], v27 offset:39552
    ds_read_b64_tr_b16 a[88:89], v26 offset:43136
    ds_read_b64_tr_b16 a[90:91], v26 offset:43648
    ds_read_b64_tr_b16 a[92:93], v27 offset:43136
    ds_read_b64_tr_b16 a[94:95], v27 offset:43648
    ds_read_b64_tr_b16 a[96:97], v24 offset:0
    ds_read_b64_tr_b16 a[98:99], v24 offset:512
    ds_read_b64_tr_b16 a[100:101], v25 offset:0
    ds_read_b64_tr_b16 a[102:103], v25 offset:512
    ds_read_b64_tr_b16 a[104:105], v24 offset:4096
    ds_read_b64_tr_b16 a[106:107], v24 offset:4608
    ds_read_b64_tr_b16 a[108:109], v25 offset:4096
    ds_read_b64_tr_b16 a[110:111], v25 offset:4608
    ds_read_b64_tr_b16 a[112:113], v24 offset:39040
    ds_read_b64_tr_b16 a[114:115], v24 offset:39552
    ds_read_b64_tr_b16 a[116:117], v25 offset:39040
    ds_read_b64_tr_b16 a[118:119], v25 offset:39552
    ds_read_b64_tr_b16 a[120:121], v24 offset:43136
    ds_read_b64_tr_b16 a[122:123], v24 offset:43648
    ds_read_b64_tr_b16 a[124:125], v25 offset:43136
    ds_read_b64_tr_b16 a[126:127], v25 offset:43648
    s_waitcnt lgkmcnt(15)
    v_mfma_f32_16x16x32_bf16 v[60:63], a[0:3], a[64:67], v[60:63]
    v_mov_b32 v102, v34
    v_mov_b32 v103, v35
    v_mul_f32 v4, s25, v121
    v_mfma_f32_16x16x32_bf16 v[68:71], a[4:7], a[64:67], v[68:71]
    v_mfma_f32_16x16x32_bf16 v[76:79], v[48:51], v[100:103], v[8:11]
    v_mfma_f32_16x16x32_bf16 v[80:83], v[56:59], v[100:103], 0
    v_mul_f32 v123, v123, v4
    v_mfma_f32_16x16x32_bf16 v[64:67], a[0:3], a[68:71], v[64:67]
    v_mul_f32 v126, v126, v4
    v_cndmask_b32 v36, v36, v37, s[4:5]
    v_cndmask_b32 v40, v40, v41, s[4:5]
    v_mfma_f32_16x16x32_bf16 v[72:75], a[4:7], a[68:71], v[72:75]
    v_cndmask_b32 v38, v38, v39, s[4:5]
    v_cndmask_b32 v42, v42, v43, s[4:5]
    v_cndmask_b32 v96, v36, v40, s[18:19]
    v_mfma_f32_16x16x32_bf16 v[60:63], a[8:11], a[72:75], v[60:63]
    v_cndmask_b32 v98, v38, v42, s[20:21]
    v_cndmask_b32 v76, v76, v77, s[4:5]
    v_cndmask_b32 v80, v80, v81, s[4:5]
    v_mfma_f32_16x16x32_bf16 v[68:71], a[12:15], a[72:75], v[68:71]
    v_cndmask_b32 v78, v78, v79, s[4:5]
    v_cndmask_b32 v82, v82, v83, s[4:5]
    v_cndmask_b32 v100, v76, v80, s[18:19]
    v_mfma_f32_16x16x32_bf16 v[64:67], a[8:11], a[76:79], v[64:67]
    v_cndmask_b32 v102, v78, v82, s[20:21]
    v_mul_f32 v96, v96, v123
    v_mul_f32 v98, v98, v126
    v_mfma_f32_16x16x32_bf16 v[72:75], a[12:15], a[76:79], v[72:75]
    v_mul_f32 v100, v100, v123
    v_mul_f32 v102, v102, v126
    v_max_f32 v4, v96, v98
    v_mfma_f32_16x16x32_bf16 v[60:63], a[16:19], a[80:83], v[60:63]
    v_max_f32 v5, v100, v102
    v_mov_b32 v6, v4
    v_mov_b32 v7, v5
    v_mfma_f32_16x16x32_bf16 v[68:71], a[20:23], a[80:83], v[68:71]
    v_permlane32_swap_b32 v4, v6
    v_permlane32_swap_b32 v5, v7
    v_max_f32 v4, v4, v6
    v_mfma_f32_16x16x32_bf16 v[64:67], a[16:19], a[84:87], v[64:67]
    v_max_f32 v5, v5, v7
    v_mov_b32 v6, v4
    v_mov_b32 v7, v5
    v_mfma_f32_16x16x32_bf16 v[72:75], a[20:23], a[84:87], v[72:75]
    v_permlane16_swap_b32 v4, v6
    v_permlane16_swap_b32 v5, v7
    s_setprio 1
    v_mfma_f32_16x16x32_bf16 v[60:63], a[24:27], a[88:91], v[60:63]
    v_max_f32 v4, v4, v6
    v_max_f32 v5, v5, v7
    v_sub_f32 v96, v96, v4
    v_mfma_f32_16x16x32_bf16 v[68:71], a[28:31], a[88:91], v[68:71]
    v_sub_f32 v98, v98, v4
    v_sub_f32 v100, v100, v5
    v_sub_f32 v102, v102, v5
    v_mfma_f32_16x16x32_bf16 v[64:67], a[24:27], a[92:95], v[64:67]
    v_exp_f32 v96, v96
    v_exp_f32 v98, v98
    v_exp_f32 v100, v100
    v_mfma_f32_16x16x32_bf16 v[72:75], a[28:31], a[92:95], v[72:75]
    v_exp_f32 v102, v102
    v_cvt_pk_bf16_f32 v96, v96, v96
    s_waitcnt lgkmcnt(12)
    v_mfma_f32_16x16x32_bf16 v[60:63], a[32:35], a[96:99], v[60:63]
    v_cvt_pk_bf16_f32 v97, v98, v98
    v_cvt_pk_bf16_f32 v100, v100, v100
    v_cvt_pk_bf16_f32 v101, v102, v102
    v_mfma_f32_16x16x32_bf16 v[68:71], a[36:39], a[96:99], v[68:71]
    v_and_b32 v98, v96, v118
    v_and_b32 v99, v97, v119
    v_and_b32 v96, v96, v116
    v_mfma_f32_16x16x32_bf16 v[64:67], a[32:35], a[100:103], v[64:67]
    v_and_b32 v97, v97, v117
    v_and_b32 v102, v100, v118
    v_and_b32 v103, v101, v119
    v_mfma_f32_16x16x32_bf16 v[72:75], a[36:39], a[100:103], v[72:75]
    v_and_b32 v100, v100, v116
    v_and_b32 v101, v101, v117
    s_waitcnt lgkmcnt(8)
    v_mfma_f32_16x16x32_bf16 v[60:63], a[40:43], a[104:107], v[60:63]
    s_lshl_b32 s36, s44, 6
    s_add_u32 s36, s36, 156160
    v_lshl_add_u32 v48, v2, 4, s36
    v_xor_b32 v49, 64, v48
    ds_read_b128 v[28:31], v48 offset:0
    v_mfma_f32_16x16x32_bf16 v[68:71], a[44:47], a[104:107], v[68:71]
    ds_read_b128 v[32:35], v48 offset:512
    ds_read_b128 v[36:39], v49 offset:0
    ds_read_b128 v[40:43], v49 offset:512
    s_lshl_b32 s36, s27, 3
    s_add_u32 s36, s36, 157696
    v_mfma_f32_16x16x32_bf16 v[64:67], a[40:43], a[108:111], v[64:67]
    v_lshl_add_u32 v48, v3, 4, s36
    v_mov_b32 v49, 157952
    v_lshl_add_u32 v125, v1, 3, s45
    s_lshl_b32 s36, s27, 10
    v_add_u32 v50, s36, v125
    v_mfma_f32_16x16x32_bf16 v[72:75], a[44:47], a[108:111], v[72:75]
    s_lshl_b32 s37, s27, 12
    s_sub_u32 s37, 2048, s37
    v_add_u32 v51, s37, v50
    v_subrev_u32 v125, 2048, v125
    s_setprio 0
    s_waitcnt lgkmcnt(8)
    v_mfma_f32_16x16x32_bf16 v[60:63], a[48:51], a[112:115], v[60:63]
    v_mfma_f32_16x16x32_bf16 v[68:71], a[52:55], a[112:115], v[68:71]
    v_mfma_f32_16x16x32_bf16 v[64:67], a[48:51], a[116:119], v[64:67]
    v_mfma_f32_16x16x32_bf16 v[72:75], a[52:55], a[116:119], v[72:75]
    s_waitcnt vmcnt(1)
Lfl_chk:
    v_cmp_eq_u32 vcc, s34, v20
    s_nop 0
    s_and_b32 s36, vcc_lo, 0x3ff
    s_cmp_lg_u32 s36, 0x3ff
    s_cbranch_scc1 Lfl_re
    buffer_load_dwordx2 v[52:53], v13, s[28:31], s59 offen offset:8 sc1
    buffer_load_dwordx2 v[54:55], v13, s[28:31], s60 offen offset:0 sc1
    s_waitcnt lgkmcnt(4)
    v_mfma_f32_16x16x32_bf16 v[60:63], a[56:59], a[120:123], v[60:63]
    v_mfma_f32_16x16x32_bf16 v[68:71], a[60:63], a[120:123], v[68:71]
    v_mfma_f32_16x16x32_bf16 v[64:67], a[56:59], a[124:127], v[64:67]
    v_mfma_f32_16x16x32_bf16 v[72:75], a[60:63], a[124:127], v[72:75]
    ds_read_b32 v46, v49
    ds_read_b64 v[44:45], v48
    s_waitcnt lgkmcnt(0)
Lcsv:
    v_readfirstlane_b32 s38, v46
    s_nop 0
    s_cmp_eq_u32 s38, 0
    s_cbranch_scc1 Lcsv_re
    v_fmac_f32 v60, v28, v44
    v_fmac_f32 v61, v29, v44
    v_fmac_f32 v62, v30, v44
    v_fmac_f32 v63, v31, v44
    v_mul_f32 v60, v60, v32
    v_mul_f32 v61, v61, v33
    v_mul_f32 v62, v62, v34
    v_mul_f32 v63, v63, v35
    v_cvt_pk_bf16_f32 v60, v60, v61
    v_cvt_pk_bf16_f32 v61, v62, v63
    ds_write_b64 v50, v[60:61] offset:0
    v_fmac_f32 v64, v28, v45
    v_fmac_f32 v65, v29, v45
    v_fmac_f32 v66, v30, v45
    v_fmac_f32 v67, v31, v45
    v_mul_f32 v64, v64, v32
    v_mul_f32 v65, v65, v33
    v_mul_f32 v66, v66, v34
    v_mul_f32 v67, v67, v35
    v_cvt_pk_bf16_f32 v64, v64, v65
    v_cvt_pk_bf16_f32 v65, v66, v67
    ds_write_b64 v50, v[64:65] offset:512
    v_fmac_f32 v68, v36, v44
    v_fmac_f32 v69, v37, v44
    v_fmac_f32 v70, v38, v44
    v_fmac_f32 v71, v39, v44
    v_mul_f32 v68, v68, v40
    v_mul_f32 v69, v69, v41
    v_mul_f32 v70, v70, v42
    v_mul_f32 v71, v71, v43
    v_cvt_pk_bf16_f32 v68, v68, v69
    v_cvt_pk_bf16_f32 v69, v70, v71
    ds_write_b64 v51, v[68:69] offset:0
    v_fmac_f32 v72, v36, v45
    v_fmac_f32 v73, v37, v45
    v_fmac_f32 v74, v38, v45
    v_fmac_f32 v75, v39, v45
    v_mul_f32 v72, v72, v40
    v_mul_f32 v73, v73, v41
    v_mul_f32 v74, v74, v42
    v_mul_f32 v75, v75, v43
    v_cvt_pk_bf16_f32 v72, v72, v73
    v_cvt_pk_bf16_f32 v73, v74, v75
    ds_write_b64 v51, v[72:73] offset:512
    v_mov_b32 v8, 157976
    v_mov_b32 v9, 1
    s_mov_b64 exec, 1
    ds_add_u32 v8, v9
    s_mov_b64 exec, -1
Lcw_4:
    s_sub_u32 s35, s35, 1
    s_cbranch_scc1 Lend
    ds_read_b32 v9, v8
    s_waitcnt lgkmcnt(0)
    v_readfirstlane_b32 s38, v9
    s_nop 0
    s_cmp_lt_u32 s38, 7
    s_cbranch_scc1 Lcw_4
    s_setprio 2
    ds_read2st64_b64 v[60:63], v125 offset0:0 offset1:4
    ds_read2st64_b64 v[64:67], v125 offset0:1 offset1:5
    ds_read2st64_b64 v[68:71], v125 offset0:2 offset1:6
    ds_read2st64_b64 v[72:75], v125 offset0:3 offset1:7
    v_mfma_f32_16x16x32_bf16 v[80:83], v[14:17], v[96:99], 0
    v_mfma_f32_16x16x32_bf16 v[84:87], v[14:17], v[100:103], 0
    v_and_b32 v6, 3, v1
    v_lshl_add_u32 v6, v6, 3, v19
    v_add_u32 v20, v6, v18
    v_xor_b32 v21, 32, v20
    v_xor_b32 v22, 64, v20
    v_xor_b32 v23, 96, v20
    s_waitcnt lgkmcnt(0)
    v_mfma_f32_16x16x32_bf16 v[28:31], v[60:63], v[96:99], 0
    v_add_u32 v24, 63616, v20
    v_mfma_f32_16x16x32_bf16 v[40:43], v[72:75], v[100:103], 0
    v_add_u32 v25, 63616, v21
    v_mfma_f32_16x16x32_bf16 v[32:35], v[64:67], v[96:99], 0
    v_add_u32 v26, 63616, v22
    v_mfma_f32_16x16x32_bf16 v[36:39], v[68:71], v[100:103], 0
    v_add_u32 v27, 63616, v23
    v_rcp_f32 v80, v80
    v_rcp_f32 v84, v84
    v_mul_f32 v28, v28, v80
    v_mul_f32 v29, v29, v80
    v_mul_f32 v30, v30, v80
    v_mul_f32 v31, v31, v80
    v_cvt_pk_bf16_f32 v8, v28, v29
    v_cvt_pk_bf16_f32 v9, v30, v31
    v_min_u32 v8, -2, v8
    v_min_u32 v9, -2, v9
    v_mul_f32 v40, v40, v84
    v_mul_f32 v41, v41, v84
    v_mul_f32 v42, v42, v84
    v_mul_f32 v43, v43, v84
    v_cvt_pk_bf16_f32 v10, v40, v41
    v_cvt_pk_bf16_f32 v11, v42, v43
    v_min_u32 v10, -2, v10
    v_min_u32 v11, -2, v11
    buffer_store_dwordx4 v[8:11], v13, s[28:31], s23 offen sc0 sc1
    s_waitcnt vmcnt(1)
Lrx_chk:
    v_and_b32 v52, s61, v52
    v_and_b32 v53, s61, v53
    v_and_b32 v54, s62, v54
    v_and_b32 v55, s62, v55
    v_max3_u32 v4, v52, v53, v54
    v_max_u32 v4, v4, v55
    v_cmp_eq_u32 vcc, -1, v4
    s_nop 0
    s_cbranch_vccnz Lrx_re
    v_add_f32 v92, v92, v52
    v_add_f32 v94, v94, v53
    v_add_f32 v104, v104, v54
    v_add_f32 v106, v106, v55
    v_mul_f32 v92, v92, v123
    v_mul_f32 v94, v94, v126
    v_mul_f32 v104, v104, v123
    v_mul_f32 v106, v106, v126
    v_max_f32 v4, v92, v94
    v_max_f32 v5, v104, v106
    v_mov_b32 v6, v4
    v_mov_b32 v7, v5
    s_nop 0
    v_permlane32_swap_b32 v4, v6
    v_permlane32_swap_b32 v5, v7
    v_max_f32 v4, v4, v6
    v_max_f32 v5, v5, v7
    v_mov_b32 v6, v4
    v_mov_b32 v7, v5
    s_nop 0
    v_permlane16_swap_b32 v4, v6
    v_permlane16_swap_b32 v5, v7
    v_max_f32 v4, v4, v6
    v_max_f32 v5, v5, v7
    v_sub_f32 v92, v92, v4
    v_sub_f32 v94, v94, v4
    v_sub_f32 v104, v104, v5
    v_sub_f32 v106, v106, v5
    v_exp_f32 v92, v92
    v_exp_f32 v94, v94
    v_exp_f32 v104, v104
    v_exp_f32 v106, v106
    v_cvt_pk_bf16_f32 v92, v92, v92
    v_cvt_pk_bf16_f32 v93, v94, v94
    v_cvt_pk_bf16_f32 v104, v104, v104
    v_cvt_pk_bf16_f32 v105, v106, v106
    v_and_b32 v94, v92, v118
    v_and_b32 v95, v93, v119
    v_and_b32 v92, v92, v116
    v_and_b32 v93, v93, v117
    v_and_b32 v106, v104, v118
    v_and_b32 v107, v105, v119
    v_and_b32 v104, v104, v116
    v_and_b32 v105, v105, v117
    v_mfma_f32_16x16x32_bf16 v[76:79], v[14:17], v[92:95], 0
    s_nop 0
    v_mfma_f32_16x16x32_bf16 v[88:91], v[14:17], v[104:107], 0
    v_mfma_f32_16x16x32_bf16 v[44:47], v[64:67], v[92:95], 0
    v_mfma_f32_16x16x32_bf16 v[48:51], v[68:71], v[92:95], 0
    v_mfma_f32_16x16x32_bf16 v[52:55], v[64:67], v[104:107], 0
    v_mfma_f32_16x16x32_bf16 v[56:59], v[68:71], v[104:107], 0
    s_nop 1
    v_rcp_f32 v76, v76
    s_nop 0
    v_rcp_f32 v88, v88
    v_cndmask_b32 v82, v80, v76, s[6:7]
    v_cndmask_b32 v82, v82, v88, s[8:9]
    v_cndmask_b32 v32, v32, v44, s[6:7]
    v_cndmask_b32 v33, v33, v45, s[6:7]
    v_cndmask_b32 v34, v34, v46, s[6:7]
    v_cndmask_b32 v35, v35, v47, s[6:7]
    v_cndmask_b32 v32, v32, v52, s[8:9]
    v_cndmask_b32 v33, v33, v53, s[8:9]
    v_cndmask_b32 v34, v34, v54, s[8:9]
    v_cndmask_b32 v35, v35, v55, s[8:9]
    v_mul_f32 v32, v32, v82
    v_mul_f32 v33, v33, v82
    v_mul_f32 v34, v34, v82
    v_mul_f32 v35, v35, v82
    v_cvt_pk_bf16_f32 v4, v32, v33
    v_cvt_pk_bf16_f32 v5, v34, v35
    v_min_u32 v4, -2, v4
    v_min_u32 v5, -2, v5
    v_cndmask_b32 v86, v84, v76, s[12:13]
    v_cndmask_b32 v86, v86, v88, s[14:15]
    v_cndmask_b32 v36, v36, v48, s[12:13]
    v_cndmask_b32 v37, v37, v49, s[12:13]
    v_cndmask_b32 v38, v38, v50, s[12:13]
    v_cndmask_b32 v39, v39, v51, s[12:13]
    v_cndmask_b32 v36, v36, v56, s[14:15]
    v_cndmask_b32 v37, v37, v57, s[14:15]
    v_cndmask_b32 v38, v38, v58, s[14:15]
    v_cndmask_b32 v39, v39, v59, s[14:15]
    v_mul_f32 v36, v36, v86
    v_mul_f32 v37, v37, v86
    v_mul_f32 v38, v38, v86
    v_mul_f32 v39, v39, v86
    v_cvt_pk_bf16_f32 v6, v36, v37
    v_cvt_pk_bf16_f32 v7, v38, v39
    v_min_u32 v6, -2, v6
    v_min_u32 v7, -2, v7
    buffer_store_dwordx4 v[4:7], v13, s[28:31], s23 offen offset:1024 sc0 sc1
    s_setprio 1
    v_mov_b32 v10, 157980
Lcw_3:
    s_sub_u32 s35, s35, 1
    s_cbranch_scc1 Lend
    ds_read_b32 v11, v10
    s_waitcnt lgkmcnt(0)
    v_readfirstlane_b32 s38, v11
    s_nop 0
    s_cmp_lt_u32 s38, 2
    s_cbranch_scc1 Lcw_3
    s_mul_i32 s36, s32, 96
    s_lshl_b32 s37, s44, 4
    s_add_u32 s36, s36, s37
    s_sub_u32 s36, s36, 32
    v_add_u32 v126, s36, v3
    v_lshrrev_b32 v6, 3, v1
    v_add_u32 v6, s36, v6
    v_mul_u32_u24 v6, 1280, v6
    v_and_b32 v7, 7, v1
    v_xor_b32 v7, v7, v2
    v_lshl_add_u32 v122, v7, 4, v6
    v_xor_b32 v123, 64, v122
    v_add_u32 v123, 10240, v123
    s_lshl_b32 s36, s44, 11
    s_add_u32 s36, s36, 102656
    v_add_u32 v124, s36, v124
    v_add_u32 v125, s36, v13
    s_lshl_b32 s24, s33, 7
    v_mov_b32 v10, 157960
    s_mov_b32 s41, 0
    s_mov_b32 s47, 3
    v_lshlrev_b32 v28, 16, v108
    ds_read_b64_tr_b16 a[0:1], v20 offset:0
    ds_read_b64_tr_b16 a[2:3], v20 offset:512
    ds_read_b64_tr_b16 a[4:5], v21 offset:0
    ds_read_b64_tr_b16 a[6:7], v21 offset:512
    ds_read_b64_tr_b16 a[8:9], v22 offset:0
    ds_read_b64_tr_b16 a[10:11], v22 offset:512
    ds_read_b64_tr_b16 a[12:13], v23 offset:0
    ds_read_b64_tr_b16 a[14:15], v23 offset:512
    v_and_b32 v29, 0xffff0000, v108
    v_lshlrev_b32 v30, 16, v109
    v_and_b32 v31, 0xffff0000, v109
    v_lshlrev_b32 v32, 16, v110
    v_and_b32 v33, 0xffff0000, v110
    v_lshlrev_b32 v34, 16, v111
    v_and_b32 v35, 0xffff0000, v111
    v_lshlrev_b32 v36, 16, v112
    v_and_b32 v37, 0xffff0000, v112
    v_lshlrev_b32 v38, 16, v113
    v_and_b32 v39, 0xffff0000, v113
    v_lshlrev_b32 v40, 16, v114
    v_and_b32 v41, 0xffff0000, v114
    v_lshlrev_b32 v42, 16, v115
    ds_read_b64_tr_b16 a[16:17], v20 offset:4096
    ds_read_b64_tr_b16 a[18:19], v20 offset:4608
    ds_read_b64_tr_b16 a[20:21], v21 offset:4096
    ds_read_b64_tr_b16 a[22:23], v21 offset:4608
    ds_read_b64_tr_b16 a[24:25], v22 offset:4096
    ds_read_b64_tr_b16 a[26:27], v22 offset:4608
    ds_read_b64_tr_b16 a[28:29], v23 offset:4096
    ds_read_b64_tr_b16 a[30:31], v23 offset:4608
    v_and_b32 v43, 0xffff0000, v115
    v_mul_f32 v4, v120, v121
    v_mul_f32 v5, 0xbfb8aa3b, v121
    v_mul_f32 v6, 0xbfb8aa3b, v4
    v_fma_f32 v44, v28, v5, v6
    v_fma_f32 v45, v29, v5, v6
    v_fma_f32 v46, v30, v5, v6
    v_fma_f32 v47, v31, v5, v6
    v_fma_f32 v48, v32, v5, v6
    v_fma_f32 v49, v33, v5, v6
    v_fma_f32 v50, v34, v5, v6
    v_fma_f32 v51, v35, v5, v6
    v_fma_f32 v52, v36, v5, v6
    v_fma_f32 v53, v37, v5, v6
    ds_read_b64_tr_b16 a[32:33], v20 offset:8192
    ds_read_b64_tr_b16 a[34:35], v20 offset:8704
    ds_read_b64_tr_b16 a[36:37], v21 offset:8192
    ds_read_b64_tr_b16 a[38:39], v21 offset:8704
    ds_read_b64_tr_b16 a[40:41], v22 offset:8192
    ds_read_b64_tr_b16 a[42:43], v22 offset:8704
    ds_read_b64_tr_b16 a[44:45], v23 offset:8192
    ds_read_b64_tr_b16 a[46:47], v23 offset:8704
    v_fma_f32 v54, v38, v5, v6
    v_fma_f32 v55, v39, v5, v6
    v_fma_f32 v56, v40, v5, v6
    v_fma_f32 v57, v41, v5, v6
    v_fma_f32 v58, v42, v5, v6
    v_fma_f32 v59, v43, v5, v6
    v_exp_f32 v44, v44
    v_exp_f32 v45, v45
    v_exp_f32 v46, v46
    v_exp_f32 v47, v47
    v_exp_f32 v48, v48
    v_exp_f32 v49, v49
    v_exp_f32 v50, v50
    v_exp_f32 v51, v51
    v_exp_f32 v52, v52
    ds_read_b64_tr_b16 a[48:49], v20 offset:12288
    ds_read_b64_tr_b16 a[50:51], v20 offset:12800
    ds_read_b64_tr_b16 a[52:53], v21 offset:12288
    ds_read_b64_tr_b16 a[54:55], v21 offset:12800
    ds_read_b64_tr_b16 a[56:57], v22 offset:12288
    ds_read_b64_tr_b16 a[58:59], v22 offset:12800
    ds_read_b64_tr_b16 a[60:61], v23 offset:12288
    ds_read_b64_tr_b16 a[62:63], v23 offset:12800
    v_exp_f32 v53, v53
    v_exp_f32 v54, v54
    v_exp_f32 v55, v55
    v_exp_f32 v56, v56
    v_exp_f32 v57, v57
    v_exp_f32 v58, v58
    v_exp_f32 v59, v59
    v_add_f32 v44, 1.0, v44
    v_add_f32 v45, 1.0, v45
    buffer_load_dwordx4 v[60:63], v13, s[28:31], s53 offen offset:0 sc1
    buffer_load_dwordx4 v[64:67], v13, s[28:31], s53 offen offset:2048 sc1
    buffer_load_dwordx4 v[68:71], v13, s[28:31], s54 offen offset:0 sc1
    buffer_load_dwordx4 v[72:75], v13, s[28:31], s54 offen offset:2048 sc1
    buffer_load_dwordx4 v[92:95], v13, s[28:31], s55 offen offset:0 sc1
    buffer_load_dwordx4 v[96:99], v13, s[28:31], s55 offen offset:2048 sc1
    buffer_load_dwordx4 v[100:103], v13, s[28:31], s56 offen offset:0 sc1
    buffer_load_dwordx4 v[104:107], v13, s[28:31], s56 offen offset:2048 sc1
    s_setprio 0
    v_add_f32 v46, 1.0, v46
    v_add_f32 v47, 1.0, v47
    v_add_f32 v48, 1.0, v48
    v_add_f32 v49, 1.0, v49
    v_add_f32 v50, 1.0, v50
    ds_read_b64_tr_b16 a[64:65], v20 offset:24576
    ds_read_b64_tr_b16 a[66:67], v20 offset:25088
    ds_read_b64_tr_b16 a[68:69], v21 offset:24576
    ds_read_b64_tr_b16 a[70:71], v21 offset:25088
    ds_read_b64_tr_b16 a[72:73], v22 offset:24576
    ds_read_b64_tr_b16 a[74:75], v22 offset:25088
    ds_read_b64_tr_b16 a[76:77], v23 offset:24576
    ds_read_b64_tr_b16 a[78:79], v23 offset:25088
    v_add_f32 v51, 1.0, v51
    v_add_f32 v52, 1.0, v52
    v_add_f32 v53, 1.0, v53
    v_add_f32 v54, 1.0, v54
    v_add_f32 v55, 1.0, v55
    v_add_f32 v56, 1.0, v56
    v_add_f32 v57, 1.0, v57
    v_add_f32 v58, 1.0, v58
    v_add_f32 v59, 1.0, v59
    v_rcp_f32 v44, v44
    v_rcp_f32 v45, v45
    v_rcp_f32 v46, v46
    v_rcp_f32 v47, v47
    v_rcp_f32 v48, v48
    ds_read_b64_tr_b16 a[80:81], v20 offset:28672
    ds_read_b64_tr_b16 a[82:83], v20 offset:29184
    ds_read_b64_tr_b16 a[84:85], v21 offset:28672
    ds_read_b64_tr_b16 a[86:87], v21 offset:29184
    ds_read_b64_tr_b16 a[88:89], v22 offset:28672
    ds_read_b64_tr_b16 a[90:91], v22 offset:29184
    ds_read_b64_tr_b16 a[92:93], v23 offset:28672
    ds_read_b64_tr_b16 a[94:95], v23 offset:29184
    v_rcp_f32 v49, v49
    v_rcp_f32 v50, v50
    v_rcp_f32 v51, v51
    v_rcp_f32 v52, v52
    v_rcp_f32 v53, v53
    v_rcp_f32 v54, v54
    v_rcp_f32 v55, v55
    v_rcp_f32 v56, v56
    v_rcp_f32 v57, v57
    v_rcp_f32 v58, v58
    v_rcp_f32 v59, v59
    v_fma_f32 v7, v28, v121, v4
    v_mul_f32 v44, v44, v7
    v_fma_f32 v11, v29, v121, v4
    v_mul_f32 v45, v45, v11
    ds_read_b64_tr_b16 a[96:97], v24 offset:59520
    ds_read_b64_tr_b16 a[98:99], v24 offset:60032
    ds_read_b64_tr_b16 a[100:101], v25 offset:59520
    ds_read_b64_tr_b16 a[102:103], v25 offset:60032
    ds_read_b64_tr_b16 a[104:105], v26 offset:59520
    ds_read_b64_tr_b16 a[106:107], v26 offset:60032
    ds_read_b64_tr_b16 a[108:109], v27 offset:59520
    ds_read_b64_tr_b16 a[110:111], v27 offset:60032
    v_fma_f32 v7, v30, v121, v4
    v_mul_f32 v46, v46, v7
    v_fma_f32 v11, v31, v121, v4
    v_mul_f32 v47, v47, v11
    v_fma_f32 v7, v32, v121, v4
    v_mul_f32 v48, v48, v7
    v_fma_f32 v11, v33, v121, v4
    v_mul_f32 v49, v49, v11
    v_fma_f32 v7, v34, v121, v4
    v_mul_f32 v50, v50, v7
    v_fma_f32 v11, v35, v121, v4
    v_mul_f32 v51, v51, v11
    v_fma_f32 v7, v36, v121, v4
    v_mul_f32 v52, v52, v7
    ds_read_b64_tr_b16 a[112:113], v24 offset:63616
    ds_read_b64_tr_b16 a[114:115], v24 offset:64128
    ds_read_b64_tr_b16 a[116:117], v25 offset:63616
    ds_read_b64_tr_b16 a[118:119], v25 offset:64128
    ds_read_b64_tr_b16 a[120:121], v26 offset:63616
    ds_read_b64_tr_b16 a[122:123], v26 offset:64128
    ds_read_b64_tr_b16 a[124:125], v27 offset:63616
    ds_read_b64_tr_b16 a[126:127], v27 offset:64128
    v_fma_f32 v11, v37, v121, v4
    v_mul_f32 v53, v53, v11
    v_fma_f32 v7, v38, v121, v4
    v_mul_f32 v54, v54, v7
    v_fma_f32 v11, v39, v121, v4
    v_mul_f32 v55, v55, v11
    v_fma_f32 v7, v40, v121, v4
    v_mul_f32 v56, v56, v7
    v_fma_f32 v11, v41, v121, v4
    v_mul_f32 v57, v57, v11
    v_fma_f32 v7, v42, v121, v4
    v_mul_f32 v58, v58, v7
    v_fma_f32 v11, v43, v121, v4
    v_mul_f32 v59, v59, v11
Lwo_go:
    s_setprio 3
    ds_read_b64 v[8:9], v10
    s_waitcnt vmcnt(6)
    v_max3_u32 v18, v60, v61, v62
    v_max3_u32 v19, v64, v65, v66
    v_max3_u32 v18, v18, v63, v67
    v_max_u32 v18, v18, v19
    v_cmp_eq_u32 vcc, -1, v18
    s_nop 0
    s_cbranch_vccnz Lre_0
Lck_0:
    s_waitcnt lgkmcnt(15)
    v_mfma_f32_16x16x32_bf16 v[108:111], a[0:3], v[60:63], 0
    ds_read_b64_tr_b16 a[0:1], v24 offset:16384
    ds_read_b64_tr_b16 a[2:3], v24 offset:16896
    buffer_load_dwordx4 v[76:79], v13, s[28:31], s57 offen offset:0 sc1
    v_mfma_f32_16x16x32_bf16 v[112:115], a[4:7], v[60:63], 0
    ds_read_b64_tr_b16 a[4:5], v25 offset:16384
    ds_read_b64_tr_b16 a[6:7], v25 offset:16896
    v_mfma_f32_16x16x32_bf16 v[116:119], a[8:11], v[60:63], 0
    ds_read_b64_tr_b16 a[8:9], v26 offset:16384
    buffer_load_dwordx4 v[80:83], v13, s[28:31], s57 offen offset:2048 sc1
    v_mfma_f32_16x16x32_bf16 v[14:17], a[12:15], v[60:63], 0
    ds_read_b64_tr_b16 a[10:11], v26 offset:16896
    ds_read_b64_tr_b16 a[12:13], v27 offset:16384
    v_mfma_f32_16x16x32_bf16 v[108:111], a[16:19], v[64:67], v[108:111]
    ds_read_b64_tr_b16 a[14:15], v27 offset:16896
    s_waitcnt vmcnt(6)
    v_max3_u32 v18, v68, v69, v70
    v_mfma_f32_16x16x32_bf16 v[112:115], a[20:23], v[64:67], v[112:115]
    ds_read_b64_tr_b16 a[16:17], v24 offset:20480
    ds_read_b64_tr_b16 a[18:19], v24 offset:20992
    v_max3_u32 v19, v72, v73, v74
    v_max3_u32 v18, v18, v71, v75
    v_mfma_f32_16x16x32_bf16 v[116:119], a[24:27], v[64:67], v[116:119]
    ds_read_b64_tr_b16 a[20:21], v25 offset:20480
    ds_read_b64_tr_b16 a[22:23], v25 offset:20992
    v_max_u32 v18, v18, v19
    v_cmp_eq_u32 vcc, -1, v18
    v_mfma_f32_16x16x32_bf16 v[14:17], a[28:31], v[64:67], v[14:17]
    ds_read_b64_tr_b16 a[24:25], v26 offset:20480
    s_cbranch_vccnz Lre_1
Lck_1:
    s_waitcnt lgkmcnt(13)
Linfo:
    v_readfirstlane_b32 s39, v8
    s_nop 0
    s_cmp_eq_u32 s39, -2
    s_cbranch_scc1 Linfo_re
    v_mfma_f32_16x16x32_bf16 v[108:111], a[32:35], v[68:71], v[108:111]
    ds_read_b64_tr_b16 a[26:27], v26 offset:20992
    ds_read_b64_tr_b16 a[28:29], v27 offset:20480
    buffer_load_dwordx4 v[84:87], v13, s[28:31], s53 offen offset:1024 sc1
    v_mfma_f32_16x16x32_bf16 v[112:115], a[36:39], v[68:71], v[112:115]
    ds_read_b64_tr_b16 a[30:31], v27 offset:20992
    v_mfma_f32_16x16x32_bf16 v[116:119], a[40:43], v[68:71], v[116:119]
    ds_read_b64_tr_b16 a[32:33], v20 offset:32768
    ds_read_b64_tr_b16 a[34:35], v20 offset:33280
    buffer_load_dwordx4 v[88:91], v13, s[28:31], s53 offen offset:3072 sc1
    v_mfma_f32_16x16x32_bf16 v[14:17], a[44:47], v[68:71], v[14:17]
    ds_read_b64_tr_b16 a[36:37], v21 offset:32768
    ds_read_b64_tr_b16 a[38:39], v21 offset:33280
    v_mfma_f32_16x16x32_bf16 v[108:111], a[48:51], v[72:75], v[108:111]
    ds_read_b64_tr_b16 a[40:41], v22 offset:32768
    s_waitcnt vmcnt(6)
    v_max3_u32 v18, v92, v93, v94
    v_mfma_f32_16x16x32_bf16 v[112:115], a[52:55], v[72:75], v[112:115]
    ds_read_b64_tr_b16 a[42:43], v22 offset:33280
    ds_read_b64_tr_b16 a[44:45], v23 offset:32768
    v_max3_u32 v19, v96, v97, v98
    v_max3_u32 v18, v18, v95, v99
    v_mfma_f32_16x16x32_bf16 v[116:119], a[56:59], v[72:75], v[116:119]
    ds_read_b64_tr_b16 a[46:47], v23 offset:33280
    v_max_u32 v18, v18, v19
    v_cmp_eq_u32 vcc, -1, v18
    v_mfma_f32_16x16x32_bf16 v[14:17], a[60:63], v[72:75], v[14:17]
    ds_read_b64_tr_b16 a[48:49], v20 offset:36864
    ds_read_b64_tr_b16 a[50:51], v20 offset:37376
    s_cbranch_vccnz Lre_2
Lck_2:
    v_mfma_f32_16x16x32_bf16 v[108:111], a[64:67], v[92:95], v[108:111]
    ds_read_b64_tr_b16 a[52:53], v21 offset:36864
    ds_read_b64_tr_b16 a[54:55], v21 offset:37376
    buffer_load_dwordx4 v[60:63], v13, s[28:31], s54 offen offset:1024 sc1
    v_mfma_f32_16x16x32_bf16 v[112:115], a[68:71], v[92:95], v[112:115]
    ds_read_b64_tr_b16 a[56:57], v22 offset:36864
    v_mfma_f32_16x16x32_bf16 v[116:119], a[72:75], v[92:95], v[116:119]
    ds_read_b64_tr_b16 a[58:59], v22 offset:37376
    ds_read_b64_tr_b16 a[60:61], v23 offset:36864
    buffer_load_dwordx4 v[64:67], v13, s[28:31], s54 offen offset:3072 sc1
    v_mfma_f32_16x16x32_bf16 v[14:17], a[76:79], v[92:95], v[14:17]
    ds_read_b64_tr_b16 a[62:63], v23 offset:37376
    v_mfma_f32_16x16x32_bf16 v[108:111], a[80:83], v[96:99], v[108:111]
    ds_read_b64_tr_b16 a[64:65], v20 offset:40960
    ds_read_b64_tr_b16 a[66:67], v20 offset:41472
    s_waitcnt vmcnt(6)
    v_max3_u32 v18, v100, v101, v102
    v_mfma_f32_16x16x32_bf16 v[112:115], a[84:87], v[96:99], v[112:115]
    ds_read_b64_tr_b16 a[68:69], v21 offset:40960
    ds_read_b64_tr_b16 a[70:71], v21 offset:41472
    v_max3_u32 v19, v104, v105, v106
    v_max3_u32 v18, v18, v103, v107
    v_mfma_f32_16x16x32_bf16 v[116:119], a[88:91], v[96:99], v[116:119]
    ds_read_b64_tr_b16 a[72:73], v22 offset:40960
    v_max_u32 v18, v18, v19
    v_cmp_eq_u32 vcc, -1, v18
    v_mfma_f32_16x16x32_bf16 v[14:17], a[92:95], v[96:99], v[14:17]
    ds_read_b64_tr_b16 a[74:75], v22 offset:41472
    ds_read_b64_tr_b16 a[76:77], v23 offset:40960
    s_cbranch_vccnz Lre_3
Lck_3:
    s_setprio 2
    v_mfma_f32_16x16x32_bf16 v[108:111], a[96:99], v[100:103], v[108:111]
    ds_read_b64_tr_b16 a[78:79], v23 offset:41472
    buffer_load_dwordx4 v[68:71], v13, s[28:31], s55 offen offset:1024 sc1
    v_mfma_f32_16x16x32_bf16 v[112:115], a[100:103], v[100:103], v[112:115]
    ds_read_b64_tr_b16 a[80:81], v20 offset:45056
    ds_read_b64_tr_b16 a[82:83], v20 offset:45568
    v_mfma_f32_16x16x32_bf16 v[116:119], a[104:107], v[100:103], v[116:119]
    ds_read_b64_tr_b16 a[84:85], v21 offset:45056
    ds_read_b64_tr_b16 a[86:87], v21 offset:45568
    buffer_load_dwordx4 v[72:75], v13, s[28:31], s55 offen offset:3072 sc1
    v_mfma_f32_16x16x32_bf16 v[14:17], a[108:111], v[100:103], v[14:17]
    ds_read_b64_tr_b16 a[88:89], v22 offset:45056
    v_mfma_f32_16x16x32_bf16 v[108:111], a[112:115], v[104:107], v[108:111]
    ds_read_b64_tr_b16 a[90:91], v22 offset:45568
    ds_read_b64_tr_b16 a[92:93], v23 offset:45056
    s_waitcnt vmcnt(6)
    v_max3_u32 v18, v76, v77, v78
    v_mfma_f32_16x16x32_bf16 v[112:115], a[116:119], v[104:107], v[112:115]
    ds_read_b64_tr_b16 a[94:95], v23 offset:45568
    v_max3_u32 v19, v80, v81, v82
    v_max3_u32 v18, v18, v79, v83
    v_mfma_f32_16x16x32_bf16 v[116:119], a[120:123], v[104:107], v[116:119]
    ds_read_b64_tr_b16 a[96:97], v24 offset:0
    ds_read_b64_tr_b16 a[98:99], v24 offset:512
    v_max_u32 v18, v18, v19
    v_cmp_eq_u32 vcc, -1, v18
    v_mfma_f32_16x16x32_bf16 v[14:17], a[124:127], v[104:107], v[14:17]
    ds_read_b64_tr_b16 a[100:101], v25 offset:0
    ds_read_b64_tr_b16 a[102:103], v25 offset:512
    s_cbranch_vccnz Lre_4
Lck_4:
    s_waitcnt lgkmcnt(15)
    v_mfma_f32_16x16x32_bf16 v[108:111], a[0:3], v[76:79], v[108:111]
    ds_read_b64_tr_b16 a[104:105], v26 offset:0
    buffer_load_dwordx4 v[92:95], v13, s[28:31], s56 offen offset:1024 sc1
    v_mfma_f32_16x16x32_bf16 v[112:115], a[4:7], v[76:79], v[112:115]
    ds_read_b64_tr_b16 a[106:107], v26 offset:512
    ds_read_b64_tr_b16 a[108:109], v27 offset:0
    v_mfma_f32_16x16x32_bf16 v[116:119], a[8:11], v[76:79], v[116:119]
    ds_read_b64_tr_b16 a[110:111], v27 offset:512
    buffer_load_dwordx4 v[96:99], v13, s[28:31], s56 offen offset:3072 sc1
    v_mfma_f32_16x16x32_bf16 v[14:17], a[12:15], v[76:79], v[14:17]
    ds_read_b64_tr_b16 a[112:113], v24 offset:4096
    ds_read_b64_tr_b16 a[114:115], v24 offset:4608
    v_mfma_f32_16x16x32_bf16 v[108:111], a[16:19], v[80:83], v[108:111]
    ds_read_b64_tr_b16 a[116:117], v25 offset:4096
    ds_read_b64_tr_b16 a[118:119], v25 offset:4608
    s_waitcnt vmcnt(6)
    v_max3_u32 v18, v84, v85, v86
    v_mfma_f32_16x16x32_bf16 v[112:115], a[20:23], v[80:83], v[112:115]
    ds_read_b64_tr_b16 a[120:121], v26 offset:4096
    v_max3_u32 v19, v88, v89, v90
    v_max3_u32 v18, v18, v87, v91
    v_mfma_f32_16x16x32_bf16 v[116:119], a[24:27], v[80:83], v[116:119]
    ds_read_b64_tr_b16 a[122:123], v26 offset:4608
    ds_read_b64_tr_b16 a[124:125], v27 offset:4096
    v_max_u32 v18, v18, v19
    v_cmp_eq_u32 vcc, -1, v18
    v_mfma_f32_16x16x32_bf16 v[14:17], a[28:31], v[80:83], v[14:17]
    ds_read_b64_tr_b16 a[126:127], v27 offset:4608
    s_cbranch_vccnz Lre_5
Lck_5:
    v_mfma_f32_16x16x32_bf16 v[108:111], a[32:35], v[84:87], v[108:111]
    ds_read_b64_tr_b16 a[0:1], v24 offset:8192
    ds_read_b64_tr_b16 a[2:3], v24 offset:8704
    buffer_load_dwordx4 v[100:103], v13, s[28:31], s57 offen offset:1024 sc1
    v_mfma_f32_16x16x32_bf16 v[112:115], a[36:39], v[84:87], v[112:115]
    ds_read_b64_tr_b16 a[4:5], v25 offset:8192
    ds_read_b64_tr_b16 a[6:7], v25 offset:8704
    v_mfma_f32_16x16x32_bf16 v[116:119], a[40:43], v[84:87], v[116:119]
    ds_read_b64_tr_b16 a[8:9], v26 offset:8192
    buffer_load_dwordx4 v[104:107], v13, s[28:31], s57 offen offset:3072 sc1
    v_mfma_f32_16x16x32_bf16 v[14:17], a[44:47], v[84:87], v[14:17]
    ds_read_b64_tr_b16 a[10:11], v26 offset:8704
    ds_read_b64_tr_b16 a[12:13], v27 offset:8192
    v_mfma_f32_16x16x32_bf16 v[108:111], a[48:51], v[88:91], v[108:111]
    ds_read_b64_tr_b16 a[14:15], v27 offset:8704
    s_waitcnt vmcnt(6)
    v_max3_u32 v18, v60, v61, v62
    v_mfma_f32_16x16x32_bf16 v[112:115], a[52:55], v[88:91], v[112:115]
    ds_read_b64_tr_b16 a[16:17], v24 offset:12288
    ds_read_b64_tr_b16 a[18:19], v24 offset:12800
    v_max3_u32 v19, v64, v65, v66
    v_max3_u32 v18, v18, v63, v67
    v_mfma_f32_16x16x32_bf16 v[116:119], a[56:59], v[88:91], v[116:119]
    ds_read_b64_tr_b16 a[20:21], v25 offset:12288
    ds_read_b64_tr_b16 a[22:23], v25 offset:12800
    v_max_u32 v18, v18, v19
    v_cmp_eq_u32 vcc, -1, v18
    v_mfma_f32_16x16x32_bf16 v[14:17], a[60:63], v[88:91], v[14:17]
    ds_read_b64_tr_b16 a[24:25], v26 offset:12288
    s_cbranch_vccnz Lre_6
Lck_6:
    s_setprio 1
    s_waitcnt lgkmcnt(15)
    v_mfma_f32_16x16x32_bf16 v[108:111], a[64:67], v[60:63], v[108:111]
    ds_read_b64_tr_b16 a[26:27], v26 offset:12800
    ds_read_b64_tr_b16 a[28:29], v27 offset:12288
    v_mfma_f32_16x16x32_bf16 v[112:115], a[68:71], v[60:63], v[112:115]
    ds_read_b64_tr_b16 a[30:31], v27 offset:12800
    v_mfma_f32_16x16x32_bf16 v[116:119], a[72:75], v[60:63], v[116:119]
    ds_read_b64_tr_b16 a[32:33], v20 offset:49152
    ds_read_b64_tr_b16 a[34:35], v20 offset:49664
    v_mfma_f32_16x16x32_bf16 v[14:17], a[76:79], v[60:63], v[14:17]
    ds_read_b64_tr_b16 a[36:37], v21 offset:49152
    ds_read_b64_tr_b16 a[38:39], v21 offset:49664
    v_mfma_f32_16x16x32_bf16 v[108:111], a[80:83], v[64:67], v[108:111]
    ds_read_b64_tr_b16 a[40:41], v22 offset:49152
    s_waitcnt vmcnt(4)
    v_max3_u32 v18, v68, v69, v70
    v_mfma_f32_16x16x32_bf16 v[112:115], a[84:87], v[64:67], v[112:115]
    ds_read_b64_tr_b16 a[42:43], v22 offset:49664
    ds_read_b64_tr_b16 a[44:45], v23 offset:49152
    v_max3_u32 v19, v72, v73, v74
    v_max3_u32 v18, v18, v71, v75
    v_mfma_f32_16x16x32_bf16 v[116:119], a[88:91], v[64:67], v[116:119]
    ds_read_b64_tr_b16 a[46:47], v23 offset:49664
    v_max_u32 v18, v18, v19
    v_cmp_eq_u32 vcc, -1, v18
    v_mfma_f32_16x16x32_bf16 v[14:17], a[92:95], v[64:67], v[14:17]
    ds_read_b64_tr_b16 a[48:49], v24 offset:24576
    ds_read_b64_tr_b16 a[50:51], v24 offset:25088
    s_cbranch_vccnz Lre_7
Lck_7:
    v_mfma_f32_16x16x32_bf16 v[108:111], a[96:99], v[68:71], v[108:111]
    ds_read_b64_tr_b16 a[52:53], v25 offset:24576
    ds_read_b64_tr_b16 a[54:55], v25 offset:25088
    v_mfma_f32_16x16x32_bf16 v[112:115], a[100:103], v[68:71], v[112:115]
    ds_read_b64_tr_b16 a[56:57], v26 offset:24576
    v_mfma_f32_16x16x32_bf16 v[116:119], a[104:107], v[68:71], v[116:119]
    ds_read_b64_tr_b16 a[58:59], v26 offset:25088
    ds_read_b64_tr_b16 a[60:61], v27 offset:24576
    v_mfma_f32_16x16x32_bf16 v[14:17], a[108:111], v[68:71], v[14:17]
    ds_read_b64_tr_b16 a[62:63], v27 offset:25088
    s_waitcnt lgkmcnt(15)
    v_mfma_f32_16x16x32_bf16 v[108:111], a[112:115], v[72:75], v[108:111]
    s_waitcnt vmcnt(2)
    v_max3_u32 v18, v92, v93, v94
    v_mfma_f32_16x16x32_bf16 v[112:115], a[116:119], v[72:75], v[112:115]
    v_max3_u32 v19, v96, v97, v98
    v_max3_u32 v18, v18, v95, v99
    v_mfma_f32_16x16x32_bf16 v[116:119], a[120:123], v[72:75], v[116:119]
    v_max_u32 v18, v18, v19
    v_cmp_eq_u32 vcc, -1, v18
    v_mfma_f32_16x16x32_bf16 v[14:17], a[124:127], v[72:75], v[14:17]
    s_cbranch_vccnz Lre_8
Lck_8:
    s_setprio 0
    v_mfma_f32_16x16x32_bf16 v[108:111], a[0:3], v[92:95], v[108:111]
    v_mfma_f32_16x16x32_bf16 v[112:115], a[4:7], v[92:95], v[112:115]
    v_mfma_f32_16x16x32_bf16 v[116:119], a[8:11], v[92:95], v[116:119]
    v_mfma_f32_16x16x32_bf16 v[14:17], a[12:15], v[92:95], v[14:17]
    v_mfma_f32_16x16x32_bf16 v[108:111], a[16:19], v[96:99], v[108:111]
    s_waitcnt vmcnt(0)
    v_max3_u32 v18, v100, v101, v102
    v_mfma_f32_16x16x32_bf16 v[112:115], a[20:23], v[96:99], v[112:115]
    v_max3_u32 v19, v104, v105, v106
    v_max3_u32 v18, v18, v103, v107
    v_mfma_f32_16x16x32_bf16 v[116:119], a[24:27], v[96:99], v[116:119]
    v_max_u32 v18, v18, v19
    v_cmp_eq_u32 vcc, -1, v18
    v_mfma_f32_16x16x32_bf16 v[14:17], a[28:31], v[96:99], v[14:17]
    s_cbranch_vccnz Lre_9
Lck_9:
    s_waitcnt lgkmcnt(8)
    v_mfma_f32_16x16x32_bf16 v[108:111], a[32:35], v[100:103], v[108:111]
    v_mfma_f32_16x16x32_bf16 v[112:115], a[36:39], v[100:103], v[112:115]
    v_mfma_f32_16x16x32_bf16 v[116:119], a[40:43], v[100:103], v[116:119]
    v_mfma_f32_16x16x32_bf16 v[14:17], a[44:47], v[100:103], v[14:17]
    s_waitcnt lgkmcnt(0)
    v_mfma_f32_16x16x32_bf16 v[108:111], a[48:51], v[104:107], v[108:111]
    v_mfma_f32_16x16x32_bf16 v[112:115], a[52:55], v[104:107], v[112:115]
    v_mfma_f32_16x16x32_bf16 v[116:119], a[56:59], v[104:107], v[116:119]
    v_mfma_f32_16x16x32_bf16 v[14:17], a[60:63], v[104:107], v[14:17]
    v_xor_b32 v60, 32, v124
    v_xor_b32 v61, 64, v124
    v_xor_b32 v62, 96, v124
    v_cmp_eq_u32 s[36:37], v8, v126
    v_cmp_eq_u32 s[38:39], v9, v126
    s_nop 0
    s_or_b64 vcc, s[36:37], s[38:39]
    s_cbranch_scc1 Lfix
Lnofix:
    v_fma_f32 v108, v108, v44, v28
    v_fma_f32 v109, v109, v45, v29
    v_fma_f32 v110, v110, v46, v30
    v_fma_f32 v111, v111, v47, v31
    v_cvt_pk_bf16_f32 v68, v108, v109
    v_cvt_pk_bf16_f32 v69, v110, v111
    ds_write_b64 v124, v[68:69]
    v_fma_f32 v112, v112, v48, v32
    v_fma_f32 v113, v113, v49, v33
    v_fma_f32 v114, v114, v50, v34
    v_fma_f32 v115, v115, v51, v35
    v_cvt_pk_bf16_f32 v70, v112, v113
    v_cvt_pk_bf16_f32 v71, v114, v115
    ds_write_b64 v60, v[70:71]
    v_fma_f32 v116, v116, v52, v36
    v_fma_f32 v117, v117, v53, v37
    v_fma_f32 v118, v118, v54, v38
    v_fma_f32 v119, v119, v55, v39
    v_cvt_pk_bf16_f32 v72, v116, v117
    v_cvt_pk_bf16_f32 v73, v118, v119
    ds_write_b64 v61, v[72:73]
    v_fma_f32 v14, v14, v56, v40
    v_fma_f32 v15, v15, v57, v41
    v_fma_f32 v16, v16, v58, v42
    v_fma_f32 v17, v17, v59, v43
    v_cvt_pk_bf16_f32 v74, v14, v15
    v_cvt_pk_bf16_f32 v75, v16, v17
    ds_write_b64 v62, v[74:75]
    ds_read_b128 v[76:79], v125 offset:0
    ds_read_b128 v[80:83], v125 offset:1024
    s_waitcnt lgkmcnt(1)
    buffer_store_dwordx4 v[76:79], v122, s[48:51], s24 offen sc0 sc1
    s_waitcnt lgkmcnt(0)
    buffer_store_dwordx4 v[80:83], v123, s[48:51], s24 offen sc0 sc1
    s_endpgm
Lh1:
    ds_write_b128 v125, v[44:47] offset:0
    ds_write_b128 v125, v[48:51] offset:1024
    v_mov_b32 v5, 157972
    v_mov_b32 v6, 1
    s_mov_b64 exec, 1
    ds_add_u32 v5, v6
    s_mov_b64 exec, -1
    v_fmac_f32 v28, v76, v120
    v_fmac_f32 v29, v77, v120
    v_fmac_f32 v30, v78, v120
    v_fmac_f32 v31, v79, v120
    v_cvt_pk_bf16_f32 v28, v28, v29
    v_cvt_pk_bf16_f32 v29, v30, v31
    v_fmac_f32 v32, v80, v120
    v_fmac_f32 v33, v81, v120
    v_fmac_f32 v34, v82, v120
    v_fmac_f32 v35, v83, v120
    v_cvt_pk_bf16_f32 v30, v32, v33
    v_cvt_pk_bf16_f32 v31, v34, v35
    v_fmac_f32 v36, v84, v120
    v_fmac_f32 v37, v85, v120
    v_fmac_f32 v38, v86, v120
    v_fmac_f32 v39, v87, v120
    v_cvt_pk_bf16_f32 v32, v36, v37
    v_cvt_pk_bf16_f32 v33, v38, v39
    v_fmac_f32 v40, v88, v120
    v_fmac_f32 v41, v89, v120
    v_fmac_f32 v42, v90, v120
    v_fmac_f32 v43, v91, v120
    v_cvt_pk_bf16_f32 v34, v40, v41
    v_cvt_pk_bf16_f32 v35, v42, v43
    v_subrev_u32 v4, 6144, v125
    v_mov_b32 v8, s22
    v_mov_b32 v9, s22
    v_mov_b32 v10, s22
    v_mov_b32 v11, s22
Lcw_2:
    s_sub_u32 s35, s35, 1
    s_cbranch_scc1 Lend
    ds_read_b32 v6, v5
    s_waitcnt lgkmcnt(0)
    v_readfirstlane_b32 s38, v6
    s_nop 0
    s_cmp_lt_u32 s38, 8
    s_cbranch_scc1 Lcw_2
    ds_read_b128 v[52:55], v125 offset:2048
    ds_read_b128 v[56:59], v125 offset:3072
    ds_read_b128 v[44:47], v4 offset:4096
    ds_read_b128 v[48:51], v4 offset:5120
    s_branch Lh_join
Lqf_re:
    s_sub_u32 s35, s35, 1
    s_cbranch_scc1 Lend
    ds_read_b32 v7, v96
    ds_read_b128 v[76:79], v95 offset:0
    ds_read_b128 v[80:83], v95 offset:64
    ds_read_b128 v[84:87], v95 offset:128
    ds_read_b128 v[88:91], v95 offset:192
    s_waitcnt lgkmcnt(0)
    s_branch Lqf
Lcsv_re:
    s_sub_u32 s35, s35, 1
    s_cbranch_scc1 Lend
    ds_read_b32 v46, v49
    ds_read_b64 v[44:45], v48
    s_waitcnt lgkmcnt(0)
    s_branch Lcsv
Lrx_re:
    s_sub_u32 s35, s35, 1
    s_cbranch_scc1 Lend
    buffer_load_dwordx2 v[52:53], v13, s[28:31], s59 offen offset:8 sc1
    buffer_load_dwordx2 v[54:55], v13, s[28:31], s60 offen offset:0 sc1
    s_waitcnt vmcnt(0)
    s_branch Lrx_chk
Linfo_re:
    s_sub_u32 s35, s35, 1
    s_cbranch_scc1 Lend
    ds_read_b64 v[8:9], v10
    s_waitcnt lgkmcnt(0)
    s_branch Linfo
Lfl_re:
    s_sub_u32 s35, s35, 1
    s_cbranch_scc1 Lend
    buffer_load_dword v20, v12, s[28:31], s24 offen sc1
    s_waitcnt vmcnt(0)
    s_branch Lfl_chk
Lxe0:
    ds_read_b64 v[108:109], v4
    ds_read_b64 v[110:111], v5
    ds_read_b64 v[112:113], v6
    ds_read_b64 v[114:115], v7
    s_branch Lxe0_b
Lxe1:
    ds_read_b64 v[108:109], v4
    ds_read_b64 v[110:111], v5
    ds_read_b64 v[112:113], v6
    ds_read_b64 v[114:115], v7
    s_branch Lxe1_b
Lxe2:
    ds_read_b64 v[108:109], v4
    ds_read_b64 v[110:111], v5
    ds_read_b64 v[112:113], v6
    ds_read_b64 v[114:115], v7
    s_branch Lxe2_b
Lxe3:
    ds_read_b64 v[108:109], v4
    ds_read_b64 v[110:111], v5
    ds_read_b64 v[112:113], v6
    ds_read_b64 v[114:115], v7
    s_branch Lxe3_b
Lxe4:
    ds_read_b64 v[108:109], v4
    ds_read_b64 v[110:111], v5
    ds_read_b64 v[112:113], v6
    ds_read_b64 v[114:115], v7
    s_branch Lxe4_b
Lxe5:
    ds_read_b64 v[108:109], v4
    ds_read_b64 v[110:111], v5
    ds_read_b64 v[112:113], v6
    ds_read_b64 v[114:115], v7
    s_branch Lxe5_b
Lxe6:
    ds_read_b64 v[108:109], v4
    ds_read_b64 v[110:111], v5
    ds_read_b64 v[112:113], v6
    ds_read_b64 v[114:115], v7
    s_branch Lxe6_b
Lxe7:
    ds_read_b64 v[108:109], v4
    ds_read_b64 v[110:111], v5
    ds_read_b64 v[112:113], v6
    ds_read_b64 v[114:115], v7
    s_branch Lxe7_b
Lxe8:
    ds_read_b64 v[108:109], v4
    ds_read_b64 v[110:111], v5
    ds_read_b64 v[112:113], v6
    ds_read_b64 v[114:115], v7
    s_branch Lxe8_b
Lxe9:
    ds_read_b64 v[108:109], v4
    ds_read_b64 v[110:111], v5
    ds_read_b64 v[112:113], v6
    ds_read_b64 v[114:115], v7
    s_branch Lxe9_b
Lre_0:
    s_mov_b32 s41, 1
    s_sub_u32 s35, s35, 1
    s_cbranch_scc1 Lend
    s_sleep 2
    buffer_load_dwordx4 v[60:63], v13, s[28:31], s53 offen offset:0 sc1
    buffer_load_dwordx4 v[64:67], v13, s[28:31], s53 offen offset:2048 sc1
    s_waitcnt vmcnt(0)
    v_max3_u32 v18, v60, v61, v62
    v_max3_u32 v19, v64, v65, v66
    v_max3_u32 v18, v18, v63, v67
    v_max_u32 v18, v18, v19
    v_cmp_eq_u32 vcc, -1, v18
    s_nop 0
    s_cbranch_vccnz Lre_0
    buffer_load_dwordx4 v[68:71], v13, s[28:31], s54 offen offset:0 sc1
    buffer_load_dwordx4 v[72:75], v13, s[28:31], s54 offen offset:2048 sc1
    buffer_load_dwordx4 v[92:95], v13, s[28:31], s55 offen offset:0 sc1
    buffer_load_dwordx4 v[96:99], v13, s[28:31], s55 offen offset:2048 sc1
    buffer_load_dwordx4 v[100:103], v13, s[28:31], s56 offen offset:0 sc1
    buffer_load_dwordx4 v[104:107], v13, s[28:31], s56 offen offset:2048 sc1
    s_branch Lck_0
Lre_1:
    s_mov_b32 s41, 1
    s_sub_u32 s35, s35, 1
    s_cbranch_scc1 Lend
    s_sleep 2
    buffer_load_dwordx4 v[68:71], v13, s[28:31], s54 offen offset:0 sc1
    buffer_load_dwordx4 v[72:75], v13, s[28:31], s54 offen offset:2048 sc1
    s_waitcnt vmcnt(0)
    v_max3_u32 v18, v68, v69, v70
    v_max3_u32 v19, v72, v73, v74
    v_max3_u32 v18, v18, v71, v75
    v_max_u32 v18, v18, v19
    v_cmp_eq_u32 vcc, -1, v18
    s_nop 0
    s_cbranch_vccnz Lre_1
    buffer_load_dwordx4 v[92:95], v13, s[28:31], s55 offen offset:0 sc1
    buffer_load_dwordx4 v[96:99], v13, s[28:31], s55 offen offset:2048 sc1
    buffer_load_dwordx4 v[100:103], v13, s[28:31], s56 offen offset:0 sc1
    buffer_load_dwordx4 v[104:107], v13, s[28:31], s56 offen offset:2048 sc1
    buffer_load_dwordx4 v[76:79], v13, s[28:31], s57 offen offset:0 sc1
    buffer_load_dwordx4 v[80:83], v13, s[28:31], s57 offen offset:2048 sc1
    s_branch Lck_1
Lre_2:
    s_mov_b32 s41, 1
    s_sub_u32 s35, s35, 1
    s_cbranch_scc1 Lend
    s_sleep 2
    buffer_load_dwordx4 v[92:95], v13, s[28:31], s55 offen offset:0 sc1
    buffer_load_dwordx4 v[96:99], v13, s[28:31], s55 offen offset:2048 sc1
    s_waitcnt vmcnt(0)
    v_max3_u32 v18, v92, v93, v94
    v_max3_u32 v19, v96, v97, v98
    v_max3_u32 v18, v18, v95, v99
    v_max_u32 v18, v18, v19
    v_cmp_eq_u32 vcc, -1, v18
    s_nop 0
    s_cbranch_vccnz Lre_2
    buffer_load_dwordx4 v[100:103], v13, s[28:31], s56 offen offset:0 sc1
    buffer_load_dwordx4 v[104:107], v13, s[28:31], s56 offen offset:2048 sc1
    buffer_load_dwordx4 v[76:79], v13, s[28:31], s57 offen offset:0 sc1
    buffer_load_dwordx4 v[80:83], v13, s[28:31], s57 offen offset:2048 sc1
    buffer_load_dwordx4 v[84:87], v13, s[28:31], s53 offen offset:1024 sc1
    buffer_load_dwordx4 v[88:91], v13, s[28:31], s53 offen offset:3072 sc1
    s_branch Lck_2
Lre_3:
    s_mov_b32 s41, 1
    s_sub_u32 s35, s35, 1
    s_cbranch_scc1 Lend
    s_sleep 2
    buffer_load_dwordx4 v[100:103], v13, s[28:31], s56 offen offset:0 sc1
    buffer_load_dwordx4 v[104:107], v13, s[28:31], s56 offen offset:2048 sc1
    s_waitcnt vmcnt(0)
    v_max3_u32 v18, v100, v101, v102
    v_max3_u32 v19, v104, v105, v106
    v_max3_u32 v18, v18, v103, v107
    v_max_u32 v18, v18, v19
    v_cmp_eq_u32 vcc, -1, v18
    s_nop 0
    s_cbranch_vccnz Lre_3
    buffer_load_dwordx4 v[76:79], v13, s[28:31], s57 offen offset:0 sc1
    buffer_load_dwordx4 v[80:83], v13, s[28:31], s57 offen offset:2048 sc1
    buffer_load_dwordx4 v[84:87], v13, s[28:31], s53 offen offset:1024 sc1
    buffer_load_dwordx4 v[88:91], v13, s[28:31], s53 offen offset:3072 sc1
    buffer_load_dwordx4 v[60:63], v13, s[28:31], s54 offen offset:1024 sc1
    buffer_load_dwordx4 v[64:67], v13, s[28:31], s54 offen offset:3072 sc1
    s_branch Lck_3
Lre_4:
    s_mov_b32 s41, 1
    s_sub_u32 s35, s35, 1
    s_cbranch_scc1 Lend
    s_sleep 2
    buffer_load_dwordx4 v[76:79], v13, s[28:31], s57 offen offset:0 sc1
    buffer_load_dwordx4 v[80:83], v13, s[28:31], s57 offen offset:2048 sc1
    s_waitcnt vmcnt(0)
    v_max3_u32 v18, v76, v77, v78
    v_max3_u32 v19, v80, v81, v82
    v_max3_u32 v18, v18, v79, v83
    v_max_u32 v18, v18, v19
    v_cmp_eq_u32 vcc, -1, v18
    s_nop 0
    s_cbranch_vccnz Lre_4
    buffer_load_dwordx4 v[84:87], v13, s[28:31], s53 offen offset:1024 sc1
    buffer_load_dwordx4 v[88:91], v13, s[28:31], s53 offen offset:3072 sc1
    buffer_load_dwordx4 v[60:63], v13, s[28:31], s54 offen offset:1024 sc1
    buffer_load_dwordx4 v[64:67], v13, s[28:31], s54 offen offset:3072 sc1
    buffer_load_dwordx4 v[68:71], v13, s[28:31], s55 offen offset:1024 sc1
    buffer_load_dwordx4 v[72:75], v13, s[28:31], s55 offen offset:3072 sc1
    s_branch Lck_4
Lre_5:
    s_mov_b32 s41, 1
    s_sub_u32 s35, s35, 1
    s_cbranch_scc1 Lend
    s_sleep 2
    buffer_load_dwordx4 v[84:87], v13, s[28:31], s53 offen offset:1024 sc1
    buffer_load_dwordx4 v[88:91], v13, s[28:31], s53 offen offset:3072 sc1
    s_waitcnt vmcnt(0)
    v_max3_u32 v18, v84, v85, v86
    v_max3_u32 v19, v88, v89, v90
    v_max3_u32 v18, v18, v87, v91
    v_max_u32 v18, v18, v19
    v_cmp_eq_u32 vcc, -1, v18
    s_nop 0
    s_cbranch_vccnz Lre_5
    buffer_load_dwordx4 v[60:63], v13, s[28:31], s54 offen offset:1024 sc1
    buffer_load_dwordx4 v[64:67], v13, s[28:31], s54 offen offset:3072 sc1
    buffer_load_dwordx4 v[68:71], v13, s[28:31], s55 offen offset:1024 sc1
    buffer_load_dwordx4 v[72:75], v13, s[28:31], s55 offen offset:3072 sc1
    buffer_load_dwordx4 v[92:95], v13, s[28:31], s56 offen offset:1024 sc1
    buffer_load_dwordx4 v[96:99], v13, s[28:31], s56 offen offset:3072 sc1
    s_branch Lck_5
Lre_6:
    s_mov_b32 s41, 1
    s_sub_u32 s35, s35, 1
    s_cbranch_scc1 Lend
    s_sleep 2
    buffer_load_dwordx4 v[60:63], v13, s[28:31], s54 offen offset:1024 sc1
    buffer_load_dwordx4 v[64:67], v13, s[28:31], s54 offen offset:3072 sc1
    s_waitcnt vmcnt(0)
    v_max3_u32 v18, v60, v61, v62
    v_max3_u32 v19, v64, v65, v66
    v_max3_u32 v18, v18, v63, v67
    v_max_u32 v18, v18, v19
    v_cmp_eq_u32 vcc, -1, v18
    s_nop 0
    s_cbranch_vccnz Lre_6
    buffer_load_dwordx4 v[68:71], v13, s[28:31], s55 offen offset:1024 sc1
    buffer_load_dwordx4 v[72:75], v13, s[28:31], s55 offen offset:3072 sc1
    buffer_load_dwordx4 v[92:95], v13, s[28:31], s56 offen offset:1024 sc1
    buffer_load_dwordx4 v[96:99], v13, s[28:31], s56 offen offset:3072 sc1
    buffer_load_dwordx4 v[100:103], v13, s[28:31], s57 offen offset:1024 sc1
    buffer_load_dwordx4 v[104:107], v13, s[28:31], s57 offen offset:3072 sc1
    s_branch Lck_6
Lre_7:
    s_mov_b32 s41, 1
    s_sub_u32 s35, s35, 1
    s_cbranch_scc1 Lend
    s_sleep 2
    buffer_load_dwordx4 v[68:71], v13, s[28:31], s55 offen offset:1024 sc1
    buffer_load_dwordx4 v[72:75], v13, s[28:31], s55 offen offset:3072 sc1
    s_waitcnt vmcnt(0)
    v_max3_u32 v18, v68, v69, v70
    v_max3_u32 v19, v72, v73, v74
    v_max3_u32 v18, v18, v71, v75
    v_max_u32 v18, v18, v19
    v_cmp_eq_u32 vcc, -1, v18
    s_nop 0
    s_cbranch_vccnz Lre_7
    buffer_load_dwordx4 v[92:95], v13, s[28:31], s56 offen offset:1024 sc1
    buffer_load_dwordx4 v[96:99], v13, s[28:31], s56 offen offset:3072 sc1
    buffer_load_dwordx4 v[100:103], v13, s[28:31], s57 offen offset:1024 sc1
    buffer_load_dwordx4 v[104:107], v13, s[28:31], s57 offen offset:3072 sc1
    s_branch Lck_7
Lre_8:
    s_mov_b32 s41, 1
    s_sub_u32 s35, s35, 1
    s_cbranch_scc1 Lend
    s_sleep 2
    buffer_load_dwordx4 v[92:95], v13, s[28:31], s56 offen offset:1024 sc1
    buffer_load_dwordx4 v[96:99], v13, s[28:31], s56 offen offset:3072 sc1
    s_waitcnt vmcnt(0)
    v_max3_u32 v18, v92, v93, v94
    v_max3_u32 v19, v96, v97, v98
    v_max3_u32 v18, v18, v95, v99
    v_max_u32 v18, v18, v19
    v_cmp_eq_u32 vcc, -1, v18
    s_nop 0
    s_cbranch_vccnz Lre_8
    buffer_load_dwordx4 v[100:103], v13, s[28:31], s57 offen offset:1024 sc1
    buffer_load_dwordx4 v[104:107], v13, s[28:31], s57 offen offset:3072 sc1
    s_branch Lck_8
Lre_9:
    s_mov_b32 s41, 1
    s_sub_u32 s35, s35, 1
    s_cbranch_scc1 Lend
    s_sleep 2
    buffer_load_dwordx4 v[100:103], v13, s[28:31], s57 offen offset:1024 sc1
    buffer_load_dwordx4 v[104:107], v13, s[28:31], s57 offen offset:3072 sc1
    s_waitcnt vmcnt(0)
    v_max3_u32 v18, v100, v101, v102
    v_max3_u32 v19, v104, v105, v106
    v_max3_u32 v18, v18, v103, v107
    v_max_u32 v18, v18, v19
    v_cmp_eq_u32 vcc, -1, v18
    s_nop 0
    s_cbranch_vccnz Lre_9
    s_branch Lck_9
Lfix:
    s_mov_b64 vcc, s[38:39]
    v_lshlrev_b32 v6, 4, v2
    v_add_u32 v6, 158208, v6
    v_mov_b32 v10, 157956
Lcw_5:
    s_sub_u32 s35, s35, 1
    s_cbranch_scc1 Lend
    ds_read_b32 v11, v10
    s_waitcnt lgkmcnt(0)
    v_readfirstlane_b32 s38, v11
    s_nop 0
    s_cmp_lt_u32 s38, 1
    s_cbranch_scc1 Lcw_5
    s_mov_b64 exec, s[36:37]
    ds_read_b128 v[44:47], v6 offset:0
    ds_read_b128 v[48:51], v6 offset:64
    ds_read_b128 v[52:55], v6 offset:128
    ds_read_b128 v[56:59], v6 offset:192
    s_mov_b64 exec, vcc
    ds_read_b128 v[44:47], v6 offset:256
    ds_read_b128 v[48:51], v6 offset:320
    ds_read_b128 v[52:55], v6 offset:384
    ds_read_b128 v[56:59], v6 offset:448
    s_mov_b64 exec, -1
    s_waitcnt lgkmcnt(0)
    s_branch Lnofix
Lhalo:
    s_mov_b32 vcc_lo, 0x00010001
    s_mov_b32 vcc_hi, 0x00010001
    v_mov_b32 v11, 38912
    v_cndmask_b32 v76, v76, v11, vcc
    v_xor_b32 v77, 64, v76
    v_add_u32 v80, 78080, v76
    v_add_u32 v81, 78080, v77
    v_mov_b32 v14, 0x3f803f80
    v_mov_b32 v15, 0x3f803f80
    v_mov_b32 v16, 0x3f803f80
    v_mov_b32 v17, 0x3f803f80
    v_and_b32 v4, 7, v1
    v_lshlrev_b32 v4, 4, v4
    v_mul_u32_u24 v5, 39040, v2
    v_add_u32 v4, v4, v5
    ds_write_b128 v4, v[14:17] offset:38912
    v_mov_b32 v4, 157952
    v_mov_b32 v8, 0
    v_mov_b32 v9, 0
    v_mov_b32 v10, -2
    v_mov_b32 v11, -2
    ds_write_b128 v4, v[8:11]
    v_min_u32 v5, 23, v1
    v_lshl_add_u32 v5, v5, 2, v4
    ds_write_b32 v5, v8 offset:16
    s_mul_i32 s36, s32, 96
    s_sub_u32 s36, s36, 16
    v_add_u32 v96, s36, v1
    v_min_u32 v5, 47, v1
    v_add3_u32 v97, s36, v5, 64
    v_mov_b32 v6, 2047
    v_med3_i32 v96, v96, 0, v6
    v_med3_i32 v97, v97, 0, v6
    v_lshlrev_b32 v96, 3, v96
    v_lshlrev_b32 v97, 3, v97
    s_mov_b32 s46, 8192000
    v_mov_b32 v127, 157984
    s_lshl_b32 s36, s3, 2
    s_add_u32 s36, s36, 158016
    v_mov_b32 v10, s36
    s_mov_b32 vcc_lo, 0x00010001
    s_mov_b32 vcc_hi, 0x00010001
    v_cndmask_b32 v116, 0, v14, vcc
    v_cndmask_b32 v117, 0, v15, vcc
    v_cndmask_b32 v118, 0, v16, vcc
    v_cndmask_b32 v119, 0, v17, vcc
    s_waitcnt vmcnt(0)
    s_waitcnt lgkmcnt(0)
    s_barrier
    s_add_u32 s34, s34, 0x9e3779b8
    s_or_b32 s34, s34, 1
    ds_read_b128 v[108:111], v76 offset:0
    ds_read_b128 v[112:115], v77 offset:0
    ds_read_b64_tr_b16 a[0:1], v20 offset:0
    ds_read_b64_tr_b16 a[2:3], v20 offset:512
    ds_read_b64_tr_b16 a[4:5], v21 offset:0
    ds_read_b64_tr_b16 a[6:7], v21 offset:512
    ds_read_b64_tr_b16 a[8:9], v22 offset:0
    ds_read_b64_tr_b16 a[10:11], v22 offset:512
    ds_read_b64_tr_b16 a[12:13], v23 offset:0
    ds_read_b64_tr_b16 a[14:15], v23 offset:512
    ds_read_b64_tr_b16 a[16:17], v20 offset:8192
    ds_read_b64_tr_b16 a[18:19], v20 offset:8704
    ds_read_b64_tr_b16 a[20:21], v21 offset:8192
    ds_read_b64_tr_b16 a[22:23], v21 offset:8704
    ds_read_b64_tr_b16 a[24:25], v22 offset:8192
    ds_read_b64_tr_b16 a[26:27], v22 offset:8704
    s_waitcnt lgkmcnt(12)
    v_mfma_f32_16x16x32_bf16 v[28:31], a[0:3], v[116:119], 0
    ds_read_b64_tr_b16 a[28:29], v23 offset:8192
    ds_read_b64_tr_b16 a[30:31], v23 offset:8704
    s_waitcnt lgkmcnt(12)
    v_mfma_f32_16x16x32_bf16 v[32:35], a[4:7], v[116:119], 0
    ds_read_b64_tr_b16 a[32:33], v20 offset:16384
    ds_read_b64_tr_b16 a[34:35], v20 offset:16896
    s_waitcnt lgkmcnt(12)
    v_mfma_f32_16x16x32_bf16 v[36:39], a[8:11], v[116:119], 0
    ds_read_b64_tr_b16 a[36:37], v21 offset:16384
    ds_read_b64_tr_b16 a[38:39], v21 offset:16896
    s_waitcnt lgkmcnt(12)
    v_mfma_f32_16x16x32_bf16 v[40:43], a[12:15], v[116:119], 0
    ds_read_b64_tr_b16 a[40:41], v22 offset:16384
    ds_read_b64_tr_b16 a[42:43], v22 offset:16896
    s_waitcnt lgkmcnt(12)
    v_mfma_f32_16x16x32_bf16 v[44:47], a[16:19], v[108:111], 0
    ds_read_b64_tr_b16 a[44:45], v23 offset:16384
    ds_read_b64_tr_b16 a[46:47], v23 offset:16896
    s_waitcnt lgkmcnt(12)
    v_mfma_f32_16x16x32_bf16 v[48:51], a[20:23], v[108:111], 0
    ds_read_b64_tr_b16 a[48:49], v20 offset:4096
    ds_read_b64_tr_b16 a[50:51], v20 offset:4608
    s_waitcnt lgkmcnt(12)
    v_mfma_f32_16x16x32_bf16 v[52:55], a[24:27], v[108:111], 0
    ds_read_b64_tr_b16 a[52:53], v21 offset:4096
    ds_read_b64_tr_b16 a[54:55], v21 offset:4608
    s_waitcnt lgkmcnt(12)
    v_mfma_f32_16x16x32_bf16 v[56:59], a[28:31], v[108:111], 0
    ds_read_b64_tr_b16 a[56:57], v22 offset:4096
    ds_read_b64_tr_b16 a[58:59], v22 offset:4608
    s_waitcnt lgkmcnt(12)
    v_mfma_f32_16x16x32_bf16 v[60:63], v[108:111], a[32:35], 0
    ds_read_b64_tr_b16 a[60:61], v23 offset:4096
    ds_read_b64_tr_b16 a[62:63], v23 offset:4608
    s_waitcnt lgkmcnt(12)
    v_mfma_f32_16x16x32_bf16 v[64:67], v[108:111], a[36:39], 0
    ds_read_b64_tr_b16 a[64:65], v20 offset:12288
    ds_read_b64_tr_b16 a[66:67], v20 offset:12800
    s_waitcnt lgkmcnt(12)
    v_mfma_f32_16x16x32_bf16 v[68:71], v[108:111], a[40:43], 0
    ds_read_b64_tr_b16 a[68:69], v21 offset:12288
    ds_read_b64_tr_b16 a[70:71], v21 offset:12800
    s_waitcnt lgkmcnt(12)
    v_mfma_f32_16x16x32_bf16 v[72:75], v[108:111], a[44:47], 0
    ds_read_b64_tr_b16 a[72:73], v22 offset:12288
    ds_read_b64_tr_b16 a[74:75], v22 offset:12800
    s_waitcnt lgkmcnt(12)
    v_mfma_f32_16x16x32_bf16 v[28:31], a[48:51], v[116:119], v[28:31]
    ds_read_b64_tr_b16 a[76:77], v23 offset:12288
    ds_read_b64_tr_b16 a[78:79], v23 offset:12800
    s_waitcnt lgkmcnt(12)
    v_mfma_f32_16x16x32_bf16 v[32:35], a[52:55], v[116:119], v[32:35]
    ds_read_b64_tr_b16 a[80:81], v20 offset:20480
    ds_read_b64_tr_b16 a[82:83], v20 offset:20992
    s_waitcnt lgkmcnt(12)
    v_mfma_f32_16x16x32_bf16 v[36:39], a[56:59], v[116:119], v[36:39]
    ds_read_b64_tr_b16 a[84:85], v21 offset:20480
    ds_read_b64_tr_b16 a[86:87], v21 offset:20992
    s_waitcnt lgkmcnt(12)
    v_mfma_f32_16x16x32_bf16 v[40:43], a[60:63], v[116:119], v[40:43]
    ds_read_b64_tr_b16 a[88:89], v22 offset:20480
    ds_read_b64_tr_b16 a[90:91], v22 offset:20992
    s_waitcnt lgkmcnt(12)
    v_mfma_f32_16x16x32_bf16 v[44:47], a[64:67], v[112:115], v[44:47]
    ds_read_b64_tr_b16 a[92:93], v23 offset:20480
    ds_read_b64_tr_b16 a[94:95], v23 offset:20992
    s_waitcnt lgkmcnt(12)
    v_mfma_f32_16x16x32_bf16 v[48:51], a[68:71], v[112:115], v[48:51]
    s_waitcnt lgkmcnt(10)
    v_mfma_f32_16x16x32_bf16 v[52:55], a[72:75], v[112:115], v[52:55]
    s_waitcnt lgkmcnt(8)
    v_mfma_f32_16x16x32_bf16 v[56:59], a[76:79], v[112:115], v[56:59]
    s_waitcnt lgkmcnt(6)
    v_mfma_f32_16x16x32_bf16 v[60:63], v[112:115], a[80:83], v[60:63]
    s_waitcnt lgkmcnt(4)
    v_mfma_f32_16x16x32_bf16 v[64:67], v[112:115], a[84:87], v[64:67]
    s_waitcnt lgkmcnt(2)
    v_mfma_f32_16x16x32_bf16 v[68:71], v[112:115], a[88:91], v[68:71]
    s_waitcnt lgkmcnt(0)
    v_mfma_f32_16x16x32_bf16 v[72:75], v[112:115], a[92:95], v[72:75]
    s_barrier
    ds_read_b128 v[108:111], v76 offset:39040
    ds_read_b128 v[112:115], v77 offset:39040
    ds_read_b64_tr_b16 a[0:1], v20 offset:39040
    ds_read_b64_tr_b16 a[2:3], v20 offset:39552
    ds_read_b64_tr_b16 a[4:5], v21 offset:39040
    ds_read_b64_tr_b16 a[6:7], v21 offset:39552
    ds_read_b64_tr_b16 a[8:9], v22 offset:39040
    ds_read_b64_tr_b16 a[10:11], v22 offset:39552
    ds_read_b64_tr_b16 a[12:13], v23 offset:39040
    ds_read_b64_tr_b16 a[14:15], v23 offset:39552
    ds_read_b64_tr_b16 a[16:17], v20 offset:47232
    ds_read_b64_tr_b16 a[18:19], v20 offset:47744
    ds_read_b64_tr_b16 a[20:21], v21 offset:47232
    ds_read_b64_tr_b16 a[22:23], v21 offset:47744
    ds_read_b64_tr_b16 a[24:25], v22 offset:47232
    ds_read_b64_tr_b16 a[26:27], v22 offset:47744
    s_waitcnt lgkmcnt(12)
    v_mfma_f32_16x16x32_bf16 v[28:31], a[0:3], v[116:119], v[28:31]
    ds_read_b64_tr_b16 a[28:29], v23 offset:47232
    ds_read_b64_tr_b16 a[30:31], v23 offset:47744
    s_waitcnt lgkmcnt(12)
    v_mfma_f32_16x16x32_bf16 v[32:35], a[4:7], v[116:119], v[32:35]
    ds_read_b64_tr_b16 a[32:33], v20 offset:55424
    ds_read_b64_tr_b16 a[34:35], v20 offset:55936
    s_waitcnt lgkmcnt(12)
    v_mfma_f32_16x16x32_bf16 v[36:39], a[8:11], v[116:119], v[36:39]
    ds_read_b64_tr_b16 a[36:37], v21 offset:55424
    ds_read_b64_tr_b16 a[38:39], v21 offset:55936
    s_waitcnt lgkmcnt(12)
    v_mfma_f32_16x16x32_bf16 v[40:43], a[12:15], v[116:119], v[40:43]
    ds_read_b64_tr_b16 a[40:41], v22 offset:55424
    ds_read_b64_tr_b16 a[42:43], v22 offset:55936
    s_waitcnt lgkmcnt(12)
    v_mfma_f32_16x16x32_bf16 v[44:47], a[16:19], v[108:111], v[44:47]
    ds_read_b64_tr_b16 a[44:45], v23 offset:55424
    ds_read_b64_tr_b16 a[46:47], v23 offset:55936
    s_waitcnt lgkmcnt(12)
    v_mfma_f32_16x16x32_bf16 v[48:51], a[20:23], v[108:111], v[48:51]
    ds_read_b64_tr_b16 a[48:49], v20 offset:43136
    ds_read_b64_tr_b16 a[50:51], v20 offset:43648
    s_waitcnt lgkmcnt(12)
    v_mfma_f32_16x16x32_bf16 v[52:55], a[24:27], v[108:111], v[52:55]
    ds_read_b64_tr_b16 a[52:53], v21 offset:43136
    ds_read_b64_tr_b16 a[54:55], v21 offset:43648
    s_waitcnt lgkmcnt(12)
    v_mfma_f32_16x16x32_bf16 v[56:59], a[28:31], v[108:111], v[56:59]
    ds_read_b64_tr_b16 a[56:57], v22 offset:43136
    ds_read_b64_tr_b16 a[58:59], v22 offset:43648
    s_waitcnt lgkmcnt(12)
    v_mfma_f32_16x16x32_bf16 v[60:63], v[108:111], a[32:35], v[60:63]
    ds_read_b64_tr_b16 a[60:61], v23 offset:43136
    ds_read_b64_tr_b16 a[62:63], v23 offset:43648
    s_waitcnt lgkmcnt(12)
    v_mfma_f32_16x16x32_bf16 v[64:67], v[108:111], a[36:39], v[64:67]
    ds_read_b64_tr_b16 a[64:65], v20 offset:51328
    ds_read_b64_tr_b16 a[66:67], v20 offset:51840
    s_waitcnt lgkmcnt(12)
    v_mfma_f32_16x16x32_bf16 v[68:71], v[108:111], a[40:43], v[68:71]
    ds_read_b64_tr_b16 a[68:69], v21 offset:51328
    ds_read_b64_tr_b16 a[70:71], v21 offset:51840
    s_waitcnt lgkmcnt(12)
    v_mfma_f32_16x16x32_bf16 v[72:75], v[108:111], a[44:47], v[72:75]
    ds_read_b64_tr_b16 a[72:73], v22 offset:51328
    ds_read_b64_tr_b16 a[74:75], v22 offset:51840
    s_waitcnt lgkmcnt(12)
    v_mfma_f32_16x16x32_bf16 v[28:31], a[48:51], v[116:119], v[28:31]
    ds_read_b64_tr_b16 a[76:77], v23 offset:51328
    ds_read_b64_tr_b16 a[78:79], v23 offset:51840
    s_waitcnt lgkmcnt(12)
    v_mfma_f32_16x16x32_bf16 v[32:35], a[52:55], v[116:119], v[32:35]
    ds_read_b64_tr_b16 a[80:81], v20 offset:59520
    ds_read_b64_tr_b16 a[82:83], v20 offset:60032
    s_waitcnt lgkmcnt(12)
    v_mfma_f32_16x16x32_bf16 v[36:39], a[56:59], v[116:119], v[36:39]
    ds_read_b64_tr_b16 a[84:85], v21 offset:59520
    ds_read_b64_tr_b16 a[86:87], v21 offset:60032
    s_waitcnt lgkmcnt(12)
    v_mfma_f32_16x16x32_bf16 v[40:43], a[60:63], v[116:119], v[40:43]
    ds_read_b64_tr_b16 a[88:89], v22 offset:59520
    ds_read_b64_tr_b16 a[90:91], v22 offset:60032
    s_waitcnt lgkmcnt(12)
    v_mfma_f32_16x16x32_bf16 v[44:47], a[64:67], v[112:115], v[44:47]
    ds_read_b64_tr_b16 a[92:93], v23 offset:59520
    ds_read_b64_tr_b16 a[94:95], v23 offset:60032
    s_waitcnt lgkmcnt(12)
    v_mfma_f32_16x16x32_bf16 v[48:51], a[68:71], v[112:115], v[48:51]
    s_waitcnt lgkmcnt(10)
    v_mfma_f32_16x16x32_bf16 v[52:55], a[72:75], v[112:115], v[52:55]
    s_waitcnt lgkmcnt(8)
    v_mfma_f32_16x16x32_bf16 v[56:59], a[76:79], v[112:115], v[56:59]
    s_waitcnt lgkmcnt(6)
    v_mfma_f32_16x16x32_bf16 v[60:63], v[112:115], a[80:83], v[60:63]
    s_waitcnt lgkmcnt(4)
    v_mfma_f32_16x16x32_bf16 v[64:67], v[112:115], a[84:87], v[64:67]
    s_waitcnt lgkmcnt(2)
    v_mfma_f32_16x16x32_bf16 v[68:71], v[112:115], a[88:91], v[68:71]
    s_waitcnt lgkmcnt(0)
    v_mfma_f32_16x16x32_bf16 v[72:75], v[112:115], a[92:95], v[72:75]
    s_mov_b64 exec, 1
    s_lshl_b32 s36, s2, 2
    s_add_u32 s36, s36, 8323072
    v_mov_b32 v4, s34
    v_mov_b32 v5, s36
    buffer_store_dword v4, v5, s[28:31], 0 offen sc1
    s_mov_b64 exec, -1
    s_barrier
    ds_read_b128 v[108:111], v80 offset:0
    ds_read_b128 v[112:115], v81 offset:0
    ds_read_b64_tr_b16 a[0:1], v24 offset:0
    ds_read_b64_tr_b16 a[2:3], v24 offset:512
    ds_read_b64_tr_b16 a[4:5], v25 offset:0
    ds_read_b64_tr_b16 a[6:7], v25 offset:512
    ds_read_b64_tr_b16 a[8:9], v26 offset:0
    ds_read_b64_tr_b16 a[10:11], v26 offset:512
    ds_read_b64_tr_b16 a[12:13], v27 offset:0
    ds_read_b64_tr_b16 a[14:15], v27 offset:512
    ds_read_b64_tr_b16 a[16:17], v24 offset:8192
    ds_read_b64_tr_b16 a[18:19], v24 offset:8704
    ds_read_b64_tr_b16 a[20:21], v25 offset:8192
    ds_read_b64_tr_b16 a[22:23], v25 offset:8704
    ds_read_b64_tr_b16 a[24:25], v26 offset:8192
    ds_read_b64_tr_b16 a[26:27], v26 offset:8704
    s_waitcnt lgkmcnt(12)
    v_mfma_f32_16x16x32_bf16 v[28:31], a[0:3], v[116:119], v[28:31]
    ds_read_b64_tr_b16 a[28:29], v27 offset:8192
    ds_read_b64_tr_b16 a[30:31], v27 offset:8704
    s_waitcnt lgkmcnt(12)
    v_mfma_f32_16x16x32_bf16 v[32:35], a[4:7], v[116:119], v[32:35]
    ds_read_b64_tr_b16 a[32:33], v24 offset:16384
    ds_read_b64_tr_b16 a[34:35], v24 offset:16896
    s_waitcnt lgkmcnt(12)
    v_mfma_f32_16x16x32_bf16 v[36:39], a[8:11], v[116:119], v[36:39]
    ds_read_b64_tr_b16 a[36:37], v25 offset:16384
    ds_read_b64_tr_b16 a[38:39], v25 offset:16896
    s_waitcnt lgkmcnt(12)
    v_mfma_f32_16x16x32_bf16 v[40:43], a[12:15], v[116:119], v[40:43]
    ds_read_b64_tr_b16 a[40:41], v26 offset:16384
    ds_read_b64_tr_b16 a[42:43], v26 offset:16896
    s_waitcnt lgkmcnt(12)
    v_mfma_f32_16x16x32_bf16 v[44:47], a[16:19], v[108:111], v[44:47]
    ds_read_b64_tr_b16 a[44:45], v27 offset:16384
    ds_read_b64_tr_b16 a[46:47], v27 offset:16896
    s_waitcnt lgkmcnt(12)
    v_mfma_f32_16x16x32_bf16 v[48:51], a[20:23], v[108:111], v[48:51]
    ds_read_b64_tr_b16 a[48:49], v24 offset:4096
    ds_read_b64_tr_b16 a[50:51], v24 offset:4608
    s_waitcnt lgkmcnt(12)
    v_mfma_f32_16x16x32_bf16 v[52:55], a[24:27], v[108:111], v[52:55]
    ds_read_b64_tr_b16 a[52:53], v25 offset:4096
    ds_read_b64_tr_b16 a[54:55], v25 offset:4608
    s_waitcnt lgkmcnt(12)
    v_mfma_f32_16x16x32_bf16 v[56:59], a[28:31], v[108:111], v[56:59]
    ds_read_b64_tr_b16 a[56:57], v26 offset:4096
    ds_read_b64_tr_b16 a[58:59], v26 offset:4608
    s_waitcnt lgkmcnt(12)
    v_mfma_f32_16x16x32_bf16 v[60:63], v[108:111], a[32:35], v[60:63]
    ds_read_b64_tr_b16 a[60:61], v27 offset:4096
    ds_read_b64_tr_b16 a[62:63], v27 offset:4608
    s_waitcnt lgkmcnt(12)
    v_mfma_f32_16x16x32_bf16 v[64:67], v[108:111], a[36:39], v[64:67]
    ds_read_b64_tr_b16 a[64:65], v24 offset:12288
    ds_read_b64_tr_b16 a[66:67], v24 offset:12800
    s_waitcnt lgkmcnt(12)
    v_mfma_f32_16x16x32_bf16 v[68:71], v[108:111], a[40:43], v[68:71]
    ds_read_b64_tr_b16 a[68:69], v25 offset:12288
    ds_read_b64_tr_b16 a[70:71], v25 offset:12800
    s_waitcnt lgkmcnt(12)
    v_mfma_f32_16x16x32_bf16 v[72:75], v[108:111], a[44:47], v[72:75]
    ds_read_b64_tr_b16 a[72:73], v26 offset:12288
    ds_read_b64_tr_b16 a[74:75], v26 offset:12800
    s_waitcnt lgkmcnt(12)
    v_mfma_f32_16x16x32_bf16 v[28:31], a[48:51], v[116:119], v[28:31]
    ds_read_b64_tr_b16 a[76:77], v27 offset:12288
    ds_read_b64_tr_b16 a[78:79], v27 offset:12800
    s_waitcnt lgkmcnt(12)
    v_mfma_f32_16x16x32_bf16 v[32:35], a[52:55], v[116:119], v[32:35]
    ds_read_b64_tr_b16 a[80:81], v24 offset:20480
    ds_read_b64_tr_b16 a[82:83], v24 offset:20992
    s_waitcnt lgkmcnt(12)
    v_mfma_f32_16x16x32_bf16 v[36:39], a[56:59], v[116:119], v[36:39]
    ds_read_b64_tr_b16 a[84:85], v25 offset:20480
    ds_read_b64_tr_b16 a[86:87], v25 offset:20992
    s_waitcnt lgkmcnt(12)
    v_mfma_f32_16x16x32_bf16 v[40:43], a[60:63], v[116:119], v[40:43]
    ds_read_b64_tr_b16 a[88:89], v26 offset:20480
    ds_read_b64_tr_b16 a[90:91], v26 offset:20992
    s_waitcnt lgkmcnt(12)
    v_mfma_f32_16x16x32_bf16 v[44:47], a[64:67], v[112:115], v[44:47]
    ds_read_b64_tr_b16 a[92:93], v27 offset:20480
    ds_read_b64_tr_b16 a[94:95], v27 offset:20992
    s_waitcnt lgkmcnt(12)
    v_mfma_f32_16x16x32_bf16 v[48:51], a[68:71], v[112:115], v[48:51]
    s_waitcnt lgkmcnt(10)
    v_mfma_f32_16x16x32_bf16 v[52:55], a[72:75], v[112:115], v[52:55]
    s_waitcnt lgkmcnt(8)
    v_mfma_f32_16x16x32_bf16 v[56:59], a[76:79], v[112:115], v[56:59]
    s_waitcnt lgkmcnt(6)
    v_mfma_f32_16x16x32_bf16 v[60:63], v[112:115], a[80:83], v[60:63]
    s_waitcnt lgkmcnt(4)
    v_mfma_f32_16x16x32_bf16 v[64:67], v[112:115], a[84:87], v[64:67]
    s_waitcnt lgkmcnt(2)
    v_mfma_f32_16x16x32_bf16 v[68:71], v[112:115], a[88:91], v[68:71]
    s_waitcnt lgkmcnt(0)
    v_mfma_f32_16x16x32_bf16 v[72:75], v[112:115], a[92:95], v[72:75]
    s_barrier
    ds_read_b128 v[108:111], v80 offset:39040
    ds_read_b128 v[112:115], v81 offset:39040
    ds_read_b64_tr_b16 a[0:1], v24 offset:39040
    ds_read_b64_tr_b16 a[2:3], v24 offset:39552
    ds_read_b64_tr_b16 a[4:5], v25 offset:39040
    ds_read_b64_tr_b16 a[6:7], v25 offset:39552
    ds_read_b64_tr_b16 a[8:9], v26 offset:39040
    ds_read_b64_tr_b16 a[10:11], v26 offset:39552
    ds_read_b64_tr_b16 a[12:13], v27 offset:39040
    ds_read_b64_tr_b16 a[14:15], v27 offset:39552
    ds_read_b64_tr_b16 a[16:17], v24 offset:47232
    ds_read_b64_tr_b16 a[18:19], v24 offset:47744
    ds_read_b64_tr_b16 a[20:21], v25 offset:47232
    ds_read_b64_tr_b16 a[22:23], v25 offset:47744
    ds_read_b64_tr_b16 a[24:25], v26 offset:47232
    ds_read_b64_tr_b16 a[26:27], v26 offset:47744
    s_waitcnt lgkmcnt(12)
    v_mfma_f32_16x16x32_bf16 v[28:31], a[0:3], v[116:119], v[28:31]
    ds_read_b64_tr_b16 a[28:29], v27 offset:47232
    ds_read_b64_tr_b16 a[30:31], v27 offset:47744
    s_waitcnt lgkmcnt(12)
    v_mfma_f32_16x16x32_bf16 v[32:35], a[4:7], v[116:119], v[32:35]
    ds_read_b64_tr_b16 a[32:33], v24 offset:55424
    ds_read_b64_tr_b16 a[34:35], v24 offset:55936
    s_waitcnt lgkmcnt(12)
    v_mfma_f32_16x16x32_bf16 v[36:39], a[8:11], v[116:119], v[36:39]
    ds_read_b64_tr_b16 a[36:37], v25 offset:55424
    ds_read_b64_tr_b16 a[38:39], v25 offset:55936
    s_waitcnt lgkmcnt(12)
    v_mfma_f32_16x16x32_bf16 v[40:43], a[12:15], v[116:119], v[40:43]
    ds_read_b64_tr_b16 a[40:41], v26 offset:55424
    ds_read_b64_tr_b16 a[42:43], v26 offset:55936
    s_waitcnt lgkmcnt(12)
    v_mfma_f32_16x16x32_bf16 v[44:47], a[16:19], v[108:111], v[44:47]
    ds_read_b64_tr_b16 a[44:45], v27 offset:55424
    ds_read_b64_tr_b16 a[46:47], v27 offset:55936
    s_waitcnt lgkmcnt(12)
    v_mfma_f32_16x16x32_bf16 v[48:51], a[20:23], v[108:111], v[48:51]
    ds_read_b64_tr_b16 a[48:49], v24 offset:43136
    ds_read_b64_tr_b16 a[50:51], v24 offset:43648
    s_waitcnt lgkmcnt(12)
    v_mfma_f32_16x16x32_bf16 v[52:55], a[24:27], v[108:111], v[52:55]
    ds_read_b64_tr_b16 a[52:53], v25 offset:43136
    ds_read_b64_tr_b16 a[54:55], v25 offset:43648
    s_waitcnt lgkmcnt(12)
    v_mfma_f32_16x16x32_bf16 v[56:59], a[28:31], v[108:111], v[56:59]
    ds_read_b64_tr_b16 a[56:57], v26 offset:43136
    ds_read_b64_tr_b16 a[58:59], v26 offset:43648
    s_waitcnt lgkmcnt(12)
    v_mfma_f32_16x16x32_bf16 v[60:63], v[108:111], a[32:35], v[60:63]
    ds_read_b64_tr_b16 a[60:61], v27 offset:43136
    ds_read_b64_tr_b16 a[62:63], v27 offset:43648
    s_waitcnt lgkmcnt(12)
    v_mfma_f32_16x16x32_bf16 v[64:67], v[108:111], a[36:39], v[64:67]
    ds_read_b64_tr_b16 a[64:65], v24 offset:51328
    ds_read_b64_tr_b16 a[66:67], v24 offset:51840
    s_waitcnt lgkmcnt(12)
    v_mfma_f32_16x16x32_bf16 v[68:71], v[108:111], a[40:43], v[68:71]
    ds_read_b64_tr_b16 a[68:69], v25 offset:51328
    ds_read_b64_tr_b16 a[70:71], v25 offset:51840
    s_waitcnt lgkmcnt(12)
    v_mfma_f32_16x16x32_bf16 v[72:75], v[108:111], a[44:47], v[72:75]
    ds_read_b64_tr_b16 a[72:73], v26 offset:51328
    ds_read_b64_tr_b16 a[74:75], v26 offset:51840
    s_waitcnt lgkmcnt(12)
    v_mfma_f32_16x16x32_bf16 v[28:31], a[48:51], v[116:119], v[28:31]
    ds_read_b64_tr_b16 a[76:77], v27 offset:51328
    ds_read_b64_tr_b16 a[78:79], v27 offset:51840
    s_waitcnt lgkmcnt(12)
    v_mfma_f32_16x16x32_bf16 v[32:35], a[52:55], v[116:119], v[32:35]
    ds_read_b64_tr_b16 a[80:81], v24 offset:59520
    ds_read_b64_tr_b16 a[82:83], v24 offset:60032
    s_waitcnt lgkmcnt(12)
    v_mfma_f32_16x16x32_bf16 v[36:39], a[56:59], v[116:119], v[36:39]
    ds_read_b64_tr_b16 a[84:85], v25 offset:59520
    ds_read_b64_tr_b16 a[86:87], v25 offset:60032
    s_waitcnt lgkmcnt(12)
    v_mfma_f32_16x16x32_bf16 v[40:43], a[60:63], v[116:119], v[40:43]
    ds_read_b64_tr_b16 a[88:89], v26 offset:59520
    ds_read_b64_tr_b16 a[90:91], v26 offset:60032
    s_waitcnt lgkmcnt(12)
    v_mfma_f32_16x16x32_bf16 v[44:47], a[64:67], v[112:115], v[44:47]
    ds_read_b64_tr_b16 a[92:93], v27 offset:59520
    ds_read_b64_tr_b16 a[94:95], v27 offset:60032
    s_waitcnt lgkmcnt(12)
    v_mfma_f32_16x16x32_bf16 v[48:51], a[68:71], v[112:115], v[48:51]
    s_waitcnt lgkmcnt(10)
    v_mfma_f32_16x16x32_bf16 v[52:55], a[72:75], v[112:115], v[52:55]
    s_waitcnt lgkmcnt(8)
    v_mfma_f32_16x16x32_bf16 v[56:59], a[76:79], v[112:115], v[56:59]
    s_waitcnt lgkmcnt(6)
    v_mfma_f32_16x16x32_bf16 v[60:63], v[112:115], a[80:83], v[60:63]
    s_waitcnt lgkmcnt(4)
    v_mfma_f32_16x16x32_bf16 v[64:67], v[112:115], a[84:87], v[64:67]
    s_waitcnt lgkmcnt(2)
    v_mfma_f32_16x16x32_bf16 v[68:71], v[112:115], a[88:91], v[68:71]
    s_waitcnt lgkmcnt(0)
    v_mfma_f32_16x16x32_bf16 v[72:75], v[112:115], a[92:95], v[72:75]
    v_add_u32 v4, 156224, v12
    v_min_u32 v5, 47, v1
    v_lshlrev_b32 v5, 2, v5
    v_add_u32 v5, 156480, v5
    v_lshlrev_b32 v6, 4, v2
    v_add_u32 v6, 157184, v6
    v_mov_b32 v7, 157968
    v_lshlrev_b32 v11, 2, v3
    v_add_u32 v11, 156224, v11
    s_barrier
    ds_read_b128 v[108:111], v76 offset:0
    ds_read_b128 v[112:115], v77 offset:0
    ds_read_b64_tr_b16 a[0:1], v20 offset:0
    ds_read_b64_tr_b16 a[2:3], v20 offset:512
    ds_read_b64_tr_b16 a[4:5], v21 offset:0
    ds_read_b64_tr_b16 a[6:7], v21 offset:512
    ds_read_b64_tr_b16 a[8:9], v22 offset:0
    ds_read_b64_tr_b16 a[10:11], v22 offset:512
    ds_read_b64_tr_b16 a[12:13], v23 offset:0
    ds_read_b64_tr_b16 a[14:15], v23 offset:512
    ds_read_b64_tr_b16 a[16:17], v20 offset:8192
    ds_read_b64_tr_b16 a[18:19], v20 offset:8704
    ds_read_b64_tr_b16 a[20:21], v21 offset:8192
    ds_read_b64_tr_b16 a[22:23], v21 offset:8704
    ds_read_b64_tr_b16 a[24:25], v22 offset:8192
    ds_read_b64_tr_b16 a[26:27], v22 offset:8704
    s_waitcnt lgkmcnt(12)
    v_mfma_f32_16x16x32_bf16 v[28:31], a[0:3], v[116:119], v[28:31]
    ds_read_b64_tr_b16 a[28:29], v23 offset:8192
    ds_read_b64_tr_b16 a[30:31], v23 offset:8704
    s_waitcnt lgkmcnt(12)
    v_mfma_f32_16x16x32_bf16 v[32:35], a[4:7], v[116:119], v[32:35]
    ds_read_b64_tr_b16 a[32:33], v20 offset:16384
    ds_read_b64_tr_b16 a[34:35], v20 offset:16896
    s_waitcnt lgkmcnt(12)
    v_mfma_f32_16x16x32_bf16 v[36:39], a[8:11], v[116:119], v[36:39]
    ds_read_b64_tr_b16 a[36:37], v21 offset:16384
    ds_read_b64_tr_b16 a[38:39], v21 offset:16896
    s_waitcnt lgkmcnt(12)
    v_mfma_f32_16x16x32_bf16 v[40:43], a[12:15], v[116:119], v[40:43]
    ds_read_b64_tr_b16 a[40:41], v22 offset:16384
    ds_read_b64_tr_b16 a[42:43], v22 offset:16896
    s_waitcnt lgkmcnt(12)
    v_mfma_f32_16x16x32_bf16 v[44:47], a[16:19], v[108:111], v[44:47]
    ds_read_b64_tr_b16 a[44:45], v23 offset:16384
    ds_read_b64_tr_b16 a[46:47], v23 offset:16896
    s_waitcnt lgkmcnt(12)
    v_mfma_f32_16x16x32_bf16 v[48:51], a[20:23], v[108:111], v[48:51]
    ds_read_b64_tr_b16 a[48:49], v20 offset:4096
    ds_read_b64_tr_b16 a[50:51], v20 offset:4608
    s_waitcnt lgkmcnt(12)
    v_mfma_f32_16x16x32_bf16 v[52:55], a[24:27], v[108:111], v[52:55]
    ds_read_b64_tr_b16 a[52:53], v21 offset:4096
    ds_read_b64_tr_b16 a[54:55], v21 offset:4608
    s_waitcnt lgkmcnt(12)
    v_mfma_f32_16x16x32_bf16 v[56:59], a[28:31], v[108:111], v[56:59]
    ds_read_b64_tr_b16 a[56:57], v22 offset:4096
    ds_read_b64_tr_b16 a[58:59], v22 offset:4608
    s_waitcnt lgkmcnt(12)
    v_mfma_f32_16x16x32_bf16 v[60:63], v[108:111], a[32:35], v[60:63]
    ds_read_b64_tr_b16 a[60:61], v23 offset:4096
    ds_read_b64_tr_b16 a[62:63], v23 offset:4608
    s_waitcnt lgkmcnt(12)
    v_mfma_f32_16x16x32_bf16 v[64:67], v[108:111], a[36:39], v[64:67]
    ds_read_b64_tr_b16 a[64:65], v20 offset:12288
    ds_read_b64_tr_b16 a[66:67], v20 offset:12800
    s_waitcnt lgkmcnt(12)
    v_mfma_f32_16x16x32_bf16 v[68:71], v[108:111], a[40:43], v[68:71]
    ds_read_b64_tr_b16 a[68:69], v21 offset:12288
    ds_read_b64_tr_b16 a[70:71], v21 offset:12800
    s_waitcnt lgkmcnt(12)
    v_mfma_f32_16x16x32_bf16 v[72:75], v[108:111], a[44:47], v[72:75]
    ds_read_b64_tr_b16 a[72:73], v22 offset:12288
    ds_read_b64_tr_b16 a[74:75], v22 offset:12800
    s_waitcnt lgkmcnt(12)
    v_mfma_f32_16x16x32_bf16 v[28:31], a[48:51], v[116:119], v[28:31]
    ds_read_b64_tr_b16 a[76:77], v23 offset:12288
    ds_read_b64_tr_b16 a[78:79], v23 offset:12800
    s_waitcnt lgkmcnt(12)
    v_mfma_f32_16x16x32_bf16 v[32:35], a[52:55], v[116:119], v[32:35]
    ds_read_b64_tr_b16 a[80:81], v20 offset:20480
    ds_read_b64_tr_b16 a[82:83], v20 offset:20992
    s_waitcnt lgkmcnt(12)
    v_mfma_f32_16x16x32_bf16 v[36:39], a[56:59], v[116:119], v[36:39]
    ds_read_b64_tr_b16 a[84:85], v21 offset:20480
    ds_read_b64_tr_b16 a[86:87], v21 offset:20992
    s_waitcnt lgkmcnt(12)
    v_mfma_f32_16x16x32_bf16 v[40:43], a[60:63], v[116:119], v[40:43]
    ds_read_b64_tr_b16 a[88:89], v22 offset:20480
    ds_read_b64_tr_b16 a[90:91], v22 offset:20992
    s_waitcnt lgkmcnt(12)
    v_mfma_f32_16x16x32_bf16 v[44:47], a[64:67], v[112:115], v[44:47]
    ds_read_b64_tr_b16 a[92:93], v23 offset:20480
    ds_read_b64_tr_b16 a[94:95], v23 offset:20992
    s_waitcnt lgkmcnt(12)
    v_mfma_f32_16x16x32_bf16 v[48:51], a[68:71], v[112:115], v[48:51]
    s_waitcnt lgkmcnt(10)
    v_mfma_f32_16x16x32_bf16 v[52:55], a[72:75], v[112:115], v[52:55]
    s_waitcnt lgkmcnt(8)
    v_mfma_f32_16x16x32_bf16 v[56:59], a[76:79], v[112:115], v[56:59]
    s_waitcnt lgkmcnt(6)
    v_mfma_f32_16x16x32_bf16 v[60:63], v[112:115], a[80:83], v[60:63]
    s_waitcnt lgkmcnt(4)
    v_mfma_f32_16x16x32_bf16 v[64:67], v[112:115], a[84:87], v[64:67]
    s_waitcnt lgkmcnt(2)
    v_mfma_f32_16x16x32_bf16 v[68:71], v[112:115], a[88:91], v[68:71]
    s_waitcnt lgkmcnt(0)
    v_mfma_f32_16x16x32_bf16 v[72:75], v[112:115], a[92:95], v[72:75]
    s_barrier
    ds_read_b128 v[108:111], v76 offset:39040
    ds_read_b128 v[112:115], v77 offset:39040
    ds_read_b64_tr_b16 a[0:1], v20 offset:39040
    ds_read_b64_tr_b16 a[2:3], v20 offset:39552
    ds_read_b64_tr_b16 a[4:5], v21 offset:39040
    ds_read_b64_tr_b16 a[6:7], v21 offset:39552
    ds_read_b64_tr_b16 a[8:9], v22 offset:39040
    ds_read_b64_tr_b16 a[10:11], v22 offset:39552
    ds_read_b64_tr_b16 a[12:13], v23 offset:39040
    ds_read_b64_tr_b16 a[14:15], v23 offset:39552
    ds_read_b64_tr_b16 a[16:17], v20 offset:47232
    ds_read_b64_tr_b16 a[18:19], v20 offset:47744
    ds_read_b64_tr_b16 a[20:21], v21 offset:47232
    ds_read_b64_tr_b16 a[22:23], v21 offset:47744
    ds_read_b64_tr_b16 a[24:25], v22 offset:47232
    ds_read_b64_tr_b16 a[26:27], v22 offset:47744
    s_waitcnt lgkmcnt(12)
    v_mfma_f32_16x16x32_bf16 v[28:31], a[0:3], v[116:119], v[28:31]
    ds_read_b64_tr_b16 a[28:29], v23 offset:47232
    ds_read_b64_tr_b16 a[30:31], v23 offset:47744
    s_waitcnt lgkmcnt(12)
    v_mfma_f32_16x16x32_bf16 v[32:35], a[4:7], v[116:119], v[32:35]
    ds_read_b64_tr_b16 a[32:33], v20 offset:55424
    ds_read_b64_tr_b16 a[34:35], v20 offset:55936
    s_waitcnt lgkmcnt(12)
    v_mfma_f32_16x16x32_bf16 v[36:39], a[8:11], v[116:119], v[36:39]
    ds_read_b64_tr_b16 a[36:37], v21 offset:55424
    ds_read_b64_tr_b16 a[38:39], v21 offset:55936
    s_waitcnt lgkmcnt(12)
    v_mfma_f32_16x16x32_bf16 v[40:43], a[12:15], v[116:119], v[40:43]
    ds_read_b64_tr_b16 a[40:41], v22 offset:55424
    ds_read_b64_tr_b16 a[42:43], v22 offset:55936
    s_waitcnt lgkmcnt(12)
    v_mfma_f32_16x16x32_bf16 v[44:47], a[16:19], v[108:111], v[44:47]
    ds_read_b64_tr_b16 a[44:45], v23 offset:55424
    ds_read_b64_tr_b16 a[46:47], v23 offset:55936
    s_waitcnt lgkmcnt(12)
    v_mfma_f32_16x16x32_bf16 v[48:51], a[20:23], v[108:111], v[48:51]
    ds_read_b64_tr_b16 a[48:49], v20 offset:43136
    ds_read_b64_tr_b16 a[50:51], v20 offset:43648
    s_waitcnt lgkmcnt(12)
    v_mfma_f32_16x16x32_bf16 v[52:55], a[24:27], v[108:111], v[52:55]
    ds_read_b64_tr_b16 a[52:53], v21 offset:43136
    ds_read_b64_tr_b16 a[54:55], v21 offset:43648
    s_waitcnt lgkmcnt(12)
    v_mfma_f32_16x16x32_bf16 v[56:59], a[28:31], v[108:111], v[56:59]
    ds_read_b64_tr_b16 a[56:57], v22 offset:43136
    ds_read_b64_tr_b16 a[58:59], v22 offset:43648
    s_waitcnt lgkmcnt(12)
    v_mfma_f32_16x16x32_bf16 v[60:63], v[108:111], a[32:35], v[60:63]
    ds_read_b64_tr_b16 a[60:61], v23 offset:43136
    ds_read_b64_tr_b16 a[62:63], v23 offset:43648
    s_waitcnt lgkmcnt(12)
    v_mfma_f32_16x16x32_bf16 v[64:67], v[108:111], a[36:39], v[64:67]
    ds_read_b64_tr_b16 a[64:65], v20 offset:51328
    ds_read_b64_tr_b16 a[66:67], v20 offset:51840
    s_waitcnt lgkmcnt(12)
    v_mfma_f32_16x16x32_bf16 v[68:71], v[108:111], a[40:43], v[68:71]
    ds_read_b64_tr_b16 a[68:69], v21 offset:51328
    ds_read_b64_tr_b16 a[70:71], v21 offset:51840
    s_waitcnt lgkmcnt(12)
    v_mfma_f32_16x16x32_bf16 v[72:75], v[108:111], a[44:47], v[72:75]
    ds_read_b64_tr_b16 a[72:73], v22 offset:51328
    ds_read_b64_tr_b16 a[74:75], v22 offset:51840
    s_waitcnt lgkmcnt(12)
    v_mfma_f32_16x16x32_bf16 v[28:31], a[48:51], v[116:119], v[28:31]
    ds_read_b64_tr_b16 a[76:77], v23 offset:51328
    ds_read_b64_tr_b16 a[78:79], v23 offset:51840
    s_waitcnt lgkmcnt(12)
    v_mfma_f32_16x16x32_bf16 v[32:35], a[52:55], v[116:119], v[32:35]
    ds_read_b64_tr_b16 a[80:81], v20 offset:59520
    ds_read_b64_tr_b16 a[82:83], v20 offset:60032
    s_waitcnt lgkmcnt(12)
    v_mfma_f32_16x16x32_bf16 v[36:39], a[56:59], v[116:119], v[36:39]
    ds_read_b64_tr_b16 a[84:85], v21 offset:59520
    ds_read_b64_tr_b16 a[86:87], v21 offset:60032
    s_waitcnt lgkmcnt(12)
    v_mfma_f32_16x16x32_bf16 v[40:43], a[60:63], v[116:119], v[40:43]
    ds_read_b64_tr_b16 a[88:89], v22 offset:59520
    ds_read_b64_tr_b16 a[90:91], v22 offset:60032
    s_waitcnt lgkmcnt(12)
    v_mfma_f32_16x16x32_bf16 v[44:47], a[64:67], v[112:115], v[44:47]
    ds_read_b64_tr_b16 a[92:93], v23 offset:59520
    ds_read_b64_tr_b16 a[94:95], v23 offset:60032
    s_waitcnt lgkmcnt(12)
    v_mfma_f32_16x16x32_bf16 v[48:51], a[68:71], v[112:115], v[48:51]
    s_waitcnt lgkmcnt(10)
    v_mfma_f32_16x16x32_bf16 v[52:55], a[72:75], v[112:115], v[52:55]
    s_waitcnt lgkmcnt(8)
    v_mfma_f32_16x16x32_bf16 v[56:59], a[76:79], v[112:115], v[56:59]
    s_waitcnt lgkmcnt(6)
    v_mfma_f32_16x16x32_bf16 v[60:63], v[112:115], a[80:83], v[60:63]
    s_waitcnt lgkmcnt(4)
    v_mfma_f32_16x16x32_bf16 v[64:67], v[112:115], a[84:87], v[64:67]
    s_waitcnt lgkmcnt(2)
    v_mfma_f32_16x16x32_bf16 v[68:71], v[112:115], a[88:91], v[68:71]
    s_waitcnt lgkmcnt(0)
    v_mfma_f32_16x16x32_bf16 v[72:75], v[112:115], a[92:95], v[72:75]
    s_barrier
    ds_read_b128 a[96:99], v80 offset:0
    ds_read_b128 a[100:103], v81 offset:0
    ds_read_b64_tr_b16 a[0:1], v24 offset:0
    ds_read_b64_tr_b16 a[2:3], v24 offset:512
    ds_read_b64_tr_b16 a[4:5], v25 offset:0
    ds_read_b64_tr_b16 a[6:7], v25 offset:512
    ds_read_b64_tr_b16 a[8:9], v26 offset:0
    ds_read_b64_tr_b16 a[10:11], v26 offset:512
    ds_read_b64_tr_b16 a[12:13], v27 offset:0
    ds_read_b64_tr_b16 a[14:15], v27 offset:512
    ds_read_b64_tr_b16 a[16:17], v24 offset:8192
    ds_read_b64_tr_b16 a[18:19], v24 offset:8704
    ds_read_b64_tr_b16 a[20:21], v25 offset:8192
    ds_read_b64_tr_b16 a[22:23], v25 offset:8704
    ds_read_b64_tr_b16 a[24:25], v26 offset:8192
    ds_read_b64_tr_b16 a[26:27], v26 offset:8704
    s_waitcnt lgkmcnt(12)
    v_mfma_f32_16x16x32_bf16 v[28:31], a[0:3], v[116:119], v[28:31]
    ds_read_b64_tr_b16 a[28:29], v27 offset:8192
    ds_read_b64_tr_b16 a[30:31], v27 offset:8704
    s_waitcnt lgkmcnt(12)
    v_mfma_f32_16x16x32_bf16 v[32:35], a[4:7], v[116:119], v[32:35]
    ds_read_b64_tr_b16 a[48:49], v24 offset:4096
    ds_read_b64_tr_b16 a[50:51], v24 offset:4608
    s_waitcnt lgkmcnt(12)
    v_mfma_f32_16x16x32_bf16 v[36:39], a[8:11], v[116:119], v[36:39]
    ds_read_b64_tr_b16 a[52:53], v25 offset:4096
    ds_read_b64_tr_b16 a[54:55], v25 offset:4608
    s_waitcnt lgkmcnt(12)
    v_mfma_f32_16x16x32_bf16 v[40:43], a[12:15], v[116:119], v[40:43]
    ds_read_b64_tr_b16 a[56:57], v26 offset:4096
    ds_read_b64_tr_b16 a[58:59], v26 offset:4608
    s_waitcnt lgkmcnt(12)
    v_mfma_f32_16x16x32_bf16 v[44:47], a[16:19], a[96:99], v[44:47]
    ds_read_b64_tr_b16 a[60:61], v27 offset:4096
    ds_read_b64_tr_b16 a[62:63], v27 offset:4608
    s_waitcnt lgkmcnt(12)
    v_mfma_f32_16x16x32_bf16 v[48:51], a[20:23], a[96:99], v[48:51]
    ds_read_b64_tr_b16 a[64:65], v24 offset:12288
    ds_read_b64_tr_b16 a[66:67], v24 offset:12800
    s_waitcnt lgkmcnt(12)
    v_mfma_f32_16x16x32_bf16 v[52:55], a[24:27], a[96:99], v[52:55]
    ds_read_b64_tr_b16 a[68:69], v25 offset:12288
    ds_read_b64_tr_b16 a[70:71], v25 offset:12800
    s_waitcnt lgkmcnt(12)
    v_mfma_f32_16x16x32_bf16 v[56:59], a[28:31], a[96:99], v[56:59]
    ds_read_b64_tr_b16 a[72:73], v26 offset:12288
    ds_read_b64_tr_b16 a[74:75], v26 offset:12800
    s_waitcnt lgkmcnt(12)
    v_mfma_f32_16x16x32_bf16 v[28:31], a[48:51], v[116:119], v[28:31]
    ds_read_b64_tr_b16 a[76:77], v27 offset:12288
    ds_read_b64_tr_b16 a[78:79], v27 offset:12800
    s_waitcnt lgkmcnt(12)
    v_mfma_f32_16x16x32_bf16 v[32:35], a[52:55], v[116:119], v[32:35]
    s_waitcnt lgkmcnt(10)
    v_mfma_f32_16x16x32_bf16 v[36:39], a[56:59], v[116:119], v[36:39]
    s_waitcnt lgkmcnt(8)
    v_mfma_f32_16x16x32_bf16 v[40:43], a[60:63], v[116:119], v[40:43]
    s_waitcnt lgkmcnt(6)
    v_mfma_f32_16x16x32_bf16 v[44:47], a[64:67], a[100:103], v[44:47]
    s_waitcnt lgkmcnt(4)
    v_mfma_f32_16x16x32_bf16 v[48:51], a[68:71], a[100:103], v[48:51]
    s_waitcnt lgkmcnt(2)
    v_mfma_f32_16x16x32_bf16 v[52:55], a[72:75], a[100:103], v[52:55]
    s_waitcnt lgkmcnt(0)
    v_mfma_f32_16x16x32_bf16 v[56:59], a[76:79], a[100:103], v[56:59]
    s_barrier
    ds_read_b128 a[104:107], v80 offset:39040
    ds_read_b128 a[108:111], v81 offset:39040
    ds_read_b64_tr_b16 a[0:1], v24 offset:39040
    ds_read_b64_tr_b16 a[2:3], v24 offset:39552
    ds_read_b64_tr_b16 a[4:5], v25 offset:39040
    ds_read_b64_tr_b16 a[6:7], v25 offset:39552
    ds_read_b64_tr_b16 a[8:9], v26 offset:39040
    ds_read_b64_tr_b16 a[10:11], v26 offset:39552
    ds_read_b64_tr_b16 a[12:13], v27 offset:39040
    ds_read_b64_tr_b16 a[14:15], v27 offset:39552
    ds_read_b64_tr_b16 a[16:17], v24 offset:47232
    ds_read_b64_tr_b16 a[18:19], v24 offset:47744
    ds_read_b64_tr_b16 a[20:21], v25 offset:47232
    ds_read_b64_tr_b16 a[22:23], v25 offset:47744
    ds_read_b64_tr_b16 a[24:25], v26 offset:47232
    ds_read_b64_tr_b16 a[26:27], v26 offset:47744
    s_waitcnt lgkmcnt(12)
    v_mfma_f32_16x16x32_bf16 v[28:31], a[0:3], v[116:119], v[28:31]
    ds_read_b64_tr_b16 a[28:29], v27 offset:47232
    ds_read_b64_tr_b16 a[30:31], v27 offset:47744
    s_waitcnt lgkmcnt(12)
    v_mfma_f32_16x16x32_bf16 v[32:35], a[4:7], v[116:119], v[32:35]
    ds_read_b64_tr_b16 a[48:49], v24 offset:43136
    ds_read_b64_tr_b16 a[50:51], v24 offset:43648
    s_waitcnt lgkmcnt(12)
    v_mfma_f32_16x16x32_bf16 v[36:39], a[8:11], v[116:119], v[36:39]
    ds_read_b64_tr_b16 a[52:53], v25 offset:43136
    ds_read_b64_tr_b16 a[54:55], v25 offset:43648
    s_waitcnt lgkmcnt(12)
    v_mfma_f32_16x16x32_bf16 v[40:43], a[12:15], v[116:119], v[40:43]
    ds_read_b64_tr_b16 a[56:57], v26 offset:43136
    ds_read_b64_tr_b16 a[58:59], v26 offset:43648
    s_waitcnt lgkmcnt(12)
    v_mfma_f32_16x16x32_bf16 v[44:47], a[16:19], a[104:107], v[44:47]
    ds_read_b64_tr_b16 a[60:61], v27 offset:43136
    ds_read_b64_tr_b16 a[62:63], v27 offset:43648
    s_waitcnt lgkmcnt(12)
    v_mfma_f32_16x16x32_bf16 v[48:51], a[20:23], a[104:107], v[48:51]
    ds_read_b64_tr_b16 a[64:65], v24 offset:51328
    ds_read_b64_tr_b16 a[66:67], v24 offset:51840
    s_waitcnt lgkmcnt(12)
    v_mfma_f32_16x16x32_bf16 v[52:55], a[24:27], a[104:107], v[52:55]
    ds_read_b64_tr_b16 a[68:69], v25 offset:51328
    ds_read_b64_tr_b16 a[70:71], v25 offset:51840
    s_waitcnt lgkmcnt(12)
    v_mfma_f32_16x16x32_bf16 v[56:59], a[28:31], a[104:107], v[56:59]
    ds_read_b64_tr_b16 a[72:73], v26 offset:51328
    ds_read_b64_tr_b16 a[74:75], v26 offset:51840
    s_waitcnt lgkmcnt(12)
    v_mfma_f32_16x16x32_bf16 v[28:31], a[48:51], v[116:119], v[28:31]
    ds_read_b64_tr_b16 a[76:77], v27 offset:51328
    ds_read_b64_tr_b16 a[78:79], v27 offset:51840
    s_waitcnt lgkmcnt(12)
    v_mfma_f32_16x16x32_bf16 v[32:35], a[52:55], v[116:119], v[32:35]
    s_waitcnt lgkmcnt(10)
    v_mfma_f32_16x16x32_bf16 v[36:39], a[56:59], v[116:119], v[36:39]
    s_waitcnt lgkmcnt(8)
    v_mfma_f32_16x16x32_bf16 v[40:43], a[60:63], v[116:119], v[40:43]
    s_waitcnt lgkmcnt(6)
    v_mfma_f32_16x16x32_bf16 v[44:47], a[64:67], a[108:111], v[44:47]
    s_waitcnt lgkmcnt(4)
    v_mfma_f32_16x16x32_bf16 v[48:51], a[68:71], a[108:111], v[48:51]
    s_waitcnt lgkmcnt(2)
    v_mfma_f32_16x16x32_bf16 v[52:55], a[72:75], a[108:111], v[52:55]
    s_waitcnt lgkmcnt(0)
    v_mfma_f32_16x16x32_bf16 v[56:59], a[76:79], a[108:111], v[56:59]
    buffer_load_dwordx2 v[92:93], v96, s[28:31], s46 offen sc1
    buffer_load_dwordx2 v[94:95], v97, s[28:31], s46 offen sc1
    s_barrier
    ds_read_b128 a[112:115], v76 offset:0
    ds_read_b128 a[116:119], v77 offset:0
    ds_read_b64_tr_b16 a[0:1], v20 offset:0
    ds_read_b64_tr_b16 a[2:3], v20 offset:512
    ds_read_b64_tr_b16 a[4:5], v21 offset:0
    ds_read_b64_tr_b16 a[6:7], v21 offset:512
    ds_read_b64_tr_b16 a[8:9], v22 offset:0
    ds_read_b64_tr_b16 a[10:11], v22 offset:512
    ds_read_b64_tr_b16 a[12:13], v23 offset:0
    ds_read_b64_tr_b16 a[14:15], v23 offset:512
    ds_read_b64_tr_b16 a[16:17], v20 offset:8192
    ds_read_b64_tr_b16 a[18:19], v20 offset:8704
    ds_read_b64_tr_b16 a[20:21], v21 offset:8192
    ds_read_b64_tr_b16 a[22:23], v21 offset:8704
    ds_read_b64_tr_b16 a[24:25], v22 offset:8192
    ds_read_b64_tr_b16 a[26:27], v22 offset:8704
    s_waitcnt lgkmcnt(12)
    v_mfma_f32_16x16x32_bf16 v[28:31], a[0:3], v[116:119], v[28:31]
    ds_read_b64_tr_b16 a[28:29], v23 offset:8192
    ds_read_b64_tr_b16 a[30:31], v23 offset:8704
    s_waitcnt lgkmcnt(12)
    v_mfma_f32_16x16x32_bf16 v[32:35], a[4:7], v[116:119], v[32:35]
    ds_read_b64_tr_b16 a[48:49], v20 offset:4096
    ds_read_b64_tr_b16 a[50:51], v20 offset:4608
    s_waitcnt lgkmcnt(12)
    v_mfma_f32_16x16x32_bf16 v[36:39], a[8:11], v[116:119], v[36:39]
    ds_read_b64_tr_b16 a[52:53], v21 offset:4096
    ds_read_b64_tr_b16 a[54:55], v21 offset:4608
    s_waitcnt lgkmcnt(12)
    v_mfma_f32_16x16x32_bf16 v[40:43], a[12:15], v[116:119], v[40:43]
    ds_read_b64_tr_b16 a[56:57], v22 offset:4096
    ds_read_b64_tr_b16 a[58:59], v22 offset:4608
    s_waitcnt lgkmcnt(12)
    v_mfma_f32_16x16x32_bf16 v[44:47], a[16:19], a[112:115], v[44:47]
    ds_read_b64_tr_b16 a[60:61], v23 offset:4096
    ds_read_b64_tr_b16 a[62:63], v23 offset:4608
    s_waitcnt lgkmcnt(12)
    v_mfma_f32_16x16x32_bf16 v[48:51], a[20:23], a[112:115], v[48:51]
    ds_read_b64_tr_b16 a[64:65], v20 offset:12288
    ds_read_b64_tr_b16 a[66:67], v20 offset:12800
    s_waitcnt lgkmcnt(12)
    v_mfma_f32_16x16x32_bf16 v[52:55], a[24:27], a[112:115], v[52:55]
    ds_read_b64_tr_b16 a[68:69], v21 offset:12288
    ds_read_b64_tr_b16 a[70:71], v21 offset:12800
    s_waitcnt lgkmcnt(12)
    v_mfma_f32_16x16x32_bf16 v[56:59], a[28:31], a[112:115], v[56:59]
    ds_read_b64_tr_b16 a[72:73], v22 offset:12288
    ds_read_b64_tr_b16 a[74:75], v22 offset:12800
    s_waitcnt lgkmcnt(12)
    v_mfma_f32_16x16x32_bf16 v[28:31], a[48:51], v[116:119], v[28:31]
    ds_read_b64_tr_b16 a[76:77], v23 offset:12288
    ds_read_b64_tr_b16 a[78:79], v23 offset:12800
    s_waitcnt lgkmcnt(12)
    v_mfma_f32_16x16x32_bf16 v[32:35], a[52:55], v[116:119], v[32:35]
    s_waitcnt lgkmcnt(10)
    v_mfma_f32_16x16x32_bf16 v[36:39], a[56:59], v[116:119], v[36:39]
    s_waitcnt vmcnt(0)
Lst_chk:
    v_cmp_ne_u32 vcc, s34, v93
    v_cmp_ne_u32 s[36:37], s34, v95
    s_nop 0
    s_or_b64 s[36:37], s[36:37], vcc
    s_cbranch_scc1 Lst_re
    v_lshlrev_b32 v93, 16, v92
    s_waitcnt lgkmcnt(8)
    v_mfma_f32_16x16x32_bf16 v[40:43], a[60:63], v[116:119], v[40:43]
    v_and_b32 v92, 0xffff0000, v92
    v_rcp_f32 v93, v93
    s_waitcnt lgkmcnt(6)
    v_mfma_f32_16x16x32_bf16 v[44:47], a[64:67], a[116:119], v[44:47]
    v_lshlrev_b32 v95, 16, v94
    v_and_b32 v94, 0xffff0000, v94
    s_waitcnt lgkmcnt(4)
    v_mfma_f32_16x16x32_bf16 v[48:51], a[68:71], a[116:119], v[48:51]
    v_rcp_f32 v95, v95
    ds_write2st64_b32 v4, v92, v93 offset0:0 offset1:2
    s_waitcnt lgkmcnt(3)
    v_mfma_f32_16x16x32_bf16 v[52:55], a[72:75], a[116:119], v[52:55]
    ds_write2st64_b32 v5, v94, v95 offset0:0 offset1:2
    ds_read_b32 v120, v11
    s_waitcnt lgkmcnt(3)
    v_mfma_f32_16x16x32_bf16 v[56:59], a[76:79], a[116:119], v[56:59]
    s_waitcnt lgkmcnt(0)
    s_barrier
    ds_read_b128 a[120:123], v76 offset:39040
    ds_read_b128 a[124:127], v77 offset:39040
    ds_read_b64_tr_b16 a[0:1], v20 offset:39040
    ds_read_b64_tr_b16 a[2:3], v20 offset:39552
    ds_read_b64_tr_b16 a[4:5], v21 offset:39040
    ds_read_b64_tr_b16 a[6:7], v21 offset:39552
    ds_read_b64_tr_b16 a[8:9], v22 offset:39040
    ds_read_b64_tr_b16 a[10:11], v22 offset:39552
    ds_read_b64_tr_b16 a[12:13], v23 offset:39040
    ds_read_b64_tr_b16 a[14:15], v23 offset:39552
    ds_read_b64_tr_b16 a[16:17], v20 offset:47232
    ds_read_b64_tr_b16 a[18:19], v20 offset:47744
    ds_read_b64_tr_b16 a[20:21], v21 offset:47232
    ds_read_b64_tr_b16 a[22:23], v21 offset:47744
    ds_read_b64_tr_b16 a[24:25], v22 offset:47232
    ds_read_b64_tr_b16 a[26:27], v22 offset:47744
    s_waitcnt lgkmcnt(12)
    v_mfma_f32_16x16x32_bf16 v[28:31], a[0:3], v[116:119], v[28:31]
    ds_read_b64_tr_b16 a[28:29], v23 offset:47232
    ds_read_b64_tr_b16 a[30:31], v23 offset:47744
    s_waitcnt lgkmcnt(12)
    v_mfma_f32_16x16x32_bf16 v[32:35], a[4:7], v[116:119], v[32:35]
    ds_read_b64_tr_b16 a[48:49], v20 offset:43136
    ds_read_b64_tr_b16 a[50:51], v20 offset:43648
    s_waitcnt lgkmcnt(12)
    v_mfma_f32_16x16x32_bf16 v[36:39], a[8:11], v[116:119], v[36:39]
    ds_read_b64_tr_b16 a[52:53], v21 offset:43136
    ds_read_b64_tr_b16 a[54:55], v21 offset:43648
    s_waitcnt lgkmcnt(12)
    v_mfma_f32_16x16x32_bf16 v[40:43], a[12:15], v[116:119], v[40:43]
    ds_read_b64_tr_b16 a[56:57], v22 offset:43136
    ds_read_b64_tr_b16 a[58:59], v22 offset:43648
    s_waitcnt lgkmcnt(12)
    v_mfma_f32_16x16x32_bf16 v[44:47], a[16:19], a[120:123], v[44:47]
    ds_read_b64_tr_b16 a[60:61], v23 offset:43136
    ds_read_b64_tr_b16 a[62:63], v23 offset:43648
    s_waitcnt lgkmcnt(12)
    v_mfma_f32_16x16x32_bf16 v[48:51], a[20:23], a[120:123], v[48:51]
    ds_read_b64_tr_b16 a[64:65], v20 offset:51328
    ds_read_b64_tr_b16 a[66:67], v20 offset:51840
    s_waitcnt lgkmcnt(12)
    v_mfma_f32_16x16x32_bf16 v[52:55], a[24:27], a[120:123], v[52:55]
    ds_read_b64_tr_b16 a[68:69], v21 offset:51328
    ds_read_b64_tr_b16 a[70:71], v21 offset:51840
    s_waitcnt lgkmcnt(12)
    v_mfma_f32_16x16x32_bf16 v[56:59], a[28:31], a[120:123], v[56:59]
    ds_read_b64_tr_b16 a[72:73], v22 offset:51328
    ds_read_b64_tr_b16 a[74:75], v22 offset:51840
    s_waitcnt lgkmcnt(12)
    v_mfma_f32_16x16x32_bf16 v[28:31], a[48:51], v[116:119], v[28:31]
    ds_read_b64_tr_b16 a[76:77], v23 offset:51328
    ds_read_b64_tr_b16 a[78:79], v23 offset:51840
    s_waitcnt lgkmcnt(12)
    v_mfma_f32_16x16x32_bf16 v[32:35], a[52:55], v[116:119], v[32:35]
    s_waitcnt lgkmcnt(10)
    v_mfma_f32_16x16x32_bf16 v[36:39], a[56:59], v[116:119], v[36:39]
    s_waitcnt lgkmcnt(8)
    v_mfma_f32_16x16x32_bf16 v[40:43], a[60:63], v[116:119], v[40:43]
    s_waitcnt lgkmcnt(6)
    v_mfma_f32_16x16x32_bf16 v[44:47], a[64:67], a[124:127], v[44:47]
    s_waitcnt lgkmcnt(4)
    v_mfma_f32_16x16x32_bf16 v[48:51], a[68:71], a[124:127], v[48:51]
    s_waitcnt lgkmcnt(2)
    v_mfma_f32_16x16x32_bf16 v[52:55], a[72:75], a[124:127], v[52:55]
    s_waitcnt lgkmcnt(0)
    v_mfma_f32_16x16x32_bf16 v[56:59], a[76:79], a[124:127], v[56:59]
    s_mov_b32 exec_lo, 0x00010001
    s_mov_b32 exec_hi, 0x00010001
    ds_write_b128 v6, v[28:31] offset:0
    ds_write_b128 v6, v[32:35] offset:64
    ds_write_b128 v6, v[36:39] offset:128
    ds_write_b128 v6, v[40:43] offset:192
    ds_write_b128 v6, v[44:47] offset:256
    ds_write_b128 v6, v[48:51] offset:320
    ds_write_b128 v6, v[52:55] offset:384
    ds_write_b128 v6, v[56:59] offset:448
    ds_write_b32 v7, v7
    s_mov_b64 exec, -1
    ds_read_b128 v[76:79], v6 offset:256
    ds_read_b128 v[80:83], v6 offset:320
    ds_read_b128 v[84:87], v6 offset:384
    ds_read_b128 v[88:91], v6 offset:448
    s_waitcnt lgkmcnt(0)
    v_fmac_f32 v44, v76, v120
    v_fmac_f32 v45, v77, v120
    v_fmac_f32 v46, v78, v120
    v_fmac_f32 v47, v79, v120
    v_cvt_pk_bf16_f32 v44, v44, v45
    v_cvt_pk_bf16_f32 v45, v46, v47
    v_fmac_f32 v48, v80, v120
    v_fmac_f32 v49, v81, v120
    v_fmac_f32 v50, v82, v120
    v_fmac_f32 v51, v83, v120
    v_cvt_pk_bf16_f32 v46, v48, v49
    v_cvt_pk_bf16_f32 v47, v50, v51
    v_fmac_f32 v52, v84, v120
    v_fmac_f32 v53, v85, v120
    v_fmac_f32 v54, v86, v120
    v_fmac_f32 v55, v87, v120
    v_cvt_pk_bf16_f32 v48, v52, v53
    v_cvt_pk_bf16_f32 v49, v54, v55
    v_fmac_f32 v56, v88, v120
    v_fmac_f32 v57, v89, v120
    v_fmac_f32 v58, v90, v120
    v_fmac_f32 v59, v91, v120
    v_cvt_pk_bf16_f32 v50, v56, v57
    v_cvt_pk_bf16_f32 v51, v58, v59
    ds_write_b128 v125, v[44:47] offset:4096
    ds_write_b128 v125, v[48:51] offset:5120
    v_mov_b32 v5, 157972
    v_mov_b32 v6, 1
    s_mov_b64 exec, 1
    ds_add_u32 v5, v6
    s_mov_b64 exec, -1
    v_mov_b32 v5, 157980
Lcw_6:
    s_sub_u32 s35, s35, 1
    s_cbranch_scc1 Lend
    ds_read_b32 v6, v5
    s_waitcnt lgkmcnt(0)
    v_readfirstlane_b32 s38, v6
    s_nop 0
    s_cmp_lt_u32 s38, 1
    s_cbranch_scc1 Lcw_6
    ds_read_b64_tr_b16 a[0:1], v24 offset:16384
    ds_read_b64_tr_b16 a[2:3], v24 offset:16896
    ds_read_b64_tr_b16 a[4:5], v25 offset:16384
    ds_read_b64_tr_b16 a[6:7], v25 offset:16896
    ds_read_b64_tr_b16 a[8:9], v26 offset:16384
    ds_read_b64_tr_b16 a[10:11], v26 offset:16896
    ds_read_b64_tr_b16 a[12:13], v27 offset:16384
    ds_read_b64_tr_b16 a[14:15], v27 offset:16896
    ds_read_b64_tr_b16 a[16:17], v24 offset:20480
    ds_read_b64_tr_b16 a[18:19], v24 offset:20992
    ds_read_b64_tr_b16 a[20:21], v25 offset:20480
    ds_read_b64_tr_b16 a[22:23], v25 offset:20992
    ds_read_b64_tr_b16 a[24:25], v26 offset:20480
    ds_read_b64_tr_b16 a[26:27], v26 offset:20992
    ds_read_b64_tr_b16 a[28:29], v27 offset:20480
    ds_read_b64_tr_b16 a[30:31], v27 offset:20992
    ds_read_b64_tr_b16 a[32:33], v24 offset:55424
    ds_read_b64_tr_b16 a[34:35], v24 offset:55936
    ds_read_b64_tr_b16 a[36:37], v25 offset:55424
    ds_read_b64_tr_b16 a[38:39], v25 offset:55936
    ds_read_b64_tr_b16 a[40:41], v26 offset:55424
    ds_read_b64_tr_b16 a[42:43], v26 offset:55936
    ds_read_b64_tr_b16 a[44:45], v27 offset:55424
    ds_read_b64_tr_b16 a[46:47], v27 offset:55936
    ds_read_b64_tr_b16 a[48:49], v24 offset:59520
    ds_read_b64_tr_b16 a[50:51], v24 offset:60032
    ds_read_b64_tr_b16 a[52:53], v25 offset:59520
    ds_read_b64_tr_b16 a[54:55], v25 offset:60032
    ds_read_b64_tr_b16 a[56:57], v26 offset:59520
    ds_read_b64_tr_b16 a[58:59], v26 offset:60032
    ds_read_b64_tr_b16 a[60:61], v27 offset:59520
    ds_read_b64_tr_b16 a[62:63], v27 offset:60032
    ds_read_b64_tr_b16 a[64:65], v20 offset:16384
    ds_read_b64_tr_b16 a[66:67], v20 offset:16896
    ds_read_b64_tr_b16 a[68:69], v21 offset:16384
    ds_read_b64_tr_b16 a[70:71], v21 offset:16896
    ds_read_b64_tr_b16 a[72:73], v22 offset:16384
    ds_read_b64_tr_b16 a[74:75], v22 offset:16896
    ds_read_b64_tr_b16 a[76:77], v23 offset:16384
    ds_read_b64_tr_b16 a[78:79], v23 offset:16896
    ds_read_b64_tr_b16 a[80:81], v20 offset:20480
    ds_read_b64_tr_b16 a[82:83], v20 offset:20992
    ds_read_b64_tr_b16 a[84:85], v21 offset:20480
    ds_read_b64_tr_b16 a[86:87], v21 offset:20992
    ds_read_b64_tr_b16 a[88:89], v22 offset:20480
    ds_read_b64_tr_b16 a[90:91], v22 offset:20992
    ds_read_b64_tr_b16 a[92:93], v23 offset:20480
    ds_read_b64_tr_b16 a[94:95], v23 offset:20992
    s_waitcnt lgkmcnt(15)
    v_mfma_f32_16x16x32_bf16 v[60:63], a[96:99], a[0:3], v[60:63]
    v_mfma_f32_16x16x32_bf16 v[64:67], a[96:99], a[4:7], v[64:67]
    v_mfma_f32_16x16x32_bf16 v[68:71], a[96:99], a[8:11], v[68:71]
    v_mfma_f32_16x16x32_bf16 v[72:75], a[96:99], a[12:15], v[72:75]
    ds_read_b64_tr_b16 a[0:1], v20 offset:55424
    ds_read_b64_tr_b16 a[2:3], v20 offset:55936
    ds_read_b64_tr_b16 a[4:5], v21 offset:55424
    ds_read_b64_tr_b16 a[6:7], v21 offset:55936
    ds_read_b64_tr_b16 a[8:9], v22 offset:55424
    ds_read_b64_tr_b16 a[10:11], v22 offset:55936
    ds_read_b64_tr_b16 a[12:13], v23 offset:55424
    ds_read_b64_tr_b16 a[14:15], v23 offset:55936
    v_mfma_f32_16x16x32_bf16 v[60:63], a[100:103], a[16:19], v[60:63]
    v_mfma_f32_16x16x32_bf16 v[64:67], a[100:103], a[20:23], v[64:67]
    v_mfma_f32_16x16x32_bf16 v[68:71], a[100:103], a[24:27], v[68:71]
    v_mfma_f32_16x16x32_bf16 v[72:75], a[100:103], a[28:31], v[72:75]
    ds_read_b64_tr_b16 a[16:17], v20 offset:59520
    ds_read_b64_tr_b16 a[18:19], v20 offset:60032
    ds_read_b64_tr_b16 a[20:21], v21 offset:59520
    ds_read_b64_tr_b16 a[22:23], v21 offset:60032
    ds_read_b64_tr_b16 a[24:25], v22 offset:59520
    ds_read_b64_tr_b16 a[26:27], v22 offset:60032
    ds_read_b64_tr_b16 a[28:29], v23 offset:59520
    ds_read_b64_tr_b16 a[30:31], v23 offset:60032
    v_mfma_f32_16x16x32_bf16 v[60:63], a[104:107], a[32:35], v[60:63]
    v_mfma_f32_16x16x32_bf16 v[64:67], a[104:107], a[36:39], v[64:67]
    v_mfma_f32_16x16x32_bf16 v[68:71], a[104:107], a[40:43], v[68:71]
    v_mfma_f32_16x16x32_bf16 v[72:75], a[104:107], a[44:47], v[72:75]
    v_mfma_f32_16x16x32_bf16 v[60:63], a[108:111], a[48:51], v[60:63]
    v_mfma_f32_16x16x32_bf16 v[64:67], a[108:111], a[52:55], v[64:67]
    v_mfma_f32_16x16x32_bf16 v[68:71], a[108:111], a[56:59], v[68:71]
    v_mfma_f32_16x16x32_bf16 v[72:75], a[108:111], a[60:63], v[72:75]
    s_waitcnt lgkmcnt(15)
    v_mfma_f32_16x16x32_bf16 v[60:63], a[112:115], a[64:67], v[60:63]
    v_mfma_f32_16x16x32_bf16 v[64:67], a[112:115], a[68:71], v[64:67]
    v_mfma_f32_16x16x32_bf16 v[68:71], a[112:115], a[72:75], v[68:71]
    v_mfma_f32_16x16x32_bf16 v[72:75], a[112:115], a[76:79], v[72:75]
    v_mfma_f32_16x16x32_bf16 v[60:63], a[116:119], a[80:83], v[60:63]
    v_mfma_f32_16x16x32_bf16 v[64:67], a[116:119], a[84:87], v[64:67]
    v_mfma_f32_16x16x32_bf16 v[68:71], a[116:119], a[88:91], v[68:71]
    v_mfma_f32_16x16x32_bf16 v[72:75], a[116:119], a[92:95], v[72:75]
    s_waitcnt lgkmcnt(8)
    v_mfma_f32_16x16x32_bf16 v[60:63], a[120:123], a[0:3], v[60:63]
    v_mfma_f32_16x16x32_bf16 v[64:67], a[120:123], a[4:7], v[64:67]
    v_mfma_f32_16x16x32_bf16 v[68:71], a[120:123], a[8:11], v[68:71]
    v_mfma_f32_16x16x32_bf16 v[72:75], a[120:123], a[12:15], v[72:75]
    s_waitcnt lgkmcnt(0)
    v_mfma_f32_16x16x32_bf16 v[60:63], a[124:127], a[16:19], v[60:63]
    v_mfma_f32_16x16x32_bf16 v[64:67], a[124:127], a[20:23], v[64:67]
    v_mfma_f32_16x16x32_bf16 v[68:71], a[124:127], a[24:27], v[68:71]
    v_mfma_f32_16x16x32_bf16 v[72:75], a[124:127], a[28:31], v[72:75]
    v_lshlrev_b32 v5, 4, v3
    v_add_u32 v5, 157696, v5
    v_mov_b32 v6, 157952
    v_lshlrev_b32 v4, 4, v2
    v_add_u32 v4, 156224, v4
    v_lshl_add_u32 v125, v1, 3, s45
    s_mov_b64 exec, 0xffff
    ds_write_b32 v5, v60 offset:0
    ds_write_b32 v5, v64 offset:4
    ds_write_b32 v5, v68 offset:8
    ds_write_b32 v5, v72 offset:12
    ds_write_b32 v6, v6
    s_mov_b64 exec, -1
    ds_read_b128 v[36:39], v5
    ds_read_b128 v[28:31], v4
    ds_read_b128 v[32:35], v4 offset:512
    s_waitcnt lgkmcnt(0)
    v_fmac_f32 v60, v28, v36
    v_fmac_f32 v61, v29, v36
    v_fmac_f32 v62, v30, v36
    v_fmac_f32 v63, v31, v36
    v_mul_f32 v60, v60, v32
    v_mul_f32 v61, v61, v33
    v_mul_f32 v62, v62, v34
    v_mul_f32 v63, v63, v35
    v_cvt_pk_bf16_f32 v60, v60, v61
    v_cvt_pk_bf16_f32 v61, v62, v63
    ds_write_b64 v125, v[60:61] offset:0
    v_fmac_f32 v64, v28, v37
    v_fmac_f32 v65, v29, v37
    v_fmac_f32 v66, v30, v37
    v_fmac_f32 v67, v31, v37
    v_mul_f32 v64, v64, v32
    v_mul_f32 v65, v65, v33
    v_mul_f32 v66, v66, v34
    v_mul_f32 v67, v67, v35
    v_cvt_pk_bf16_f32 v64, v64, v65
    v_cvt_pk_bf16_f32 v65, v66, v67
    ds_write_b64 v125, v[64:65] offset:512
    v_fmac_f32 v68, v28, v38
    v_fmac_f32 v69, v29, v38
    v_fmac_f32 v70, v30, v38
    v_fmac_f32 v71, v31, v38
    v_mul_f32 v68, v68, v32
    v_mul_f32 v69, v69, v33
    v_mul_f32 v70, v70, v34
    v_mul_f32 v71, v71, v35
    v_cvt_pk_bf16_f32 v68, v68, v69
    v_cvt_pk_bf16_f32 v69, v70, v71
    ds_write_b64 v125, v[68:69] offset:1024
    v_fmac_f32 v72, v28, v39
    v_fmac_f32 v73, v29, v39
    v_fmac_f32 v74, v30, v39
    v_fmac_f32 v75, v31, v39
    v_mul_f32 v72, v72, v32
    v_mul_f32 v73, v73, v33
    v_mul_f32 v74, v74, v34
    v_mul_f32 v75, v75, v35
    v_cvt_pk_bf16_f32 v72, v72, v73
    v_cvt_pk_bf16_f32 v73, v74, v75
    ds_write_b64 v125, v[72:73] offset:1536
    v_mov_b32 v8, 157976
    v_mov_b32 v9, 1
    s_mov_b64 exec, 1
    ds_add_u32 v8, v9
    s_mov_b64 exec, -1
    s_branch Lagent
Lst_re:
    s_sub_u32 s35, s35, 1
    s_cbranch_scc1 Lend
    buffer_load_dwordx2 v[92:93], v96, s[28:31], s46 offen sc1
    buffer_load_dwordx2 v[94:95], v97, s[28:31], s46 offen sc1
    s_waitcnt vmcnt(0)
    s_branch Lst_chk
Laux:
    s_lshl_b32 s32, s37, 3
    s_lshl_b32 s39, s38, 2
    s_add_u32 s32, s32, s36
    s_cmp_lt_u32 s37, 4
    s_cselect_b32 s39, s39, 0
    s_add_u32 s32, s32, s39
    s_and_b32 s33, s2, 3
    s_lshl_b32 s33, s33, 3
    s_and_b32 s39, s2, 4
    s_add_u32 s33, s33, s39
    s_add_u32 s33, s33, s37
    s_cmp_ge_u32 s32, 32
    s_cbranch_scc1 Lmst
    v_lshrrev_b32 v5, 3, v1
    v_and_b32 v6, 7, v1
    s_lshl_b32 s40, s3, 14
    s_cmp_eq_u32 s27, 0
    s_cbranch_scc0 Laux_u
    s_lshl_b32 s36, s33, 6
    s_lshl_b32 s37, s26, 4
    s_add_u32 s36, s36, s37
    v_add_u32 v7, s36, v5
    v_mul_u32_u24 v7, 1280, v7
    v_xor_b32 v8, v6, v2
    v_lshl_add_u32 v92, v8, 4, v7
    v_add_u32 v92, 4096, v92
    v_xor_b32 v93, 64, v92
    v_add_u32 v93, 9216, v93
    v_subrev_u32 v94, 1920, v92
    v_subrev_u32 v95, 1920, v93
    s_waitcnt lgkmcnt(0)
    s_sub_u32 s52, s4, 4096
    s_subb_u32 s53, s5, 0
    s_mov_b32 s54, 2625536
    s_mov_b32 s55, 0x20000
    s_mov_b64 s[60:61], s[12:13]
    s_mov_b32 s62, 1280
    s_mov_b32 s63, 0x20000
    s_mov_b32 m0, 131072
    s_nop 0
    buffer_load_dwordx4 v13, s[60:63], 0 offen lds
    s_mov_b64 exec, 0xffff
    buffer_load_dwordx4 v13, s[60:63], 0 offen offset:1024 lds
    s_mov_b64 exec, -1
    s_add_u32 m0, s40, 0
    s_mov_b32 s41, 0
    buffer_load_dwordx4 v92, s[52:55], s41 offen lds
    buffer_load_dwordx4 v93, s[52:55], s41 offen offset:1024 lds
    buffer_load_dwordx4 v94, s[52:55], s41 offen offset:2048 lds
    buffer_load_dwordx4 v95, s[52:55], s41 offen offset:3072 lds
    s_add_u32 m0, s40, 4096
    s_mov_b32 s41, 256
    buffer_load_dwordx4 v92, s[52:55], s41 offen lds
    buffer_load_dwordx4 v93, s[52:55], s41 offen offset:1024 lds
    buffer_load_dwordx4 v94, s[52:55], s41 offen offset:2048 lds
    buffer_load_dwordx4 v95, s[52:55], s41 offen offset:3072 lds
    s_add_u32 m0, s40, 8192
    s_mov_b32 s41, 512
    buffer_load_dwordx4 v92, s[52:55], s41 offen lds
    buffer_load_dwordx4 v93, s[52:55], s41 offen offset:1024 lds
    buffer_load_dwordx4 v94, s[52:55], s41 offen offset:2048 lds
    buffer_load_dwordx4 v95, s[52:55], s41 offen offset:3072 lds
    s_add_u32 m0, s40, 12288
    s_mov_b32 s41, 768
    buffer_load_dwordx4 v92, s[52:55], s41 offen lds
    buffer_load_dwordx4 v93, s[52:55], s41 offen offset:1024 lds
    buffer_load_dwordx4 v94, s[52:55], s41 offen offset:2048 lds
    buffer_load_dwordx4 v95, s[52:55], s41 offen offset:3072 lds
    s_mov_b64 s[28:29], s[24:25]
    s_mov_b32 s30, 268435456
    s_mov_b32 s31, 0x20000
    s_load_dword s34, s[28:29], 0
    s_mov_b64 s[44:45], s[14:15]
    s_mov_b32 s46, 2211840
    s_mov_b32 s47, 0x20000
    s_mov_b64 s[48:49], s[18:19]
    s_mov_b32 s50, 2211840
    s_mov_b32 s51, 0x20000
    v_and_b32 v8, 1, v2
    v_lshlrev_b32 v8, 1, v8
    v_xor_b32 v8, v8, v6
    v_lshlrev_b32 v8, 4, v8
    v_mul_u32_u24 v9, 3456, v5
    s_lshl_b32 s38, s32, 7
    v_add3_u32 v18, v9, v8, s38
    v_xor_b32 v19, 64, v18
    v_add_u32 v19, 26624, v19
    v_add_u32 v20, 53248, v18
    v_add_u32 v21, 53248, v19
    s_mul_i32 s42, s26, 110592
    v_mul_u32_u24 v9, 1280, v5
    v_add_u32 v22, v9, v8
    v_xor_b32 v23, 64, v22
    v_add_u32 v23, 9216, v23
    v_add_u32 v24, 18432, v22
    v_add_u32 v25, 18432, v23
    s_mul_i32 s43, s32, 81920
    s_lshl_b32 s38, s3, 7
    s_add_u32 s43, s43, s38
    v_mov_b32 v96, 0x3f803f80
    v_mov_b32 v97, 0x3f803f80
    v_mov_b32 v98, 0x3f803f80
    v_mov_b32 v99, 0x3f803f80
    v_lshlrev_b32 v100, 4, v2
    v_add_u32 v100, 131072, v100
    v_lshrrev_b32 v10, 1, v3
    v_xor_b32 v10, v10, v2
    v_lshlrev_b32 v10, 4, v10
    v_lshl_add_u32 v10, v3, 7, v10
    v_add_u32 v102, s40, v10
    v_xor_b32 v103, 64, v102
    s_mov_b32 s58, 0xaaaaaaaa
    s_mov_b32 s59, 0xaaaaaaaa
    s_mov_b32 s64, 0xcccccccc
    s_mov_b32 s65, 0xcccccccc
    v_lshrrev_b32 v101, 2, v3
    v_lshl_add_u32 v101, v101, 4, v3
    v_lshlrev_b32 v101, 2, v101
    s_lshl_b32 s36, s26, 4
    v_add_u32 v10, s36, v3
    s_lshl_b32 s37, s33, 6
    s_sub_u32 s37, 2047, s37
    v_sub_u32 v106, s37, v10
    v_lshlrev_b32 v107, 2, v10
    v_add_u32 v107, 132608, v107
    s_lshl_b32 s36, s33, 9
    s_add_u32 s36, s36, 8192000
    v_lshl_add_u32 v108, v10, 3, s36
    v_bfe_u32 v10, v1, 2, 2
    v_and_b32 v8, 3, v1
    v_lshl_add_u32 v14, v2, 3, v10
    v_lshlrev_b32 v14, 7, v14
    v_lshlrev_b32 v9, 2, v1
    v_and_b32 v9, 0x60, v9
    v_add3_u32 v14, v14, v9, s40
    v_lshl_add_u32 v14, v8, 3, v14
    v_xor_b32 v15, 32, v14
    v_xor_b32 v16, 64, v14
    v_xor_b32 v17, 96, v14
    s_lshl_b32 s36, s26, 6
    s_add_u32 s36, s36, 141312
    v_lshl_add_u32 v26, v2, 4, s36
    v_min_u32 v8, 2, v3
    v_mul_u32_u24 v8, 1536, v8
    v_add_u32 v26, v26, v8
    v_add_u32 v4, 132864, v12
    v_mov_b32 v5, 0
    ds_write_b32 v4, v5
    s_waitcnt lgkmcnt(0)
    s_add_u32 s34, s34, 0x9e3779b8
    s_or_b32 s34, s34, 1
    s_waitcnt vmcnt(12)
    ds_read_b128 a[80:83], v102 offset:0
    ds_read_b128 a[84:87], v100 offset:0
    ds_read_b128 a[88:91], v103 offset:0
    ds_read_b128 a[92:95], v100 offset:64
    ds_read_b128 a[96:99], v102 offset:2048
    ds_read_b128 a[100:103], v100 offset:128
    ds_read_b128 a[104:107], v103 offset:2048
    ds_read_b128 a[108:111], v100 offset:192
    s_waitcnt lgkmcnt(0)
    s_add_u32 m0, s40, 0
    s_mov_b32 s41, 1024
    buffer_load_dwordx4 v92, s[52:55], s41 offen lds
    buffer_load_dwordx4 v93, s[52:55], s41 offen offset:1024 lds
    buffer_load_dwordx4 v94, s[52:55], s41 offen offset:2048 lds
    buffer_load_dwordx4 v95, s[52:55], s41 offen offset:3072 lds
    s_barrier
    v_mfma_f32_16x16x32_bf16 v[116:119], a[80:83], a[80:83], 0
    v_mfma_f32_16x16x32_bf16 v[112:115], v[96:99], a[80:83], 0
    v_mfma_f32_16x16x32_bf16 v[120:123], a[84:87], a[80:83], 0
    v_mfma_f32_16x16x32_bf16 v[124:127], a[84:87], v[96:99], 0
    v_mfma_f32_16x16x32_bf16 v[116:119], a[88:91], a[88:91], v[116:119]
    v_mfma_f32_16x16x32_bf16 v[112:115], v[96:99], a[88:91], v[112:115]
    v_mfma_f32_16x16x32_bf16 v[120:123], a[92:95], a[88:91], v[120:123]
    v_mfma_f32_16x16x32_bf16 v[124:127], a[92:95], v[96:99], v[124:127]
    v_mfma_f32_16x16x32_bf16 v[116:119], a[96:99], a[96:99], v[116:119]
    v_mfma_f32_16x16x32_bf16 v[112:115], v[96:99], a[96:99], v[112:115]
    v_mfma_f32_16x16x32_bf16 v[120:123], a[100:103], a[96:99], v[120:123]
    v_mfma_f32_16x16x32_bf16 v[124:127], a[100:103], v[96:99], v[124:127]
    v_mfma_f32_16x16x32_bf16 v[116:119], a[104:107], a[104:107], v[116:119]
    v_mfma_f32_16x16x32_bf16 v[112:115], v[96:99], a[104:107], v[112:115]
    v_mfma_f32_16x16x32_bf16 v[120:123], a[108:111], a[104:107], v[120:123]
    v_mfma_f32_16x16x32_bf16 v[124:127], a[108:111], v[96:99], v[124:127]
    s_waitcnt vmcnt(12)
    ds_read_b128 a[80:83], v102 offset:4096
    ds_read_b128 a[84:87], v100 offset:256
    ds_read_b128 a[88:91], v103 offset:4096
    ds_read_b128 a[92:95], v100 offset:320
    ds_read_b128 a[96:99], v102 offset:6144
    ds_read_b128 a[100:103], v100 offset:384
    ds_read_b128 a[104:107], v103 offset:6144
    ds_read_b128 a[108:111], v100 offset:448
    s_waitcnt lgkmcnt(0)
    v_mfma_f32_16x16x32_bf16 v[116:119], a[80:83], a[80:83], v[116:119]
    v_mfma_f32_16x16x32_bf16 v[112:115], v[96:99], a[80:83], v[112:115]
    v_mfma_f32_16x16x32_bf16 v[120:123], a[84:87], a[80:83], v[120:123]
    v_mfma_f32_16x16x32_bf16 v[124:127], a[84:87], v[96:99], v[124:127]
    v_mfma_f32_16x16x32_bf16 v[116:119], a[88:91], a[88:91], v[116:119]
    v_mfma_f32_16x16x32_bf16 v[112:115], v[96:99], a[88:91], v[112:115]
    v_mfma_f32_16x16x32_bf16 v[120:123], a[92:95], a[88:91], v[120:123]
    v_mfma_f32_16x16x32_bf16 v[124:127], a[92:95], v[96:99], v[124:127]
    v_mfma_f32_16x16x32_bf16 v[116:119], a[96:99], a[96:99], v[116:119]
    v_mfma_f32_16x16x32_bf16 v[112:115], v[96:99], a[96:99], v[112:115]
    v_mfma_f32_16x16x32_bf16 v[120:123], a[100:103], a[96:99], v[120:123]
    v_mfma_f32_16x16x32_bf16 v[124:127], a[100:103], v[96:99], v[124:127]
    v_mfma_f32_16x16x32_bf16 v[116:119], a[104:107], a[104:107], v[116:119]
    v_mfma_f32_16x16x32_bf16 v[112:115], v[96:99], a[104:107], v[112:115]
    v_mfma_f32_16x16x32_bf16 v[120:123], a[108:111], a[104:107], v[120:123]
    v_mfma_f32_16x16x32_bf16 v[124:127], a[108:111], v[96:99], v[124:127]
    s_waitcnt vmcnt(8)
    ds_read_b128 a[80:83], v102 offset:8192
    ds_read_b128 a[84:87], v100 offset:512
    ds_read_b128 a[88:91], v103 offset:8192
    ds_read_b128 a[92:95], v100 offset:576
    ds_read_b128 a[96:99], v102 offset:10240
    ds_read_b128 a[100:103], v100 offset:640
    ds_read_b128 a[104:107], v103 offset:10240
    ds_read_b128 a[108:111], v100 offset:704
    s_waitcnt lgkmcnt(0)
    v_mfma_f32_16x16x32_bf16 v[116:119], a[80:83], a[80:83], v[116:119]
    v_mfma_f32_16x16x32_bf16 v[112:115], v[96:99], a[80:83], v[112:115]
    v_mfma_f32_16x16x32_bf16 v[120:123], a[84:87], a[80:83], v[120:123]
    v_mfma_f32_16x16x32_bf16 v[124:127], a[84:87], v[96:99], v[124:127]
    v_mfma_f32_16x16x32_bf16 v[116:119], a[88:91], a[88:91], v[116:119]
    v_mfma_f32_16x16x32_bf16 v[112:115], v[96:99], a[88:91], v[112:115]
    v_mfma_f32_16x16x32_bf16 v[120:123], a[92:95], a[88:91], v[120:123]
    v_mfma_f32_16x16x32_bf16 v[124:127], a[92:95], v[96:99], v[124:127]
    v_mfma_f32_16x16x32_bf16 v[116:119], a[96:99], a[96:99], v[116:119]
    v_mfma_f32_16x16x32_bf16 v[112:115], v[96:99], a[96:99], v[112:115]
    v_mfma_f32_16x16x32_bf16 v[120:123], a[100:103], a[96:99], v[120:123]
    v_mfma_f32_16x16x32_bf16 v[124:127], a[100:103], v[96:99], v[124:127]
    v_mfma_f32_16x16x32_bf16 v[116:119], a[104:107], a[104:107], v[116:119]
    v_mfma_f32_16x16x32_bf16 v[112:115], v[96:99], a[104:107], v[112:115]
    v_mfma_f32_16x16x32_bf16 v[120:123], a[108:111], a[104:107], v[120:123]
    v_mfma_f32_16x16x32_bf16 v[124:127], a[108:111], v[96:99], v[124:127]
    s_waitcnt vmcnt(4)
    ds_read_b128 a[80:83], v102 offset:12288
    ds_read_b128 a[84:87], v100 offset:768
    ds_read_b128 a[88:91], v103 offset:12288
    ds_read_b128 a[92:95], v100 offset:832
    ds_read_b128 a[96:99], v102 offset:14336
    ds_read_b128 a[100:103], v100 offset:896
    ds_read_b128 a[104:107], v103 offset:14336
    ds_read_b128 a[108:111], v100 offset:960
    s_waitcnt lgkmcnt(0)
    v_mfma_f32_16x16x32_bf16 v[116:119], a[80:83], a[80:83], v[116:119]
    v_mfma_f32_16x16x32_bf16 v[112:115], v[96:99], a[80:83], v[112:115]
    v_mfma_f32_16x16x32_bf16 v[120:123], a[84:87], a[80:83], v[120:123]
    v_mfma_f32_16x16x32_bf16 v[124:127], a[84:87], v[96:99], v[124:127]
    v_mfma_f32_16x16x32_bf16 v[116:119], a[88:91], a[88:91], v[116:119]
    v_mfma_f32_16x16x32_bf16 v[112:115], v[96:99], a[88:91], v[112:115]
    v_mfma_f32_16x16x32_bf16 v[120:123], a[92:95], a[88:91], v[120:123]
    v_mfma_f32_16x16x32_bf16 v[124:127], a[92:95], v[96:99], v[124:127]
    v_mfma_f32_16x16x32_bf16 v[116:119], a[96:99], a[96:99], v[116:119]
    v_mfma_f32_16x16x32_bf16 v[112:115], v[96:99], a[96:99], v[112:115]
    v_mfma_f32_16x16x32_bf16 v[120:123], a[100:103], a[96:99], v[120:123]
    v_mfma_f32_16x16x32_bf16 v[124:127], a[100:103], v[96:99], v[124:127]
    v_mfma_f32_16x16x32_bf16 v[116:119], a[104:107], a[104:107], v[116:119]
    v_mfma_f32_16x16x32_bf16 v[112:115], v[96:99], a[104:107], v[112:115]
    v_mfma_f32_16x16x32_bf16 v[120:123], a[108:111], a[104:107], v[120:123]
    v_mfma_f32_16x16x32_bf16 v[124:127], a[108:111], v[96:99], v[124:127]
    s_waitcnt vmcnt(0)
    ds_read_b128 a[80:83], v102 offset:0
    ds_read_b128 a[84:87], v100 offset:1024
    ds_read_b128 a[88:91], v103 offset:0
    ds_read_b128 a[92:95], v100 offset:1088
    ds_read_b128 a[96:99], v102 offset:2048
    ds_read_b128 a[100:103], v100 offset:1152
    ds_read_b128 a[104:107], v103 offset:2048
    ds_read_b128 a[108:111], v100 offset:1216
    s_waitcnt lgkmcnt(0)
    v_mfma_f32_16x16x32_bf16 v[116:119], a[80:83], a[80:83], v[116:119]
    v_mfma_f32_16x16x32_bf16 v[112:115], v[96:99], a[80:83], v[112:115]
    v_mfma_f32_16x16x32_bf16 v[120:123], a[84:87], a[80:83], v[120:123]
    v_mfma_f32_16x16x32_bf16 v[124:127], a[84:87], v[96:99], v[124:127]
    v_mfma_f32_16x16x32_bf16 v[116:119], a[88:91], a[88:91], v[116:119]
    v_mfma_f32_16x16x32_bf16 v[112:115], v[96:99], a[88:91], v[112:115]
    v_mfma_f32_16x16x32_bf16 v[120:123], a[92:95], a[88:91], v[120:123]
    v_mfma_f32_16x16x32_bf16 v[124:127], a[92:95], v[96:99], v[124:127]
    v_mfma_f32_16x16x32_bf16 v[116:119], a[96:99], a[96:99], v[116:119]
    v_mfma_f32_16x16x32_bf16 v[112:115], v[96:99], a[96:99], v[112:115]
    v_mfma_f32_16x16x32_bf16 v[120:123], a[100:103], a[96:99], v[120:123]
    v_mfma_f32_16x16x32_bf16 v[124:127], a[100:103], v[96:99], v[124:127]
    v_mfma_f32_16x16x32_bf16 v[116:119], a[104:107], a[104:107], v[116:119]
    v_mfma_f32_16x16x32_bf16 v[112:115], v[96:99], a[104:107], v[112:115]
    v_mfma_f32_16x16x32_bf16 v[120:123], a[108:111], a[104:107], v[120:123]
    v_mfma_f32_16x16x32_bf16 v[124:127], a[108:111], v[96:99], v[124:127]
    s_nop 4
    v_cndmask_b32 v4, v116, v117, s[58:59]
    v_cndmask_b32 v5, v118, v119, s[58:59]
    v_cndmask_b32 v4, v4, v5, s[64:65]
    ds_bpermute_b32 v4, v101, v4
    v_mul_f32 v5, 0xbacccccd, v112
    v_cvt_pk_bf16_f32 v104, v5, v5
    v_lshlrev_b32 v104, 16, v104
    v_mul_f32 v5, v5, v5
    v_mov_b32 v6, 0x3acccccd
    s_waitcnt lgkmcnt(0)
    v_fma_f32 v4, v4, v6, -v5
    v_max_f32 v4, 0, v4
    v_cvt_pk_bf16_f32 v4, v4, v4
    v_lshlrev_b32 v4, 16, v4
    v_add_f32 v4, 0x3727c5ac, v4
    v_cvt_pk_bf16_f32 v4, v4, v4
    v_lshlrev_b32 v4, 16, v4
    v_sqrt_f32 v4, v4
    s_nop 0
    v_cvt_pk_bf16_f32 v4, v4, v4
    v_lshlrev_b32 v4, 16, v4
    v_rcp_f32 v105, v4
    v_lshrrev_b32 v8, 16, v4
    v_fma_f32 v4, v104, v124, v120
    v_mul_f32 v4, v4, v105
    v_cvt_pk_bf16_f32 v4, v4, v4
    v_ashrrev_i32 v5, 31, v4
    v_or_b32 v5, 0x80000000, v5
    v_xor_b32 v4, v4, v5
    v_and_b32 v4, 0xffff0000, v4
    v_or_b32 v4, v4, v106
    ds_write_b32 v107, v4
    v_mov_b32 v11, 132864
    v_mov_b32 v7, 1
    s_mov_b64 exec, 1
    ds_add_u32 v11, v7
    s_mov_b64 exec, -1
    v_or_b32 v8, v8, v104
    v_mov_b32 v9, s34
    s_mov_b64 exec, 0xffff
    buffer_store_dwordx2 v[8:9], v108, s[28:31], 0 offen sc1
    s_mov_b64 exec, -1
    s_cmp_lg_u32 s26, 0
    s_cbranch_scc1 Lpub_done
    s_setprio 3
Lcw_8:
    s_sub_u32 s35, s35, 1
    s_cbranch_scc1 Lend
    ds_read_b32 v7, v11
    s_waitcnt lgkmcnt(0)
    v_readfirstlane_b32 s38, v7
    s_nop 0
    s_cmp_lt_u32 s38, 4
    s_cbranch_scc1 Lcw_8
    v_add_u32 v5, 132608, v12
    ds_read_b32 v6, v5
    s_waitcnt lgkmcnt(0)
    v_mov_b32 v4, v6
    s_nop 1
    v_max_u32_dpp v4, v4, v4 row_ror:8 row_mask:0xf bank_mask:0xf
    s_nop 1
    v_max_u32_dpp v4, v4, v4 row_ror:4 row_mask:0xf bank_mask:0xf
    s_nop 1
    v_max_u32_dpp v4, v4, v4 row_ror:2 row_mask:0xf bank_mask:0xf
    s_nop 1
    v_max_u32_dpp v4, v4, v4 row_ror:1 row_mask:0xf bank_mask:0xf
    s_nop 0
    v_readlane_b32 s66, v4, 0
    v_readlane_b32 s36, v4, 16
    v_readlane_b32 s37, v4, 32
    v_readlane_b32 s38, v4, 48
    s_max_u32 s66, s66, s36
    s_max_u32 s37, s37, s38
    s_max_u32 s66, s66, s37
    v_cmp_eq_u32 vcc, s66, v6
    s_nop 1
    v_cndmask_b32 v4, v6, 0, vcc
    s_nop 1
    v_max_u32_dpp v4, v4, v4 row_ror:8 row_mask:0xf bank_mask:0xf
    s_nop 1
    v_max_u32_dpp v4, v4, v4 row_ror:4 row_mask:0xf bank_mask:0xf
    s_nop 1
    v_max_u32_dpp v4, v4, v4 row_ror:2 row_mask:0xf bank_mask:0xf
    s_nop 1
    v_max_u32_dpp v4, v4, v4 row_ror:1 row_mask:0xf bank_mask:0xf
    s_nop 0
    v_readlane_b32 s67, v4, 0
    v_readlane_b32 s36, v4, 16
    v_readlane_b32 s37, v4, 32
    v_readlane_b32 s38, v4, 48
    s_max_u32 s67, s67, s36
    s_max_u32 s37, s37, s38
    s_max_u32 s67, s67, s37
    v_mov_b32 v112, s66
    v_mov_b32 v113, s34
    v_mov_b32 v114, s67
    v_mov_b32 v115, s34
    s_lshl_b32 s36, s32, 7
    s_add_u32 s36, s36, 8126464
    s_mov_b64 exec, 0xff
    buffer_store_dwordx4 v[112:115], v13, s[28:31], s36 offen sc1
    s_mov_b64 exec, -1
    v_mov_b32 v11, 132864
    v_mov_b32 v7, 1
    s_mov_b64 exec, 1
    ds_add_u32 v11, v7
    s_mov_b64 exec, -1
    s_mov_b64 exec, 1
    s_lshl_b32 s36, s2, 2
    s_add_u32 s36, s36, 8323072
    v_mov_b32 v4, s34
    v_mov_b32 v5, s36
    buffer_store_dword v4, v5, s[28:31], 0 offen sc1
    s_mov_b64 exec, -1
    s_setprio 0
Lpub_done:
Lcw_9:
    s_sub_u32 s35, s35, 1
    s_cbranch_scc1 Lend
    ds_read_b32 v7, v11
    s_waitcnt lgkmcnt(0)
    v_readfirstlane_b32 s38, v7
    s_nop 0
    s_cmp_lt_u32 s38, 5
    s_cbranch_scc1 Lcw_9
    s_cmp_ge_u32 s32, 27
    s_cbranch_scc1 Lhelp_r
    s_add_u32 m0, s40, 0
    s_add_u32 s41, s42, 0
    buffer_load_dwordx4 v18, s[44:47], s41 offen nt lds
    buffer_load_dwordx4 v19, s[44:47], s41 offen offset:1024 nt lds
    buffer_load_dwordx4 v20, s[44:47], s41 offen offset:2048 nt lds
    buffer_load_dwordx4 v21, s[44:47], s41 offen offset:3072 nt lds
    s_add_u32 m0, s40, 4096
    s_add_u32 s41, s42, 442368
    buffer_load_dwordx4 v18, s[44:47], s41 offen nt lds
    buffer_load_dwordx4 v19, s[44:47], s41 offen offset:1024 nt lds
    buffer_load_dwordx4 v20, s[44:47], s41 offen offset:2048 nt lds
    buffer_load_dwordx4 v21, s[44:47], s41 offen offset:3072 nt lds
    s_add_u32 m0, s40, 8192
    s_add_u32 s41, s42, 884736
    buffer_load_dwordx4 v18, s[44:47], s41 offen nt lds
    buffer_load_dwordx4 v19, s[44:47], s41 offen offset:1024 nt lds
    buffer_load_dwordx4 v20, s[44:47], s41 offen offset:2048 nt lds
    buffer_load_dwordx4 v21, s[44:47], s41 offen offset:3072 nt lds
    s_add_u32 m0, s40, 12288
    s_add_u32 s41, s42, 1327104
    buffer_load_dwordx4 v18, s[44:47], s41 offen nt lds
    buffer_load_dwordx4 v19, s[44:47], s41 offen offset:1024 nt lds
    buffer_load_dwordx4 v20, s[44:47], s41 offen offset:2048 nt lds
    buffer_load_dwordx4 v21, s[44:47], s41 offen offset:3072 nt lds
    s_waitcnt vmcnt(12)
    ds_read_b64_tr_b16 a[0:1], v14 offset:0
    ds_read_b64_tr_b16 a[2:3], v14 offset:512
    ds_read_b64_tr_b16 a[4:5], v15 offset:0
    ds_read_b64_tr_b16 a[6:7], v15 offset:512
    ds_read_b64_tr_b16 a[8:9], v16 offset:0
    ds_read_b64_tr_b16 a[10:11], v16 offset:512
    ds_read_b64_tr_b16 a[12:13], v17 offset:0
    ds_read_b64_tr_b16 a[14:15], v17 offset:512
    s_waitcnt lgkmcnt(0)
    s_add_u32 m0, s40, 0
    s_add_u32 s41, s42, 1769472
    buffer_load_dwordx4 v18, s[44:47], s41 offen nt lds
    buffer_load_dwordx4 v19, s[44:47], s41 offen offset:1024 nt lds
    buffer_load_dwordx4 v20, s[44:47], s41 offen offset:2048 nt lds
    buffer_load_dwordx4 v21, s[44:47], s41 offen offset:3072 nt lds
    v_mov_b32 v11, 132864
    v_mov_b32 v7, 1
    s_mov_b64 exec, 1
    ds_add_u32 v11, v7
    s_mov_b64 exec, -1
    s_waitcnt vmcnt(12)
    ds_read_b64_tr_b16 a[16:17], v14 offset:4096
    ds_read_b64_tr_b16 a[18:19], v14 offset:4608
    ds_read_b64_tr_b16 a[20:21], v15 offset:4096
    ds_read_b64_tr_b16 a[22:23], v15 offset:4608
    ds_read_b64_tr_b16 a[24:25], v16 offset:4096
    ds_read_b64_tr_b16 a[26:27], v16 offset:4608
    ds_read_b64_tr_b16 a[28:29], v17 offset:4096
    ds_read_b64_tr_b16 a[30:31], v17 offset:4608
    s_waitcnt lgkmcnt(0)
    s_add_u32 m0, s40, 4096
    s_add_u32 s41, s43, 0
    buffer_load_dwordx4 v22, s[48:51], s41 offen nt lds
    buffer_load_dwordx4 v23, s[48:51], s41 offen offset:1024 nt lds
    buffer_load_dwordx4 v24, s[48:51], s41 offen offset:2048 nt lds
    buffer_load_dwordx4 v25, s[48:51], s41 offen offset:3072 nt lds
    s_waitcnt vmcnt(12)
    ds_read_b64_tr_b16 a[32:33], v14 offset:8192
    ds_read_b64_tr_b16 a[34:35], v14 offset:8704
    ds_read_b64_tr_b16 a[36:37], v15 offset:8192
    ds_read_b64_tr_b16 a[38:39], v15 offset:8704
    ds_read_b64_tr_b16 a[40:41], v16 offset:8192
    ds_read_b64_tr_b16 a[42:43], v16 offset:8704
    ds_read_b64_tr_b16 a[44:45], v17 offset:8192
    ds_read_b64_tr_b16 a[46:47], v17 offset:8704
    s_waitcnt lgkmcnt(0)
    s_add_u32 m0, s40, 8192
    s_add_u32 s41, s43, 40960
    buffer_load_dwordx4 v22, s[48:51], s41 offen nt lds
    buffer_load_dwordx4 v23, s[48:51], s41 offen offset:1024 nt lds
    buffer_load_dwordx4 v24, s[48:51], s41 offen offset:2048 nt lds
    buffer_load_dwordx4 v25, s[48:51], s41 offen offset:3072 nt lds
    s_waitcnt vmcnt(12)
    ds_read_b64_tr_b16 a[48:49], v14 offset:12288
    ds_read_b64_tr_b16 a[50:51], v14 offset:12800
    ds_read_b64_tr_b16 a[52:53], v15 offset:12288
    ds_read_b64_tr_b16 a[54:55], v15 offset:12800
    ds_read_b64_tr_b16 a[56:57], v16 offset:12288
    ds_read_b64_tr_b16 a[58:59], v16 offset:12800
    ds_read_b64_tr_b16 a[60:61], v17 offset:12288
    ds_read_b64_tr_b16 a[62:63], v17 offset:12800
    s_waitcnt vmcnt(8)
    ds_read_b64_tr_b16 a[64:65], v14 offset:0
    ds_read_b64_tr_b16 a[66:67], v14 offset:512
    ds_read_b64_tr_b16 a[68:69], v15 offset:0
    ds_read_b64_tr_b16 a[70:71], v15 offset:512
    ds_read_b64_tr_b16 a[72:73], v16 offset:0
    ds_read_b64_tr_b16 a[74:75], v16 offset:512
    ds_read_b64_tr_b16 a[76:77], v17 offset:0
    ds_read_b64_tr_b16 a[78:79], v17 offset:512
    s_branch Laux_mm
Laux_u:
    s_cmp_ge_u32 s32, 27
    s_cbranch_scc1 Lend
    v_and_b32 v8, 1, v2
    v_lshlrev_b32 v8, 1, v8
    v_xor_b32 v8, v8, v6
    v_lshlrev_b32 v8, 4, v8
    v_mul_u32_u24 v9, 3456, v5
    s_lshl_b32 s38, s32, 7
    v_add3_u32 v18, v9, v8, s38
    v_xor_b32 v19, 64, v18
    v_add_u32 v19, 26624, v19
    v_add_u32 v20, 53248, v18
    v_add_u32 v21, 53248, v19
    s_mul_i32 s42, s26, 110592
    v_mul_u32_u24 v9, 1280, v5
    v_add_u32 v22, v9, v8
    v_xor_b32 v23, 64, v22
    v_add_u32 v23, 9216, v23
    v_add_u32 v24, 18432, v22
    v_add_u32 v25, 18432, v23
    s_mul_i32 s43, s32, 81920
    s_lshl_b32 s38, s3, 7
    s_add_u32 s43, s43, s38
    s_waitcnt lgkmcnt(0)
    s_mov_b64 s[44:45], s[16:17]
    s_mov_b32 s46, 2211840
    s_mov_b32 s47, 0x20000
    s_mov_b64 s[28:29], s[24:25]
    s_mov_b32 s30, 268435456
    s_mov_b32 s31, 0x20000
    s_load_dword s34, s[28:29], 0
    s_mov_b64 s[52:53], s[4:5]
    s_mov_b32 s54, 2621440
    s_mov_b32 s55, 0x20000
    s_mov_b64 s[48:49], s[18:19]
    s_mov_b32 s50, 2211840
    s_mov_b32 s51, 0x20000
    s_mov_b64 s[68:69], s[18:19]
    s_mov_b32 s70, 2211840
    s_mov_b32 s71, 0x20000
    s_cmp_ge_u32 s26, 2
    s_cselect_b32 s70, 0, s70
    v_bfe_u32 v10, v1, 2, 2
    v_and_b32 v8, 3, v1
    v_lshl_add_u32 v14, v2, 3, v10
    v_lshlrev_b32 v14, 7, v14
    v_lshlrev_b32 v9, 2, v1
    v_and_b32 v9, 0x60, v9
    v_add3_u32 v14, v14, v9, s40
    v_lshl_add_u32 v14, v8, 3, v14
    v_xor_b32 v15, 32, v14
    v_xor_b32 v16, 64, v14
    v_xor_b32 v17, 96, v14
    s_lshl_b32 s36, s26, 6
    s_add_u32 s36, s36, 141312
    v_lshl_add_u32 v26, v2, 4, s36
    v_min_u32 v8, 2, v3
    v_mul_u32_u24 v8, 1536, v8
    v_add_u32 v26, v26, v8
    s_waitcnt lgkmcnt(0)
    s_add_u32 s34, s34, 0x9e3779b8
    s_or_b32 s34, s34, 1
    s_cmp_lg_u32 s3, 7
    s_cbranch_scc1 Lnop7
    s_setprio 3
Lnop7:
    s_barrier
    s_add_u32 m0, s40, 0
    s_add_u32 s41, s42, 0
    buffer_load_dwordx4 v18, s[44:47], s41 offen nt lds
    buffer_load_dwordx4 v19, s[44:47], s41 offen offset:1024 nt lds
    buffer_load_dwordx4 v20, s[44:47], s41 offen offset:2048 nt lds
    buffer_load_dwordx4 v21, s[44:47], s41 offen offset:3072 nt lds
    s_add_u32 m0, s40, 4096
    s_add_u32 s41, s42, 442368
    buffer_load_dwordx4 v18, s[44:47], s41 offen nt lds
    buffer_load_dwordx4 v19, s[44:47], s41 offen offset:1024 nt lds
    buffer_load_dwordx4 v20, s[44:47], s41 offen offset:2048 nt lds
    buffer_load_dwordx4 v21, s[44:47], s41 offen offset:3072 nt lds
    s_add_u32 m0, s40, 8192
    s_add_u32 s41, s42, 884736
    buffer_load_dwordx4 v18, s[44:47], s41 offen nt lds
    buffer_load_dwordx4 v19, s[44:47], s41 offen offset:1024 nt lds
    buffer_load_dwordx4 v20, s[44:47], s41 offen offset:2048 nt lds
    buffer_load_dwordx4 v21, s[44:47], s41 offen offset:3072 nt lds
    s_add_u32 m0, s40, 12288
    s_add_u32 s41, s42, 1327104
    buffer_load_dwordx4 v18, s[44:47], s41 offen nt lds
    buffer_load_dwordx4 v19, s[44:47], s41 offen offset:1024 nt lds
    buffer_load_dwordx4 v20, s[44:47], s41 offen offset:2048 nt lds
    buffer_load_dwordx4 v21, s[44:47], s41 offen offset:3072 nt lds
    v_mov_b32 v11, 132864
Lcw_10:
    s_sub_u32 s35, s35, 1
    s_cbranch_scc1 Lend
    s_sleep 4
    ds_read_b32 v7, v11
    s_waitcnt lgkmcnt(0)
    v_readfirstlane_b32 s38, v7
    s_nop 0
    s_cmp_lt_u32 s38, 5
    s_cbranch_scc1 Lcw_10
    s_waitcnt vmcnt(12)
    ds_read_b64_tr_b16 a[0:1], v14 offset:0
    ds_read_b64_tr_b16 a[2:3], v14 offset:512
    ds_read_b64_tr_b16 a[4:5], v15 offset:0
    ds_read_b64_tr_b16 a[6:7], v15 offset:512
    ds_read_b64_tr_b16 a[8:9], v16 offset:0
    ds_read_b64_tr_b16 a[10:11], v16 offset:512
    ds_read_b64_tr_b16 a[12:13], v17 offset:0
    ds_read_b64_tr_b16 a[14:15], v17 offset:512
    s_waitcnt lgkmcnt(0)
    s_add_u32 m0, s40, 0
    s_add_u32 s41, s42, 1769472
    buffer_load_dwordx4 v18, s[44:47], s41 offen nt lds
    buffer_load_dwordx4 v19, s[44:47], s41 offen offset:1024 nt lds
    buffer_load_dwordx4 v20, s[44:47], s41 offen offset:2048 nt lds
    buffer_load_dwordx4 v21, s[44:47], s41 offen offset:3072 nt lds
    s_waitcnt vmcnt(12)
    ds_read_b64_tr_b16 a[16:17], v14 offset:4096
    ds_read_b64_tr_b16 a[18:19], v14 offset:4608
    ds_read_b64_tr_b16 a[20:21], v15 offset:4096
    ds_read_b64_tr_b16 a[22:23], v15 offset:4608
    ds_read_b64_tr_b16 a[24:25], v16 offset:4096
    ds_read_b64_tr_b16 a[26:27], v16 offset:4608
    ds_read_b64_tr_b16 a[28:29], v17 offset:4096
    ds_read_b64_tr_b16 a[30:31], v17 offset:4608
    s_waitcnt vmcnt(8)
    ds_read_b64_tr_b16 a[32:33], v14 offset:8192
    ds_read_b64_tr_b16 a[34:35], v14 offset:8704
    ds_read_b64_tr_b16 a[36:37], v15 offset:8192
    ds_read_b64_tr_b16 a[38:39], v15 offset:8704
    ds_read_b64_tr_b16 a[40:41], v16 offset:8192
    ds_read_b64_tr_b16 a[42:43], v16 offset:8704
    ds_read_b64_tr_b16 a[44:45], v17 offset:8192
    ds_read_b64_tr_b16 a[46:47], v17 offset:8704
    s_waitcnt vmcnt(4)
    ds_read_b64_tr_b16 a[48:49], v14 offset:12288
    ds_read_b64_tr_b16 a[50:51], v14 offset:12800
    ds_read_b64_tr_b16 a[52:53], v15 offset:12288
    ds_read_b64_tr_b16 a[54:55], v15 offset:12800
    ds_read_b64_tr_b16 a[56:57], v16 offset:12288
    ds_read_b64_tr_b16 a[58:59], v16 offset:12800
    ds_read_b64_tr_b16 a[60:61], v17 offset:12288
    ds_read_b64_tr_b16 a[62:63], v17 offset:12800
    s_waitcnt vmcnt(0)
    ds_read_b64_tr_b16 a[64:65], v14 offset:0
    ds_read_b64_tr_b16 a[66:67], v14 offset:512
    ds_read_b64_tr_b16 a[68:69], v15 offset:0
    ds_read_b64_tr_b16 a[70:71], v15 offset:512
    ds_read_b64_tr_b16 a[72:73], v16 offset:0
    ds_read_b64_tr_b16 a[74:75], v16 offset:512
    ds_read_b64_tr_b16 a[76:77], v17 offset:0
    ds_read_b64_tr_b16 a[78:79], v17 offset:512
    s_cmp_lg_u32 s3, 7
    s_cbranch_scc1 Lnofx
    v_mov_b32 v92, 0x3f803f80
    v_mov_b32 v93, 0x3f803f80
    v_mov_b32 v94, 0x3f803f80
    v_mov_b32 v95, 0x3f803f80
    v_add_u32 v4, 144384, v13
    ds_write_b128 v4, v[92:95]
    ds_write_b128 v4, v[92:95] offset:1024
    v_and_b32 v120, 31, v1
    v_lshlrev_b32 v120, 7, v120
    v_add_u32 v120, 8126464, v120
Lpt_11:
    s_sub_u32 s35, s35, 1
    s_cbranch_scc1 Lend
    s_sleep 2
    buffer_load_dwordx4 v[124:127], v120, s[28:31], 0 offen sc1
    s_waitcnt vmcnt(0)
    v_cmp_ne_u32 vcc, s34, v125
    v_cmp_ne_u32 s[36:37], s34, v127
    s_nop 0
    s_or_b64 s[36:37], s[36:37], vcc
    s_cbranch_scc1 Lpt_11
    v_mov_b32 v120, v124
    s_nop 1
    v_max_u32_dpp v120, v120, v120 row_ror:8 row_mask:0xf bank_mask:0xf
    s_nop 1
    v_max_u32_dpp v120, v120, v120 row_ror:4 row_mask:0xf bank_mask:0xf
    s_nop 1
    v_max_u32_dpp v120, v120, v120 row_ror:2 row_mask:0xf bank_mask:0xf
    s_nop 1
    v_max_u32_dpp v120, v120, v120 row_ror:1 row_mask:0xf bank_mask:0xf
    s_nop 0
    v_readlane_b32 s56, v120, 0
    v_readlane_b32 s36, v120, 16
    v_readlane_b32 s37, v120, 32
    v_readlane_b32 s38, v120, 48
    s_max_u32 s56, s56, s36
    s_max_u32 s37, s37, s38
    s_max_u32 s56, s56, s37
    v_cmp_eq_u32 vcc, s56, v124
    s_nop 1
    v_cndmask_b32 v120, v124, v126, vcc
    s_nop 1
    v_max_u32_dpp v120, v120, v120 row_ror:8 row_mask:0xf bank_mask:0xf
    s_nop 1
    v_max_u32_dpp v120, v120, v120 row_ror:4 row_mask:0xf bank_mask:0xf
    s_nop 1
    v_max_u32_dpp v120, v120, v120 row_ror:2 row_mask:0xf bank_mask:0xf
    s_nop 1
    v_max_u32_dpp v120, v120, v120 row_ror:1 row_mask:0xf bank_mask:0xf
    s_nop 0
    v_readlane_b32 s57, v120, 0
    v_readlane_b32 s36, v120, 16
    v_readlane_b32 s37, v120, 32
    v_readlane_b32 s38, v120, 48
    s_max_u32 s57, s57, s36
    s_max_u32 s37, s37, s38
    s_max_u32 s57, s57, s37
    s_and_b32 s36, s56, 0x7ff
    s_sub_u32 s36, 2047, s36
    s_and_b32 s37, s57, 0x7ff
    s_sub_u32 s37, 2047, s37
    s_mul_i32 s38, s36, 1280
    s_mul_i32 s39, s37, 1280
    s_mov_b32 m0, 141312
    v_mov_b32 v4, s36
    buffer_load_dwordx4 v13, s[52:55], s38 offen lds
    s_mov_b32 m0, 142848
    v_mov_b32 v5, s37
    buffer_load_dwordx4 v13, s[52:55], s39 offen lds
    s_mov_b64 exec, 0xffff
    buffer_load_dwordx4 v13, s[52:55], s39 offen offset:1024 lds
    s_mov_b32 m0, 141312
    s_mov_b32 vcc_lo, 0xaaaaaaaa
    buffer_load_dwordx4 v13, s[52:55], s38 offen offset:1024 lds
    s_mov_b64 exec, 3
    v_cndmask_b32 v4, v4, v5, vcc
    v_lshlrev_b32 v118, 3, v4
    v_add_u32 v118, 8192000, v118
    v_add_u32 v9, 132872, v12
Lxs_chk:
    s_sub_u32 s35, s35, 1
    s_cbranch_scc1 Lend
    buffer_load_dwordx2 v[116:117], v118, s[28:31], 0 offen sc1
    s_waitcnt vmcnt(0)
    v_cmp_ne_u32 vcc, s34, v117
    s_nop 0
    s_cbranch_vccnz Lxs_chk
    ds_write_b32 v9, v116
    s_mov_b64 exec, -1
    v_mov_b32 v10, 132868
    v_mov_b32 v7, 1
    s_mov_b64 exec, 1
    ds_add_u32 v10, v7
    s_mov_b64 exec, -1
Lnofx:
Lcw_12:
    s_sub_u32 s35, s35, 1
    s_cbranch_scc1 Lend
    s_sleep 2
    ds_read_b32 v7, v11
    s_waitcnt lgkmcnt(0)
    v_readfirstlane_b32 s38, v7
    s_nop 0
    s_cmp_lt_u32 s38, 9
    s_cbranch_scc1 Lcw_12
    s_add_u32 m0, s40, 4096
    s_add_u32 s41, s43, 0
    buffer_load_dwordx4 v22, s[48:51], s41 offen nt lds
    buffer_load_dwordx4 v23, s[48:51], s41 offen offset:1024 nt lds
    buffer_load_dwordx4 v24, s[48:51], s41 offen offset:2048 nt lds
    buffer_load_dwordx4 v25, s[48:51], s41 offen offset:3072 nt lds
    s_add_u32 m0, s40, 8192
    s_add_u32 s41, s43, 40960
    buffer_load_dwordx4 v22, s[48:51], s41 offen nt lds
    buffer_load_dwordx4 v23, s[48:51], s41 offen offset:1024 nt lds
    buffer_load_dwordx4 v24, s[48:51], s41 offen offset:2048 nt lds
    buffer_load_dwordx4 v25, s[48:51], s41 offen offset:3072 nt lds
    s_add_u32 m0, s40, 12288
    s_add_u32 s41, s43, 512
    buffer_load_dwordx4 v22, s[68:71], s41 offen nt lds
    buffer_load_dwordx4 v23, s[68:71], s41 offen offset:1024 nt lds
    buffer_load_dwordx4 v24, s[68:71], s41 offen offset:2048 nt lds
    buffer_load_dwordx4 v25, s[68:71], s41 offen offset:3072 nt lds
    s_add_u32 m0, s40, 0
    s_add_u32 s41, s43, 41472
    buffer_load_dwordx4 v22, s[68:71], s41 offen nt lds
    buffer_load_dwordx4 v23, s[68:71], s41 offen offset:1024 nt lds
    buffer_load_dwordx4 v24, s[68:71], s41 offen offset:2048 nt lds
    buffer_load_dwordx4 v25, s[68:71], s41 offen offset:3072 nt lds
Laux_mm:
    v_mov_b32 v10, 132868
Lcw_13:
    s_sub_u32 s35, s35, 1
    s_cbranch_scc1 Lend
    s_sleep 1
    ds_read_b32 v7, v10
    s_waitcnt lgkmcnt(0)
    v_readfirstlane_b32 s38, v7
    s_nop 0
    s_cmp_lt_u32 s38, 1
    s_cbranch_scc1 Lcw_13
    ds_read_b128 v[92:95], v26 offset:0
    ds_read_b128 v[96:99], v26 offset:256
    ds_read_b128 v[100:103], v26 offset:512
    ds_read_b128 v[104:107], v26 offset:768
    ds_read_b128 v[108:111], v26 offset:1024
    ds_read_b64 v[116:117], v10 offset:4
    s_waitcnt lgkmcnt(0)
    v_readfirstlane_b32 s56, v116
    v_readfirstlane_b32 s57, v117
    v_mfma_f32_16x16x32_bf16 v[112:115], a[0:3], v[92:95], 0
    v_mfma_f32_16x16x32_bf16 v[116:119], a[4:7], v[92:95], 0
    v_mfma_f32_16x16x32_bf16 v[120:123], a[8:11], v[92:95], 0
    v_mfma_f32_16x16x32_bf16 v[124:127], a[12:15], v[92:95], 0
    v_mfma_f32_16x16x32_bf16 v[112:115], a[16:19], v[96:99], v[112:115]
    v_mfma_f32_16x16x32_bf16 v[116:119], a[20:23], v[96:99], v[116:119]
    v_mfma_f32_16x16x32_bf16 v[120:123], a[24:27], v[96:99], v[120:123]
    v_mfma_f32_16x16x32_bf16 v[124:127], a[28:31], v[96:99], v[124:127]
    v_mfma_f32_16x16x32_bf16 v[112:115], a[32:35], v[100:103], v[112:115]
    v_mfma_f32_16x16x32_bf16 v[116:119], a[36:39], v[100:103], v[116:119]
    v_mfma_f32_16x16x32_bf16 v[120:123], a[40:43], v[100:103], v[120:123]
    v_mfma_f32_16x16x32_bf16 v[124:127], a[44:47], v[100:103], v[124:127]
    v_mfma_f32_16x16x32_bf16 v[112:115], a[48:51], v[104:107], v[112:115]
    v_mfma_f32_16x16x32_bf16 v[116:119], a[52:55], v[104:107], v[116:119]
    v_mfma_f32_16x16x32_bf16 v[120:123], a[56:59], v[104:107], v[120:123]
    v_mfma_f32_16x16x32_bf16 v[124:127], a[60:63], v[104:107], v[124:127]
    v_mfma_f32_16x16x32_bf16 v[112:115], a[64:67], v[108:111], v[112:115]
    v_mfma_f32_16x16x32_bf16 v[116:119], a[68:71], v[108:111], v[116:119]
    v_mfma_f32_16x16x32_bf16 v[120:123], a[72:75], v[108:111], v[120:123]
    v_mfma_f32_16x16x32_bf16 v[124:127], a[76:79], v[108:111], v[124:127]
    s_mul_i32 s36, s3, 768
    s_add_u32 s36, s36, 133120
    v_lshlrev_b32 v4, 8, v3
    v_lshl_add_u32 v4, v2, 4, v4
    v_add_u32 v4, s36, v4
    v_add_u32 v5, 133120, v12
    s_lshl_b32 s37, s3, 8
    s_add_u32 s37, s37, 139264
    v_lshl_add_u32 v6, v1, 1, s37
    v_and_b32 v7, 1, v1
    v_lshlrev_b32 v7, 7, v7
    v_lshl_add_u32 v7, v2, 4, v7
    v_add_u32 v7, s37, v7
    s_lshl_b32 s38, s56, 16
    s_lshl_b32 s39, s57, 16
    v_rcp_f32 v8, s38
    v_rcp_f32 v9, s39
    s_and_b32 s56, s56, 0xffff0000
    s_and_b32 s57, s57, 0xffff0000
    s_mov_b32 exec_lo, 0x00070007
    s_mov_b32 exec_hi, 0x00070007
    ds_write_b128 v4, v[112:115] offset:0
    ds_write_b128 v4, v[116:119] offset:64
    ds_write_b128 v4, v[120:123] offset:128
    ds_write_b128 v4, v[124:127] offset:192
    s_mov_b64 exec, -1
    s_waitcnt lgkmcnt(0)
    s_barrier
    ds_read2st64_b32 v[92:93], v5 offset0:0 offset1:1
    ds_read2st64_b32 v[94:95], v5 offset0:2 offset1:3
    ds_read2st64_b32 v[96:97], v5 offset0:4 offset1:5
    ds_read2st64_b32 v[98:99], v5 offset0:6 offset1:7
    ds_read2st64_b32 v[100:101], v5 offset0:8 offset1:9
    ds_read2st64_b32 v[102:103], v5 offset0:10 offset1:11
    ds_read2st64_b32 v[116:117], v5 offset0:12 offset1:13
    ds_read2st64_b32 v[118:119], v5 offset0:14 offset1:15
    ds_read2st64_b32 v[120:121], v5 offset0:16 offset1:17
    ds_read2st64_b32 v[122:123], v5 offset0:18 offset1:19
    ds_read2st64_b32 v[124:125], v5 offset0:20 offset1:21
    ds_read2st64_b32 v[126:127], v5 offset0:22 offset1:23
    v_cmp_eq_u32 s[72:73], 1, v2
    v_cmp_eq_u32 s[74:75], 2, v2
    v_cmp_eq_u32 s[76:77], 3, v2
    s_mul_i32 s37, s32, 10
    s_add_u32 s37, s37, s3
    s_lshl_b32 s37, s37, 10
    s_add_u32 s37, s37, 7405568
    s_waitcnt lgkmcnt(0)
    v_add_f32 v92, v92, v95
    v_add_f32 v98, v98, v101
    v_add_f32 v92, v92, v98
    v_add_f32 v93, v93, v96
    v_add_f32 v99, v99, v102
    v_add_f32 v93, v93, v99
    v_add_f32 v94, v94, v97
    v_add_f32 v100, v100, v103
    v_add_f32 v94, v94, v100
    v_add_f32 v116, v116, v119
    v_add_f32 v122, v122, v125
    v_add_f32 v116, v116, v122
    v_add_f32 v117, v117, v120
    v_add_f32 v123, v123, v126
    v_add_f32 v117, v117, v123
    v_add_f32 v118, v118, v121
    v_add_f32 v124, v124, v127
    v_add_f32 v118, v118, v124
    v_fmac_f32 v92, s56, v94
    v_mul_f32 v112, v92, v8
    v_fmac_f32 v93, s57, v94
    v_mul_f32 v113, v93, v9
    v_fmac_f32 v116, s56, v118
    v_mul_f32 v120, v116, v8
    v_fmac_f32 v117, s57, v118
    v_mul_f32 v121, v117, v9
    v_cvt_pk_bf16_f32 v113, v112, v113
    v_lshlrev_b32 v112, 16, v113
    v_and_b32 v113, 0xffff0000, v113
    v_cvt_pk_bf16_f32 v121, v120, v121
    v_lshlrev_b32 v120, 16, v121
    v_and_b32 v121, 0xffff0000, v121
    v_mul_f32 v114, 0xbfb8aa3b, v112
    v_mul_f32 v115, 0xbfb8aa3b, v113
    v_exp_f32 v114, v114
    v_exp_f32 v115, v115
    v_add_f32 v114, 1.0, v114
    v_add_f32 v115, 1.0, v115
    v_rcp_f32 v114, v114
    v_rcp_f32 v115, v115
    v_mul_f32 v114, v114, v112
    v_mul_f32 v115, v115, v113
    v_cvt_pk_bf16_f32 v115, v114, v115
    v_lshlrev_b32 v114, 16, v115
    v_and_b32 v115, 0xffff0000, v115
    v_mul_f32 v114, v114, v120
    v_mul_f32 v115, v115, v121
    v_cvt_pk_bf16_f32 v114, v114, v115
    ds_write_b16 v6, v114
    ds_write_b16_d16_hi v6, v114 offset:128
    ds_read_b128 v[92:95], v7 offset:0
    ds_read_b128 v[96:99], v7 offset:64
    v_mov_b32 v101, s34
    v_mov_b32 v103, s34
    s_waitcnt vmcnt(0)
    ds_read_b64_tr_b16 v[28:29], v14 offset:4096
    ds_read_b64_tr_b16 v[30:31], v14 offset:4608
    ds_read_b64_tr_b16 v[32:33], v15 offset:4096
    ds_read_b64_tr_b16 v[34:35], v15 offset:4608
    ds_read_b64_tr_b16 v[36:37], v16 offset:4096
    ds_read_b64_tr_b16 v[38:39], v16 offset:4608
    ds_read_b64_tr_b16 v[40:41], v17 offset:4096
    ds_read_b64_tr_b16 v[42:43], v17 offset:4608
    ds_read_b64_tr_b16 v[44:45], v14 offset:8192
    ds_read_b64_tr_b16 v[46:47], v14 offset:8704
    ds_read_b64_tr_b16 v[48:49], v15 offset:8192
    ds_read_b64_tr_b16 v[50:51], v15 offset:8704
    ds_read_b64_tr_b16 v[52:53], v16 offset:8192
    ds_read_b64_tr_b16 v[54:55], v16 offset:8704
    ds_read_b64_tr_b16 v[56:57], v17 offset:8192
    ds_read_b64_tr_b16 v[58:59], v17 offset:8704
    s_waitcnt lgkmcnt(0)
    v_mfma_f32_16x16x32_bf16 v[112:115], v[92:95], v[28:31], 0
    v_mfma_f32_16x16x32_bf16 v[116:119], v[92:95], v[32:35], 0
    v_mfma_f32_16x16x32_bf16 v[120:123], v[92:95], v[36:39], 0
    v_mfma_f32_16x16x32_bf16 v[124:127], v[92:95], v[40:43], 0
    v_mfma_f32_16x16x32_bf16 v[112:115], v[96:99], v[44:47], v[112:115]
    v_mfma_f32_16x16x32_bf16 v[116:119], v[96:99], v[48:51], v[116:119]
    v_mfma_f32_16x16x32_bf16 v[120:123], v[96:99], v[52:55], v[120:123]
    v_mfma_f32_16x16x32_bf16 v[124:127], v[96:99], v[56:59], v[124:127]
    s_nop 5
    v_cndmask_b32 v100, v112, v116, s[72:73]
    v_cndmask_b32 v100, v100, v120, s[74:75]
    v_cndmask_b32 v100, v100, v124, s[76:77]
    v_cndmask_b32 v102, v113, v117, s[72:73]
    v_cndmask_b32 v102, v102, v121, s[74:75]
    v_cndmask_b32 v102, v102, v125, s[76:77]
    buffer_store_dwordx4 v[100:103], v13, s[28:31], s37 offen sc1
    s_sub_u32 s36, s3, 4
    s_cmp_ge_u32 s36, 2
    s_cbranch_scc1 Laux_end
    s_add_u32 s37, s37, 4096
    ds_read_b64_tr_b16 v[60:61], v14 offset:12288
    ds_read_b64_tr_b16 v[62:63], v14 offset:12800
    ds_read_b64_tr_b16 v[64:65], v15 offset:12288
    ds_read_b64_tr_b16 v[66:67], v15 offset:12800
    ds_read_b64_tr_b16 v[68:69], v16 offset:12288
    ds_read_b64_tr_b16 v[70:71], v16 offset:12800
    ds_read_b64_tr_b16 v[72:73], v17 offset:12288
    ds_read_b64_tr_b16 v[74:75], v17 offset:12800
    ds_read_b64_tr_b16 v[76:77], v14 offset:0
    ds_read_b64_tr_b16 v[78:79], v14 offset:512
    ds_read_b64_tr_b16 v[80:81], v15 offset:0
    ds_read_b64_tr_b16 v[82:83], v15 offset:512
    ds_read_b64_tr_b16 v[84:85], v16 offset:0
    ds_read_b64_tr_b16 v[86:87], v16 offset:512
    ds_read_b64_tr_b16 v[88:89], v17 offset:0
    ds_read_b64_tr_b16 v[90:91], v17 offset:512
    s_waitcnt lgkmcnt(0)
    v_mfma_f32_16x16x32_bf16 v[112:115], v[92:95], v[60:63], 0
    v_mfma_f32_16x16x32_bf16 v[116:119], v[92:95], v[64:67], 0
    v_mfma_f32_16x16x32_bf16 v[120:123], v[92:95], v[68:71], 0
    v_mfma_f32_16x16x32_bf16 v[124:127], v[92:95], v[72:75], 0
    v_mfma_f32_16x16x32_bf16 v[112:115], v[96:99], v[76:79], v[112:115]
    v_mfma_f32_16x16x32_bf16 v[116:119], v[96:99], v[80:83], v[116:119]
    v_mfma_f32_16x16x32_bf16 v[120:123], v[96:99], v[84:87], v[120:123]
    v_mfma_f32_16x16x32_bf16 v[124:127], v[96:99], v[88:91], v[124:127]
    s_nop 5
    v_cndmask_b32 v100, v112, v116, s[72:73]
    v_cndmask_b32 v100, v100, v120, s[74:75]
    v_cndmask_b32 v100, v100, v124, s[76:77]
    v_cndmask_b32 v102, v113, v117, s[72:73]
    v_cndmask_b32 v102, v102, v121, s[74:75]
    v_cndmask_b32 v102, v102, v125, s[76:77]
    buffer_store_dwordx4 v[100:103], v13, s[28:31], s37 offen sc1
Laux_end:
    s_endpgm
Lmst:
    s_cmp_lg_u32 s3, 0
    s_cbranch_scc1 Lhelp_i
    s_waitcnt lgkmcnt(0)
    s_mov_b64 s[28:29], s[24:25]
    s_mov_b32 s30, 268435456
    s_mov_b32 s31, 0x20000
    s_load_dword s34, s[28:29], 0
    s_waitcnt lgkmcnt(0)
    s_add_u32 s34, s34, 0x9e3779b8
    s_or_b32 s34, s34, 1
    s_mov_b64 exec, 1
    s_lshl_b32 s36, s2, 2
    s_add_u32 s36, s36, 8323072
    v_mov_b32 v4, s34
    v_mov_b32 v5, s36
    buffer_store_dword v4, v5, s[28:31], 0 offen sc1
    s_mov_b64 exec, -1
    s_cmp_lg_u32 s32, 32
    s_cbranch_scc1 Lend
Lmst_bc:
    v_and_b32 v4, 31, v1
    v_lshlrev_b32 v4, 7, v4
    v_add_u32 v4, 8126464, v4
Lpt_14:
    s_sub_u32 s35, s35, 1
    s_cbranch_scc1 Lend
    s_sleep 8
    buffer_load_dwordx4 v[8:11], v4, s[28:31], 0 offen sc1
    s_waitcnt vmcnt(0)
    v_cmp_ne_u32 vcc, s34, v9
    v_cmp_ne_u32 s[36:37], s34, v11
    s_nop 0
    s_or_b64 s[36:37], s[36:37], vcc
    s_cbranch_scc1 Lpt_14
    v_mov_b32 v4, v8
    s_nop 1
    v_max_u32_dpp v4, v4, v4 row_ror:8 row_mask:0xf bank_mask:0xf
    s_nop 1
    v_max_u32_dpp v4, v4, v4 row_ror:4 row_mask:0xf bank_mask:0xf
    s_nop 1
    v_max_u32_dpp v4, v4, v4 row_ror:2 row_mask:0xf bank_mask:0xf
    s_nop 1
    v_max_u32_dpp v4, v4, v4 row_ror:1 row_mask:0xf bank_mask:0xf
    s_nop 0
    v_readlane_b32 s40, v4, 0
    v_readlane_b32 s36, v4, 16
    v_readlane_b32 s37, v4, 32
    v_readlane_b32 s38, v4, 48
    s_max_u32 s40, s40, s36
    s_max_u32 s37, s37, s38
    s_max_u32 s40, s40, s37
    v_cmp_eq_u32 vcc, s40, v8
    s_nop 1
    v_cndmask_b32 v4, v8, v10, vcc
    s_nop 1
    v_max_u32_dpp v4, v4, v4 row_ror:8 row_mask:0xf bank_mask:0xf
    s_nop 1
    v_max_u32_dpp v4, v4, v4 row_ror:4 row_mask:0xf bank_mask:0xf
    s_nop 1
    v_max_u32_dpp v4, v4, v4 row_ror:2 row_mask:0xf bank_mask:0xf
    s_nop 1
    v_max_u32_dpp v4, v4, v4 row_ror:1 row_mask:0xf bank_mask:0xf
    s_nop 0
    v_readlane_b32 s41, v4, 0
    v_readlane_b32 s36, v4, 16
    v_readlane_b32 s37, v4, 32
    v_readlane_b32 s38, v4, 48
    s_max_u32 s41, s41, s36
    s_max_u32 s37, s37, s38
    s_max_u32 s41, s41, s37
    v_mov_b32 v8, s40
    v_mov_b32 v9, s34
    v_mov_b32 v10, s41
    v_mov_b32 v11, s34
    s_mov_b32 s36, 8257536
    buffer_store_dwordx4 v[8:11], v13, s[28:31], s36 offen offset:0 sc1
    buffer_store_dwordx4 v[8:11], v13, s[28:31], s36 offen offset:1024 sc1
    buffer_store_dwordx4 v[8:11], v13, s[28:31], s36 offen offset:2048 sc1
    s_mov_b32 s36, 8323072
Lmaster:
    s_sub_u32 s35, s35, 1
    s_cbranch_scc1 Lend
    s_sleep 16
    buffer_load_dwordx4 v[4:7], v13, s[28:31], s36 offen sc1
    s_waitcnt vmcnt(0)
    v_xor_b32 v4, s34, v4
    v_xor_b32 v5, s34, v5
    v_xor_b32 v6, s34, v6
    v_xor_b32 v7, s34, v7
    v_or3_b32 v4, v4, v5, v6
    v_or_b32 v4, v4, v7
    v_cmp_ne_u32 vcc, 0, v4
    s_nop 0
    s_cbranch_vccnz Lmaster
    s_mov_b64 exec, 1
    buffer_store_dword v9, v4, s[28:31], 0 offen sc1
    s_endpgm
Lhelp_r:
    s_sub_u32 s72, s32, 27
    s_add_u32 s72, s72, 9
    s_mov_b32 s73, 5
    s_mov_b32 s37, 2
    s_branch Lhelp
Lhelp_i:
    s_cmp_eq_u32 s32, 32
    s_cbranch_scc1 Lend
    s_cmp_eq_u32 s27, 0
    s_cbranch_scc1 Lend
    s_sub_u32 s72, s32, 33
    s_mov_b32 s73, 3
    s_mov_b32 s37, 3
Lhelp:
    s_lshl_b32 s38, s26, 6
    v_add_u32 v4, s38, v1
    v_mul_u32_u24 v4, 1280, v4
    s_waitcnt lgkmcnt(0)
    s_mov_b64 s[68:69], s[8:9]
    s_mov_b32 s70, 819200
    s_mov_b32 s71, 0x20000
    v_add_u32 v7, s38, v1
    v_lshlrev_b32 v7, 7, v7
    s_cmp_eq_u32 s73, 3
    s_cselect_b32 s36, 5, 2
    s_cselect_b32 s39, 33, 27
    s_cselect_b32 s38, 0, 15
    s_sub_u32 s39, s32, s39
    s_mul_i32 s39, s39, s36
    s_add_u32 s39, s39, s38
    s_lshl_b32 s39, s39, 15
Lhelp1:
    buffer_load_dword v5, v7, s[68:71], s39 offen
    s_add_u32 s39, s39, 32768
    s_sub_u32 s36, s36, 1
    s_cmp_lg_u32 s36, 0
    s_cbranch_scc1 Lhelp1
    s_mov_b64 s[68:69], s[18:19]
    s_mov_b32 s70, 2211840
    s_mov_b32 s71, 0x20000
Lhelp2:
    s_mul_i32 s38, s72, 9363
    s_lshr_b32 s38, s38, 16
    s_mul_i32 s39, s38, 7
    s_sub_u32 s39, s72, s39
    s_mul_i32 s39, s39, 327680
    s_lshl_b32 s38, s38, 7
    s_sub_u32 s39, s39, s38
    s_add_u32 s39, s39, 1152
    v_add_u32 v6, s39, v4
    buffer_load_dword v5, v6, s[68:71], 0 offen
    s_add_u32 s72, s72, s73
    s_sub_u32 s37, s37, 1
    s_cmp_lg_u32 s37, 0
    s_cbranch_scc1 Lhelp2
Lend:
    s_endpgm
.section .rodata,"a"
.p2align 6
.amdhsa_kernel recurrent_scan__sliding_local_dilated__moe_arch_mod__prompt_kernel
  .amdhsa_next_free_vgpr 256
  .amdhsa_next_free_sgpr 102
  .amdhsa_accum_offset 128
  .amdhsa_group_segment_fixed_size 0
  .amdhsa_kernarg_size 88
  .amdhsa_user_sgpr_count 2
  .amdhsa_user_sgpr_kernarg_segment_ptr 1
  .amdhsa_system_sgpr_workgroup_id_x 1
  .amdhsa_float_denorm_mode_32 3
.end_amdhsa_kernel
```

```asm
; @launch grid=(256,1,1) block=(512,1,1) lds=163840
.amdgcn_target "amdgcn-amd-amdhsa--gfx950"
.text
.globl recurrent_scan__sliding_local_dilated__moe_arch_mod__prompt_kernel
.p2align 8
.type recurrent_scan__sliding_local_dilated__moe_arch_mod__prompt_kernel,@function
recurrent_scan__sliding_local_dilated__moe_arch_mod__prompt_kernel:
    s_load_dwordx16 s[4:19], s[0:1], 0
    s_load_dwordx4 s[20:23], s[0:1], 64
    s_load_dwordx2 s[24:25], s[0:1], 80
    v_lshrrev_b32 v4, 6, v0
    v_and_b32 v1, 63, v0
    s_cmp_ge_u32 s2, 256
    s_cbranch_scc1 Lend
    v_readfirstlane_b32 s3, v4
    s_getpc_b64 s[36:37]
Lpc:
    s_and_b32 s38, s2, 0xf8
    v_add_u32 v5, s38, v4
    v_and_b32 v6, 1, v0
    v_lshl_add_u32 v5, v5, 1, v6
    v_lshlrev_b32 v5, 7, v5
    v_min_u32 v5, Lend-Lpc, v5
    v_mov_b32 v7, s37
    v_add_co_u32 v6, vcc, s36, v5
    s_nop 1
    v_addc_co_u32 v7, vcc, 0, v7, vcc
    global_load_dword v0, v[6:7], off
    v_lshrrev_b32 v2, 4, v1
    v_and_b32 v3, 15, v1
    v_lshlrev_b32 v12, 2, v1
    v_lshlrev_b32 v13, 4, v1
    s_mov_b32 s35, 2000000
    s_and_b32 s36, s2, 7
    s_lshr_b32 s37, s2, 3
    s_and_b32 s38, s36, 1
    s_lshr_b32 s36, s36, 1
    s_add_u32 s39, s38, 4
    s_and_b32 s26, s3, 3
    s_lshr_b32 s27, s3, 2
    s_cmp_lt_u32 s37, s39
    s_cbranch_scc1 Laux
    s_lshr_b32 s33, s36, 1
    s_and_b32 s36, s36, 1
    s_mul_i32 s36, s36, 55
    s_mul_i32 s38, s38, 28
    s_add_u32 s36, s36, s38
    s_add_u32 s36, s36, s37
    s_sub_u32 s36, s36, s39
    s_mul_i32 s32, s36, 13108
    s_lshr_b32 s32, s32, 16
    s_mul_i32 s37, s32, 5
    s_sub_u32 s36, s36, s37
    s_mul_i32 s33, s33, 5
    s_add_u32 s33, s33, s36
    s_add_u32 s42, s33, s32
    s_mul_i32 s36, s42, 13108
    s_lshr_b32 s36, s36, 16
    s_mul_i32 s36, s36, 5
    s_sub_u32 s42, s42, s36
    s_and_b32 s43, s2, 7
    s_lshl_b32 s43, s43, 2
    s_lshr_b32 s43, 0x30858530, s43
    s_and_b32 s43, s43, 15
    s_cmp_lg_u32 s3, 0
    s_cbranch_scc1 Lcomp
Lloader:
    s_setprio 3
    v_lshrrev_b32 v5, 3, v1
    v_and_b32 v6, 7, v1
    v_and_b32 v8, 1, v2
    v_lshlrev_b32 v8, 1, v8
    v_xor_b32 v8, v8, v6
    s_lshl_b32 s39, s33, 7
    v_lshl_add_u32 v50, v8, 4, s39
    v_mov_b32 v7, 3840
    v_mad_u32_u24 v28, v5, v7, v50
    v_xor_b32 v29, 64, v28
    v_add_u32 v29, 29696, v29
    v_add_u32 v30, 59392, v28
    v_add_u32 v31, 59392, v29
    v_add_u32 v32, 122880, v28
    v_add_u32 v33, 122880, v29
    v_add_u32 v34, 182272, v28
    v_add_u32 v35, 182272, v29
    s_lshl_b32 s79, s42, 2
    s_lshr_b32 s79, 0x11000, s79
    s_and_b32 s79, s79, 15
    s_add_u32 s79, s79, s43
    s_sub_u32 s38, s79, 10
    s_cmp_ge_u32 s79, 10
    s_cselect_b32 s79, s38, s79
    s_mul_i32 s68, s79, 245760
    s_lshl_b32 s78, s79, 7
    s_waitcnt lgkmcnt(0)
    s_mov_b64 s[48:49], s[6:7]
    s_mov_b32 s50, 2457600
    s_mov_b32 s51, 0x20000
    s_add_u32 s52, s6, 1280
    s_addc_u32 s53, s7, 0
    s_mov_b32 s54, 2456320
    s_mov_b32 s55, 0x20000
    s_add_u32 s56, s6, 2560
    s_addc_u32 s57, s7, 0
    s_mov_b32 s58, 2455040
    s_mov_b32 s59, 0x20000
    s_lshr_b32 s69, 10, s42
    s_and_b32 s69, s69, 1
    s_mul_i32 s70, s69, 122880
    s_sub_u32 s71, 122880, s70
    s_add_u32 s70, s70, s68
    s_add_u32 s71, s71, s68
    s_lshl_b32 s72, s69, 12
    s_xor_b32 s73, s72, 4096
    s_add_u32 m0, s72, 0
    s_mul_i32 s38, s32, 96
    s_sub_u32 s38, s38, 16
    v_add_u32 v7, s38, v5
    v_xor_b32 v9, v6, v2
    v_lshlrev_b32 v9, 4, v9
    buffer_load_dwordx4 v28, s[48:51], s70 offen lds
    v_xor_b32 v10, 64, v9
    v_mov_b32 v11, 2052
    v_mov_b32 v8, 1280
    v_add_u32 v36, 0, v7
    buffer_load_dwordx4 v29, s[48:51], s70 offen offset:1024 lds
    v_med3_i32 v36, v36, 0, v11
    v_mad_u32_u24 v36, v36, v8, v9
    v_add_u32 v36, 4096, v36
    v_add_u32 v37, 8, v7
    buffer_load_dwordx4 v30, s[48:51], s70 offen offset:2048 lds
    v_med3_i32 v37, v37, 0, v11
    v_mad_u32_u24 v37, v37, v8, v10
    v_add_u32 v37, 3072, v37
    v_add_u32 v38, 16, v7
    v_med3_i32 v38, v38, 0, v11
    buffer_load_dwordx4 v31, s[48:51], s70 offen offset:3072 lds
    v_mad_u32_u24 v38, v38, v8, v9
    v_add_u32 v38, 2048, v38
    v_add_u32 v39, 24, v7
    v_med3_i32 v39, v39, 0, v11
    s_add_u32 m0, s72, 8192
    v_mad_u32_u24 v39, v39, v8, v10
    v_add_u32 v39, 1024, v39
    v_add_u32 v40, 32, v7
    v_med3_i32 v40, v40, 0, v11
    buffer_load_dwordx4 v28, s[52:55], s70 offen lds
    v_mad_u32_u24 v40, v40, v8, v9
    v_add_u32 v40, 4096, v40
    v_add_u32 v41, 40, v7
    v_med3_i32 v41, v41, 0, v11
    v_mad_u32_u24 v41, v41, v8, v10
    buffer_load_dwordx4 v29, s[52:55], s70 offen offset:1024 lds
    v_add_u32 v41, 3072, v41
    v_add_u32 v42, 48, v7
    v_med3_i32 v42, v42, 0, v11
    v_mad_u32_u24 v42, v42, v8, v9
    buffer_load_dwordx4 v30, s[52:55], s70 offen offset:2048 lds
    v_add_u32 v42, 2048, v42
    v_add_u32 v43, 56, v7
    v_med3_i32 v43, v43, 0, v11
    v_mad_u32_u24 v43, v43, v8, v10
    buffer_load_dwordx4 v31, s[52:55], s70 offen offset:3072 lds
    v_add_u32 v43, 1024, v43
    v_add_u32 v44, 64, v7
    v_med3_i32 v44, v44, 0, v11
    v_mad_u32_u24 v44, v44, v8, v9
    v_add_u32 v44, 4096, v44
    s_add_u32 m0, s72, 16384
    v_add_u32 v45, 72, v7
    v_med3_i32 v45, v45, 0, v11
    v_mad_u32_u24 v45, v45, v8, v10
    v_add_u32 v45, 3072, v45
    buffer_load_dwordx4 v28, s[56:59], s70 offen lds
    v_add_u32 v46, 80, v7
    v_med3_i32 v46, v46, 0, v11
    v_mad_u32_u24 v46, v46, v8, v9
    v_add_u32 v46, 2048, v46
    buffer_load_dwordx4 v29, s[56:59], s70 offen offset:1024 lds
    v_add_u32 v47, 88, v7
    v_med3_i32 v47, v47, 0, v11
    v_mad_u32_u24 v47, v47, v8, v10
    v_add_u32 v47, 1024, v47
    v_add_u32 v48, 96, v7
    buffer_load_dwordx4 v30, s[56:59], s70 offen offset:2048 lds
    v_med3_i32 v48, v48, 0, v11
    v_mad_u32_u24 v48, v48, v8, v9
    v_add_u32 v48, 4096, v48
    v_add_u32 v49, 104, v7
    buffer_load_dwordx4 v31, s[56:59], s70 offen offset:3072 lds
    v_med3_i32 v49, v49, 0, v11
    v_mad_u32_u24 v49, v49, v8, v10
    v_add_u32 v49, 3072, v49
    s_sub_u32 s44, s4, 4096
    s_subb_u32 s45, s5, 0
    s_mov_b32 s46, 2625536
    s_mov_b32 s47, 0x20000
    s_mov_b32 m0, 24576
    s_nop 0
    buffer_load_dwordx4 v36, s[44:47], s78 offen lds
    buffer_load_dwordx4 v37, s[44:47], s78 offen offset:1024 lds
    buffer_load_dwordx4 v38, s[44:47], s78 offen offset:2048 lds
    buffer_load_dwordx4 v39, s[44:47], s78 offen offset:3072 lds
    s_mov_b32 m0, 28672
    s_nop 0
    buffer_load_dwordx4 v40, s[44:47], s78 offen lds
    buffer_load_dwordx4 v41, s[44:47], s78 offen offset:1024 lds
    buffer_load_dwordx4 v42, s[44:47], s78 offen offset:2048 lds
    buffer_load_dwordx4 v43, s[44:47], s78 offen offset:3072 lds
    s_mov_b32 m0, 32768
    s_nop 0
    buffer_load_dwordx4 v44, s[44:47], s78 offen lds
    buffer_load_dwordx4 v45, s[44:47], s78 offen offset:1024 lds
    buffer_load_dwordx4 v46, s[44:47], s78 offen offset:2048 lds
    buffer_load_dwordx4 v47, s[44:47], s78 offen offset:3072 lds
    s_mov_b32 m0, 36864
    s_nop 0
    buffer_load_dwordx4 v48, s[44:47], s78 offen lds
    buffer_load_dwordx4 v49, s[44:47], s78 offen offset:1024 lds
    s_add_u32 m0, s73, 0
    s_nop 0
    buffer_load_dwordx4 v28, s[48:51], s71 offen lds
    buffer_load_dwordx4 v29, s[48:51], s71 offen offset:1024 lds
    buffer_load_dwordx4 v30, s[48:51], s71 offen offset:2048 lds
    buffer_load_dwordx4 v31, s[48:51], s71 offen offset:3072 lds
    s_add_u32 m0, s73, 8192
    s_nop 0
    buffer_load_dwordx4 v28, s[52:55], s71 offen lds
    buffer_load_dwordx4 v29, s[52:55], s71 offen offset:1024 lds
    buffer_load_dwordx4 v30, s[52:55], s71 offen offset:2048 lds
    buffer_load_dwordx4 v31, s[52:55], s71 offen offset:3072 lds
    s_add_u32 m0, s73, 16384
    s_nop 0
    buffer_load_dwordx4 v28, s[56:59], s71 offen lds
    buffer_load_dwordx4 v29, s[56:59], s71 offen offset:1024 lds
    buffer_load_dwordx4 v30, s[56:59], s71 offen offset:2048 lds
    buffer_load_dwordx4 v31, s[56:59], s71 offen offset:3072 lds
    s_mov_b32 s80, 0x86542310
    s_mov_b32 s81, 0x97
    s_cmp_eq_u32 s42, 1
    s_cselect_b32 s80, 0x76453210, s80
    s_cselect_b32 s81, 0x98, s81
    s_cmp_eq_u32 s42, 2
    s_cselect_b32 s80, 0x67543120, s80
    s_cselect_b32 s81, 0x98, s81
    s_cmp_eq_u32 s42, 3
    s_cselect_b32 s80, 0x76534201, s80
    s_cselect_b32 s81, 0x89, s81
    s_cmp_eq_u32 s42, 4
    s_cselect_b32 s80, 0x75643201, s80
    s_cselect_b32 s81, 0x98, s81
    s_lshr_b64 s[80:81], s[80:81], 4
    s_and_b32 s79, s80, 15
    s_add_u32 s79, s79, s43
    s_sub_u32 s38, s79, 10
    s_cmp_ge_u32 s79, 10
    s_cselect_b32 s79, s38, s79
    s_mov_b64 s[28:29], s[24:25]
    s_mov_b32 s30, 268435456
    s_mov_b32 s31, 0x20000
    s_load_dword s34, s[28:29], 0
    s_mov_b64 s[60:61], s[8:9]
    s_mov_b32 s62, 819200
    s_mov_b32 s63, 0x20000
    v_mov_b32 v51, 157984
    v_and_b32 v66, 7, v1
    v_max_u32 v66, 1, v66
    v_lshlrev_b32 v66, 2, v66
    v_add_u32 v66, 158016, v66
    s_mul_i32 s69, s79, 245760
    s_lshl_b32 s78, s79, 7
    s_mov_b32 m0, 63616
    s_nop 0
    buffer_load_dwordx4 v36, s[44:47], s78 offen lds
    buffer_load_dwordx4 v37, s[44:47], s78 offen offset:1024 lds
    buffer_load_dwordx4 v38, s[44:47], s78 offen offset:2048 lds
    buffer_load_dwordx4 v39, s[44:47], s78 offen offset:3072 lds
    s_mov_b32 m0, 39040
    s_nop 0
    buffer_load_dwordx4 v28, s[48:51], s69 offen lds
    buffer_load_dwordx4 v29, s[48:51], s69 offen offset:1024 lds
    buffer_load_dwordx4 v30, s[48:51], s69 offen offset:2048 lds
    buffer_load_dwordx4 v31, s[48:51], s69 offen offset:3072 lds
    s_mov_b32 m0, 67712
    s_nop 0
    buffer_load_dwordx4 v40, s[44:47], s78 offen lds
    buffer_load_dwordx4 v41, s[44:47], s78 offen offset:1024 lds
    buffer_load_dwordx4 v42, s[44:47], s78 offen offset:2048 lds
    buffer_load_dwordx4 v43, s[44:47], s78 offen offset:3072 lds
    s_mov_b32 m0, 47232
    s_nop 0
    buffer_load_dwordx4 v28, s[52:55], s69 offen lds
    buffer_load_dwordx4 v29, s[52:55], s69 offen offset:1024 lds
    buffer_load_dwordx4 v30, s[52:55], s69 offen offset:2048 lds
    buffer_load_dwordx4 v31, s[52:55], s69 offen offset:3072 lds
    s_mov_b32 m0, 71808
    s_nop 0
    buffer_load_dwordx4 v44, s[44:47], s78 offen lds
    buffer_load_dwordx4 v45, s[44:47], s78 offen offset:1024 lds
    buffer_load_dwordx4 v46, s[44:47], s78 offen offset:2048 lds
    buffer_load_dwordx4 v47, s[44:47], s78 offen offset:3072 lds
    s_mov_b32 m0, 55424
    s_nop 0
    buffer_load_dwordx4 v28, s[56:59], s69 offen lds
    buffer_load_dwordx4 v29, s[56:59], s69 offen offset:1024 lds
    buffer_load_dwordx4 v30, s[56:59], s69 offen offset:2048 lds
    buffer_load_dwordx4 v31, s[56:59], s69 offen offset:3072 lds
    s_mov_b32 m0, 75904
    s_nop 0
    buffer_load_dwordx4 v48, s[44:47], s78 offen lds
    s_waitcnt vmcnt(55)
    buffer_load_dwordx4 v49, s[44:47], s78 offen offset:1024 lds
    s_mov_b32 m0, 43136
    s_nop 0
    buffer_load_dwordx4 v32, s[48:51], s69 offen lds
    buffer_load_dwordx4 v33, s[48:51], s69 offen offset:1024 lds
    buffer_load_dwordx4 v34, s[48:51], s69 offen offset:2048 lds
    buffer_load_dwordx4 v35, s[48:51], s69 offen offset:3072 lds
    s_mov_b32 m0, 51328
    s_nop 0
    buffer_load_dwordx4 v32, s[52:55], s69 offen lds
    buffer_load_dwordx4 v33, s[52:55], s69 offen offset:1024 lds
    buffer_load_dwordx4 v34, s[52:55], s69 offen offset:2048 lds
    s_waitcnt vmcnt(55)
    buffer_load_dwordx4 v35, s[52:55], s69 offen offset:3072 lds
    s_mov_b32 m0, 59520
    s_nop 0
    buffer_load_dwordx4 v32, s[56:59], s69 offen lds
    buffer_load_dwordx4 v33, s[56:59], s69 offen offset:1024 lds
    buffer_load_dwordx4 v34, s[56:59], s69 offen offset:2048 lds
    buffer_load_dwordx4 v35, s[56:59], s69 offen offset:3072 lds
    s_waitcnt vmcnt(38) lgkmcnt(0)
    s_barrier
    s_add_u32 s34, s34, 0x9e3779b8
    s_or_b32 s34, s34, 1
    s_lshr_b64 s[80:81], s[80:81], 4
    s_and_b32 s79, s80, 15
    s_add_u32 s79, s79, s43
    s_sub_u32 s38, s79, 10
    s_cmp_ge_u32 s79, 10
    s_cselect_b32 s79, s38, s79
    s_mul_i32 s70, s79, 245760
    s_lshl_b32 s78, s79, 7
    s_mov_b32 m0, 102656
    s_nop 0
    buffer_load_dwordx4 v36, s[44:47], s78 offen lds
    buffer_load_dwordx4 v37, s[44:47], s78 offen offset:1024 lds
    buffer_load_dwordx4 v38, s[44:47], s78 offen offset:2048 lds
    buffer_load_dwordx4 v39, s[44:47], s78 offen offset:3072 lds
    s_mov_b32 m0, 78080
    s_nop 0
    buffer_load_dwordx4 v28, s[48:51], s70 offen lds
    buffer_load_dwordx4 v29, s[48:51], s70 offen offset:1024 lds
    buffer_load_dwordx4 v30, s[48:51], s70 offen offset:2048 lds
    buffer_load_dwordx4 v31, s[48:51], s70 offen offset:3072 lds
    s_mov_b32 m0, 106752
    s_nop 0
    buffer_load_dwordx4 v40, s[44:47], s78 offen lds
    buffer_load_dwordx4 v41, s[44:47], s78 offen offset:1024 lds
    buffer_load_dwordx4 v42, s[44:47], s78 offen offset:2048 lds
    buffer_load_dwordx4 v43, s[44:47], s78 offen offset:3072 lds
    s_mov_b32 m0, 86272
    s_nop 0
    buffer_load_dwordx4 v28, s[52:55], s70 offen lds
    buffer_load_dwordx4 v29, s[52:55], s70 offen offset:1024 lds
    buffer_load_dwordx4 v30, s[52:55], s70 offen offset:2048 lds
    buffer_load_dwordx4 v31, s[52:55], s70 offen offset:3072 lds
    s_mov_b32 m0, 110848
    s_nop 0
    buffer_load_dwordx4 v44, s[44:47], s78 offen lds
    buffer_load_dwordx4 v45, s[44:47], s78 offen offset:1024 lds
    buffer_load_dwordx4 v46, s[44:47], s78 offen offset:2048 lds
    buffer_load_dwordx4 v47, s[44:47], s78 offen offset:3072 lds
    s_mov_b32 m0, 94464
    s_nop 0
    buffer_load_dwordx4 v28, s[56:59], s70 offen lds
    buffer_load_dwordx4 v29, s[56:59], s70 offen offset:1024 lds
    buffer_load_dwordx4 v30, s[56:59], s70 offen offset:2048 lds
    buffer_load_dwordx4 v31, s[56:59], s70 offen offset:3072 lds
    s_mov_b32 m0, 114944
    s_nop 0
    buffer_load_dwordx4 v48, s[44:47], s78 offen lds
    s_waitcnt vmcnt(55)
    buffer_load_dwordx4 v49, s[44:47], s78 offen offset:1024 lds
    s_mov_b32 m0, 82176
    s_nop 0
    buffer_load_dwordx4 v32, s[48:51], s70 offen lds
    buffer_load_dwordx4 v33, s[48:51], s70 offen offset:1024 lds
    buffer_load_dwordx4 v34, s[48:51], s70 offen offset:2048 lds
    buffer_load_dwordx4 v35, s[48:51], s70 offen offset:3072 lds
    s_mov_b32 m0, 90368
    s_nop 0
    buffer_load_dwordx4 v32, s[52:55], s70 offen lds
    buffer_load_dwordx4 v33, s[52:55], s70 offen offset:1024 lds
    buffer_load_dwordx4 v34, s[52:55], s70 offen offset:2048 lds
    s_waitcnt vmcnt(55)
    buffer_load_dwordx4 v35, s[52:55], s70 offen offset:3072 lds
    s_mov_b32 m0, 98560
    s_nop 0
    buffer_load_dwordx4 v32, s[56:59], s70 offen lds
    buffer_load_dwordx4 v33, s[56:59], s70 offen offset:1024 lds
    buffer_load_dwordx4 v34, s[56:59], s70 offen offset:2048 lds
    buffer_load_dwordx4 v35, s[56:59], s70 offen offset:3072 lds
    s_waitcnt vmcnt(38) lgkmcnt(0)
    s_barrier
    s_lshr_b64 s[80:81], s[80:81], 4
    s_and_b32 s79, s80, 15
    s_add_u32 s79, s79, s43
    s_sub_u32 s38, s79, 10
    s_cmp_ge_u32 s79, 10
    s_cselect_b32 s79, s38, s79
    s_mul_i32 s71, s79, 245760
    s_lshl_b32 s78, s79, 7
    s_mov_b32 m0, 141696
    s_nop 0
    buffer_load_dwordx4 v36, s[44:47], s78 offen lds
    buffer_load_dwordx4 v37, s[44:47], s78 offen offset:1024 lds
    buffer_load_dwordx4 v38, s[44:47], s78 offen offset:2048 lds
    buffer_load_dwordx4 v39, s[44:47], s78 offen offset:3072 lds
    s_mov_b32 m0, 117120
    s_nop 0
    buffer_load_dwordx4 v28, s[48:51], s71 offen lds
    buffer_load_dwordx4 v29, s[48:51], s71 offen offset:1024 lds
    buffer_load_dwordx4 v30, s[48:51], s71 offen offset:2048 lds
    buffer_load_dwordx4 v31, s[48:51], s71 offen offset:3072 lds
    s_mov_b32 m0, 145792
    s_nop 0
    buffer_load_dwordx4 v40, s[44:47], s78 offen lds
    buffer_load_dwordx4 v41, s[44:47], s78 offen offset:1024 lds
    buffer_load_dwordx4 v42, s[44:47], s78 offen offset:2048 lds
    buffer_load_dwordx4 v43, s[44:47], s78 offen offset:3072 lds
    s_mov_b32 m0, 125312
    s_nop 0
    buffer_load_dwordx4 v28, s[52:55], s71 offen lds
    buffer_load_dwordx4 v29, s[52:55], s71 offen offset:1024 lds
    buffer_load_dwordx4 v30, s[52:55], s71 offen offset:2048 lds
    buffer_load_dwordx4 v31, s[52:55], s71 offen offset:3072 lds
    s_mov_b32 m0, 149888
    s_nop 0
    buffer_load_dwordx4 v44, s[44:47], s78 offen lds
    buffer_load_dwordx4 v45, s[44:47], s78 offen offset:1024 lds
    buffer_load_dwordx4 v46, s[44:47], s78 offen offset:2048 lds
    buffer_load_dwordx4 v47, s[44:47], s78 offen offset:3072 lds
    s_mov_b32 m0, 133504
    s_nop 0
    buffer_load_dwordx4 v28, s[56:59], s71 offen lds
    buffer_load_dwordx4 v29, s[56:59], s71 offen offset:1024 lds
    buffer_load_dwordx4 v30, s[56:59], s71 offen offset:2048 lds
    buffer_load_dwordx4 v31, s[56:59], s71 offen offset:3072 lds
    s_mov_b32 m0, 153984
    s_nop 0
    buffer_load_dwordx4 v48, s[44:47], s78 offen lds
    s_waitcnt vmcnt(55)
    buffer_load_dwordx4 v49, s[44:47], s78 offen offset:1024 lds
    s_mov_b32 m0, 121216
    s_nop 0
    buffer_load_dwordx4 v32, s[48:51], s71 offen lds
    buffer_load_dwordx4 v33, s[48:51], s71 offen offset:1024 lds
    buffer_load_dwordx4 v34, s[48:51], s71 offen offset:2048 lds
    buffer_load_dwordx4 v35, s[48:51], s71 offen offset:3072 lds
    s_mov_b32 m0, 129408
    s_nop 0
    buffer_load_dwordx4 v32, s[52:55], s71 offen lds
    buffer_load_dwordx4 v33, s[52:55], s71 offen offset:1024 lds
    buffer_load_dwordx4 v34, s[52:55], s71 offen offset:2048 lds
    s_waitcnt vmcnt(55)
    buffer_load_dwordx4 v35, s[52:55], s71 offen offset:3072 lds
    s_mov_b32 m0, 137600
    s_nop 0
    buffer_load_dwordx4 v32, s[56:59], s71 offen lds
    buffer_load_dwordx4 v33, s[56:59], s71 offen offset:1024 lds
    buffer_load_dwordx4 v34, s[56:59], s71 offen offset:2048 lds
    buffer_load_dwordx4 v35, s[56:59], s71 offen offset:3072 lds
    s_waitcnt vmcnt(38) lgkmcnt(0)
    s_barrier
    s_lshr_b64 s[80:81], s[80:81], 4
    s_and_b32 s79, s80, 15
    s_add_u32 s79, s79, s43
    s_sub_u32 s38, s79, 10
    s_cmp_ge_u32 s79, 10
    s_cselect_b32 s79, s38, s79
    s_mul_i32 s72, s79, 245760
    s_lshl_b32 s78, s79, 7
    s_mov_b32 m0, 24576
    s_nop 0
    buffer_load_dwordx4 v36, s[44:47], s78 offen lds
    buffer_load_dwordx4 v37, s[44:47], s78 offen offset:1024 lds
    buffer_load_dwordx4 v38, s[44:47], s78 offen offset:2048 lds
    buffer_load_dwordx4 v39, s[44:47], s78 offen offset:3072 lds
    s_mov_b32 m0, 0
    s_nop 0
    buffer_load_dwordx4 v28, s[48:51], s72 offen lds
    buffer_load_dwordx4 v29, s[48:51], s72 offen offset:1024 lds
    buffer_load_dwordx4 v30, s[48:51], s72 offen offset:2048 lds
    buffer_load_dwordx4 v31, s[48:51], s72 offen offset:3072 lds
    s_mov_b32 m0, 28672
    s_nop 0
    buffer_load_dwordx4 v40, s[44:47], s78 offen lds
    buffer_load_dwordx4 v41, s[44:47], s78 offen offset:1024 lds
    buffer_load_dwordx4 v42, s[44:47], s78 offen offset:2048 lds
    buffer_load_dwordx4 v43, s[44:47], s78 offen offset:3072 lds
    s_mov_b32 m0, 8192
    s_nop 0
    buffer_load_dwordx4 v28, s[52:55], s72 offen lds
    buffer_load_dwordx4 v29, s[52:55], s72 offen offset:1024 lds
    buffer_load_dwordx4 v30, s[52:55], s72 offen offset:2048 lds
    buffer_load_dwordx4 v31, s[52:55], s72 offen offset:3072 lds
    s_mov_b32 m0, 32768
    s_nop 0
    buffer_load_dwordx4 v44, s[44:47], s78 offen lds
    buffer_load_dwordx4 v45, s[44:47], s78 offen offset:1024 lds
    buffer_load_dwordx4 v46, s[44:47], s78 offen offset:2048 lds
    buffer_load_dwordx4 v47, s[44:47], s78 offen offset:3072 lds
    s_mov_b32 m0, 16384
    s_nop 0
    buffer_load_dwordx4 v28, s[56:59], s72 offen lds
    buffer_load_dwordx4 v29, s[56:59], s72 offen offset:1024 lds
    buffer_load_dwordx4 v30, s[56:59], s72 offen offset:2048 lds
    buffer_load_dwordx4 v31, s[56:59], s72 offen offset:3072 lds
    s_mov_b32 m0, 36864
    s_nop 0
    buffer_load_dwordx4 v48, s[44:47], s78 offen lds
    s_waitcnt vmcnt(55)
    buffer_load_dwordx4 v49, s[44:47], s78 offen offset:1024 lds
    s_mov_b32 m0, 4096
    s_nop 0
    buffer_load_dwordx4 v32, s[48:51], s72 offen lds
    buffer_load_dwordx4 v33, s[48:51], s72 offen offset:1024 lds
    buffer_load_dwordx4 v34, s[48:51], s72 offen offset:2048 lds
    buffer_load_dwordx4 v35, s[48:51], s72 offen offset:3072 lds
    s_mov_b32 m0, 12288
    s_nop 0
    buffer_load_dwordx4 v32, s[52:55], s72 offen lds
    buffer_load_dwordx4 v33, s[52:55], s72 offen offset:1024 lds
    buffer_load_dwordx4 v34, s[52:55], s72 offen offset:2048 lds
    s_waitcnt vmcnt(55)
    buffer_load_dwordx4 v35, s[52:55], s72 offen offset:3072 lds
    s_mov_b32 m0, 20480
    s_nop 0
    buffer_load_dwordx4 v32, s[56:59], s72 offen lds
    buffer_load_dwordx4 v33, s[56:59], s72 offen offset:1024 lds
    buffer_load_dwordx4 v34, s[56:59], s72 offen offset:2048 lds
    buffer_load_dwordx4 v35, s[56:59], s72 offen offset:3072 lds
    s_waitcnt vmcnt(38) lgkmcnt(0)
    s_barrier
    s_lshr_b64 s[80:81], s[80:81], 4
    s_and_b32 s79, s80, 15
    s_add_u32 s79, s79, s43
    s_sub_u32 s38, s79, 10
    s_cmp_ge_u32 s79, 10
    s_cselect_b32 s79, s38, s79
    s_mul_i32 s73, s79, 245760
    s_lshl_b32 s78, s79, 7
    s_mov_b32 m0, 63616
    s_nop 0
    buffer_load_dwordx4 v36, s[44:47], s78 offen lds
    buffer_load_dwordx4 v37, s[44:47], s78 offen offset:1024 lds
    buffer_load_dwordx4 v38, s[44:47], s78 offen offset:2048 lds
    buffer_load_dwordx4 v39, s[44:47], s78 offen offset:3072 lds
    s_mov_b32 m0, 39040
    s_nop 0
    buffer_load_dwordx4 v28, s[48:51], s73 offen lds
    buffer_load_dwordx4 v29, s[48:51], s73 offen offset:1024 lds
    buffer_load_dwordx4 v30, s[48:51], s73 offen offset:2048 lds
    buffer_load_dwordx4 v31, s[48:51], s73 offen offset:3072 lds
    s_mov_b32 m0, 67712
    s_nop 0
    buffer_load_dwordx4 v40, s[44:47], s78 offen lds
    buffer_load_dwordx4 v41, s[44:47], s78 offen offset:1024 lds
    buffer_load_dwordx4 v42, s[44:47], s78 offen offset:2048 lds
    buffer_load_dwordx4 v43, s[44:47], s78 offen offset:3072 lds
    s_mov_b32 m0, 47232
    s_nop 0
    buffer_load_dwordx4 v28, s[52:55], s73 offen lds
    buffer_load_dwordx4 v29, s[52:55], s73 offen offset:1024 lds
    buffer_load_dwordx4 v30, s[52:55], s73 offen offset:2048 lds
    buffer_load_dwordx4 v31, s[52:55], s73 offen offset:3072 lds
    s_mov_b32 m0, 71808
    s_nop 0
    buffer_load_dwordx4 v44, s[44:47], s78 offen lds
    buffer_load_dwordx4 v45, s[44:47], s78 offen offset:1024 lds
    buffer_load_dwordx4 v46, s[44:47], s78 offen offset:2048 lds
    buffer_load_dwordx4 v47, s[44:47], s78 offen offset:3072 lds
    s_mov_b32 m0, 55424
    s_nop 0
    buffer_load_dwordx4 v28, s[56:59], s73 offen lds
    buffer_load_dwordx4 v29, s[56:59], s73 offen offset:1024 lds
    buffer_load_dwordx4 v30, s[56:59], s73 offen offset:2048 lds
    buffer_load_dwordx4 v31, s[56:59], s73 offen offset:3072 lds
    s_mov_b32 m0, 75904
    s_nop 0
    buffer_load_dwordx4 v48, s[44:47], s78 offen lds
    s_waitcnt vmcnt(55)
    buffer_load_dwordx4 v49, s[44:47], s78 offen offset:1024 lds
    s_mov_b32 m0, 43136
    s_nop 0
    buffer_load_dwordx4 v32, s[48:51], s73 offen lds
    buffer_load_dwordx4 v33, s[48:51], s73 offen offset:1024 lds
    buffer_load_dwordx4 v34, s[48:51], s73 offen offset:2048 lds
    buffer_load_dwordx4 v35, s[48:51], s73 offen offset:3072 lds
    s_mov_b32 m0, 51328
    s_nop 0
    buffer_load_dwordx4 v32, s[52:55], s73 offen lds
    buffer_load_dwordx4 v33, s[52:55], s73 offen offset:1024 lds
    buffer_load_dwordx4 v34, s[52:55], s73 offen offset:2048 lds
    s_waitcnt vmcnt(55)
    buffer_load_dwordx4 v35, s[52:55], s73 offen offset:3072 lds
    s_mov_b32 m0, 59520
    s_nop 0
    buffer_load_dwordx4 v32, s[56:59], s73 offen lds
    buffer_load_dwordx4 v33, s[56:59], s73 offen offset:1024 lds
    buffer_load_dwordx4 v34, s[56:59], s73 offen offset:2048 lds
    buffer_load_dwordx4 v35, s[56:59], s73 offen offset:3072 lds
    s_waitcnt vmcnt(38) lgkmcnt(0)
    s_barrier
    s_lshr_b64 s[80:81], s[80:81], 4
    s_and_b32 s79, s80, 15
    s_add_u32 s79, s79, s43
    s_sub_u32 s38, s79, 10
    s_cmp_ge_u32 s79, 10
    s_cselect_b32 s79, s38, s79
    s_mul_i32 s74, s79, 245760
    s_lshl_b32 s78, s79, 7
    s_mov_b32 m0, 102656
    s_nop 0
    buffer_load_dwordx4 v36, s[44:47], s78 offen lds
    buffer_load_dwordx4 v37, s[44:47], s78 offen offset:1024 lds
    buffer_load_dwordx4 v38, s[44:47], s78 offen offset:2048 lds
    buffer_load_dwordx4 v39, s[44:47], s78 offen offset:3072 lds
    s_mov_b32 m0, 78080
    s_nop 0
    buffer_load_dwordx4 v28, s[48:51], s74 offen lds
    buffer_load_dwordx4 v29, s[48:51], s74 offen offset:1024 lds
    buffer_load_dwordx4 v30, s[48:51], s74 offen offset:2048 lds
    buffer_load_dwordx4 v31, s[48:51], s74 offen offset:3072 lds
    s_mov_b32 m0, 106752
    s_nop 0
    buffer_load_dwordx4 v40, s[44:47], s78 offen lds
    buffer_load_dwordx4 v41, s[44:47], s78 offen offset:1024 lds
    buffer_load_dwordx4 v42, s[44:47], s78 offen offset:2048 lds
    buffer_load_dwordx4 v43, s[44:47], s78 offen offset:3072 lds
    s_mov_b32 m0, 86272
    s_nop 0
    buffer_load_dwordx4 v28, s[52:55], s74 offen lds
    buffer_load_dwordx4 v29, s[52:55], s74 offen offset:1024 lds
    buffer_load_dwordx4 v30, s[52:55], s74 offen offset:2048 lds
    buffer_load_dwordx4 v31, s[52:55], s74 offen offset:3072 lds
    s_mov_b32 m0, 110848
    s_nop 0
    buffer_load_dwordx4 v44, s[44:47], s78 offen lds
    buffer_load_dwordx4 v45, s[44:47], s78 offen offset:1024 lds
    buffer_load_dwordx4 v46, s[44:47], s78 offen offset:2048 lds
    buffer_load_dwordx4 v47, s[44:47], s78 offen offset:3072 lds
    s_mov_b32 m0, 82176
    s_nop 0
    buffer_load_dwordx4 v32, s[48:51], s74 offen lds
    buffer_load_dwordx4 v33, s[48:51], s74 offen offset:1024 lds
    buffer_load_dwordx4 v34, s[48:51], s74 offen offset:2048 lds
    buffer_load_dwordx4 v35, s[48:51], s74 offen offset:3072 lds
    s_mov_b32 m0, 114944
    s_nop 0
    buffer_load_dwordx4 v48, s[44:47], s78 offen lds
    s_waitcnt vmcnt(55)
    buffer_load_dwordx4 v49, s[44:47], s78 offen offset:1024 lds
    s_mov_b32 m0, 90368
    s_nop 0
    buffer_load_dwordx4 v32, s[52:55], s74 offen lds
    buffer_load_dwordx4 v33, s[52:55], s74 offen offset:1024 lds
    buffer_load_dwordx4 v34, s[52:55], s74 offen offset:2048 lds
    buffer_load_dwordx4 v35, s[52:55], s74 offen offset:3072 lds
    s_waitcnt vmcnt(30) lgkmcnt(0)
    s_barrier
    s_lshr_b64 s[80:81], s[80:81], 4
    s_and_b32 s79, s80, 15
    s_add_u32 s79, s79, s43
    s_sub_u32 s38, s79, 10
    s_cmp_ge_u32 s79, 10
    s_cselect_b32 s79, s38, s79
    s_mul_i32 s75, s79, 245760
    s_lshl_b32 s78, s79, 7
    s_mov_b32 m0, 141696
    s_nop 0
    buffer_load_dwordx4 v36, s[44:47], s78 offen lds
    buffer_load_dwordx4 v37, s[44:47], s78 offen offset:1024 lds
    buffer_load_dwordx4 v38, s[44:47], s78 offen offset:2048 lds
    buffer_load_dwordx4 v39, s[44:47], s78 offen offset:3072 lds
    s_mov_b32 m0, 117120
    s_nop 0
    buffer_load_dwordx4 v28, s[48:51], s75 offen lds
    buffer_load_dwordx4 v29, s[48:51], s75 offen offset:1024 lds
    buffer_load_dwordx4 v30, s[48:51], s75 offen offset:2048 lds
    buffer_load_dwordx4 v31, s[48:51], s75 offen offset:3072 lds
    s_mov_b32 m0, 145792
    s_nop 0
    buffer_load_dwordx4 v40, s[44:47], s78 offen lds
    buffer_load_dwordx4 v41, s[44:47], s78 offen offset:1024 lds
    buffer_load_dwordx4 v42, s[44:47], s78 offen offset:2048 lds
    buffer_load_dwordx4 v43, s[44:47], s78 offen offset:3072 lds
    s_mov_b32 m0, 125312
    s_nop 0
    buffer_load_dwordx4 v28, s[52:55], s75 offen lds
    buffer_load_dwordx4 v29, s[52:55], s75 offen offset:1024 lds
    buffer_load_dwordx4 v30, s[52:55], s75 offen offset:2048 lds
    buffer_load_dwordx4 v31, s[52:55], s75 offen offset:3072 lds
    s_mov_b32 m0, 149888
    s_nop 0
    buffer_load_dwordx4 v44, s[44:47], s78 offen lds
    buffer_load_dwordx4 v45, s[44:47], s78 offen offset:1024 lds
    buffer_load_dwordx4 v46, s[44:47], s78 offen offset:2048 lds
    buffer_load_dwordx4 v47, s[44:47], s78 offen offset:3072 lds
    s_mov_b32 m0, 121216
    s_nop 0
    buffer_load_dwordx4 v32, s[48:51], s75 offen lds
    buffer_load_dwordx4 v33, s[48:51], s75 offen offset:1024 lds
    buffer_load_dwordx4 v34, s[48:51], s75 offen offset:2048 lds
    buffer_load_dwordx4 v35, s[48:51], s75 offen offset:3072 lds
    s_mov_b32 m0, 153984
    s_nop 0
    buffer_load_dwordx4 v48, s[44:47], s78 offen lds
    buffer_load_dwordx4 v49, s[44:47], s78 offen offset:1024 lds
    s_mov_b32 m0, 129408
    s_nop 0
    buffer_load_dwordx4 v32, s[52:55], s75 offen lds
    buffer_load_dwordx4 v33, s[52:55], s75 offen offset:1024 lds
    buffer_load_dwordx4 v34, s[52:55], s75 offen offset:2048 lds
    buffer_load_dwordx4 v35, s[52:55], s75 offen offset:3072 lds
    s_waitcnt vmcnt(30) lgkmcnt(0)
    s_barrier
    s_lshr_b64 s[80:81], s[80:81], 4
    s_and_b32 s79, s80, 15
    s_add_u32 s79, s79, s43
    s_sub_u32 s38, s79, 10
    s_cmp_ge_u32 s79, 10
    s_cselect_b32 s79, s38, s79
    s_mul_i32 s76, s79, 245760
    s_lshl_b32 s78, s79, 7
    s_mov_b32 m0, 24576
    s_nop 0
    buffer_load_dwordx4 v36, s[44:47], s78 offen lds
    buffer_load_dwordx4 v37, s[44:47], s78 offen offset:1024 lds
    buffer_load_dwordx4 v38, s[44:47], s78 offen offset:2048 lds
    buffer_load_dwordx4 v39, s[44:47], s78 offen offset:3072 lds
    s_mov_b32 m0, 0
    s_nop 0
    buffer_load_dwordx4 v28, s[48:51], s76 offen lds
    buffer_load_dwordx4 v29, s[48:51], s76 offen offset:1024 lds
    buffer_load_dwordx4 v30, s[48:51], s76 offen offset:2048 lds
    buffer_load_dwordx4 v31, s[48:51], s76 offen offset:3072 lds
    s_mov_b32 m0, 28672
    s_nop 0
    buffer_load_dwordx4 v40, s[44:47], s78 offen lds
    buffer_load_dwordx4 v41, s[44:47], s78 offen offset:1024 lds
    buffer_load_dwordx4 v42, s[44:47], s78 offen offset:2048 lds
    buffer_load_dwordx4 v43, s[44:47], s78 offen offset:3072 lds
    s_mov_b32 m0, 8192
    s_nop 0
    buffer_load_dwordx4 v28, s[52:55], s76 offen lds
    buffer_load_dwordx4 v29, s[52:55], s76 offen offset:1024 lds
    buffer_load_dwordx4 v30, s[52:55], s76 offen offset:2048 lds
    buffer_load_dwordx4 v31, s[52:55], s76 offen offset:3072 lds
    s_mov_b32 m0, 32768
    s_nop 0
    buffer_load_dwordx4 v44, s[44:47], s78 offen lds
    buffer_load_dwordx4 v45, s[44:47], s78 offen offset:1024 lds
    buffer_load_dwordx4 v46, s[44:47], s78 offen offset:2048 lds
    buffer_load_dwordx4 v47, s[44:47], s78 offen offset:3072 lds
    s_mov_b32 m0, 4096
    s_nop 0
    buffer_load_dwordx4 v32, s[48:51], s76 offen lds
    buffer_load_dwordx4 v33, s[48:51], s76 offen offset:1024 lds
    buffer_load_dwordx4 v34, s[48:51], s76 offen offset:2048 lds
    buffer_load_dwordx4 v35, s[48:51], s76 offen offset:3072 lds
    s_mov_b32 m0, 36864
    s_nop 0
    buffer_load_dwordx4 v48, s[44:47], s78 offen lds
    buffer_load_dwordx4 v49, s[44:47], s78 offen offset:1024 lds
    s_mov_b32 m0, 12288
    s_nop 0
    buffer_load_dwordx4 v32, s[52:55], s76 offen lds
    buffer_load_dwordx4 v33, s[52:55], s76 offen offset:1024 lds
    buffer_load_dwordx4 v34, s[52:55], s76 offen offset:2048 lds
    buffer_load_dwordx4 v35, s[52:55], s76 offen offset:3072 lds
    s_waitcnt vmcnt(30) lgkmcnt(0)
    s_barrier
    s_lshr_b64 s[80:81], s[80:81], 4
    s_and_b32 s79, s80, 15
    s_add_u32 s79, s79, s43
    s_sub_u32 s38, s79, 10
    s_cmp_ge_u32 s79, 10
    s_cselect_b32 s79, s38, s79
    s_mul_i32 s77, s79, 245760
    s_lshl_b32 s78, s79, 7
    s_mov_b32 m0, 63616
    s_nop 0
    buffer_load_dwordx4 v36, s[44:47], s78 offen lds
    buffer_load_dwordx4 v37, s[44:47], s78 offen offset:1024 lds
    buffer_load_dwordx4 v38, s[44:47], s78 offen offset:2048 lds
    buffer_load_dwordx4 v39, s[44:47], s78 offen offset:3072 lds
    s_mov_b32 m0, 39040
    s_nop 0
    buffer_load_dwordx4 v28, s[48:51], s77 offen lds
    buffer_load_dwordx4 v29, s[48:51], s77 offen offset:1024 lds
    buffer_load_dwordx4 v30, s[48:51], s77 offen offset:2048 lds
    buffer_load_dwordx4 v31, s[48:51], s77 offen offset:3072 lds
    s_mov_b32 m0, 67712
    s_nop 0
    buffer_load_dwordx4 v40, s[44:47], s78 offen lds
    buffer_load_dwordx4 v41, s[44:47], s78 offen offset:1024 lds
    buffer_load_dwordx4 v42, s[44:47], s78 offen offset:2048 lds
    buffer_load_dwordx4 v43, s[44:47], s78 offen offset:3072 lds
    s_mov_b32 m0, 47232
    s_nop 0
    buffer_load_dwordx4 v28, s[52:55], s77 offen lds
    buffer_load_dwordx4 v29, s[52:55], s77 offen offset:1024 lds
    buffer_load_dwordx4 v30, s[52:55], s77 offen offset:2048 lds
    buffer_load_dwordx4 v31, s[52:55], s77 offen offset:3072 lds
    s_mov_b32 m0, 71808
    s_nop 0
    buffer_load_dwordx4 v44, s[44:47], s78 offen lds
    buffer_load_dwordx4 v45, s[44:47], s78 offen offset:1024 lds
    buffer_load_dwordx4 v46, s[44:47], s78 offen offset:2048 lds
    buffer_load_dwordx4 v47, s[44:47], s78 offen offset:3072 lds
    s_mov_b32 m0, 43136
    s_nop 0
    buffer_load_dwordx4 v32, s[48:51], s77 offen lds
    buffer_load_dwordx4 v33, s[48:51], s77 offen offset:1024 lds
    buffer_load_dwordx4 v34, s[48:51], s77 offen offset:2048 lds
    buffer_load_dwordx4 v35, s[48:51], s77 offen offset:3072 lds
    s_mov_b32 m0, 75904
    s_nop 0
    buffer_load_dwordx4 v48, s[44:47], s78 offen lds
    buffer_load_dwordx4 v49, s[44:47], s78 offen offset:1024 lds
    s_mov_b32 m0, 51328
    s_nop 0
    buffer_load_dwordx4 v32, s[52:55], s77 offen lds
    buffer_load_dwordx4 v33, s[52:55], s77 offen offset:1024 lds
    buffer_load_dwordx4 v34, s[52:55], s77 offen offset:2048 lds
    buffer_load_dwordx4 v35, s[52:55], s77 offen offset:3072 lds
    s_waitcnt vmcnt(30) lgkmcnt(0)
    s_barrier
    s_lshr_b64 s[80:81], s[80:81], 4
    s_and_b32 s79, s80, 15
    s_add_u32 s79, s79, s43
    s_sub_u32 s38, s79, 10
    s_cmp_ge_u32 s79, 10
    s_cselect_b32 s79, s38, s79
    s_mov_b32 m0, 94464
    s_nop 0
    buffer_load_dwordx4 v28, s[56:59], s74 offen lds
    buffer_load_dwordx4 v29, s[56:59], s74 offen offset:1024 lds
    buffer_load_dwordx4 v30, s[56:59], s74 offen offset:2048 lds
    buffer_load_dwordx4 v31, s[56:59], s74 offen offset:3072 lds
    s_mov_b32 m0, 98560
    s_nop 0
    buffer_load_dwordx4 v32, s[56:59], s74 offen lds
    buffer_load_dwordx4 v33, s[56:59], s74 offen offset:1024 lds
    buffer_load_dwordx4 v34, s[56:59], s74 offen offset:2048 lds
    buffer_load_dwordx4 v35, s[56:59], s74 offen offset:3072 lds
    s_mov_b32 m0, 133504
    s_nop 0
    buffer_load_dwordx4 v28, s[56:59], s75 offen lds
    buffer_load_dwordx4 v29, s[56:59], s75 offen offset:1024 lds
    buffer_load_dwordx4 v30, s[56:59], s75 offen offset:2048 lds
    buffer_load_dwordx4 v31, s[56:59], s75 offen offset:3072 lds
    s_waitcnt vmcnt(12) lgkmcnt(0)
    s_barrier
    s_setprio 3
    s_mov_b32 m0, 137600
    s_nop 0
    buffer_load_dwordx4 v32, s[56:59], s75 offen lds
    buffer_load_dwordx4 v33, s[56:59], s75 offen offset:1024 lds
    buffer_load_dwordx4 v34, s[56:59], s75 offen offset:2048 lds
    buffer_load_dwordx4 v35, s[56:59], s75 offen offset:3072 lds
    s_mov_b32 m0, 16384
    s_nop 0
    buffer_load_dwordx4 v28, s[56:59], s76 offen lds
    buffer_load_dwordx4 v29, s[56:59], s76 offen offset:1024 lds
    buffer_load_dwordx4 v30, s[56:59], s76 offen offset:2048 lds
    buffer_load_dwordx4 v31, s[56:59], s76 offen offset:3072 lds
    s_mov_b32 m0, 20480
    s_nop 0
    buffer_load_dwordx4 v32, s[56:59], s76 offen lds
    buffer_load_dwordx4 v33, s[56:59], s76 offen offset:1024 lds
    buffer_load_dwordx4 v34, s[56:59], s76 offen offset:2048 lds
    buffer_load_dwordx4 v35, s[56:59], s76 offen offset:3072 lds
    s_mov_b32 m0, 55424
    s_nop 0
    buffer_load_dwordx4 v28, s[56:59], s77 offen lds
    buffer_load_dwordx4 v29, s[56:59], s77 offen offset:1024 lds
    buffer_load_dwordx4 v30, s[56:59], s77 offen offset:2048 lds
    buffer_load_dwordx4 v31, s[56:59], s77 offen offset:3072 lds
    s_mov_b32 m0, 59520
    s_nop 0
    buffer_load_dwordx4 v32, s[56:59], s77 offen lds
    buffer_load_dwordx4 v33, s[56:59], s77 offen offset:1024 lds
    buffer_load_dwordx4 v34, s[56:59], s77 offen offset:2048 lds
    buffer_load_dwordx4 v35, s[56:59], s77 offen offset:3072 lds
    s_mov_b32 s10, 20480
    v_lshrrev_b32 v52, 5, v1
    v_lshlrev_b32 v52, 3, v52
    v_add_u32 v56, 8, v52
    v_mul_u32_u24 v52, 3, v52
    v_add_u32 v53, 2, v52
    v_add_u32 v54, 4, v52
    v_add_u32 v55, 6, v52
    v_add_u32 v57, 2, v56
    v_add_u32 v58, 4, v56
    v_add_u32 v59, 6, v56
    v_and_b32 v7, 3, v5
    v_mul_u32_u24 v7, 1280, v7
    v_add_u32 v60, v7, v50
    v_xor_b32 v61, 64, v60
    v_add_u32 v61, 4096, v61
    v_add_u32 v62, 8192, v60
    v_add_u32 v63, 8192, v61
    s_mov_b32 s42, 0
    s_mov_b32 s5, 0xbfe10856
    s_mov_b32 s6, 0xaff80255
    s_mov_b32 s7, 0xabfe4015
    s_mov_b32 s8, 0xaa7fd005
    s_mov_b32 s9, 0x6adfb401
    s_cmp_eq_u32 s42, 1
    s_cselect_b32 s5, 0xabfe4015, s5
    s_cselect_b32 s6, 0xaa7fd005, s6
    s_cselect_b32 s7, 0x6adfb401, s7
    s_cselect_b32 s8, 0xbfe10856, s8
    s_cselect_b32 s9, 0xaff80255, s9
    s_cmp_eq_u32 s42, 2
    s_cselect_b32 s5, 0x6adfb401, s5
    s_cselect_b32 s6, 0xbfe10856, s6
    s_cselect_b32 s7, 0xaff80255, s7
    s_cselect_b32 s8, 0xabfe4015, s8
    s_cselect_b32 s9, 0xaa7fd005, s9
    s_cmp_eq_u32 s42, 3
    s_cselect_b32 s5, 0xaff80255, s5
    s_cselect_b32 s6, 0xabfe4015, s6
    s_cselect_b32 s7, 0xaa7fd005, s7
    s_cselect_b32 s8, 0x6adfb401, s8
    s_cselect_b32 s9, 0xbfe10856, s9
    s_cmp_eq_u32 s42, 4
    s_cselect_b32 s5, 0xaa7fd005, s5
    s_cselect_b32 s6, 0x6adfb401, s6
    s_cselect_b32 s7, 0xbfe10856, s7
    s_cselect_b32 s8, 0xaff80255, s8
    s_cselect_b32 s9, 0xabfe4015, s9
    s_mul_i32 s4, s42, 163840
    s_mov_b32 m0, 0
    s_mov_b32 s4, 0
    v_bfe_u32 v64, s5, v52, 2
    v_mad_u32_u24 v64, v64, s10, v60
    buffer_load_dwordx4 v64, s[60:63], s4 offen lds
    v_bfe_u32 v65, s5, v53, 2
    v_mad_u32_u24 v65, v65, s10, v61
    buffer_load_dwordx4 v65, s[60:63], s4 offen offset:1024 lds
    v_bfe_u32 v64, s5, v54, 2
    v_mad_u32_u24 v64, v64, s10, v62
    buffer_load_dwordx4 v64, s[60:63], s4 offen offset:2048 lds
    v_bfe_u32 v65, s5, v55, 2
    v_mad_u32_u24 v65, v65, s10, v63
    buffer_load_dwordx4 v65, s[60:63], s4 offen offset:3072 lds
    s_mov_b32 m0, 4096
    s_mov_b32 s4, 81920
    v_bfe_u32 v64, s6, v52, 2
    v_mad_u32_u24 v64, v64, s10, v60
    buffer_load_dwordx4 v64, s[60:63], s4 offen lds
    v_bfe_u32 v65, s6, v53, 2
    v_mad_u32_u24 v65, v65, s10, v61
    buffer_load_dwordx4 v65, s[60:63], s4 offen offset:1024 lds
    v_bfe_u32 v64, s6, v54, 2
    v_mad_u32_u24 v64, v64, s10, v62
    buffer_load_dwordx4 v64, s[60:63], s4 offen offset:2048 lds
    v_bfe_u32 v65, s6, v55, 2
    v_mad_u32_u24 v65, v65, s10, v63
    buffer_load_dwordx4 v65, s[60:63], s4 offen offset:3072 lds
    s_mov_b32 m0, 8192
    s_mov_b32 s4, 163840
    v_bfe_u32 v64, s7, v52, 2
    v_mad_u32_u24 v64, v64, s10, v60
    buffer_load_dwordx4 v64, s[60:63], s4 offen lds
    v_bfe_u32 v65, s7, v53, 2
    v_mad_u32_u24 v65, v65, s10, v61
    buffer_load_dwordx4 v65, s[60:63], s4 offen offset:1024 lds
    v_bfe_u32 v64, s7, v54, 2
    v_mad_u32_u24 v64, v64, s10, v62
    buffer_load_dwordx4 v64, s[60:63], s4 offen offset:2048 lds
    v_bfe_u32 v65, s7, v55, 2
    v_mad_u32_u24 v65, v65, s10, v63
    buffer_load_dwordx4 v65, s[60:63], s4 offen offset:3072 lds
    s_mov_b32 m0, 12288
    s_mov_b32 s4, 245760
    v_bfe_u32 v64, s8, v52, 2
    v_mad_u32_u24 v64, v64, s10, v60
    buffer_load_dwordx4 v64, s[60:63], s4 offen lds
    v_bfe_u32 v65, s8, v53, 2
    v_mad_u32_u24 v65, v65, s10, v61
    buffer_load_dwordx4 v65, s[60:63], s4 offen offset:1024 lds
    v_bfe_u32 v64, s8, v54, 2
    v_mad_u32_u24 v64, v64, s10, v62
    buffer_load_dwordx4 v64, s[60:63], s4 offen offset:2048 lds
    v_bfe_u32 v65, s8, v55, 2
    v_mad_u32_u24 v65, v65, s10, v63
    buffer_load_dwordx4 v65, s[60:63], s4 offen offset:3072 lds
    s_waitcnt vmcnt(16)
    v_mov_b32 v5, 157980
    v_mov_b32 v6, 1
    s_mov_b64 exec, 1
    ds_add_u32 v5, v6
    s_mov_b64 exec, -1
    v_mov_b32 v5, 157972
    v_mov_b32 v6, 1
    s_mov_b64 exec, 1
    ds_add_u32 v5, v6
    s_mov_b64 exec, -1
    s_mov_b32 m0, 24576
    s_mov_b32 s4, 327680
    v_bfe_u32 v64, s9, v52, 2
    v_mad_u32_u24 v64, v64, s10, v60
    buffer_load_dwordx4 v64, s[60:63], s4 offen lds
    v_bfe_u32 v65, s9, v53, 2
    v_mad_u32_u24 v65, v65, s10, v61
    buffer_load_dwordx4 v65, s[60:63], s4 offen offset:1024 lds
    v_bfe_u32 v64, s9, v54, 2
    v_mad_u32_u24 v64, v64, s10, v62
    buffer_load_dwordx4 v64, s[60:63], s4 offen offset:2048 lds
    v_bfe_u32 v65, s9, v55, 2
    v_mad_u32_u24 v65, v65, s10, v63
    buffer_load_dwordx4 v65, s[60:63], s4 offen offset:3072 lds
    s_mov_b32 m0, 28672
    s_mov_b32 s4, 409600
    v_bfe_u32 v64, s5, v52, 2
    v_mad_u32_u24 v64, v64, s10, v60
    buffer_load_dwordx4 v64, s[60:63], s4 offen lds
    v_bfe_u32 v65, s5, v53, 2
    v_mad_u32_u24 v65, v65, s10, v61
    buffer_load_dwordx4 v65, s[60:63], s4 offen offset:1024 lds
    v_bfe_u32 v64, s5, v54, 2
    v_mad_u32_u24 v64, v64, s10, v62
    buffer_load_dwordx4 v64, s[60:63], s4 offen offset:2048 lds
    v_bfe_u32 v65, s5, v55, 2
    v_mad_u32_u24 v65, v65, s10, v63
    buffer_load_dwordx4 v65, s[60:63], s4 offen offset:3072 lds
    s_mov_b32 m0, 123136
    s_mov_b32 s4, 491520
    v_bfe_u32 v64, s6, v52, 2
    v_mad_u32_u24 v64, v64, s10, v60
    buffer_load_dwordx4 v64, s[60:63], s4 offen lds
    v_bfe_u32 v65, s6, v53, 2
    v_mad_u32_u24 v65, v65, s10, v61
    buffer_load_dwordx4 v65, s[60:63], s4 offen offset:1024 lds
    v_bfe_u32 v64, s6, v54, 2
    v_mad_u32_u24 v64, v64, s10, v62
    buffer_load_dwordx4 v64, s[60:63], s4 offen offset:2048 lds
    v_bfe_u32 v65, s6, v55, 2
    v_mad_u32_u24 v65, v65, s10, v63
    buffer_load_dwordx4 v65, s[60:63], s4 offen offset:3072 lds
    s_mov_b32 m0, 127232
    s_mov_b32 s4, 573440
    v_bfe_u32 v64, s7, v52, 2
    v_mad_u32_u24 v64, v64, s10, v60
    buffer_load_dwordx4 v64, s[60:63], s4 offen lds
    v_bfe_u32 v65, s7, v53, 2
    v_mad_u32_u24 v65, v65, s10, v61
    buffer_load_dwordx4 v65, s[60:63], s4 offen offset:1024 lds
    v_bfe_u32 v64, s7, v54, 2
    v_mad_u32_u24 v64, v64, s10, v62
    buffer_load_dwordx4 v64, s[60:63], s4 offen offset:2048 lds
    v_bfe_u32 v65, s7, v55, 2
    v_mad_u32_u24 v65, v65, s10, v63
    buffer_load_dwordx4 v65, s[60:63], s4 offen offset:3072 lds
    s_mov_b32 m0, 80000
    s_mov_b32 s4, 655360
    v_bfe_u32 v64, s8, v52, 2
    v_mad_u32_u24 v64, v64, s10, v60
    buffer_load_dwordx4 v64, s[60:63], s4 offen lds
    v_bfe_u32 v65, s8, v53, 2
    v_mad_u32_u24 v65, v65, s10, v61
    buffer_load_dwordx4 v65, s[60:63], s4 offen offset:1024 lds
    v_bfe_u32 v64, s8, v54, 2
    v_mad_u32_u24 v64, v64, s10, v62
    buffer_load_dwordx4 v64, s[60:63], s4 offen offset:2048 lds
    v_bfe_u32 v65, s8, v55, 2
    v_mad_u32_u24 v65, v65, s10, v63
    buffer_load_dwordx4 v65, s[60:63], s4 offen offset:3072 lds
    s_mov_b32 m0, 84096
    s_mov_b32 s4, 737280
    v_bfe_u32 v64, s9, v52, 2
    v_mad_u32_u24 v64, v64, s10, v60
    buffer_load_dwordx4 v64, s[60:63], s4 offen lds
    v_bfe_u32 v65, s9, v53, 2
    v_mad_u32_u24 v65, v65, s10, v61
    buffer_load_dwordx4 v65, s[60:63], s4 offen offset:1024 lds
    v_bfe_u32 v64, s9, v54, 2
    v_mad_u32_u24 v64, v64, s10, v62
    buffer_load_dwordx4 v64, s[60:63], s4 offen offset:2048 lds
    v_bfe_u32 v65, s9, v55, 2
    v_mad_u32_u24 v65, v65, s10, v63
    buffer_load_dwordx4 v65, s[60:63], s4 offen offset:3072 lds
    s_waitcnt vmcnt(0)
    v_mov_b32 v7, 157980
    v_mov_b32 v6, 1
    s_mov_b64 exec, 1
    ds_add_u32 v7, v6
    s_mov_b64 exec, -1
Lcw_7:
    s_sub_u32 s35, s35, 1
    s_cbranch_scc1 Lend
    s_sleep 2
    ds_read_b32 v6, v5
    s_waitcnt lgkmcnt(0)
    v_readfirstlane_b32 s38, v6
    s_nop 0
    s_cmp_lt_u32 s38, 8
    s_cbranch_scc1 Lcw_7
    s_lshl_b32 s36, s32, 7
    s_add_u32 s36, s36, 8257536
    v_mov_b32 v69, s36
    buffer_load_dwordx4 v[70:73], v69, s[28:31], 0 offen sc1
    s_mov_b32 m0, 32768
    s_mov_b32 s4, 0
    v_bfe_u32 v64, s5, v56, 2
    v_mad_u32_u24 v64, v64, s10, v60
    buffer_load_dwordx4 v64, s[60:63], s4 offen lds
    v_bfe_u32 v65, s5, v57, 2
    v_mad_u32_u24 v65, v65, s10, v61
    buffer_load_dwordx4 v65, s[60:63], s4 offen offset:1024 lds
    v_bfe_u32 v64, s5, v58, 2
    v_mad_u32_u24 v64, v64, s10, v62
    buffer_load_dwordx4 v64, s[60:63], s4 offen offset:2048 lds
    v_bfe_u32 v65, s5, v59, 2
    v_mad_u32_u24 v65, v65, s10, v63
    buffer_load_dwordx4 v65, s[60:63], s4 offen offset:3072 lds
    s_mov_b32 m0, 36864
    s_mov_b32 s4, 81920
    v_bfe_u32 v64, s6, v56, 2
    v_mad_u32_u24 v64, v64, s10, v60
    buffer_load_dwordx4 v64, s[60:63], s4 offen lds
    v_bfe_u32 v65, s6, v57, 2
    v_mad_u32_u24 v65, v65, s10, v61
    buffer_load_dwordx4 v65, s[60:63], s4 offen offset:1024 lds
    v_bfe_u32 v64, s6, v58, 2
    v_mad_u32_u24 v64, v64, s10, v62
    buffer_load_dwordx4 v64, s[60:63], s4 offen offset:2048 lds
    v_bfe_u32 v65, s6, v59, 2
    v_mad_u32_u24 v65, v65, s10, v63
    buffer_load_dwordx4 v65, s[60:63], s4 offen offset:3072 lds
    s_mov_b32 m0, 40960
    s_mov_b32 s4, 163840
    v_bfe_u32 v64, s7, v56, 2
    v_mad_u32_u24 v64, v64, s10, v60
    buffer_load_dwordx4 v64, s[60:63], s4 offen lds
    v_bfe_u32 v65, s7, v57, 2
    v_mad_u32_u24 v65, v65, s10, v61
    buffer_load_dwordx4 v65, s[60:63], s4 offen offset:1024 lds
    v_bfe_u32 v64, s7, v58, 2
    v_mad_u32_u24 v64, v64, s10, v62
    buffer_load_dwordx4 v64, s[60:63], s4 offen offset:2048 lds
    v_bfe_u32 v65, s7, v59, 2
    v_mad_u32_u24 v65, v65, s10, v63
    buffer_load_dwordx4 v65, s[60:63], s4 offen offset:3072 lds
    s_mov_b32 m0, 45056
    s_mov_b32 s4, 245760
    v_bfe_u32 v64, s8, v56, 2
    v_mad_u32_u24 v64, v64, s10, v60
    buffer_load_dwordx4 v64, s[60:63], s4 offen lds
    v_bfe_u32 v65, s8, v57, 2
    v_mad_u32_u24 v65, v65, s10, v61
    buffer_load_dwordx4 v65, s[60:63], s4 offen offset:1024 lds
    v_bfe_u32 v64, s8, v58, 2
    v_mad_u32_u24 v64, v64, s10, v62
    buffer_load_dwordx4 v64, s[60:63], s4 offen offset:2048 lds
    v_bfe_u32 v65, s8, v59, 2
    v_mad_u32_u24 v65, v65, s10, v63
    buffer_load_dwordx4 v65, s[60:63], s4 offen offset:3072 lds
    s_mov_b32 m0, 63616
    s_mov_b32 s4, 327680
    v_bfe_u32 v64, s9, v56, 2
    v_mad_u32_u24 v64, v64, s10, v60
    buffer_load_dwordx4 v64, s[60:63], s4 offen lds
    v_bfe_u32 v65, s9, v57, 2
    v_mad_u32_u24 v65, v65, s10, v61
    buffer_load_dwordx4 v65, s[60:63], s4 offen offset:1024 lds
    v_bfe_u32 v64, s9, v58, 2
    v_mad_u32_u24 v64, v64, s10, v62
    buffer_load_dwordx4 v64, s[60:63], s4 offen offset:2048 lds
    v_bfe_u32 v65, s9, v59, 2
    v_mad_u32_u24 v65, v65, s10, v63
    buffer_load_dwordx4 v65, s[60:63], s4 offen offset:3072 lds
    s_mov_b32 m0, 67712
    s_mov_b32 s4, 409600
    v_bfe_u32 v64, s5, v56, 2
    v_mad_u32_u24 v64, v64, s10, v60
    buffer_load_dwordx4 v64, s[60:63], s4 offen lds
    v_bfe_u32 v65, s5, v57, 2
    v_mad_u32_u24 v65, v65, s10, v61
    buffer_load_dwordx4 v65, s[60:63], s4 offen offset:1024 lds
    v_bfe_u32 v64, s5, v58, 2
    v_mad_u32_u24 v64, v64, s10, v62
    buffer_load_dwordx4 v64, s[60:63], s4 offen offset:2048 lds
    v_bfe_u32 v65, s5, v59, 2
    v_mad_u32_u24 v65, v65, s10, v63
    buffer_load_dwordx4 v65, s[60:63], s4 offen offset:3072 lds
    s_mov_b32 m0, 71808
    s_mov_b32 s4, 491520
    v_bfe_u32 v64, s6, v56, 2
    v_mad_u32_u24 v64, v64, s10, v60
    buffer_load_dwordx4 v64, s[60:63], s4 offen lds
    v_bfe_u32 v65, s6, v57, 2
    v_mad_u32_u24 v65, v65, s10, v61
    buffer_load_dwordx4 v65, s[60:63], s4 offen offset:1024 lds
    v_bfe_u32 v64, s6, v58, 2
    v_mad_u32_u24 v64, v64, s10, v62
    buffer_load_dwordx4 v64, s[60:63], s4 offen offset:2048 lds
    v_bfe_u32 v65, s6, v59, 2
    v_mad_u32_u24 v65, v65, s10, v63
    buffer_load_dwordx4 v65, s[60:63], s4 offen offset:3072 lds
    s_mov_b32 m0, 75904
    s_mov_b32 s4, 573440
    v_bfe_u32 v64, s7, v56, 2
    v_mad_u32_u24 v64, v64, s10, v60
    buffer_load_dwordx4 v64, s[60:63], s4 offen lds
    v_bfe_u32 v65, s7, v57, 2
    v_mad_u32_u24 v65, v65, s10, v61
    buffer_load_dwordx4 v65, s[60:63], s4 offen offset:1024 lds
    v_bfe_u32 v64, s7, v58, 2
    v_mad_u32_u24 v64, v64, s10, v62
    buffer_load_dwordx4 v64, s[60:63], s4 offen offset:2048 lds
    v_bfe_u32 v65, s7, v59, 2
    v_mad_u32_u24 v65, v65, s10, v63
    buffer_load_dwordx4 v65, s[60:63], s4 offen offset:3072 lds
    s_mov_b32 m0, 49152
    s_mov_b32 s4, 655360
    v_bfe_u32 v64, s8, v56, 2
    v_mad_u32_u24 v64, v64, s10, v60
    buffer_load_dwordx4 v64, s[60:63], s4 offen lds
    v_bfe_u32 v65, s8, v57, 2
    v_mad_u32_u24 v65, v65, s10, v61
    buffer_load_dwordx4 v65, s[60:63], s4 offen offset:1024 lds
    v_bfe_u32 v64, s8, v58, 2
    v_mad_u32_u24 v64, v64, s10, v62
    buffer_load_dwordx4 v64, s[60:63], s4 offen offset:2048 lds
    v_bfe_u32 v65, s8, v59, 2
    v_mad_u32_u24 v65, v65, s10, v63
    buffer_load_dwordx4 v65, s[60:63], s4 offen offset:3072 lds
    s_mov_b32 m0, 88192
    s_mov_b32 s4, 737280
    v_bfe_u32 v64, s9, v56, 2
    v_mad_u32_u24 v64, v64, s10, v60
    buffer_load_dwordx4 v64, s[60:63], s4 offen lds
    v_bfe_u32 v65, s9, v57, 2
    v_mad_u32_u24 v65, v65, s10, v61
    buffer_load_dwordx4 v65, s[60:63], s4 offen offset:1024 lds
    v_bfe_u32 v64, s9, v58, 2
    v_mad_u32_u24 v64, v64, s10, v62
    buffer_load_dwordx4 v64, s[60:63], s4 offen offset:2048 lds
    v_bfe_u32 v65, s9, v59, 2
    v_mad_u32_u24 v65, v65, s10, v63
    buffer_load_dwordx4 v65, s[60:63], s4 offen offset:3072 lds
    s_waitcnt vmcnt(0)
Lbc:
    v_readfirstlane_b32 s11, v70
    v_readfirstlane_b32 s36, v71
    v_readfirstlane_b32 s12, v72
    v_readfirstlane_b32 s37, v73
    s_cmp_eq_u32 s36, s34
    s_cselect_b32 s37, s37, s36
    s_cmp_eq_u32 s37, s34
    s_cbranch_scc1 Lbc_ok
Lbc_re:
    s_sub_u32 s35, s35, 1
    s_cbranch_scc1 Lend
    buffer_load_dwordx4 v[70:73], v69, s[28:31], 0 offen sc1
    s_waitcnt vmcnt(0)
    s_branch Lbc
Lbc_ok:
    s_mul_i32 s36, s32, 96
    s_and_b32 s13, s11, 0x7ff
    s_sub_u32 s13, 2047, s13
    s_sub_u32 s37, s13, s36
    s_cmp_lt_u32 s37, 96
    s_cselect_b32 s13, s13, -1
    s_and_b32 s14, s12, 0x7ff
    s_sub_u32 s14, 2047, s14
    s_sub_u32 s37, s14, s36
    s_cmp_lt_u32 s37, 96
    s_cselect_b32 s14, s14, -1
    v_mov_b32 v4, s13
    v_mov_b32 v5, s14
    v_mov_b32 v6, 157960
    s_cmp_lg_u32 s3, 0
    s_cbranch_scc1 Lag2
    ds_write_b64 v6, v[4:5]
    s_branch Lw0_done
Lag2:
    s_and_b32 s37, s13, s14
    s_cmp_eq_u32 s37, -1
    s_cbranch_scc1 Lw0_done
    s_max_i32 s36, s13, 0
    s_mul_i32 s36, s36, 1280
    s_lshl_b32 s37, s33, 7
    s_add_u32 s36, s36, s37
    s_add_u32 s36, s36, 4096
    v_lshlrev_b32 v8, 1, v1
    buffer_load_ushort v124, v8, s[44:47], s36 offen
    s_max_i32 s36, s14, 0
    s_mul_i32 s36, s36, 1280
    s_lshl_b32 s37, s33, 7
    s_add_u32 s36, s36, s37
    s_add_u32 s36, s36, 4096
    v_lshlrev_b32 v8, 1, v1
    buffer_load_ushort v125, v8, s[44:47], s36 offen
    v_min_u32 v7, 26, v1
    v_mul_u32_u24 v7, 10240, v7
Ly_poll:
    s_sub_u32 s35, s35, 1
    s_cbranch_scc1 Lend
    s_sleep 4
    s_lshl_b32 s36, s33, 10
    s_add_u32 s36, s36, 7405568
    buffer_load_dword v4, v7, s[28:31], s36 offen offset:1020 sc1
    s_waitcnt vmcnt(0)
    v_cmp_ne_u32 vcc, s34, v4
    s_nop 0
    s_cbranch_vccnz Ly_poll
    buffer_load_dwordx4 v[16:19], v13, s[28:31], s36 offen sc1
    s_add_u32 s36, s36, 10240
    buffer_load_dwordx4 v[20:23], v13, s[28:31], s36 offen sc1
    s_add_u32 s36, s36, 10240
    buffer_load_dwordx4 v[24:27], v13, s[28:31], s36 offen sc1
    s_add_u32 s36, s36, 10240
    buffer_load_dwordx4 v[28:31], v13, s[28:31], s36 offen sc1
    s_add_u32 s36, s36, 10240
    buffer_load_dwordx4 v[32:35], v13, s[28:31], s36 offen sc1
    s_add_u32 s36, s36, 10240
    buffer_load_dwordx4 v[36:39], v13, s[28:31], s36 offen sc1
    s_add_u32 s36, s36, 10240
    buffer_load_dwordx4 v[40:43], v13, s[28:31], s36 offen sc1
    s_add_u32 s36, s36, 10240
    buffer_load_dwordx4 v[44:47], v13, s[28:31], s36 offen sc1
    s_add_u32 s36, s36, 10240
    buffer_load_dwordx4 v[48:51], v13, s[28:31], s36 offen sc1
    s_add_u32 s36, s36, 10240
    buffer_load_dwordx4 v[52:55], v13, s[28:31], s36 offen sc1
    s_add_u32 s36, s36, 10240
    buffer_load_dwordx4 v[56:59], v13, s[28:31], s36 offen sc1
    s_add_u32 s36, s36, 10240
    buffer_load_dwordx4 v[60:63], v13, s[28:31], s36 offen sc1
    s_add_u32 s36, s36, 10240
    buffer_load_dwordx4 v[64:67], v13, s[28:31], s36 offen sc1
    s_add_u32 s36, s36, 10240
    buffer_load_dwordx4 v[68:71], v13, s[28:31], s36 offen sc1
    s_add_u32 s36, s36, 10240
    buffer_load_dwordx4 v[72:75], v13, s[28:31], s36 offen sc1
    s_add_u32 s36, s36, 10240
    buffer_load_dwordx4 v[76:79], v13, s[28:31], s36 offen sc1
    s_add_u32 s36, s36, 10240
    buffer_load_dwordx4 v[80:83], v13, s[28:31], s36 offen sc1
    s_add_u32 s36, s36, 10240
    buffer_load_dwordx4 v[84:87], v13, s[28:31], s36 offen sc1
    s_add_u32 s36, s36, 10240
    buffer_load_dwordx4 v[88:91], v13, s[28:31], s36 offen sc1
    s_add_u32 s36, s36, 10240
    buffer_load_dwordx4 v[92:95], v13, s[28:31], s36 offen sc1
    s_add_u32 s36, s36, 10240
    buffer_load_dwordx4 v[96:99], v13, s[28:31], s36 offen sc1
    s_add_u32 s36, s36, 10240
    buffer_load_dwordx4 v[100:103], v13, s[28:31], s36 offen sc1
    s_add_u32 s36, s36, 10240
    buffer_load_dwordx4 v[104:107], v13, s[28:31], s36 offen sc1
    s_add_u32 s36, s36, 10240
    buffer_load_dwordx4 v[108:111], v13, s[28:31], s36 offen sc1
    s_add_u32 s36, s36, 10240
    buffer_load_dwordx4 v[112:115], v13, s[28:31], s36 offen sc1
    s_add_u32 s36, s36, 10240
    buffer_load_dwordx4 v[116:119], v13, s[28:31], s36 offen sc1
    s_add_u32 s36, s36, 10240
    buffer_load_dwordx4 v[120:123], v13, s[28:31], s36 offen sc1
    s_add_u32 s36, s36, 10240
    s_waitcnt vmcnt(0)
    v_xor_b32 v4, s34, v17
    v_xor_b32 v5, s34, v19
    v_or_b32 v4, v4, v5
    v_xor_b32 v5, s34, v21
    v_or_b32 v4, v4, v5
    v_xor_b32 v5, s34, v23
    v_or_b32 v4, v4, v5
    v_xor_b32 v5, s34, v25
    v_or_b32 v4, v4, v5
    v_xor_b32 v5, s34, v27
    v_or_b32 v4, v4, v5
    v_xor_b32 v5, s34, v29
    v_or_b32 v4, v4, v5
    v_xor_b32 v5, s34, v31
    v_or_b32 v4, v4, v5
    v_xor_b32 v5, s34, v33
    v_or_b32 v4, v4, v5
    v_xor_b32 v5, s34, v35
    v_or_b32 v4, v4, v5
    v_xor_b32 v5, s34, v37
    v_or_b32 v4, v4, v5
    v_xor_b32 v5, s34, v39
    v_or_b32 v4, v4, v5
    v_xor_b32 v5, s34, v41
    v_or_b32 v4, v4, v5
    v_xor_b32 v5, s34, v43
    v_or_b32 v4, v4, v5
    v_xor_b32 v5, s34, v45
    v_or_b32 v4, v4, v5
    v_xor_b32 v5, s34, v47
    v_or_b32 v4, v4, v5
    v_xor_b32 v5, s34, v49
    v_or_b32 v4, v4, v5
    v_xor_b32 v5, s34, v51
    v_or_b32 v4, v4, v5
    v_xor_b32 v5, s34, v53
    v_or_b32 v4, v4, v5
    v_xor_b32 v5, s34, v55
    v_or_b32 v4, v4, v5
    v_xor_b32 v5, s34, v57
    v_or_b32 v4, v4, v5
    v_xor_b32 v5, s34, v59
    v_or_b32 v4, v4, v5
    v_xor_b32 v5, s34, v61
    v_or_b32 v4, v4, v5
    v_xor_b32 v5, s34, v63
    v_or_b32 v4, v4, v5
    v_xor_b32 v5, s34, v65
    v_or_b32 v4, v4, v5
    v_xor_b32 v5, s34, v67
    v_or_b32 v4, v4, v5
    v_xor_b32 v5, s34, v69
    v_or_b32 v4, v4, v5
    v_xor_b32 v5, s34, v71
    v_or_b32 v4, v4, v5
    v_xor_b32 v5, s34, v73
    v_or_b32 v4, v4, v5
    v_xor_b32 v5, s34, v75
    v_or_b32 v4, v4, v5
    v_xor_b32 v5, s34, v77
    v_or_b32 v4, v4, v5
    v_xor_b32 v5, s34, v79
    v_or_b32 v4, v4, v5
    v_xor_b32 v5, s34, v81
    v_or_b32 v4, v4, v5
    v_xor_b32 v5, s34, v83
    v_or_b32 v4, v4, v5
    v_xor_b32 v5, s34, v85
    v_or_b32 v4, v4, v5
    v_xor_b32 v5, s34, v87
    v_or_b32 v4, v4, v5
    v_xor_b32 v5, s34, v89
    v_or_b32 v4, v4, v5
    v_xor_b32 v5, s34, v91
    v_or_b32 v4, v4, v5
    v_xor_b32 v5, s34, v93
    v_or_b32 v4, v4, v5
    v_xor_b32 v5, s34, v95
    v_or_b32 v4, v4, v5
    v_xor_b32 v5, s34, v97
    v_or_b32 v4, v4, v5
    v_xor_b32 v5, s34, v99
    v_or_b32 v4, v4, v5
    v_xor_b32 v5, s34, v101
    v_or_b32 v4, v4, v5
    v_xor_b32 v5, s34, v103
    v_or_b32 v4, v4, v5
    v_xor_b32 v5, s34, v105
    v_or_b32 v4, v4, v5
    v_xor_b32 v5, s34, v107
    v_or_b32 v4, v4, v5
    v_xor_b32 v5, s34, v109
    v_or_b32 v4, v4, v5
    v_xor_b32 v5, s34, v111
    v_or_b32 v4, v4, v5
    v_xor_b32 v5, s34, v113
    v_or_b32 v4, v4, v5
    v_xor_b32 v5, s34, v115
    v_or_b32 v4, v4, v5
    v_xor_b32 v5, s34, v117
    v_or_b32 v4, v4, v5
    v_xor_b32 v5, s34, v119
    v_or_b32 v4, v4, v5
    v_xor_b32 v5, s34, v121
    v_or_b32 v4, v4, v5
    v_xor_b32 v5, s34, v123
    v_or_b32 v4, v4, v5
    v_cmp_ne_u32 vcc, 0, v4
    s_nop 0
    s_cmp_lg_u64 vcc, 0
    s_cbranch_scc1 Ly_poll
    v_add_f32 v16, v16, v20
    v_add_f32 v18, v18, v22
    v_add_f32 v16, v16, v24
    v_add_f32 v18, v18, v26
    v_add_f32 v16, v16, v28
    v_add_f32 v18, v18, v30
    v_add_f32 v16, v16, v32
    v_add_f32 v18, v18, v34
    v_add_f32 v16, v16, v36
    v_add_f32 v18, v18, v38
    v_add_f32 v16, v16, v40
    v_add_f32 v18, v18, v42
    v_add_f32 v16, v16, v44
    v_add_f32 v18, v18, v46
    v_add_f32 v16, v16, v48
    v_add_f32 v18, v18, v50
    v_add_f32 v16, v16, v52
    v_add_f32 v18, v18, v54
    v_add_f32 v16, v16, v56
    v_add_f32 v18, v18, v58
    v_add_f32 v16, v16, v60
    v_add_f32 v18, v18, v62
    v_add_f32 v16, v16, v64
    v_add_f32 v18, v18, v66
    v_add_f32 v16, v16, v68
    v_add_f32 v18, v18, v70
    v_add_f32 v16, v16, v72
    v_add_f32 v18, v18, v74
    v_add_f32 v16, v16, v76
    v_add_f32 v18, v18, v78
    v_add_f32 v16, v16, v80
    v_add_f32 v18, v18, v82
    v_add_f32 v16, v16, v84
    v_add_f32 v18, v18, v86
    v_add_f32 v16, v16, v88
    v_add_f32 v18, v18, v90
    v_add_f32 v16, v16, v92
    v_add_f32 v18, v18, v94
    v_add_f32 v16, v16, v96
    v_add_f32 v18, v18, v98
    v_add_f32 v16, v16, v100
    v_add_f32 v18, v18, v102
    v_add_f32 v16, v16, v104
    v_add_f32 v18, v18, v106
    v_add_f32 v16, v16, v108
    v_add_f32 v18, v18, v110
    v_add_f32 v16, v16, v112
    v_add_f32 v18, v18, v114
    v_add_f32 v16, v16, v116
    v_add_f32 v18, v18, v118
    v_add_f32 v16, v16, v120
    v_add_f32 v18, v18, v122
    s_lshr_b32 s36, s11, 16
    s_cmp_ge_u32 s36, 0x8000
    s_cselect_b32 s37, 0x8000, -1
    s_xor_b32 s36, s36, s37
    s_lshl_b32 s36, s36, 16
    v_mov_b32 v4, s36
    v_mul_f32 v4, 0xbfb8aa3b, v4
    v_exp_f32 v4, v4
    s_nop 0
    v_add_f32 v4, 1.0, v4
    v_rcp_f32 v4, v4
    s_nop 0
    v_cvt_pk_bf16_f32 v4, v4, v4
    v_lshlrev_b32 v4, 16, v4
    v_cvt_pk_bf16_f32 v16, v16, v16
    v_lshlrev_b32 v16, 16, v16
    v_mul_f32 v16, v16, v4
    v_cvt_pk_bf16_f32 v16, v16, v16
    v_lshlrev_b32 v16, 16, v16
    s_lshr_b32 s36, s12, 16
    s_cmp_ge_u32 s36, 0x8000
    s_cselect_b32 s37, 0x8000, -1
    s_xor_b32 s36, s36, s37
    s_lshl_b32 s36, s36, 16
    v_mov_b32 v4, s36
    v_mul_f32 v4, 0xbfb8aa3b, v4
    v_exp_f32 v4, v4
    s_nop 0
    v_add_f32 v4, 1.0, v4
    v_rcp_f32 v4, v4
    s_nop 0
    v_cvt_pk_bf16_f32 v4, v4, v4
    v_lshlrev_b32 v4, 16, v4
    v_cvt_pk_bf16_f32 v18, v18, v18
    v_lshlrev_b32 v18, 16, v18
    v_mul_f32 v18, v18, v4
    v_cvt_pk_bf16_f32 v18, v18, v18
    v_lshlrev_b32 v18, 16, v18
    s_mul_i32 s36, s32, 96
    s_sub_u32 s36, s13, s36
    s_max_i32 s36, s36, 0
    s_lshl_b32 s36, s36, 2
    s_add_u32 s36, s36, 156288
    v_mov_b32 v4, s36
    ds_read2st64_b32 v[4:5], v4 offset0:0 offset1:2
    v_lshlrev_b32 v124, 16, v124
    s_waitcnt lgkmcnt(0)
    v_add_f32 v20, v124, v4
    v_cvt_pk_bf16_f32 v20, v20, v20
    v_lshlrev_b32 v20, 16, v20
    v_mul_f32 v20, v20, v5
    v_cvt_pk_bf16_f32 v20, v20, v20
    v_lshlrev_b32 v20, 16, v20
    v_add_f32 v20, v20, v16
    v_cvt_pk_bf16_f32 v20, v20, v20
    v_lshlrev_b32 v20, 16, v20
    v_mul_f32 v16, 0xbfb8aa3b, v20
    v_exp_f32 v16, v16
    s_nop 0
    v_add_f32 v16, 1.0, v16
    v_rcp_f32 v16, v16
    s_nop 0
    v_mul_f32 v16, v16, v20
    v_cvt_pk_bf16_f32 v16, v16, v16
    v_lshlrev_b32 v16, 16, v16
    s_mul_i32 s36, s32, 96
    s_sub_u32 s36, s14, s36
    s_max_i32 s36, s36, 0
    s_lshl_b32 s36, s36, 2
    s_add_u32 s36, s36, 156288
    v_mov_b32 v4, s36
    ds_read2st64_b32 v[4:5], v4 offset0:0 offset1:2
    v_lshlrev_b32 v125, 16, v125
    s_waitcnt lgkmcnt(0)
    v_add_f32 v22, v125, v4
    v_cvt_pk_bf16_f32 v22, v22, v22
    v_lshlrev_b32 v22, 16, v22
    v_mul_f32 v22, v22, v5
    v_cvt_pk_bf16_f32 v22, v22, v22
    v_lshlrev_b32 v22, 16, v22
    v_add_f32 v22, v22, v18
    v_cvt_pk_bf16_f32 v22, v22, v22
    v_lshlrev_b32 v22, 16, v22
    v_mul_f32 v18, 0xbfb8aa3b, v22
    v_exp_f32 v18, v18
    s_nop 0
    v_add_f32 v18, 1.0, v18
    v_rcp_f32 v18, v18
    s_nop 0
    v_mul_f32 v18, v18, v22
    v_cvt_pk_bf16_f32 v18, v18, v18
    v_lshlrev_b32 v18, 16, v18
    v_add_u32 v5, 158208, v12
    ds_write2st64_b32 v5, v16, v18 offset0:0 offset1:1
    v_mov_b32 v6, 157956
    v_mov_b32 v7, 1
    s_mov_b64 exec, 1
    ds_add_u32 v6, v7
    s_mov_b64 exec, -1
Lw0_done:
    s_endpgm
Lagent:
    s_sub_u32 s44, s4, 4096
    s_subb_u32 s45, s5, 0
    s_mov_b32 s46, 2625536
    s_mov_b32 s47, 0x20000
    s_lshl_b32 s36, s32, 7
    s_add_u32 s36, s36, 8257536
    v_mov_b32 v69, s36
    s_branch Lbc_re
Lcomp:
    s_lshl_b32 s44, s26, 1
    s_add_u32 s44, s44, s27
    s_sub_u32 s36, s33, 5
    s_cmp_ge_u32 s33, 5
    s_cselect_b32 s40, s36, s33
    s_mov_b32 s41, 0xbfe10856
    s_cmp_eq_u32 s40, 1
    s_cselect_b32 s41, 0xaff80255, s41
    s_cmp_eq_u32 s40, 2
    s_cselect_b32 s41, 0xabfe4015, s41
    s_cmp_eq_u32 s40, 3
    s_cselect_b32 s41, 0xaa7fd005, s41
    s_cmp_eq_u32 s40, 4
    s_cselect_b32 s41, 0x6adfb401, s41
    s_lshl_b32 s37, s27, 13
    s_cmp_eq_u32 s44, 1
    s_cselect_b32 s37, 0, s37
    v_bfe_u32 v7, v1, 2, 2
    v_and_b32 v8, 3, v1
    v_lshl_add_u32 v18, v2, 3, v7
    v_lshlrev_b32 v18, 7, v18
    v_lshlrev_b32 v19, 2, v1
    v_and_b32 v19, 0x60, v19
    v_lshlrev_b32 v10, 1, v8
    v_add_u32 v9, s37, v18
    v_add_u32 v11, 0, v10
    v_bfe_u32 v11, s41, v11, 2
    v_lshl_add_u32 v11, v11, 2, v8
    v_lshlrev_b32 v11, 3, v11
    v_xad_u32 v20, v11, v19, v9
    v_add_u32 v11, 8, v10
    v_bfe_u32 v11, s41, v11, 2
    v_lshl_add_u32 v11, v11, 2, v8
    v_lshlrev_b32 v11, 3, v11
    v_xad_u32 v21, v11, v19, v9
    v_add_u32 v11, 16, v10
    v_bfe_u32 v11, s41, v11, 2
    v_lshl_add_u32 v11, v11, 2, v8
    v_lshlrev_b32 v11, 3, v11
    v_xad_u32 v22, v11, v19, v9
    v_add_u32 v11, 24, v10
    v_bfe_u32 v11, s41, v11, 2
    v_lshl_add_u32 v11, v11, 2, v8
    v_lshlrev_b32 v11, 3, v11
    v_xad_u32 v23, v11, v19, v9
    v_add_u32 v24, 78080, v20
    v_add_u32 v25, 78080, v21
    v_add_u32 v26, 78080, v22
    v_add_u32 v27, 78080, v23
    v_lshrrev_b32 v10, 1, v3
    v_xor_b32 v9, v10, v2
    v_lshlrev_b32 v9, 4, v9
    v_lshl_add_u32 v9, v3, 7, v9
    s_lshl_b32 s36, s44, 11
    s_xor_b32 s38, s36, 2048
    s_add_u32 s36, s36, 22528
    s_add_u32 s38, s38, 22528
    v_add_u32 v76, s36, v9
    v_add_u32 v78, s38, v9
    s_mul_i32 s39, s26, 6144
    s_add_u32 s39, s39, 98560
    v_add_u32 v125, s39, v13
    s_lshl_b32 s45, s44, 11
    s_add_u32 s45, s45, 139648
    s_waitcnt lgkmcnt(0)
    s_mov_b64 s[28:29], s[24:25]
    s_mov_b32 s30, 268435456
    s_mov_b32 s31, 0x20000
    s_load_dword s34, s[28:29], 0
    s_cmp_eq_u32 s44, 1
    s_cbranch_scc1 Lhalo
    v_xor_b32 v77, 64, v76
    v_xor_b32 v79, 64, v78
    v_add_u32 v80, 78080, v76
    v_add_u32 v81, 78080, v77
    v_add_u32 v82, 78080, v78
    v_add_u32 v83, 78080, v79
    s_cmp_eq_u32 s27, 0
    s_cselect_b64 vcc, 0, -1
    s_sub_u32 s37, 16384, s37
    v_cndmask_b32 v84, v20, v22, vcc
    v_cndmask_b32 v85, v21, v23, vcc
    v_add_u32 v84, s37, v84
    v_add_u32 v85, s37, v85
    v_add_u32 v86, 78080, v84
    v_add_u32 v87, 78080, v85
    v_lshrrev_b32 v8, 1, v2
    v_xor_b32 v8, v8, v10
    v_lshlrev_b32 v8, 4, v8
    v_lshl_add_u32 v8, v3, 7, v8
    v_and_b32 v7, 1, v2
    v_lshl_add_u32 v124, v7, 3, v8
    s_mov_b32 s46, 0
    s_mov_b32 s38, 0x86542310
    s_mov_b32 s39, 0x97
    s_cmp_eq_u32 s42, 1
    s_cselect_b32 s38, 0x76453210, s38
    s_cselect_b32 s39, 0x98, s39
    s_cmp_eq_u32 s42, 2
    s_cselect_b32 s38, 0x67543120, s38
    s_cselect_b32 s39, 0x98, s39
    s_cmp_eq_u32 s42, 3
    s_cselect_b32 s38, 0x76534201, s38
    s_cselect_b32 s39, 0x89, s39
    s_cmp_eq_u32 s42, 4
    s_cselect_b32 s38, 0x75643201, s38
    s_cselect_b32 s39, 0x98, s39
    s_sub_u32 s42, s33, s43
    s_cselect_b32 s43, 10, 0
    s_add_u32 s42, s42, s43
    s_lshl_b32 s42, s42, 2
    s_lshr_b64 s[38:39], s[38:39], s42
    s_and_b32 s42, s38, 15
    s_and_b32 s38, s42, 3
    s_mul_i32 s38, s38, 39040
    s_add_u32 s38, s38, s36
    v_add_u32 v4, s38, v124
    v_xor_b32 v5, 32, v4
    v_xor_b32 v6, 64, v4
    v_xor_b32 v7, 0x60, v4
    s_mov_b64 s[48:49], s[20:21]
    s_mov_b32 s50, 2621440
    s_mov_b32 s51, 0x20000
    v_mov_b32 v14, 0x3f803f80
    v_mov_b32 v15, 0x3f803f80
    v_mov_b32 v16, 0x3f803f80
    v_mov_b32 v17, 0x3f803f80
    s_mov_b32 s4, 0xaae00455
    s_cmp_eq_u32 s40, 1
    s_cselect_b32 s4, 0xaaf80155, s4
    s_cmp_eq_u32 s40, 2
    s_cselect_b32 s4, 0xaafe4055, s4
    s_cmp_eq_u32 s40, 3
    s_cselect_b32 s4, 0xaabfd055, s4
    s_cmp_eq_u32 s40, 4
    s_cselect_b32 s4, 0xaaeff455, s4
    v_lshlrev_b32 v10, 1, v2
    v_add_u32 v10, 8, v10
    v_bfe_u32 v10, s4, v10, 2
    v_cmp_eq_u32 s[6:7], 0, v10
    v_cmp_eq_u32 s[8:9], 3, v10
    v_cmp_eq_u32 s[10:11], 1, v10
    v_lshlrev_b32 v10, 1, v2
    v_add_u32 v10, 16, v10
    v_bfe_u32 v10, s4, v10, 2
    v_cmp_eq_u32 s[12:13], 0, v10
    v_cmp_eq_u32 s[14:15], 3, v10
    v_cmp_eq_u32 s[16:17], 2, v10
    s_mov_b32 s4, 0xaaaaaaaa
    s_mov_b32 s5, 0xaaaaaaaa
    s_mov_b32 s18, 0xfff0ffff
    s_mov_b32 s19, 0xf000ff00
    s_mov_b32 s20, 0xffc0fffc
    s_mov_b32 s21, 0xc000fc00
    v_mov_b32 v8, 0xffff
    v_not_b32 v9, v8
    v_cndmask_b32 v8, v8, v9, s[4:5]
    v_cndmask_b32 v118, 0, v8, s[18:19]
    v_cndmask_b32 v119, 0, v8, s[20:21]
    v_xor_b32 v116, v118, v8
    v_xor_b32 v117, v119, v8
    s_cmp_eq_u32 s32, 0
    s_cselect_b32 s36, s44, 0
    s_cmp_eq_u32 s36, 2
    s_cselect_b32 s22, 0xff800000, 0
    s_mul_i32 s36, s32, 6
    s_add_u32 s36, s36, s44
    s_sub_u32 s36, s36, 2
    s_lshl_b32 s24, s36, 7
    s_add_u32 s24, s24, 7340032
    s_mul_i32 s52, s36, 20480
    s_add_u32 s52, s52, 4194304
    s_lshl_b32 s36, s33, 11
    s_add_u32 s23, s36, s52
    s_add_u32 s53, s52, s46
    s_add_u32 s46, s46, 4096
    s_cmp_eq_u32 s46, 20480
    s_cselect_b32 s46, 0, s46
    s_add_u32 s54, s52, s46
    s_add_u32 s46, s46, 4096
    s_cmp_eq_u32 s46, 20480
    s_cselect_b32 s46, 0, s46
    s_add_u32 s55, s52, s46
    s_add_u32 s46, s46, 4096
    s_cmp_eq_u32 s46, 20480
    s_cselect_b32 s46, 0, s46
    s_add_u32 s56, s52, s46
    s_add_u32 s46, s46, 4096
    s_cmp_eq_u32 s46, 20480
    s_cselect_b32 s46, 0, s46
    s_add_u32 s57, s52, s46
    s_add_u32 s46, s46, 4096
    s_cmp_eq_u32 s46, 20480
    s_cselect_b32 s46, 0, s46
    s_mul_i32 s36, s32, 10
    s_add_u32 s36, s36, s33
    s_mul_i32 s58, s36, 6144
    s_lshl_b32 s36, s44, 10
    s_add_u32 s58, s58, s36
    s_add_u32 s58, s58, 1046528
    s_sub_u32 s59, s58, 6144
    s_add_u32 s60, s58, 6144
    s_cmp_eq_u32 s40, 0
    s_cselect_b32 s61, 0, -1
    s_cmp_eq_u32 s40, 4
    s_cselect_b32 s62, 0, -1
    s_lshl_b32 s36, s33, 2
    v_mov_b32 v97, s36
    s_mov_b32 s25, 0x3ea52b5c
    s_lshl_b32 s36, s44, 6
    s_add_u32 s36, s36, 156160
    v_lshl_add_u32 v94, v3, 2, s36
    v_and_b32 v8, 1, v1
    v_lshl_add_u32 v8, v2, 2, v8
    v_lshl_add_u32 v8, v8, 2, s36
    v_subrev_u32 v9, 64, v8
    v_cndmask_b32 v92, v9, v8, s[18:19]
    v_cndmask_b32 v93, v9, v8, s[20:21]
    v_lshlrev_b32 v95, 4, v2
    s_lshl_b32 s36, s27, 8
    s_add_u32 s36, s36, 157184
    v_add_u32 v95, s36, v95
    v_mov_b32 v96, 157968
    s_lshl_b32 s36, s27, 11
    v_add_u32 v99, s36, v125
    v_mov_b32 v100, -1
    v_mov_b32 v101, -1
    v_mov_b32 v102, -1
    v_mov_b32 v103, -1
    v_mov_b32 v127, 157984
    s_lshl_b32 s36, s3, 2
    s_add_u32 s36, s36, 158016
    v_mov_b32 v10, s36
    v_xor_b32 v11, 16, v10
    v_cndmask_b32 v127, v127, v11, s[4:5]
    s_waitcnt vmcnt(0)
    s_waitcnt lgkmcnt(0)
    s_barrier
    ds_read_b128 a[96:99], v76 offset:0
    ds_read_b128 a[100:103], v78 offset:0
    ds_read_b64_tr_b16 a[64:65], v20 offset:0
    ds_read_b64_tr_b16 a[66:67], v20 offset:512
    ds_read_b64_tr_b16 a[68:69], v21 offset:0
    ds_read_b64_tr_b16 a[70:71], v21 offset:512
    ds_read_b64_tr_b16 a[72:73], v22 offset:0
    ds_read_b64_tr_b16 a[74:75], v22 offset:512
    ds_read_b64_tr_b16 a[76:77], v23 offset:0
    ds_read_b64_tr_b16 a[78:79], v23 offset:512
    ds_read_b64_tr_b16 a[112:113], v84 offset:0
    ds_read_b64_tr_b16 a[114:115], v84 offset:512
    ds_read_b64_tr_b16 a[116:117], v85 offset:0
    ds_read_b64_tr_b16 a[118:119], v85 offset:512
    s_add_u32 s34, s34, 0x9e3779b8
    s_or_b32 s34, s34, 1
    s_cmp_eq_u32 s42, 0
    s_cbranch_scc1 Lxe0
Lxe0_b:
    s_setprio 1
    s_waitcnt lgkmcnt(10)
    v_mfma_f32_16x16x32_bf16 v[28:31], a[64:67], a[96:99], 0
    ds_read_b128 a[104:107], v77 offset:0
    ds_read_b128 a[108:111], v79 offset:0
    v_mfma_f32_16x16x32_bf16 v[44:47], a[64:67], a[100:103], 0
    ds_read_b64_tr_b16 a[80:81], v20 offset:4096
    s_waitcnt lgkmcnt(11)
    v_mfma_f32_16x16x32_bf16 v[48:51], a[68:71], a[100:103], 0
    ds_read_b64_tr_b16 a[82:83], v20 offset:4608
    v_mfma_f32_16x16x32_bf16 v[32:35], a[68:71], a[96:99], 0
    ds_read_b64_tr_b16 a[84:85], v21 offset:4096
    s_waitcnt lgkmcnt(11)
    v_mfma_f32_16x16x32_bf16 v[36:39], a[72:75], a[96:99], 0
    ds_read_b64_tr_b16 a[86:87], v21 offset:4608
    ds_read_b64_tr_b16 a[88:89], v22 offset:4096
    v_mfma_f32_16x16x32_bf16 v[52:55], a[72:75], a[100:103], 0
    ds_read_b64_tr_b16 a[90:91], v22 offset:4608
    s_setprio 0
    s_waitcnt lgkmcnt(12)
    v_mfma_f32_16x16x32_bf16 v[56:59], a[76:79], a[100:103], 0
    ds_read_b64_tr_b16 a[92:93], v23 offset:4096
    v_mfma_f32_16x16x32_bf16 v[40:43], a[76:79], a[96:99], 0
    ds_read_b64_tr_b16 a[94:95], v23 offset:4608
    s_waitcnt lgkmcnt(12)
    v_mfma_f32_16x16x32_bf16 v[60:63], a[96:99], a[112:115], 0
    ds_read_b64_tr_b16 a[120:121], v84 offset:4096
    v_mfma_f32_16x16x32_bf16 v[68:71], a[100:103], a[112:115], 0
    ds_read_b64_tr_b16 a[122:123], v84 offset:4608
    s_waitcnt lgkmcnt(12)
    v_mfma_f32_16x16x32_bf16 v[72:75], a[100:103], a[116:119], 0
    ds_read_b64_tr_b16 a[124:125], v85 offset:4096
    v_mfma_f32_16x16x32_bf16 v[64:67], a[96:99], a[116:119], 0
    ds_read_b64_tr_b16 a[126:127], v85 offset:4608
    s_barrier
    s_setprio 3
    s_waitcnt lgkmcnt(10)
    v_mfma_f32_16x16x32_bf16 v[28:31], a[80:83], a[104:107], v[28:31]
    ds_read_b128 a[96:99], v76 offset:39040
    ds_read_b128 a[100:103], v78 offset:39040
    v_mfma_f32_16x16x32_bf16 v[44:47], a[80:83], a[108:111], v[44:47]
    ds_read_b64_tr_b16 a[64:65], v20 offset:39040
    s_waitcnt lgkmcnt(11)
    v_mfma_f32_16x16x32_bf16 v[48:51], a[84:87], a[108:111], v[48:51]
    ds_read_b64_tr_b16 a[66:67], v20 offset:39552
    v_mfma_f32_16x16x32_bf16 v[32:35], a[84:87], a[104:107], v[32:35]
    ds_read_b64_tr_b16 a[68:69], v21 offset:39040
    s_waitcnt lgkmcnt(11)
    v_mfma_f32_16x16x32_bf16 v[36:39], a[88:91], a[104:107], v[36:39]
    ds_read_b64_tr_b16 a[70:71], v21 offset:39552
    v_mfma_f32_16x16x32_bf16 v[52:55], a[88:91], a[108:111], v[52:55]
    ds_read_b64_tr_b16 a[72:73], v22 offset:39040
    s_setprio 2
    s_waitcnt lgkmcnt(11)
    v_mfma_f32_16x16x32_bf16 v[56:59], a[92:95], a[108:111], v[56:59]
    ds_read_b64_tr_b16 a[74:75], v22 offset:39552
    ds_read_b64_tr_b16 a[76:77], v23 offset:39040
    v_mfma_f32_16x16x32_bf16 v[40:43], a[92:95], a[104:107], v[40:43]
    ds_read_b64_tr_b16 a[78:79], v23 offset:39552
    s_waitcnt lgkmcnt(12)
    v_mfma_f32_16x16x32_bf16 v[60:63], a[104:107], a[120:123], v[60:63]
    ds_read_b64_tr_b16 a[112:113], v84 offset:39040
    v_mfma_f32_16x16x32_bf16 v[68:71], a[108:111], a[120:123], v[68:71]
    ds_read_b64_tr_b16 a[114:115], v84 offset:39552
    s_waitcnt lgkmcnt(12)
    v_mfma_f32_16x16x32_bf16 v[72:75], a[108:111], a[124:127], v[72:75]
    ds_read_b64_tr_b16 a[116:117], v85 offset:39040
    v_mfma_f32_16x16x32_bf16 v[64:67], a[104:107], a[124:127], v[64:67]
    ds_read_b64_tr_b16 a[118:119], v85 offset:39552
    s_cmp_eq_u32 s42, 1
    s_cbranch_scc1 Lxe1
Lxe1_b:
    s_setprio 1
    s_waitcnt lgkmcnt(10)
    v_mfma_f32_16x16x32_bf16 v[28:31], a[64:67], a[96:99], v[28:31]
    ds_read_b128 a[104:107], v77 offset:39040
    ds_read_b128 a[108:111], v79 offset:39040
    v_mfma_f32_16x16x32_bf16 v[44:47], a[64:67], a[100:103], v[44:47]
    ds_read_b64_tr_b16 a[80:81], v20 offset:43136
    s_waitcnt lgkmcnt(11)
    v_mfma_f32_16x16x32_bf16 v[48:51], a[68:71], a[100:103], v[48:51]
    ds_read_b64_tr_b16 a[82:83], v20 offset:43648
    v_mfma_f32_16x16x32_bf16 v[32:35], a[68:71], a[96:99], v[32:35]
    ds_read_b64_tr_b16 a[84:85], v21 offset:43136
    s_waitcnt lgkmcnt(11)
    v_mfma_f32_16x16x32_bf16 v[36:39], a[72:75], a[96:99], v[36:39]
    ds_read_b64_tr_b16 a[86:87], v21 offset:43648
    ds_read_b64_tr_b16 a[88:89], v22 offset:43136
    v_mfma_f32_16x16x32_bf16 v[52:55], a[72:75], a[100:103], v[52:55]
    ds_read_b64_tr_b16 a[90:91], v22 offset:43648
    s_setprio 0
    s_waitcnt lgkmcnt(12)
    v_mfma_f32_16x16x32_bf16 v[56:59], a[76:79], a[100:103], v[56:59]
    ds_read_b64_tr_b16 a[92:93], v23 offset:43136
    v_mfma_f32_16x16x32_bf16 v[40:43], a[76:79], a[96:99], v[40:43]
    ds_read_b64_tr_b16 a[94:95], v23 offset:43648
    s_waitcnt lgkmcnt(12)
    v_mfma_f32_16x16x32_bf16 v[60:63], a[96:99], a[112:115], v[60:63]
    ds_read_b64_tr_b16 a[120:121], v84 offset:43136
    v_mfma_f32_16x16x32_bf16 v[68:71], a[100:103], a[112:115], v[68:71]
    ds_read_b64_tr_b16 a[122:123], v84 offset:43648
    s_waitcnt lgkmcnt(12)
    v_mfma_f32_16x16x32_bf16 v[72:75], a[100:103], a[116:119], v[72:75]
    ds_read_b64_tr_b16 a[124:125], v85 offset:43136
    v_mfma_f32_16x16x32_bf16 v[64:67], a[96:99], a[116:119], v[64:67]
    ds_read_b64_tr_b16 a[126:127], v85 offset:43648
    s_barrier
    s_setprio 3
    s_waitcnt lgkmcnt(10)
    v_mfma_f32_16x16x32_bf16 v[28:31], a[80:83], a[104:107], v[28:31]
    ds_read_b128 a[96:99], v80 offset:0
    ds_read_b128 a[100:103], v82 offset:0
    v_mfma_f32_16x16x32_bf16 v[44:47], a[80:83], a[108:111], v[44:47]
    ds_read_b64_tr_b16 a[64:65], v24 offset:0
    s_waitcnt lgkmcnt(11)
    v_mfma_f32_16x16x32_bf16 v[48:51], a[84:87], a[108:111], v[48:51]
    ds_read_b64_tr_b16 a[66:67], v24 offset:512
    v_mfma_f32_16x16x32_bf16 v[32:35], a[84:87], a[104:107], v[32:35]
    ds_read_b64_tr_b16 a[68:69], v25 offset:0
    s_waitcnt lgkmcnt(11)
    v_mfma_f32_16x16x32_bf16 v[36:39], a[88:91], a[104:107], v[36:39]
    ds_read_b64_tr_b16 a[70:71], v25 offset:512
    v_mfma_f32_16x16x32_bf16 v[52:55], a[88:91], a[108:111], v[52:55]
    ds_read_b64_tr_b16 a[72:73], v26 offset:0
    s_setprio 2
    s_waitcnt lgkmcnt(11)
    v_mfma_f32_16x16x32_bf16 v[56:59], a[92:95], a[108:111], v[56:59]
    ds_read_b64_tr_b16 a[74:75], v26 offset:512
    ds_read_b64_tr_b16 a[76:77], v27 offset:0
    v_mfma_f32_16x16x32_bf16 v[40:43], a[92:95], a[104:107], v[40:43]
    ds_read_b64_tr_b16 a[78:79], v27 offset:512
    s_waitcnt lgkmcnt(12)
    v_mfma_f32_16x16x32_bf16 v[60:63], a[104:107], a[120:123], v[60:63]
    ds_read_b64_tr_b16 a[112:113], v86 offset:0
    v_mfma_f32_16x16x32_bf16 v[68:71], a[108:111], a[120:123], v[68:71]
    ds_read_b64_tr_b16 a[114:115], v86 offset:512
    s_waitcnt lgkmcnt(12)
    v_mfma_f32_16x16x32_bf16 v[72:75], a[108:111], a[124:127], v[72:75]
    ds_read_b64_tr_b16 a[116:117], v87 offset:0
    v_mfma_f32_16x16x32_bf16 v[64:67], a[104:107], a[124:127], v[64:67]
    ds_read_b64_tr_b16 a[118:119], v87 offset:512
    buffer_store_dwordx4 v[100:103], v13, s[28:31], s58 offen sc1
    s_cmp_eq_u32 s42, 2
    s_cbranch_scc1 Lxe2
Lxe2_b:
    s_setprio 1
    s_waitcnt lgkmcnt(10)
    v_mfma_f32_16x16x32_bf16 v[28:31], a[64:67], a[96:99], v[28:31]
    ds_read_b128 a[104:107], v81 offset:0
    ds_read_b128 a[108:111], v83 offset:0
    v_mfma_f32_16x16x32_bf16 v[44:47], a[64:67], a[100:103], v[44:47]
    ds_read_b64_tr_b16 a[80:81], v24 offset:4096
    s_waitcnt lgkmcnt(11)
    v_mfma_f32_16x16x32_bf16 v[48:51], a[68:71], a[100:103], v[48:51]
    ds_read_b64_tr_b16 a[82:83], v24 offset:4608
    v_mfma_f32_16x16x32_bf16 v[32:35], a[68:71], a[96:99], v[32:35]
    ds_read_b64_tr_b16 a[84:85], v25 offset:4096
    s_waitcnt lgkmcnt(11)
    v_mfma_f32_16x16x32_bf16 v[36:39], a[72:75], a[96:99], v[36:39]
    ds_read_b64_tr_b16 a[86:87], v25 offset:4608
    ds_read_b64_tr_b16 a[88:89], v26 offset:4096
    v_mfma_f32_16x16x32_bf16 v[52:55], a[72:75], a[100:103], v[52:55]
    ds_read_b64_tr_b16 a[90:91], v26 offset:4608
    s_setprio 0
    s_waitcnt lgkmcnt(12)
    v_mfma_f32_16x16x32_bf16 v[56:59], a[76:79], a[100:103], v[56:59]
    ds_read_b64_tr_b16 a[92:93], v27 offset:4096
    v_mfma_f32_16x16x32_bf16 v[40:43], a[76:79], a[96:99], v[40:43]
    ds_read_b64_tr_b16 a[94:95], v27 offset:4608
    s_waitcnt lgkmcnt(12)
    v_mfma_f32_16x16x32_bf16 v[60:63], a[96:99], a[112:115], v[60:63]
    ds_read_b64_tr_b16 a[120:121], v86 offset:4096
    v_mfma_f32_16x16x32_bf16 v[68:71], a[100:103], a[112:115], v[68:71]
    ds_read_b64_tr_b16 a[122:123], v86 offset:4608
    s_waitcnt lgkmcnt(12)
    v_mfma_f32_16x16x32_bf16 v[72:75], a[100:103], a[116:119], v[72:75]
    ds_read_b64_tr_b16 a[124:125], v87 offset:4096
    v_mfma_f32_16x16x32_bf16 v[64:67], a[96:99], a[116:119], v[64:67]
    ds_read_b64_tr_b16 a[126:127], v87 offset:4608
    s_barrier
    s_setprio 3
    s_waitcnt lgkmcnt(10)
    v_mfma_f32_16x16x32_bf16 v[28:31], a[80:83], a[104:107], v[28:31]
    ds_read_b128 a[96:99], v80 offset:39040
    ds_read_b128 a[100:103], v82 offset:39040
    v_mfma_f32_16x16x32_bf16 v[44:47], a[80:83], a[108:111], v[44:47]
    ds_read_b64_tr_b16 a[64:65], v24 offset:39040
    s_waitcnt lgkmcnt(11)
    v_mfma_f32_16x16x32_bf16 v[48:51], a[84:87], a[108:111], v[48:51]
    ds_read_b64_tr_b16 a[66:67], v24 offset:39552
    v_mfma_f32_16x16x32_bf16 v[32:35], a[84:87], a[104:107], v[32:35]
    ds_read_b64_tr_b16 a[68:69], v25 offset:39040
    s_waitcnt lgkmcnt(11)
    v_mfma_f32_16x16x32_bf16 v[36:39], a[88:91], a[104:107], v[36:39]
    ds_read_b64_tr_b16 a[70:71], v25 offset:39552
    v_mfma_f32_16x16x32_bf16 v[52:55], a[88:91], a[108:111], v[52:55]
    ds_read_b64_tr_b16 a[72:73], v26 offset:39040
    s_setprio 2
    s_waitcnt lgkmcnt(11)
    v_mfma_f32_16x16x32_bf16 v[56:59], a[92:95], a[108:111], v[56:59]
    ds_read_b64_tr_b16 a[74:75], v26 offset:39552
    ds_read_b64_tr_b16 a[76:77], v27 offset:39040
    v_mfma_f32_16x16x32_bf16 v[40:43], a[92:95], a[104:107], v[40:43]
    ds_read_b64_tr_b16 a[78:79], v27 offset:39552
    s_waitcnt lgkmcnt(12)
    v_mfma_f32_16x16x32_bf16 v[60:63], a[104:107], a[120:123], v[60:63]
    ds_read_b64_tr_b16 a[112:113], v86 offset:39040
    v_mfma_f32_16x16x32_bf16 v[68:71], a[108:111], a[120:123], v[68:71]
    ds_read_b64_tr_b16 a[114:115], v86 offset:39552
    s_waitcnt lgkmcnt(12)
    v_mfma_f32_16x16x32_bf16 v[72:75], a[108:111], a[124:127], v[72:75]
    ds_read_b64_tr_b16 a[116:117], v87 offset:39040
    v_mfma_f32_16x16x32_bf16 v[64:67], a[104:107], a[124:127], v[64:67]
    ds_read_b64_tr_b16 a[118:119], v87 offset:39552
    s_cmp_eq_u32 s42, 3
    s_cbranch_scc1 Lxe3
Lxe3_b:
    s_setprio 1
    s_waitcnt lgkmcnt(10)
    v_mfma_f32_16x16x32_bf16 v[28:31], a[64:67], a[96:99], v[28:31]
    ds_read_b128 a[104:107], v81 offset:39040
    ds_read_b128 a[108:111], v83 offset:39040
    v_mfma_f32_16x16x32_bf16 v[44:47], a[64:67], a[100:103], v[44:47]
    ds_read_b64_tr_b16 a[80:81], v24 offset:43136
    s_waitcnt lgkmcnt(11)
    v_mfma_f32_16x16x32_bf16 v[48:51], a[68:71], a[100:103], v[48:51]
    ds_read_b64_tr_b16 a[82:83], v24 offset:43648
    v_mfma_f32_16x16x32_bf16 v[32:35], a[68:71], a[96:99], v[32:35]
    ds_read_b64_tr_b16 a[84:85], v25 offset:43136
    s_waitcnt lgkmcnt(11)
    v_mfma_f32_16x16x32_bf16 v[36:39], a[72:75], a[96:99], v[36:39]
    ds_read_b64_tr_b16 a[86:87], v25 offset:43648
    ds_read_b64_tr_b16 a[88:89], v26 offset:43136
    v_mfma_f32_16x16x32_bf16 v[52:55], a[72:75], a[100:103], v[52:55]
    ds_read_b64_tr_b16 a[90:91], v26 offset:43648
    s_setprio 0
    s_waitcnt lgkmcnt(12)
    v_mfma_f32_16x16x32_bf16 v[56:59], a[76:79], a[100:103], v[56:59]
    ds_read_b64_tr_b16 a[92:93], v27 offset:43136
    v_mfma_f32_16x16x32_bf16 v[40:43], a[76:79], a[96:99], v[40:43]
    ds_read_b64_tr_b16 a[94:95], v27 offset:43648
    s_waitcnt lgkmcnt(12)
    v_mfma_f32_16x16x32_bf16 v[60:63], a[96:99], a[112:115], v[60:63]
    ds_read_b64_tr_b16 a[120:121], v86 offset:43136
    v_mfma_f32_16x16x32_bf16 v[68:71], a[100:103], a[112:115], v[68:71]
    ds_read_b64_tr_b16 a[122:123], v86 offset:43648
    s_waitcnt lgkmcnt(12)
    v_mfma_f32_16x16x32_bf16 v[72:75], a[100:103], a[116:119], v[72:75]
    ds_read_b64_tr_b16 a[124:125], v87 offset:43136
    v_mfma_f32_16x16x32_bf16 v[64:67], a[96:99], a[116:119], v[64:67]
    ds_read_b64_tr_b16 a[126:127], v87 offset:43648
    s_barrier
    s_setprio 3
    s_waitcnt lgkmcnt(10)
    v_mfma_f32_16x16x32_bf16 v[28:31], a[80:83], a[104:107], v[28:31]
    ds_read_b128 a[96:99], v76 offset:0
    ds_read_b128 a[100:103], v78 offset:0
    v_mfma_f32_16x16x32_bf16 v[44:47], a[80:83], a[108:111], v[44:47]
    ds_read_b64_tr_b16 a[64:65], v20 offset:0
    s_waitcnt lgkmcnt(11)
    v_mfma_f32_16x16x32_bf16 v[48:51], a[84:87], a[108:111], v[48:51]
    ds_read_b64_tr_b16 a[66:67], v20 offset:512
    v_mfma_f32_16x16x32_bf16 v[32:35], a[84:87], a[104:107], v[32:35]
    ds_read_b64_tr_b16 a[68:69], v21 offset:0
    s_waitcnt lgkmcnt(11)
    v_mfma_f32_16x16x32_bf16 v[36:39], a[88:91], a[104:107], v[36:39]
    ds_read_b64_tr_b16 a[70:71], v21 offset:512
    v_mfma_f32_16x16x32_bf16 v[52:55], a[88:91], a[108:111], v[52:55]
    ds_read_b64_tr_b16 a[72:73], v22 offset:0
    s_setprio 2
    s_waitcnt lgkmcnt(11)
    v_mfma_f32_16x16x32_bf16 v[56:59], a[92:95], a[108:111], v[56:59]
    ds_read_b64_tr_b16 a[74:75], v22 offset:512
    ds_read_b64_tr_b16 a[76:77], v23 offset:0
    v_mfma_f32_16x16x32_bf16 v[40:43], a[92:95], a[104:107], v[40:43]
    ds_read_b64_tr_b16 a[78:79], v23 offset:512
    s_waitcnt lgkmcnt(12)
    v_mfma_f32_16x16x32_bf16 v[60:63], a[104:107], a[120:123], v[60:63]
    ds_read_b64_tr_b16 a[112:113], v84 offset:0
    v_mfma_f32_16x16x32_bf16 v[68:71], a[108:111], a[120:123], v[68:71]
    ds_read_b64_tr_b16 a[114:115], v84 offset:512
    s_waitcnt lgkmcnt(12)
    v_mfma_f32_16x16x32_bf16 v[72:75], a[108:111], a[124:127], v[72:75]
    ds_read_b64_tr_b16 a[116:117], v85 offset:0
    v_mfma_f32_16x16x32_bf16 v[64:67], a[104:107], a[124:127], v[64:67]
    ds_read_b64_tr_b16 a[118:119], v85 offset:512
    buffer_store_dwordx4 v[100:103], v13, s[28:31], s23 offen offset:0 sc1
    s_cmp_eq_u32 s42, 4
    s_cbranch_scc1 Lxe4
Lxe4_b:
    s_setprio 1
    s_waitcnt lgkmcnt(10)
    v_mfma_f32_16x16x32_bf16 v[28:31], a[64:67], a[96:99], v[28:31]
    ds_read_b128 a[104:107], v77 offset:0
    ds_read_b128 a[108:111], v79 offset:0
    v_mfma_f32_16x16x32_bf16 v[44:47], a[64:67], a[100:103], v[44:47]
    ds_read_b64_tr_b16 a[80:81], v20 offset:4096
    s_waitcnt lgkmcnt(11)
    v_mfma_f32_16x16x32_bf16 v[48:51], a[68:71], a[100:103], v[48:51]
    ds_read_b64_tr_b16 a[82:83], v20 offset:4608
    v_mfma_f32_16x16x32_bf16 v[32:35], a[68:71], a[96:99], v[32:35]
    ds_read_b64_tr_b16 a[84:85], v21 offset:4096
    s_waitcnt lgkmcnt(11)
    v_mfma_f32_16x16x32_bf16 v[36:39], a[72:75], a[96:99], v[36:39]
    ds_read_b64_tr_b16 a[86:87], v21 offset:4608
    ds_read_b64_tr_b16 a[88:89], v22 offset:4096
    v_mfma_f32_16x16x32_bf16 v[52:55], a[72:75], a[100:103], v[52:55]
    ds_read_b64_tr_b16 a[90:91], v22 offset:4608
    s_setprio 0
    s_waitcnt lgkmcnt(12)
    v_mfma_f32_16x16x32_bf16 v[56:59], a[76:79], a[100:103], v[56:59]
    ds_read_b64_tr_b16 a[92:93], v23 offset:4096
    v_mfma_f32_16x16x32_bf16 v[40:43], a[76:79], a[96:99], v[40:43]
    ds_read_b64_tr_b16 a[94:95], v23 offset:4608
    s_waitcnt lgkmcnt(12)
    v_mfma_f32_16x16x32_bf16 v[60:63], a[96:99], a[112:115], v[60:63]
    ds_read_b64_tr_b16 a[120:121], v84 offset:4096
    v_mfma_f32_16x16x32_bf16 v[68:71], a[100:103], a[112:115], v[68:71]
    ds_read_b64_tr_b16 a[122:123], v84 offset:4608
    s_waitcnt lgkmcnt(12)
    v_mfma_f32_16x16x32_bf16 v[72:75], a[100:103], a[116:119], v[72:75]
    ds_read_b64_tr_b16 a[124:125], v85 offset:4096
    v_mfma_f32_16x16x32_bf16 v[64:67], a[96:99], a[116:119], v[64:67]
    ds_read_b64_tr_b16 a[126:127], v85 offset:4608
    s_barrier
    s_setprio 3
    s_waitcnt lgkmcnt(10)
    v_mfma_f32_16x16x32_bf16 v[28:31], a[80:83], a[104:107], v[28:31]
    ds_read_b128 a[96:99], v76 offset:39040
    ds_read_b128 a[100:103], v78 offset:39040
    v_mfma_f32_16x16x32_bf16 v[44:47], a[80:83], a[108:111], v[44:47]
    ds_read_b64_tr_b16 a[64:65], v20 offset:39040
    s_waitcnt lgkmcnt(11)
    v_mfma_f32_16x16x32_bf16 v[48:51], a[84:87], a[108:111], v[48:51]
    ds_read_b64_tr_b16 a[66:67], v20 offset:39552
    v_mfma_f32_16x16x32_bf16 v[32:35], a[84:87], a[104:107], v[32:35]
    ds_read_b64_tr_b16 a[68:69], v21 offset:39040
    s_waitcnt lgkmcnt(11)
    v_mfma_f32_16x16x32_bf16 v[36:39], a[88:91], a[104:107], v[36:39]
    ds_read_b64_tr_b16 a[70:71], v21 offset:39552
    v_mfma_f32_16x16x32_bf16 v[52:55], a[88:91], a[108:111], v[52:55]
    ds_read_b64_tr_b16 a[72:73], v22 offset:39040
    s_setprio 2
    s_waitcnt lgkmcnt(11)
    v_mfma_f32_16x16x32_bf16 v[56:59], a[92:95], a[108:111], v[56:59]
    ds_read_b64_tr_b16 a[74:75], v22 offset:39552
    ds_read_b64_tr_b16 a[76:77], v23 offset:39040
    v_mfma_f32_16x16x32_bf16 v[40:43], a[92:95], a[104:107], v[40:43]
    ds_read_b64_tr_b16 a[78:79], v23 offset:39552
    s_waitcnt lgkmcnt(12)
    v_mfma_f32_16x16x32_bf16 v[60:63], a[104:107], a[120:123], v[60:63]
    ds_read_b64_tr_b16 a[112:113], v84 offset:39040
    v_mfma_f32_16x16x32_bf16 v[68:71], a[108:111], a[120:123], v[68:71]
    ds_read_b64_tr_b16 a[114:115], v84 offset:39552
    s_waitcnt lgkmcnt(12)
    v_mfma_f32_16x16x32_bf16 v[72:75], a[108:111], a[124:127], v[72:75]
    ds_read_b64_tr_b16 a[116:117], v85 offset:39040
    v_mfma_f32_16x16x32_bf16 v[64:67], a[104:107], a[124:127], v[64:67]
    ds_read_b64_tr_b16 a[118:119], v85 offset:39552
    s_cmp_eq_u32 s42, 5
    s_cbranch_scc1 Lxe5
Lxe5_b:
    s_setprio 1
    s_waitcnt lgkmcnt(10)
    v_mfma_f32_16x16x32_bf16 v[28:31], a[64:67], a[96:99], v[28:31]
    ds_read_b128 a[104:107], v77 offset:39040
    ds_read_b128 a[108:111], v79 offset:39040
    v_mfma_f32_16x16x32_bf16 v[44:47], a[64:67], a[100:103], v[44:47]
    ds_read_b64_tr_b16 a[80:81], v20 offset:43136
    s_waitcnt lgkmcnt(11)
    v_mfma_f32_16x16x32_bf16 v[48:51], a[68:71], a[100:103], v[48:51]
    ds_read_b64_tr_b16 a[82:83], v20 offset:43648
    v_mfma_f32_16x16x32_bf16 v[32:35], a[68:71], a[96:99], v[32:35]
    ds_read_b64_tr_b16 a[84:85], v21 offset:43136
    s_waitcnt lgkmcnt(11)
    v_mfma_f32_16x16x32_bf16 v[36:39], a[72:75], a[96:99], v[36:39]
    ds_read_b64_tr_b16 a[86:87], v21 offset:43648
    ds_read_b64_tr_b16 a[88:89], v22 offset:43136
    v_mfma_f32_16x16x32_bf16 v[52:55], a[72:75], a[100:103], v[52:55]
    ds_read_b64_tr_b16 a[90:91], v22 offset:43648
    s_setprio 0
    s_waitcnt lgkmcnt(12)
    v_mfma_f32_16x16x32_bf16 v[56:59], a[76:79], a[100:103], v[56:59]
    ds_read_b64_tr_b16 a[92:93], v23 offset:43136
    v_mfma_f32_16x16x32_bf16 v[40:43], a[76:79], a[96:99], v[40:43]
    ds_read_b64_tr_b16 a[94:95], v23 offset:43648
    s_waitcnt lgkmcnt(12)
    v_mfma_f32_16x16x32_bf16 v[60:63], a[96:99], a[112:115], v[60:63]
    ds_read_b64_tr_b16 a[120:121], v84 offset:43136
    v_mfma_f32_16x16x32_bf16 v[68:71], a[100:103], a[112:115], v[68:71]
    ds_read_b64_tr_b16 a[122:123], v84 offset:43648
    s_waitcnt lgkmcnt(12)
    v_mfma_f32_16x16x32_bf16 v[72:75], a[100:103], a[116:119], v[72:75]
    ds_read_b64_tr_b16 a[124:125], v85 offset:43136
    v_mfma_f32_16x16x32_bf16 v[64:67], a[96:99], a[116:119], v[64:67]
    ds_read_b64_tr_b16 a[126:127], v85 offset:43648
    s_barrier
    s_setprio 3
    s_waitcnt lgkmcnt(10)
    v_mfma_f32_16x16x32_bf16 v[28:31], a[80:83], a[104:107], v[28:31]
    ds_read_b128 a[0:3], v80 offset:0
    v_mfma_f32_16x16x32_bf16 v[44:47], a[80:83], a[108:111], v[44:47]
    ds_read_b128 a[4:7], v82 offset:0
    s_waitcnt lgkmcnt(10)
    v_mfma_f32_16x16x32_bf16 v[48:51], a[84:87], a[108:111], v[48:51]
    ds_read_b64_tr_b16 a[64:65], v24 offset:0
    v_mfma_f32_16x16x32_bf16 v[32:35], a[84:87], a[104:107], v[32:35]
    ds_read_b64_tr_b16 a[66:67], v24 offset:512
    s_waitcnt lgkmcnt(10)
    v_mfma_f32_16x16x32_bf16 v[36:39], a[88:91], a[104:107], v[36:39]
    ds_read_b64_tr_b16 a[68:69], v25 offset:0
    v_mfma_f32_16x16x32_bf16 v[52:55], a[88:91], a[108:111], v[52:55]
    s_setprio 2
    s_waitcnt lgkmcnt(9)
    v_mfma_f32_16x16x32_bf16 v[56:59], a[92:95], a[108:111], v[56:59]
    ds_read_b64_tr_b16 a[70:71], v25 offset:512
    v_mfma_f32_16x16x32_bf16 v[40:43], a[92:95], a[104:107], v[40:43]
    ds_read_b64_tr_b16 a[72:73], v26 offset:0
    s_waitcnt lgkmcnt(9)
    v_mfma_f32_16x16x32_bf16 v[60:63], a[104:107], a[120:123], v[60:63]
    ds_read_b64_tr_b16 a[74:75], v26 offset:512
    v_mfma_f32_16x16x32_bf16 v[68:71], a[108:111], a[120:123], v[68:71]
    ds_read_b64_tr_b16 a[76:77], v27 offset:0
    s_waitcnt lgkmcnt(9)
    v_mfma_f32_16x16x32_bf16 v[72:75], a[108:111], a[124:127], v[72:75]
    ds_read_b64_tr_b16 a[78:79], v27 offset:512
    v_mfma_f32_16x16x32_bf16 v[64:67], a[104:107], a[124:127], v[64:67]
    buffer_store_dwordx4 v[100:103], v13, s[28:31], s23 offen offset:1024 sc1
    s_cmp_eq_u32 s42, 6
    s_cbranch_scc1 Lxe6
Lxe6_b:
    s_setprio 1
    s_waitcnt lgkmcnt(6)
    v_mfma_f32_16x16x32_bf16 v[28:31], a[64:67], a[0:3], v[28:31]
    ds_read_b128 a[8:11], v81 offset:0
    ds_read_b128 a[12:15], v83 offset:0
    v_mfma_f32_16x16x32_bf16 v[44:47], a[64:67], a[4:7], v[44:47]
    ds_read_b64_tr_b16 a[80:81], v24 offset:4096
    s_waitcnt lgkmcnt(7)
    v_mfma_f32_16x16x32_bf16 v[48:51], a[68:71], a[4:7], v[48:51]
    ds_read_b64_tr_b16 a[82:83], v24 offset:4608
    ds_read_b64_tr_b16 a[84:85], v25 offset:4096
    v_mfma_f32_16x16x32_bf16 v[32:35], a[68:71], a[0:3], v[32:35]
    ds_read_b64_tr_b16 a[86:87], v25 offset:4608
    s_setprio 0
    s_waitcnt lgkmcnt(8)
    v_mfma_f32_16x16x32_bf16 v[36:39], a[72:75], a[0:3], v[36:39]
    v_mfma_f32_16x16x32_bf16 v[52:55], a[72:75], a[4:7], v[52:55]
    ds_read_b64_tr_b16 a[88:89], v26 offset:4096
    ds_read_b64_tr_b16 a[90:91], v26 offset:4608
    s_waitcnt lgkmcnt(8)
    v_mfma_f32_16x16x32_bf16 v[56:59], a[76:79], a[4:7], v[56:59]
    ds_read_b64_tr_b16 a[92:93], v27 offset:4096
    v_mfma_f32_16x16x32_bf16 v[40:43], a[76:79], a[0:3], v[40:43]
    ds_read_b64_tr_b16 a[94:95], v27 offset:4608
    s_barrier
    s_setprio 3
    s_waitcnt lgkmcnt(6)
    v_mfma_f32_16x16x32_bf16 v[28:31], a[80:83], a[8:11], v[28:31]
    ds_read_b128 a[16:19], v80 offset:39040
    ds_read_b128 a[20:23], v82 offset:39040
    v_mfma_f32_16x16x32_bf16 v[44:47], a[80:83], a[12:15], v[44:47]
    ds_read_b64_tr_b16 a[64:65], v24 offset:39040
    s_waitcnt lgkmcnt(7)
    v_mfma_f32_16x16x32_bf16 v[48:51], a[84:87], a[12:15], v[48:51]
    ds_read_b64_tr_b16 a[66:67], v24 offset:39552
    v_mfma_f32_16x16x32_bf16 v[32:35], a[84:87], a[8:11], v[32:35]
    ds_read_b64_tr_b16 a[68:69], v25 offset:39040
    s_setprio 2
    s_waitcnt lgkmcnt(7)
    v_mfma_f32_16x16x32_bf16 v[36:39], a[88:91], a[8:11], v[36:39]
    ds_read_b64_tr_b16 a[70:71], v25 offset:39552
    ds_read_b64_tr_b16 a[72:73], v26 offset:39040
    v_mfma_f32_16x16x32_bf16 v[52:55], a[88:91], a[12:15], v[52:55]
    ds_read_b64_tr_b16 a[74:75], v26 offset:39552
    s_waitcnt lgkmcnt(8)
    v_mfma_f32_16x16x32_bf16 v[56:59], a[92:95], a[12:15], v[56:59]
    ds_read_b64_tr_b16 a[76:77], v27 offset:39040
    v_mfma_f32_16x16x32_bf16 v[40:43], a[92:95], a[8:11], v[40:43]
    ds_read_b64_tr_b16 a[78:79], v27 offset:39552
    s_cmp_eq_u32 s42, 7
    s_cbranch_scc1 Lxe7
Lxe7_b:
    s_setprio 1
    s_waitcnt lgkmcnt(6)
    v_mfma_f32_16x16x32_bf16 v[28:31], a[64:67], a[16:19], v[28:31]
    ds_read_b128 a[24:27], v81 offset:39040
    ds_read_b128 a[28:31], v83 offset:39040
    v_mfma_f32_16x16x32_bf16 v[44:47], a[64:67], a[20:23], v[44:47]
    ds_read_b64_tr_b16 a[80:81], v24 offset:43136
    s_waitcnt lgkmcnt(7)
    v_mfma_f32_16x16x32_bf16 v[48:51], a[68:71], a[20:23], v[48:51]
    ds_read_b64_tr_b16 a[82:83], v24 offset:43648
    ds_read_b64_tr_b16 a[84:85], v25 offset:43136
    v_mfma_f32_16x16x32_bf16 v[32:35], a[68:71], a[16:19], v[32:35]
    ds_read_b64_tr_b16 a[86:87], v25 offset:43648
    s_setprio 0
    s_waitcnt lgkmcnt(8)
    v_mfma_f32_16x16x32_bf16 v[36:39], a[72:75], a[16:19], v[36:39]
    v_mfma_f32_16x16x32_bf16 v[52:55], a[72:75], a[20:23], v[52:55]
    ds_read_b64_tr_b16 a[88:89], v26 offset:43136
    ds_read_b64_tr_b16 a[90:91], v26 offset:43648
    s_waitcnt lgkmcnt(8)
    v_mfma_f32_16x16x32_bf16 v[56:59], a[76:79], a[20:23], v[56:59]
    ds_read_b64_tr_b16 a[92:93], v27 offset:43136
    v_mfma_f32_16x16x32_bf16 v[40:43], a[76:79], a[16:19], v[40:43]
    ds_read_b64_tr_b16 a[94:95], v27 offset:43648
    s_barrier
    s_setprio 3
    s_waitcnt lgkmcnt(6)
    v_mfma_f32_16x16x32_bf16 v[28:31], a[80:83], a[24:27], v[28:31]
    ds_read_b128 a[32:35], v76 offset:0
    ds_read_b128 a[36:39], v78 offset:0
    v_mfma_f32_16x16x32_bf16 v[44:47], a[80:83], a[28:31], v[44:47]
    ds_read_b64_tr_b16 a[64:65], v20 offset:0
    s_waitcnt lgkmcnt(7)
    v_mfma_f32_16x16x32_bf16 v[48:51], a[84:87], a[28:31], v[48:51]
    ds_read_b64_tr_b16 a[66:67], v20 offset:512
    v_mfma_f32_16x16x32_bf16 v[32:35], a[84:87], a[24:27], v[32:35]
    ds_read_b64_tr_b16 a[68:69], v21 offset:0
    s_setprio 2
    s_waitcnt lgkmcnt(7)
    v_mfma_f32_16x16x32_bf16 v[36:39], a[88:91], a[24:27], v[36:39]
    ds_read_b64_tr_b16 a[70:71], v21 offset:512
    ds_read_b64_tr_b16 a[72:73], v22 offset:0
    v_mfma_f32_16x16x32_bf16 v[52:55], a[88:91], a[28:31], v[52:55]
    ds_read_b64_tr_b16 a[74:75], v22 offset:512
    s_waitcnt lgkmcnt(8)
    v_mfma_f32_16x16x32_bf16 v[56:59], a[92:95], a[28:31], v[56:59]
    ds_read_b64_tr_b16 a[76:77], v23 offset:0
    v_mfma_f32_16x16x32_bf16 v[40:43], a[92:95], a[24:27], v[40:43]
    ds_read_b64_tr_b16 a[78:79], v23 offset:512
    s_cmp_eq_u32 s42, 8
    s_cbranch_scc1 Lxe8
Lxe8_b:
    s_setprio 1
    s_waitcnt lgkmcnt(6)
    v_mfma_f32_16x16x32_bf16 v[28:31], a[64:67], a[32:35], v[28:31]
    ds_read_b128 a[40:43], v77 offset:0
    ds_read_b128 a[44:47], v79 offset:0
    v_mfma_f32_16x16x32_bf16 v[44:47], a[64:67], a[36:39], v[44:47]
    ds_read_b64_tr_b16 a[80:81], v20 offset:4096
    s_waitcnt lgkmcnt(7)
    v_mfma_f32_16x16x32_bf16 v[48:51], a[68:71], a[36:39], v[48:51]
    ds_read_b64_tr_b16 a[82:83], v20 offset:4608
    v_mfma_f32_16x16x32_bf16 v[32:35], a[68:71], a[32:35], v[32:35]
    ds_read_b64_tr_b16 a[84:85], v21 offset:4096
    s_setprio 0
    s_waitcnt lgkmcnt(7)
    v_mfma_f32_16x16x32_bf16 v[36:39], a[72:75], a[32:35], v[36:39]
    ds_read_b64_tr_b16 a[86:87], v21 offset:4608
    ds_read_b64_tr_b16 a[88:89], v22 offset:4096
    v_mfma_f32_16x16x32_bf16 v[52:55], a[72:75], a[36:39], v[52:55]
    ds_read_b64_tr_b16 a[90:91], v22 offset:4608
    s_waitcnt lgkmcnt(8)
    v_mfma_f32_16x16x32_bf16 v[56:59], a[76:79], a[36:39], v[56:59]
    ds_read_b64_tr_b16 a[92:93], v23 offset:4096
    v_mfma_f32_16x16x32_bf16 v[40:43], a[76:79], a[32:35], v[40:43]
    ds_read_b64_tr_b16 a[94:95], v23 offset:4608
    s_waitcnt lgkmcnt(0)
    s_barrier
    s_setprio 3
    v_mfma_f32_16x16x32_bf16 v[28:31], a[80:83], a[40:43], v[28:31]
    ds_read_b128 a[48:51], v76 offset:39040
    ds_read_b128 a[52:55], v78 offset:39040
    v_mfma_f32_16x16x32_bf16 v[44:47], a[80:83], a[44:47], v[44:47]
    ds_read_b64_tr_b16 a[64:65], v20 offset:39040
    v_mfma_f32_16x16x32_bf16 v[48:51], a[84:87], a[44:47], v[48:51]
    ds_read_b64_tr_b16 a[66:67], v20 offset:39552
    v_mfma_f32_16x16x32_bf16 v[32:35], a[84:87], a[40:43], v[32:35]
    ds_read_b64_tr_b16 a[68:69], v21 offset:39040
    s_setprio 2
    v_mfma_f32_16x16x32_bf16 v[36:39], a[88:91], a[40:43], v[36:39]
    ds_read_b64_tr_b16 a[70:71], v21 offset:39552
    ds_read_b64_tr_b16 a[72:73], v22 offset:39040
    v_mfma_f32_16x16x32_bf16 v[52:55], a[88:91], a[44:47], v[52:55]
    ds_read_b64_tr_b16 a[74:75], v22 offset:39552
    v_mfma_f32_16x16x32_bf16 v[56:59], a[92:95], a[44:47], v[56:59]
    ds_read_b64_tr_b16 a[76:77], v23 offset:39040
    v_mfma_f32_16x16x32_bf16 v[40:43], a[92:95], a[40:43], v[40:43]
    ds_read_b64_tr_b16 a[78:79], v23 offset:39552
    v_mov_b32 v98, s34
    s_waitcnt vmcnt(0)
    s_mov_b64 exec, 1
    buffer_store_dword v98, v97, s[28:31], s24 offen sc1
    s_mov_b64 exec, -1
    s_cmp_eq_u32 s42, 9
    s_cbranch_scc1 Lxe9
Lxe9_b:
    s_setprio 1
    s_waitcnt lgkmcnt(6)
    v_mfma_f32_16x16x32_bf16 v[28:31], a[64:67], a[48:51], v[28:31]
    ds_read_b128 a[56:59], v77 offset:39040
    ds_read_b128 a[60:63], v79 offset:39040
    ds_read_b64_tr_b16 a[80:81], v20 offset:43136
    v_mfma_f32_16x16x32_bf16 v[44:47], a[64:67], a[52:55], v[44:47]
    ds_read_b64_tr_b16 a[82:83], v20 offset:43648
    ds_read_b64_tr_b16 a[84:85], v21 offset:43136
    s_waitcnt lgkmcnt(9)
    v_mfma_f32_16x16x32_bf16 v[48:51], a[68:71], a[52:55], v[48:51]
    ds_read_b64_tr_b16 a[86:87], v21 offset:43648
    ds_read_b64_tr_b16 a[88:89], v22 offset:43136
    ds_read_b64_tr_b16 a[90:91], v22 offset:43648
    v_mfma_f32_16x16x32_bf16 v[32:35], a[68:71], a[48:51], v[32:35]
    ds_read_b64_tr_b16 a[92:93], v23 offset:43136
    ds_read_b64_tr_b16 a[94:95], v23 offset:43648
    s_setprio 0
    s_waitcnt lgkmcnt(12)
    v_mfma_f32_16x16x32_bf16 v[36:39], a[72:75], a[48:51], v[36:39]
    ds_read_b32 v120, v94
    ds_read_b32 v121, v94 offset:512
    v_xor_b32 v94, 64, v94
    v_mfma_f32_16x16x32_bf16 v[52:55], a[72:75], a[52:55], v[52:55]
    ds_read_b32 v122, v94
    ds_read_b32 v123, v92 offset:512
    s_waitcnt lgkmcnt(14)
    v_mfma_f32_16x16x32_bf16 v[56:59], a[76:79], a[52:55], v[56:59]
    ds_read_b32 v126, v93 offset:520
    v_mov_b32 v24, v84
    v_mov_b32 v25, v85
    v_mfma_f32_16x16x32_bf16 v[40:43], a[76:79], a[48:51], v[40:43]
    v_mov_b32 v26, v86
    v_mov_b32 v27, v87
    s_waitcnt lgkmcnt(5)
    v_mfma_f32_16x16x32_bf16 v[44:47], a[80:83], a[60:63], v[44:47]
    v_mfma_f32_16x16x32_bf16 v[48:51], a[84:87], a[60:63], v[48:51]
    v_mfma_f32_16x16x32_bf16 v[52:55], a[88:91], a[60:63], v[52:55]
    v_mfma_f32_16x16x32_bf16 v[56:59], a[92:95], a[60:63], v[56:59]
    v_mfma_f32_16x16x32_bf16 v[28:31], a[80:83], a[56:59], v[28:31]
    v_mfma_f32_16x16x32_bf16 v[32:35], a[84:87], a[56:59], v[32:35]
    ds_read_b32 v7, v96
    ds_read_b128 v[76:79], v95 offset:0
    ds_read_b128 v[80:83], v95 offset:64
    ds_read_b128 v[84:87], v95 offset:128
    ds_read_b128 v[88:91], v95 offset:192
    v_mfma_f32_16x16x32_bf16 v[36:39], a[88:91], a[56:59], v[36:39]
    v_mfma_f32_16x16x32_bf16 v[40:43], a[92:95], a[56:59], v[40:43]
    s_waitcnt lgkmcnt(0)
Lqf:
    v_readfirstlane_b32 s38, v7
    s_nop 0
    s_cmp_eq_u32 s38, 0
    s_cbranch_scc1 Lqf_re
    s_cmp_eq_u32 s27, 0
    v_fmac_f32 v44, v76, v122
    v_fmac_f32 v45, v77, v122
    v_fmac_f32 v46, v78, v122
    v_fmac_f32 v47, v79, v122
    v_cvt_pk_bf16_f32 v44, v44, v45
    v_cvt_pk_bf16_f32 v45, v46, v47
    v_fmac_f32 v48, v80, v122
    v_fmac_f32 v49, v81, v122
    v_fmac_f32 v50, v82, v122
    v_fmac_f32 v51, v83, v122
    v_cvt_pk_bf16_f32 v46, v48, v49
    v_cvt_pk_bf16_f32 v47, v50, v51
    v_fmac_f32 v52, v84, v122
    v_fmac_f32 v53, v85, v122
    v_fmac_f32 v54, v86, v122
    v_fmac_f32 v55, v87, v122
    v_cvt_pk_bf16_f32 v48, v52, v53
    v_cvt_pk_bf16_f32 v49, v54, v55
    v_fmac_f32 v56, v88, v122
    v_fmac_f32 v57, v89, v122
    v_fmac_f32 v58, v90, v122
    v_fmac_f32 v59, v91, v122
    v_cvt_pk_bf16_f32 v50, v56, v57
    v_cvt_pk_bf16_f32 v51, v58, v59
    s_cbranch_scc1 Lh1
    s_setprio 3
    ds_write_b128 v125, v[44:47] offset:2048
    ds_write_b128 v125, v[48:51] offset:3072
    v_fmac_f32 v28, v76, v120
    v_fmac_f32 v29, v77, v120
    v_fmac_f32 v30, v78, v120
    v_fmac_f32 v31, v79, v120
    v_cvt_pk_bf16_f32 v52, v28, v29
    v_cvt_pk_bf16_f32 v53, v30, v31
    v_fmac_f32 v32, v80, v120
    v_fmac_f32 v33, v81, v120
    v_fmac_f32 v34, v82, v120
    v_fmac_f32 v35, v83, v120
    v_cvt_pk_bf16_f32 v54, v32, v33
    v_cvt_pk_bf16_f32 v55, v34, v35
    v_fmac_f32 v36, v84, v120
    v_fmac_f32 v37, v85, v120
    v_fmac_f32 v38, v86, v120
    v_fmac_f32 v39, v87, v120
    v_cvt_pk_bf16_f32 v56, v36, v37
    v_cvt_pk_bf16_f32 v57, v38, v39
    v_fmac_f32 v40, v88, v120
    v_fmac_f32 v41, v89, v120
    v_fmac_f32 v42, v90, v120
    v_fmac_f32 v43, v91, v120
    v_cvt_pk_bf16_f32 v58, v40, v41
    v_cvt_pk_bf16_f32 v59, v42, v43
    ds_write_b128 v125, v[52:55] offset:4096
    ds_write_b128 v125, v[56:59] offset:5120
    v_mov_b32 v5, 157972
    v_mov_b32 v6, 1
    s_mov_b64 exec, 1
    ds_add_u32 v5, v6
    s_mov_b64 exec, -1
    v_mov_b32 v8, s22
    v_mov_b32 v9, s22
    v_mov_b32 v10, s22
    v_mov_b32 v11, s22
Lcw_1:
    s_sub_u32 s35, s35, 1
    s_cbranch_scc1 Lend
    ds_read_b32 v6, v5
    s_waitcnt lgkmcnt(0)
    v_readfirstlane_b32 s38, v6
    s_nop 0
    s_cmp_lt_u32 s38, 8
    s_cbranch_scc1 Lcw_1
    ds_read_b128 v[28:31], v125 offset:0
    ds_read_b128 v[32:35], v125 offset:1024
Lh_join:
    buffer_load_dword v20, v12, s[28:31], s24 offen sc1
    ds_read_b64_tr_b16 a[64:65], v26 offset:0
    ds_read_b64_tr_b16 a[66:67], v26 offset:512
    ds_read_b64_tr_b16 a[68:69], v27 offset:0
    ds_read_b64_tr_b16 a[70:71], v27 offset:512
    ds_read_b64_tr_b16 a[72:73], v26 offset:4096
    ds_read_b64_tr_b16 a[74:75], v26 offset:4608
    ds_read_b64_tr_b16 a[76:77], v27 offset:4096
    ds_read_b64_tr_b16 a[78:79], v27 offset:4608
    s_waitcnt lgkmcnt(8)
    s_setprio 3
    v_cndmask_b32 v92, 0, v30, s[6:7]
    v_cndmask_b32 v93, 0, v31, s[6:7]
    v_cndmask_b32 v94, 0, v32, s[12:13]
    v_cndmask_b32 v95, 0, v33, s[12:13]
    v_cndmask_b32 v104, 0, v30, s[8:9]
    v_cndmask_b32 v105, 0, v31, s[8:9]
    v_mfma_f32_16x16x32_bf16 v[76:79], v[46:49], v[92:95], v[8:11]
    v_mfma_f32_16x16x32_bf16 v[80:83], v[54:57], v[92:95], 0
    v_cndmask_b32 v106, 0, v32, s[14:15]
    v_cndmask_b32 v107, 0, v33, s[14:15]
    v_mov_b32 v96, v28
    v_mov_b32 v97, v29
    v_mfma_f32_16x16x32_bf16 v[84:87], v[46:49], v[104:107], v[8:11]
    v_mfma_f32_16x16x32_bf16 v[88:91], v[54:57], v[104:107], 0
    v_cndmask_b32 v98, 0, v30, s[10:11]
    v_cndmask_b32 v99, 0, v31, s[10:11]
    v_cndmask_b32 v100, 0, v32, s[16:17]
    v_cndmask_b32 v101, 0, v33, s[16:17]
    v_mfma_f32_16x16x32_bf16 v[36:39], v[44:47], v[96:99], v[8:11]
    v_mfma_f32_16x16x32_bf16 v[40:43], v[52:55], v[96:99], 0
    v_cndmask_b32 v76, v76, v77, s[4:5]
    v_cndmask_b32 v80, v80, v81, s[4:5]
    v_cndmask_b32 v78, v78, v79, s[4:5]
    v_cndmask_b32 v82, v82, v83, s[4:5]
    v_cndmask_b32 v92, v76, v80, s[18:19]
    v_cndmask_b32 v94, v78, v82, s[20:21]
    v_min_u32 v4, -2, v92
    v_min_u32 v5, -2, v94
    v_cndmask_b32 v84, v84, v85, s[4:5]
    v_cndmask_b32 v88, v88, v89, s[4:5]
    v_cndmask_b32 v86, v86, v87, s[4:5]
    v_cndmask_b32 v90, v90, v91, s[4:5]
    v_cndmask_b32 v104, v84, v88, s[18:19]
    v_cndmask_b32 v106, v86, v90, s[20:21]
    v_min_u32 v6, -2, v104
    v_min_u32 v7, -2, v106
    buffer_store_dwordx4 v[4:7], v13, s[28:31], s58 offen sc0 sc1
    s_setprio 2
    ds_read_b64_tr_b16 a[80:81], v26 offset:39040
    ds_read_b64_tr_b16 a[82:83], v26 offset:39552
    ds_read_b64_tr_b16 a[84:85], v27 offset:39040
    ds_read_b64_tr_b16 a[86:87], v27 offset:39552
    ds_read_b64_tr_b16 a[88:89], v26 offset:43136
    ds_read_b64_tr_b16 a[90:91], v26 offset:43648
    ds_read_b64_tr_b16 a[92:93], v27 offset:43136
    ds_read_b64_tr_b16 a[94:95], v27 offset:43648
    ds_read_b64_tr_b16 a[96:97], v24 offset:0
    ds_read_b64_tr_b16 a[98:99], v24 offset:512
    ds_read_b64_tr_b16 a[100:101], v25 offset:0
    ds_read_b64_tr_b16 a[102:103], v25 offset:512
    ds_read_b64_tr_b16 a[104:105], v24 offset:4096
    ds_read_b64_tr_b16 a[106:107], v24 offset:4608
    ds_read_b64_tr_b16 a[108:109], v25 offset:4096
    ds_read_b64_tr_b16 a[110:111], v25 offset:4608
    ds_read_b64_tr_b16 a[112:113], v24 offset:39040
    ds_read_b64_tr_b16 a[114:115], v24 offset:39552
    ds_read_b64_tr_b16 a[116:117], v25 offset:39040
    ds_read_b64_tr_b16 a[118:119], v25 offset:39552
    ds_read_b64_tr_b16 a[120:121], v24 offset:43136
    ds_read_b64_tr_b16 a[122:123], v24 offset:43648
    ds_read_b64_tr_b16 a[124:125], v25 offset:43136
    ds_read_b64_tr_b16 a[126:127], v25 offset:43648
    s_waitcnt lgkmcnt(15)
    v_mfma_f32_16x16x32_bf16 v[60:63], a[0:3], a[64:67], v[60:63]
    v_mov_b32 v102, v34
    v_mov_b32 v103, v35
    v_mul_f32 v4, s25, v121
    v_mfma_f32_16x16x32_bf16 v[68:71], a[4:7], a[64:67], v[68:71]
    v_mfma_f32_16x16x32_bf16 v[76:79], v[48:51], v[100:103], v[8:11]
    v_mfma_f32_16x16x32_bf16 v[80:83], v[56:59], v[100:103], 0
    v_mul_f32 v123, v123, v4
    v_mfma_f32_16x16x32_bf16 v[64:67], a[0:3], a[68:71], v[64:67]
    v_mul_f32 v126, v126, v4
    v_cndmask_b32 v36, v36, v37, s[4:5]
    v_cndmask_b32 v40, v40, v41, s[4:5]
    v_mfma_f32_16x16x32_bf16 v[72:75], a[4:7], a[68:71], v[72:75]
    v_cndmask_b32 v38, v38, v39, s[4:5]
    v_cndmask_b32 v42, v42, v43, s[4:5]
    v_cndmask_b32 v96, v36, v40, s[18:19]
    v_mfma_f32_16x16x32_bf16 v[60:63], a[8:11], a[72:75], v[60:63]
    v_cndmask_b32 v98, v38, v42, s[20:21]
    v_cndmask_b32 v76, v76, v77, s[4:5]
    v_cndmask_b32 v80, v80, v81, s[4:5]
    v_mfma_f32_16x16x32_bf16 v[68:71], a[12:15], a[72:75], v[68:71]
    v_cndmask_b32 v78, v78, v79, s[4:5]
    v_cndmask_b32 v82, v82, v83, s[4:5]
    v_cndmask_b32 v100, v76, v80, s[18:19]
    v_mfma_f32_16x16x32_bf16 v[64:67], a[8:11], a[76:79], v[64:67]
    v_cndmask_b32 v102, v78, v82, s[20:21]
    v_mul_f32 v96, v96, v123
    v_mul_f32 v98, v98, v126
    v_mfma_f32_16x16x32_bf16 v[72:75], a[12:15], a[76:79], v[72:75]
    v_mul_f32 v100, v100, v123
    v_mul_f32 v102, v102, v126
    v_max_f32 v4, v96, v98
    v_mfma_f32_16x16x32_bf16 v[60:63], a[16:19], a[80:83], v[60:63]
    v_max_f32 v5, v100, v102
    v_mov_b32 v6, v4
    v_mov_b32 v7, v5
    v_mfma_f32_16x16x32_bf16 v[68:71], a[20:23], a[80:83], v[68:71]
    v_permlane32_swap_b32 v4, v6
    v_permlane32_swap_b32 v5, v7
    v_max_f32 v4, v4, v6
    v_mfma_f32_16x16x32_bf16 v[64:67], a[16:19], a[84:87], v[64:67]
    v_max_f32 v5, v5, v7
    v_mov_b32 v6, v4
    v_mov_b32 v7, v5
    v_mfma_f32_16x16x32_bf16 v[72:75], a[20:23], a[84:87], v[72:75]
    v_permlane16_swap_b32 v4, v6
    v_permlane16_swap_b32 v5, v7
    s_setprio 1
    v_mfma_f32_16x16x32_bf16 v[60:63], a[24:27], a[88:91], v[60:63]
    v_max_f32 v4, v4, v6
    v_max_f32 v5, v5, v7
    v_sub_f32 v96, v96, v4
    v_mfma_f32_16x16x32_bf16 v[68:71], a[28:31], a[88:91], v[68:71]
    v_sub_f32 v98, v98, v4
    v_sub_f32 v100, v100, v5
    v_sub_f32 v102, v102, v5
    v_mfma_f32_16x16x32_bf16 v[64:67], a[24:27], a[92:95], v[64:67]
    v_exp_f32 v96, v96
    v_exp_f32 v98, v98
    v_exp_f32 v100, v100
    v_mfma_f32_16x16x32_bf16 v[72:75], a[28:31], a[92:95], v[72:75]
    v_exp_f32 v102, v102
    v_cvt_pk_bf16_f32 v96, v96, v96
    s_waitcnt lgkmcnt(12)
    v_mfma_f32_16x16x32_bf16 v[60:63], a[32:35], a[96:99], v[60:63]
    v_cvt_pk_bf16_f32 v97, v98, v98
    v_cvt_pk_bf16_f32 v100, v100, v100
    v_cvt_pk_bf16_f32 v101, v102, v102
    v_mfma_f32_16x16x32_bf16 v[68:71], a[36:39], a[96:99], v[68:71]
    v_and_b32 v98, v96, v118
    v_and_b32 v99, v97, v119
    v_and_b32 v96, v96, v116
    v_mfma_f32_16x16x32_bf16 v[64:67], a[32:35], a[100:103], v[64:67]
    v_and_b32 v97, v97, v117
    v_and_b32 v102, v100, v118
    v_and_b32 v103, v101, v119
    v_mfma_f32_16x16x32_bf16 v[72:75], a[36:39], a[100:103], v[72:75]
    v_and_b32 v100, v100, v116
    v_and_b32 v101, v101, v117
    s_waitcnt lgkmcnt(8)
    v_mfma_f32_16x16x32_bf16 v[60:63], a[40:43], a[104:107], v[60:63]
    s_lshl_b32 s36, s44, 6
    s_add_u32 s36, s36, 156160
    v_lshl_add_u32 v48, v2, 4, s36
    v_xor_b32 v49, 64, v48
    ds_read_b128 v[28:31], v48 offset:0
    v_mfma_f32_16x16x32_bf16 v[68:71], a[44:47], a[104:107], v[68:71]
    ds_read_b128 v[32:35], v48 offset:512
    ds_read_b128 v[36:39], v49 offset:0
    ds_read_b128 v[40:43], v49 offset:512
    s_lshl_b32 s36, s27, 3
    s_add_u32 s36, s36, 157696
    v_mfma_f32_16x16x32_bf16 v[64:67], a[40:43], a[108:111], v[64:67]
    v_lshl_add_u32 v48, v3, 4, s36
    v_mov_b32 v49, 157952
    v_lshl_add_u32 v125, v1, 3, s45
    s_lshl_b32 s36, s27, 10
    v_add_u32 v50, s36, v125
    v_mfma_f32_16x16x32_bf16 v[72:75], a[44:47], a[108:111], v[72:75]
    s_lshl_b32 s37, s27, 12
    s_sub_u32 s37, 2048, s37
    v_add_u32 v51, s37, v50
    v_subrev_u32 v125, 2048, v125
    s_setprio 0
    ds_read_b32 v46, v49
    ds_read_b64 v[44:45], v48
    s_waitcnt lgkmcnt(10)
    v_mfma_f32_16x16x32_bf16 v[60:63], a[48:51], a[112:115], v[60:63]
    v_mfma_f32_16x16x32_bf16 v[68:71], a[52:55], a[112:115], v[68:71]
    v_mfma_f32_16x16x32_bf16 v[64:67], a[48:51], a[116:119], v[64:67]
    v_mfma_f32_16x16x32_bf16 v[72:75], a[52:55], a[116:119], v[72:75]
    s_waitcnt vmcnt(1)
Lfl_chk:
    v_cmp_eq_u32 vcc, s34, v20
    s_nop 0
    s_and_b32 s36, vcc_lo, 0x3ff
    s_cmp_lg_u32 s36, 0x3ff
    s_cbranch_scc1 Lfl_re
    buffer_load_dwordx2 v[52:53], v13, s[28:31], s59 offen offset:8 sc1
    buffer_load_dwordx2 v[54:55], v13, s[28:31], s60 offen offset:0 sc1
    s_waitcnt lgkmcnt(0)
Lcsv:
    v_readfirstlane_b32 s38, v46
    s_nop 0
    s_cmp_eq_u32 s38, 0
    s_cbranch_scc1 Lcsv_re
    v_fmac_f32 v60, v28, v44
    v_fmac_f32 v61, v29, v44
    v_fmac_f32 v62, v30, v44
    v_fmac_f32 v63, v31, v44
    v_fmac_f32 v68, v36, v44
    v_fmac_f32 v69, v37, v44
    v_fmac_f32 v70, v38, v44
    v_fmac_f32 v71, v39, v44
    v_mfma_f32_16x16x32_bf16 v[60:63], a[56:59], a[120:123], v[60:63]
    v_fmac_f32 v64, v28, v45
    v_fmac_f32 v65, v29, v45
    v_fmac_f32 v66, v30, v45
    v_fmac_f32 v67, v31, v45
    v_mfma_f32_16x16x32_bf16 v[68:71], a[60:63], a[120:123], v[68:71]
    v_fmac_f32 v72, v36, v45
    v_fmac_f32 v73, v37, v45
    v_fmac_f32 v74, v38, v45
    v_fmac_f32 v75, v39, v45
    v_mfma_f32_16x16x32_bf16 v[64:67], a[56:59], a[124:127], v[64:67]
    s_nop 0
    v_mfma_f32_16x16x32_bf16 v[72:75], a[60:63], a[124:127], v[72:75]
    v_mul_f32 v60, v60, v32
    v_mul_f32 v61, v61, v33
    v_mul_f32 v62, v62, v34
    v_mul_f32 v63, v63, v35
    v_cvt_pk_bf16_f32 v60, v60, v61
    v_cvt_pk_bf16_f32 v61, v62, v63
    ds_write_b64 v50, v[60:61] offset:0
    v_mul_f32 v68, v68, v40
    v_mul_f32 v69, v69, v41
    v_mul_f32 v70, v70, v42
    v_mul_f32 v71, v71, v43
    v_cvt_pk_bf16_f32 v68, v68, v69
    v_cvt_pk_bf16_f32 v69, v70, v71
    ds_write_b64 v51, v[68:69] offset:0
    v_mul_f32 v64, v64, v32
    v_mul_f32 v65, v65, v33
    v_mul_f32 v66, v66, v34
    v_mul_f32 v67, v67, v35
    v_cvt_pk_bf16_f32 v64, v64, v65
    v_cvt_pk_bf16_f32 v65, v66, v67
    ds_write_b64 v50, v[64:65] offset:512
    v_mul_f32 v72, v72, v40
    v_mul_f32 v73, v73, v41
    v_mul_f32 v74, v74, v42
    v_mul_f32 v75, v75, v43
    v_cvt_pk_bf16_f32 v72, v72, v73
    v_cvt_pk_bf16_f32 v73, v74, v75
    ds_write_b64 v51, v[72:73] offset:512
    v_mov_b32 v8, 157976
    v_mov_b32 v9, 1
    s_mov_b64 exec, 1
    ds_add_u32 v8, v9
    s_mov_b64 exec, -1
Lcw_4:
    s_sub_u32 s35, s35, 1
    s_cbranch_scc1 Lend
    ds_read_b32 v9, v8
    s_waitcnt lgkmcnt(0)
    v_readfirstlane_b32 s38, v9
    s_nop 0
    s_cmp_lt_u32 s38, 7
    s_cbranch_scc1 Lcw_4
    s_setprio 2
    ds_read2st64_b64 v[60:63], v125 offset0:0 offset1:4
    ds_read2st64_b64 v[64:67], v125 offset0:1 offset1:5
    ds_read2st64_b64 v[68:71], v125 offset0:2 offset1:6
    ds_read2st64_b64 v[72:75], v125 offset0:3 offset1:7
    v_mfma_f32_16x16x32_bf16 v[80:83], v[14:17], v[96:99], 0
    v_mfma_f32_16x16x32_bf16 v[84:87], v[14:17], v[100:103], 0
    v_and_b32 v6, 3, v1
    v_lshl_add_u32 v6, v6, 3, v19
    v_add_u32 v20, v6, v18
    v_xor_b32 v21, 32, v20
    v_xor_b32 v22, 64, v20
    v_xor_b32 v23, 96, v20
    s_waitcnt lgkmcnt(0)
    v_mfma_f32_16x16x32_bf16 v[28:31], v[60:63], v[96:99], 0
    v_add_u32 v24, 63616, v20
    v_mfma_f32_16x16x32_bf16 v[40:43], v[72:75], v[100:103], 0
    v_add_u32 v25, 63616, v21
    v_mfma_f32_16x16x32_bf16 v[32:35], v[64:67], v[96:99], 0
    v_add_u32 v26, 63616, v22
    v_mfma_f32_16x16x32_bf16 v[36:39], v[68:71], v[100:103], 0
    v_add_u32 v27, 63616, v23
    v_rcp_f32 v80, v80
    v_rcp_f32 v84, v84
    v_mul_f32 v28, v28, v80
    v_mul_f32 v29, v29, v80
    v_mul_f32 v30, v30, v80
    v_mul_f32 v31, v31, v80
    v_cvt_pk_bf16_f32 v8, v28, v29
    v_cvt_pk_bf16_f32 v9, v30, v31
    v_min_u32 v8, -2, v8
    v_min_u32 v9, -2, v9
    v_mul_f32 v40, v40, v84
    v_mul_f32 v41, v41, v84
    v_mul_f32 v42, v42, v84
    v_mul_f32 v43, v43, v84
    v_cvt_pk_bf16_f32 v10, v40, v41
    v_cvt_pk_bf16_f32 v11, v42, v43
    v_min_u32 v10, -2, v10
    v_min_u32 v11, -2, v11
    buffer_store_dwordx4 v[8:11], v13, s[28:31], s23 offen sc0 sc1
    s_waitcnt vmcnt(1)
Lrx_chk:
    v_and_b32 v52, s61, v52
    v_and_b32 v53, s61, v53
    v_and_b32 v54, s62, v54
    v_and_b32 v55, s62, v55
    v_max3_u32 v4, v52, v53, v54
    v_max_u32 v4, v4, v55
    v_cmp_eq_u32 vcc, -1, v4
    s_nop 0
    s_cbranch_vccnz Lrx_re
    v_add_f32 v92, v92, v52
    v_add_f32 v94, v94, v53
    v_add_f32 v104, v104, v54
    v_add_f32 v106, v106, v55
    v_mul_f32 v92, v92, v123
    v_mul_f32 v94, v94, v126
    v_mul_f32 v104, v104, v123
    v_mul_f32 v106, v106, v126
    v_max_f32 v4, v92, v94
    v_max_f32 v5, v104, v106
    v_mov_b32 v6, v4
    v_mov_b32 v7, v5
    s_nop 0
    v_permlane32_swap_b32 v4, v6
    v_permlane32_swap_b32 v5, v7
    v_max_f32 v4, v4, v6
    v_max_f32 v5, v5, v7
    v_mov_b32 v6, v4
    v_mov_b32 v7, v5
    s_nop 0
    v_permlane16_swap_b32 v4, v6
    v_permlane16_swap_b32 v5, v7
    v_max_f32 v4, v4, v6
    v_max_f32 v5, v5, v7
    v_sub_f32 v92, v92, v4
    v_sub_f32 v94, v94, v4
    v_sub_f32 v104, v104, v5
    v_sub_f32 v106, v106, v5
    v_exp_f32 v92, v92
    v_exp_f32 v94, v94
    v_exp_f32 v104, v104
    v_exp_f32 v106, v106
    v_cvt_pk_bf16_f32 v92, v92, v92
    v_cvt_pk_bf16_f32 v93, v94, v94
    v_cvt_pk_bf16_f32 v104, v104, v104
    v_cvt_pk_bf16_f32 v105, v106, v106
    v_and_b32 v94, v92, v118
    v_and_b32 v95, v93, v119
    v_and_b32 v92, v92, v116
    v_and_b32 v93, v93, v117
    v_and_b32 v106, v104, v118
    v_and_b32 v107, v105, v119
    v_and_b32 v104, v104, v116
    v_and_b32 v105, v105, v117
    v_mfma_f32_16x16x32_bf16 v[76:79], v[14:17], v[92:95], 0
    s_nop 0
    v_mfma_f32_16x16x32_bf16 v[88:91], v[14:17], v[104:107], 0
    v_mfma_f32_16x16x32_bf16 v[44:47], v[64:67], v[92:95], 0
    v_mfma_f32_16x16x32_bf16 v[48:51], v[68:71], v[92:95], 0
    v_mfma_f32_16x16x32_bf16 v[52:55], v[64:67], v[104:107], 0
    v_mfma_f32_16x16x32_bf16 v[56:59], v[68:71], v[104:107], 0
    s_nop 1
    v_rcp_f32 v76, v76
    s_nop 0
    v_rcp_f32 v88, v88
    v_cndmask_b32 v82, v80, v76, s[6:7]
    v_cndmask_b32 v82, v82, v88, s[8:9]
    v_cndmask_b32 v32, v32, v44, s[6:7]
    v_cndmask_b32 v33, v33, v45, s[6:7]
    v_cndmask_b32 v34, v34, v46, s[6:7]
    v_cndmask_b32 v35, v35, v47, s[6:7]
    v_cndmask_b32 v32, v32, v52, s[8:9]
    v_cndmask_b32 v33, v33, v53, s[8:9]
    v_cndmask_b32 v34, v34, v54, s[8:9]
    v_cndmask_b32 v35, v35, v55, s[8:9]
    v_mul_f32 v32, v32, v82
    v_mul_f32 v33, v33, v82
    v_mul_f32 v34, v34, v82
    v_mul_f32 v35, v35, v82
    v_cvt_pk_bf16_f32 v4, v32, v33
    v_cvt_pk_bf16_f32 v5, v34, v35
    v_min_u32 v4, -2, v4
    v_min_u32 v5, -2, v5
    v_cndmask_b32 v86, v84, v76, s[12:13]
    v_cndmask_b32 v86, v86, v88, s[14:15]
    v_cndmask_b32 v36, v36, v48, s[12:13]
    v_cndmask_b32 v37, v37, v49, s[12:13]
    v_cndmask_b32 v38, v38, v50, s[12:13]
    v_cndmask_b32 v39, v39, v51, s[12:13]
    v_cndmask_b32 v36, v36, v56, s[14:15]
    v_cndmask_b32 v37, v37, v57, s[14:15]
    v_cndmask_b32 v38, v38, v58, s[14:15]
    v_cndmask_b32 v39, v39, v59, s[14:15]
    v_mul_f32 v36, v36, v86
    v_mul_f32 v37, v37, v86
    v_mul_f32 v38, v38, v86
    v_mul_f32 v39, v39, v86
    v_cvt_pk_bf16_f32 v6, v36, v37
    v_cvt_pk_bf16_f32 v7, v38, v39
    v_min_u32 v6, -2, v6
    v_min_u32 v7, -2, v7
    buffer_store_dwordx4 v[4:7], v13, s[28:31], s23 offen offset:1024 sc0 sc1
    s_setprio 1
    v_mov_b32 v10, 157980
Lcw_3:
    s_sub_u32 s35, s35, 1
    s_cbranch_scc1 Lend
    ds_read_b32 v11, v10
    s_waitcnt lgkmcnt(0)
    v_readfirstlane_b32 s38, v11
    s_nop 0
    s_cmp_lt_u32 s38, 2
    s_cbranch_scc1 Lcw_3
    s_mul_i32 s36, s32, 96
    s_lshl_b32 s37, s44, 4
    s_add_u32 s36, s36, s37
    s_sub_u32 s36, s36, 32
    v_add_u32 v126, s36, v3
    v_lshrrev_b32 v6, 3, v1
    v_add_u32 v6, s36, v6
    v_mul_u32_u24 v6, 1280, v6
    v_and_b32 v7, 7, v1
    v_xor_b32 v7, v7, v2
    v_lshl_add_u32 v122, v7, 4, v6
    v_xor_b32 v123, 64, v122
    v_add_u32 v123, 10240, v123
    s_lshl_b32 s36, s44, 11
    s_add_u32 s36, s36, 102656
    v_add_u32 v124, s36, v124
    v_add_u32 v125, s36, v13
    s_lshl_b32 s24, s33, 7
    v_mov_b32 v10, 157960
    s_mov_b32 s41, 0
    s_mov_b32 s47, 3
    v_lshlrev_b32 v28, 16, v108
    ds_read_b64_tr_b16 a[0:1], v20 offset:0
    ds_read_b64_tr_b16 a[2:3], v20 offset:512
    ds_read_b64_tr_b16 a[4:5], v21 offset:0
    ds_read_b64_tr_b16 a[6:7], v21 offset:512
    ds_read_b64_tr_b16 a[8:9], v22 offset:0
    ds_read_b64_tr_b16 a[10:11], v22 offset:512
    ds_read_b64_tr_b16 a[12:13], v23 offset:0
    ds_read_b64_tr_b16 a[14:15], v23 offset:512
    v_and_b32 v29, 0xffff0000, v108
    v_lshlrev_b32 v30, 16, v109
    v_and_b32 v31, 0xffff0000, v109
    v_lshlrev_b32 v32, 16, v110
    v_and_b32 v33, 0xffff0000, v110
    v_lshlrev_b32 v34, 16, v111
    v_and_b32 v35, 0xffff0000, v111
    v_lshlrev_b32 v36, 16, v112
    v_and_b32 v37, 0xffff0000, v112
    v_lshlrev_b32 v38, 16, v113
    v_and_b32 v39, 0xffff0000, v113
    v_lshlrev_b32 v40, 16, v114
    v_and_b32 v41, 0xffff0000, v114
    v_lshlrev_b32 v42, 16, v115
    ds_read_b64_tr_b16 a[16:17], v20 offset:4096
    ds_read_b64_tr_b16 a[18:19], v20 offset:4608
    ds_read_b64_tr_b16 a[20:21], v21 offset:4096
    ds_read_b64_tr_b16 a[22:23], v21 offset:4608
    ds_read_b64_tr_b16 a[24:25], v22 offset:4096
    ds_read_b64_tr_b16 a[26:27], v22 offset:4608
    ds_read_b64_tr_b16 a[28:29], v23 offset:4096
    ds_read_b64_tr_b16 a[30:31], v23 offset:4608
    v_and_b32 v43, 0xffff0000, v115
    v_mul_f32 v4, v120, v121
    v_mul_f32 v5, 0xbfb8aa3b, v121
    v_mul_f32 v6, 0xbfb8aa3b, v4
    v_fma_f32 v44, v28, v5, v6
    v_fma_f32 v45, v29, v5, v6
    v_fma_f32 v46, v30, v5, v6
    v_fma_f32 v47, v31, v5, v6
    v_fma_f32 v48, v32, v5, v6
    v_fma_f32 v49, v33, v5, v6
    v_fma_f32 v50, v34, v5, v6
    v_fma_f32 v51, v35, v5, v6
    v_fma_f32 v52, v36, v5, v6
    v_fma_f32 v53, v37, v5, v6
    ds_read_b64_tr_b16 a[32:33], v20 offset:8192
    ds_read_b64_tr_b16 a[34:35], v20 offset:8704
    ds_read_b64_tr_b16 a[36:37], v21 offset:8192
    ds_read_b64_tr_b16 a[38:39], v21 offset:8704
    ds_read_b64_tr_b16 a[40:41], v22 offset:8192
    ds_read_b64_tr_b16 a[42:43], v22 offset:8704
    ds_read_b64_tr_b16 a[44:45], v23 offset:8192
    ds_read_b64_tr_b16 a[46:47], v23 offset:8704
    v_fma_f32 v54, v38, v5, v6
    v_fma_f32 v55, v39, v5, v6
    v_fma_f32 v56, v40, v5, v6
    v_fma_f32 v57, v41, v5, v6
    v_fma_f32 v58, v42, v5, v6
    v_fma_f32 v59, v43, v5, v6
    v_exp_f32 v44, v44
    v_exp_f32 v45, v45
    v_exp_f32 v46, v46
    v_exp_f32 v47, v47
    v_exp_f32 v48, v48
    v_exp_f32 v49, v49
    v_exp_f32 v50, v50
    v_exp_f32 v51, v51
    v_exp_f32 v52, v52
    ds_read_b64_tr_b16 a[48:49], v20 offset:12288
    ds_read_b64_tr_b16 a[50:51], v20 offset:12800
    ds_read_b64_tr_b16 a[52:53], v21 offset:12288
    ds_read_b64_tr_b16 a[54:55], v21 offset:12800
    ds_read_b64_tr_b16 a[56:57], v22 offset:12288
    ds_read_b64_tr_b16 a[58:59], v22 offset:12800
    ds_read_b64_tr_b16 a[60:61], v23 offset:12288
    ds_read_b64_tr_b16 a[62:63], v23 offset:12800
    v_exp_f32 v53, v53
    v_exp_f32 v54, v54
    v_exp_f32 v55, v55
    v_exp_f32 v56, v56
    v_exp_f32 v57, v57
    v_exp_f32 v58, v58
    v_exp_f32 v59, v59
    v_add_f32 v44, 1.0, v44
    v_add_f32 v45, 1.0, v45
    buffer_load_dwordx4 v[60:63], v13, s[28:31], s53 offen offset:0 sc1
    buffer_load_dwordx4 v[64:67], v13, s[28:31], s53 offen offset:2048 sc1
    buffer_load_dwordx4 v[68:71], v13, s[28:31], s54 offen offset:0 sc1
    buffer_load_dwordx4 v[72:75], v13, s[28:31], s54 offen offset:2048 sc1
    buffer_load_dwordx4 v[92:95], v13, s[28:31], s55 offen offset:0 sc1
    buffer_load_dwordx4 v[96:99], v13, s[28:31], s55 offen offset:2048 sc1
    buffer_load_dwordx4 v[100:103], v13, s[28:31], s56 offen offset:0 sc1
    buffer_load_dwordx4 v[104:107], v13, s[28:31], s56 offen offset:2048 sc1
    s_setprio 0
    v_add_f32 v46, 1.0, v46
    v_add_f32 v47, 1.0, v47
    v_add_f32 v48, 1.0, v48
    v_add_f32 v49, 1.0, v49
    v_add_f32 v50, 1.0, v50
    ds_read_b64_tr_b16 a[64:65], v20 offset:24576
    ds_read_b64_tr_b16 a[66:67], v20 offset:25088
    ds_read_b64_tr_b16 a[68:69], v21 offset:24576
    ds_read_b64_tr_b16 a[70:71], v21 offset:25088
    ds_read_b64_tr_b16 a[72:73], v22 offset:24576
    ds_read_b64_tr_b16 a[74:75], v22 offset:25088
    ds_read_b64_tr_b16 a[76:77], v23 offset:24576
    ds_read_b64_tr_b16 a[78:79], v23 offset:25088
    v_add_f32 v51, 1.0, v51
    v_add_f32 v52, 1.0, v52
    v_add_f32 v53, 1.0, v53
    v_add_f32 v54, 1.0, v54
    v_add_f32 v55, 1.0, v55
    v_add_f32 v56, 1.0, v56
    v_add_f32 v57, 1.0, v57
    v_add_f32 v58, 1.0, v58
    v_add_f32 v59, 1.0, v59
    v_rcp_f32 v44, v44
    v_rcp_f32 v45, v45
    v_rcp_f32 v46, v46
    v_rcp_f32 v47, v47
    v_rcp_f32 v48, v48
    ds_read_b64_tr_b16 a[80:81], v20 offset:28672
    ds_read_b64_tr_b16 a[82:83], v20 offset:29184
    ds_read_b64_tr_b16 a[84:85], v21 offset:28672
    ds_read_b64_tr_b16 a[86:87], v21 offset:29184
    ds_read_b64_tr_b16 a[88:89], v22 offset:28672
    ds_read_b64_tr_b16 a[90:91], v22 offset:29184
    ds_read_b64_tr_b16 a[92:93], v23 offset:28672
    ds_read_b64_tr_b16 a[94:95], v23 offset:29184
    v_rcp_f32 v49, v49
    v_rcp_f32 v50, v50
    v_rcp_f32 v51, v51
    v_rcp_f32 v52, v52
    v_rcp_f32 v53, v53
    v_rcp_f32 v54, v54
    v_rcp_f32 v55, v55
    v_rcp_f32 v56, v56
    v_rcp_f32 v57, v57
    v_rcp_f32 v58, v58
    v_rcp_f32 v59, v59
    v_fma_f32 v7, v28, v121, v4
    v_mul_f32 v44, v44, v7
    v_fma_f32 v11, v29, v121, v4
    v_mul_f32 v45, v45, v11
    ds_read_b64_tr_b16 a[96:97], v24 offset:59520
    ds_read_b64_tr_b16 a[98:99], v24 offset:60032
    ds_read_b64_tr_b16 a[100:101], v25 offset:59520
    ds_read_b64_tr_b16 a[102:103], v25 offset:60032
    ds_read_b64_tr_b16 a[104:105], v26 offset:59520
    ds_read_b64_tr_b16 a[106:107], v26 offset:60032
    ds_read_b64_tr_b16 a[108:109], v27 offset:59520
    ds_read_b64_tr_b16 a[110:111], v27 offset:60032
    v_fma_f32 v7, v30, v121, v4
    v_mul_f32 v46, v46, v7
    v_fma_f32 v11, v31, v121, v4
    v_mul_f32 v47, v47, v11
    v_fma_f32 v7, v32, v121, v4
    v_mul_f32 v48, v48, v7
    v_fma_f32 v11, v33, v121, v4
    v_mul_f32 v49, v49, v11
    v_fma_f32 v7, v34, v121, v4
    v_mul_f32 v50, v50, v7
    v_fma_f32 v11, v35, v121, v4
    v_mul_f32 v51, v51, v11
    v_fma_f32 v7, v36, v121, v4
    v_mul_f32 v52, v52, v7
    ds_read_b64_tr_b16 a[112:113], v24 offset:63616
    ds_read_b64_tr_b16 a[114:115], v24 offset:64128
    ds_read_b64_tr_b16 a[116:117], v25 offset:63616
    ds_read_b64_tr_b16 a[118:119], v25 offset:64128
    ds_read_b64_tr_b16 a[120:121], v26 offset:63616
    ds_read_b64_tr_b16 a[122:123], v26 offset:64128
    ds_read_b64_tr_b16 a[124:125], v27 offset:63616
    ds_read_b64_tr_b16 a[126:127], v27 offset:64128
    v_fma_f32 v11, v37, v121, v4
    v_mul_f32 v53, v53, v11
    v_fma_f32 v7, v38, v121, v4
    v_mul_f32 v54, v54, v7
    v_fma_f32 v11, v39, v121, v4
    v_mul_f32 v55, v55, v11
    v_fma_f32 v7, v40, v121, v4
    v_mul_f32 v56, v56, v7
    v_fma_f32 v11, v41, v121, v4
    v_mul_f32 v57, v57, v11
    v_fma_f32 v7, v42, v121, v4
    v_mul_f32 v58, v58, v7
    v_fma_f32 v11, v43, v121, v4
    v_mul_f32 v59, v59, v11
Lwo_go:
    s_setprio 3
    ds_read_b64 v[8:9], v10
    s_waitcnt vmcnt(6)
    v_max3_u32 v18, v60, v61, v62
    v_max3_u32 v19, v64, v65, v66
    v_max3_u32 v18, v18, v63, v67
    v_max_u32 v18, v18, v19
    v_cmp_eq_u32 vcc, -1, v18
    s_nop 0
    s_cbranch_vccnz Lre_0
Lck_0:
    s_waitcnt lgkmcnt(15)
    v_mfma_f32_16x16x32_bf16 v[108:111], a[0:3], v[60:63], 0
    ds_read_b64_tr_b16 a[0:1], v24 offset:16384
    ds_read_b64_tr_b16 a[2:3], v24 offset:16896
    buffer_load_dwordx4 v[76:79], v13, s[28:31], s57 offen offset:0 sc1
    v_mfma_f32_16x16x32_bf16 v[112:115], a[4:7], v[60:63], 0
    ds_read_b64_tr_b16 a[4:5], v25 offset:16384
    ds_read_b64_tr_b16 a[6:7], v25 offset:16896
    v_mfma_f32_16x16x32_bf16 v[116:119], a[8:11], v[60:63], 0
    ds_read_b64_tr_b16 a[8:9], v26 offset:16384
    buffer_load_dwordx4 v[80:83], v13, s[28:31], s57 offen offset:2048 sc1
    v_mfma_f32_16x16x32_bf16 v[14:17], a[12:15], v[60:63], 0
    ds_read_b64_tr_b16 a[10:11], v26 offset:16896
    ds_read_b64_tr_b16 a[12:13], v27 offset:16384
    v_mfma_f32_16x16x32_bf16 v[108:111], a[16:19], v[64:67], v[108:111]
    ds_read_b64_tr_b16 a[14:15], v27 offset:16896
    s_waitcnt vmcnt(6)
    v_max3_u32 v18, v68, v69, v70
    v_mfma_f32_16x16x32_bf16 v[112:115], a[20:23], v[64:67], v[112:115]
    ds_read_b64_tr_b16 a[16:17], v24 offset:20480
    ds_read_b64_tr_b16 a[18:19], v24 offset:20992
    v_max3_u32 v19, v72, v73, v74
    v_max3_u32 v18, v18, v71, v75
    v_mfma_f32_16x16x32_bf16 v[116:119], a[24:27], v[64:67], v[116:119]
    ds_read_b64_tr_b16 a[20:21], v25 offset:20480
    ds_read_b64_tr_b16 a[22:23], v25 offset:20992
    v_max_u32 v18, v18, v19
    v_cmp_eq_u32 vcc, -1, v18
    v_mfma_f32_16x16x32_bf16 v[14:17], a[28:31], v[64:67], v[14:17]
    ds_read_b64_tr_b16 a[24:25], v26 offset:20480
    s_cbranch_vccnz Lre_1
Lck_1:
    s_waitcnt lgkmcnt(13)
Linfo:
    v_readfirstlane_b32 s39, v8
    s_nop 0
    s_cmp_eq_u32 s39, -2
    s_cbranch_scc1 Linfo_re
    v_mfma_f32_16x16x32_bf16 v[108:111], a[32:35], v[68:71], v[108:111]
    ds_read_b64_tr_b16 a[26:27], v26 offset:20992
    ds_read_b64_tr_b16 a[28:29], v27 offset:20480
    buffer_load_dwordx4 v[84:87], v13, s[28:31], s53 offen offset:1024 sc1
    v_mfma_f32_16x16x32_bf16 v[112:115], a[36:39], v[68:71], v[112:115]
    ds_read_b64_tr_b16 a[30:31], v27 offset:20992
    v_mfma_f32_16x16x32_bf16 v[116:119], a[40:43], v[68:71], v[116:119]
    ds_read_b64_tr_b16 a[32:33], v20 offset:32768
    ds_read_b64_tr_b16 a[34:35], v20 offset:33280
    buffer_load_dwordx4 v[88:91], v13, s[28:31], s53 offen offset:3072 sc1
    v_mfma_f32_16x16x32_bf16 v[14:17], a[44:47], v[68:71], v[14:17]
    ds_read_b64_tr_b16 a[36:37], v21 offset:32768
    ds_read_b64_tr_b16 a[38:39], v21 offset:33280
    v_mfma_f32_16x16x32_bf16 v[108:111], a[48:51], v[72:75], v[108:111]
    ds_read_b64_tr_b16 a[40:41], v22 offset:32768
    s_waitcnt vmcnt(6)
    v_max3_u32 v18, v92, v93, v94
    v_mfma_f32_16x16x32_bf16 v[112:115], a[52:55], v[72:75], v[112:115]
    ds_read_b64_tr_b16 a[42:43], v22 offset:33280
    ds_read_b64_tr_b16 a[44:45], v23 offset:32768
    v_max3_u32 v19, v96, v97, v98
    v_max3_u32 v18, v18, v95, v99
    v_mfma_f32_16x16x32_bf16 v[116:119], a[56:59], v[72:75], v[116:119]
    ds_read_b64_tr_b16 a[46:47], v23 offset:33280
    v_max_u32 v18, v18, v19
    v_cmp_eq_u32 vcc, -1, v18
    v_mfma_f32_16x16x32_bf16 v[14:17], a[60:63], v[72:75], v[14:17]
    ds_read_b64_tr_b16 a[48:49], v20 offset:36864
    ds_read_b64_tr_b16 a[50:51], v20 offset:37376
    s_cbranch_vccnz Lre_2
Lck_2:
    v_mfma_f32_16x16x32_bf16 v[108:111], a[64:67], v[92:95], v[108:111]
    ds_read_b64_tr_b16 a[52:53], v21 offset:36864
    ds_read_b64_tr_b16 a[54:55], v21 offset:37376
    buffer_load_dwordx4 v[60:63], v13, s[28:31], s54 offen offset:1024 sc1
    v_mfma_f32_16x16x32_bf16 v[112:115], a[68:71], v[92:95], v[112:115]
    ds_read_b64_tr_b16 a[56:57], v22 offset:36864
    v_mfma_f32_16x16x32_bf16 v[116:119], a[72:75], v[92:95], v[116:119]
    ds_read_b64_tr_b16 a[58:59], v22 offset:37376
    ds_read_b64_tr_b16 a[60:61], v23 offset:36864
    buffer_load_dwordx4 v[64:67], v13, s[28:31], s54 offen offset:3072 sc1
    v_mfma_f32_16x16x32_bf16 v[14:17], a[76:79], v[92:95], v[14:17]
    ds_read_b64_tr_b16 a[62:63], v23 offset:37376
    v_mfma_f32_16x16x32_bf16 v[108:111], a[80:83], v[96:99], v[108:111]
    ds_read_b64_tr_b16 a[64:65], v20 offset:40960
    ds_read_b64_tr_b16 a[66:67], v20 offset:41472
    s_waitcnt vmcnt(6)
    v_max3_u32 v18, v100, v101, v102
    v_mfma_f32_16x16x32_bf16 v[112:115], a[84:87], v[96:99], v[112:115]
    ds_read_b64_tr_b16 a[68:69], v21 offset:40960
    ds_read_b64_tr_b16 a[70:71], v21 offset:41472
    v_max3_u32 v19, v104, v105, v106
    v_max3_u32 v18, v18, v103, v107
    v_mfma_f32_16x16x32_bf16 v[116:119], a[88:91], v[96:99], v[116:119]
    ds_read_b64_tr_b16 a[72:73], v22 offset:40960
    v_max_u32 v18, v18, v19
    v_cmp_eq_u32 vcc, -1, v18
    v_mfma_f32_16x16x32_bf16 v[14:17], a[92:95], v[96:99], v[14:17]
    ds_read_b64_tr_b16 a[74:75], v22 offset:41472
    ds_read_b64_tr_b16 a[76:77], v23 offset:40960
    s_cbranch_vccnz Lre_3
Lck_3:
    s_setprio 2
    v_mfma_f32_16x16x32_bf16 v[108:111], a[96:99], v[100:103], v[108:111]
    ds_read_b64_tr_b16 a[78:79], v23 offset:41472
    buffer_load_dwordx4 v[68:71], v13, s[28:31], s55 offen offset:1024 sc1
    v_mfma_f32_16x16x32_bf16 v[112:115], a[100:103], v[100:103], v[112:115]
    ds_read_b64_tr_b16 a[80:81], v20 offset:45056
    ds_read_b64_tr_b16 a[82:83], v20 offset:45568
    v_mfma_f32_16x16x32_bf16 v[116:119], a[104:107], v[100:103], v[116:119]
    ds_read_b64_tr_b16 a[84:85], v21 offset:45056
    ds_read_b64_tr_b16 a[86:87], v21 offset:45568
    buffer_load_dwordx4 v[72:75], v13, s[28:31], s55 offen offset:3072 sc1
    v_mfma_f32_16x16x32_bf16 v[14:17], a[108:111], v[100:103], v[14:17]
    ds_read_b64_tr_b16 a[88:89], v22 offset:45056
    v_mfma_f32_16x16x32_bf16 v[108:111], a[112:115], v[104:107], v[108:111]
    ds_read_b64_tr_b16 a[90:91], v22 offset:45568
    ds_read_b64_tr_b16 a[92:93], v23 offset:45056
    s_waitcnt vmcnt(6)
    v_max3_u32 v18, v76, v77, v78
    v_mfma_f32_16x16x32_bf16 v[112:115], a[116:119], v[104:107], v[112:115]
    ds_read_b64_tr_b16 a[94:95], v23 offset:45568
    v_max3_u32 v19, v80, v81, v82
    v_max3_u32 v18, v18, v79, v83
    v_mfma_f32_16x16x32_bf16 v[116:119], a[120:123], v[104:107], v[116:119]
    ds_read_b64_tr_b16 a[96:97], v24 offset:0
    ds_read_b64_tr_b16 a[98:99], v24 offset:512
    v_max_u32 v18, v18, v19
    v_cmp_eq_u32 vcc, -1, v18
    v_mfma_f32_16x16x32_bf16 v[14:17], a[124:127], v[104:107], v[14:17]
    ds_read_b64_tr_b16 a[100:101], v25 offset:0
    ds_read_b64_tr_b16 a[102:103], v25 offset:512
    s_cbranch_vccnz Lre_4
Lck_4:
    s_waitcnt lgkmcnt(15)
    v_mfma_f32_16x16x32_bf16 v[108:111], a[0:3], v[76:79], v[108:111]
    ds_read_b64_tr_b16 a[104:105], v26 offset:0
    buffer_load_dwordx4 v[92:95], v13, s[28:31], s56 offen offset:1024 sc1
    v_mfma_f32_16x16x32_bf16 v[112:115], a[4:7], v[76:79], v[112:115]
    ds_read_b64_tr_b16 a[106:107], v26 offset:512
    ds_read_b64_tr_b16 a[108:109], v27 offset:0
    v_mfma_f32_16x16x32_bf16 v[116:119], a[8:11], v[76:79], v[116:119]
    ds_read_b64_tr_b16 a[110:111], v27 offset:512
    buffer_load_dwordx4 v[96:99], v13, s[28:31], s56 offen offset:3072 sc1
    v_mfma_f32_16x16x32_bf16 v[14:17], a[12:15], v[76:79], v[14:17]
    ds_read_b64_tr_b16 a[112:113], v24 offset:4096
    ds_read_b64_tr_b16 a[114:115], v24 offset:4608
    v_mfma_f32_16x16x32_bf16 v[108:111], a[16:19], v[80:83], v[108:111]
    ds_read_b64_tr_b16 a[116:117], v25 offset:4096
    ds_read_b64_tr_b16 a[118:119], v25 offset:4608
    s_waitcnt vmcnt(6)
    v_max3_u32 v18, v84, v85, v86
    v_mfma_f32_16x16x32_bf16 v[112:115], a[20:23], v[80:83], v[112:115]
    ds_read_b64_tr_b16 a[120:121], v26 offset:4096
    v_max3_u32 v19, v88, v89, v90
    v_max3_u32 v18, v18, v87, v91
    v_mfma_f32_16x16x32_bf16 v[116:119], a[24:27], v[80:83], v[116:119]
    ds_read_b64_tr_b16 a[122:123], v26 offset:4608
    ds_read_b64_tr_b16 a[124:125], v27 offset:4096
    v_max_u32 v18, v18, v19
    v_cmp_eq_u32 vcc, -1, v18
    v_mfma_f32_16x16x32_bf16 v[14:17], a[28:31], v[80:83], v[14:17]
    ds_read_b64_tr_b16 a[126:127], v27 offset:4608
    s_cbranch_vccnz Lre_5
Lck_5:
    v_mfma_f32_16x16x32_bf16 v[108:111], a[32:35], v[84:87], v[108:111]
    ds_read_b64_tr_b16 a[0:1], v24 offset:8192
    ds_read_b64_tr_b16 a[2:3], v24 offset:8704
    buffer_load_dwordx4 v[100:103], v13, s[28:31], s57 offen offset:1024 sc1
    v_mfma_f32_16x16x32_bf16 v[112:115], a[36:39], v[84:87], v[112:115]
    ds_read_b64_tr_b16 a[4:5], v25 offset:8192
    ds_read_b64_tr_b16 a[6:7], v25 offset:8704
    v_mfma_f32_16x16x32_bf16 v[116:119], a[40:43], v[84:87], v[116:119]
    ds_read_b64_tr_b16 a[8:9], v26 offset:8192
    buffer_load_dwordx4 v[104:107], v13, s[28:31], s57 offen offset:3072 sc1
    v_mfma_f32_16x16x32_bf16 v[14:17], a[44:47], v[84:87], v[14:17]
    ds_read_b64_tr_b16 a[10:11], v26 offset:8704
    ds_read_b64_tr_b16 a[12:13], v27 offset:8192
    v_mfma_f32_16x16x32_bf16 v[108:111], a[48:51], v[88:91], v[108:111]
    ds_read_b64_tr_b16 a[14:15], v27 offset:8704
    s_waitcnt vmcnt(6)
    v_max3_u32 v18, v60, v61, v62
    v_mfma_f32_16x16x32_bf16 v[112:115], a[52:55], v[88:91], v[112:115]
    ds_read_b64_tr_b16 a[16:17], v24 offset:12288
    ds_read_b64_tr_b16 a[18:19], v24 offset:12800
    v_max3_u32 v19, v64, v65, v66
    v_max3_u32 v18, v18, v63, v67
    v_mfma_f32_16x16x32_bf16 v[116:119], a[56:59], v[88:91], v[116:119]
    ds_read_b64_tr_b16 a[20:21], v25 offset:12288
    ds_read_b64_tr_b16 a[22:23], v25 offset:12800
    v_max_u32 v18, v18, v19
    v_cmp_eq_u32 vcc, -1, v18
    v_mfma_f32_16x16x32_bf16 v[14:17], a[60:63], v[88:91], v[14:17]
    ds_read_b64_tr_b16 a[24:25], v26 offset:12288
    s_cbranch_vccnz Lre_6
Lck_6:
    s_setprio 1
    s_waitcnt lgkmcnt(15)
    v_mfma_f32_16x16x32_bf16 v[108:111], a[64:67], v[60:63], v[108:111]
    ds_read_b64_tr_b16 a[26:27], v26 offset:12800
    ds_read_b64_tr_b16 a[28:29], v27 offset:12288
    v_mfma_f32_16x16x32_bf16 v[112:115], a[68:71], v[60:63], v[112:115]
    ds_read_b64_tr_b16 a[30:31], v27 offset:12800
    v_mfma_f32_16x16x32_bf16 v[116:119], a[72:75], v[60:63], v[116:119]
    ds_read_b64_tr_b16 a[32:33], v20 offset:49152
    ds_read_b64_tr_b16 a[34:35], v20 offset:49664
    v_mfma_f32_16x16x32_bf16 v[14:17], a[76:79], v[60:63], v[14:17]
    ds_read_b64_tr_b16 a[36:37], v21 offset:49152
    ds_read_b64_tr_b16 a[38:39], v21 offset:49664
    v_mfma_f32_16x16x32_bf16 v[108:111], a[80:83], v[64:67], v[108:111]
    ds_read_b64_tr_b16 a[40:41], v22 offset:49152
    s_waitcnt vmcnt(4)
    v_max3_u32 v18, v68, v69, v70
    v_mfma_f32_16x16x32_bf16 v[112:115], a[84:87], v[64:67], v[112:115]
    ds_read_b64_tr_b16 a[42:43], v22 offset:49664
    ds_read_b64_tr_b16 a[44:45], v23 offset:49152
    v_max3_u32 v19, v72, v73, v74
    v_max3_u32 v18, v18, v71, v75
    v_mfma_f32_16x16x32_bf16 v[116:119], a[88:91], v[64:67], v[116:119]
    ds_read_b64_tr_b16 a[46:47], v23 offset:49664
    v_max_u32 v18, v18, v19
    v_cmp_eq_u32 vcc, -1, v18
    v_mfma_f32_16x16x32_bf16 v[14:17], a[92:95], v[64:67], v[14:17]
    ds_read_b64_tr_b16 a[48:49], v24 offset:24576
    ds_read_b64_tr_b16 a[50:51], v24 offset:25088
    s_cbranch_vccnz Lre_7
Lck_7:
    v_mfma_f32_16x16x32_bf16 v[108:111], a[96:99], v[68:71], v[108:111]
    ds_read_b64_tr_b16 a[52:53], v25 offset:24576
    ds_read_b64_tr_b16 a[54:55], v25 offset:25088
    v_mfma_f32_16x16x32_bf16 v[112:115], a[100:103], v[68:71], v[112:115]
    ds_read_b64_tr_b16 a[56:57], v26 offset:24576
    v_mfma_f32_16x16x32_bf16 v[116:119], a[104:107], v[68:71], v[116:119]
    ds_read_b64_tr_b16 a[58:59], v26 offset:25088
    ds_read_b64_tr_b16 a[60:61], v27 offset:24576
    v_mfma_f32_16x16x32_bf16 v[14:17], a[108:111], v[68:71], v[14:17]
    ds_read_b64_tr_b16 a[62:63], v27 offset:25088
    s_waitcnt lgkmcnt(15)
    v_mfma_f32_16x16x32_bf16 v[108:111], a[112:115], v[72:75], v[108:111]
    s_waitcnt vmcnt(2)
    v_max3_u32 v18, v92, v93, v94
    v_mfma_f32_16x16x32_bf16 v[112:115], a[116:119], v[72:75], v[112:115]
    v_max3_u32 v19, v96, v97, v98
    v_max3_u32 v18, v18, v95, v99
    v_mfma_f32_16x16x32_bf16 v[116:119], a[120:123], v[72:75], v[116:119]
    v_max_u32 v18, v18, v19
    v_cmp_eq_u32 vcc, -1, v18
    v_mfma_f32_16x16x32_bf16 v[14:17], a[124:127], v[72:75], v[14:17]
    s_cbranch_vccnz Lre_8
Lck_8:
    s_setprio 0
    v_mfma_f32_16x16x32_bf16 v[108:111], a[0:3], v[92:95], v[108:111]
    v_mfma_f32_16x16x32_bf16 v[112:115], a[4:7], v[92:95], v[112:115]
    v_mfma_f32_16x16x32_bf16 v[116:119], a[8:11], v[92:95], v[116:119]
    v_mfma_f32_16x16x32_bf16 v[14:17], a[12:15], v[92:95], v[14:17]
    v_mfma_f32_16x16x32_bf16 v[108:111], a[16:19], v[96:99], v[108:111]
    s_waitcnt vmcnt(0)
    v_max3_u32 v18, v100, v101, v102
    v_mfma_f32_16x16x32_bf16 v[112:115], a[20:23], v[96:99], v[112:115]
    v_max3_u32 v19, v104, v105, v106
    v_max3_u32 v18, v18, v103, v107
    v_mfma_f32_16x16x32_bf16 v[116:119], a[24:27], v[96:99], v[116:119]
    v_max_u32 v18, v18, v19
    v_cmp_eq_u32 vcc, -1, v18
    v_mfma_f32_16x16x32_bf16 v[14:17], a[28:31], v[96:99], v[14:17]
    s_cbranch_vccnz Lre_9
Lck_9:
    s_waitcnt lgkmcnt(8)
    v_mfma_f32_16x16x32_bf16 v[108:111], a[32:35], v[100:103], v[108:111]
    v_mfma_f32_16x16x32_bf16 v[112:115], a[36:39], v[100:103], v[112:115]
    v_mfma_f32_16x16x32_bf16 v[116:119], a[40:43], v[100:103], v[116:119]
    v_mfma_f32_16x16x32_bf16 v[14:17], a[44:47], v[100:103], v[14:17]
    s_waitcnt lgkmcnt(0)
    v_mfma_f32_16x16x32_bf16 v[108:111], a[48:51], v[104:107], v[108:111]
    v_mfma_f32_16x16x32_bf16 v[112:115], a[52:55], v[104:107], v[112:115]
    v_mfma_f32_16x16x32_bf16 v[116:119], a[56:59], v[104:107], v[116:119]
    v_mfma_f32_16x16x32_bf16 v[14:17], a[60:63], v[104:107], v[14:17]
    v_xor_b32 v60, 32, v124
    v_xor_b32 v61, 64, v124
    v_xor_b32 v62, 96, v124
    v_cmp_eq_u32 s[36:37], v8, v126
    v_cmp_eq_u32 s[38:39], v9, v126
    s_nop 0
    s_or_b64 vcc, s[36:37], s[38:39]
    s_cbranch_scc1 Lfix
Lnofix:
    v_fma_f32 v108, v108, v44, v28
    v_fma_f32 v109, v109, v45, v29
    v_fma_f32 v110, v110, v46, v30
    v_fma_f32 v111, v111, v47, v31
    v_cvt_pk_bf16_f32 v68, v108, v109
    v_cvt_pk_bf16_f32 v69, v110, v111
    ds_write_b64 v124, v[68:69]
    v_fma_f32 v112, v112, v48, v32
    v_fma_f32 v113, v113, v49, v33
    v_fma_f32 v114, v114, v50, v34
    v_fma_f32 v115, v115, v51, v35
    v_cvt_pk_bf16_f32 v70, v112, v113
    v_cvt_pk_bf16_f32 v71, v114, v115
    ds_write_b64 v60, v[70:71]
    v_fma_f32 v116, v116, v52, v36
    v_fma_f32 v117, v117, v53, v37
    v_fma_f32 v118, v118, v54, v38
    v_fma_f32 v119, v119, v55, v39
    v_cvt_pk_bf16_f32 v72, v116, v117
    v_cvt_pk_bf16_f32 v73, v118, v119
    ds_write_b64 v61, v[72:73]
    v_fma_f32 v14, v14, v56, v40
    v_fma_f32 v15, v15, v57, v41
    v_fma_f32 v16, v16, v58, v42
    v_fma_f32 v17, v17, v59, v43
    v_cvt_pk_bf16_f32 v74, v14, v15
    v_cvt_pk_bf16_f32 v75, v16, v17
    ds_write_b64 v62, v[74:75]
    ds_read_b128 v[76:79], v125 offset:0
    ds_read_b128 v[80:83], v125 offset:1024
    s_waitcnt lgkmcnt(1)
    buffer_store_dwordx4 v[76:79], v122, s[48:51], s24 offen sc0 sc1
    s_waitcnt lgkmcnt(0)
    buffer_store_dwordx4 v[80:83], v123, s[48:51], s24 offen sc0 sc1
    s_endpgm
Lh1:
    ds_write_b128 v125, v[44:47] offset:0
    ds_write_b128 v125, v[48:51] offset:1024
    v_mov_b32 v5, 157972
    v_mov_b32 v6, 1
    s_mov_b64 exec, 1
    ds_add_u32 v5, v6
    s_mov_b64 exec, -1
    v_fmac_f32 v28, v76, v120
    v_fmac_f32 v29, v77, v120
    v_fmac_f32 v30, v78, v120
    v_fmac_f32 v31, v79, v120
    v_cvt_pk_bf16_f32 v28, v28, v29
    v_cvt_pk_bf16_f32 v29, v30, v31
    v_fmac_f32 v32, v80, v120
    v_fmac_f32 v33, v81, v120
    v_fmac_f32 v34, v82, v120
    v_fmac_f32 v35, v83, v120
    v_cvt_pk_bf16_f32 v30, v32, v33
    v_cvt_pk_bf16_f32 v31, v34, v35
    v_fmac_f32 v36, v84, v120
    v_fmac_f32 v37, v85, v120
    v_fmac_f32 v38, v86, v120
    v_fmac_f32 v39, v87, v120
    v_cvt_pk_bf16_f32 v32, v36, v37
    v_cvt_pk_bf16_f32 v33, v38, v39
    v_fmac_f32 v40, v88, v120
    v_fmac_f32 v41, v89, v120
    v_fmac_f32 v42, v90, v120
    v_fmac_f32 v43, v91, v120
    v_cvt_pk_bf16_f32 v34, v40, v41
    v_cvt_pk_bf16_f32 v35, v42, v43
    v_subrev_u32 v4, 6144, v125
    v_mov_b32 v8, s22
    v_mov_b32 v9, s22
    v_mov_b32 v10, s22
    v_mov_b32 v11, s22
Lcw_2:
    s_sub_u32 s35, s35, 1
    s_cbranch_scc1 Lend
    ds_read_b32 v6, v5
    s_waitcnt lgkmcnt(0)
    v_readfirstlane_b32 s38, v6
    s_nop 0
    s_cmp_lt_u32 s38, 8
    s_cbranch_scc1 Lcw_2
    ds_read_b128 v[52:55], v125 offset:2048
    ds_read_b128 v[56:59], v125 offset:3072
    ds_read_b128 v[44:47], v4 offset:4096
    ds_read_b128 v[48:51], v4 offset:5120
    s_branch Lh_join
Lqf_re:
    s_sub_u32 s35, s35, 1
    s_cbranch_scc1 Lend
    ds_read_b32 v7, v96
    ds_read_b128 v[76:79], v95 offset:0
    ds_read_b128 v[80:83], v95 offset:64
    ds_read_b128 v[84:87], v95 offset:128
    ds_read_b128 v[88:91], v95 offset:192
    s_waitcnt lgkmcnt(0)
    s_branch Lqf
Lcsv_re:
    s_sub_u32 s35, s35, 1
    s_cbranch_scc1 Lend
    ds_read_b32 v46, v49
    ds_read_b64 v[44:45], v48
    s_waitcnt lgkmcnt(0)
    s_branch Lcsv
Lrx_re:
    s_sub_u32 s35, s35, 1
    s_cbranch_scc1 Lend
    buffer_load_dwordx2 v[52:53], v13, s[28:31], s59 offen offset:8 sc1
    buffer_load_dwordx2 v[54:55], v13, s[28:31], s60 offen offset:0 sc1
    s_waitcnt vmcnt(0)
    s_branch Lrx_chk
Linfo_re:
    s_sub_u32 s35, s35, 1
    s_cbranch_scc1 Lend
    ds_read_b64 v[8:9], v10
    s_waitcnt lgkmcnt(0)
    s_branch Linfo
Lfl_re:
    s_sub_u32 s35, s35, 1
    s_cbranch_scc1 Lend
    buffer_load_dword v20, v12, s[28:31], s24 offen sc1
    s_waitcnt vmcnt(0)
    s_branch Lfl_chk
Lxe0:
    ds_read_b64 v[108:109], v4
    ds_read_b64 v[110:111], v5
    ds_read_b64 v[112:113], v6
    ds_read_b64 v[114:115], v7
    s_branch Lxe0_b
Lxe1:
    ds_read_b64 v[108:109], v4
    ds_read_b64 v[110:111], v5
    ds_read_b64 v[112:113], v6
    ds_read_b64 v[114:115], v7
    s_branch Lxe1_b
Lxe2:
    ds_read_b64 v[108:109], v4
    ds_read_b64 v[110:111], v5
    ds_read_b64 v[112:113], v6
    ds_read_b64 v[114:115], v7
    s_branch Lxe2_b
Lxe3:
    ds_read_b64 v[108:109], v4
    ds_read_b64 v[110:111], v5
    ds_read_b64 v[112:113], v6
    ds_read_b64 v[114:115], v7
    s_branch Lxe3_b
Lxe4:
    ds_read_b64 v[108:109], v4
    ds_read_b64 v[110:111], v5
    ds_read_b64 v[112:113], v6
    ds_read_b64 v[114:115], v7
    s_branch Lxe4_b
Lxe5:
    ds_read_b64 v[108:109], v4
    ds_read_b64 v[110:111], v5
    ds_read_b64 v[112:113], v6
    ds_read_b64 v[114:115], v7
    s_branch Lxe5_b
Lxe6:
    ds_read_b64 v[108:109], v4
    ds_read_b64 v[110:111], v5
    ds_read_b64 v[112:113], v6
    ds_read_b64 v[114:115], v7
    s_branch Lxe6_b
Lxe7:
    ds_read_b64 v[108:109], v4
    ds_read_b64 v[110:111], v5
    ds_read_b64 v[112:113], v6
    ds_read_b64 v[114:115], v7
    s_branch Lxe7_b
Lxe8:
    ds_read_b64 v[108:109], v4
    ds_read_b64 v[110:111], v5
    ds_read_b64 v[112:113], v6
    ds_read_b64 v[114:115], v7
    s_branch Lxe8_b
Lxe9:
    ds_read_b64 v[108:109], v4
    ds_read_b64 v[110:111], v5
    ds_read_b64 v[112:113], v6
    ds_read_b64 v[114:115], v7
    s_branch Lxe9_b
Lre_0:
    s_mov_b32 s41, 1
    s_sub_u32 s35, s35, 1
    s_cbranch_scc1 Lend
    s_sleep 2
    buffer_load_dwordx4 v[60:63], v13, s[28:31], s53 offen offset:0 sc1
    buffer_load_dwordx4 v[64:67], v13, s[28:31], s53 offen offset:2048 sc1
    s_waitcnt vmcnt(0)
    v_max3_u32 v18, v60, v61, v62
    v_max3_u32 v19, v64, v65, v66
    v_max3_u32 v18, v18, v63, v67
    v_max_u32 v18, v18, v19
    v_cmp_eq_u32 vcc, -1, v18
    s_nop 0
    s_cbranch_vccnz Lre_0
    buffer_load_dwordx4 v[68:71], v13, s[28:31], s54 offen offset:0 sc1
    buffer_load_dwordx4 v[72:75], v13, s[28:31], s54 offen offset:2048 sc1
    buffer_load_dwordx4 v[92:95], v13, s[28:31], s55 offen offset:0 sc1
    buffer_load_dwordx4 v[96:99], v13, s[28:31], s55 offen offset:2048 sc1
    buffer_load_dwordx4 v[100:103], v13, s[28:31], s56 offen offset:0 sc1
    buffer_load_dwordx4 v[104:107], v13, s[28:31], s56 offen offset:2048 sc1
    s_branch Lck_0
Lre_1:
    s_mov_b32 s41, 1
    s_sub_u32 s35, s35, 1
    s_cbranch_scc1 Lend
    s_sleep 2
    buffer_load_dwordx4 v[68:71], v13, s[28:31], s54 offen offset:0 sc1
    buffer_load_dwordx4 v[72:75], v13, s[28:31], s54 offen offset:2048 sc1
    s_waitcnt vmcnt(0)
    v_max3_u32 v18, v68, v69, v70
    v_max3_u32 v19, v72, v73, v74
    v_max3_u32 v18, v18, v71, v75
    v_max_u32 v18, v18, v19
    v_cmp_eq_u32 vcc, -1, v18
    s_nop 0
    s_cbranch_vccnz Lre_1
    buffer_load_dwordx4 v[92:95], v13, s[28:31], s55 offen offset:0 sc1
    buffer_load_dwordx4 v[96:99], v13, s[28:31], s55 offen offset:2048 sc1
    buffer_load_dwordx4 v[100:103], v13, s[28:31], s56 offen offset:0 sc1
    buffer_load_dwordx4 v[104:107], v13, s[28:31], s56 offen offset:2048 sc1
    buffer_load_dwordx4 v[76:79], v13, s[28:31], s57 offen offset:0 sc1
    buffer_load_dwordx4 v[80:83], v13, s[28:31], s57 offen offset:2048 sc1
    s_branch Lck_1
Lre_2:
    s_mov_b32 s41, 1
    s_sub_u32 s35, s35, 1
    s_cbranch_scc1 Lend
    s_sleep 2
    buffer_load_dwordx4 v[92:95], v13, s[28:31], s55 offen offset:0 sc1
    buffer_load_dwordx4 v[96:99], v13, s[28:31], s55 offen offset:2048 sc1
    s_waitcnt vmcnt(0)
    v_max3_u32 v18, v92, v93, v94
    v_max3_u32 v19, v96, v97, v98
    v_max3_u32 v18, v18, v95, v99
    v_max_u32 v18, v18, v19
    v_cmp_eq_u32 vcc, -1, v18
    s_nop 0
    s_cbranch_vccnz Lre_2
    buffer_load_dwordx4 v[100:103], v13, s[28:31], s56 offen offset:0 sc1
    buffer_load_dwordx4 v[104:107], v13, s[28:31], s56 offen offset:2048 sc1
    buffer_load_dwordx4 v[76:79], v13, s[28:31], s57 offen offset:0 sc1
    buffer_load_dwordx4 v[80:83], v13, s[28:31], s57 offen offset:2048 sc1
    buffer_load_dwordx4 v[84:87], v13, s[28:31], s53 offen offset:1024 sc1
    buffer_load_dwordx4 v[88:91], v13, s[28:31], s53 offen offset:3072 sc1
    s_branch Lck_2
Lre_3:
    s_mov_b32 s41, 1
    s_sub_u32 s35, s35, 1
    s_cbranch_scc1 Lend
    s_sleep 2
    buffer_load_dwordx4 v[100:103], v13, s[28:31], s56 offen offset:0 sc1
    buffer_load_dwordx4 v[104:107], v13, s[28:31], s56 offen offset:2048 sc1
    s_waitcnt vmcnt(0)
    v_max3_u32 v18, v100, v101, v102
    v_max3_u32 v19, v104, v105, v106
    v_max3_u32 v18, v18, v103, v107
    v_max_u32 v18, v18, v19
    v_cmp_eq_u32 vcc, -1, v18
    s_nop 0
    s_cbranch_vccnz Lre_3
    buffer_load_dwordx4 v[76:79], v13, s[28:31], s57 offen offset:0 sc1
    buffer_load_dwordx4 v[80:83], v13, s[28:31], s57 offen offset:2048 sc1
    buffer_load_dwordx4 v[84:87], v13, s[28:31], s53 offen offset:1024 sc1
    buffer_load_dwordx4 v[88:91], v13, s[28:31], s53 offen offset:3072 sc1
    buffer_load_dwordx4 v[60:63], v13, s[28:31], s54 offen offset:1024 sc1
    buffer_load_dwordx4 v[64:67], v13, s[28:31], s54 offen offset:3072 sc1
    s_branch Lck_3
Lre_4:
    s_mov_b32 s41, 1
    s_sub_u32 s35, s35, 1
    s_cbranch_scc1 Lend
    s_sleep 2
    buffer_load_dwordx4 v[76:79], v13, s[28:31], s57 offen offset:0 sc1
    buffer_load_dwordx4 v[80:83], v13, s[28:31], s57 offen offset:2048 sc1
    s_waitcnt vmcnt(0)
    v_max3_u32 v18, v76, v77, v78
    v_max3_u32 v19, v80, v81, v82
    v_max3_u32 v18, v18, v79, v83
    v_max_u32 v18, v18, v19
    v_cmp_eq_u32 vcc, -1, v18
    s_nop 0
    s_cbranch_vccnz Lre_4
    buffer_load_dwordx4 v[84:87], v13, s[28:31], s53 offen offset:1024 sc1
    buffer_load_dwordx4 v[88:91], v13, s[28:31], s53 offen offset:3072 sc1
    buffer_load_dwordx4 v[60:63], v13, s[28:31], s54 offen offset:1024 sc1
    buffer_load_dwordx4 v[64:67], v13, s[28:31], s54 offen offset:3072 sc1
    buffer_load_dwordx4 v[68:71], v13, s[28:31], s55 offen offset:1024 sc1
    buffer_load_dwordx4 v[72:75], v13, s[28:31], s55 offen offset:3072 sc1
    s_branch Lck_4
Lre_5:
    s_mov_b32 s41, 1
    s_sub_u32 s35, s35, 1
    s_cbranch_scc1 Lend
    s_sleep 2
    buffer_load_dwordx4 v[84:87], v13, s[28:31], s53 offen offset:1024 sc1
    buffer_load_dwordx4 v[88:91], v13, s[28:31], s53 offen offset:3072 sc1
    s_waitcnt vmcnt(0)
    v_max3_u32 v18, v84, v85, v86
    v_max3_u32 v19, v88, v89, v90
    v_max3_u32 v18, v18, v87, v91
    v_max_u32 v18, v18, v19
    v_cmp_eq_u32 vcc, -1, v18
    s_nop 0
    s_cbranch_vccnz Lre_5
    buffer_load_dwordx4 v[60:63], v13, s[28:31], s54 offen offset:1024 sc1
    buffer_load_dwordx4 v[64:67], v13, s[28:31], s54 offen offset:3072 sc1
    buffer_load_dwordx4 v[68:71], v13, s[28:31], s55 offen offset:1024 sc1
    buffer_load_dwordx4 v[72:75], v13, s[28:31], s55 offen offset:3072 sc1
    buffer_load_dwordx4 v[92:95], v13, s[28:31], s56 offen offset:1024 sc1
    buffer_load_dwordx4 v[96:99], v13, s[28:31], s56 offen offset:3072 sc1
    s_branch Lck_5
Lre_6:
    s_mov_b32 s41, 1
    s_sub_u32 s35, s35, 1
    s_cbranch_scc1 Lend
    s_sleep 2
    buffer_load_dwordx4 v[60:63], v13, s[28:31], s54 offen offset:1024 sc1
    buffer_load_dwordx4 v[64:67], v13, s[28:31], s54 offen offset:3072 sc1
    s_waitcnt vmcnt(0)
    v_max3_u32 v18, v60, v61, v62
    v_max3_u32 v19, v64, v65, v66
    v_max3_u32 v18, v18, v63, v67
    v_max_u32 v18, v18, v19
    v_cmp_eq_u32 vcc, -1, v18
    s_nop 0
    s_cbranch_vccnz Lre_6
    buffer_load_dwordx4 v[68:71], v13, s[28:31], s55 offen offset:1024 sc1
    buffer_load_dwordx4 v[72:75], v13, s[28:31], s55 offen offset:3072 sc1
    buffer_load_dwordx4 v[92:95], v13, s[28:31], s56 offen offset:1024 sc1
    buffer_load_dwordx4 v[96:99], v13, s[28:31], s56 offen offset:3072 sc1
    buffer_load_dwordx4 v[100:103], v13, s[28:31], s57 offen offset:1024 sc1
    buffer_load_dwordx4 v[104:107], v13, s[28:31], s57 offen offset:3072 sc1
    s_branch Lck_6
Lre_7:
    s_mov_b32 s41, 1
    s_sub_u32 s35, s35, 1
    s_cbranch_scc1 Lend
    s_sleep 2
    buffer_load_dwordx4 v[68:71], v13, s[28:31], s55 offen offset:1024 sc1
    buffer_load_dwordx4 v[72:75], v13, s[28:31], s55 offen offset:3072 sc1
    s_waitcnt vmcnt(0)
    v_max3_u32 v18, v68, v69, v70
    v_max3_u32 v19, v72, v73, v74
    v_max3_u32 v18, v18, v71, v75
    v_max_u32 v18, v18, v19
    v_cmp_eq_u32 vcc, -1, v18
    s_nop 0
    s_cbranch_vccnz Lre_7
    buffer_load_dwordx4 v[92:95], v13, s[28:31], s56 offen offset:1024 sc1
    buffer_load_dwordx4 v[96:99], v13, s[28:31], s56 offen offset:3072 sc1
    buffer_load_dwordx4 v[100:103], v13, s[28:31], s57 offen offset:1024 sc1
    buffer_load_dwordx4 v[104:107], v13, s[28:31], s57 offen offset:3072 sc1
    s_branch Lck_7
Lre_8:
    s_mov_b32 s41, 1
    s_sub_u32 s35, s35, 1
    s_cbranch_scc1 Lend
    s_sleep 2
    buffer_load_dwordx4 v[92:95], v13, s[28:31], s56 offen offset:1024 sc1
    buffer_load_dwordx4 v[96:99], v13, s[28:31], s56 offen offset:3072 sc1
    s_waitcnt vmcnt(0)
    v_max3_u32 v18, v92, v93, v94
    v_max3_u32 v19, v96, v97, v98
    v_max3_u32 v18, v18, v95, v99
    v_max_u32 v18, v18, v19
    v_cmp_eq_u32 vcc, -1, v18
    s_nop 0
    s_cbranch_vccnz Lre_8
    buffer_load_dwordx4 v[100:103], v13, s[28:31], s57 offen offset:1024 sc1
    buffer_load_dwordx4 v[104:107], v13, s[28:31], s57 offen offset:3072 sc1
    s_branch Lck_8
Lre_9:
    s_mov_b32 s41, 1
    s_sub_u32 s35, s35, 1
    s_cbranch_scc1 Lend
    s_sleep 2
    buffer_load_dwordx4 v[100:103], v13, s[28:31], s57 offen offset:1024 sc1
    buffer_load_dwordx4 v[104:107], v13, s[28:31], s57 offen offset:3072 sc1
    s_waitcnt vmcnt(0)
    v_max3_u32 v18, v100, v101, v102
    v_max3_u32 v19, v104, v105, v106
    v_max3_u32 v18, v18, v103, v107
    v_max_u32 v18, v18, v19
    v_cmp_eq_u32 vcc, -1, v18
    s_nop 0
    s_cbranch_vccnz Lre_9
    s_branch Lck_9
Lfix:
    s_mov_b64 vcc, s[38:39]
    v_lshlrev_b32 v6, 4, v2
    v_add_u32 v6, 158208, v6
    v_mov_b32 v10, 157956
Lcw_5:
    s_sub_u32 s35, s35, 1
    s_cbranch_scc1 Lend
    ds_read_b32 v11, v10
    s_waitcnt lgkmcnt(0)
    v_readfirstlane_b32 s38, v11
    s_nop 0
    s_cmp_lt_u32 s38, 1
    s_cbranch_scc1 Lcw_5
    s_mov_b64 exec, s[36:37]
    ds_read_b128 v[44:47], v6 offset:0
    ds_read_b128 v[48:51], v6 offset:64
    ds_read_b128 v[52:55], v6 offset:128
    ds_read_b128 v[56:59], v6 offset:192
    s_mov_b64 exec, vcc
    ds_read_b128 v[44:47], v6 offset:256
    ds_read_b128 v[48:51], v6 offset:320
    ds_read_b128 v[52:55], v6 offset:384
    ds_read_b128 v[56:59], v6 offset:448
    s_mov_b64 exec, -1
    s_waitcnt lgkmcnt(0)
    s_branch Lnofix
Lhalo:
    s_mov_b32 vcc_lo, 0x00010001
    s_mov_b32 vcc_hi, 0x00010001
    v_mov_b32 v11, 38912
    v_cndmask_b32 v76, v76, v11, vcc
    v_xor_b32 v77, 64, v76
    v_add_u32 v80, 78080, v76
    v_add_u32 v81, 78080, v77
    v_mov_b32 v14, 0x3f803f80
    v_mov_b32 v15, 0x3f803f80
    v_mov_b32 v16, 0x3f803f80
    v_mov_b32 v17, 0x3f803f80
    v_and_b32 v4, 7, v1
    v_lshlrev_b32 v4, 4, v4
    v_mul_u32_u24 v5, 39040, v2
    v_add_u32 v4, v4, v5
    ds_write_b128 v4, v[14:17] offset:38912
    v_mov_b32 v4, 157952
    v_mov_b32 v8, 0
    v_mov_b32 v9, 0
    v_mov_b32 v10, -2
    v_mov_b32 v11, -2
    ds_write_b128 v4, v[8:11]
    v_min_u32 v5, 23, v1
    v_lshl_add_u32 v5, v5, 2, v4
    ds_write_b32 v5, v8 offset:16
    s_mul_i32 s36, s32, 96
    s_sub_u32 s36, s36, 16
    v_add_u32 v96, s36, v1
    v_min_u32 v5, 47, v1
    v_add3_u32 v97, s36, v5, 64
    v_mov_b32 v6, 2047
    v_med3_i32 v96, v96, 0, v6
    v_med3_i32 v97, v97, 0, v6
    v_lshlrev_b32 v96, 3, v96
    v_lshlrev_b32 v97, 3, v97
    s_mov_b32 s46, 8192000
    v_mov_b32 v127, 157984
    s_lshl_b32 s36, s3, 2
    s_add_u32 s36, s36, 158016
    v_mov_b32 v10, s36
    s_mov_b32 vcc_lo, 0x00010001
    s_mov_b32 vcc_hi, 0x00010001
    v_cndmask_b32 v116, 0, v14, vcc
    v_cndmask_b32 v117, 0, v15, vcc
    v_cndmask_b32 v118, 0, v16, vcc
    v_cndmask_b32 v119, 0, v17, vcc
    s_waitcnt vmcnt(0)
    s_waitcnt lgkmcnt(0)
    s_barrier
    s_add_u32 s34, s34, 0x9e3779b8
    s_or_b32 s34, s34, 1
    ds_read_b128 v[108:111], v76 offset:0
    ds_read_b128 v[112:115], v77 offset:0
    ds_read_b64_tr_b16 a[0:1], v20 offset:0
    ds_read_b64_tr_b16 a[2:3], v20 offset:512
    ds_read_b64_tr_b16 a[4:5], v21 offset:0
    ds_read_b64_tr_b16 a[6:7], v21 offset:512
    ds_read_b64_tr_b16 a[8:9], v22 offset:0
    ds_read_b64_tr_b16 a[10:11], v22 offset:512
    ds_read_b64_tr_b16 a[12:13], v23 offset:0
    ds_read_b64_tr_b16 a[14:15], v23 offset:512
    ds_read_b64_tr_b16 a[16:17], v20 offset:8192
    ds_read_b64_tr_b16 a[18:19], v20 offset:8704
    ds_read_b64_tr_b16 a[20:21], v21 offset:8192
    ds_read_b64_tr_b16 a[22:23], v21 offset:8704
    ds_read_b64_tr_b16 a[24:25], v22 offset:8192
    ds_read_b64_tr_b16 a[26:27], v22 offset:8704
    s_waitcnt lgkmcnt(12)
    v_mfma_f32_16x16x32_bf16 v[28:31], a[0:3], v[116:119], 0
    ds_read_b64_tr_b16 a[28:29], v23 offset:8192
    ds_read_b64_tr_b16 a[30:31], v23 offset:8704
    s_waitcnt lgkmcnt(12)
    v_mfma_f32_16x16x32_bf16 v[32:35], a[4:7], v[116:119], 0
    ds_read_b64_tr_b16 a[32:33], v20 offset:16384
    ds_read_b64_tr_b16 a[34:35], v20 offset:16896
    s_waitcnt lgkmcnt(12)
    v_mfma_f32_16x16x32_bf16 v[36:39], a[8:11], v[116:119], 0
    ds_read_b64_tr_b16 a[36:37], v21 offset:16384
    ds_read_b64_tr_b16 a[38:39], v21 offset:16896
    s_waitcnt lgkmcnt(12)
    v_mfma_f32_16x16x32_bf16 v[40:43], a[12:15], v[116:119], 0
    ds_read_b64_tr_b16 a[40:41], v22 offset:16384
    ds_read_b64_tr_b16 a[42:43], v22 offset:16896
    s_waitcnt lgkmcnt(12)
    v_mfma_f32_16x16x32_bf16 v[44:47], a[16:19], v[108:111], 0
    ds_read_b64_tr_b16 a[44:45], v23 offset:16384
    ds_read_b64_tr_b16 a[46:47], v23 offset:16896
    s_waitcnt lgkmcnt(12)
    v_mfma_f32_16x16x32_bf16 v[48:51], a[20:23], v[108:111], 0
    ds_read_b64_tr_b16 a[48:49], v20 offset:4096
    ds_read_b64_tr_b16 a[50:51], v20 offset:4608
    s_waitcnt lgkmcnt(12)
    v_mfma_f32_16x16x32_bf16 v[52:55], a[24:27], v[108:111], 0
    ds_read_b64_tr_b16 a[52:53], v21 offset:4096
    ds_read_b64_tr_b16 a[54:55], v21 offset:4608
    s_waitcnt lgkmcnt(12)
    v_mfma_f32_16x16x32_bf16 v[56:59], a[28:31], v[108:111], 0
    ds_read_b64_tr_b16 a[56:57], v22 offset:4096
    ds_read_b64_tr_b16 a[58:59], v22 offset:4608
    s_waitcnt lgkmcnt(12)
    v_mfma_f32_16x16x32_bf16 v[60:63], v[108:111], a[32:35], 0
    ds_read_b64_tr_b16 a[60:61], v23 offset:4096
    ds_read_b64_tr_b16 a[62:63], v23 offset:4608
    s_waitcnt lgkmcnt(12)
    v_mfma_f32_16x16x32_bf16 v[64:67], v[108:111], a[36:39], 0
    ds_read_b64_tr_b16 a[64:65], v20 offset:12288
    ds_read_b64_tr_b16 a[66:67], v20 offset:12800
    s_waitcnt lgkmcnt(12)
    v_mfma_f32_16x16x32_bf16 v[68:71], v[108:111], a[40:43], 0
    ds_read_b64_tr_b16 a[68:69], v21 offset:12288
    ds_read_b64_tr_b16 a[70:71], v21 offset:12800
    s_waitcnt lgkmcnt(12)
    v_mfma_f32_16x16x32_bf16 v[72:75], v[108:111], a[44:47], 0
    ds_read_b64_tr_b16 a[72:73], v22 offset:12288
    ds_read_b64_tr_b16 a[74:75], v22 offset:12800
    s_waitcnt lgkmcnt(12)
    v_mfma_f32_16x16x32_bf16 v[28:31], a[48:51], v[116:119], v[28:31]
    ds_read_b64_tr_b16 a[76:77], v23 offset:12288
    ds_read_b64_tr_b16 a[78:79], v23 offset:12800
    s_waitcnt lgkmcnt(12)
    v_mfma_f32_16x16x32_bf16 v[32:35], a[52:55], v[116:119], v[32:35]
    ds_read_b64_tr_b16 a[80:81], v20 offset:20480
    ds_read_b64_tr_b16 a[82:83], v20 offset:20992
    s_waitcnt lgkmcnt(12)
    v_mfma_f32_16x16x32_bf16 v[36:39], a[56:59], v[116:119], v[36:39]
    ds_read_b64_tr_b16 a[84:85], v21 offset:20480
    ds_read_b64_tr_b16 a[86:87], v21 offset:20992
    s_waitcnt lgkmcnt(12)
    v_mfma_f32_16x16x32_bf16 v[40:43], a[60:63], v[116:119], v[40:43]
    ds_read_b64_tr_b16 a[88:89], v22 offset:20480
    ds_read_b64_tr_b16 a[90:91], v22 offset:20992
    s_waitcnt lgkmcnt(12)
    v_mfma_f32_16x16x32_bf16 v[44:47], a[64:67], v[112:115], v[44:47]
    ds_read_b64_tr_b16 a[92:93], v23 offset:20480
    ds_read_b64_tr_b16 a[94:95], v23 offset:20992
    s_waitcnt lgkmcnt(12)
    v_mfma_f32_16x16x32_bf16 v[48:51], a[68:71], v[112:115], v[48:51]
    s_waitcnt lgkmcnt(10)
    v_mfma_f32_16x16x32_bf16 v[52:55], a[72:75], v[112:115], v[52:55]
    s_waitcnt lgkmcnt(8)
    v_mfma_f32_16x16x32_bf16 v[56:59], a[76:79], v[112:115], v[56:59]
    s_waitcnt lgkmcnt(6)
    v_mfma_f32_16x16x32_bf16 v[60:63], v[112:115], a[80:83], v[60:63]
    s_waitcnt lgkmcnt(4)
    v_mfma_f32_16x16x32_bf16 v[64:67], v[112:115], a[84:87], v[64:67]
    s_waitcnt lgkmcnt(2)
    v_mfma_f32_16x16x32_bf16 v[68:71], v[112:115], a[88:91], v[68:71]
    s_waitcnt lgkmcnt(0)
    v_mfma_f32_16x16x32_bf16 v[72:75], v[112:115], a[92:95], v[72:75]
    s_barrier
    ds_read_b128 v[108:111], v76 offset:39040
    ds_read_b128 v[112:115], v77 offset:39040
    ds_read_b64_tr_b16 a[0:1], v20 offset:39040
    ds_read_b64_tr_b16 a[2:3], v20 offset:39552
    ds_read_b64_tr_b16 a[4:5], v21 offset:39040
    ds_read_b64_tr_b16 a[6:7], v21 offset:39552
    ds_read_b64_tr_b16 a[8:9], v22 offset:39040
    ds_read_b64_tr_b16 a[10:11], v22 offset:39552
    ds_read_b64_tr_b16 a[12:13], v23 offset:39040
    ds_read_b64_tr_b16 a[14:15], v23 offset:39552
    ds_read_b64_tr_b16 a[16:17], v20 offset:47232
    ds_read_b64_tr_b16 a[18:19], v20 offset:47744
    ds_read_b64_tr_b16 a[20:21], v21 offset:47232
    ds_read_b64_tr_b16 a[22:23], v21 offset:47744
    ds_read_b64_tr_b16 a[24:25], v22 offset:47232
    ds_read_b64_tr_b16 a[26:27], v22 offset:47744
    s_waitcnt lgkmcnt(12)
    v_mfma_f32_16x16x32_bf16 v[28:31], a[0:3], v[116:119], v[28:31]
    ds_read_b64_tr_b16 a[28:29], v23 offset:47232
    ds_read_b64_tr_b16 a[30:31], v23 offset:47744
    s_waitcnt lgkmcnt(12)
    v_mfma_f32_16x16x32_bf16 v[32:35], a[4:7], v[116:119], v[32:35]
    ds_read_b64_tr_b16 a[32:33], v20 offset:55424
    ds_read_b64_tr_b16 a[34:35], v20 offset:55936
    s_waitcnt lgkmcnt(12)
    v_mfma_f32_16x16x32_bf16 v[36:39], a[8:11], v[116:119], v[36:39]
    ds_read_b64_tr_b16 a[36:37], v21 offset:55424
    ds_read_b64_tr_b16 a[38:39], v21 offset:55936
    s_waitcnt lgkmcnt(12)
    v_mfma_f32_16x16x32_bf16 v[40:43], a[12:15], v[116:119], v[40:43]
    ds_read_b64_tr_b16 a[40:41], v22 offset:55424
    ds_read_b64_tr_b16 a[42:43], v22 offset:55936
    s_waitcnt lgkmcnt(12)
    v_mfma_f32_16x16x32_bf16 v[44:47], a[16:19], v[108:111], v[44:47]
    ds_read_b64_tr_b16 a[44:45], v23 offset:55424
    ds_read_b64_tr_b16 a[46:47], v23 offset:55936
    s_waitcnt lgkmcnt(12)
    v_mfma_f32_16x16x32_bf16 v[48:51], a[20:23], v[108:111], v[48:51]
    ds_read_b64_tr_b16 a[48:49], v20 offset:43136
    ds_read_b64_tr_b16 a[50:51], v20 offset:43648
    s_waitcnt lgkmcnt(12)
    v_mfma_f32_16x16x32_bf16 v[52:55], a[24:27], v[108:111], v[52:55]
    ds_read_b64_tr_b16 a[52:53], v21 offset:43136
    ds_read_b64_tr_b16 a[54:55], v21 offset:43648
    s_waitcnt lgkmcnt(12)
    v_mfma_f32_16x16x32_bf16 v[56:59], a[28:31], v[108:111], v[56:59]
    ds_read_b64_tr_b16 a[56:57], v22 offset:43136
    ds_read_b64_tr_b16 a[58:59], v22 offset:43648
    s_waitcnt lgkmcnt(12)
    v_mfma_f32_16x16x32_bf16 v[60:63], v[108:111], a[32:35], v[60:63]
    ds_read_b64_tr_b16 a[60:61], v23 offset:43136
    ds_read_b64_tr_b16 a[62:63], v23 offset:43648
    s_waitcnt lgkmcnt(12)
    v_mfma_f32_16x16x32_bf16 v[64:67], v[108:111], a[36:39], v[64:67]
    ds_read_b64_tr_b16 a[64:65], v20 offset:51328
    ds_read_b64_tr_b16 a[66:67], v20 offset:51840
    s_waitcnt lgkmcnt(12)
    v_mfma_f32_16x16x32_bf16 v[68:71], v[108:111], a[40:43], v[68:71]
    ds_read_b64_tr_b16 a[68:69], v21 offset:51328
    ds_read_b64_tr_b16 a[70:71], v21 offset:51840
    s_waitcnt lgkmcnt(12)
    v_mfma_f32_16x16x32_bf16 v[72:75], v[108:111], a[44:47], v[72:75]
    ds_read_b64_tr_b16 a[72:73], v22 offset:51328
    ds_read_b64_tr_b16 a[74:75], v22 offset:51840
    s_waitcnt lgkmcnt(12)
    v_mfma_f32_16x16x32_bf16 v[28:31], a[48:51], v[116:119], v[28:31]
    ds_read_b64_tr_b16 a[76:77], v23 offset:51328
    ds_read_b64_tr_b16 a[78:79], v23 offset:51840
    s_waitcnt lgkmcnt(12)
    v_mfma_f32_16x16x32_bf16 v[32:35], a[52:55], v[116:119], v[32:35]
    ds_read_b64_tr_b16 a[80:81], v20 offset:59520
    ds_read_b64_tr_b16 a[82:83], v20 offset:60032
    s_waitcnt lgkmcnt(12)
    v_mfma_f32_16x16x32_bf16 v[36:39], a[56:59], v[116:119], v[36:39]
    ds_read_b64_tr_b16 a[84:85], v21 offset:59520
    ds_read_b64_tr_b16 a[86:87], v21 offset:60032
    s_waitcnt lgkmcnt(12)
    v_mfma_f32_16x16x32_bf16 v[40:43], a[60:63], v[116:119], v[40:43]
    ds_read_b64_tr_b16 a[88:89], v22 offset:59520
    ds_read_b64_tr_b16 a[90:91], v22 offset:60032
    s_waitcnt lgkmcnt(12)
    v_mfma_f32_16x16x32_bf16 v[44:47], a[64:67], v[112:115], v[44:47]
    ds_read_b64_tr_b16 a[92:93], v23 offset:59520
    ds_read_b64_tr_b16 a[94:95], v23 offset:60032
    s_waitcnt lgkmcnt(12)
    v_mfma_f32_16x16x32_bf16 v[48:51], a[68:71], v[112:115], v[48:51]
    s_waitcnt lgkmcnt(10)
    v_mfma_f32_16x16x32_bf16 v[52:55], a[72:75], v[112:115], v[52:55]
    s_waitcnt lgkmcnt(8)
    v_mfma_f32_16x16x32_bf16 v[56:59], a[76:79], v[112:115], v[56:59]
    s_waitcnt lgkmcnt(6)
    v_mfma_f32_16x16x32_bf16 v[60:63], v[112:115], a[80:83], v[60:63]
    s_waitcnt lgkmcnt(4)
    v_mfma_f32_16x16x32_bf16 v[64:67], v[112:115], a[84:87], v[64:67]
    s_waitcnt lgkmcnt(2)
    v_mfma_f32_16x16x32_bf16 v[68:71], v[112:115], a[88:91], v[68:71]
    s_waitcnt lgkmcnt(0)
    v_mfma_f32_16x16x32_bf16 v[72:75], v[112:115], a[92:95], v[72:75]
    s_mov_b64 exec, 1
    s_lshl_b32 s36, s2, 2
    s_add_u32 s36, s36, 8323072
    v_mov_b32 v4, s34
    v_mov_b32 v5, s36
    buffer_store_dword v4, v5, s[28:31], 0 offen sc1
    s_mov_b64 exec, -1
    s_barrier
    ds_read_b128 v[108:111], v80 offset:0
    ds_read_b128 v[112:115], v81 offset:0
    ds_read_b64_tr_b16 a[0:1], v24 offset:0
    ds_read_b64_tr_b16 a[2:3], v24 offset:512
    ds_read_b64_tr_b16 a[4:5], v25 offset:0
    ds_read_b64_tr_b16 a[6:7], v25 offset:512
    ds_read_b64_tr_b16 a[8:9], v26 offset:0
    ds_read_b64_tr_b16 a[10:11], v26 offset:512
    ds_read_b64_tr_b16 a[12:13], v27 offset:0
    ds_read_b64_tr_b16 a[14:15], v27 offset:512
    ds_read_b64_tr_b16 a[16:17], v24 offset:8192
    ds_read_b64_tr_b16 a[18:19], v24 offset:8704
    ds_read_b64_tr_b16 a[20:21], v25 offset:8192
    ds_read_b64_tr_b16 a[22:23], v25 offset:8704
    ds_read_b64_tr_b16 a[24:25], v26 offset:8192
    ds_read_b64_tr_b16 a[26:27], v26 offset:8704
    s_waitcnt lgkmcnt(12)
    v_mfma_f32_16x16x32_bf16 v[28:31], a[0:3], v[116:119], v[28:31]
    ds_read_b64_tr_b16 a[28:29], v27 offset:8192
    ds_read_b64_tr_b16 a[30:31], v27 offset:8704
    s_waitcnt lgkmcnt(12)
    v_mfma_f32_16x16x32_bf16 v[32:35], a[4:7], v[116:119], v[32:35]
    ds_read_b64_tr_b16 a[32:33], v24 offset:16384
    ds_read_b64_tr_b16 a[34:35], v24 offset:16896
    s_waitcnt lgkmcnt(12)
    v_mfma_f32_16x16x32_bf16 v[36:39], a[8:11], v[116:119], v[36:39]
    ds_read_b64_tr_b16 a[36:37], v25 offset:16384
    ds_read_b64_tr_b16 a[38:39], v25 offset:16896
    s_waitcnt lgkmcnt(12)
    v_mfma_f32_16x16x32_bf16 v[40:43], a[12:15], v[116:119], v[40:43]
    ds_read_b64_tr_b16 a[40:41], v26 offset:16384
    ds_read_b64_tr_b16 a[42:43], v26 offset:16896
    s_waitcnt lgkmcnt(12)
    v_mfma_f32_16x16x32_bf16 v[44:47], a[16:19], v[108:111], v[44:47]
    ds_read_b64_tr_b16 a[44:45], v27 offset:16384
    ds_read_b64_tr_b16 a[46:47], v27 offset:16896
    s_waitcnt lgkmcnt(12)
    v_mfma_f32_16x16x32_bf16 v[48:51], a[20:23], v[108:111], v[48:51]
    ds_read_b64_tr_b16 a[48:49], v24 offset:4096
    ds_read_b64_tr_b16 a[50:51], v24 offset:4608
    s_waitcnt lgkmcnt(12)
    v_mfma_f32_16x16x32_bf16 v[52:55], a[24:27], v[108:111], v[52:55]
    ds_read_b64_tr_b16 a[52:53], v25 offset:4096
    ds_read_b64_tr_b16 a[54:55], v25 offset:4608
    s_waitcnt lgkmcnt(12)
    v_mfma_f32_16x16x32_bf16 v[56:59], a[28:31], v[108:111], v[56:59]
    ds_read_b64_tr_b16 a[56:57], v26 offset:4096
    ds_read_b64_tr_b16 a[58:59], v26 offset:4608
    s_waitcnt lgkmcnt(12)
    v_mfma_f32_16x16x32_bf16 v[60:63], v[108:111], a[32:35], v[60:63]
    ds_read_b64_tr_b16 a[60:61], v27 offset:4096
    ds_read_b64_tr_b16 a[62:63], v27 offset:4608
    s_waitcnt lgkmcnt(12)
    v_mfma_f32_16x16x32_bf16 v[64:67], v[108:111], a[36:39], v[64:67]
    ds_read_b64_tr_b16 a[64:65], v24 offset:12288
    ds_read_b64_tr_b16 a[66:67], v24 offset:12800
    s_waitcnt lgkmcnt(12)
    v_mfma_f32_16x16x32_bf16 v[68:71], v[108:111], a[40:43], v[68:71]
    ds_read_b64_tr_b16 a[68:69], v25 offset:12288
    ds_read_b64_tr_b16 a[70:71], v25 offset:12800
    s_waitcnt lgkmcnt(12)
    v_mfma_f32_16x16x32_bf16 v[72:75], v[108:111], a[44:47], v[72:75]
    ds_read_b64_tr_b16 a[72:73], v26 offset:12288
    ds_read_b64_tr_b16 a[74:75], v26 offset:12800
    s_waitcnt lgkmcnt(12)
    v_mfma_f32_16x16x32_bf16 v[28:31], a[48:51], v[116:119], v[28:31]
    ds_read_b64_tr_b16 a[76:77], v27 offset:12288
    ds_read_b64_tr_b16 a[78:79], v27 offset:12800
    s_waitcnt lgkmcnt(12)
    v_mfma_f32_16x16x32_bf16 v[32:35], a[52:55], v[116:119], v[32:35]
    ds_read_b64_tr_b16 a[80:81], v24 offset:20480
    ds_read_b64_tr_b16 a[82:83], v24 offset:20992
    s_waitcnt lgkmcnt(12)
    v_mfma_f32_16x16x32_bf16 v[36:39], a[56:59], v[116:119], v[36:39]
    ds_read_b64_tr_b16 a[84:85], v25 offset:20480
    ds_read_b64_tr_b16 a[86:87], v25 offset:20992
    s_waitcnt lgkmcnt(12)
    v_mfma_f32_16x16x32_bf16 v[40:43], a[60:63], v[116:119], v[40:43]
    ds_read_b64_tr_b16 a[88:89], v26 offset:20480
    ds_read_b64_tr_b16 a[90:91], v26 offset:20992
    s_waitcnt lgkmcnt(12)
    v_mfma_f32_16x16x32_bf16 v[44:47], a[64:67], v[112:115], v[44:47]
    ds_read_b64_tr_b16 a[92:93], v27 offset:20480
    ds_read_b64_tr_b16 a[94:95], v27 offset:20992
    s_waitcnt lgkmcnt(12)
    v_mfma_f32_16x16x32_bf16 v[48:51], a[68:71], v[112:115], v[48:51]
    s_waitcnt lgkmcnt(10)
    v_mfma_f32_16x16x32_bf16 v[52:55], a[72:75], v[112:115], v[52:55]
    s_waitcnt lgkmcnt(8)
    v_mfma_f32_16x16x32_bf16 v[56:59], a[76:79], v[112:115], v[56:59]
    s_waitcnt lgkmcnt(6)
    v_mfma_f32_16x16x32_bf16 v[60:63], v[112:115], a[80:83], v[60:63]
    s_waitcnt lgkmcnt(4)
    v_mfma_f32_16x16x32_bf16 v[64:67], v[112:115], a[84:87], v[64:67]
    s_waitcnt lgkmcnt(2)
    v_mfma_f32_16x16x32_bf16 v[68:71], v[112:115], a[88:91], v[68:71]
    s_waitcnt lgkmcnt(0)
    v_mfma_f32_16x16x32_bf16 v[72:75], v[112:115], a[92:95], v[72:75]
    s_barrier
    ds_read_b128 v[108:111], v80 offset:39040
    ds_read_b128 v[112:115], v81 offset:39040
    ds_read_b64_tr_b16 a[0:1], v24 offset:39040
    ds_read_b64_tr_b16 a[2:3], v24 offset:39552
    ds_read_b64_tr_b16 a[4:5], v25 offset:39040
    ds_read_b64_tr_b16 a[6:7], v25 offset:39552
    ds_read_b64_tr_b16 a[8:9], v26 offset:39040
    ds_read_b64_tr_b16 a[10:11], v26 offset:39552
    ds_read_b64_tr_b16 a[12:13], v27 offset:39040
    ds_read_b64_tr_b16 a[14:15], v27 offset:39552
    ds_read_b64_tr_b16 a[16:17], v24 offset:47232
    ds_read_b64_tr_b16 a[18:19], v24 offset:47744
    ds_read_b64_tr_b16 a[20:21], v25 offset:47232
    ds_read_b64_tr_b16 a[22:23], v25 offset:47744
    ds_read_b64_tr_b16 a[24:25], v26 offset:47232
    ds_read_b64_tr_b16 a[26:27], v26 offset:47744
    s_waitcnt lgkmcnt(12)
    v_mfma_f32_16x16x32_bf16 v[28:31], a[0:3], v[116:119], v[28:31]
    ds_read_b64_tr_b16 a[28:29], v27 offset:47232
    ds_read_b64_tr_b16 a[30:31], v27 offset:47744
    s_waitcnt lgkmcnt(12)
    v_mfma_f32_16x16x32_bf16 v[32:35], a[4:7], v[116:119], v[32:35]
    ds_read_b64_tr_b16 a[32:33], v24 offset:55424
    ds_read_b64_tr_b16 a[34:35], v24 offset:55936
    s_waitcnt lgkmcnt(12)
    v_mfma_f32_16x16x32_bf16 v[36:39], a[8:11], v[116:119], v[36:39]
    ds_read_b64_tr_b16 a[36:37], v25 offset:55424
    ds_read_b64_tr_b16 a[38:39], v25 offset:55936
    s_waitcnt lgkmcnt(12)
    v_mfma_f32_16x16x32_bf16 v[40:43], a[12:15], v[116:119], v[40:43]
    ds_read_b64_tr_b16 a[40:41], v26 offset:55424
    ds_read_b64_tr_b16 a[42:43], v26 offset:55936
    s_waitcnt lgkmcnt(12)
    v_mfma_f32_16x16x32_bf16 v[44:47], a[16:19], v[108:111], v[44:47]
    ds_read_b64_tr_b16 a[44:45], v27 offset:55424
    ds_read_b64_tr_b16 a[46:47], v27 offset:55936
    s_waitcnt lgkmcnt(12)
    v_mfma_f32_16x16x32_bf16 v[48:51], a[20:23], v[108:111], v[48:51]
    ds_read_b64_tr_b16 a[48:49], v24 offset:43136
    ds_read_b64_tr_b16 a[50:51], v24 offset:43648
    s_waitcnt lgkmcnt(12)
    v_mfma_f32_16x16x32_bf16 v[52:55], a[24:27], v[108:111], v[52:55]
    ds_read_b64_tr_b16 a[52:53], v25 offset:43136
    ds_read_b64_tr_b16 a[54:55], v25 offset:43648
    s_waitcnt lgkmcnt(12)
    v_mfma_f32_16x16x32_bf16 v[56:59], a[28:31], v[108:111], v[56:59]
    ds_read_b64_tr_b16 a[56:57], v26 offset:43136
    ds_read_b64_tr_b16 a[58:59], v26 offset:43648
    s_waitcnt lgkmcnt(12)
    v_mfma_f32_16x16x32_bf16 v[60:63], v[108:111], a[32:35], v[60:63]
    ds_read_b64_tr_b16 a[60:61], v27 offset:43136
    ds_read_b64_tr_b16 a[62:63], v27 offset:43648
    s_waitcnt lgkmcnt(12)
    v_mfma_f32_16x16x32_bf16 v[64:67], v[108:111], a[36:39], v[64:67]
    ds_read_b64_tr_b16 a[64:65], v24 offset:51328
    ds_read_b64_tr_b16 a[66:67], v24 offset:51840
    s_waitcnt lgkmcnt(12)
    v_mfma_f32_16x16x32_bf16 v[68:71], v[108:111], a[40:43], v[68:71]
    ds_read_b64_tr_b16 a[68:69], v25 offset:51328
    ds_read_b64_tr_b16 a[70:71], v25 offset:51840
    s_waitcnt lgkmcnt(12)
    v_mfma_f32_16x16x32_bf16 v[72:75], v[108:111], a[44:47], v[72:75]
    ds_read_b64_tr_b16 a[72:73], v26 offset:51328
    ds_read_b64_tr_b16 a[74:75], v26 offset:51840
    s_waitcnt lgkmcnt(12)
    v_mfma_f32_16x16x32_bf16 v[28:31], a[48:51], v[116:119], v[28:31]
    ds_read_b64_tr_b16 a[76:77], v27 offset:51328
    ds_read_b64_tr_b16 a[78:79], v27 offset:51840
    s_waitcnt lgkmcnt(12)
    v_mfma_f32_16x16x32_bf16 v[32:35], a[52:55], v[116:119], v[32:35]
    ds_read_b64_tr_b16 a[80:81], v24 offset:59520
    ds_read_b64_tr_b16 a[82:83], v24 offset:60032
    s_waitcnt lgkmcnt(12)
    v_mfma_f32_16x16x32_bf16 v[36:39], a[56:59], v[116:119], v[36:39]
    ds_read_b64_tr_b16 a[84:85], v25 offset:59520
    ds_read_b64_tr_b16 a[86:87], v25 offset:60032
    s_waitcnt lgkmcnt(12)
    v_mfma_f32_16x16x32_bf16 v[40:43], a[60:63], v[116:119], v[40:43]
    ds_read_b64_tr_b16 a[88:89], v26 offset:59520
    ds_read_b64_tr_b16 a[90:91], v26 offset:60032
    s_waitcnt lgkmcnt(12)
    v_mfma_f32_16x16x32_bf16 v[44:47], a[64:67], v[112:115], v[44:47]
    ds_read_b64_tr_b16 a[92:93], v27 offset:59520
    ds_read_b64_tr_b16 a[94:95], v27 offset:60032
    s_waitcnt lgkmcnt(12)
    v_mfma_f32_16x16x32_bf16 v[48:51], a[68:71], v[112:115], v[48:51]
    s_waitcnt lgkmcnt(10)
    v_mfma_f32_16x16x32_bf16 v[52:55], a[72:75], v[112:115], v[52:55]
    s_waitcnt lgkmcnt(8)
    v_mfma_f32_16x16x32_bf16 v[56:59], a[76:79], v[112:115], v[56:59]
    s_waitcnt lgkmcnt(6)
    v_mfma_f32_16x16x32_bf16 v[60:63], v[112:115], a[80:83], v[60:63]
    s_waitcnt lgkmcnt(4)
    v_mfma_f32_16x16x32_bf16 v[64:67], v[112:115], a[84:87], v[64:67]
    s_waitcnt lgkmcnt(2)
    v_mfma_f32_16x16x32_bf16 v[68:71], v[112:115], a[88:91], v[68:71]
    s_waitcnt lgkmcnt(0)
    v_mfma_f32_16x16x32_bf16 v[72:75], v[112:115], a[92:95], v[72:75]
    v_add_u32 v4, 156224, v12
    v_min_u32 v5, 47, v1
    v_lshlrev_b32 v5, 2, v5
    v_add_u32 v5, 156480, v5
    v_lshlrev_b32 v6, 4, v2
    v_add_u32 v6, 157184, v6
    v_mov_b32 v7, 157968
    v_lshlrev_b32 v11, 2, v3
    v_add_u32 v11, 156224, v11
    s_barrier
    ds_read_b128 v[108:111], v76 offset:0
    ds_read_b128 v[112:115], v77 offset:0
    ds_read_b64_tr_b16 a[0:1], v20 offset:0
    ds_read_b64_tr_b16 a[2:3], v20 offset:512
    ds_read_b64_tr_b16 a[4:5], v21 offset:0
    ds_read_b64_tr_b16 a[6:7], v21 offset:512
    ds_read_b64_tr_b16 a[8:9], v22 offset:0
    ds_read_b64_tr_b16 a[10:11], v22 offset:512
    ds_read_b64_tr_b16 a[12:13], v23 offset:0
    ds_read_b64_tr_b16 a[14:15], v23 offset:512
    ds_read_b64_tr_b16 a[16:17], v20 offset:8192
    ds_read_b64_tr_b16 a[18:19], v20 offset:8704
    ds_read_b64_tr_b16 a[20:21], v21 offset:8192
    ds_read_b64_tr_b16 a[22:23], v21 offset:8704
    ds_read_b64_tr_b16 a[24:25], v22 offset:8192
    ds_read_b64_tr_b16 a[26:27], v22 offset:8704
    s_waitcnt lgkmcnt(12)
    v_mfma_f32_16x16x32_bf16 v[28:31], a[0:3], v[116:119], v[28:31]
    ds_read_b64_tr_b16 a[28:29], v23 offset:8192
    ds_read_b64_tr_b16 a[30:31], v23 offset:8704
    s_waitcnt lgkmcnt(12)
    v_mfma_f32_16x16x32_bf16 v[32:35], a[4:7], v[116:119], v[32:35]
    ds_read_b64_tr_b16 a[32:33], v20 offset:16384
    ds_read_b64_tr_b16 a[34:35], v20 offset:16896
    s_waitcnt lgkmcnt(12)
    v_mfma_f32_16x16x32_bf16 v[36:39], a[8:11], v[116:119], v[36:39]
    ds_read_b64_tr_b16 a[36:37], v21 offset:16384
    ds_read_b64_tr_b16 a[38:39], v21 offset:16896
    s_waitcnt lgkmcnt(12)
    v_mfma_f32_16x16x32_bf16 v[40:43], a[12:15], v[116:119], v[40:43]
    ds_read_b64_tr_b16 a[40:41], v22 offset:16384
    ds_read_b64_tr_b16 a[42:43], v22 offset:16896
    s_waitcnt lgkmcnt(12)
    v_mfma_f32_16x16x32_bf16 v[44:47], a[16:19], v[108:111], v[44:47]
    ds_read_b64_tr_b16 a[44:45], v23 offset:16384
    ds_read_b64_tr_b16 a[46:47], v23 offset:16896
    s_waitcnt lgkmcnt(12)
    v_mfma_f32_16x16x32_bf16 v[48:51], a[20:23], v[108:111], v[48:51]
    ds_read_b64_tr_b16 a[48:49], v20 offset:4096
    ds_read_b64_tr_b16 a[50:51], v20 offset:4608
    s_waitcnt lgkmcnt(12)
    v_mfma_f32_16x16x32_bf16 v[52:55], a[24:27], v[108:111], v[52:55]
    ds_read_b64_tr_b16 a[52:53], v21 offset:4096
    ds_read_b64_tr_b16 a[54:55], v21 offset:4608
    s_waitcnt lgkmcnt(12)
    v_mfma_f32_16x16x32_bf16 v[56:59], a[28:31], v[108:111], v[56:59]
    ds_read_b64_tr_b16 a[56:57], v22 offset:4096
    ds_read_b64_tr_b16 a[58:59], v22 offset:4608
    s_waitcnt lgkmcnt(12)
    v_mfma_f32_16x16x32_bf16 v[60:63], v[108:111], a[32:35], v[60:63]
    ds_read_b64_tr_b16 a[60:61], v23 offset:4096
    ds_read_b64_tr_b16 a[62:63], v23 offset:4608
    s_waitcnt lgkmcnt(12)
    v_mfma_f32_16x16x32_bf16 v[64:67], v[108:111], a[36:39], v[64:67]
    ds_read_b64_tr_b16 a[64:65], v20 offset:12288
    ds_read_b64_tr_b16 a[66:67], v20 offset:12800
    s_waitcnt lgkmcnt(12)
    v_mfma_f32_16x16x32_bf16 v[68:71], v[108:111], a[40:43], v[68:71]
    ds_read_b64_tr_b16 a[68:69], v21 offset:12288
    ds_read_b64_tr_b16 a[70:71], v21 offset:12800
    s_waitcnt lgkmcnt(12)
    v_mfma_f32_16x16x32_bf16 v[72:75], v[108:111], a[44:47], v[72:75]
    ds_read_b64_tr_b16 a[72:73], v22 offset:12288
    ds_read_b64_tr_b16 a[74:75], v22 offset:12800
    s_waitcnt lgkmcnt(12)
    v_mfma_f32_16x16x32_bf16 v[28:31], a[48:51], v[116:119], v[28:31]
    ds_read_b64_tr_b16 a[76:77], v23 offset:12288
    ds_read_b64_tr_b16 a[78:79], v23 offset:12800
    s_waitcnt lgkmcnt(12)
    v_mfma_f32_16x16x32_bf16 v[32:35], a[52:55], v[116:119], v[32:35]
    ds_read_b64_tr_b16 a[80:81], v20 offset:20480
    ds_read_b64_tr_b16 a[82:83], v20 offset:20992
    s_waitcnt lgkmcnt(12)
    v_mfma_f32_16x16x32_bf16 v[36:39], a[56:59], v[116:119], v[36:39]
    ds_read_b64_tr_b16 a[84:85], v21 offset:20480
    ds_read_b64_tr_b16 a[86:87], v21 offset:20992
    s_waitcnt lgkmcnt(12)
    v_mfma_f32_16x16x32_bf16 v[40:43], a[60:63], v[116:119], v[40:43]
    ds_read_b64_tr_b16 a[88:89], v22 offset:20480
    ds_read_b64_tr_b16 a[90:91], v22 offset:20992
    s_waitcnt lgkmcnt(12)
    v_mfma_f32_16x16x32_bf16 v[44:47], a[64:67], v[112:115], v[44:47]
    ds_read_b64_tr_b16 a[92:93], v23 offset:20480
    ds_read_b64_tr_b16 a[94:95], v23 offset:20992
    s_waitcnt lgkmcnt(12)
    v_mfma_f32_16x16x32_bf16 v[48:51], a[68:71], v[112:115], v[48:51]
    s_waitcnt lgkmcnt(10)
    v_mfma_f32_16x16x32_bf16 v[52:55], a[72:75], v[112:115], v[52:55]
    s_waitcnt lgkmcnt(8)
    v_mfma_f32_16x16x32_bf16 v[56:59], a[76:79], v[112:115], v[56:59]
    s_waitcnt lgkmcnt(6)
    v_mfma_f32_16x16x32_bf16 v[60:63], v[112:115], a[80:83], v[60:63]
    s_waitcnt lgkmcnt(4)
    v_mfma_f32_16x16x32_bf16 v[64:67], v[112:115], a[84:87], v[64:67]
    s_waitcnt lgkmcnt(2)
    v_mfma_f32_16x16x32_bf16 v[68:71], v[112:115], a[88:91], v[68:71]
    s_waitcnt lgkmcnt(0)
    v_mfma_f32_16x16x32_bf16 v[72:75], v[112:115], a[92:95], v[72:75]
    s_barrier
    ds_read_b128 v[108:111], v76 offset:39040
    ds_read_b128 v[112:115], v77 offset:39040
    ds_read_b64_tr_b16 a[0:1], v20 offset:39040
    ds_read_b64_tr_b16 a[2:3], v20 offset:39552
    ds_read_b64_tr_b16 a[4:5], v21 offset:39040
    ds_read_b64_tr_b16 a[6:7], v21 offset:39552
    ds_read_b64_tr_b16 a[8:9], v22 offset:39040
    ds_read_b64_tr_b16 a[10:11], v22 offset:39552
    ds_read_b64_tr_b16 a[12:13], v23 offset:39040
    ds_read_b64_tr_b16 a[14:15], v23 offset:39552
    ds_read_b64_tr_b16 a[16:17], v20 offset:47232
    ds_read_b64_tr_b16 a[18:19], v20 offset:47744
    ds_read_b64_tr_b16 a[20:21], v21 offset:47232
    ds_read_b64_tr_b16 a[22:23], v21 offset:47744
    ds_read_b64_tr_b16 a[24:25], v22 offset:47232
    ds_read_b64_tr_b16 a[26:27], v22 offset:47744
    s_waitcnt lgkmcnt(12)
    v_mfma_f32_16x16x32_bf16 v[28:31], a[0:3], v[116:119], v[28:31]
    ds_read_b64_tr_b16 a[28:29], v23 offset:47232
    ds_read_b64_tr_b16 a[30:31], v23 offset:47744
    s_waitcnt lgkmcnt(12)
    v_mfma_f32_16x16x32_bf16 v[32:35], a[4:7], v[116:119], v[32:35]
    ds_read_b64_tr_b16 a[32:33], v20 offset:55424
    ds_read_b64_tr_b16 a[34:35], v20 offset:55936
    s_waitcnt lgkmcnt(12)
    v_mfma_f32_16x16x32_bf16 v[36:39], a[8:11], v[116:119], v[36:39]
    ds_read_b64_tr_b16 a[36:37], v21 offset:55424
    ds_read_b64_tr_b16 a[38:39], v21 offset:55936
    s_waitcnt lgkmcnt(12)
    v_mfma_f32_16x16x32_bf16 v[40:43], a[12:15], v[116:119], v[40:43]
    ds_read_b64_tr_b16 a[40:41], v22 offset:55424
    ds_read_b64_tr_b16 a[42:43], v22 offset:55936
    s_waitcnt lgkmcnt(12)
    v_mfma_f32_16x16x32_bf16 v[44:47], a[16:19], v[108:111], v[44:47]
    ds_read_b64_tr_b16 a[44:45], v23 offset:55424
    ds_read_b64_tr_b16 a[46:47], v23 offset:55936
    s_waitcnt lgkmcnt(12)
    v_mfma_f32_16x16x32_bf16 v[48:51], a[20:23], v[108:111], v[48:51]
    ds_read_b64_tr_b16 a[48:49], v20 offset:43136
    ds_read_b64_tr_b16 a[50:51], v20 offset:43648
    s_waitcnt lgkmcnt(12)
    v_mfma_f32_16x16x32_bf16 v[52:55], a[24:27], v[108:111], v[52:55]
    ds_read_b64_tr_b16 a[52:53], v21 offset:43136
    ds_read_b64_tr_b16 a[54:55], v21 offset:43648
    s_waitcnt lgkmcnt(12)
    v_mfma_f32_16x16x32_bf16 v[56:59], a[28:31], v[108:111], v[56:59]
    ds_read_b64_tr_b16 a[56:57], v22 offset:43136
    ds_read_b64_tr_b16 a[58:59], v22 offset:43648
    s_waitcnt lgkmcnt(12)
    v_mfma_f32_16x16x32_bf16 v[60:63], v[108:111], a[32:35], v[60:63]
    ds_read_b64_tr_b16 a[60:61], v23 offset:43136
    ds_read_b64_tr_b16 a[62:63], v23 offset:43648
    s_waitcnt lgkmcnt(12)
    v_mfma_f32_16x16x32_bf16 v[64:67], v[108:111], a[36:39], v[64:67]
    ds_read_b64_tr_b16 a[64:65], v20 offset:51328
    ds_read_b64_tr_b16 a[66:67], v20 offset:51840
    s_waitcnt lgkmcnt(12)
    v_mfma_f32_16x16x32_bf16 v[68:71], v[108:111], a[40:43], v[68:71]
    ds_read_b64_tr_b16 a[68:69], v21 offset:51328
    ds_read_b64_tr_b16 a[70:71], v21 offset:51840
    s_waitcnt lgkmcnt(12)
    v_mfma_f32_16x16x32_bf16 v[72:75], v[108:111], a[44:47], v[72:75]
    ds_read_b64_tr_b16 a[72:73], v22 offset:51328
    ds_read_b64_tr_b16 a[74:75], v22 offset:51840
    s_waitcnt lgkmcnt(12)
    v_mfma_f32_16x16x32_bf16 v[28:31], a[48:51], v[116:119], v[28:31]
    ds_read_b64_tr_b16 a[76:77], v23 offset:51328
    ds_read_b64_tr_b16 a[78:79], v23 offset:51840
    s_waitcnt lgkmcnt(12)
    v_mfma_f32_16x16x32_bf16 v[32:35], a[52:55], v[116:119], v[32:35]
    ds_read_b64_tr_b16 a[80:81], v20 offset:59520
    ds_read_b64_tr_b16 a[82:83], v20 offset:60032
    s_waitcnt lgkmcnt(12)
    v_mfma_f32_16x16x32_bf16 v[36:39], a[56:59], v[116:119], v[36:39]
    ds_read_b64_tr_b16 a[84:85], v21 offset:59520
    ds_read_b64_tr_b16 a[86:87], v21 offset:60032
    s_waitcnt lgkmcnt(12)
    v_mfma_f32_16x16x32_bf16 v[40:43], a[60:63], v[116:119], v[40:43]
    ds_read_b64_tr_b16 a[88:89], v22 offset:59520
    ds_read_b64_tr_b16 a[90:91], v22 offset:60032
    s_waitcnt lgkmcnt(12)
    v_mfma_f32_16x16x32_bf16 v[44:47], a[64:67], v[112:115], v[44:47]
    ds_read_b64_tr_b16 a[92:93], v23 offset:59520
    ds_read_b64_tr_b16 a[94:95], v23 offset:60032
    s_waitcnt lgkmcnt(12)
    v_mfma_f32_16x16x32_bf16 v[48:51], a[68:71], v[112:115], v[48:51]
    s_waitcnt lgkmcnt(10)
    v_mfma_f32_16x16x32_bf16 v[52:55], a[72:75], v[112:115], v[52:55]
    s_waitcnt lgkmcnt(8)
    v_mfma_f32_16x16x32_bf16 v[56:59], a[76:79], v[112:115], v[56:59]
    s_waitcnt lgkmcnt(6)
    v_mfma_f32_16x16x32_bf16 v[60:63], v[112:115], a[80:83], v[60:63]
    s_waitcnt lgkmcnt(4)
    v_mfma_f32_16x16x32_bf16 v[64:67], v[112:115], a[84:87], v[64:67]
    s_waitcnt lgkmcnt(2)
    v_mfma_f32_16x16x32_bf16 v[68:71], v[112:115], a[88:91], v[68:71]
    s_waitcnt lgkmcnt(0)
    v_mfma_f32_16x16x32_bf16 v[72:75], v[112:115], a[92:95], v[72:75]
    s_barrier
    ds_read_b128 a[96:99], v80 offset:0
    ds_read_b128 a[100:103], v81 offset:0
    ds_read_b64_tr_b16 a[0:1], v24 offset:0
    ds_read_b64_tr_b16 a[2:3], v24 offset:512
    ds_read_b64_tr_b16 a[4:5], v25 offset:0
    ds_read_b64_tr_b16 a[6:7], v25 offset:512
    ds_read_b64_tr_b16 a[8:9], v26 offset:0
    ds_read_b64_tr_b16 a[10:11], v26 offset:512
    ds_read_b64_tr_b16 a[12:13], v27 offset:0
    ds_read_b64_tr_b16 a[14:15], v27 offset:512
    ds_read_b64_tr_b16 a[16:17], v24 offset:8192
    ds_read_b64_tr_b16 a[18:19], v24 offset:8704
    ds_read_b64_tr_b16 a[20:21], v25 offset:8192
    ds_read_b64_tr_b16 a[22:23], v25 offset:8704
    ds_read_b64_tr_b16 a[24:25], v26 offset:8192
    ds_read_b64_tr_b16 a[26:27], v26 offset:8704
    s_waitcnt lgkmcnt(12)
    v_mfma_f32_16x16x32_bf16 v[28:31], a[0:3], v[116:119], v[28:31]
    ds_read_b64_tr_b16 a[28:29], v27 offset:8192
    ds_read_b64_tr_b16 a[30:31], v27 offset:8704
    s_waitcnt lgkmcnt(12)
    v_mfma_f32_16x16x32_bf16 v[32:35], a[4:7], v[116:119], v[32:35]
    ds_read_b64_tr_b16 a[48:49], v24 offset:4096
    ds_read_b64_tr_b16 a[50:51], v24 offset:4608
    s_waitcnt lgkmcnt(12)
    v_mfma_f32_16x16x32_bf16 v[36:39], a[8:11], v[116:119], v[36:39]
    ds_read_b64_tr_b16 a[52:53], v25 offset:4096
    ds_read_b64_tr_b16 a[54:55], v25 offset:4608
    s_waitcnt lgkmcnt(12)
    v_mfma_f32_16x16x32_bf16 v[40:43], a[12:15], v[116:119], v[40:43]
    ds_read_b64_tr_b16 a[56:57], v26 offset:4096
    ds_read_b64_tr_b16 a[58:59], v26 offset:4608
    s_waitcnt lgkmcnt(12)
    v_mfma_f32_16x16x32_bf16 v[44:47], a[16:19], a[96:99], v[44:47]
    ds_read_b64_tr_b16 a[60:61], v27 offset:4096
    ds_read_b64_tr_b16 a[62:63], v27 offset:4608
    s_waitcnt lgkmcnt(12)
    v_mfma_f32_16x16x32_bf16 v[48:51], a[20:23], a[96:99], v[48:51]
    ds_read_b64_tr_b16 a[64:65], v24 offset:12288
    ds_read_b64_tr_b16 a[66:67], v24 offset:12800
    s_waitcnt lgkmcnt(12)
    v_mfma_f32_16x16x32_bf16 v[52:55], a[24:27], a[96:99], v[52:55]
    ds_read_b64_tr_b16 a[68:69], v25 offset:12288
    ds_read_b64_tr_b16 a[70:71], v25 offset:12800
    s_waitcnt lgkmcnt(12)
    v_mfma_f32_16x16x32_bf16 v[56:59], a[28:31], a[96:99], v[56:59]
    ds_read_b64_tr_b16 a[72:73], v26 offset:12288
    ds_read_b64_tr_b16 a[74:75], v26 offset:12800
    s_waitcnt lgkmcnt(12)
    v_mfma_f32_16x16x32_bf16 v[28:31], a[48:51], v[116:119], v[28:31]
    ds_read_b64_tr_b16 a[76:77], v27 offset:12288
    ds_read_b64_tr_b16 a[78:79], v27 offset:12800
    s_waitcnt lgkmcnt(12)
    v_mfma_f32_16x16x32_bf16 v[32:35], a[52:55], v[116:119], v[32:35]
    s_waitcnt lgkmcnt(10)
    v_mfma_f32_16x16x32_bf16 v[36:39], a[56:59], v[116:119], v[36:39]
    s_waitcnt lgkmcnt(8)
    v_mfma_f32_16x16x32_bf16 v[40:43], a[60:63], v[116:119], v[40:43]
    s_waitcnt lgkmcnt(6)
    v_mfma_f32_16x16x32_bf16 v[44:47], a[64:67], a[100:103], v[44:47]
    s_waitcnt lgkmcnt(4)
    v_mfma_f32_16x16x32_bf16 v[48:51], a[68:71], a[100:103], v[48:51]
    s_waitcnt lgkmcnt(2)
    v_mfma_f32_16x16x32_bf16 v[52:55], a[72:75], a[100:103], v[52:55]
    s_waitcnt lgkmcnt(0)
    v_mfma_f32_16x16x32_bf16 v[56:59], a[76:79], a[100:103], v[56:59]
    s_barrier
    ds_read_b128 a[104:107], v80 offset:39040
    ds_read_b128 a[108:111], v81 offset:39040
    ds_read_b64_tr_b16 a[0:1], v24 offset:39040
    ds_read_b64_tr_b16 a[2:3], v24 offset:39552
    ds_read_b64_tr_b16 a[4:5], v25 offset:39040
    ds_read_b64_tr_b16 a[6:7], v25 offset:39552
    ds_read_b64_tr_b16 a[8:9], v26 offset:39040
    ds_read_b64_tr_b16 a[10:11], v26 offset:39552
    ds_read_b64_tr_b16 a[12:13], v27 offset:39040
    ds_read_b64_tr_b16 a[14:15], v27 offset:39552
    ds_read_b64_tr_b16 a[16:17], v24 offset:47232
    ds_read_b64_tr_b16 a[18:19], v24 offset:47744
    ds_read_b64_tr_b16 a[20:21], v25 offset:47232
    ds_read_b64_tr_b16 a[22:23], v25 offset:47744
    ds_read_b64_tr_b16 a[24:25], v26 offset:47232
    ds_read_b64_tr_b16 a[26:27], v26 offset:47744
    s_waitcnt lgkmcnt(12)
    v_mfma_f32_16x16x32_bf16 v[28:31], a[0:3], v[116:119], v[28:31]
    ds_read_b64_tr_b16 a[28:29], v27 offset:47232
    ds_read_b64_tr_b16 a[30:31], v27 offset:47744
    s_waitcnt lgkmcnt(12)
    v_mfma_f32_16x16x32_bf16 v[32:35], a[4:7], v[116:119], v[32:35]
    ds_read_b64_tr_b16 a[48:49], v24 offset:43136
    ds_read_b64_tr_b16 a[50:51], v24 offset:43648
    s_waitcnt lgkmcnt(12)
    v_mfma_f32_16x16x32_bf16 v[36:39], a[8:11], v[116:119], v[36:39]
    ds_read_b64_tr_b16 a[52:53], v25 offset:43136
    ds_read_b64_tr_b16 a[54:55], v25 offset:43648
    s_waitcnt lgkmcnt(12)
    v_mfma_f32_16x16x32_bf16 v[40:43], a[12:15], v[116:119], v[40:43]
    ds_read_b64_tr_b16 a[56:57], v26 offset:43136
    ds_read_b64_tr_b16 a[58:59], v26 offset:43648
    s_waitcnt lgkmcnt(12)
    v_mfma_f32_16x16x32_bf16 v[44:47], a[16:19], a[104:107], v[44:47]
    ds_read_b64_tr_b16 a[60:61], v27 offset:43136
    ds_read_b64_tr_b16 a[62:63], v27 offset:43648
    s_waitcnt lgkmcnt(12)
    v_mfma_f32_16x16x32_bf16 v[48:51], a[20:23], a[104:107], v[48:51]
    ds_read_b64_tr_b16 a[64:65], v24 offset:51328
    ds_read_b64_tr_b16 a[66:67], v24 offset:51840
    s_waitcnt lgkmcnt(12)
    v_mfma_f32_16x16x32_bf16 v[52:55], a[24:27], a[104:107], v[52:55]
    ds_read_b64_tr_b16 a[68:69], v25 offset:51328
    ds_read_b64_tr_b16 a[70:71], v25 offset:51840
    s_waitcnt lgkmcnt(12)
    v_mfma_f32_16x16x32_bf16 v[56:59], a[28:31], a[104:107], v[56:59]
    ds_read_b64_tr_b16 a[72:73], v26 offset:51328
    ds_read_b64_tr_b16 a[74:75], v26 offset:51840
    s_waitcnt lgkmcnt(12)
    v_mfma_f32_16x16x32_bf16 v[28:31], a[48:51], v[116:119], v[28:31]
    ds_read_b64_tr_b16 a[76:77], v27 offset:51328
    ds_read_b64_tr_b16 a[78:79], v27 offset:51840
    s_waitcnt lgkmcnt(12)
    v_mfma_f32_16x16x32_bf16 v[32:35], a[52:55], v[116:119], v[32:35]
    s_waitcnt lgkmcnt(10)
    v_mfma_f32_16x16x32_bf16 v[36:39], a[56:59], v[116:119], v[36:39]
    s_waitcnt lgkmcnt(8)
    v_mfma_f32_16x16x32_bf16 v[40:43], a[60:63], v[116:119], v[40:43]
    s_waitcnt lgkmcnt(6)
    v_mfma_f32_16x16x32_bf16 v[44:47], a[64:67], a[108:111], v[44:47]
    s_waitcnt lgkmcnt(4)
    v_mfma_f32_16x16x32_bf16 v[48:51], a[68:71], a[108:111], v[48:51]
    s_waitcnt lgkmcnt(2)
    v_mfma_f32_16x16x32_bf16 v[52:55], a[72:75], a[108:111], v[52:55]
    s_waitcnt lgkmcnt(0)
    v_mfma_f32_16x16x32_bf16 v[56:59], a[76:79], a[108:111], v[56:59]
    buffer_load_dwordx2 v[92:93], v96, s[28:31], s46 offen sc1
    buffer_load_dwordx2 v[94:95], v97, s[28:31], s46 offen sc1
    s_barrier
    ds_read_b128 a[112:115], v76 offset:0
    ds_read_b128 a[116:119], v77 offset:0
    ds_read_b64_tr_b16 a[0:1], v20 offset:0
    ds_read_b64_tr_b16 a[2:3], v20 offset:512
    ds_read_b64_tr_b16 a[4:5], v21 offset:0
    ds_read_b64_tr_b16 a[6:7], v21 offset:512
    ds_read_b64_tr_b16 a[8:9], v22 offset:0
    ds_read_b64_tr_b16 a[10:11], v22 offset:512
    ds_read_b64_tr_b16 a[12:13], v23 offset:0
    ds_read_b64_tr_b16 a[14:15], v23 offset:512
    ds_read_b64_tr_b16 a[16:17], v20 offset:8192
    ds_read_b64_tr_b16 a[18:19], v20 offset:8704
    ds_read_b64_tr_b16 a[20:21], v21 offset:8192
    ds_read_b64_tr_b16 a[22:23], v21 offset:8704
    ds_read_b64_tr_b16 a[24:25], v22 offset:8192
    ds_read_b64_tr_b16 a[26:27], v22 offset:8704
    s_waitcnt lgkmcnt(12)
    v_mfma_f32_16x16x32_bf16 v[28:31], a[0:3], v[116:119], v[28:31]
    ds_read_b64_tr_b16 a[28:29], v23 offset:8192
    ds_read_b64_tr_b16 a[30:31], v23 offset:8704
    s_waitcnt lgkmcnt(12)
    v_mfma_f32_16x16x32_bf16 v[32:35], a[4:7], v[116:119], v[32:35]
    ds_read_b64_tr_b16 a[48:49], v20 offset:4096
    ds_read_b64_tr_b16 a[50:51], v20 offset:4608
    s_waitcnt lgkmcnt(12)
    v_mfma_f32_16x16x32_bf16 v[36:39], a[8:11], v[116:119], v[36:39]
    ds_read_b64_tr_b16 a[52:53], v21 offset:4096
    ds_read_b64_tr_b16 a[54:55], v21 offset:4608
    s_waitcnt lgkmcnt(12)
    v_mfma_f32_16x16x32_bf16 v[40:43], a[12:15], v[116:119], v[40:43]
    ds_read_b64_tr_b16 a[56:57], v22 offset:4096
    ds_read_b64_tr_b16 a[58:59], v22 offset:4608
    s_waitcnt lgkmcnt(12)
    v_mfma_f32_16x16x32_bf16 v[44:47], a[16:19], a[112:115], v[44:47]
    ds_read_b64_tr_b16 a[60:61], v23 offset:4096
    ds_read_b64_tr_b16 a[62:63], v23 offset:4608
    s_waitcnt lgkmcnt(12)
    v_mfma_f32_16x16x32_bf16 v[48:51], a[20:23], a[112:115], v[48:51]
    ds_read_b64_tr_b16 a[64:65], v20 offset:12288
    ds_read_b64_tr_b16 a[66:67], v20 offset:12800
    s_waitcnt lgkmcnt(12)
    v_mfma_f32_16x16x32_bf16 v[52:55], a[24:27], a[112:115], v[52:55]
    ds_read_b64_tr_b16 a[68:69], v21 offset:12288
    ds_read_b64_tr_b16 a[70:71], v21 offset:12800
    s_waitcnt lgkmcnt(12)
    v_mfma_f32_16x16x32_bf16 v[56:59], a[28:31], a[112:115], v[56:59]
    ds_read_b64_tr_b16 a[72:73], v22 offset:12288
    ds_read_b64_tr_b16 a[74:75], v22 offset:12800
    s_waitcnt lgkmcnt(12)
    v_mfma_f32_16x16x32_bf16 v[28:31], a[48:51], v[116:119], v[28:31]
    ds_read_b64_tr_b16 a[76:77], v23 offset:12288
    ds_read_b64_tr_b16 a[78:79], v23 offset:12800
    s_waitcnt lgkmcnt(12)
    v_mfma_f32_16x16x32_bf16 v[32:35], a[52:55], v[116:119], v[32:35]
    s_waitcnt lgkmcnt(10)
    v_mfma_f32_16x16x32_bf16 v[36:39], a[56:59], v[116:119], v[36:39]
    s_waitcnt vmcnt(0)
Lst_chk:
    v_cmp_ne_u32 vcc, s34, v93
    v_cmp_ne_u32 s[36:37], s34, v95
    s_nop 0
    s_or_b64 s[36:37], s[36:37], vcc
    s_cbranch_scc1 Lst_re
    v_lshlrev_b32 v93, 16, v92
    s_waitcnt lgkmcnt(8)
    v_mfma_f32_16x16x32_bf16 v[40:43], a[60:63], v[116:119], v[40:43]
    v_and_b32 v92, 0xffff0000, v92
    v_rcp_f32 v93, v93
    s_waitcnt lgkmcnt(6)
    v_mfma_f32_16x16x32_bf16 v[44:47], a[64:67], a[116:119], v[44:47]
    v_lshlrev_b32 v95, 16, v94
    v_and_b32 v94, 0xffff0000, v94
    s_waitcnt lgkmcnt(4)
    v_mfma_f32_16x16x32_bf16 v[48:51], a[68:71], a[116:119], v[48:51]
    v_rcp_f32 v95, v95
    ds_write2st64_b32 v4, v92, v93 offset0:0 offset1:2
    s_waitcnt lgkmcnt(3)
    v_mfma_f32_16x16x32_bf16 v[52:55], a[72:75], a[116:119], v[52:55]
    ds_write2st64_b32 v5, v94, v95 offset0:0 offset1:2
    ds_read_b32 v120, v11
    s_waitcnt lgkmcnt(3)
    v_mfma_f32_16x16x32_bf16 v[56:59], a[76:79], a[116:119], v[56:59]
    s_waitcnt lgkmcnt(0)
    s_barrier
    ds_read_b128 a[120:123], v76 offset:39040
    ds_read_b128 a[124:127], v77 offset:39040
    ds_read_b64_tr_b16 a[0:1], v20 offset:39040
    ds_read_b64_tr_b16 a[2:3], v20 offset:39552
    ds_read_b64_tr_b16 a[4:5], v21 offset:39040
    ds_read_b64_tr_b16 a[6:7], v21 offset:39552
    ds_read_b64_tr_b16 a[8:9], v22 offset:39040
    ds_read_b64_tr_b16 a[10:11], v22 offset:39552
    ds_read_b64_tr_b16 a[12:13], v23 offset:39040
    ds_read_b64_tr_b16 a[14:15], v23 offset:39552
    ds_read_b64_tr_b16 a[16:17], v20 offset:47232
    ds_read_b64_tr_b16 a[18:19], v20 offset:47744
    ds_read_b64_tr_b16 a[20:21], v21 offset:47232
    ds_read_b64_tr_b16 a[22:23], v21 offset:47744
    ds_read_b64_tr_b16 a[24:25], v22 offset:47232
    ds_read_b64_tr_b16 a[26:27], v22 offset:47744
    s_waitcnt lgkmcnt(12)
    v_mfma_f32_16x16x32_bf16 v[28:31], a[0:3], v[116:119], v[28:31]
    ds_read_b64_tr_b16 a[28:29], v23 offset:47232
    ds_read_b64_tr_b16 a[30:31], v23 offset:47744
    s_waitcnt lgkmcnt(12)
    v_mfma_f32_16x16x32_bf16 v[32:35], a[4:7], v[116:119], v[32:35]
    ds_read_b64_tr_b16 a[48:49], v20 offset:43136
    ds_read_b64_tr_b16 a[50:51], v20 offset:43648
    s_waitcnt lgkmcnt(12)
    v_mfma_f32_16x16x32_bf16 v[36:39], a[8:11], v[116:119], v[36:39]
    ds_read_b64_tr_b16 a[52:53], v21 offset:43136
    ds_read_b64_tr_b16 a[54:55], v21 offset:43648
    s_waitcnt lgkmcnt(12)
    v_mfma_f32_16x16x32_bf16 v[40:43], a[12:15], v[116:119], v[40:43]
    ds_read_b64_tr_b16 a[56:57], v22 offset:43136
    ds_read_b64_tr_b16 a[58:59], v22 offset:43648
    s_waitcnt lgkmcnt(12)
    v_mfma_f32_16x16x32_bf16 v[44:47], a[16:19], a[120:123], v[44:47]
    ds_read_b64_tr_b16 a[60:61], v23 offset:43136
    ds_read_b64_tr_b16 a[62:63], v23 offset:43648
    s_waitcnt lgkmcnt(12)
    v_mfma_f32_16x16x32_bf16 v[48:51], a[20:23], a[120:123], v[48:51]
    ds_read_b64_tr_b16 a[64:65], v20 offset:51328
    ds_read_b64_tr_b16 a[66:67], v20 offset:51840
    s_waitcnt lgkmcnt(12)
    v_mfma_f32_16x16x32_bf16 v[52:55], a[24:27], a[120:123], v[52:55]
    ds_read_b64_tr_b16 a[68:69], v21 offset:51328
    ds_read_b64_tr_b16 a[70:71], v21 offset:51840
    s_waitcnt lgkmcnt(12)
    v_mfma_f32_16x16x32_bf16 v[56:59], a[28:31], a[120:123], v[56:59]
    ds_read_b64_tr_b16 a[72:73], v22 offset:51328
    ds_read_b64_tr_b16 a[74:75], v22 offset:51840
    s_waitcnt lgkmcnt(12)
    v_mfma_f32_16x16x32_bf16 v[28:31], a[48:51], v[116:119], v[28:31]
    ds_read_b64_tr_b16 a[76:77], v23 offset:51328
    ds_read_b64_tr_b16 a[78:79], v23 offset:51840
    s_waitcnt lgkmcnt(12)
    v_mfma_f32_16x16x32_bf16 v[32:35], a[52:55], v[116:119], v[32:35]
    s_waitcnt lgkmcnt(10)
    v_mfma_f32_16x16x32_bf16 v[36:39], a[56:59], v[116:119], v[36:39]
    s_waitcnt lgkmcnt(8)
    v_mfma_f32_16x16x32_bf16 v[40:43], a[60:63], v[116:119], v[40:43]
    s_waitcnt lgkmcnt(6)
    v_mfma_f32_16x16x32_bf16 v[44:47], a[64:67], a[124:127], v[44:47]
    s_waitcnt lgkmcnt(4)
    v_mfma_f32_16x16x32_bf16 v[48:51], a[68:71], a[124:127], v[48:51]
    s_waitcnt lgkmcnt(2)
    v_mfma_f32_16x16x32_bf16 v[52:55], a[72:75], a[124:127], v[52:55]
    s_waitcnt lgkmcnt(0)
    v_mfma_f32_16x16x32_bf16 v[56:59], a[76:79], a[124:127], v[56:59]
    s_mov_b32 exec_lo, 0x00010001
    s_mov_b32 exec_hi, 0x00010001
    ds_write_b128 v6, v[28:31] offset:0
    ds_write_b128 v6, v[32:35] offset:64
    ds_write_b128 v6, v[36:39] offset:128
    ds_write_b128 v6, v[40:43] offset:192
    ds_write_b128 v6, v[44:47] offset:256
    ds_write_b128 v6, v[48:51] offset:320
    ds_write_b128 v6, v[52:55] offset:384
    ds_write_b128 v6, v[56:59] offset:448
    ds_write_b32 v7, v7
    s_mov_b64 exec, -1
    ds_read_b128 v[76:79], v6 offset:256
    ds_read_b128 v[80:83], v6 offset:320
    ds_read_b128 v[84:87], v6 offset:384
    ds_read_b128 v[88:91], v6 offset:448
    s_waitcnt lgkmcnt(0)
    v_fmac_f32 v44, v76, v120
    v_fmac_f32 v45, v77, v120
    v_fmac_f32 v46, v78, v120
    v_fmac_f32 v47, v79, v120
    v_cvt_pk_bf16_f32 v44, v44, v45
    v_cvt_pk_bf16_f32 v45, v46, v47
    v_fmac_f32 v48, v80, v120
    v_fmac_f32 v49, v81, v120
    v_fmac_f32 v50, v82, v120
    v_fmac_f32 v51, v83, v120
    v_cvt_pk_bf16_f32 v46, v48, v49
    v_cvt_pk_bf16_f32 v47, v50, v51
    v_fmac_f32 v52, v84, v120
    v_fmac_f32 v53, v85, v120
    v_fmac_f32 v54, v86, v120
    v_fmac_f32 v55, v87, v120
    v_cvt_pk_bf16_f32 v48, v52, v53
    v_cvt_pk_bf16_f32 v49, v54, v55
    v_fmac_f32 v56, v88, v120
    v_fmac_f32 v57, v89, v120
    v_fmac_f32 v58, v90, v120
    v_fmac_f32 v59, v91, v120
    v_cvt_pk_bf16_f32 v50, v56, v57
    v_cvt_pk_bf16_f32 v51, v58, v59
    ds_write_b128 v125, v[44:47] offset:4096
    ds_write_b128 v125, v[48:51] offset:5120
    v_mov_b32 v5, 157972
    v_mov_b32 v6, 1
    s_mov_b64 exec, 1
    ds_add_u32 v5, v6
    s_mov_b64 exec, -1
    v_mov_b32 v5, 157980
Lcw_6:
    s_sub_u32 s35, s35, 1
    s_cbranch_scc1 Lend
    ds_read_b32 v6, v5
    s_waitcnt lgkmcnt(0)
    v_readfirstlane_b32 s38, v6
    s_nop 0
    s_cmp_lt_u32 s38, 1
    s_cbranch_scc1 Lcw_6
    ds_read_b64_tr_b16 a[0:1], v24 offset:16384
    ds_read_b64_tr_b16 a[2:3], v24 offset:16896
    ds_read_b64_tr_b16 a[4:5], v25 offset:16384
    ds_read_b64_tr_b16 a[6:7], v25 offset:16896
    ds_read_b64_tr_b16 a[8:9], v26 offset:16384
    ds_read_b64_tr_b16 a[10:11], v26 offset:16896
    ds_read_b64_tr_b16 a[12:13], v27 offset:16384
    ds_read_b64_tr_b16 a[14:15], v27 offset:16896
    ds_read_b64_tr_b16 a[16:17], v24 offset:20480
    ds_read_b64_tr_b16 a[18:19], v24 offset:20992
    ds_read_b64_tr_b16 a[20:21], v25 offset:20480
    ds_read_b64_tr_b16 a[22:23], v25 offset:20992
    ds_read_b64_tr_b16 a[24:25], v26 offset:20480
    ds_read_b64_tr_b16 a[26:27], v26 offset:20992
    ds_read_b64_tr_b16 a[28:29], v27 offset:20480
    ds_read_b64_tr_b16 a[30:31], v27 offset:20992
    ds_read_b64_tr_b16 a[32:33], v24 offset:55424
    ds_read_b64_tr_b16 a[34:35], v24 offset:55936
    ds_read_b64_tr_b16 a[36:37], v25 offset:55424
    ds_read_b64_tr_b16 a[38:39], v25 offset:55936
    ds_read_b64_tr_b16 a[40:41], v26 offset:55424
    ds_read_b64_tr_b16 a[42:43], v26 offset:55936
    ds_read_b64_tr_b16 a[44:45], v27 offset:55424
    ds_read_b64_tr_b16 a[46:47], v27 offset:55936
    ds_read_b64_tr_b16 a[48:49], v24 offset:59520
    ds_read_b64_tr_b16 a[50:51], v24 offset:60032
    ds_read_b64_tr_b16 a[52:53], v25 offset:59520
    ds_read_b64_tr_b16 a[54:55], v25 offset:60032
    ds_read_b64_tr_b16 a[56:57], v26 offset:59520
    ds_read_b64_tr_b16 a[58:59], v26 offset:60032
    ds_read_b64_tr_b16 a[60:61], v27 offset:59520
    ds_read_b64_tr_b16 a[62:63], v27 offset:60032
    ds_read_b64_tr_b16 a[64:65], v20 offset:16384
    ds_read_b64_tr_b16 a[66:67], v20 offset:16896
    ds_read_b64_tr_b16 a[68:69], v21 offset:16384
    ds_read_b64_tr_b16 a[70:71], v21 offset:16896
    ds_read_b64_tr_b16 a[72:73], v22 offset:16384
    ds_read_b64_tr_b16 a[74:75], v22 offset:16896
    ds_read_b64_tr_b16 a[76:77], v23 offset:16384
    ds_read_b64_tr_b16 a[78:79], v23 offset:16896
    ds_read_b64_tr_b16 a[80:81], v20 offset:20480
    ds_read_b64_tr_b16 a[82:83], v20 offset:20992
    ds_read_b64_tr_b16 a[84:85], v21 offset:20480
    ds_read_b64_tr_b16 a[86:87], v21 offset:20992
    ds_read_b64_tr_b16 a[88:89], v22 offset:20480
    ds_read_b64_tr_b16 a[90:91], v22 offset:20992
    ds_read_b64_tr_b16 a[92:93], v23 offset:20480
    ds_read_b64_tr_b16 a[94:95], v23 offset:20992
    s_waitcnt lgkmcnt(15)
    v_mfma_f32_16x16x32_bf16 v[60:63], a[96:99], a[0:3], v[60:63]
    v_mfma_f32_16x16x32_bf16 v[64:67], a[96:99], a[4:7], v[64:67]
    v_mfma_f32_16x16x32_bf16 v[68:71], a[96:99], a[8:11], v[68:71]
    v_mfma_f32_16x16x32_bf16 v[72:75], a[96:99], a[12:15], v[72:75]
    ds_read_b64_tr_b16 a[0:1], v20 offset:55424
    ds_read_b64_tr_b16 a[2:3], v20 offset:55936
    ds_read_b64_tr_b16 a[4:5], v21 offset:55424
    ds_read_b64_tr_b16 a[6:7], v21 offset:55936
    ds_read_b64_tr_b16 a[8:9], v22 offset:55424
    ds_read_b64_tr_b16 a[10:11], v22 offset:55936
    ds_read_b64_tr_b16 a[12:13], v23 offset:55424
    ds_read_b64_tr_b16 a[14:15], v23 offset:55936
    v_mfma_f32_16x16x32_bf16 v[60:63], a[100:103], a[16:19], v[60:63]
    v_mfma_f32_16x16x32_bf16 v[64:67], a[100:103], a[20:23], v[64:67]
    v_mfma_f32_16x16x32_bf16 v[68:71], a[100:103], a[24:27], v[68:71]
    v_mfma_f32_16x16x32_bf16 v[72:75], a[100:103], a[28:31], v[72:75]
    ds_read_b64_tr_b16 a[16:17], v20 offset:59520
    ds_read_b64_tr_b16 a[18:19], v20 offset:60032
    ds_read_b64_tr_b16 a[20:21], v21 offset:59520
    ds_read_b64_tr_b16 a[22:23], v21 offset:60032
    ds_read_b64_tr_b16 a[24:25], v22 offset:59520
    ds_read_b64_tr_b16 a[26:27], v22 offset:60032
    ds_read_b64_tr_b16 a[28:29], v23 offset:59520
    ds_read_b64_tr_b16 a[30:31], v23 offset:60032
    v_mfma_f32_16x16x32_bf16 v[60:63], a[104:107], a[32:35], v[60:63]
    v_mfma_f32_16x16x32_bf16 v[64:67], a[104:107], a[36:39], v[64:67]
    v_mfma_f32_16x16x32_bf16 v[68:71], a[104:107], a[40:43], v[68:71]
    v_mfma_f32_16x16x32_bf16 v[72:75], a[104:107], a[44:47], v[72:75]
    v_mfma_f32_16x16x32_bf16 v[60:63], a[108:111], a[48:51], v[60:63]
    v_mfma_f32_16x16x32_bf16 v[64:67], a[108:111], a[52:55], v[64:67]
    v_mfma_f32_16x16x32_bf16 v[68:71], a[108:111], a[56:59], v[68:71]
    v_mfma_f32_16x16x32_bf16 v[72:75], a[108:111], a[60:63], v[72:75]
    s_waitcnt lgkmcnt(15)
    v_mfma_f32_16x16x32_bf16 v[60:63], a[112:115], a[64:67], v[60:63]
    v_mfma_f32_16x16x32_bf16 v[64:67], a[112:115], a[68:71], v[64:67]
    v_mfma_f32_16x16x32_bf16 v[68:71], a[112:115], a[72:75], v[68:71]
    v_mfma_f32_16x16x32_bf16 v[72:75], a[112:115], a[76:79], v[72:75]
    v_mfma_f32_16x16x32_bf16 v[60:63], a[116:119], a[80:83], v[60:63]
    v_mfma_f32_16x16x32_bf16 v[64:67], a[116:119], a[84:87], v[64:67]
    v_mfma_f32_16x16x32_bf16 v[68:71], a[116:119], a[88:91], v[68:71]
    v_mfma_f32_16x16x32_bf16 v[72:75], a[116:119], a[92:95], v[72:75]
    s_waitcnt lgkmcnt(8)
    v_mfma_f32_16x16x32_bf16 v[60:63], a[120:123], a[0:3], v[60:63]
    v_mfma_f32_16x16x32_bf16 v[64:67], a[120:123], a[4:7], v[64:67]
    v_mfma_f32_16x16x32_bf16 v[68:71], a[120:123], a[8:11], v[68:71]
    v_mfma_f32_16x16x32_bf16 v[72:75], a[120:123], a[12:15], v[72:75]
    s_waitcnt lgkmcnt(0)
    v_mfma_f32_16x16x32_bf16 v[60:63], a[124:127], a[16:19], v[60:63]
    v_mfma_f32_16x16x32_bf16 v[64:67], a[124:127], a[20:23], v[64:67]
    v_mfma_f32_16x16x32_bf16 v[68:71], a[124:127], a[24:27], v[68:71]
    v_mfma_f32_16x16x32_bf16 v[72:75], a[124:127], a[28:31], v[72:75]
    v_lshlrev_b32 v5, 4, v3
    v_add_u32 v5, 157696, v5
    v_mov_b32 v6, 157952
    v_lshlrev_b32 v4, 4, v2
    v_add_u32 v4, 156224, v4
    v_lshl_add_u32 v125, v1, 3, s45
    s_mov_b64 exec, 0xffff
    ds_write_b32 v5, v60 offset:0
    ds_write_b32 v5, v64 offset:4
    ds_write_b32 v5, v68 offset:8
    ds_write_b32 v5, v72 offset:12
    ds_write_b32 v6, v6
    s_mov_b64 exec, -1
    ds_read_b128 v[36:39], v5
    ds_read_b128 v[28:31], v4
    ds_read_b128 v[32:35], v4 offset:512
    s_waitcnt lgkmcnt(0)
    v_fmac_f32 v60, v28, v36
    v_fmac_f32 v61, v29, v36
    v_fmac_f32 v62, v30, v36
    v_fmac_f32 v63, v31, v36
    v_mul_f32 v60, v60, v32
    v_mul_f32 v61, v61, v33
    v_mul_f32 v62, v62, v34
    v_mul_f32 v63, v63, v35
    v_cvt_pk_bf16_f32 v60, v60, v61
    v_cvt_pk_bf16_f32 v61, v62, v63
    ds_write_b64 v125, v[60:61] offset:0
    v_fmac_f32 v64, v28, v37
    v_fmac_f32 v65, v29, v37
    v_fmac_f32 v66, v30, v37
    v_fmac_f32 v67, v31, v37
    v_mul_f32 v64, v64, v32
    v_mul_f32 v65, v65, v33
    v_mul_f32 v66, v66, v34
    v_mul_f32 v67, v67, v35
    v_cvt_pk_bf16_f32 v64, v64, v65
    v_cvt_pk_bf16_f32 v65, v66, v67
    ds_write_b64 v125, v[64:65] offset:512
    v_fmac_f32 v68, v28, v38
    v_fmac_f32 v69, v29, v38
    v_fmac_f32 v70, v30, v38
    v_fmac_f32 v71, v31, v38
    v_mul_f32 v68, v68, v32
    v_mul_f32 v69, v69, v33
    v_mul_f32 v70, v70, v34
    v_mul_f32 v71, v71, v35
    v_cvt_pk_bf16_f32 v68, v68, v69
    v_cvt_pk_bf16_f32 v69, v70, v71
    ds_write_b64 v125, v[68:69] offset:1024
    v_fmac_f32 v72, v28, v39
    v_fmac_f32 v73, v29, v39
    v_fmac_f32 v74, v30, v39
    v_fmac_f32 v75, v31, v39
    v_mul_f32 v72, v72, v32
    v_mul_f32 v73, v73, v33
    v_mul_f32 v74, v74, v34
    v_mul_f32 v75, v75, v35
    v_cvt_pk_bf16_f32 v72, v72, v73
    v_cvt_pk_bf16_f32 v73, v74, v75
    ds_write_b64 v125, v[72:73] offset:1536
    v_mov_b32 v8, 157976
    v_mov_b32 v9, 1
    s_mov_b64 exec, 1
    ds_add_u32 v8, v9
    s_mov_b64 exec, -1
    s_branch Lagent
Lst_re:
    s_sub_u32 s35, s35, 1
    s_cbranch_scc1 Lend
    buffer_load_dwordx2 v[92:93], v96, s[28:31], s46 offen sc1
    buffer_load_dwordx2 v[94:95], v97, s[28:31], s46 offen sc1
    s_waitcnt vmcnt(0)
    s_branch Lst_chk
Laux:
    s_lshl_b32 s32, s37, 3
    s_lshl_b32 s39, s38, 2
    s_add_u32 s32, s32, s36
    s_cmp_lt_u32 s37, 4
    s_cselect_b32 s39, s39, 0
    s_add_u32 s32, s32, s39
    s_and_b32 s33, s2, 3
    s_lshl_b32 s33, s33, 3
    s_and_b32 s39, s2, 4
    s_add_u32 s33, s33, s39
    s_add_u32 s33, s33, s37
    s_cmp_ge_u32 s32, 32
    s_cbranch_scc1 Lmst
    v_lshrrev_b32 v5, 3, v1
    v_and_b32 v6, 7, v1
    s_lshl_b32 s40, s3, 14
    s_cmp_eq_u32 s27, 0
    s_cbranch_scc0 Laux_u
    s_lshl_b32 s36, s33, 6
    s_lshl_b32 s37, s26, 4
    s_add_u32 s36, s36, s37
    v_add_u32 v7, s36, v5
    v_mul_u32_u24 v7, 1280, v7
    v_xor_b32 v8, v6, v2
    v_lshl_add_u32 v92, v8, 4, v7
    v_add_u32 v92, 4096, v92
    v_xor_b32 v93, 64, v92
    v_add_u32 v93, 9216, v93
    v_subrev_u32 v94, 1920, v92
    v_subrev_u32 v95, 1920, v93
    s_waitcnt lgkmcnt(0)
    s_sub_u32 s52, s4, 4096
    s_subb_u32 s53, s5, 0
    s_mov_b32 s54, 2625536
    s_mov_b32 s55, 0x20000
    s_mov_b64 s[60:61], s[12:13]
    s_mov_b32 s62, 1280
    s_mov_b32 s63, 0x20000
    s_mov_b32 m0, 131072
    s_nop 0
    buffer_load_dwordx4 v13, s[60:63], 0 offen lds
    s_mov_b64 exec, 0xffff
    buffer_load_dwordx4 v13, s[60:63], 0 offen offset:1024 lds
    s_mov_b64 exec, -1
    s_add_u32 m0, s40, 0
    s_mov_b32 s41, 0
    buffer_load_dwordx4 v92, s[52:55], s41 offen lds
    buffer_load_dwordx4 v93, s[52:55], s41 offen offset:1024 lds
    buffer_load_dwordx4 v94, s[52:55], s41 offen offset:2048 lds
    buffer_load_dwordx4 v95, s[52:55], s41 offen offset:3072 lds
    s_add_u32 m0, s40, 4096
    s_mov_b32 s41, 256
    buffer_load_dwordx4 v92, s[52:55], s41 offen lds
    buffer_load_dwordx4 v93, s[52:55], s41 offen offset:1024 lds
    buffer_load_dwordx4 v94, s[52:55], s41 offen offset:2048 lds
    buffer_load_dwordx4 v95, s[52:55], s41 offen offset:3072 lds
    s_add_u32 m0, s40, 8192
    s_mov_b32 s41, 512
    buffer_load_dwordx4 v92, s[52:55], s41 offen lds
    buffer_load_dwordx4 v93, s[52:55], s41 offen offset:1024 lds
    buffer_load_dwordx4 v94, s[52:55], s41 offen offset:2048 lds
    buffer_load_dwordx4 v95, s[52:55], s41 offen offset:3072 lds
    s_add_u32 m0, s40, 12288
    s_mov_b32 s41, 768
    buffer_load_dwordx4 v92, s[52:55], s41 offen lds
    buffer_load_dwordx4 v93, s[52:55], s41 offen offset:1024 lds
    buffer_load_dwordx4 v94, s[52:55], s41 offen offset:2048 lds
    buffer_load_dwordx4 v95, s[52:55], s41 offen offset:3072 lds
    s_mov_b64 s[28:29], s[24:25]
    s_mov_b32 s30, 268435456
    s_mov_b32 s31, 0x20000
    s_load_dword s34, s[28:29], 0
    s_mov_b64 s[44:45], s[14:15]
    s_mov_b32 s46, 2211840
    s_mov_b32 s47, 0x20000
    s_mov_b64 s[48:49], s[18:19]
    s_mov_b32 s50, 2211840
    s_mov_b32 s51, 0x20000
    v_and_b32 v8, 1, v2
    v_lshlrev_b32 v8, 1, v8
    v_xor_b32 v8, v8, v6
    v_lshlrev_b32 v8, 4, v8
    v_mul_u32_u24 v9, 3456, v5
    s_lshl_b32 s38, s32, 7
    v_add3_u32 v18, v9, v8, s38
    v_xor_b32 v19, 64, v18
    v_add_u32 v19, 26624, v19
    v_add_u32 v20, 53248, v18
    v_add_u32 v21, 53248, v19
    s_mul_i32 s42, s26, 110592
    v_mul_u32_u24 v9, 1280, v5
    v_add_u32 v22, v9, v8
    v_xor_b32 v23, 64, v22
    v_add_u32 v23, 9216, v23
    v_add_u32 v24, 18432, v22
    v_add_u32 v25, 18432, v23
    s_mul_i32 s43, s32, 81920
    s_lshl_b32 s38, s3, 7
    s_add_u32 s43, s43, s38
    v_mov_b32 v96, 0x3f803f80
    v_mov_b32 v97, 0x3f803f80
    v_mov_b32 v98, 0x3f803f80
    v_mov_b32 v99, 0x3f803f80
    v_lshlrev_b32 v100, 4, v2
    v_add_u32 v100, 131072, v100
    v_lshrrev_b32 v10, 1, v3
    v_xor_b32 v10, v10, v2
    v_lshlrev_b32 v10, 4, v10
    v_lshl_add_u32 v10, v3, 7, v10
    v_add_u32 v102, s40, v10
    v_xor_b32 v103, 64, v102
    s_mov_b32 s58, 0xaaaaaaaa
    s_mov_b32 s59, 0xaaaaaaaa
    s_mov_b32 s64, 0xcccccccc
    s_mov_b32 s65, 0xcccccccc
    v_lshrrev_b32 v101, 2, v3
    v_lshl_add_u32 v101, v101, 4, v3
    v_lshlrev_b32 v101, 2, v101
    s_lshl_b32 s36, s26, 4
    v_add_u32 v10, s36, v3
    s_lshl_b32 s37, s33, 6
    s_sub_u32 s37, 2047, s37
    v_sub_u32 v106, s37, v10
    v_lshlrev_b32 v107, 2, v10
    v_add_u32 v107, 132608, v107
    s_lshl_b32 s36, s33, 9
    s_add_u32 s36, s36, 8192000
    v_lshl_add_u32 v108, v10, 3, s36
    v_bfe_u32 v10, v1, 2, 2
    v_and_b32 v8, 3, v1
    v_lshl_add_u32 v14, v2, 3, v10
    v_lshlrev_b32 v14, 7, v14
    v_lshlrev_b32 v9, 2, v1
    v_and_b32 v9, 0x60, v9
    v_add3_u32 v14, v14, v9, s40
    v_lshl_add_u32 v14, v8, 3, v14
    v_xor_b32 v15, 32, v14
    v_xor_b32 v16, 64, v14
    v_xor_b32 v17, 96, v14
    s_lshl_b32 s36, s26, 6
    s_add_u32 s36, s36, 141312
    v_lshl_add_u32 v26, v2, 4, s36
    v_min_u32 v8, 2, v3
    v_mul_u32_u24 v8, 1536, v8
    v_add_u32 v26, v26, v8
    v_add_u32 v4, 132864, v12
    v_mov_b32 v5, 0
    ds_write_b32 v4, v5
    s_waitcnt lgkmcnt(0)
    s_add_u32 s34, s34, 0x9e3779b8
    s_or_b32 s34, s34, 1
    s_waitcnt vmcnt(12)
    ds_read_b128 a[80:83], v102 offset:0
    ds_read_b128 a[84:87], v100 offset:0
    ds_read_b128 a[88:91], v103 offset:0
    ds_read_b128 a[92:95], v100 offset:64
    ds_read_b128 a[96:99], v102 offset:2048
    ds_read_b128 a[100:103], v100 offset:128
    ds_read_b128 a[104:107], v103 offset:2048
    ds_read_b128 a[108:111], v100 offset:192
    s_waitcnt lgkmcnt(0)
    s_add_u32 m0, s40, 0
    s_mov_b32 s41, 1024
    buffer_load_dwordx4 v92, s[52:55], s41 offen lds
    buffer_load_dwordx4 v93, s[52:55], s41 offen offset:1024 lds
    buffer_load_dwordx4 v94, s[52:55], s41 offen offset:2048 lds
    buffer_load_dwordx4 v95, s[52:55], s41 offen offset:3072 lds
    s_barrier
    v_mfma_f32_16x16x32_bf16 v[116:119], a[80:83], a[80:83], 0
    v_mfma_f32_16x16x32_bf16 v[112:115], v[96:99], a[80:83], 0
    v_mfma_f32_16x16x32_bf16 v[120:123], a[84:87], a[80:83], 0
    v_mfma_f32_16x16x32_bf16 v[124:127], a[84:87], v[96:99], 0
    v_mfma_f32_16x16x32_bf16 v[116:119], a[88:91], a[88:91], v[116:119]
    v_mfma_f32_16x16x32_bf16 v[112:115], v[96:99], a[88:91], v[112:115]
    v_mfma_f32_16x16x32_bf16 v[120:123], a[92:95], a[88:91], v[120:123]
    v_mfma_f32_16x16x32_bf16 v[124:127], a[92:95], v[96:99], v[124:127]
    v_mfma_f32_16x16x32_bf16 v[116:119], a[96:99], a[96:99], v[116:119]
    v_mfma_f32_16x16x32_bf16 v[112:115], v[96:99], a[96:99], v[112:115]
    v_mfma_f32_16x16x32_bf16 v[120:123], a[100:103], a[96:99], v[120:123]
    v_mfma_f32_16x16x32_bf16 v[124:127], a[100:103], v[96:99], v[124:127]
    v_mfma_f32_16x16x32_bf16 v[116:119], a[104:107], a[104:107], v[116:119]
    v_mfma_f32_16x16x32_bf16 v[112:115], v[96:99], a[104:107], v[112:115]
    v_mfma_f32_16x16x32_bf16 v[120:123], a[108:111], a[104:107], v[120:123]
    v_mfma_f32_16x16x32_bf16 v[124:127], a[108:111], v[96:99], v[124:127]
    s_waitcnt vmcnt(12)
    ds_read_b128 a[80:83], v102 offset:4096
    ds_read_b128 a[84:87], v100 offset:256
    ds_read_b128 a[88:91], v103 offset:4096
    ds_read_b128 a[92:95], v100 offset:320
    ds_read_b128 a[96:99], v102 offset:6144
    ds_read_b128 a[100:103], v100 offset:384
    ds_read_b128 a[104:107], v103 offset:6144
    ds_read_b128 a[108:111], v100 offset:448
    s_waitcnt lgkmcnt(0)
    v_mfma_f32_16x16x32_bf16 v[116:119], a[80:83], a[80:83], v[116:119]
    v_mfma_f32_16x16x32_bf16 v[112:115], v[96:99], a[80:83], v[112:115]
    v_mfma_f32_16x16x32_bf16 v[120:123], a[84:87], a[80:83], v[120:123]
    v_mfma_f32_16x16x32_bf16 v[124:127], a[84:87], v[96:99], v[124:127]
    v_mfma_f32_16x16x32_bf16 v[116:119], a[88:91], a[88:91], v[116:119]
    v_mfma_f32_16x16x32_bf16 v[112:115], v[96:99], a[88:91], v[112:115]
    v_mfma_f32_16x16x32_bf16 v[120:123], a[92:95], a[88:91], v[120:123]
    v_mfma_f32_16x16x32_bf16 v[124:127], a[92:95], v[96:99], v[124:127]
    v_mfma_f32_16x16x32_bf16 v[116:119], a[96:99], a[96:99], v[116:119]
    v_mfma_f32_16x16x32_bf16 v[112:115], v[96:99], a[96:99], v[112:115]
    v_mfma_f32_16x16x32_bf16 v[120:123], a[100:103], a[96:99], v[120:123]
    v_mfma_f32_16x16x32_bf16 v[124:127], a[100:103], v[96:99], v[124:127]
    v_mfma_f32_16x16x32_bf16 v[116:119], a[104:107], a[104:107], v[116:119]
    v_mfma_f32_16x16x32_bf16 v[112:115], v[96:99], a[104:107], v[112:115]
    v_mfma_f32_16x16x32_bf16 v[120:123], a[108:111], a[104:107], v[120:123]
    v_mfma_f32_16x16x32_bf16 v[124:127], a[108:111], v[96:99], v[124:127]
    s_waitcnt vmcnt(8)
    ds_read_b128 a[80:83], v102 offset:8192
    ds_read_b128 a[84:87], v100 offset:512
    ds_read_b128 a[88:91], v103 offset:8192
    ds_read_b128 a[92:95], v100 offset:576
    ds_read_b128 a[96:99], v102 offset:10240
    ds_read_b128 a[100:103], v100 offset:640
    ds_read_b128 a[104:107], v103 offset:10240
    ds_read_b128 a[108:111], v100 offset:704
    s_waitcnt lgkmcnt(0)
    v_mfma_f32_16x16x32_bf16 v[116:119], a[80:83], a[80:83], v[116:119]
    v_mfma_f32_16x16x32_bf16 v[112:115], v[96:99], a[80:83], v[112:115]
    v_mfma_f32_16x16x32_bf16 v[120:123], a[84:87], a[80:83], v[120:123]
    v_mfma_f32_16x16x32_bf16 v[124:127], a[84:87], v[96:99], v[124:127]
    v_mfma_f32_16x16x32_bf16 v[116:119], a[88:91], a[88:91], v[116:119]
    v_mfma_f32_16x16x32_bf16 v[112:115], v[96:99], a[88:91], v[112:115]
    v_mfma_f32_16x16x32_bf16 v[120:123], a[92:95], a[88:91], v[120:123]
    v_mfma_f32_16x16x32_bf16 v[124:127], a[92:95], v[96:99], v[124:127]
    v_mfma_f32_16x16x32_bf16 v[116:119], a[96:99], a[96:99], v[116:119]
    v_mfma_f32_16x16x32_bf16 v[112:115], v[96:99], a[96:99], v[112:115]
    v_mfma_f32_16x16x32_bf16 v[120:123], a[100:103], a[96:99], v[120:123]
    v_mfma_f32_16x16x32_bf16 v[124:127], a[100:103], v[96:99], v[124:127]
    v_mfma_f32_16x16x32_bf16 v[116:119], a[104:107], a[104:107], v[116:119]
    v_mfma_f32_16x16x32_bf16 v[112:115], v[96:99], a[104:107], v[112:115]
    v_mfma_f32_16x16x32_bf16 v[120:123], a[108:111], a[104:107], v[120:123]
    v_mfma_f32_16x16x32_bf16 v[124:127], a[108:111], v[96:99], v[124:127]
    s_waitcnt vmcnt(4)
    ds_read_b128 a[80:83], v102 offset:12288
    ds_read_b128 a[84:87], v100 offset:768
    ds_read_b128 a[88:91], v103 offset:12288
    ds_read_b128 a[92:95], v100 offset:832
    ds_read_b128 a[96:99], v102 offset:14336
    ds_read_b128 a[100:103], v100 offset:896
    ds_read_b128 a[104:107], v103 offset:14336
    ds_read_b128 a[108:111], v100 offset:960
    s_waitcnt lgkmcnt(0)
    v_mfma_f32_16x16x32_bf16 v[116:119], a[80:83], a[80:83], v[116:119]
    v_mfma_f32_16x16x32_bf16 v[112:115], v[96:99], a[80:83], v[112:115]
    v_mfma_f32_16x16x32_bf16 v[120:123], a[84:87], a[80:83], v[120:123]
    v_mfma_f32_16x16x32_bf16 v[124:127], a[84:87], v[96:99], v[124:127]
    v_mfma_f32_16x16x32_bf16 v[116:119], a[88:91], a[88:91], v[116:119]
    v_mfma_f32_16x16x32_bf16 v[112:115], v[96:99], a[88:91], v[112:115]
    v_mfma_f32_16x16x32_bf16 v[120:123], a[92:95], a[88:91], v[120:123]
    v_mfma_f32_16x16x32_bf16 v[124:127], a[92:95], v[96:99], v[124:127]
    v_mfma_f32_16x16x32_bf16 v[116:119], a[96:99], a[96:99], v[116:119]
    v_mfma_f32_16x16x32_bf16 v[112:115], v[96:99], a[96:99], v[112:115]
    v_mfma_f32_16x16x32_bf16 v[120:123], a[100:103], a[96:99], v[120:123]
    v_mfma_f32_16x16x32_bf16 v[124:127], a[100:103], v[96:99], v[124:127]
    v_mfma_f32_16x16x32_bf16 v[116:119], a[104:107], a[104:107], v[116:119]
    v_mfma_f32_16x16x32_bf16 v[112:115], v[96:99], a[104:107], v[112:115]
    v_mfma_f32_16x16x32_bf16 v[120:123], a[108:111], a[104:107], v[120:123]
    v_mfma_f32_16x16x32_bf16 v[124:127], a[108:111], v[96:99], v[124:127]
    s_waitcnt vmcnt(0)
    ds_read_b128 a[80:83], v102 offset:0
    ds_read_b128 a[84:87], v100 offset:1024
    ds_read_b128 a[88:91], v103 offset:0
    ds_read_b128 a[92:95], v100 offset:1088
    ds_read_b128 a[96:99], v102 offset:2048
    ds_read_b128 a[100:103], v100 offset:1152
    ds_read_b128 a[104:107], v103 offset:2048
    ds_read_b128 a[108:111], v100 offset:1216
    s_waitcnt lgkmcnt(0)
    v_mfma_f32_16x16x32_bf16 v[116:119], a[80:83], a[80:83], v[116:119]
    v_mfma_f32_16x16x32_bf16 v[112:115], v[96:99], a[80:83], v[112:115]
    v_mfma_f32_16x16x32_bf16 v[120:123], a[84:87], a[80:83], v[120:123]
    v_mfma_f32_16x16x32_bf16 v[124:127], a[84:87], v[96:99], v[124:127]
    v_mfma_f32_16x16x32_bf16 v[116:119], a[88:91], a[88:91], v[116:119]
    v_mfma_f32_16x16x32_bf16 v[112:115], v[96:99], a[88:91], v[112:115]
    v_mfma_f32_16x16x32_bf16 v[120:123], a[92:95], a[88:91], v[120:123]
    v_mfma_f32_16x16x32_bf16 v[124:127], a[92:95], v[96:99], v[124:127]
    v_mfma_f32_16x16x32_bf16 v[116:119], a[96:99], a[96:99], v[116:119]
    v_mfma_f32_16x16x32_bf16 v[112:115], v[96:99], a[96:99], v[112:115]
    v_mfma_f32_16x16x32_bf16 v[120:123], a[100:103], a[96:99], v[120:123]
    v_mfma_f32_16x16x32_bf16 v[124:127], a[100:103], v[96:99], v[124:127]
    v_mfma_f32_16x16x32_bf16 v[116:119], a[104:107], a[104:107], v[116:119]
    v_mfma_f32_16x16x32_bf16 v[112:115], v[96:99], a[104:107], v[112:115]
    v_mfma_f32_16x16x32_bf16 v[120:123], a[108:111], a[104:107], v[120:123]
    v_mfma_f32_16x16x32_bf16 v[124:127], a[108:111], v[96:99], v[124:127]
    s_nop 4
    v_cndmask_b32 v4, v116, v117, s[58:59]
    v_cndmask_b32 v5, v118, v119, s[58:59]
    v_cndmask_b32 v4, v4, v5, s[64:65]
    ds_bpermute_b32 v4, v101, v4
    v_mul_f32 v5, 0xbacccccd, v112
    v_cvt_pk_bf16_f32 v104, v5, v5
    v_lshlrev_b32 v104, 16, v104
    v_mul_f32 v5, v5, v5
    v_mov_b32 v6, 0x3acccccd
    s_waitcnt lgkmcnt(0)
    v_fma_f32 v4, v4, v6, -v5
    v_max_f32 v4, 0, v4
    v_cvt_pk_bf16_f32 v4, v4, v4
    v_lshlrev_b32 v4, 16, v4
    v_add_f32 v4, 0x3727c5ac, v4
    v_cvt_pk_bf16_f32 v4, v4, v4
    v_lshlrev_b32 v4, 16, v4
    v_sqrt_f32 v4, v4
    s_nop 0
    v_cvt_pk_bf16_f32 v4, v4, v4
    v_lshlrev_b32 v4, 16, v4
    v_rcp_f32 v105, v4
    v_lshrrev_b32 v8, 16, v4
    v_fma_f32 v4, v104, v124, v120
    v_mul_f32 v4, v4, v105
    v_cvt_pk_bf16_f32 v4, v4, v4
    v_ashrrev_i32 v5, 31, v4
    v_or_b32 v5, 0x80000000, v5
    v_xor_b32 v4, v4, v5
    v_and_b32 v4, 0xffff0000, v4
    v_or_b32 v4, v4, v106
    ds_write_b32 v107, v4
    v_mov_b32 v11, 132864
    v_mov_b32 v7, 1
    s_mov_b64 exec, 1
    ds_add_u32 v11, v7
    s_mov_b64 exec, -1
    v_or_b32 v8, v8, v104
    v_mov_b32 v9, s34
    s_mov_b64 exec, 0xffff
    buffer_store_dwordx2 v[8:9], v108, s[28:31], 0 offen sc1
    s_mov_b64 exec, -1
    s_cmp_lg_u32 s26, 0
    s_cbranch_scc1 Lpub_done
    s_setprio 3
Lcw_8:
    s_sub_u32 s35, s35, 1
    s_cbranch_scc1 Lend
    ds_read_b32 v7, v11
    s_waitcnt lgkmcnt(0)
    v_readfirstlane_b32 s38, v7
    s_nop 0
    s_cmp_lt_u32 s38, 4
    s_cbranch_scc1 Lcw_8
    v_add_u32 v5, 132608, v12
    ds_read_b32 v6, v5
    s_waitcnt lgkmcnt(0)
    v_mov_b32 v4, v6
    s_nop 1
    v_max_u32_dpp v4, v4, v4 row_ror:8 row_mask:0xf bank_mask:0xf
    s_nop 1
    v_max_u32_dpp v4, v4, v4 row_ror:4 row_mask:0xf bank_mask:0xf
    s_nop 1
    v_max_u32_dpp v4, v4, v4 row_ror:2 row_mask:0xf bank_mask:0xf
    s_nop 1
    v_max_u32_dpp v4, v4, v4 row_ror:1 row_mask:0xf bank_mask:0xf
    s_nop 0
    v_readlane_b32 s66, v4, 0
    v_readlane_b32 s36, v4, 16
    v_readlane_b32 s37, v4, 32
    v_readlane_b32 s38, v4, 48
    s_max_u32 s66, s66, s36
    s_max_u32 s37, s37, s38
    s_max_u32 s66, s66, s37
    v_cmp_eq_u32 vcc, s66, v6
    s_nop 1
    v_cndmask_b32 v4, v6, 0, vcc
    s_nop 1
    v_max_u32_dpp v4, v4, v4 row_ror:8 row_mask:0xf bank_mask:0xf
    s_nop 1
    v_max_u32_dpp v4, v4, v4 row_ror:4 row_mask:0xf bank_mask:0xf
    s_nop 1
    v_max_u32_dpp v4, v4, v4 row_ror:2 row_mask:0xf bank_mask:0xf
    s_nop 1
    v_max_u32_dpp v4, v4, v4 row_ror:1 row_mask:0xf bank_mask:0xf
    s_nop 0
    v_readlane_b32 s67, v4, 0
    v_readlane_b32 s36, v4, 16
    v_readlane_b32 s37, v4, 32
    v_readlane_b32 s38, v4, 48
    s_max_u32 s67, s67, s36
    s_max_u32 s37, s37, s38
    s_max_u32 s67, s67, s37
    v_mov_b32 v112, s66
    v_mov_b32 v113, s34
    v_mov_b32 v114, s67
    v_mov_b32 v115, s34
    s_lshl_b32 s36, s32, 7
    s_add_u32 s36, s36, 8126464
    s_mov_b64 exec, 0xff
    buffer_store_dwordx4 v[112:115], v13, s[28:31], s36 offen sc1
    s_mov_b64 exec, -1
    v_mov_b32 v11, 132864
    v_mov_b32 v7, 1
    s_mov_b64 exec, 1
    ds_add_u32 v11, v7
    s_mov_b64 exec, -1
    s_mov_b64 exec, 1
    s_lshl_b32 s36, s2, 2
    s_add_u32 s36, s36, 8323072
    v_mov_b32 v4, s34
    v_mov_b32 v5, s36
    buffer_store_dword v4, v5, s[28:31], 0 offen sc1
    s_mov_b64 exec, -1
    s_setprio 0
Lpub_done:
Lcw_9:
    s_sub_u32 s35, s35, 1
    s_cbranch_scc1 Lend
    ds_read_b32 v7, v11
    s_waitcnt lgkmcnt(0)
    v_readfirstlane_b32 s38, v7
    s_nop 0
    s_cmp_lt_u32 s38, 5
    s_cbranch_scc1 Lcw_9
    s_cmp_ge_u32 s32, 27
    s_cbranch_scc1 Lhelp_r
    s_add_u32 m0, s40, 0
    s_add_u32 s41, s42, 0
    buffer_load_dwordx4 v18, s[44:47], s41 offen nt lds
    buffer_load_dwordx4 v19, s[44:47], s41 offen offset:1024 nt lds
    buffer_load_dwordx4 v20, s[44:47], s41 offen offset:2048 nt lds
    buffer_load_dwordx4 v21, s[44:47], s41 offen offset:3072 nt lds
    s_add_u32 m0, s40, 4096
    s_add_u32 s41, s42, 442368
    buffer_load_dwordx4 v18, s[44:47], s41 offen nt lds
    buffer_load_dwordx4 v19, s[44:47], s41 offen offset:1024 nt lds
    buffer_load_dwordx4 v20, s[44:47], s41 offen offset:2048 nt lds
    buffer_load_dwordx4 v21, s[44:47], s41 offen offset:3072 nt lds
    s_add_u32 m0, s40, 8192
    s_add_u32 s41, s42, 884736
    buffer_load_dwordx4 v18, s[44:47], s41 offen nt lds
    buffer_load_dwordx4 v19, s[44:47], s41 offen offset:1024 nt lds
    buffer_load_dwordx4 v20, s[44:47], s41 offen offset:2048 nt lds
    buffer_load_dwordx4 v21, s[44:47], s41 offen offset:3072 nt lds
    s_add_u32 m0, s40, 12288
    s_add_u32 s41, s42, 1327104
    buffer_load_dwordx4 v18, s[44:47], s41 offen nt lds
    buffer_load_dwordx4 v19, s[44:47], s41 offen offset:1024 nt lds
    buffer_load_dwordx4 v20, s[44:47], s41 offen offset:2048 nt lds
    buffer_load_dwordx4 v21, s[44:47], s41 offen offset:3072 nt lds
    s_waitcnt vmcnt(12)
    ds_read_b64_tr_b16 a[0:1], v14 offset:0
    ds_read_b64_tr_b16 a[2:3], v14 offset:512
    ds_read_b64_tr_b16 a[4:5], v15 offset:0
    ds_read_b64_tr_b16 a[6:7], v15 offset:512
    ds_read_b64_tr_b16 a[8:9], v16 offset:0
    ds_read_b64_tr_b16 a[10:11], v16 offset:512
    ds_read_b64_tr_b16 a[12:13], v17 offset:0
    ds_read_b64_tr_b16 a[14:15], v17 offset:512
    s_waitcnt lgkmcnt(0)
    s_add_u32 m0, s40, 0
    s_add_u32 s41, s42, 1769472
    buffer_load_dwordx4 v18, s[44:47], s41 offen nt lds
    buffer_load_dwordx4 v19, s[44:47], s41 offen offset:1024 nt lds
    buffer_load_dwordx4 v20, s[44:47], s41 offen offset:2048 nt lds
    buffer_load_dwordx4 v21, s[44:47], s41 offen offset:3072 nt lds
    v_mov_b32 v11, 132864
    v_mov_b32 v7, 1
    s_mov_b64 exec, 1
    ds_add_u32 v11, v7
    s_mov_b64 exec, -1
    s_waitcnt vmcnt(12)
    ds_read_b64_tr_b16 a[16:17], v14 offset:4096
    ds_read_b64_tr_b16 a[18:19], v14 offset:4608
    ds_read_b64_tr_b16 a[20:21], v15 offset:4096
    ds_read_b64_tr_b16 a[22:23], v15 offset:4608
    ds_read_b64_tr_b16 a[24:25], v16 offset:4096
    ds_read_b64_tr_b16 a[26:27], v16 offset:4608
    ds_read_b64_tr_b16 a[28:29], v17 offset:4096
    ds_read_b64_tr_b16 a[30:31], v17 offset:4608
    s_waitcnt lgkmcnt(0)
    s_add_u32 m0, s40, 4096
    s_add_u32 s41, s43, 0
    buffer_load_dwordx4 v22, s[48:51], s41 offen nt lds
    buffer_load_dwordx4 v23, s[48:51], s41 offen offset:1024 nt lds
    buffer_load_dwordx4 v24, s[48:51], s41 offen offset:2048 nt lds
    buffer_load_dwordx4 v25, s[48:51], s41 offen offset:3072 nt lds
    s_waitcnt vmcnt(12)
    ds_read_b64_tr_b16 a[32:33], v14 offset:8192
    ds_read_b64_tr_b16 a[34:35], v14 offset:8704
    ds_read_b64_tr_b16 a[36:37], v15 offset:8192
    ds_read_b64_tr_b16 a[38:39], v15 offset:8704
    ds_read_b64_tr_b16 a[40:41], v16 offset:8192
    ds_read_b64_tr_b16 a[42:43], v16 offset:8704
    ds_read_b64_tr_b16 a[44:45], v17 offset:8192
    ds_read_b64_tr_b16 a[46:47], v17 offset:8704
    s_waitcnt lgkmcnt(0)
    s_add_u32 m0, s40, 8192
    s_add_u32 s41, s43, 40960
    buffer_load_dwordx4 v22, s[48:51], s41 offen nt lds
    buffer_load_dwordx4 v23, s[48:51], s41 offen offset:1024 nt lds
    buffer_load_dwordx4 v24, s[48:51], s41 offen offset:2048 nt lds
    buffer_load_dwordx4 v25, s[48:51], s41 offen offset:3072 nt lds
    s_waitcnt vmcnt(12)
    ds_read_b64_tr_b16 a[48:49], v14 offset:12288
    ds_read_b64_tr_b16 a[50:51], v14 offset:12800
    ds_read_b64_tr_b16 a[52:53], v15 offset:12288
    ds_read_b64_tr_b16 a[54:55], v15 offset:12800
    ds_read_b64_tr_b16 a[56:57], v16 offset:12288
    ds_read_b64_tr_b16 a[58:59], v16 offset:12800
    ds_read_b64_tr_b16 a[60:61], v17 offset:12288
    ds_read_b64_tr_b16 a[62:63], v17 offset:12800
    s_waitcnt vmcnt(8)
    ds_read_b64_tr_b16 a[64:65], v14 offset:0
    ds_read_b64_tr_b16 a[66:67], v14 offset:512
    ds_read_b64_tr_b16 a[68:69], v15 offset:0
    ds_read_b64_tr_b16 a[70:71], v15 offset:512
    ds_read_b64_tr_b16 a[72:73], v16 offset:0
    ds_read_b64_tr_b16 a[74:75], v16 offset:512
    ds_read_b64_tr_b16 a[76:77], v17 offset:0
    ds_read_b64_tr_b16 a[78:79], v17 offset:512
    s_branch Laux_mm
Laux_u:
    s_cmp_ge_u32 s32, 27
    s_cbranch_scc1 Lend
    v_and_b32 v8, 1, v2
    v_lshlrev_b32 v8, 1, v8
    v_xor_b32 v8, v8, v6
    v_lshlrev_b32 v8, 4, v8
    v_mul_u32_u24 v9, 3456, v5
    s_lshl_b32 s38, s32, 7
    v_add3_u32 v18, v9, v8, s38
    v_xor_b32 v19, 64, v18
    v_add_u32 v19, 26624, v19
    v_add_u32 v20, 53248, v18
    v_add_u32 v21, 53248, v19
    s_mul_i32 s42, s26, 110592
    v_mul_u32_u24 v9, 1280, v5
    v_add_u32 v22, v9, v8
    v_xor_b32 v23, 64, v22
    v_add_u32 v23, 9216, v23
    v_add_u32 v24, 18432, v22
    v_add_u32 v25, 18432, v23
    s_mul_i32 s43, s32, 81920
    s_lshl_b32 s38, s3, 7
    s_add_u32 s43, s43, s38
    s_waitcnt lgkmcnt(0)
    s_mov_b64 s[44:45], s[16:17]
    s_mov_b32 s46, 2211840
    s_mov_b32 s47, 0x20000
    s_mov_b64 s[28:29], s[24:25]
    s_mov_b32 s30, 268435456
    s_mov_b32 s31, 0x20000
    s_load_dword s34, s[28:29], 0
    s_mov_b64 s[52:53], s[4:5]
    s_mov_b32 s54, 2621440
    s_mov_b32 s55, 0x20000
    s_mov_b64 s[48:49], s[18:19]
    s_mov_b32 s50, 2211840
    s_mov_b32 s51, 0x20000
    s_mov_b64 s[68:69], s[18:19]
    s_mov_b32 s70, 2211840
    s_mov_b32 s71, 0x20000
    s_cmp_ge_u32 s26, 2
    s_cselect_b32 s70, 0, s70
    v_bfe_u32 v10, v1, 2, 2
    v_and_b32 v8, 3, v1
    v_lshl_add_u32 v14, v2, 3, v10
    v_lshlrev_b32 v14, 7, v14
    v_lshlrev_b32 v9, 2, v1
    v_and_b32 v9, 0x60, v9
    v_add3_u32 v14, v14, v9, s40
    v_lshl_add_u32 v14, v8, 3, v14
    v_xor_b32 v15, 32, v14
    v_xor_b32 v16, 64, v14
    v_xor_b32 v17, 96, v14
    s_lshl_b32 s36, s26, 6
    s_add_u32 s36, s36, 141312
    v_lshl_add_u32 v26, v2, 4, s36
    v_min_u32 v8, 2, v3
    v_mul_u32_u24 v8, 1536, v8
    v_add_u32 v26, v26, v8
    s_waitcnt lgkmcnt(0)
    s_add_u32 s34, s34, 0x9e3779b8
    s_or_b32 s34, s34, 1
    s_cmp_lg_u32 s3, 7
    s_cbranch_scc1 Lnop7
    s_setprio 3
Lnop7:
    s_barrier
    s_add_u32 m0, s40, 0
    s_add_u32 s41, s42, 0
    buffer_load_dwordx4 v18, s[44:47], s41 offen nt lds
    buffer_load_dwordx4 v19, s[44:47], s41 offen offset:1024 nt lds
    buffer_load_dwordx4 v20, s[44:47], s41 offen offset:2048 nt lds
    buffer_load_dwordx4 v21, s[44:47], s41 offen offset:3072 nt lds
    s_add_u32 m0, s40, 4096
    s_add_u32 s41, s42, 442368
    buffer_load_dwordx4 v18, s[44:47], s41 offen nt lds
    buffer_load_dwordx4 v19, s[44:47], s41 offen offset:1024 nt lds
    buffer_load_dwordx4 v20, s[44:47], s41 offen offset:2048 nt lds
    buffer_load_dwordx4 v21, s[44:47], s41 offen offset:3072 nt lds
    s_add_u32 m0, s40, 8192
    s_add_u32 s41, s42, 884736
    buffer_load_dwordx4 v18, s[44:47], s41 offen nt lds
    buffer_load_dwordx4 v19, s[44:47], s41 offen offset:1024 nt lds
    buffer_load_dwordx4 v20, s[44:47], s41 offen offset:2048 nt lds
    buffer_load_dwordx4 v21, s[44:47], s41 offen offset:3072 nt lds
    s_add_u32 m0, s40, 12288
    s_add_u32 s41, s42, 1327104
    buffer_load_dwordx4 v18, s[44:47], s41 offen nt lds
    buffer_load_dwordx4 v19, s[44:47], s41 offen offset:1024 nt lds
    buffer_load_dwordx4 v20, s[44:47], s41 offen offset:2048 nt lds
    buffer_load_dwordx4 v21, s[44:47], s41 offen offset:3072 nt lds
    v_mov_b32 v11, 132864
Lcw_10:
    s_sub_u32 s35, s35, 1
    s_cbranch_scc1 Lend
    s_sleep 4
    ds_read_b32 v7, v11
    s_waitcnt lgkmcnt(0)
    v_readfirstlane_b32 s38, v7
    s_nop 0
    s_cmp_lt_u32 s38, 5
    s_cbranch_scc1 Lcw_10
    s_waitcnt vmcnt(12)
    ds_read_b64_tr_b16 a[0:1], v14 offset:0
    ds_read_b64_tr_b16 a[2:3], v14 offset:512
    ds_read_b64_tr_b16 a[4:5], v15 offset:0
    ds_read_b64_tr_b16 a[6:7], v15 offset:512
    ds_read_b64_tr_b16 a[8:9], v16 offset:0
    ds_read_b64_tr_b16 a[10:11], v16 offset:512
    ds_read_b64_tr_b16 a[12:13], v17 offset:0
    ds_read_b64_tr_b16 a[14:15], v17 offset:512
    s_waitcnt lgkmcnt(0)
    s_add_u32 m0, s40, 0
    s_add_u32 s41, s42, 1769472
    buffer_load_dwordx4 v18, s[44:47], s41 offen nt lds
    buffer_load_dwordx4 v19, s[44:47], s41 offen offset:1024 nt lds
    buffer_load_dwordx4 v20, s[44:47], s41 offen offset:2048 nt lds
    buffer_load_dwordx4 v21, s[44:47], s41 offen offset:3072 nt lds
    s_waitcnt vmcnt(12)
    ds_read_b64_tr_b16 a[16:17], v14 offset:4096
    ds_read_b64_tr_b16 a[18:19], v14 offset:4608
    ds_read_b64_tr_b16 a[20:21], v15 offset:4096
    ds_read_b64_tr_b16 a[22:23], v15 offset:4608
    ds_read_b64_tr_b16 a[24:25], v16 offset:4096
    ds_read_b64_tr_b16 a[26:27], v16 offset:4608
    ds_read_b64_tr_b16 a[28:29], v17 offset:4096
    ds_read_b64_tr_b16 a[30:31], v17 offset:4608
    s_waitcnt vmcnt(8)
    ds_read_b64_tr_b16 a[32:33], v14 offset:8192
    ds_read_b64_tr_b16 a[34:35], v14 offset:8704
    ds_read_b64_tr_b16 a[36:37], v15 offset:8192
    ds_read_b64_tr_b16 a[38:39], v15 offset:8704
    ds_read_b64_tr_b16 a[40:41], v16 offset:8192
    ds_read_b64_tr_b16 a[42:43], v16 offset:8704
    ds_read_b64_tr_b16 a[44:45], v17 offset:8192
    ds_read_b64_tr_b16 a[46:47], v17 offset:8704
    s_waitcnt vmcnt(4)
    ds_read_b64_tr_b16 a[48:49], v14 offset:12288
    ds_read_b64_tr_b16 a[50:51], v14 offset:12800
    ds_read_b64_tr_b16 a[52:53], v15 offset:12288
    ds_read_b64_tr_b16 a[54:55], v15 offset:12800
    ds_read_b64_tr_b16 a[56:57], v16 offset:12288
    ds_read_b64_tr_b16 a[58:59], v16 offset:12800
    ds_read_b64_tr_b16 a[60:61], v17 offset:12288
    ds_read_b64_tr_b16 a[62:63], v17 offset:12800
    s_waitcnt vmcnt(0)
    ds_read_b64_tr_b16 a[64:65], v14 offset:0
    ds_read_b64_tr_b16 a[66:67], v14 offset:512
    ds_read_b64_tr_b16 a[68:69], v15 offset:0
    ds_read_b64_tr_b16 a[70:71], v15 offset:512
    ds_read_b64_tr_b16 a[72:73], v16 offset:0
    ds_read_b64_tr_b16 a[74:75], v16 offset:512
    ds_read_b64_tr_b16 a[76:77], v17 offset:0
    ds_read_b64_tr_b16 a[78:79], v17 offset:512
    s_cmp_lg_u32 s3, 7
    s_cbranch_scc1 Lnofx
    v_mov_b32 v92, 0x3f803f80
    v_mov_b32 v93, 0x3f803f80
    v_mov_b32 v94, 0x3f803f80
    v_mov_b32 v95, 0x3f803f80
    v_add_u32 v4, 144384, v13
    ds_write_b128 v4, v[92:95]
    ds_write_b128 v4, v[92:95] offset:1024
    v_and_b32 v120, 31, v1
    v_lshlrev_b32 v120, 7, v120
    v_add_u32 v120, 8126464, v120
Lpt_11:
    s_sub_u32 s35, s35, 1
    s_cbranch_scc1 Lend
    s_sleep 2
    buffer_load_dwordx4 v[124:127], v120, s[28:31], 0 offen sc1
    s_waitcnt vmcnt(0)
    v_cmp_ne_u32 vcc, s34, v125
    v_cmp_ne_u32 s[36:37], s34, v127
    s_nop 0
    s_or_b64 s[36:37], s[36:37], vcc
    s_cbranch_scc1 Lpt_11
    v_mov_b32 v120, v124
    s_nop 1
    v_max_u32_dpp v120, v120, v120 row_ror:8 row_mask:0xf bank_mask:0xf
    s_nop 1
    v_max_u32_dpp v120, v120, v120 row_ror:4 row_mask:0xf bank_mask:0xf
    s_nop 1
    v_max_u32_dpp v120, v120, v120 row_ror:2 row_mask:0xf bank_mask:0xf
    s_nop 1
    v_max_u32_dpp v120, v120, v120 row_ror:1 row_mask:0xf bank_mask:0xf
    s_nop 0
    v_readlane_b32 s56, v120, 0
    v_readlane_b32 s36, v120, 16
    v_readlane_b32 s37, v120, 32
    v_readlane_b32 s38, v120, 48
    s_max_u32 s56, s56, s36
    s_max_u32 s37, s37, s38
    s_max_u32 s56, s56, s37
    v_cmp_eq_u32 vcc, s56, v124
    s_nop 1
    v_cndmask_b32 v120, v124, v126, vcc
    s_nop 1
    v_max_u32_dpp v120, v120, v120 row_ror:8 row_mask:0xf bank_mask:0xf
    s_nop 1
    v_max_u32_dpp v120, v120, v120 row_ror:4 row_mask:0xf bank_mask:0xf
    s_nop 1
    v_max_u32_dpp v120, v120, v120 row_ror:2 row_mask:0xf bank_mask:0xf
    s_nop 1
    v_max_u32_dpp v120, v120, v120 row_ror:1 row_mask:0xf bank_mask:0xf
    s_nop 0
    v_readlane_b32 s57, v120, 0
    v_readlane_b32 s36, v120, 16
    v_readlane_b32 s37, v120, 32
    v_readlane_b32 s38, v120, 48
    s_max_u32 s57, s57, s36
    s_max_u32 s37, s37, s38
    s_max_u32 s57, s57, s37
    s_and_b32 s36, s56, 0x7ff
    s_sub_u32 s36, 2047, s36
    s_and_b32 s37, s57, 0x7ff
    s_sub_u32 s37, 2047, s37
    s_mul_i32 s38, s36, 1280
    s_mul_i32 s39, s37, 1280
    s_mov_b32 m0, 141312
    v_mov_b32 v4, s36
    buffer_load_dwordx4 v13, s[52:55], s38 offen lds
    s_mov_b32 m0, 142848
    v_mov_b32 v5, s37
    buffer_load_dwordx4 v13, s[52:55], s39 offen lds
    s_mov_b64 exec, 0xffff
    buffer_load_dwordx4 v13, s[52:55], s39 offen offset:1024 lds
    s_mov_b32 m0, 141312
    s_mov_b32 vcc_lo, 0xaaaaaaaa
    buffer_load_dwordx4 v13, s[52:55], s38 offen offset:1024 lds
    s_mov_b64 exec, 3
    v_cndmask_b32 v4, v4, v5, vcc
    v_lshlrev_b32 v118, 3, v4
    v_add_u32 v118, 8192000, v118
    v_add_u32 v9, 132872, v12
Lxs_chk:
    s_sub_u32 s35, s35, 1
    s_cbranch_scc1 Lend
    buffer_load_dwordx2 v[116:117], v118, s[28:31], 0 offen sc1
    s_waitcnt vmcnt(0)
    v_cmp_ne_u32 vcc, s34, v117
    s_nop 0
    s_cbranch_vccnz Lxs_chk
    ds_write_b32 v9, v116
    s_mov_b64 exec, -1
    v_mov_b32 v10, 132868
    v_mov_b32 v7, 1
    s_mov_b64 exec, 1
    ds_add_u32 v10, v7
    s_mov_b64 exec, -1
Lnofx:
Lcw_12:
    s_sub_u32 s35, s35, 1
    s_cbranch_scc1 Lend
    s_sleep 2
    ds_read_b32 v7, v11
    s_waitcnt lgkmcnt(0)
    v_readfirstlane_b32 s38, v7
    s_nop 0
    s_cmp_lt_u32 s38, 9
    s_cbranch_scc1 Lcw_12
    s_add_u32 m0, s40, 4096
    s_add_u32 s41, s43, 0
    buffer_load_dwordx4 v22, s[48:51], s41 offen nt lds
    buffer_load_dwordx4 v23, s[48:51], s41 offen offset:1024 nt lds
    buffer_load_dwordx4 v24, s[48:51], s41 offen offset:2048 nt lds
    buffer_load_dwordx4 v25, s[48:51], s41 offen offset:3072 nt lds
    s_add_u32 m0, s40, 8192
    s_add_u32 s41, s43, 40960
    buffer_load_dwordx4 v22, s[48:51], s41 offen nt lds
    buffer_load_dwordx4 v23, s[48:51], s41 offen offset:1024 nt lds
    buffer_load_dwordx4 v24, s[48:51], s41 offen offset:2048 nt lds
    buffer_load_dwordx4 v25, s[48:51], s41 offen offset:3072 nt lds
    s_add_u32 m0, s40, 12288
    s_add_u32 s41, s43, 512
    buffer_load_dwordx4 v22, s[68:71], s41 offen nt lds
    buffer_load_dwordx4 v23, s[68:71], s41 offen offset:1024 nt lds
    buffer_load_dwordx4 v24, s[68:71], s41 offen offset:2048 nt lds
    buffer_load_dwordx4 v25, s[68:71], s41 offen offset:3072 nt lds
    s_add_u32 m0, s40, 0
    s_add_u32 s41, s43, 41472
    buffer_load_dwordx4 v22, s[68:71], s41 offen nt lds
    buffer_load_dwordx4 v23, s[68:71], s41 offen offset:1024 nt lds
    buffer_load_dwordx4 v24, s[68:71], s41 offen offset:2048 nt lds
    buffer_load_dwordx4 v25, s[68:71], s41 offen offset:3072 nt lds
Laux_mm:
    v_mov_b32 v10, 132868
Lcw_13:
    s_sub_u32 s35, s35, 1
    s_cbranch_scc1 Lend
    s_sleep 1
    ds_read_b32 v7, v10
    s_waitcnt lgkmcnt(0)
    v_readfirstlane_b32 s38, v7
    s_nop 0
    s_cmp_lt_u32 s38, 1
    s_cbranch_scc1 Lcw_13
    ds_read_b128 v[92:95], v26 offset:0
    ds_read_b128 v[96:99], v26 offset:256
    ds_read_b128 v[100:103], v26 offset:512
    ds_read_b128 v[104:107], v26 offset:768
    ds_read_b128 v[108:111], v26 offset:1024
    ds_read_b64 v[116:117], v10 offset:4
    s_waitcnt lgkmcnt(0)
    v_readfirstlane_b32 s56, v116
    v_readfirstlane_b32 s57, v117
    v_mfma_f32_16x16x32_bf16 v[112:115], a[0:3], v[92:95], 0
    v_mfma_f32_16x16x32_bf16 v[116:119], a[4:7], v[92:95], 0
    v_mfma_f32_16x16x32_bf16 v[120:123], a[8:11], v[92:95], 0
    v_mfma_f32_16x16x32_bf16 v[124:127], a[12:15], v[92:95], 0
    v_mfma_f32_16x16x32_bf16 v[112:115], a[16:19], v[96:99], v[112:115]
    v_mfma_f32_16x16x32_bf16 v[116:119], a[20:23], v[96:99], v[116:119]
    v_mfma_f32_16x16x32_bf16 v[120:123], a[24:27], v[96:99], v[120:123]
    v_mfma_f32_16x16x32_bf16 v[124:127], a[28:31], v[96:99], v[124:127]
    v_mfma_f32_16x16x32_bf16 v[112:115], a[32:35], v[100:103], v[112:115]
    v_mfma_f32_16x16x32_bf16 v[116:119], a[36:39], v[100:103], v[116:119]
    v_mfma_f32_16x16x32_bf16 v[120:123], a[40:43], v[100:103], v[120:123]
    v_mfma_f32_16x16x32_bf16 v[124:127], a[44:47], v[100:103], v[124:127]
    v_mfma_f32_16x16x32_bf16 v[112:115], a[48:51], v[104:107], v[112:115]
    v_mfma_f32_16x16x32_bf16 v[116:119], a[52:55], v[104:107], v[116:119]
    v_mfma_f32_16x16x32_bf16 v[120:123], a[56:59], v[104:107], v[120:123]
    v_mfma_f32_16x16x32_bf16 v[124:127], a[60:63], v[104:107], v[124:127]
    v_mfma_f32_16x16x32_bf16 v[112:115], a[64:67], v[108:111], v[112:115]
    v_mfma_f32_16x16x32_bf16 v[116:119], a[68:71], v[108:111], v[116:119]
    v_mfma_f32_16x16x32_bf16 v[120:123], a[72:75], v[108:111], v[120:123]
    v_mfma_f32_16x16x32_bf16 v[124:127], a[76:79], v[108:111], v[124:127]
    s_mul_i32 s36, s3, 768
    s_add_u32 s36, s36, 133120
    v_lshlrev_b32 v4, 8, v3
    v_lshl_add_u32 v4, v2, 4, v4
    v_add_u32 v4, s36, v4
    v_add_u32 v5, 133120, v12
    s_lshl_b32 s37, s3, 8
    s_add_u32 s37, s37, 139264
    v_lshl_add_u32 v6, v1, 1, s37
    v_and_b32 v7, 1, v1
    v_lshlrev_b32 v7, 7, v7
    v_lshl_add_u32 v7, v2, 4, v7
    v_add_u32 v7, s37, v7
    s_lshl_b32 s38, s56, 16
    s_lshl_b32 s39, s57, 16
    v_rcp_f32 v8, s38
    v_rcp_f32 v9, s39
    s_and_b32 s56, s56, 0xffff0000
    s_and_b32 s57, s57, 0xffff0000
    s_mov_b32 exec_lo, 0x00070007
    s_mov_b32 exec_hi, 0x00070007
    ds_write_b128 v4, v[112:115] offset:0
    ds_write_b128 v4, v[116:119] offset:64
    ds_write_b128 v4, v[120:123] offset:128
    ds_write_b128 v4, v[124:127] offset:192
    s_mov_b64 exec, -1
    s_waitcnt lgkmcnt(0)
    s_barrier
    ds_read2st64_b32 v[92:93], v5 offset0:0 offset1:1
    ds_read2st64_b32 v[94:95], v5 offset0:2 offset1:3
    ds_read2st64_b32 v[96:97], v5 offset0:4 offset1:5
    ds_read2st64_b32 v[98:99], v5 offset0:6 offset1:7
    ds_read2st64_b32 v[100:101], v5 offset0:8 offset1:9
    ds_read2st64_b32 v[102:103], v5 offset0:10 offset1:11
    ds_read2st64_b32 v[116:117], v5 offset0:12 offset1:13
    ds_read2st64_b32 v[118:119], v5 offset0:14 offset1:15
    ds_read2st64_b32 v[120:121], v5 offset0:16 offset1:17
    ds_read2st64_b32 v[122:123], v5 offset0:18 offset1:19
    ds_read2st64_b32 v[124:125], v5 offset0:20 offset1:21
    ds_read2st64_b32 v[126:127], v5 offset0:22 offset1:23
    v_cmp_eq_u32 s[72:73], 1, v2
    v_cmp_eq_u32 s[74:75], 2, v2
    v_cmp_eq_u32 s[76:77], 3, v2
    s_mul_i32 s37, s32, 10
    s_add_u32 s37, s37, s3
    s_lshl_b32 s37, s37, 10
    s_add_u32 s37, s37, 7405568
    s_waitcnt lgkmcnt(0)
    v_add_f32 v92, v92, v95
    v_add_f32 v98, v98, v101
    v_add_f32 v92, v92, v98
    v_add_f32 v93, v93, v96
    v_add_f32 v99, v99, v102
    v_add_f32 v93, v93, v99
    v_add_f32 v94, v94, v97
    v_add_f32 v100, v100, v103
    v_add_f32 v94, v94, v100
    v_add_f32 v116, v116, v119
    v_add_f32 v122, v122, v125
    v_add_f32 v116, v116, v122
    v_add_f32 v117, v117, v120
    v_add_f32 v123, v123, v126
    v_add_f32 v117, v117, v123
    v_add_f32 v118, v118, v121
    v_add_f32 v124, v124, v127
    v_add_f32 v118, v118, v124
    v_fmac_f32 v92, s56, v94
    v_mul_f32 v112, v92, v8
    v_fmac_f32 v93, s57, v94
    v_mul_f32 v113, v93, v9
    v_fmac_f32 v116, s56, v118
    v_mul_f32 v120, v116, v8
    v_fmac_f32 v117, s57, v118
    v_mul_f32 v121, v117, v9
    v_cvt_pk_bf16_f32 v113, v112, v113
    v_lshlrev_b32 v112, 16, v113
    v_and_b32 v113, 0xffff0000, v113
    v_cvt_pk_bf16_f32 v121, v120, v121
    v_lshlrev_b32 v120, 16, v121
    v_and_b32 v121, 0xffff0000, v121
    v_mul_f32 v114, 0xbfb8aa3b, v112
    v_mul_f32 v115, 0xbfb8aa3b, v113
    v_exp_f32 v114, v114
    v_exp_f32 v115, v115
    v_add_f32 v114, 1.0, v114
    v_add_f32 v115, 1.0, v115
    v_rcp_f32 v114, v114
    v_rcp_f32 v115, v115
    v_mul_f32 v114, v114, v112
    v_mul_f32 v115, v115, v113
    v_cvt_pk_bf16_f32 v115, v114, v115
    v_lshlrev_b32 v114, 16, v115
    v_and_b32 v115, 0xffff0000, v115
    v_mul_f32 v114, v114, v120
    v_mul_f32 v115, v115, v121
    v_cvt_pk_bf16_f32 v114, v114, v115
    ds_write_b16 v6, v114
    ds_write_b16_d16_hi v6, v114 offset:128
    ds_read_b128 v[92:95], v7 offset:0
    ds_read_b128 v[96:99], v7 offset:64
    v_mov_b32 v101, s34
    v_mov_b32 v103, s34
    s_waitcnt vmcnt(0)
    ds_read_b64_tr_b16 v[28:29], v14 offset:4096
    ds_read_b64_tr_b16 v[30:31], v14 offset:4608
    ds_read_b64_tr_b16 v[32:33], v15 offset:4096
    ds_read_b64_tr_b16 v[34:35], v15 offset:4608
    ds_read_b64_tr_b16 v[36:37], v16 offset:4096
    ds_read_b64_tr_b16 v[38:39], v16 offset:4608
    ds_read_b64_tr_b16 v[40:41], v17 offset:4096
    ds_read_b64_tr_b16 v[42:43], v17 offset:4608
    ds_read_b64_tr_b16 v[44:45], v14 offset:8192
    ds_read_b64_tr_b16 v[46:47], v14 offset:8704
    ds_read_b64_tr_b16 v[48:49], v15 offset:8192
    ds_read_b64_tr_b16 v[50:51], v15 offset:8704
    ds_read_b64_tr_b16 v[52:53], v16 offset:8192
    ds_read_b64_tr_b16 v[54:55], v16 offset:8704
    ds_read_b64_tr_b16 v[56:57], v17 offset:8192
    ds_read_b64_tr_b16 v[58:59], v17 offset:8704
    s_waitcnt lgkmcnt(0)
    v_mfma_f32_16x16x32_bf16 v[112:115], v[92:95], v[28:31], 0
    v_mfma_f32_16x16x32_bf16 v[116:119], v[92:95], v[32:35], 0
    v_mfma_f32_16x16x32_bf16 v[120:123], v[92:95], v[36:39], 0
    v_mfma_f32_16x16x32_bf16 v[124:127], v[92:95], v[40:43], 0
    v_mfma_f32_16x16x32_bf16 v[112:115], v[96:99], v[44:47], v[112:115]
    v_mfma_f32_16x16x32_bf16 v[116:119], v[96:99], v[48:51], v[116:119]
    v_mfma_f32_16x16x32_bf16 v[120:123], v[96:99], v[52:55], v[120:123]
    v_mfma_f32_16x16x32_bf16 v[124:127], v[96:99], v[56:59], v[124:127]
    s_nop 5
    v_cndmask_b32 v100, v112, v116, s[72:73]
    v_cndmask_b32 v100, v100, v120, s[74:75]
    v_cndmask_b32 v100, v100, v124, s[76:77]
    v_cndmask_b32 v102, v113, v117, s[72:73]
    v_cndmask_b32 v102, v102, v121, s[74:75]
    v_cndmask_b32 v102, v102, v125, s[76:77]
    buffer_store_dwordx4 v[100:103], v13, s[28:31], s37 offen sc1
    s_sub_u32 s36, s3, 4
    s_cmp_ge_u32 s36, 2
    s_cbranch_scc1 Laux_end
    s_add_u32 s37, s37, 4096
    ds_read_b64_tr_b16 v[60:61], v14 offset:12288
    ds_read_b64_tr_b16 v[62:63], v14 offset:12800
    ds_read_b64_tr_b16 v[64:65], v15 offset:12288
    ds_read_b64_tr_b16 v[66:67], v15 offset:12800
    ds_read_b64_tr_b16 v[68:69], v16 offset:12288
    ds_read_b64_tr_b16 v[70:71], v16 offset:12800
    ds_read_b64_tr_b16 v[72:73], v17 offset:12288
    ds_read_b64_tr_b16 v[74:75], v17 offset:12800
    ds_read_b64_tr_b16 v[76:77], v14 offset:0
    ds_read_b64_tr_b16 v[78:79], v14 offset:512
    ds_read_b64_tr_b16 v[80:81], v15 offset:0
    ds_read_b64_tr_b16 v[82:83], v15 offset:512
    ds_read_b64_tr_b16 v[84:85], v16 offset:0
    ds_read_b64_tr_b16 v[86:87], v16 offset:512
    ds_read_b64_tr_b16 v[88:89], v17 offset:0
    ds_read_b64_tr_b16 v[90:91], v17 offset:512
    s_waitcnt lgkmcnt(0)
    v_mfma_f32_16x16x32_bf16 v[112:115], v[92:95], v[60:63], 0
    v_mfma_f32_16x16x32_bf16 v[116:119], v[92:95], v[64:67], 0
    v_mfma_f32_16x16x32_bf16 v[120:123], v[92:95], v[68:71], 0
    v_mfma_f32_16x16x32_bf16 v[124:127], v[92:95], v[72:75], 0
    v_mfma_f32_16x16x32_bf16 v[112:115], v[96:99], v[76:79], v[112:115]
    v_mfma_f32_16x16x32_bf16 v[116:119], v[96:99], v[80:83], v[116:119]
    v_mfma_f32_16x16x32_bf16 v[120:123], v[96:99], v[84:87], v[120:123]
    v_mfma_f32_16x16x32_bf16 v[124:127], v[96:99], v[88:91], v[124:127]
    s_nop 5
    v_cndmask_b32 v100, v112, v116, s[72:73]
    v_cndmask_b32 v100, v100, v120, s[74:75]
    v_cndmask_b32 v100, v100, v124, s[76:77]
    v_cndmask_b32 v102, v113, v117, s[72:73]
    v_cndmask_b32 v102, v102, v121, s[74:75]
    v_cndmask_b32 v102, v102, v125, s[76:77]
    buffer_store_dwordx4 v[100:103], v13, s[28:31], s37 offen sc1
Laux_end:
    s_endpgm
Lmst:
    s_cmp_lg_u32 s3, 0
    s_cbranch_scc1 Lhelp_i
    s_waitcnt lgkmcnt(0)
    s_mov_b64 s[28:29], s[24:25]
    s_mov_b32 s30, 268435456
    s_mov_b32 s31, 0x20000
    s_load_dword s34, s[28:29], 0
    s_waitcnt lgkmcnt(0)
    s_add_u32 s34, s34, 0x9e3779b8
    s_or_b32 s34, s34, 1
    s_mov_b64 exec, 1
    s_lshl_b32 s36, s2, 2
    s_add_u32 s36, s36, 8323072
    v_mov_b32 v4, s34
    v_mov_b32 v5, s36
    buffer_store_dword v4, v5, s[28:31], 0 offen sc1
    s_mov_b64 exec, -1
    s_cmp_lg_u32 s32, 32
    s_cbranch_scc1 Lend
Lmst_bc:
    v_and_b32 v4, 31, v1
    v_lshlrev_b32 v4, 7, v4
    v_add_u32 v4, 8126464, v4
Lpt_14:
    s_sub_u32 s35, s35, 1
    s_cbranch_scc1 Lend
    s_sleep 8
    buffer_load_dwordx4 v[8:11], v4, s[28:31], 0 offen sc1
    s_waitcnt vmcnt(0)
    v_cmp_ne_u32 vcc, s34, v9
    v_cmp_ne_u32 s[36:37], s34, v11
    s_nop 0
    s_or_b64 s[36:37], s[36:37], vcc
    s_cbranch_scc1 Lpt_14
    v_mov_b32 v4, v8
    s_nop 1
    v_max_u32_dpp v4, v4, v4 row_ror:8 row_mask:0xf bank_mask:0xf
    s_nop 1
    v_max_u32_dpp v4, v4, v4 row_ror:4 row_mask:0xf bank_mask:0xf
    s_nop 1
    v_max_u32_dpp v4, v4, v4 row_ror:2 row_mask:0xf bank_mask:0xf
    s_nop 1
    v_max_u32_dpp v4, v4, v4 row_ror:1 row_mask:0xf bank_mask:0xf
    s_nop 0
    v_readlane_b32 s40, v4, 0
    v_readlane_b32 s36, v4, 16
    v_readlane_b32 s37, v4, 32
    v_readlane_b32 s38, v4, 48
    s_max_u32 s40, s40, s36
    s_max_u32 s37, s37, s38
    s_max_u32 s40, s40, s37
    v_cmp_eq_u32 vcc, s40, v8
    s_nop 1
    v_cndmask_b32 v4, v8, v10, vcc
    s_nop 1
    v_max_u32_dpp v4, v4, v4 row_ror:8 row_mask:0xf bank_mask:0xf
    s_nop 1
    v_max_u32_dpp v4, v4, v4 row_ror:4 row_mask:0xf bank_mask:0xf
    s_nop 1
    v_max_u32_dpp v4, v4, v4 row_ror:2 row_mask:0xf bank_mask:0xf
    s_nop 1
    v_max_u32_dpp v4, v4, v4 row_ror:1 row_mask:0xf bank_mask:0xf
    s_nop 0
    v_readlane_b32 s41, v4, 0
    v_readlane_b32 s36, v4, 16
    v_readlane_b32 s37, v4, 32
    v_readlane_b32 s38, v4, 48
    s_max_u32 s41, s41, s36
    s_max_u32 s37, s37, s38
    s_max_u32 s41, s41, s37
    v_mov_b32 v8, s40
    v_mov_b32 v9, s34
    v_mov_b32 v10, s41
    v_mov_b32 v11, s34
    s_mov_b32 s36, 8257536
    buffer_store_dwordx4 v[8:11], v13, s[28:31], s36 offen offset:0 sc1
    buffer_store_dwordx4 v[8:11], v13, s[28:31], s36 offen offset:1024 sc1
    buffer_store_dwordx4 v[8:11], v13, s[28:31], s36 offen offset:2048 sc1
    s_mov_b32 s36, 8323072
Lmaster:
    s_sub_u32 s35, s35, 1
    s_cbranch_scc1 Lend
    s_sleep 16
    buffer_load_dwordx4 v[4:7], v13, s[28:31], s36 offen sc1
    s_waitcnt vmcnt(0)
    v_xor_b32 v4, s34, v4
    v_xor_b32 v5, s34, v5
    v_xor_b32 v6, s34, v6
    v_xor_b32 v7, s34, v7
    v_or3_b32 v4, v4, v5, v6
    v_or_b32 v4, v4, v7
    v_cmp_ne_u32 vcc, 0, v4
    s_nop 0
    s_cbranch_vccnz Lmaster
    s_mov_b64 exec, 1
    buffer_store_dword v9, v4, s[28:31], 0 offen sc1
    s_endpgm
Lhelp_r:
    s_sub_u32 s72, s32, 27
    s_add_u32 s72, s72, 9
    s_mov_b32 s73, 5
    s_mov_b32 s37, 2
    s_branch Lhelp
Lhelp_i:
    s_cmp_eq_u32 s32, 32
    s_cbranch_scc1 Lend
    s_cmp_eq_u32 s27, 0
    s_cbranch_scc1 Lend
    s_sub_u32 s72, s32, 33
    s_mov_b32 s73, 3
    s_mov_b32 s37, 3
Lhelp:
    s_lshl_b32 s38, s26, 6
    v_add_u32 v4, s38, v1
    v_mul_u32_u24 v4, 1280, v4
    s_waitcnt lgkmcnt(0)
    s_mov_b64 s[68:69], s[8:9]
    s_mov_b32 s70, 819200
    s_mov_b32 s71, 0x20000
    v_add_u32 v7, s38, v1
    v_lshlrev_b32 v7, 7, v7
    s_cmp_eq_u32 s73, 3
    s_cselect_b32 s36, 5, 2
    s_cselect_b32 s39, 33, 27
    s_cselect_b32 s38, 0, 15
    s_sub_u32 s39, s32, s39
    s_mul_i32 s39, s39, s36
    s_add_u32 s39, s39, s38
    s_lshl_b32 s39, s39, 15
Lhelp1:
    buffer_load_dword v5, v7, s[68:71], s39 offen
    s_add_u32 s39, s39, 32768
    s_sub_u32 s36, s36, 1
    s_cmp_lg_u32 s36, 0
    s_cbranch_scc1 Lhelp1
    s_mov_b64 s[68:69], s[18:19]
    s_mov_b32 s70, 2211840
    s_mov_b32 s71, 0x20000
Lhelp2:
    s_mul_i32 s38, s72, 9363
    s_lshr_b32 s38, s38, 16
    s_mul_i32 s39, s38, 7
    s_sub_u32 s39, s72, s39
    s_mul_i32 s39, s39, 327680
    s_lshl_b32 s38, s38, 7
    s_sub_u32 s39, s39, s38
    s_add_u32 s39, s39, 1152
    v_add_u32 v6, s39, v4
    buffer_load_dword v5, v6, s[68:71], 0 offen
    s_add_u32 s72, s72, s73
    s_sub_u32 s37, s37, 1
    s_cmp_lg_u32 s37, 0
    s_cbranch_scc1 Lhelp2
Lend:
    s_endpgm
.section .rodata,"a"
.p2align 6
.amdhsa_kernel recurrent_scan__sliding_local_dilated__moe_arch_mod__prompt_kernel
  .amdhsa_next_free_vgpr 256
  .amdhsa_next_free_sgpr 102
  .amdhsa_accum_offset 128
  .amdhsa_group_segment_fixed_size 0
  .amdhsa_kernarg_size 88
  .amdhsa_user_sgpr_count 2
  .amdhsa_user_sgpr_kernarg_segment_ptr 1
  .amdhsa_system_sgpr_workgroup_id_x 1
  .amdhsa_float_denorm_mode_32 3
.end_amdhsa_kernel
```
